```python
import torch

def _softmax(x, axis=-1):
    return torch.softmax(x, dim=axis)
def _gelu(x):
    return torch.nn.functional.gelu(x, approximate="tanh")
def _silu(x):
    return torch.nn.functional.silu(x)
def _sigmoid(x):
    return torch.sigmoid(x)
def _layernorm(x, axis=-1, eps=1e-5):
    m = x.mean(dim=axis, keepdim=True)
    v = x.var(dim=axis, keepdim=True, unbiased=False)
    return (x - m) / torch.sqrt(v + eps)
def _scatter_add(tgt, idx, src, axis=0):
    return tgt.clone().index_add_(axis, idx, src)
def _segment_sum(src, seg, n):
    out = torch.zeros((n,) + src.shape[1:], dtype=src.dtype)
    return out.index_add_(0, seg, src)
def _pad(x, pw):
    flat = tuple(v for pair in reversed(pw) for v in pair)
    return torch.nn.functional.pad(x, flat)

kernel_name = 'gated_mix__compressed_kv_cla__mha_block__prompt'

def setup_inputs():

    _w = (lambda a: (lambda t: t.to(torch.bfloat16) if t.is_floating_point() else t)(torch.as_tensor(a)))
    def _A_setup():
        B, H, Sq, Sk, D, M = 1, 32, 2048, 2048, 128, 512
        Dc = 4 * D
        return {
            "x": _w((lambda *s: torch.randn(*s, dtype=torch.bfloat16) * 0.05)(B, Sq, M)),
            "c_kv": _w((lambda *s: torch.randn(*s, dtype=torch.bfloat16) * 1.6)(B, Sk, Dc)),
            "w_q": _w((lambda *s: torch.randn(*s, dtype=torch.bfloat16) * 3.2)(M, H, D) * (M ** -0.5)),
            "w_uk": _w((lambda *s: torch.randn(*s, dtype=torch.bfloat16) * 3.2)(Dc, H, D) * (Dc ** -0.5)),
            "w_uv": _w((lambda *s: torch.randn(*s, dtype=torch.bfloat16) * 1.6)(Dc, H, D) * (Dc ** -0.5)),
            "w_o": _w((lambda *s: torch.randn(*s, dtype=torch.bfloat16) * 1.6)(H, D, M) * ((H * D) ** -0.5)),
        }
    _A_in = _A_setup()

    def _B_setup():
        B, S, D, H = 1, 2048, 512, 32
        return {
            "x": _w((lambda *s: torch.randn(*s, dtype=torch.bfloat16) * 0.05)(B, S, D)),
            "wqkv": _w((lambda *s: torch.randn(*s, dtype=torch.bfloat16) * 1.6)(D, 3 * D)),
            "wo": _w((lambda *s: torch.randn(*s, dtype=torch.bfloat16) * 0.05)(D, D)),
        }
    _B_in = _B_setup()

    return {
        "A_x": _A_in["x"],
        "A_c_kv": _A_in["c_kv"],
        "A_w_q": _A_in["w_q"],
        "A_w_uk": _A_in["w_uk"],
        "A_w_uv": _A_in["w_uv"],
        "A_w_o": _A_in["w_o"],
        "B_x": _B_in["x"],
        "B_wqkv": _B_in["wqkv"],
        "B_wo": _B_in["wo"],
        "gate_w": _w((lambda *s: torch.randn(*s, dtype=torch.bfloat16) * 0.05)(512) * 16.0),
    }

def reference(A_x, A_c_kv, A_w_q, A_w_uk, A_w_uv, A_w_o, B_x, B_wqkv, B_wo, gate_w):
    def _A_ref(x, c_kv, w_q, w_uk, w_uv, w_o):
        B, Sq, M = x.shape[0], x.shape[1], x.shape[2]
        Sk = c_kv.shape[1]
        H, D = w_q.shape[1], w_q.shape[2]
        q = torch.einsum("bqm,mhd->bhqd", x, w_q)
        k = torch.einsum("bkc,chd->bhkd", c_kv, w_uk)
        v = torch.einsum("bkc,chd->bhkd", c_kv, w_uv)
        scores = torch.einsum("bhqd,bhkd->bhqk", q, k) * (D ** -0.5)
        off = Sk - Sq
        qi = torch.arange(Sq)[:, None]
        kj = torch.arange(Sk)[None, :]
        cmask = kj <= (qi + off)
        scores = torch.where(cmask[None, None], scores, -1e9)
        p = _softmax(scores, axis=-1)
        ctx = torch.einsum("bhqk,bhkd->bhqd", p, v)
        return torch.einsum("bhqd,hdm->bqm", ctx, w_o)

    def _B_ref(x, wqkv, wo):
        B, S, D = x.shape
        H = 32
        Dh = D // H
        qkv = (lambda x, *d: x.permute(*d))((x @ wqkv).reshape(B, S, 3, H, Dh), 2, 0, 3, 1, 4)
        q, k, v = qkv[0], qkv[1], qkv[2]
        scores = torch.einsum("bhqd,bhkd->bhqk", q, k) * (Dh ** -0.5)
        p = _softmax(scores, axis=-1)
        o = torch.einsum("bhqk,bhkd->bhqd", p, v)
        return (lambda x, *d: x.permute(*d))(o, 0, 2, 1, 3).reshape(B, S, D) @ wo

    x = A_x
    g = _sigmoid((x * gate_w).sum(-1, keepdims=True))
    a = _A_ref(x, A_c_kv, A_w_q, A_w_uk, A_w_uv, A_w_o)
    b = _B_ref(x, B_wqkv, B_wo)
    return g * a + (1 - g) * b
```

```asm
; @launch grid=(256,1,1) block=(256,1,1) lds=163840
.amdgcn_target "amdgcn-amd-amdhsa--gfx950"
.text
.globl gated_mix__compressed_kv_cla__mha_block__prompt_kernel
.p2align 8
.type gated_mix__compressed_kv_cla__mha_block__prompt_kernel,@function
gated_mix__compressed_kv_cla__mha_block__prompt_kernel:
  s_cmp_ge_u32 s2, 256
  s_cbranch_scc1 F_END
  s_load_dwordx4 s[72:75], s[0:1], 0
  s_load_dwordx4 s[76:79], s[0:1], 24
  s_load_dwordx2 s[6:7], s[0:1], 56
  s_getpc_b64 s[96:97]
P1_PC0:
  s_mov_b32 s98, P1_TAB-P1_PC0
  s_mov_b32 s99, 0x20000
  s_lshr_b32 s3, s2, 3
  s_mul_i32 s3, s3, 5120
  v_mul_u32_u24 v22, 20, v0
  v_add_u32 v22, s3, v22
  buffer_load_dword v23, v22, s[96:99], 0 offen
  v_lshrrev_b32 v27, 6, v0
  v_and_b32 v20, 63, v0
  v_readfirstlane_b32 s16, v27
  s_and_b32 s3, s2, 7
  s_bfe_u32 s18, s2, 0x30003
  s_lshr_b32 s37, s2, 6
  s_lshl_b32 s17, s3, 2
  s_add_u32 s17, s17, s37
  v_lshrrev_b32 v27, 4, v20
  v_lshrrev_b32 v18, 3, v20
  v_and_b32 v31, 7, v20
  v_xor_b32 v30, v31, v27
  v_lshlrev_b32 v30, 4, v30
  v_lshl_add_u32 v9, v18, 10, v30
  v_xor_b32 v10, 64, v9
  v_add_u32 v10, 7168, v10
  v_add_u32 v11, 14336, v9
  v_add_u32 v12, 14336, v10
  v_and_b32 v24, 1, v27
  v_lshlrev_b32 v30, 1, v24
  v_xor_b32 v30, v30, v31
  v_lshlrev_b32 v19, 4, v30
  s_lshl_b32 s19, s16, 12
  s_mul_i32 s20, s16, 24576
  s_add_u32 s20, s20, 65536
  s_lshl_b32 s30, s18, 2
  s_add_u32 s30, s30, s16
  s_lshl_b32 s25, s30, 16
  s_add_u32 s26, s25, 32768
  s_lshl_b32 s30, s30, 1
  s_and_b32 s31, s3, 3
  s_mul_i32 s35, s31, 3
  s_add_u32 s35, s35, s37
  s_mul_i32 s35, s35, 640
  s_cmp_eq_u32 s37, 3
  s_cselect_b32 s35, 7680, s35
  s_cselect_b32 s31, s31, 0
  s_lshr_b32 s37, s3, 2
  s_sub_u32 s28, s3, s37
  s_sub_u32 s28, s28, 1
  s_lshl_b32 s28, s28, 9
  s_mov_b32 s34, 8192
  s_mov_b32 s14, 4194304
  s_cmp_lg_u32 s31, 0
  s_cselect_b32 s35, s28, s35
  s_cselect_b32 s34, 3072, s34
  s_cselect_b32 s14, 1572864, s14
  s_mov_b32 s46, 2097152
  s_mov_b32 s47, 0x20000
  s_mov_b32 s15, 0x20000
  s_waitcnt lgkmcnt(0)
  s_cmp_eq_u32 s37, 0
  s_cselect_b64 s[12:13], s[76:77], s[78:79]
  s_cmp_lg_u32 s31, 0
  s_cselect_b64 s[44:45], s[72:73], s[74:75]
  s_cselect_b64 s[12:13], s[6:7], s[12:13]
  s_mov_b32 s76, 0
  s_mov_b32 s77, 256
  s_mov_b32 s78, 512
  s_mov_b32 s79, 768
  s_add_u32 m0, s20, 0
  s_add_u32 s28, s25, s76
  buffer_load_dwordx4 v9, s[44:47], s28 offen offset:0 lds
  buffer_load_dwordx4 v10, s[44:47], s28 offen offset:1024 lds
  buffer_load_dwordx4 v11, s[44:47], s28 offen offset:2048 lds
  buffer_load_dwordx4 v12, s[44:47], s28 offen offset:3072 lds
  s_add_u32 m0, s20, 4096
  s_add_u32 s28, s26, s76
  buffer_load_dwordx4 v9, s[44:47], s28 offen offset:0 lds
  buffer_load_dwordx4 v10, s[44:47], s28 offen offset:1024 lds
  buffer_load_dwordx4 v11, s[44:47], s28 offen offset:2048 lds
  buffer_load_dwordx4 v12, s[44:47], s28 offen offset:3072 lds
  s_load_dwordx2 s[52:53], s[0:1], 16
  s_load_dwordx2 s[8:9], s[0:1], 96
  s_load_dwordx2 s[40:41], s[0:1], 88
  s_load_dwordx2 s[32:33], s[0:1], 72
  s_getpc_b64 s[6:7]
P1_PC:
  s_add_u32 s4, s6, P1_TAB-P1_PC
  s_addc_u32 s5, s7, 0
  s_lshl_b32 s3, s17, 6
  s_load_dwordx16 s[56:71], s[4:5], s3
  v_mad_u32_u24 v5, v18, s34, v19
  s_lshl_b32 s29, s34, 3
  s_sub_u32 s29, s29, 1024
  v_xor_b32 v6, 64, v5
  v_add_u32 v6, s29, v6
  s_lshl_b32 s29, s29, 1
  v_add_u32 v7, s29, v5
  v_add_u32 v8, s29, v6
  s_mul_i32 s21, s34, s16
  s_lshl_b32 s21, s21, 5
  s_add_u32 s21, s21, s35
  s_lshr_b32 s29, s76, 1
  s_mul_i32 s29, s29, s34
  s_add_u32 s22, s21, s29
  s_lshr_b32 s29, s77, 1
  s_mul_i32 s29, s29, s34
  s_add_u32 s23, s21, s29
  s_lshr_b32 s29, s78, 1
  s_mul_i32 s29, s29, s34
  s_add_u32 s24, s21, s29
  s_lshr_b32 s29, s79, 1
  s_mul_i32 s29, s29, s34
  s_add_u32 s38, s21, s29
  s_add_u32 m0, s19, 0
  s_add_u32 s21, s22, 0
  buffer_load_dwordx4 v5, s[12:15], s21 offen offset:0 lds
  buffer_load_dwordx4 v6, s[12:15], s21 offen offset:1024 lds
  buffer_load_dwordx4 v7, s[12:15], s21 offen offset:2048 lds
  buffer_load_dwordx4 v8, s[12:15], s21 offen offset:3072 lds
  v_and_b32 v28, 15, v20
  v_lshrrev_b32 v25, 1, v27
  v_lshlrev_b32 v26, 4, v28
  v_and_b32 v29, 3, v28
  v_bfe_u32 v30, v28, 2, 1
  v_bfe_u32 v31, v28, 3, 1
  v_lshl_add_u32 v29, v30, 3, v29
  v_lshl_add_u32 v29, v31, 2, v29
  v_lshlrev_b32 v21, 4, v29
  v_lshrrev_b32 v30, 1, v29
  v_xor_b32 v30, v30, v27
  v_lshlrev_b32 v30, 4, v30
  v_lshl_add_u32 v30, v29, 7, v30
  v_add_u32 v13, s20, v30
  v_xor_b32 v14, 64, v13
  v_lshrrev_b32 v30, 1, v28
  v_xor_b32 v30, v30, v27
  v_lshlrev_b32 v30, 4, v30
  v_lshl_add_u32 v30, v28, 7, v30
  v_add_u32 v15, s20, v30
  v_xor_b32 v16, 64, v15
  v_lshrrev_b32 v30, 2, v28
  v_lshl_add_u32 v29, v27, 3, v30
  v_lshlrev_b32 v29, 7, v29
  v_and_b32 v31, 3, v28
  v_lshl_add_u32 v29, v31, 3, v29
  v_lshrrev_b32 v30, 1, v30
  v_lshl_add_u32 v30, v24, 1, v30
  v_lshlrev_b32 v30, 5, v30
  v_add_u32 v1, v29, v30
  v_xor_b32 v2, 32, v1
  v_xor_b32 v3, 64, v1
  v_xor_b32 v4, 96, v1
  s_mov_b32 s10, 83886080
  s_mov_b32 s11, 0x20000
  s_mov_b32 s50, 83886080
  s_mov_b32 s51, 0x20000
  s_mov_b32 s42, 256
  s_mov_b32 s43, 0x20000
  s_mov_b64 s[54:55], s[72:73]
  s_mov_b32 s39, 83886080
  v_and_b32 v30, 15, v20
  s_lshl_b32 s101, s30, 3
  v_add_u32 v30, s101, v30
  v_mul_u32_u24 v28, s34, v30
  v_lshl_add_u32 v30, v24, 7, v28
  v_lshrrev_b32 v31, 4, v20
  v_min_u32 v31, 2, v31
  v_lshl_add_u32 v28, v31, 7, v28
  s_add_u32 m0, s20, 8064
  s_add_u32 s28, s25, s76
  buffer_load_dwordx4 v9, s[44:47], s28 offen offset:128 lds
  buffer_load_dwordx4 v10, s[44:47], s28 offen offset:1152 lds
  buffer_load_dwordx4 v11, s[44:47], s28 offen offset:2176 lds
  buffer_load_dwordx4 v12, s[44:47], s28 offen offset:3200 lds
  s_add_u32 m0, s20, 12160
  s_add_u32 s28, s26, s76
  buffer_load_dwordx4 v9, s[44:47], s28 offen offset:128 lds
  buffer_load_dwordx4 v10, s[44:47], s28 offen offset:1152 lds
  buffer_load_dwordx4 v11, s[44:47], s28 offen offset:2176 lds
  buffer_load_dwordx4 v12, s[44:47], s28 offen offset:3200 lds
  s_add_u32 m0, s19, 16384
  s_add_u32 s21, s22, 128
  buffer_load_dwordx4 v5, s[12:15], s21 offen offset:0 lds
  buffer_load_dwordx4 v6, s[12:15], s21 offen offset:1024 lds
  buffer_load_dwordx4 v7, s[12:15], s21 offen offset:2048 lds
  buffer_load_dwordx4 v8, s[12:15], s21 offen offset:3072 lds
  s_add_u32 m0, s19, 32768
  s_add_u32 s21, s22, 256
  buffer_load_dwordx4 v5, s[12:15], s21 offen offset:0 lds
  buffer_load_dwordx4 v6, s[12:15], s21 offen offset:1024 lds
  buffer_load_dwordx4 v7, s[12:15], s21 offen offset:2048 lds
  buffer_load_dwordx4 v8, s[12:15], s21 offen offset:3072 lds
  v_and_b32 v31, 31, v20
  v_lshlrev_b32 v31, 7, v31
  s_mov_b32 s99, 0x20000
  s_mov_b32 s98, 2097152
  s_lshl_b32 s100, s2, 1
  s_and_b32 s101, s16, 1
  s_add_u32 s100, s100, s101
  s_lshl_b32 s100, s100, 12
  s_cmp_lt_u32 s16, 2
  s_cselect_b64 s[96:97], s[74:75], s[72:73]
  buffer_load_dword v23, v31, s[96:99], s100 offen
  buffer_load_dword v23, v28, s[12:15], s35 offen
  s_waitcnt lgkmcnt(0)
  s_lshr_b32 s4, s61, 16
  s_mov_b64 s[48:49], s[8:9]
  s_mov_b32 s27, s60
  s_mov_b64 s[72:73], s[32:33]
  s_mov_b32 s74, 1024
  s_mov_b32 s75, 0x20000
  s_cmp_lg_u32 s16, 0
  s_cbranch_scc1 P1_Z
  buffer_load_dword v23, v31, s[72:75], 0 offen
  s_lshl_b32 s37, s4, 7
  s_lshr_b32 s31, s30, 1
  s_add_u32 s37, s37, s31
  s_add_u32 s37, s37, 81788928
  v_mov_b32 v27, 0
  s_mov_b64 exec, 1
  buffer_store_dword v27, off, s[8:11], s37 sc1
  s_lshl_b32 s37, s18, 7
  s_lshl_b32 s31, s17, 2
  s_add_u32 s37, s37, s31
  s_add_u32 s37, s37, 81793024
  buffer_store_dword v27, off, s[8:11], s37 sc1
  buffer_store_dword v27, off, s[8:11], s37 offset:1024 sc1
  s_mov_b64 exec, -1
P1_Z:
  s_lshl_b32 s31, s18, 2
  s_add_u32 s31, s31, s16
  s_lshl_b32 s31, s31, 17
  v_and_b32 v29, 15, v20
  v_lshlrev_b32 v29, 13, v29
  v_lshl_add_u32 v29, v24, 7, v29
  v_add_u32 v29, s31, v29
  s_waitcnt vmcnt(22)
  ds_read_b128 a[0:3], v13 offset:0
  ds_read_b128 a[16:19], v14 offset:0
  ds_read_b128 a[4:7], v13 offset:2048
  ds_read_b128 a[20:23], v14 offset:2048
  ds_read_b128 a[8:11], v13 offset:4096
  ds_read_b128 a[24:27], v14 offset:4096
  ds_read_b128 a[12:15], v13 offset:6144
  ds_read_b128 a[28:31], v14 offset:6144
  s_waitcnt vmcnt(10)
  s_barrier
  ds_read_b64_tr_b16 v[224:225], v1 offset:0
  ds_read_b64_tr_b16 v[226:227], v1 offset:512
  ds_read_b64_tr_b16 v[228:229], v1 offset:4096
  ds_read_b64_tr_b16 v[230:231], v1 offset:4608
  ds_read_b64_tr_b16 v[232:233], v1 offset:8192
  ds_read_b64_tr_b16 v[234:235], v1 offset:8704
  ds_read_b64_tr_b16 v[236:237], v1 offset:12288
  ds_read_b64_tr_b16 v[238:239], v1 offset:12800
  ds_read_b128 a[32:35], v13 offset:8192
  ds_read_b128 a[48:51], v14 offset:8192
  ds_read_b128 a[36:39], v13 offset:10240
  ds_read_b128 a[52:55], v14 offset:10240
  ds_read_b128 a[40:43], v13 offset:12288
  ds_read_b128 a[56:59], v14 offset:12288
  ds_read_b128 a[44:47], v13 offset:14336
  ds_read_b128 a[60:63], v14 offset:14336
  s_cmp_eq_u32 s59, 0
  s_cbranch_scc0 P1_V1
P1_V0:
  v_mad_u32_u24 v17, v24, s63, v21
  v_mad_u32_u24 v17, v25, s64, v17
  s_mul_i32 s29, s56, 3968
  v_bfe_u32 v27, v20, 2, 1
  v_mad_u32_u24 v17, v27, s29, v17
  s_mul_i32 s29, s66, s30
  s_add_u32 s36, s69, s29
  s_waitcnt lgkmcnt(0)
  v_mfma_f32_16x16x32_bf16 v[32:35], v[224:227], a[0:3], 0
  ds_read_b64_tr_b16 v[240:241], v2 offset:0
  v_mfma_f32_16x16x32_bf16 v[32:35], v[228:231], a[16:19], v[32:35]
  ds_read_b64_tr_b16 v[242:243], v2 offset:512
  v_mfma_f32_16x16x32_bf16 v[32:35], v[232:235], a[32:35], v[32:35]
  ds_read_b64_tr_b16 v[244:245], v2 offset:4096
  v_mfma_f32_16x16x32_bf16 v[32:35], v[236:239], a[48:51], v[32:35]
  v_mfma_f32_16x16x32_bf16 v[36:39], v[224:227], a[4:7], 0
  ds_read_b64_tr_b16 v[246:247], v2 offset:4608
  v_mfma_f32_16x16x32_bf16 v[36:39], v[228:231], a[20:23], v[36:39]
  ds_read_b64_tr_b16 v[248:249], v2 offset:8192
  v_mfma_f32_16x16x32_bf16 v[36:39], v[232:235], a[36:39], v[36:39]
  ds_read_b64_tr_b16 v[250:251], v2 offset:8704
  v_mfma_f32_16x16x32_bf16 v[36:39], v[236:239], a[52:55], v[36:39]
  v_mfma_f32_16x16x32_bf16 v[40:43], v[224:227], a[8:11], 0
  ds_read_b64_tr_b16 v[252:253], v2 offset:12288
  v_mfma_f32_16x16x32_bf16 v[40:43], v[228:231], a[24:27], v[40:43]
  ds_read_b64_tr_b16 v[254:255], v2 offset:12800
  v_mfma_f32_16x16x32_bf16 v[40:43], v[232:235], a[40:43], v[40:43]
  v_mfma_f32_16x16x32_bf16 v[40:43], v[236:239], a[56:59], v[40:43]
  v_mfma_f32_16x16x32_bf16 v[44:47], v[224:227], a[12:15], 0
  v_mfma_f32_16x16x32_bf16 v[44:47], v[228:231], a[28:31], v[44:47]
  v_mfma_f32_16x16x32_bf16 v[44:47], v[232:235], a[44:47], v[44:47]
  v_mfma_f32_16x16x32_bf16 v[44:47], v[236:239], a[60:63], v[44:47]
  s_waitcnt lgkmcnt(0)
  v_mfma_f32_16x16x32_bf16 v[48:51], v[240:243], a[0:3], 0
  ds_read_b64_tr_b16 v[224:225], v3 offset:0
  v_mfma_f32_16x16x32_bf16 v[48:51], v[244:247], a[16:19], v[48:51]
  ds_read_b64_tr_b16 v[226:227], v3 offset:512
  v_mfma_f32_16x16x32_bf16 v[48:51], v[248:251], a[32:35], v[48:51]
  ds_read_b64_tr_b16 v[228:229], v3 offset:4096
  v_mfma_f32_16x16x32_bf16 v[48:51], v[252:255], a[48:51], v[48:51]
  v_mfma_f32_16x16x32_bf16 v[52:55], v[240:243], a[4:7], 0
  ds_read_b64_tr_b16 v[230:231], v3 offset:4608
  v_mfma_f32_16x16x32_bf16 v[52:55], v[244:247], a[20:23], v[52:55]
  ds_read_b64_tr_b16 v[232:233], v3 offset:8192
  v_mfma_f32_16x16x32_bf16 v[52:55], v[248:251], a[36:39], v[52:55]
  ds_read_b64_tr_b16 v[234:235], v3 offset:8704
  v_mfma_f32_16x16x32_bf16 v[52:55], v[252:255], a[52:55], v[52:55]
  v_mfma_f32_16x16x32_bf16 v[56:59], v[240:243], a[8:11], 0
  ds_read_b64_tr_b16 v[236:237], v3 offset:12288
  v_mfma_f32_16x16x32_bf16 v[56:59], v[244:247], a[24:27], v[56:59]
  ds_read_b64_tr_b16 v[238:239], v3 offset:12800
  v_mfma_f32_16x16x32_bf16 v[56:59], v[248:251], a[40:43], v[56:59]
  v_mfma_f32_16x16x32_bf16 v[56:59], v[252:255], a[56:59], v[56:59]
  v_mfma_f32_16x16x32_bf16 v[60:63], v[240:243], a[12:15], 0
  v_mfma_f32_16x16x32_bf16 v[60:63], v[244:247], a[28:31], v[60:63]
  v_mfma_f32_16x16x32_bf16 v[60:63], v[248:251], a[44:47], v[60:63]
  v_mfma_f32_16x16x32_bf16 v[60:63], v[252:255], a[60:63], v[60:63]
  s_waitcnt lgkmcnt(0)
  v_mfma_f32_16x16x32_bf16 v[64:67], v[224:227], a[0:3], 0
  ds_read_b64_tr_b16 v[240:241], v4 offset:0
  s_add_u32 m0, s19, 49152
  v_mfma_f32_16x16x32_bf16 v[64:67], v[228:231], a[16:19], v[64:67]
  ds_read_b64_tr_b16 v[242:243], v4 offset:512
  s_add_u32 s21, s23, 0
  v_mfma_f32_16x16x32_bf16 v[64:67], v[232:235], a[32:35], v[64:67]
  ds_read_b64_tr_b16 v[244:245], v4 offset:4096
  v_mfma_f32_16x16x32_bf16 v[64:67], v[236:239], a[48:51], v[64:67]
  buffer_load_dwordx4 v5, s[12:15], s21 offen offset:0 lds
  v_mfma_f32_16x16x32_bf16 v[68:71], v[224:227], a[4:7], 0
  ds_read_b64_tr_b16 v[246:247], v4 offset:4608
  v_mfma_f32_16x16x32_bf16 v[68:71], v[228:231], a[20:23], v[68:71]
  ds_read_b64_tr_b16 v[248:249], v4 offset:8192
  v_mfma_f32_16x16x32_bf16 v[68:71], v[232:235], a[36:39], v[68:71]
  ds_read_b64_tr_b16 v[250:251], v4 offset:8704
  v_mfma_f32_16x16x32_bf16 v[68:71], v[236:239], a[52:55], v[68:71]
  buffer_load_dwordx4 v6, s[12:15], s21 offen offset:1024 lds
  v_mfma_f32_16x16x32_bf16 v[72:75], v[224:227], a[8:11], 0
  ds_read_b64_tr_b16 v[252:253], v4 offset:12288
  v_mfma_f32_16x16x32_bf16 v[72:75], v[228:231], a[24:27], v[72:75]
  ds_read_b64_tr_b16 v[254:255], v4 offset:12800
  v_mfma_f32_16x16x32_bf16 v[72:75], v[232:235], a[40:43], v[72:75]
  v_mfma_f32_16x16x32_bf16 v[72:75], v[236:239], a[56:59], v[72:75]
  buffer_load_dwordx4 v7, s[12:15], s21 offen offset:2048 lds
  v_mfma_f32_16x16x32_bf16 v[76:79], v[224:227], a[12:15], 0
  v_mfma_f32_16x16x32_bf16 v[76:79], v[228:231], a[28:31], v[76:79]
  v_mfma_f32_16x16x32_bf16 v[76:79], v[232:235], a[44:47], v[76:79]
  v_mfma_f32_16x16x32_bf16 v[76:79], v[236:239], a[60:63], v[76:79]
  buffer_load_dwordx4 v8, s[12:15], s21 offen offset:3072 lds
  s_waitcnt vmcnt(10) lgkmcnt(0)
  s_barrier
  v_mfma_f32_16x16x32_bf16 v[80:83], v[240:243], a[0:3], 0
  ds_read_b64_tr_b16 v[224:225], v1 offset:16384
  s_add_u32 m0, s20, 16384
  v_mfma_f32_16x16x32_bf16 v[80:83], v[244:247], a[16:19], v[80:83]
  ds_read_b64_tr_b16 v[226:227], v1 offset:16896
  s_add_u32 s28, s25, s77
  v_mfma_f32_16x16x32_bf16 v[80:83], v[248:251], a[32:35], v[80:83]
  ds_read_b64_tr_b16 v[228:229], v1 offset:20480
  v_mfma_f32_16x16x32_bf16 v[80:83], v[252:255], a[48:51], v[80:83]
  buffer_load_dwordx4 v9, s[44:47], s28 offen offset:0 lds
  v_mfma_f32_16x16x32_bf16 v[84:87], v[240:243], a[4:7], 0
  ds_read_b64_tr_b16 v[230:231], v1 offset:20992
  v_mfma_f32_16x16x32_bf16 v[84:87], v[244:247], a[20:23], v[84:87]
  ds_read_b64_tr_b16 v[232:233], v1 offset:24576
  v_mfma_f32_16x16x32_bf16 v[84:87], v[248:251], a[36:39], v[84:87]
  ds_read_b64_tr_b16 v[234:235], v1 offset:25088
  v_mfma_f32_16x16x32_bf16 v[84:87], v[252:255], a[52:55], v[84:87]
  buffer_load_dwordx4 v10, s[44:47], s28 offen offset:1024 lds
  v_mfma_f32_16x16x32_bf16 v[88:91], v[240:243], a[8:11], 0
  ds_read_b64_tr_b16 v[236:237], v1 offset:28672
  v_mfma_f32_16x16x32_bf16 v[88:91], v[244:247], a[24:27], v[88:91]
  ds_read_b64_tr_b16 v[238:239], v1 offset:29184
  v_mfma_f32_16x16x32_bf16 v[88:91], v[248:251], a[40:43], v[88:91]
  v_mfma_f32_16x16x32_bf16 v[88:91], v[252:255], a[56:59], v[88:91]
  buffer_load_dwordx4 v11, s[44:47], s28 offen offset:2048 lds
  v_mfma_f32_16x16x32_bf16 v[92:95], v[240:243], a[12:15], 0
  v_mfma_f32_16x16x32_bf16 v[92:95], v[244:247], a[28:31], v[92:95]
  v_mfma_f32_16x16x32_bf16 v[92:95], v[248:251], a[44:47], v[92:95]
  v_mfma_f32_16x16x32_bf16 v[92:95], v[252:255], a[60:63], v[92:95]
  buffer_load_dwordx4 v12, s[44:47], s28 offen offset:3072 lds
  s_waitcnt lgkmcnt(0)
  v_mfma_f32_16x16x32_bf16 v[96:99], v[224:227], a[0:3], 0
  ds_read_b64_tr_b16 v[240:241], v2 offset:16384
  s_add_u32 m0, s20, 20480
  v_mfma_f32_16x16x32_bf16 v[96:99], v[228:231], a[16:19], v[96:99]
  ds_read_b64_tr_b16 v[242:243], v2 offset:16896
  s_add_u32 s28, s26, s77
  v_mfma_f32_16x16x32_bf16 v[96:99], v[232:235], a[32:35], v[96:99]
  ds_read_b64_tr_b16 v[244:245], v2 offset:20480
  v_mfma_f32_16x16x32_bf16 v[96:99], v[236:239], a[48:51], v[96:99]
  buffer_load_dwordx4 v9, s[44:47], s28 offen offset:0 lds
  v_mfma_f32_16x16x32_bf16 v[100:103], v[224:227], a[4:7], 0
  ds_read_b64_tr_b16 v[246:247], v2 offset:20992
  v_mfma_f32_16x16x32_bf16 v[100:103], v[228:231], a[20:23], v[100:103]
  ds_read_b64_tr_b16 v[248:249], v2 offset:24576
  v_mfma_f32_16x16x32_bf16 v[100:103], v[232:235], a[36:39], v[100:103]
  ds_read_b64_tr_b16 v[250:251], v2 offset:25088
  v_mfma_f32_16x16x32_bf16 v[100:103], v[236:239], a[52:55], v[100:103]
  buffer_load_dwordx4 v10, s[44:47], s28 offen offset:1024 lds
  v_mfma_f32_16x16x32_bf16 v[104:107], v[224:227], a[8:11], 0
  ds_read_b64_tr_b16 v[252:253], v2 offset:28672
  v_mfma_f32_16x16x32_bf16 v[104:107], v[228:231], a[24:27], v[104:107]
  ds_read_b64_tr_b16 v[254:255], v2 offset:29184
  v_mfma_f32_16x16x32_bf16 v[104:107], v[232:235], a[40:43], v[104:107]
  v_mfma_f32_16x16x32_bf16 v[104:107], v[236:239], a[56:59], v[104:107]
  buffer_load_dwordx4 v11, s[44:47], s28 offen offset:2048 lds
  v_mfma_f32_16x16x32_bf16 v[108:111], v[224:227], a[12:15], 0
  v_mfma_f32_16x16x32_bf16 v[108:111], v[228:231], a[28:31], v[108:111]
  v_mfma_f32_16x16x32_bf16 v[108:111], v[232:235], a[44:47], v[108:111]
  v_mfma_f32_16x16x32_bf16 v[108:111], v[236:239], a[60:63], v[108:111]
  buffer_load_dwordx4 v12, s[44:47], s28 offen offset:3072 lds
  s_waitcnt lgkmcnt(0)
  v_mfma_f32_16x16x32_bf16 v[112:115], v[240:243], a[0:3], 0
  ds_read_b64_tr_b16 v[224:225], v3 offset:16384
  s_add_u32 m0, s20, -128
  v_mfma_f32_16x16x32_bf16 v[112:115], v[244:247], a[16:19], v[112:115]
  ds_read_b64_tr_b16 v[226:227], v3 offset:16896
  s_add_u32 s28, s25, s77
  v_mfma_f32_16x16x32_bf16 v[112:115], v[248:251], a[32:35], v[112:115]
  ds_read_b64_tr_b16 v[228:229], v3 offset:20480
  v_mfma_f32_16x16x32_bf16 v[112:115], v[252:255], a[48:51], v[112:115]
  buffer_load_dwordx4 v9, s[44:47], s28 offen offset:128 lds
  v_mfma_f32_16x16x32_bf16 v[116:119], v[240:243], a[4:7], 0
  ds_read_b64_tr_b16 v[230:231], v3 offset:20992
  v_mfma_f32_16x16x32_bf16 v[116:119], v[244:247], a[20:23], v[116:119]
  ds_read_b64_tr_b16 v[232:233], v3 offset:24576
  v_mfma_f32_16x16x32_bf16 v[116:119], v[248:251], a[36:39], v[116:119]
  ds_read_b64_tr_b16 v[234:235], v3 offset:25088
  v_mfma_f32_16x16x32_bf16 v[116:119], v[252:255], a[52:55], v[116:119]
  buffer_load_dwordx4 v10, s[44:47], s28 offen offset:1152 lds
  v_mfma_f32_16x16x32_bf16 v[120:123], v[240:243], a[8:11], 0
  ds_read_b64_tr_b16 v[236:237], v3 offset:28672
  v_mfma_f32_16x16x32_bf16 v[120:123], v[244:247], a[24:27], v[120:123]
  ds_read_b64_tr_b16 v[238:239], v3 offset:29184
  v_mfma_f32_16x16x32_bf16 v[120:123], v[248:251], a[40:43], v[120:123]
  v_mfma_f32_16x16x32_bf16 v[120:123], v[252:255], a[56:59], v[120:123]
  buffer_load_dwordx4 v11, s[44:47], s28 offen offset:2176 lds
  v_mfma_f32_16x16x32_bf16 v[124:127], v[240:243], a[12:15], 0
  v_mfma_f32_16x16x32_bf16 v[124:127], v[244:247], a[28:31], v[124:127]
  v_mfma_f32_16x16x32_bf16 v[124:127], v[248:251], a[44:47], v[124:127]
  v_mfma_f32_16x16x32_bf16 v[124:127], v[252:255], a[60:63], v[124:127]
  buffer_load_dwordx4 v12, s[44:47], s28 offen offset:3200 lds
  s_waitcnt lgkmcnt(0)
  v_mfma_f32_16x16x32_bf16 v[128:131], v[224:227], a[0:3], 0
  ds_read_b64_tr_b16 v[240:241], v4 offset:16384
  s_add_u32 m0, s20, 3968
  v_mfma_f32_16x16x32_bf16 v[128:131], v[228:231], a[16:19], v[128:131]
  ds_read_b64_tr_b16 v[242:243], v4 offset:16896
  s_add_u32 s28, s26, s77
  v_mfma_f32_16x16x32_bf16 v[128:131], v[232:235], a[32:35], v[128:131]
  ds_read_b64_tr_b16 v[244:245], v4 offset:20480
  v_mfma_f32_16x16x32_bf16 v[128:131], v[236:239], a[48:51], v[128:131]
  buffer_load_dwordx4 v9, s[44:47], s28 offen offset:128 lds
  v_mfma_f32_16x16x32_bf16 v[132:135], v[224:227], a[4:7], 0
  ds_read_b64_tr_b16 v[246:247], v4 offset:20992
  v_mfma_f32_16x16x32_bf16 v[132:135], v[228:231], a[20:23], v[132:135]
  ds_read_b64_tr_b16 v[248:249], v4 offset:24576
  v_mfma_f32_16x16x32_bf16 v[132:135], v[232:235], a[36:39], v[132:135]
  ds_read_b64_tr_b16 v[250:251], v4 offset:25088
  v_mfma_f32_16x16x32_bf16 v[132:135], v[236:239], a[52:55], v[132:135]
  buffer_load_dwordx4 v10, s[44:47], s28 offen offset:1152 lds
  v_mfma_f32_16x16x32_bf16 v[136:139], v[224:227], a[8:11], 0
  ds_read_b64_tr_b16 v[252:253], v4 offset:28672
  v_mfma_f32_16x16x32_bf16 v[136:139], v[228:231], a[24:27], v[136:139]
  ds_read_b64_tr_b16 v[254:255], v4 offset:29184
  v_mfma_f32_16x16x32_bf16 v[136:139], v[232:235], a[40:43], v[136:139]
  v_mfma_f32_16x16x32_bf16 v[136:139], v[236:239], a[56:59], v[136:139]
  buffer_load_dwordx4 v11, s[44:47], s28 offen offset:2176 lds
  v_mfma_f32_16x16x32_bf16 v[140:143], v[224:227], a[12:15], 0
  v_mfma_f32_16x16x32_bf16 v[140:143], v[228:231], a[28:31], v[140:143]
  v_mfma_f32_16x16x32_bf16 v[140:143], v[232:235], a[44:47], v[140:143]
  v_mfma_f32_16x16x32_bf16 v[140:143], v[236:239], a[60:63], v[140:143]
  buffer_load_dwordx4 v12, s[44:47], s28 offen offset:3200 lds
  s_waitcnt vmcnt(22) lgkmcnt(0)
  s_barrier
  v_mfma_f32_16x16x32_bf16 v[144:147], v[240:243], a[0:3], 0
  ds_read_b64_tr_b16 v[224:225], v1 offset:32768
  s_add_u32 m0, s19, 0
  v_mfma_f32_16x16x32_bf16 v[144:147], v[244:247], a[16:19], v[144:147]
  ds_read_b64_tr_b16 v[226:227], v1 offset:33280
  s_add_u32 s21, s23, 128
  v_mfma_f32_16x16x32_bf16 v[144:147], v[248:251], a[32:35], v[144:147]
  ds_read_b64_tr_b16 v[228:229], v1 offset:36864
  v_mfma_f32_16x16x32_bf16 v[144:147], v[252:255], a[48:51], v[144:147]
  buffer_load_dwordx4 v5, s[12:15], s21 offen offset:0 lds
  v_mfma_f32_16x16x32_bf16 v[148:151], v[240:243], a[4:7], 0
  ds_read_b64_tr_b16 v[230:231], v1 offset:37376
  v_mfma_f32_16x16x32_bf16 v[148:151], v[244:247], a[20:23], v[148:151]
  ds_read_b64_tr_b16 v[232:233], v1 offset:40960
  v_mfma_f32_16x16x32_bf16 v[148:151], v[248:251], a[36:39], v[148:151]
  ds_read_b64_tr_b16 v[234:235], v1 offset:41472
  v_mfma_f32_16x16x32_bf16 v[148:151], v[252:255], a[52:55], v[148:151]
  buffer_load_dwordx4 v6, s[12:15], s21 offen offset:1024 lds
  v_mfma_f32_16x16x32_bf16 v[152:155], v[240:243], a[8:11], 0
  ds_read_b64_tr_b16 v[236:237], v1 offset:45056
  v_mfma_f32_16x16x32_bf16 v[152:155], v[244:247], a[24:27], v[152:155]
  ds_read_b64_tr_b16 v[238:239], v1 offset:45568
  v_mfma_f32_16x16x32_bf16 v[152:155], v[248:251], a[40:43], v[152:155]
  v_mfma_f32_16x16x32_bf16 v[152:155], v[252:255], a[56:59], v[152:155]
  buffer_load_dwordx4 v7, s[12:15], s21 offen offset:2048 lds
  v_mfma_f32_16x16x32_bf16 v[156:159], v[240:243], a[12:15], 0
  v_mfma_f32_16x16x32_bf16 v[156:159], v[244:247], a[28:31], v[156:159]
  v_mfma_f32_16x16x32_bf16 v[156:159], v[248:251], a[44:47], v[156:159]
  v_mfma_f32_16x16x32_bf16 v[156:159], v[252:255], a[60:63], v[156:159]
  buffer_load_dwordx4 v8, s[12:15], s21 offen offset:3072 lds
  s_waitcnt lgkmcnt(0)
  v_mfma_f32_16x16x32_bf16 v[160:163], v[224:227], a[0:3], 0
  ds_read_b64_tr_b16 v[240:241], v2 offset:32768
  s_add_u32 m0, s19, 16384
  v_mfma_f32_16x16x32_bf16 v[160:163], v[228:231], a[16:19], v[160:163]
  ds_read_b64_tr_b16 v[242:243], v2 offset:33280
  s_add_u32 s21, s23, 256
  v_mfma_f32_16x16x32_bf16 v[160:163], v[232:235], a[32:35], v[160:163]
  ds_read_b64_tr_b16 v[244:245], v2 offset:36864
  v_mfma_f32_16x16x32_bf16 v[160:163], v[236:239], a[48:51], v[160:163]
  buffer_load_dwordx4 v5, s[12:15], s21 offen offset:0 lds
  v_mfma_f32_16x16x32_bf16 v[164:167], v[224:227], a[4:7], 0
  ds_read_b64_tr_b16 v[246:247], v2 offset:37376
  v_mfma_f32_16x16x32_bf16 v[164:167], v[228:231], a[20:23], v[164:167]
  ds_read_b64_tr_b16 v[248:249], v2 offset:40960
  v_mfma_f32_16x16x32_bf16 v[164:167], v[232:235], a[36:39], v[164:167]
  ds_read_b64_tr_b16 v[250:251], v2 offset:41472
  v_mfma_f32_16x16x32_bf16 v[164:167], v[236:239], a[52:55], v[164:167]
  buffer_load_dwordx4 v6, s[12:15], s21 offen offset:1024 lds
  v_mfma_f32_16x16x32_bf16 v[168:171], v[224:227], a[8:11], 0
  ds_read_b64_tr_b16 v[252:253], v2 offset:45056
  v_mfma_f32_16x16x32_bf16 v[168:171], v[228:231], a[24:27], v[168:171]
  ds_read_b64_tr_b16 v[254:255], v2 offset:45568
  v_mfma_f32_16x16x32_bf16 v[168:171], v[232:235], a[40:43], v[168:171]
  v_mfma_f32_16x16x32_bf16 v[168:171], v[236:239], a[56:59], v[168:171]
  buffer_load_dwordx4 v7, s[12:15], s21 offen offset:2048 lds
  v_mfma_f32_16x16x32_bf16 v[172:175], v[224:227], a[12:15], 0
  v_mfma_f32_16x16x32_bf16 v[172:175], v[228:231], a[28:31], v[172:175]
  v_mfma_f32_16x16x32_bf16 v[172:175], v[232:235], a[44:47], v[172:175]
  v_mfma_f32_16x16x32_bf16 v[172:175], v[236:239], a[60:63], v[172:175]
  buffer_load_dwordx4 v8, s[12:15], s21 offen offset:3072 lds
  s_waitcnt vmcnt(16) lgkmcnt(0)
  v_mfma_f32_16x16x32_bf16 v[176:179], v[240:243], a[0:3], 0
  ds_read_b64_tr_b16 v[224:225], v3 offset:32768
  v_mfma_f32_16x16x32_bf16 v[176:179], v[244:247], a[16:19], v[176:179]
  ds_read_b64_tr_b16 v[226:227], v3 offset:33280
  v_mfma_f32_16x16x32_bf16 v[176:179], v[248:251], a[32:35], v[176:179]
  ds_read_b64_tr_b16 v[228:229], v3 offset:36864
  v_mfma_f32_16x16x32_bf16 v[176:179], v[252:255], a[48:51], v[176:179]
  ds_read_b128 a[64:67], v13 offset:16384
  v_mfma_f32_16x16x32_bf16 v[180:183], v[240:243], a[4:7], 0
  ds_read_b64_tr_b16 v[230:231], v3 offset:37376
  v_mfma_f32_16x16x32_bf16 v[180:183], v[244:247], a[20:23], v[180:183]
  ds_read_b64_tr_b16 v[232:233], v3 offset:40960
  v_mfma_f32_16x16x32_bf16 v[180:183], v[248:251], a[36:39], v[180:183]
  ds_read_b64_tr_b16 v[234:235], v3 offset:41472
  v_mfma_f32_16x16x32_bf16 v[180:183], v[252:255], a[52:55], v[180:183]
  ds_read_b128 a[80:83], v14 offset:16384
  v_mfma_f32_16x16x32_bf16 v[184:187], v[240:243], a[8:11], 0
  ds_read_b64_tr_b16 v[236:237], v3 offset:45056
  v_mfma_f32_16x16x32_bf16 v[184:187], v[244:247], a[24:27], v[184:187]
  ds_read_b64_tr_b16 v[238:239], v3 offset:45568
  v_mfma_f32_16x16x32_bf16 v[184:187], v[248:251], a[40:43], v[184:187]
  ds_read_b128 a[68:71], v13 offset:18432
  v_mfma_f32_16x16x32_bf16 v[184:187], v[252:255], a[56:59], v[184:187]
  ds_read_b128 a[84:87], v14 offset:18432
  v_mfma_f32_16x16x32_bf16 v[188:191], v[240:243], a[12:15], 0
  ds_read_b128 a[72:75], v13 offset:20480
  v_mfma_f32_16x16x32_bf16 v[188:191], v[244:247], a[28:31], v[188:191]
  ds_read_b128 a[88:91], v14 offset:20480
  v_mfma_f32_16x16x32_bf16 v[188:191], v[248:251], a[44:47], v[188:191]
  ds_read_b128 a[76:79], v13 offset:22528
  v_mfma_f32_16x16x32_bf16 v[188:191], v[252:255], a[60:63], v[188:191]
  ds_read_b128 a[92:95], v14 offset:22528
  s_waitcnt vmcnt(8) lgkmcnt(4)
  v_mfma_f32_16x16x32_bf16 v[192:195], v[224:227], a[0:3], 0
  ds_read_b64_tr_b16 v[240:241], v4 offset:32768
  v_mfma_f32_16x16x32_bf16 v[192:195], v[228:231], a[16:19], v[192:195]
  ds_read_b64_tr_b16 v[242:243], v4 offset:33280
  v_mfma_f32_16x16x32_bf16 v[192:195], v[232:235], a[32:35], v[192:195]
  ds_read_b64_tr_b16 v[244:245], v4 offset:36864
  v_mfma_f32_16x16x32_bf16 v[192:195], v[236:239], a[48:51], v[192:195]
  ds_read_b128 a[96:99], v13 offset:0
  v_mfma_f32_16x16x32_bf16 v[196:199], v[224:227], a[4:7], 0
  ds_read_b64_tr_b16 v[246:247], v4 offset:37376
  v_mfma_f32_16x16x32_bf16 v[196:199], v[228:231], a[20:23], v[196:199]
  ds_read_b64_tr_b16 v[248:249], v4 offset:40960
  v_mfma_f32_16x16x32_bf16 v[196:199], v[232:235], a[36:39], v[196:199]
  ds_read_b64_tr_b16 v[250:251], v4 offset:41472
  v_mfma_f32_16x16x32_bf16 v[196:199], v[236:239], a[52:55], v[196:199]
  ds_read_b128 a[112:115], v14 offset:0
  v_mfma_f32_16x16x32_bf16 v[200:203], v[224:227], a[8:11], 0
  ds_read_b64_tr_b16 v[252:253], v4 offset:45056
  v_mfma_f32_16x16x32_bf16 v[200:203], v[228:231], a[24:27], v[200:203]
  ds_read_b64_tr_b16 v[254:255], v4 offset:45568
  v_mfma_f32_16x16x32_bf16 v[200:203], v[232:235], a[40:43], v[200:203]
  ds_read_b128 a[100:103], v13 offset:2048
  v_mfma_f32_16x16x32_bf16 v[200:203], v[236:239], a[56:59], v[200:203]
  ds_read_b128 a[116:119], v14 offset:2048
  v_mfma_f32_16x16x32_bf16 v[204:207], v[224:227], a[12:15], 0
  ds_read_b128 a[104:107], v13 offset:4096
  v_mfma_f32_16x16x32_bf16 v[204:207], v[228:231], a[28:31], v[204:207]
  ds_read_b128 a[120:123], v14 offset:4096
  v_mfma_f32_16x16x32_bf16 v[204:207], v[232:235], a[44:47], v[204:207]
  ds_read_b128 a[108:111], v13 offset:6144
  v_mfma_f32_16x16x32_bf16 v[204:207], v[236:239], a[60:63], v[204:207]
  ds_read_b128 a[124:127], v14 offset:6144
  s_waitcnt vmcnt(24) lgkmcnt(4)
  s_barrier
  s_cmp_lg_u32 s16, 0
  s_cbranch_scc1 P1_CL0
  s_and_b32 s37, s2, 1
  s_lshl_b32 s37, s37, 7
  v_mov_b32 v26, 1
  s_mov_b64 exec, 1
  buffer_atomic_add v26, off, s[40:43], s37 sc1
  s_mov_b64 exec, -1
P1_CL0:
  v_mfma_f32_16x16x32_bf16 v[208:211], v[240:243], a[0:3], 0
  ds_read_b64_tr_b16 v[224:225], v1 offset:49152
  s_add_u32 m0, s19, 32768
  v_mfma_f32_16x16x32_bf16 v[208:211], v[244:247], a[16:19], v[208:211]
  ds_read_b64_tr_b16 v[226:227], v1 offset:49664
  s_add_u32 s21, s24, 0
  v_mfma_f32_16x16x32_bf16 v[208:211], v[248:251], a[32:35], v[208:211]
  ds_read_b64_tr_b16 v[228:229], v1 offset:53248
  v_mfma_f32_16x16x32_bf16 v[208:211], v[252:255], a[48:51], v[208:211]
  buffer_load_dwordx4 v5, s[12:15], s21 offen offset:0 lds
  v_mfma_f32_16x16x32_bf16 v[212:215], v[240:243], a[4:7], 0
  ds_read_b64_tr_b16 v[230:231], v1 offset:53760
  v_mfma_f32_16x16x32_bf16 v[212:215], v[244:247], a[20:23], v[212:215]
  ds_read_b64_tr_b16 v[232:233], v1 offset:57344
  v_mfma_f32_16x16x32_bf16 v[212:215], v[248:251], a[36:39], v[212:215]
  ds_read_b64_tr_b16 v[234:235], v1 offset:57856
  v_mfma_f32_16x16x32_bf16 v[212:215], v[252:255], a[52:55], v[212:215]
  buffer_load_dwordx4 v6, s[12:15], s21 offen offset:1024 lds
  v_mfma_f32_16x16x32_bf16 v[216:219], v[240:243], a[8:11], 0
  ds_read_b64_tr_b16 v[236:237], v1 offset:61440
  v_mfma_f32_16x16x32_bf16 v[216:219], v[244:247], a[24:27], v[216:219]
  ds_read_b64_tr_b16 v[238:239], v1 offset:61952
  v_mfma_f32_16x16x32_bf16 v[216:219], v[248:251], a[40:43], v[216:219]
  v_mfma_f32_16x16x32_bf16 v[216:219], v[252:255], a[56:59], v[216:219]
  buffer_load_dwordx4 v7, s[12:15], s21 offen offset:2048 lds
  v_mfma_f32_16x16x32_bf16 v[220:223], v[240:243], a[12:15], 0
  v_mfma_f32_16x16x32_bf16 v[220:223], v[244:247], a[28:31], v[220:223]
  v_mfma_f32_16x16x32_bf16 v[220:223], v[248:251], a[44:47], v[220:223]
  v_mfma_f32_16x16x32_bf16 v[220:223], v[252:255], a[60:63], v[220:223]
  buffer_load_dwordx4 v8, s[12:15], s21 offen offset:3072 lds
  s_waitcnt lgkmcnt(0)
  v_mfma_f32_16x16x32_bf16 v[32:35], v[224:227], a[64:67], v[32:35]
  ds_read_b64_tr_b16 v[240:241], v2 offset:49152
  v_mfma_f32_16x16x32_bf16 v[32:35], v[228:231], a[80:83], v[32:35]
  ds_read_b64_tr_b16 v[242:243], v2 offset:49664
  v_mfma_f32_16x16x32_bf16 v[32:35], v[232:235], a[96:99], v[32:35]
  ds_read_b64_tr_b16 v[244:245], v2 offset:53248
  v_mfma_f32_16x16x32_bf16 v[32:35], v[236:239], a[112:115], v[32:35]
  buffer_load_dword v23, v30, s[12:15], s62 offen offset:384
  v_mfma_f32_16x16x32_bf16 v[36:39], v[224:227], a[68:71], v[36:39]
  ds_read_b64_tr_b16 v[246:247], v2 offset:53760
  v_mfma_f32_16x16x32_bf16 v[36:39], v[228:231], a[84:87], v[36:39]
  ds_read_b64_tr_b16 v[248:249], v2 offset:57344
  v_mfma_f32_16x16x32_bf16 v[36:39], v[232:235], a[100:103], v[36:39]
  ds_read_b64_tr_b16 v[250:251], v2 offset:57856
  v_mfma_f32_16x16x32_bf16 v[36:39], v[236:239], a[116:119], v[36:39]
  v_mfma_f32_16x16x32_bf16 v[40:43], v[224:227], a[72:75], v[40:43]
  ds_read_b64_tr_b16 v[252:253], v2 offset:61440
  v_mfma_f32_16x16x32_bf16 v[40:43], v[228:231], a[88:91], v[40:43]
  ds_read_b64_tr_b16 v[254:255], v2 offset:61952
  v_mfma_f32_16x16x32_bf16 v[40:43], v[232:235], a[104:107], v[40:43]
  v_mfma_f32_16x16x32_bf16 v[40:43], v[236:239], a[120:123], v[40:43]
  v_mfma_f32_16x16x32_bf16 v[44:47], v[224:227], a[76:79], v[44:47]
  v_mfma_f32_16x16x32_bf16 v[44:47], v[228:231], a[92:95], v[44:47]
  v_mfma_f32_16x16x32_bf16 v[44:47], v[232:235], a[108:111], v[44:47]
  v_mfma_f32_16x16x32_bf16 v[44:47], v[236:239], a[124:127], v[44:47]
  s_waitcnt lgkmcnt(0)
  v_mfma_f32_16x16x32_bf16 v[48:51], v[240:243], a[64:67], v[48:51]
  ds_read_b64_tr_b16 v[224:225], v3 offset:49152
  v_mfma_f32_16x16x32_bf16 v[48:51], v[244:247], a[80:83], v[48:51]
  ds_read_b64_tr_b16 v[226:227], v3 offset:49664
  v_mfma_f32_16x16x32_bf16 v[48:51], v[248:251], a[96:99], v[48:51]
  ds_read_b64_tr_b16 v[228:229], v3 offset:53248
  v_mfma_f32_16x16x32_bf16 v[48:51], v[252:255], a[112:115], v[48:51]
  v_mfma_f32_16x16x32_bf16 v[52:55], v[240:243], a[68:71], v[52:55]
  ds_read_b64_tr_b16 v[230:231], v3 offset:53760
  v_mfma_f32_16x16x32_bf16 v[52:55], v[244:247], a[84:87], v[52:55]
  ds_read_b64_tr_b16 v[232:233], v3 offset:57344
  v_mfma_f32_16x16x32_bf16 v[52:55], v[248:251], a[100:103], v[52:55]
  ds_read_b64_tr_b16 v[234:235], v3 offset:57856
  v_mfma_f32_16x16x32_bf16 v[52:55], v[252:255], a[116:119], v[52:55]
  v_mfma_f32_16x16x32_bf16 v[56:59], v[240:243], a[72:75], v[56:59]
  ds_read_b64_tr_b16 v[236:237], v3 offset:61440
  v_mfma_f32_16x16x32_bf16 v[56:59], v[244:247], a[88:91], v[56:59]
  ds_read_b64_tr_b16 v[238:239], v3 offset:61952
  v_mfma_f32_16x16x32_bf16 v[56:59], v[248:251], a[104:107], v[56:59]
  v_mfma_f32_16x16x32_bf16 v[56:59], v[252:255], a[120:123], v[56:59]
  v_mfma_f32_16x16x32_bf16 v[60:63], v[240:243], a[76:79], v[60:63]
  v_mfma_f32_16x16x32_bf16 v[60:63], v[244:247], a[92:95], v[60:63]
  v_mfma_f32_16x16x32_bf16 v[60:63], v[248:251], a[108:111], v[60:63]
  v_mfma_f32_16x16x32_bf16 v[60:63], v[252:255], a[124:127], v[60:63]
  s_waitcnt lgkmcnt(0)
  v_mfma_f32_16x16x32_bf16 v[64:67], v[224:227], a[64:67], v[64:67]
  ds_read_b64_tr_b16 v[240:241], v4 offset:49152
  s_add_u32 m0, s20, 8192
  v_mfma_f32_16x16x32_bf16 v[64:67], v[228:231], a[80:83], v[64:67]
  ds_read_b64_tr_b16 v[242:243], v4 offset:49664
  s_add_u32 s28, s25, s78
  v_mfma_f32_16x16x32_bf16 v[64:67], v[232:235], a[96:99], v[64:67]
  ds_read_b64_tr_b16 v[244:245], v4 offset:53248
  v_mfma_f32_16x16x32_bf16 v[64:67], v[236:239], a[112:115], v[64:67]
  buffer_load_dwordx4 v9, s[44:47], s28 offen offset:0 lds
  v_mfma_f32_16x16x32_bf16 v[68:71], v[224:227], a[68:71], v[68:71]
  ds_read_b64_tr_b16 v[246:247], v4 offset:53760
  v_mfma_f32_16x16x32_bf16 v[68:71], v[228:231], a[84:87], v[68:71]
  ds_read_b64_tr_b16 v[248:249], v4 offset:57344
  v_mfma_f32_16x16x32_bf16 v[68:71], v[232:235], a[100:103], v[68:71]
  ds_read_b64_tr_b16 v[250:251], v4 offset:57856
  v_mfma_f32_16x16x32_bf16 v[68:71], v[236:239], a[116:119], v[68:71]
  buffer_load_dwordx4 v10, s[44:47], s28 offen offset:1024 lds
  v_mfma_f32_16x16x32_bf16 v[72:75], v[224:227], a[72:75], v[72:75]
  ds_read_b64_tr_b16 v[252:253], v4 offset:61440
  v_mfma_f32_16x16x32_bf16 v[72:75], v[228:231], a[88:91], v[72:75]
  ds_read_b64_tr_b16 v[254:255], v4 offset:61952
  v_mfma_f32_16x16x32_bf16 v[72:75], v[232:235], a[104:107], v[72:75]
  v_mfma_f32_16x16x32_bf16 v[72:75], v[236:239], a[120:123], v[72:75]
  buffer_load_dwordx4 v11, s[44:47], s28 offen offset:2048 lds
  v_mfma_f32_16x16x32_bf16 v[76:79], v[224:227], a[76:79], v[76:79]
  v_mfma_f32_16x16x32_bf16 v[76:79], v[228:231], a[92:95], v[76:79]
  v_mfma_f32_16x16x32_bf16 v[76:79], v[232:235], a[108:111], v[76:79]
  v_mfma_f32_16x16x32_bf16 v[76:79], v[236:239], a[124:127], v[76:79]
  buffer_load_dwordx4 v12, s[44:47], s28 offen offset:3072 lds
  s_waitcnt vmcnt(13) lgkmcnt(0)
  s_barrier
  v_mfma_f32_16x16x32_bf16 v[80:83], v[240:243], a[64:67], v[80:83]
  ds_read_b64_tr_b16 v[224:225], v1 offset:0
  s_add_u32 m0, s19, 49152
  v_mfma_f32_16x16x32_bf16 v[80:83], v[244:247], a[80:83], v[80:83]
  ds_read_b64_tr_b16 v[226:227], v1 offset:512
  s_add_u32 s21, s24, 128
  v_mfma_f32_16x16x32_bf16 v[80:83], v[248:251], a[96:99], v[80:83]
  ds_read_b64_tr_b16 v[228:229], v1 offset:4096
  v_mfma_f32_16x16x32_bf16 v[80:83], v[252:255], a[112:115], v[80:83]
  buffer_load_dwordx4 v5, s[12:15], s21 offen offset:0 lds
  v_mfma_f32_16x16x32_bf16 v[84:87], v[240:243], a[68:71], v[84:87]
  ds_read_b64_tr_b16 v[230:231], v1 offset:4608
  v_mfma_f32_16x16x32_bf16 v[84:87], v[244:247], a[84:87], v[84:87]
  ds_read_b64_tr_b16 v[232:233], v1 offset:8192
  v_mfma_f32_16x16x32_bf16 v[84:87], v[248:251], a[100:103], v[84:87]
  ds_read_b64_tr_b16 v[234:235], v1 offset:8704
  v_mfma_f32_16x16x32_bf16 v[84:87], v[252:255], a[116:119], v[84:87]
  buffer_load_dwordx4 v6, s[12:15], s21 offen offset:1024 lds
  v_mfma_f32_16x16x32_bf16 v[88:91], v[240:243], a[72:75], v[88:91]
  ds_read_b64_tr_b16 v[236:237], v1 offset:12288
  v_mfma_f32_16x16x32_bf16 v[88:91], v[244:247], a[88:91], v[88:91]
  ds_read_b64_tr_b16 v[238:239], v1 offset:12800
  v_mfma_f32_16x16x32_bf16 v[88:91], v[248:251], a[104:107], v[88:91]
  v_mfma_f32_16x16x32_bf16 v[88:91], v[252:255], a[120:123], v[88:91]
  buffer_load_dwordx4 v7, s[12:15], s21 offen offset:2048 lds
  v_mfma_f32_16x16x32_bf16 v[92:95], v[240:243], a[76:79], v[92:95]
  v_mfma_f32_16x16x32_bf16 v[92:95], v[244:247], a[92:95], v[92:95]
  v_mfma_f32_16x16x32_bf16 v[92:95], v[248:251], a[108:111], v[92:95]
  v_mfma_f32_16x16x32_bf16 v[92:95], v[252:255], a[124:127], v[92:95]
  buffer_load_dwordx4 v8, s[12:15], s21 offen offset:3072 lds
  s_waitcnt lgkmcnt(0)
  v_mfma_f32_16x16x32_bf16 v[96:99], v[224:227], a[64:67], v[96:99]
  ds_read_b64_tr_b16 v[240:241], v2 offset:0
  s_add_u32 m0, s20, 12288
  v_mfma_f32_16x16x32_bf16 v[96:99], v[228:231], a[80:83], v[96:99]
  ds_read_b64_tr_b16 v[242:243], v2 offset:512
  s_add_u32 s28, s26, s78
  v_mfma_f32_16x16x32_bf16 v[96:99], v[232:235], a[96:99], v[96:99]
  ds_read_b64_tr_b16 v[244:245], v2 offset:4096
  v_mfma_f32_16x16x32_bf16 v[96:99], v[236:239], a[112:115], v[96:99]
  buffer_load_dwordx4 v9, s[44:47], s28 offen offset:0 lds
  v_mfma_f32_16x16x32_bf16 v[100:103], v[224:227], a[68:71], v[100:103]
  ds_read_b64_tr_b16 v[246:247], v2 offset:4608
  v_mfma_f32_16x16x32_bf16 v[100:103], v[228:231], a[84:87], v[100:103]
  ds_read_b64_tr_b16 v[248:249], v2 offset:8192
  v_mfma_f32_16x16x32_bf16 v[100:103], v[232:235], a[100:103], v[100:103]
  ds_read_b64_tr_b16 v[250:251], v2 offset:8704
  v_mfma_f32_16x16x32_bf16 v[100:103], v[236:239], a[116:119], v[100:103]
  buffer_load_dwordx4 v10, s[44:47], s28 offen offset:1024 lds
  v_mfma_f32_16x16x32_bf16 v[104:107], v[224:227], a[72:75], v[104:107]
  ds_read_b64_tr_b16 v[252:253], v2 offset:12288
  v_mfma_f32_16x16x32_bf16 v[104:107], v[228:231], a[88:91], v[104:107]
  ds_read_b64_tr_b16 v[254:255], v2 offset:12800
  v_mfma_f32_16x16x32_bf16 v[104:107], v[232:235], a[104:107], v[104:107]
  v_mfma_f32_16x16x32_bf16 v[104:107], v[236:239], a[120:123], v[104:107]
  buffer_load_dwordx4 v11, s[44:47], s28 offen offset:2048 lds
  v_mfma_f32_16x16x32_bf16 v[108:111], v[224:227], a[76:79], v[108:111]
  v_mfma_f32_16x16x32_bf16 v[108:111], v[228:231], a[92:95], v[108:111]
  v_mfma_f32_16x16x32_bf16 v[108:111], v[232:235], a[108:111], v[108:111]
  v_mfma_f32_16x16x32_bf16 v[108:111], v[236:239], a[124:127], v[108:111]
  buffer_load_dwordx4 v12, s[44:47], s28 offen offset:3072 lds
  s_waitcnt lgkmcnt(0)
  v_mfma_f32_16x16x32_bf16 v[112:115], v[240:243], a[64:67], v[112:115]
  ds_read_b64_tr_b16 v[224:225], v3 offset:0
  s_add_u32 m0, s20, 16256
  v_mfma_f32_16x16x32_bf16 v[112:115], v[244:247], a[80:83], v[112:115]
  ds_read_b64_tr_b16 v[226:227], v3 offset:512
  s_add_u32 s28, s25, s78
  v_mfma_f32_16x16x32_bf16 v[112:115], v[248:251], a[96:99], v[112:115]
  ds_read_b64_tr_b16 v[228:229], v3 offset:4096
  v_mfma_f32_16x16x32_bf16 v[112:115], v[252:255], a[112:115], v[112:115]
  buffer_load_dwordx4 v9, s[44:47], s28 offen offset:128 lds
  v_mfma_f32_16x16x32_bf16 v[116:119], v[240:243], a[68:71], v[116:119]
  ds_read_b64_tr_b16 v[230:231], v3 offset:4608
  v_mfma_f32_16x16x32_bf16 v[116:119], v[244:247], a[84:87], v[116:119]
  ds_read_b64_tr_b16 v[232:233], v3 offset:8192
  v_mfma_f32_16x16x32_bf16 v[116:119], v[248:251], a[100:103], v[116:119]
  ds_read_b64_tr_b16 v[234:235], v3 offset:8704
  v_mfma_f32_16x16x32_bf16 v[116:119], v[252:255], a[116:119], v[116:119]
  buffer_load_dwordx4 v10, s[44:47], s28 offen offset:1152 lds
  v_mfma_f32_16x16x32_bf16 v[120:123], v[240:243], a[72:75], v[120:123]
  ds_read_b64_tr_b16 v[236:237], v3 offset:12288
  v_mfma_f32_16x16x32_bf16 v[120:123], v[244:247], a[88:91], v[120:123]
  ds_read_b64_tr_b16 v[238:239], v3 offset:12800
  v_mfma_f32_16x16x32_bf16 v[120:123], v[248:251], a[104:107], v[120:123]
  v_mfma_f32_16x16x32_bf16 v[120:123], v[252:255], a[120:123], v[120:123]
  buffer_load_dwordx4 v11, s[44:47], s28 offen offset:2176 lds
  v_mfma_f32_16x16x32_bf16 v[124:127], v[240:243], a[76:79], v[124:127]
  v_mfma_f32_16x16x32_bf16 v[124:127], v[244:247], a[92:95], v[124:127]
  v_mfma_f32_16x16x32_bf16 v[124:127], v[248:251], a[108:111], v[124:127]
  v_mfma_f32_16x16x32_bf16 v[124:127], v[252:255], a[124:127], v[124:127]
  buffer_load_dwordx4 v12, s[44:47], s28 offen offset:3200 lds
  s_waitcnt lgkmcnt(0)
  v_mfma_f32_16x16x32_bf16 v[128:131], v[224:227], a[64:67], v[128:131]
  ds_read_b64_tr_b16 v[240:241], v4 offset:0
  s_add_u32 m0, s20, 20352
  v_mfma_f32_16x16x32_bf16 v[128:131], v[228:231], a[80:83], v[128:131]
  ds_read_b64_tr_b16 v[242:243], v4 offset:512
  s_add_u32 s28, s26, s78
  v_mfma_f32_16x16x32_bf16 v[128:131], v[232:235], a[96:99], v[128:131]
  ds_read_b64_tr_b16 v[244:245], v4 offset:4096
  v_mfma_f32_16x16x32_bf16 v[128:131], v[236:239], a[112:115], v[128:131]
  buffer_load_dwordx4 v9, s[44:47], s28 offen offset:128 lds
  v_mfma_f32_16x16x32_bf16 v[132:135], v[224:227], a[68:71], v[132:135]
  ds_read_b64_tr_b16 v[246:247], v4 offset:4608
  v_mfma_f32_16x16x32_bf16 v[132:135], v[228:231], a[84:87], v[132:135]
  ds_read_b64_tr_b16 v[248:249], v4 offset:8192
  v_mfma_f32_16x16x32_bf16 v[132:135], v[232:235], a[100:103], v[132:135]
  ds_read_b64_tr_b16 v[250:251], v4 offset:8704
  v_mfma_f32_16x16x32_bf16 v[132:135], v[236:239], a[116:119], v[132:135]
  buffer_load_dwordx4 v10, s[44:47], s28 offen offset:1152 lds
  v_mfma_f32_16x16x32_bf16 v[136:139], v[224:227], a[72:75], v[136:139]
  ds_read_b64_tr_b16 v[252:253], v4 offset:12288
  v_mfma_f32_16x16x32_bf16 v[136:139], v[228:231], a[88:91], v[136:139]
  ds_read_b64_tr_b16 v[254:255], v4 offset:12800
  v_mfma_f32_16x16x32_bf16 v[136:139], v[232:235], a[104:107], v[136:139]
  v_mfma_f32_16x16x32_bf16 v[136:139], v[236:239], a[120:123], v[136:139]
  buffer_load_dwordx4 v11, s[44:47], s28 offen offset:2176 lds
  v_mfma_f32_16x16x32_bf16 v[140:143], v[224:227], a[76:79], v[140:143]
  v_mfma_f32_16x16x32_bf16 v[140:143], v[228:231], a[92:95], v[140:143]
  v_mfma_f32_16x16x32_bf16 v[140:143], v[232:235], a[108:111], v[140:143]
  v_mfma_f32_16x16x32_bf16 v[140:143], v[236:239], a[124:127], v[140:143]
  buffer_load_dwordx4 v12, s[44:47], s28 offen offset:3200 lds
  s_waitcnt vmcnt(25) lgkmcnt(0)
  s_barrier
  v_mfma_f32_16x16x32_bf16 v[144:147], v[240:243], a[64:67], v[144:147]
  ds_read_b64_tr_b16 v[224:225], v1 offset:16384
  s_add_u32 m0, s19, 0
  v_mfma_f32_16x16x32_bf16 v[144:147], v[244:247], a[80:83], v[144:147]
  ds_read_b64_tr_b16 v[226:227], v1 offset:16896
  s_add_u32 s21, s24, 256
  v_mfma_f32_16x16x32_bf16 v[144:147], v[248:251], a[96:99], v[144:147]
  ds_read_b64_tr_b16 v[228:229], v1 offset:20480
  v_mfma_f32_16x16x32_bf16 v[144:147], v[252:255], a[112:115], v[144:147]
  buffer_load_dwordx4 v5, s[12:15], s21 offen offset:0 lds
  v_mfma_f32_16x16x32_bf16 v[148:151], v[240:243], a[68:71], v[148:151]
  ds_read_b64_tr_b16 v[230:231], v1 offset:20992
  v_mfma_f32_16x16x32_bf16 v[148:151], v[244:247], a[84:87], v[148:151]
  ds_read_b64_tr_b16 v[232:233], v1 offset:24576
  v_mfma_f32_16x16x32_bf16 v[148:151], v[248:251], a[100:103], v[148:151]
  ds_read_b64_tr_b16 v[234:235], v1 offset:25088
  v_mfma_f32_16x16x32_bf16 v[148:151], v[252:255], a[116:119], v[148:151]
  buffer_load_dwordx4 v6, s[12:15], s21 offen offset:1024 lds
  v_mfma_f32_16x16x32_bf16 v[152:155], v[240:243], a[72:75], v[152:155]
  ds_read_b64_tr_b16 v[236:237], v1 offset:28672
  v_mfma_f32_16x16x32_bf16 v[152:155], v[244:247], a[88:91], v[152:155]
  ds_read_b64_tr_b16 v[238:239], v1 offset:29184
  v_mfma_f32_16x16x32_bf16 v[152:155], v[248:251], a[104:107], v[152:155]
  v_mfma_f32_16x16x32_bf16 v[152:155], v[252:255], a[120:123], v[152:155]
  buffer_load_dwordx4 v7, s[12:15], s21 offen offset:2048 lds
  v_mfma_f32_16x16x32_bf16 v[156:159], v[240:243], a[76:79], v[156:159]
  v_mfma_f32_16x16x32_bf16 v[156:159], v[244:247], a[92:95], v[156:159]
  v_mfma_f32_16x16x32_bf16 v[156:159], v[248:251], a[108:111], v[156:159]
  v_mfma_f32_16x16x32_bf16 v[156:159], v[252:255], a[124:127], v[156:159]
  buffer_load_dwordx4 v8, s[12:15], s21 offen offset:3072 lds
  s_waitcnt lgkmcnt(0)
  v_mfma_f32_16x16x32_bf16 v[160:163], v[224:227], a[64:67], v[160:163]
  ds_read_b64_tr_b16 v[240:241], v2 offset:16384
  s_add_u32 m0, s20, 0
  v_mfma_f32_16x16x32_bf16 v[160:163], v[228:231], a[80:83], v[160:163]
  ds_read_b64_tr_b16 v[242:243], v2 offset:16896
  s_add_u32 s28, s25, s79
  v_mfma_f32_16x16x32_bf16 v[160:163], v[232:235], a[96:99], v[160:163]
  ds_read_b64_tr_b16 v[244:245], v2 offset:20480
  v_mfma_f32_16x16x32_bf16 v[160:163], v[236:239], a[112:115], v[160:163]
  buffer_load_dwordx4 v9, s[44:47], s28 offen offset:0 lds
  v_mfma_f32_16x16x32_bf16 v[164:167], v[224:227], a[68:71], v[164:167]
  ds_read_b64_tr_b16 v[246:247], v2 offset:20992
  v_mfma_f32_16x16x32_bf16 v[164:167], v[228:231], a[84:87], v[164:167]
  ds_read_b64_tr_b16 v[248:249], v2 offset:24576
  v_mfma_f32_16x16x32_bf16 v[164:167], v[232:235], a[100:103], v[164:167]
  ds_read_b64_tr_b16 v[250:251], v2 offset:25088
  v_mfma_f32_16x16x32_bf16 v[164:167], v[236:239], a[116:119], v[164:167]
  buffer_load_dwordx4 v10, s[44:47], s28 offen offset:1024 lds
  v_mfma_f32_16x16x32_bf16 v[168:171], v[224:227], a[72:75], v[168:171]
  ds_read_b64_tr_b16 v[252:253], v2 offset:28672
  v_mfma_f32_16x16x32_bf16 v[168:171], v[228:231], a[88:91], v[168:171]
  ds_read_b64_tr_b16 v[254:255], v2 offset:29184
  v_mfma_f32_16x16x32_bf16 v[168:171], v[232:235], a[104:107], v[168:171]
  v_mfma_f32_16x16x32_bf16 v[168:171], v[236:239], a[120:123], v[168:171]
  buffer_load_dwordx4 v11, s[44:47], s28 offen offset:2048 lds
  v_mfma_f32_16x16x32_bf16 v[172:175], v[224:227], a[76:79], v[172:175]
  v_mfma_f32_16x16x32_bf16 v[172:175], v[228:231], a[92:95], v[172:175]
  v_mfma_f32_16x16x32_bf16 v[172:175], v[232:235], a[108:111], v[172:175]
  v_mfma_f32_16x16x32_bf16 v[172:175], v[236:239], a[124:127], v[172:175]
  buffer_load_dwordx4 v12, s[44:47], s28 offen offset:3072 lds
  s_waitcnt vmcnt(16) lgkmcnt(0)
  v_mfma_f32_16x16x32_bf16 v[176:179], v[240:243], a[64:67], v[176:179]
  ds_read_b64_tr_b16 v[224:225], v3 offset:16384
  s_add_u32 m0, s20, 4096
  v_mfma_f32_16x16x32_bf16 v[176:179], v[244:247], a[80:83], v[176:179]
  ds_read_b64_tr_b16 v[226:227], v3 offset:16896
  s_add_u32 s28, s26, s79
  v_mfma_f32_16x16x32_bf16 v[176:179], v[248:251], a[96:99], v[176:179]
  ds_read_b64_tr_b16 v[228:229], v3 offset:20480
  v_mfma_f32_16x16x32_bf16 v[176:179], v[252:255], a[112:115], v[176:179]
  ds_read_b128 a[128:131], v13 offset:8192
  buffer_load_dwordx4 v9, s[44:47], s28 offen offset:0 lds
  v_mfma_f32_16x16x32_bf16 v[180:183], v[240:243], a[68:71], v[180:183]
  ds_read_b64_tr_b16 v[230:231], v3 offset:20992
  v_mfma_f32_16x16x32_bf16 v[180:183], v[244:247], a[84:87], v[180:183]
  ds_read_b64_tr_b16 v[232:233], v3 offset:24576
  v_mfma_f32_16x16x32_bf16 v[180:183], v[248:251], a[100:103], v[180:183]
  ds_read_b64_tr_b16 v[234:235], v3 offset:25088
  v_mfma_f32_16x16x32_bf16 v[180:183], v[252:255], a[116:119], v[180:183]
  ds_read_b128 a[144:147], v14 offset:8192
  buffer_load_dwordx4 v10, s[44:47], s28 offen offset:1024 lds
  v_mfma_f32_16x16x32_bf16 v[184:187], v[240:243], a[72:75], v[184:187]
  ds_read_b64_tr_b16 v[236:237], v3 offset:28672
  v_mfma_f32_16x16x32_bf16 v[184:187], v[244:247], a[88:91], v[184:187]
  ds_read_b64_tr_b16 v[238:239], v3 offset:29184
  v_mfma_f32_16x16x32_bf16 v[184:187], v[248:251], a[104:107], v[184:187]
  ds_read_b128 a[132:135], v13 offset:10240
  v_mfma_f32_16x16x32_bf16 v[184:187], v[252:255], a[120:123], v[184:187]
  ds_read_b128 a[148:151], v14 offset:10240
  buffer_load_dwordx4 v11, s[44:47], s28 offen offset:2048 lds
  v_mfma_f32_16x16x32_bf16 v[188:191], v[240:243], a[76:79], v[188:191]
  ds_read_b128 a[136:139], v13 offset:12288
  v_mfma_f32_16x16x32_bf16 v[188:191], v[244:247], a[92:95], v[188:191]
  ds_read_b128 a[152:155], v14 offset:12288
  v_mfma_f32_16x16x32_bf16 v[188:191], v[248:251], a[108:111], v[188:191]
  ds_read_b128 a[140:143], v13 offset:14336
  v_mfma_f32_16x16x32_bf16 v[188:191], v[252:255], a[124:127], v[188:191]
  ds_read_b128 a[156:159], v14 offset:14336
  buffer_load_dwordx4 v12, s[44:47], s28 offen offset:3072 lds
  s_waitcnt vmcnt(12) lgkmcnt(4)
  v_mfma_f32_16x16x32_bf16 v[192:195], v[224:227], a[64:67], v[192:195]
  ds_read_b64_tr_b16 v[240:241], v4 offset:16384
  v_mfma_f32_16x16x32_bf16 v[192:195], v[228:231], a[80:83], v[192:195]
  ds_read_b64_tr_b16 v[242:243], v4 offset:16896
  v_mfma_f32_16x16x32_bf16 v[192:195], v[232:235], a[96:99], v[192:195]
  ds_read_b64_tr_b16 v[244:245], v4 offset:20480
  v_mfma_f32_16x16x32_bf16 v[192:195], v[236:239], a[112:115], v[192:195]
  ds_read_b128 a[160:163], v13 offset:16384
  v_mfma_f32_16x16x32_bf16 v[196:199], v[224:227], a[68:71], v[196:199]
  ds_read_b64_tr_b16 v[246:247], v4 offset:20992
  v_mfma_f32_16x16x32_bf16 v[196:199], v[228:231], a[84:87], v[196:199]
  ds_read_b64_tr_b16 v[248:249], v4 offset:24576
  v_mfma_f32_16x16x32_bf16 v[196:199], v[232:235], a[100:103], v[196:199]
  ds_read_b64_tr_b16 v[250:251], v4 offset:25088
  v_mfma_f32_16x16x32_bf16 v[196:199], v[236:239], a[116:119], v[196:199]
  ds_read_b128 a[176:179], v14 offset:16384
  v_mfma_f32_16x16x32_bf16 v[200:203], v[224:227], a[72:75], v[200:203]
  ds_read_b64_tr_b16 v[252:253], v4 offset:28672
  v_mfma_f32_16x16x32_bf16 v[200:203], v[228:231], a[88:91], v[200:203]
  ds_read_b64_tr_b16 v[254:255], v4 offset:29184
  v_mfma_f32_16x16x32_bf16 v[200:203], v[232:235], a[104:107], v[200:203]
  ds_read_b128 a[164:167], v13 offset:18432
  v_mfma_f32_16x16x32_bf16 v[200:203], v[236:239], a[120:123], v[200:203]
  ds_read_b128 a[180:183], v14 offset:18432
  v_mfma_f32_16x16x32_bf16 v[204:207], v[224:227], a[76:79], v[204:207]
  ds_read_b128 a[168:171], v13 offset:20480
  v_mfma_f32_16x16x32_bf16 v[204:207], v[228:231], a[92:95], v[204:207]
  ds_read_b128 a[184:187], v14 offset:20480
  v_mfma_f32_16x16x32_bf16 v[204:207], v[232:235], a[108:111], v[204:207]
  ds_read_b128 a[172:175], v13 offset:22528
  v_mfma_f32_16x16x32_bf16 v[204:207], v[236:239], a[124:127], v[204:207]
  ds_read_b128 a[188:191], v14 offset:22528
  s_waitcnt vmcnt(33) lgkmcnt(4)
  s_barrier
  v_mfma_f32_16x16x32_bf16 v[208:211], v[240:243], a[64:67], v[208:211]
  ds_read_b64_tr_b16 v[224:225], v1 offset:32768
  s_add_u32 m0, s19, 16384
  v_mfma_f32_16x16x32_bf16 v[208:211], v[244:247], a[80:83], v[208:211]
  ds_read_b64_tr_b16 v[226:227], v1 offset:33280
  s_add_u32 s21, s38, 0
  v_mfma_f32_16x16x32_bf16 v[208:211], v[248:251], a[96:99], v[208:211]
  ds_read_b64_tr_b16 v[228:229], v1 offset:36864
  v_mfma_f32_16x16x32_bf16 v[208:211], v[252:255], a[112:115], v[208:211]
  buffer_load_dwordx4 v5, s[12:15], s21 offen offset:0 lds
  v_mfma_f32_16x16x32_bf16 v[212:215], v[240:243], a[68:71], v[212:215]
  ds_read_b64_tr_b16 v[230:231], v1 offset:37376
  v_mfma_f32_16x16x32_bf16 v[212:215], v[244:247], a[84:87], v[212:215]
  ds_read_b64_tr_b16 v[232:233], v1 offset:40960
  v_mfma_f32_16x16x32_bf16 v[212:215], v[248:251], a[100:103], v[212:215]
  ds_read_b64_tr_b16 v[234:235], v1 offset:41472
  v_mfma_f32_16x16x32_bf16 v[212:215], v[252:255], a[116:119], v[212:215]
  buffer_load_dwordx4 v6, s[12:15], s21 offen offset:1024 lds
  v_mfma_f32_16x16x32_bf16 v[216:219], v[240:243], a[72:75], v[216:219]
  ds_read_b64_tr_b16 v[236:237], v1 offset:45056
  v_mfma_f32_16x16x32_bf16 v[216:219], v[244:247], a[88:91], v[216:219]
  ds_read_b64_tr_b16 v[238:239], v1 offset:45568
  v_mfma_f32_16x16x32_bf16 v[216:219], v[248:251], a[104:107], v[216:219]
  v_mfma_f32_16x16x32_bf16 v[216:219], v[252:255], a[120:123], v[216:219]
  buffer_load_dwordx4 v7, s[12:15], s21 offen offset:2048 lds
  v_mfma_f32_16x16x32_bf16 v[220:223], v[240:243], a[76:79], v[220:223]
  v_mfma_f32_16x16x32_bf16 v[220:223], v[244:247], a[92:95], v[220:223]
  v_mfma_f32_16x16x32_bf16 v[220:223], v[248:251], a[108:111], v[220:223]
  v_mfma_f32_16x16x32_bf16 v[220:223], v[252:255], a[124:127], v[220:223]
  buffer_load_dwordx4 v8, s[12:15], s21 offen offset:3072 lds
  s_waitcnt lgkmcnt(0)
  v_mfma_f32_16x16x32_bf16 v[32:35], v[224:227], a[128:131], v[32:35]
  ds_read_b64_tr_b16 v[240:241], v2 offset:32768
  s_add_u32 m0, s20, 8064
  v_mfma_f32_16x16x32_bf16 v[32:35], v[228:231], a[144:147], v[32:35]
  ds_read_b64_tr_b16 v[242:243], v2 offset:33280
  s_add_u32 s28, s25, s79
  v_mfma_f32_16x16x32_bf16 v[32:35], v[232:235], a[160:163], v[32:35]
  ds_read_b64_tr_b16 v[244:245], v2 offset:36864
  v_mfma_f32_16x16x32_bf16 v[32:35], v[236:239], a[176:179], v[32:35]
  buffer_load_dwordx4 v9, s[44:47], s28 offen offset:128 lds
  v_mfma_f32_16x16x32_bf16 v[36:39], v[224:227], a[132:135], v[36:39]
  ds_read_b64_tr_b16 v[246:247], v2 offset:37376
  v_mfma_f32_16x16x32_bf16 v[36:39], v[228:231], a[148:151], v[36:39]
  ds_read_b64_tr_b16 v[248:249], v2 offset:40960
  v_mfma_f32_16x16x32_bf16 v[36:39], v[232:235], a[164:167], v[36:39]
  ds_read_b64_tr_b16 v[250:251], v2 offset:41472
  v_mfma_f32_16x16x32_bf16 v[36:39], v[236:239], a[180:183], v[36:39]
  buffer_load_dwordx4 v10, s[44:47], s28 offen offset:1152 lds
  v_mfma_f32_16x16x32_bf16 v[40:43], v[224:227], a[136:139], v[40:43]
  ds_read_b64_tr_b16 v[252:253], v2 offset:45056
  v_mfma_f32_16x16x32_bf16 v[40:43], v[228:231], a[152:155], v[40:43]
  ds_read_b64_tr_b16 v[254:255], v2 offset:45568
  v_mfma_f32_16x16x32_bf16 v[40:43], v[232:235], a[168:171], v[40:43]
  v_mfma_f32_16x16x32_bf16 v[40:43], v[236:239], a[184:187], v[40:43]
  buffer_load_dwordx4 v11, s[44:47], s28 offen offset:2176 lds
  v_mfma_f32_16x16x32_bf16 v[44:47], v[224:227], a[140:143], v[44:47]
  v_mfma_f32_16x16x32_bf16 v[44:47], v[228:231], a[156:159], v[44:47]
  v_mfma_f32_16x16x32_bf16 v[44:47], v[232:235], a[172:175], v[44:47]
  v_mfma_f32_16x16x32_bf16 v[44:47], v[236:239], a[188:191], v[44:47]
  buffer_load_dwordx4 v12, s[44:47], s28 offen offset:3200 lds
  s_waitcnt lgkmcnt(0)
  v_mfma_f32_16x16x32_bf16 v[48:51], v[240:243], a[128:131], v[48:51]
  ds_read_b64_tr_b16 v[224:225], v3 offset:32768
  s_add_u32 m0, s20, 12160
  v_mfma_f32_16x16x32_bf16 v[48:51], v[244:247], a[144:147], v[48:51]
  ds_read_b64_tr_b16 v[226:227], v3 offset:33280
  s_add_u32 s28, s26, s79
  v_mfma_f32_16x16x32_bf16 v[48:51], v[248:251], a[160:163], v[48:51]
  ds_read_b64_tr_b16 v[228:229], v3 offset:36864
  v_mfma_f32_16x16x32_bf16 v[48:51], v[252:255], a[176:179], v[48:51]
  buffer_load_dwordx4 v9, s[44:47], s28 offen offset:128 lds
  v_mfma_f32_16x16x32_bf16 v[52:55], v[240:243], a[132:135], v[52:55]
  ds_read_b64_tr_b16 v[230:231], v3 offset:37376
  v_mfma_f32_16x16x32_bf16 v[52:55], v[244:247], a[148:151], v[52:55]
  ds_read_b64_tr_b16 v[232:233], v3 offset:40960
  v_mfma_f32_16x16x32_bf16 v[52:55], v[248:251], a[164:167], v[52:55]
  ds_read_b64_tr_b16 v[234:235], v3 offset:41472
  v_mfma_f32_16x16x32_bf16 v[52:55], v[252:255], a[180:183], v[52:55]
  buffer_load_dwordx4 v10, s[44:47], s28 offen offset:1152 lds
  v_mfma_f32_16x16x32_bf16 v[56:59], v[240:243], a[136:139], v[56:59]
  ds_read_b64_tr_b16 v[236:237], v3 offset:45056
  v_mfma_f32_16x16x32_bf16 v[56:59], v[244:247], a[152:155], v[56:59]
  ds_read_b64_tr_b16 v[238:239], v3 offset:45568
  v_mfma_f32_16x16x32_bf16 v[56:59], v[248:251], a[168:171], v[56:59]
  v_mfma_f32_16x16x32_bf16 v[56:59], v[252:255], a[184:187], v[56:59]
  buffer_load_dwordx4 v11, s[44:47], s28 offen offset:2176 lds
  v_mfma_f32_16x16x32_bf16 v[60:63], v[240:243], a[140:143], v[60:63]
  v_mfma_f32_16x16x32_bf16 v[60:63], v[244:247], a[156:159], v[60:63]
  v_mfma_f32_16x16x32_bf16 v[60:63], v[248:251], a[172:175], v[60:63]
  v_mfma_f32_16x16x32_bf16 v[60:63], v[252:255], a[188:191], v[60:63]
  buffer_load_dwordx4 v12, s[44:47], s28 offen offset:3200 lds
  s_waitcnt lgkmcnt(0)
  v_mfma_f32_16x16x32_bf16 v[64:67], v[224:227], a[128:131], v[64:67]
  ds_read_b64_tr_b16 v[240:241], v4 offset:32768
  s_mov_b64 s[96:97], s[52:53]
  v_mfma_f32_16x16x32_bf16 v[64:67], v[228:231], a[144:147], v[64:67]
  ds_read_b64_tr_b16 v[242:243], v4 offset:33280
  v_mfma_f32_16x16x32_bf16 v[64:67], v[232:235], a[160:163], v[64:67]
  ds_read_b64_tr_b16 v[244:245], v4 offset:36864
  v_mfma_f32_16x16x32_bf16 v[64:67], v[236:239], a[176:179], v[64:67]
  s_mov_b32 s98, 4194304
  v_mfma_f32_16x16x32_bf16 v[68:71], v[224:227], a[132:135], v[68:71]
  ds_read_b64_tr_b16 v[246:247], v4 offset:37376
  v_mfma_f32_16x16x32_bf16 v[68:71], v[228:231], a[148:151], v[68:71]
  ds_read_b64_tr_b16 v[248:249], v4 offset:40960
  v_mfma_f32_16x16x32_bf16 v[68:71], v[232:235], a[164:167], v[68:71]
  ds_read_b64_tr_b16 v[250:251], v4 offset:41472
  s_mov_b32 s99, 0x20000
  v_mfma_f32_16x16x32_bf16 v[68:71], v[236:239], a[180:183], v[68:71]
  v_mfma_f32_16x16x32_bf16 v[72:75], v[224:227], a[136:139], v[72:75]
  ds_read_b64_tr_b16 v[252:253], v4 offset:45056
  v_mfma_f32_16x16x32_bf16 v[72:75], v[228:231], a[152:155], v[72:75]
  ds_read_b64_tr_b16 v[254:255], v4 offset:45568
  s_lshl_b32 s101, s17, 8
  v_mfma_f32_16x16x32_bf16 v[72:75], v[232:235], a[168:171], v[72:75]
  v_mfma_f32_16x16x32_bf16 v[72:75], v[236:239], a[184:187], v[72:75]
  v_mfma_f32_16x16x32_bf16 v[76:79], v[224:227], a[140:143], v[76:79]
  buffer_load_dword v23, v29, s[96:99], s101 offen
  v_mfma_f32_16x16x32_bf16 v[76:79], v[228:231], a[156:159], v[76:79]
  v_mfma_f32_16x16x32_bf16 v[76:79], v[232:235], a[172:175], v[76:79]
  v_mfma_f32_16x16x32_bf16 v[76:79], v[236:239], a[188:191], v[76:79]
  s_waitcnt vmcnt(37) lgkmcnt(0)
  s_barrier
  v_mfma_f32_16x16x32_bf16 v[80:83], v[240:243], a[128:131], v[80:83]
  ds_read_b64_tr_b16 v[224:225], v1 offset:49152
  s_add_u32 m0, s19, 32768
  v_mfma_f32_16x16x32_bf16 v[80:83], v[244:247], a[144:147], v[80:83]
  ds_read_b64_tr_b16 v[226:227], v1 offset:49664
  s_add_u32 s21, s38, 128
  v_mfma_f32_16x16x32_bf16 v[80:83], v[248:251], a[160:163], v[80:83]
  ds_read_b64_tr_b16 v[228:229], v1 offset:53248
  v_mfma_f32_16x16x32_bf16 v[80:83], v[252:255], a[176:179], v[80:83]
  buffer_load_dwordx4 v5, s[12:15], s21 offen offset:0 lds
  v_mfma_f32_16x16x32_bf16 v[84:87], v[240:243], a[132:135], v[84:87]
  ds_read_b64_tr_b16 v[230:231], v1 offset:53760
  v_mfma_f32_16x16x32_bf16 v[84:87], v[244:247], a[148:151], v[84:87]
  ds_read_b64_tr_b16 v[232:233], v1 offset:57344
  v_mfma_f32_16x16x32_bf16 v[84:87], v[248:251], a[164:167], v[84:87]
  ds_read_b64_tr_b16 v[234:235], v1 offset:57856
  v_mfma_f32_16x16x32_bf16 v[84:87], v[252:255], a[180:183], v[84:87]
  buffer_load_dwordx4 v6, s[12:15], s21 offen offset:1024 lds
  v_mfma_f32_16x16x32_bf16 v[88:91], v[240:243], a[136:139], v[88:91]
  ds_read_b64_tr_b16 v[236:237], v1 offset:61440
  v_mfma_f32_16x16x32_bf16 v[88:91], v[244:247], a[152:155], v[88:91]
  ds_read_b64_tr_b16 v[238:239], v1 offset:61952
  v_mfma_f32_16x16x32_bf16 v[88:91], v[248:251], a[168:171], v[88:91]
  v_mfma_f32_16x16x32_bf16 v[88:91], v[252:255], a[184:187], v[88:91]
  buffer_load_dwordx4 v7, s[12:15], s21 offen offset:2048 lds
  v_mfma_f32_16x16x32_bf16 v[92:95], v[240:243], a[140:143], v[92:95]
  v_mfma_f32_16x16x32_bf16 v[92:95], v[244:247], a[156:159], v[92:95]
  v_mfma_f32_16x16x32_bf16 v[92:95], v[248:251], a[172:175], v[92:95]
  v_mfma_f32_16x16x32_bf16 v[92:95], v[252:255], a[188:191], v[92:95]
  buffer_load_dwordx4 v8, s[12:15], s21 offen offset:3072 lds
  s_waitcnt vmcnt(17) lgkmcnt(0)
  v_mfma_f32_16x16x32_bf16 v[96:99], v[224:227], a[128:131], v[96:99]
  ds_read_b64_tr_b16 v[240:241], v2 offset:49152
  v_mfma_f32_16x16x32_bf16 v[96:99], v[228:231], a[144:147], v[96:99]
  ds_read_b64_tr_b16 v[242:243], v2 offset:49664
  v_mfma_f32_16x16x32_bf16 v[96:99], v[232:235], a[160:163], v[96:99]
  ds_read_b64_tr_b16 v[244:245], v2 offset:53248
  v_mfma_f32_16x16x32_bf16 v[96:99], v[236:239], a[176:179], v[96:99]
  ds_read_b128 a[192:195], v13 offset:0
  v_mfma_f32_16x16x32_bf16 v[100:103], v[224:227], a[132:135], v[100:103]
  ds_read_b64_tr_b16 v[246:247], v2 offset:53760
  v_mfma_f32_16x16x32_bf16 v[100:103], v[228:231], a[148:151], v[100:103]
  ds_read_b64_tr_b16 v[248:249], v2 offset:57344
  v_mfma_f32_16x16x32_bf16 v[100:103], v[232:235], a[164:167], v[100:103]
  ds_read_b64_tr_b16 v[250:251], v2 offset:57856
  v_mfma_f32_16x16x32_bf16 v[100:103], v[236:239], a[180:183], v[100:103]
  ds_read_b128 a[208:211], v14 offset:0
  v_mfma_f32_16x16x32_bf16 v[104:107], v[224:227], a[136:139], v[104:107]
  ds_read_b64_tr_b16 v[252:253], v2 offset:61440
  v_mfma_f32_16x16x32_bf16 v[104:107], v[228:231], a[152:155], v[104:107]
  ds_read_b64_tr_b16 v[254:255], v2 offset:61952
  v_mfma_f32_16x16x32_bf16 v[104:107], v[232:235], a[168:171], v[104:107]
  ds_read_b128 a[196:199], v13 offset:2048
  v_mfma_f32_16x16x32_bf16 v[104:107], v[236:239], a[184:187], v[104:107]
  ds_read_b128 a[212:215], v14 offset:2048
  v_mfma_f32_16x16x32_bf16 v[108:111], v[224:227], a[140:143], v[108:111]
  ds_read_b128 a[200:203], v13 offset:4096
  v_mfma_f32_16x16x32_bf16 v[108:111], v[228:231], a[156:159], v[108:111]
  ds_read_b128 a[216:219], v14 offset:4096
  v_mfma_f32_16x16x32_bf16 v[108:111], v[232:235], a[172:175], v[108:111]
  ds_read_b128 a[204:207], v13 offset:6144
  v_mfma_f32_16x16x32_bf16 v[108:111], v[236:239], a[188:191], v[108:111]
  ds_read_b128 a[220:223], v14 offset:6144
  s_waitcnt lgkmcnt(4)
  v_mfma_f32_16x16x32_bf16 v[112:115], v[240:243], a[128:131], v[112:115]
  ds_read_b64_tr_b16 v[224:225], v3 offset:49152
  s_mov_b64 s[44:45], s[54:55]
  v_mfma_f32_16x16x32_bf16 v[112:115], v[244:247], a[144:147], v[112:115]
  ds_read_b64_tr_b16 v[226:227], v3 offset:49664
  s_lshl_b32 s25, s18, 2
  v_mfma_f32_16x16x32_bf16 v[112:115], v[248:251], a[160:163], v[112:115]
  ds_read_b64_tr_b16 v[228:229], v3 offset:53248
  s_add_u32 s25, s25, s16
  v_mfma_f32_16x16x32_bf16 v[112:115], v[252:255], a[176:179], v[112:115]
  s_sub_u32 s26, 63, s25
  s_lshl_b32 s25, s25, 15
  s_lshl_b32 s26, s26, 15
  v_mfma_f32_16x16x32_bf16 v[116:119], v[240:243], a[132:135], v[116:119]
  ds_read_b64_tr_b16 v[230:231], v3 offset:53760
  s_add_u32 s5, s17, s18
  v_mfma_f32_16x16x32_bf16 v[116:119], v[244:247], a[148:151], v[116:119]
  ds_read_b64_tr_b16 v[232:233], v3 offset:57344
  s_and_b32 s5, s5, 2
  v_mfma_f32_16x16x32_bf16 v[116:119], v[248:251], a[164:167], v[116:119]
  ds_read_b64_tr_b16 v[234:235], v3 offset:57856
  s_lshl_b32 s5, s5, 8
  v_mfma_f32_16x16x32_bf16 v[116:119], v[252:255], a[180:183], v[116:119]
  s_mov_b32 s3, s77
  s_xor_b32 s76, s5, 0
  s_xor_b32 s77, s5, 256
  v_mfma_f32_16x16x32_bf16 v[120:123], v[240:243], a[136:139], v[120:123]
  ds_read_b64_tr_b16 v[236:237], v3 offset:61440
  s_xor_b32 s78, s5, 512
  v_mfma_f32_16x16x32_bf16 v[120:123], v[244:247], a[152:155], v[120:123]
  ds_read_b64_tr_b16 v[238:239], v3 offset:61952
  s_xor_b32 s79, s5, 768
  v_mfma_f32_16x16x32_bf16 v[120:123], v[248:251], a[168:171], v[120:123]
  v_mfma_f32_16x16x32_bf16 v[120:123], v[252:255], a[184:187], v[120:123]
  v_mfma_f32_16x16x32_bf16 v[124:127], v[240:243], a[140:143], v[124:127]
  v_mfma_f32_16x16x32_bf16 v[124:127], v[244:247], a[156:159], v[124:127]
  v_mfma_f32_16x16x32_bf16 v[124:127], v[248:251], a[172:175], v[124:127]
  v_mfma_f32_16x16x32_bf16 v[124:127], v[252:255], a[188:191], v[124:127]
  s_waitcnt vmcnt(5) lgkmcnt(0)
  v_mfma_f32_16x16x32_bf16 v[128:131], v[224:227], a[128:131], v[128:131]
  ds_read_b64_tr_b16 v[240:241], v4 offset:49152
  v_mfma_f32_16x16x32_bf16 v[128:131], v[228:231], a[144:147], v[128:131]
  ds_read_b64_tr_b16 v[242:243], v4 offset:49664
  v_mfma_f32_16x16x32_bf16 v[128:131], v[232:235], a[160:163], v[128:131]
  ds_read_b64_tr_b16 v[244:245], v4 offset:53248
  v_mfma_f32_16x16x32_bf16 v[128:131], v[236:239], a[176:179], v[128:131]
  ds_read_b128 a[224:227], v13 offset:8192
  v_mfma_f32_16x16x32_bf16 v[132:135], v[224:227], a[132:135], v[132:135]
  ds_read_b64_tr_b16 v[246:247], v4 offset:53760
  v_mfma_f32_16x16x32_bf16 v[132:135], v[228:231], a[148:151], v[132:135]
  ds_read_b64_tr_b16 v[248:249], v4 offset:57344
  v_mfma_f32_16x16x32_bf16 v[132:135], v[232:235], a[164:167], v[132:135]
  ds_read_b64_tr_b16 v[250:251], v4 offset:57856
  v_mfma_f32_16x16x32_bf16 v[132:135], v[236:239], a[180:183], v[132:135]
  ds_read_b128 a[240:243], v14 offset:8192
  v_mfma_f32_16x16x32_bf16 v[136:139], v[224:227], a[136:139], v[136:139]
  ds_read_b64_tr_b16 v[252:253], v4 offset:61440
  v_mfma_f32_16x16x32_bf16 v[136:139], v[228:231], a[152:155], v[136:139]
  ds_read_b64_tr_b16 v[254:255], v4 offset:61952
  v_mfma_f32_16x16x32_bf16 v[136:139], v[232:235], a[168:171], v[136:139]
  ds_read_b128 a[228:231], v13 offset:10240
  v_mfma_f32_16x16x32_bf16 v[136:139], v[236:239], a[184:187], v[136:139]
  ds_read_b128 a[244:247], v14 offset:10240
  v_mfma_f32_16x16x32_bf16 v[140:143], v[224:227], a[140:143], v[140:143]
  ds_read_b128 a[232:235], v13 offset:12288
  v_mfma_f32_16x16x32_bf16 v[140:143], v[228:231], a[156:159], v[140:143]
  ds_read_b128 a[248:251], v14 offset:12288
  v_mfma_f32_16x16x32_bf16 v[140:143], v[232:235], a[172:175], v[140:143]
  ds_read_b128 a[236:239], v13 offset:14336
  v_mfma_f32_16x16x32_bf16 v[140:143], v[236:239], a[188:191], v[140:143]
  ds_read_b128 a[252:255], v14 offset:14336
  s_waitcnt vmcnt(25) lgkmcnt(4)
  s_barrier
  v_mfma_f32_16x16x32_bf16 v[144:147], v[240:243], a[128:131], v[144:147]
  ds_read_b64_tr_b16 v[224:225], v1 offset:0
  s_add_u32 m0, s19, 49152
  v_mfma_f32_16x16x32_bf16 v[144:147], v[244:247], a[144:147], v[144:147]
  ds_read_b64_tr_b16 v[226:227], v1 offset:512
  s_add_u32 s21, s38, 256
  v_mfma_f32_16x16x32_bf16 v[144:147], v[248:251], a[160:163], v[144:147]
  ds_read_b64_tr_b16 v[228:229], v1 offset:4096
  v_mfma_f32_16x16x32_bf16 v[144:147], v[252:255], a[176:179], v[144:147]
  buffer_load_dwordx4 v5, s[12:15], s21 offen offset:0 lds
  v_mfma_f32_16x16x32_bf16 v[148:151], v[240:243], a[132:135], v[148:151]
  ds_read_b64_tr_b16 v[230:231], v1 offset:4608
  v_mfma_f32_16x16x32_bf16 v[148:151], v[244:247], a[148:151], v[148:151]
  ds_read_b64_tr_b16 v[232:233], v1 offset:8192
  v_mfma_f32_16x16x32_bf16 v[148:151], v[248:251], a[164:167], v[148:151]
  ds_read_b64_tr_b16 v[234:235], v1 offset:8704
  v_mfma_f32_16x16x32_bf16 v[148:151], v[252:255], a[180:183], v[148:151]
  buffer_load_dwordx4 v6, s[12:15], s21 offen offset:1024 lds
  v_mfma_f32_16x16x32_bf16 v[152:155], v[240:243], a[136:139], v[152:155]
  ds_read_b64_tr_b16 v[236:237], v1 offset:12288
  v_mfma_f32_16x16x32_bf16 v[152:155], v[244:247], a[152:155], v[152:155]
  ds_read_b64_tr_b16 v[238:239], v1 offset:12800
  v_mfma_f32_16x16x32_bf16 v[152:155], v[248:251], a[168:171], v[152:155]
  v_mfma_f32_16x16x32_bf16 v[152:155], v[252:255], a[184:187], v[152:155]
  buffer_load_dwordx4 v7, s[12:15], s21 offen offset:2048 lds
  v_mfma_f32_16x16x32_bf16 v[156:159], v[240:243], a[140:143], v[156:159]
  v_mfma_f32_16x16x32_bf16 v[156:159], v[244:247], a[156:159], v[156:159]
  v_mfma_f32_16x16x32_bf16 v[156:159], v[248:251], a[172:175], v[156:159]
  v_mfma_f32_16x16x32_bf16 v[156:159], v[252:255], a[188:191], v[156:159]
  buffer_load_dwordx4 v8, s[12:15], s21 offen offset:3072 lds
  s_waitcnt lgkmcnt(0)
  v_mfma_f32_16x16x32_bf16 v[160:163], v[224:227], a[128:131], v[160:163]
  ds_read_b64_tr_b16 v[240:241], v2 offset:0
  s_add_u32 m0, s20, 0
  v_mfma_f32_16x16x32_bf16 v[160:163], v[228:231], a[144:147], v[160:163]
  ds_read_b64_tr_b16 v[242:243], v2 offset:512
  s_add_u32 s28, s25, s76
  v_mfma_f32_16x16x32_bf16 v[160:163], v[232:235], a[160:163], v[160:163]
  ds_read_b64_tr_b16 v[244:245], v2 offset:4096
  v_mfma_f32_16x16x32_bf16 v[160:163], v[236:239], a[176:179], v[160:163]
  buffer_load_dwordx4 v9, s[44:47], s28 offen offset:0 lds
  v_mfma_f32_16x16x32_bf16 v[164:167], v[224:227], a[132:135], v[164:167]
  ds_read_b64_tr_b16 v[246:247], v2 offset:4608
  v_mfma_f32_16x16x32_bf16 v[164:167], v[228:231], a[148:151], v[164:167]
  ds_read_b64_tr_b16 v[248:249], v2 offset:8192
  v_mfma_f32_16x16x32_bf16 v[164:167], v[232:235], a[164:167], v[164:167]
  ds_read_b64_tr_b16 v[250:251], v2 offset:8704
  v_mfma_f32_16x16x32_bf16 v[164:167], v[236:239], a[180:183], v[164:167]
  buffer_load_dwordx4 v10, s[44:47], s28 offen offset:1024 lds
  v_mfma_f32_16x16x32_bf16 v[168:171], v[224:227], a[136:139], v[168:171]
  ds_read_b64_tr_b16 v[252:253], v2 offset:12288
  v_mfma_f32_16x16x32_bf16 v[168:171], v[228:231], a[152:155], v[168:171]
  ds_read_b64_tr_b16 v[254:255], v2 offset:12800
  v_mfma_f32_16x16x32_bf16 v[168:171], v[232:235], a[168:171], v[168:171]
  v_mfma_f32_16x16x32_bf16 v[168:171], v[236:239], a[184:187], v[168:171]
  buffer_load_dwordx4 v11, s[44:47], s28 offen offset:2048 lds
  v_mfma_f32_16x16x32_bf16 v[172:175], v[224:227], a[140:143], v[172:175]
  v_mfma_f32_16x16x32_bf16 v[172:175], v[228:231], a[156:159], v[172:175]
  v_mfma_f32_16x16x32_bf16 v[172:175], v[232:235], a[172:175], v[172:175]
  v_mfma_f32_16x16x32_bf16 v[172:175], v[236:239], a[188:191], v[172:175]
  buffer_load_dwordx4 v12, s[44:47], s28 offen offset:3072 lds
  s_waitcnt lgkmcnt(0)
  v_mfma_f32_16x16x32_bf16 v[176:179], v[240:243], a[128:131], v[176:179]
  ds_read_b64_tr_b16 v[224:225], v3 offset:0
  s_add_u32 m0, s20, 4096
  v_mfma_f32_16x16x32_bf16 v[176:179], v[244:247], a[144:147], v[176:179]
  ds_read_b64_tr_b16 v[226:227], v3 offset:512
  s_add_u32 s28, s26, s76
  v_mfma_f32_16x16x32_bf16 v[176:179], v[248:251], a[160:163], v[176:179]
  ds_read_b64_tr_b16 v[228:229], v3 offset:4096
  v_mfma_f32_16x16x32_bf16 v[176:179], v[252:255], a[176:179], v[176:179]
  buffer_load_dwordx4 v9, s[44:47], s28 offen offset:0 lds
  v_mfma_f32_16x16x32_bf16 v[180:183], v[240:243], a[132:135], v[180:183]
  ds_read_b64_tr_b16 v[230:231], v3 offset:4608
  v_mfma_f32_16x16x32_bf16 v[180:183], v[244:247], a[148:151], v[180:183]
  ds_read_b64_tr_b16 v[232:233], v3 offset:8192
  v_mfma_f32_16x16x32_bf16 v[180:183], v[248:251], a[164:167], v[180:183]
  ds_read_b64_tr_b16 v[234:235], v3 offset:8704
  v_mfma_f32_16x16x32_bf16 v[180:183], v[252:255], a[180:183], v[180:183]
  buffer_load_dwordx4 v10, s[44:47], s28 offen offset:1024 lds
  v_mfma_f32_16x16x32_bf16 v[184:187], v[240:243], a[136:139], v[184:187]
  ds_read_b64_tr_b16 v[236:237], v3 offset:12288
  v_mfma_f32_16x16x32_bf16 v[184:187], v[244:247], a[152:155], v[184:187]
  ds_read_b64_tr_b16 v[238:239], v3 offset:12800
  v_mfma_f32_16x16x32_bf16 v[184:187], v[248:251], a[168:171], v[184:187]
  v_mfma_f32_16x16x32_bf16 v[184:187], v[252:255], a[184:187], v[184:187]
  buffer_load_dwordx4 v11, s[44:47], s28 offen offset:2048 lds
  v_mfma_f32_16x16x32_bf16 v[188:191], v[240:243], a[140:143], v[188:191]
  v_mfma_f32_16x16x32_bf16 v[188:191], v[244:247], a[156:159], v[188:191]
  v_mfma_f32_16x16x32_bf16 v[188:191], v[248:251], a[172:175], v[188:191]
  v_mfma_f32_16x16x32_bf16 v[188:191], v[252:255], a[188:191], v[188:191]
  buffer_load_dwordx4 v12, s[44:47], s28 offen offset:3072 lds
  s_waitcnt lgkmcnt(0)
  v_mfma_f32_16x16x32_bf16 v[192:195], v[224:227], a[128:131], v[192:195]
  ds_read_b64_tr_b16 v[240:241], v4 offset:0
  s_add_u32 m0, s20, 8064
  v_mfma_f32_16x16x32_bf16 v[192:195], v[228:231], a[144:147], v[192:195]
  ds_read_b64_tr_b16 v[242:243], v4 offset:512
  s_add_u32 s28, s25, s76
  v_mfma_f32_16x16x32_bf16 v[192:195], v[232:235], a[160:163], v[192:195]
  ds_read_b64_tr_b16 v[244:245], v4 offset:4096
  v_mfma_f32_16x16x32_bf16 v[192:195], v[236:239], a[176:179], v[192:195]
  buffer_load_dwordx4 v9, s[44:47], s28 offen offset:128 lds
  v_mfma_f32_16x16x32_bf16 v[196:199], v[224:227], a[132:135], v[196:199]
  ds_read_b64_tr_b16 v[246:247], v4 offset:4608
  v_mfma_f32_16x16x32_bf16 v[196:199], v[228:231], a[148:151], v[196:199]
  ds_read_b64_tr_b16 v[248:249], v4 offset:8192
  v_mfma_f32_16x16x32_bf16 v[196:199], v[232:235], a[164:167], v[196:199]
  ds_read_b64_tr_b16 v[250:251], v4 offset:8704
  v_mfma_f32_16x16x32_bf16 v[196:199], v[236:239], a[180:183], v[196:199]
  buffer_load_dwordx4 v10, s[44:47], s28 offen offset:1152 lds
  v_mfma_f32_16x16x32_bf16 v[200:203], v[224:227], a[136:139], v[200:203]
  ds_read_b64_tr_b16 v[252:253], v4 offset:12288
  v_mfma_f32_16x16x32_bf16 v[200:203], v[228:231], a[152:155], v[200:203]
  ds_read_b64_tr_b16 v[254:255], v4 offset:12800
  v_mfma_f32_16x16x32_bf16 v[200:203], v[232:235], a[168:171], v[200:203]
  v_mfma_f32_16x16x32_bf16 v[200:203], v[236:239], a[184:187], v[200:203]
  buffer_load_dwordx4 v11, s[44:47], s28 offen offset:2176 lds
  v_mfma_f32_16x16x32_bf16 v[204:207], v[224:227], a[140:143], v[204:207]
  v_mfma_f32_16x16x32_bf16 v[204:207], v[228:231], a[156:159], v[204:207]
  v_mfma_f32_16x16x32_bf16 v[204:207], v[232:235], a[172:175], v[204:207]
  v_mfma_f32_16x16x32_bf16 v[204:207], v[236:239], a[188:191], v[204:207]
  buffer_load_dwordx4 v12, s[44:47], s28 offen offset:3200 lds
  s_waitcnt vmcnt(29) lgkmcnt(0)
  s_barrier
  v_mfma_f32_16x16x32_bf16 v[208:211], v[240:243], a[128:131], v[208:211]
  ds_read_b64_tr_b16 v[224:225], v1 offset:16384
  s_add_u32 m0, s19, 0
  v_mfma_f32_16x16x32_bf16 v[208:211], v[244:247], a[144:147], v[208:211]
  ds_read_b64_tr_b16 v[226:227], v1 offset:16896
  s_add_u32 s21, s22, 384
  v_mfma_f32_16x16x32_bf16 v[208:211], v[248:251], a[160:163], v[208:211]
  ds_read_b64_tr_b16 v[228:229], v1 offset:20480
  v_mfma_f32_16x16x32_bf16 v[208:211], v[252:255], a[176:179], v[208:211]
  buffer_load_dwordx4 v5, s[12:15], s21 offen offset:0 lds
  v_mfma_f32_16x16x32_bf16 v[212:215], v[240:243], a[132:135], v[212:215]
  ds_read_b64_tr_b16 v[230:231], v1 offset:20992
  v_mfma_f32_16x16x32_bf16 v[212:215], v[244:247], a[148:151], v[212:215]
  ds_read_b64_tr_b16 v[232:233], v1 offset:24576
  v_mfma_f32_16x16x32_bf16 v[212:215], v[248:251], a[164:167], v[212:215]
  ds_read_b64_tr_b16 v[234:235], v1 offset:25088
  v_mfma_f32_16x16x32_bf16 v[212:215], v[252:255], a[180:183], v[212:215]
  buffer_load_dwordx4 v6, s[12:15], s21 offen offset:1024 lds
  v_mfma_f32_16x16x32_bf16 v[216:219], v[240:243], a[136:139], v[216:219]
  ds_read_b64_tr_b16 v[236:237], v1 offset:28672
  v_mfma_f32_16x16x32_bf16 v[216:219], v[244:247], a[152:155], v[216:219]
  ds_read_b64_tr_b16 v[238:239], v1 offset:29184
  v_mfma_f32_16x16x32_bf16 v[216:219], v[248:251], a[168:171], v[216:219]
  v_mfma_f32_16x16x32_bf16 v[216:219], v[252:255], a[184:187], v[216:219]
  buffer_load_dwordx4 v7, s[12:15], s21 offen offset:2048 lds
  v_mfma_f32_16x16x32_bf16 v[220:223], v[240:243], a[140:143], v[220:223]
  v_mfma_f32_16x16x32_bf16 v[220:223], v[244:247], a[156:159], v[220:223]
  v_mfma_f32_16x16x32_bf16 v[220:223], v[248:251], a[172:175], v[220:223]
  v_mfma_f32_16x16x32_bf16 v[220:223], v[252:255], a[188:191], v[220:223]
  buffer_load_dwordx4 v8, s[12:15], s21 offen offset:3072 lds
  s_waitcnt lgkmcnt(0)
  v_mfma_f32_16x16x32_bf16 v[32:35], v[224:227], a[192:195], v[32:35]
  ds_read_b64_tr_b16 v[240:241], v2 offset:16384
  s_add_u32 m0, s20, 12160
  v_mfma_f32_16x16x32_bf16 v[32:35], v[228:231], a[208:211], v[32:35]
  ds_read_b64_tr_b16 v[242:243], v2 offset:16896
  s_add_u32 s28, s26, s76
  v_mfma_f32_16x16x32_bf16 v[32:35], v[232:235], a[224:227], v[32:35]
  ds_read_b64_tr_b16 v[244:245], v2 offset:20480
  v_mfma_f32_16x16x32_bf16 v[32:35], v[236:239], a[240:243], v[32:35]
  buffer_load_dwordx4 v9, s[44:47], s28 offen offset:128 lds
  v_mfma_f32_16x16x32_bf16 v[36:39], v[224:227], a[196:199], v[36:39]
  ds_read_b64_tr_b16 v[246:247], v2 offset:20992
  v_mfma_f32_16x16x32_bf16 v[36:39], v[228:231], a[212:215], v[36:39]
  ds_read_b64_tr_b16 v[248:249], v2 offset:24576
  v_mfma_f32_16x16x32_bf16 v[36:39], v[232:235], a[228:231], v[36:39]
  ds_read_b64_tr_b16 v[250:251], v2 offset:25088
  v_mfma_f32_16x16x32_bf16 v[36:39], v[236:239], a[244:247], v[36:39]
  buffer_load_dwordx4 v10, s[44:47], s28 offen offset:1152 lds
  v_mfma_f32_16x16x32_bf16 v[40:43], v[224:227], a[200:203], v[40:43]
  ds_read_b64_tr_b16 v[252:253], v2 offset:28672
  v_mfma_f32_16x16x32_bf16 v[40:43], v[228:231], a[216:219], v[40:43]
  ds_read_b64_tr_b16 v[254:255], v2 offset:29184
  v_mfma_f32_16x16x32_bf16 v[40:43], v[232:235], a[232:235], v[40:43]
  v_mfma_f32_16x16x32_bf16 v[40:43], v[236:239], a[248:251], v[40:43]
  buffer_load_dwordx4 v11, s[44:47], s28 offen offset:2176 lds
  v_mfma_f32_16x16x32_bf16 v[44:47], v[224:227], a[204:207], v[44:47]
  v_mfma_f32_16x16x32_bf16 v[44:47], v[228:231], a[220:223], v[44:47]
  v_mfma_f32_16x16x32_bf16 v[44:47], v[232:235], a[236:239], v[44:47]
  v_mfma_f32_16x16x32_bf16 v[44:47], v[236:239], a[252:255], v[44:47]
  buffer_load_dwordx4 v12, s[44:47], s28 offen offset:3200 lds
  s_waitcnt lgkmcnt(0)
  v_mfma_f32_16x16x32_bf16 v[48:51], v[240:243], a[192:195], v[48:51]
  ds_read_b64_tr_b16 v[224:225], v3 offset:16384
  s_add_u32 m0, s20, 16384
  v_mfma_f32_16x16x32_bf16 v[48:51], v[244:247], a[208:211], v[48:51]
  ds_read_b64_tr_b16 v[226:227], v3 offset:16896
  s_add_u32 s28, s25, s77
  v_mfma_f32_16x16x32_bf16 v[48:51], v[248:251], a[224:227], v[48:51]
  ds_read_b64_tr_b16 v[228:229], v3 offset:20480
  v_mfma_f32_16x16x32_bf16 v[48:51], v[252:255], a[240:243], v[48:51]
  buffer_load_dwordx4 v9, s[44:47], s28 offen offset:0 lds
  v_mfma_f32_16x16x32_bf16 v[52:55], v[240:243], a[196:199], v[52:55]
  ds_read_b64_tr_b16 v[230:231], v3 offset:20992
  v_mfma_f32_16x16x32_bf16 v[52:55], v[244:247], a[212:215], v[52:55]
  ds_read_b64_tr_b16 v[232:233], v3 offset:24576
  v_mfma_f32_16x16x32_bf16 v[52:55], v[248:251], a[228:231], v[52:55]
  ds_read_b64_tr_b16 v[234:235], v3 offset:25088
  v_mfma_f32_16x16x32_bf16 v[52:55], v[252:255], a[244:247], v[52:55]
  buffer_load_dwordx4 v10, s[44:47], s28 offen offset:1024 lds
  v_mfma_f32_16x16x32_bf16 v[56:59], v[240:243], a[200:203], v[56:59]
  ds_read_b64_tr_b16 v[236:237], v3 offset:28672
  v_mfma_f32_16x16x32_bf16 v[56:59], v[244:247], a[216:219], v[56:59]
  ds_read_b64_tr_b16 v[238:239], v3 offset:29184
  v_mfma_f32_16x16x32_bf16 v[56:59], v[248:251], a[232:235], v[56:59]
  v_mfma_f32_16x16x32_bf16 v[56:59], v[252:255], a[248:251], v[56:59]
  buffer_load_dwordx4 v11, s[44:47], s28 offen offset:2048 lds
  v_mfma_f32_16x16x32_bf16 v[60:63], v[240:243], a[204:207], v[60:63]
  v_mfma_f32_16x16x32_bf16 v[60:63], v[244:247], a[220:223], v[60:63]
  v_mfma_f32_16x16x32_bf16 v[60:63], v[248:251], a[236:239], v[60:63]
  v_mfma_f32_16x16x32_bf16 v[60:63], v[252:255], a[252:255], v[60:63]
  buffer_load_dwordx4 v12, s[44:47], s28 offen offset:3072 lds
  s_waitcnt lgkmcnt(0)
  v_mfma_f32_16x16x32_bf16 v[64:67], v[224:227], a[192:195], v[64:67]
  ds_read_b64_tr_b16 v[240:241], v4 offset:16384
  s_add_u32 m0, s20, 20480
  v_mfma_f32_16x16x32_bf16 v[64:67], v[228:231], a[208:211], v[64:67]
  ds_read_b64_tr_b16 v[242:243], v4 offset:16896
  s_add_u32 s28, s26, s77
  v_mfma_f32_16x16x32_bf16 v[64:67], v[232:235], a[224:227], v[64:67]
  ds_read_b64_tr_b16 v[244:245], v4 offset:20480
  v_mfma_f32_16x16x32_bf16 v[64:67], v[236:239], a[240:243], v[64:67]
  buffer_load_dwordx4 v9, s[44:47], s28 offen offset:0 lds
  v_mfma_f32_16x16x32_bf16 v[68:71], v[224:227], a[196:199], v[68:71]
  ds_read_b64_tr_b16 v[246:247], v4 offset:20992
  v_mfma_f32_16x16x32_bf16 v[68:71], v[228:231], a[212:215], v[68:71]
  ds_read_b64_tr_b16 v[248:249], v4 offset:24576
  v_mfma_f32_16x16x32_bf16 v[68:71], v[232:235], a[228:231], v[68:71]
  ds_read_b64_tr_b16 v[250:251], v4 offset:25088
  v_mfma_f32_16x16x32_bf16 v[68:71], v[236:239], a[244:247], v[68:71]
  buffer_load_dwordx4 v10, s[44:47], s28 offen offset:1024 lds
  v_mfma_f32_16x16x32_bf16 v[72:75], v[224:227], a[200:203], v[72:75]
  ds_read_b64_tr_b16 v[252:253], v4 offset:28672
  v_mfma_f32_16x16x32_bf16 v[72:75], v[228:231], a[216:219], v[72:75]
  ds_read_b64_tr_b16 v[254:255], v4 offset:29184
  v_mfma_f32_16x16x32_bf16 v[72:75], v[232:235], a[232:235], v[72:75]
  v_mfma_f32_16x16x32_bf16 v[72:75], v[236:239], a[248:251], v[72:75]
  buffer_load_dwordx4 v11, s[44:47], s28 offen offset:2048 lds
  v_mfma_f32_16x16x32_bf16 v[76:79], v[224:227], a[204:207], v[76:79]
  v_mfma_f32_16x16x32_bf16 v[76:79], v[228:231], a[220:223], v[76:79]
  v_mfma_f32_16x16x32_bf16 v[76:79], v[232:235], a[236:239], v[76:79]
  v_mfma_f32_16x16x32_bf16 v[76:79], v[236:239], a[252:255], v[76:79]
  buffer_load_dwordx4 v12, s[44:47], s28 offen offset:3072 lds
  s_waitcnt vmcnt(32) lgkmcnt(0)
  s_barrier
  v_mfma_f32_16x16x32_bf16 v[80:83], v[240:243], a[192:195], v[80:83]
  ds_read_b64_tr_b16 v[224:225], v1 offset:32768
  s_add_u32 m0, s19, 16384
  v_mfma_f32_16x16x32_bf16 v[80:83], v[244:247], a[208:211], v[80:83]
  ds_read_b64_tr_b16 v[226:227], v1 offset:33280
  s_add_u32 s21, s23, 384
  v_mfma_f32_16x16x32_bf16 v[80:83], v[248:251], a[224:227], v[80:83]
  ds_read_b64_tr_b16 v[228:229], v1 offset:36864
  v_mfma_f32_16x16x32_bf16 v[80:83], v[252:255], a[240:243], v[80:83]
  buffer_load_dwordx4 v5, s[12:15], s21 offen offset:0 lds
  v_mfma_f32_16x16x32_bf16 v[84:87], v[240:243], a[196:199], v[84:87]
  ds_read_b64_tr_b16 v[230:231], v1 offset:37376
  v_mfma_f32_16x16x32_bf16 v[84:87], v[244:247], a[212:215], v[84:87]
  ds_read_b64_tr_b16 v[232:233], v1 offset:40960
  v_mfma_f32_16x16x32_bf16 v[84:87], v[248:251], a[228:231], v[84:87]
  ds_read_b64_tr_b16 v[234:235], v1 offset:41472
  v_mfma_f32_16x16x32_bf16 v[84:87], v[252:255], a[244:247], v[84:87]
  buffer_load_dwordx4 v6, s[12:15], s21 offen offset:1024 lds
  v_mfma_f32_16x16x32_bf16 v[88:91], v[240:243], a[200:203], v[88:91]
  ds_read_b64_tr_b16 v[236:237], v1 offset:45056
  v_mfma_f32_16x16x32_bf16 v[88:91], v[244:247], a[216:219], v[88:91]
  ds_read_b64_tr_b16 v[238:239], v1 offset:45568
  v_mfma_f32_16x16x32_bf16 v[88:91], v[248:251], a[232:235], v[88:91]
  v_mfma_f32_16x16x32_bf16 v[88:91], v[252:255], a[248:251], v[88:91]
  buffer_load_dwordx4 v7, s[12:15], s21 offen offset:2048 lds
  v_mfma_f32_16x16x32_bf16 v[92:95], v[240:243], a[204:207], v[92:95]
  v_mfma_f32_16x16x32_bf16 v[92:95], v[244:247], a[220:223], v[92:95]
  v_mfma_f32_16x16x32_bf16 v[92:95], v[248:251], a[236:239], v[92:95]
  v_mfma_f32_16x16x32_bf16 v[92:95], v[252:255], a[252:255], v[92:95]
  buffer_load_dwordx4 v8, s[12:15], s21 offen offset:3072 lds
  s_waitcnt lgkmcnt(0)
  v_mfma_f32_16x16x32_bf16 v[96:99], v[224:227], a[192:195], v[96:99]
  ds_read_b64_tr_b16 v[240:241], v2 offset:32768
  v_mfma_f32_16x16x32_bf16 v[96:99], v[228:231], a[208:211], v[96:99]
  ds_read_b64_tr_b16 v[242:243], v2 offset:33280
  v_mfma_f32_16x16x32_bf16 v[96:99], v[232:235], a[224:227], v[96:99]
  ds_read_b64_tr_b16 v[244:245], v2 offset:36864
  v_mfma_f32_16x16x32_bf16 v[96:99], v[236:239], a[240:243], v[96:99]
  v_mfma_f32_16x16x32_bf16 v[100:103], v[224:227], a[196:199], v[100:103]
  ds_read_b64_tr_b16 v[246:247], v2 offset:37376
  v_mfma_f32_16x16x32_bf16 v[100:103], v[228:231], a[212:215], v[100:103]
  ds_read_b64_tr_b16 v[248:249], v2 offset:40960
  v_mfma_f32_16x16x32_bf16 v[100:103], v[232:235], a[228:231], v[100:103]
  ds_read_b64_tr_b16 v[250:251], v2 offset:41472
  v_mfma_f32_16x16x32_bf16 v[100:103], v[236:239], a[244:247], v[100:103]
  v_mfma_f32_16x16x32_bf16 v[104:107], v[224:227], a[200:203], v[104:107]
  ds_read_b64_tr_b16 v[252:253], v2 offset:45056
  s_lshr_b32 s29, s27, 1
  v_mfma_f32_16x16x32_bf16 v[104:107], v[228:231], a[216:219], v[104:107]
  ds_read_b64_tr_b16 v[254:255], v2 offset:45568
  s_mul_i32 s32, s29, s70
  v_mfma_f32_16x16x32_bf16 v[104:107], v[232:235], a[232:235], v[104:107]
  s_and_b32 s29, s27, 1
  s_mul_i32 s29, s29, s71
  s_add_u32 s32, s32, s29
  v_mfma_f32_16x16x32_bf16 v[104:107], v[236:239], a[248:251], v[104:107]
  s_add_u32 s32, s32, s36
  s_add_u32 s27, s27, 1
  s_add_u32 s33, s32, s67
  v_mfma_f32_16x16x32_bf16 v[108:111], v[224:227], a[204:207], v[108:111]
  s_add_u32 s34, s32, s66
  s_add_u32 s35, s34, s67
  v_mul_f32 v32, s68, v32
  v_mfma_f32_16x16x32_bf16 v[108:111], v[228:231], a[220:223], v[108:111]
  v_mul_f32 v33, s68, v33
  v_mul_f32 v34, s68, v34
  v_mfma_f32_16x16x32_bf16 v[108:111], v[232:235], a[236:239], v[108:111]
  v_mul_f32 v35, s68, v35
  v_mul_f32 v48, s68, v48
  v_mfma_f32_16x16x32_bf16 v[108:111], v[236:239], a[252:255], v[108:111]
  v_mul_f32 v49, s68, v49
  s_waitcnt lgkmcnt(0)
  v_mfma_f32_16x16x32_bf16 v[112:115], v[240:243], a[192:195], v[112:115]
  ds_read_b64_tr_b16 v[224:225], v3 offset:32768
  v_mul_f32 v50, s68, v50
  v_mfma_f32_16x16x32_bf16 v[112:115], v[244:247], a[208:211], v[112:115]
  ds_read_b64_tr_b16 v[226:227], v3 offset:33280
  v_mul_f32 v51, s68, v51
  v_mfma_f32_16x16x32_bf16 v[112:115], v[248:251], a[224:227], v[112:115]
  ds_read_b64_tr_b16 v[228:229], v3 offset:36864
  v_cvt_pk_bf16_f32 v32, v32, v33
  v_mfma_f32_16x16x32_bf16 v[112:115], v[252:255], a[240:243], v[112:115]
  v_cvt_pk_bf16_f32 v33, v34, v35
  v_cvt_pk_bf16_f32 v34, v48, v49
  v_mfma_f32_16x16x32_bf16 v[116:119], v[240:243], a[196:199], v[116:119]
  ds_read_b64_tr_b16 v[230:231], v3 offset:37376
  v_cvt_pk_bf16_f32 v35, v50, v51
  v_mfma_f32_16x16x32_bf16 v[116:119], v[244:247], a[212:215], v[116:119]
  ds_read_b64_tr_b16 v[232:233], v3 offset:40960
  v_mul_f32 v36, s68, v36
  v_mfma_f32_16x16x32_bf16 v[116:119], v[248:251], a[228:231], v[116:119]
  ds_read_b64_tr_b16 v[234:235], v3 offset:41472
  v_mul_f32 v37, s68, v37
  v_mfma_f32_16x16x32_bf16 v[116:119], v[252:255], a[244:247], v[116:119]
  v_mul_f32 v38, s68, v38
  v_mul_f32 v39, s68, v39
  v_mfma_f32_16x16x32_bf16 v[120:123], v[240:243], a[200:203], v[120:123]
  ds_read_b64_tr_b16 v[236:237], v3 offset:45056
  v_mul_f32 v52, s68, v52
  v_mfma_f32_16x16x32_bf16 v[120:123], v[244:247], a[216:219], v[120:123]
  ds_read_b64_tr_b16 v[238:239], v3 offset:45568
  v_mul_f32 v53, s68, v53
  v_mfma_f32_16x16x32_bf16 v[120:123], v[248:251], a[232:235], v[120:123]
  v_mul_f32 v54, s68, v54
  v_mul_f32 v55, s68, v55
  v_mfma_f32_16x16x32_bf16 v[120:123], v[252:255], a[248:251], v[120:123]
  v_cvt_pk_bf16_f32 v36, v36, v37
  v_cvt_pk_bf16_f32 v37, v38, v39
  v_mfma_f32_16x16x32_bf16 v[124:127], v[240:243], a[204:207], v[124:127]
  v_permlane16_swap_b32 v32, v34
  v_mfma_f32_16x16x32_bf16 v[124:127], v[244:247], a[220:223], v[124:127]
  v_permlane16_swap_b32 v33, v35
  v_mfma_f32_16x16x32_bf16 v[124:127], v[248:251], a[236:239], v[124:127]
  v_cvt_pk_bf16_f32 v38, v52, v53
  v_cvt_pk_bf16_f32 v39, v54, v55
  v_mfma_f32_16x16x32_bf16 v[124:127], v[252:255], a[252:255], v[124:127]
  buffer_store_dwordx4 v[32:35], v17, s[48:51], s32 offen sc1
  s_waitcnt lgkmcnt(0)
  v_mfma_f32_16x16x32_bf16 v[128:131], v[224:227], a[192:195], v[128:131]
  ds_read_b64_tr_b16 v[240:241], v4 offset:32768
  v_mfma_f32_16x16x32_bf16 v[128:131], v[228:231], a[208:211], v[128:131]
  ds_read_b64_tr_b16 v[242:243], v4 offset:33280
  s_add_u32 s32, s32, s65
  v_mfma_f32_16x16x32_bf16 v[128:131], v[232:235], a[224:227], v[128:131]
  ds_read_b64_tr_b16 v[244:245], v4 offset:36864
  v_mul_f32 v40, s68, v40
  v_mfma_f32_16x16x32_bf16 v[128:131], v[236:239], a[240:243], v[128:131]
  v_mul_f32 v41, s68, v41
  v_mul_f32 v42, s68, v42
  v_mfma_f32_16x16x32_bf16 v[132:135], v[224:227], a[196:199], v[132:135]
  ds_read_b64_tr_b16 v[246:247], v4 offset:37376
  v_mul_f32 v43, s68, v43
  v_mfma_f32_16x16x32_bf16 v[132:135], v[228:231], a[212:215], v[132:135]
  ds_read_b64_tr_b16 v[248:249], v4 offset:40960
  v_mul_f32 v56, s68, v56
  v_mfma_f32_16x16x32_bf16 v[132:135], v[232:235], a[228:231], v[132:135]
  ds_read_b64_tr_b16 v[250:251], v4 offset:41472
  v_mul_f32 v57, s68, v57
  v_mfma_f32_16x16x32_bf16 v[132:135], v[236:239], a[244:247], v[132:135]
  v_mul_f32 v58, s68, v58
  v_mul_f32 v59, s68, v59
  v_mfma_f32_16x16x32_bf16 v[136:139], v[224:227], a[200:203], v[136:139]
  ds_read_b64_tr_b16 v[252:253], v4 offset:45056
  v_cvt_pk_bf16_f32 v40, v40, v41
  v_mfma_f32_16x16x32_bf16 v[136:139], v[228:231], a[216:219], v[136:139]
  ds_read_b64_tr_b16 v[254:255], v4 offset:45568
  v_cvt_pk_bf16_f32 v41, v42, v43
  v_mfma_f32_16x16x32_bf16 v[136:139], v[232:235], a[232:235], v[136:139]
  v_permlane16_swap_b32 v36, v38
  v_mfma_f32_16x16x32_bf16 v[136:139], v[236:239], a[248:251], v[136:139]
  v_permlane16_swap_b32 v37, v39
  v_mfma_f32_16x16x32_bf16 v[140:143], v[224:227], a[204:207], v[140:143]
  v_cvt_pk_bf16_f32 v42, v56, v57
  v_mfma_f32_16x16x32_bf16 v[140:143], v[228:231], a[220:223], v[140:143]
  buffer_store_dwordx4 v[36:39], v17, s[48:51], s33 offen sc1
  v_cvt_pk_bf16_f32 v43, v58, v59
  v_mfma_f32_16x16x32_bf16 v[140:143], v[232:235], a[236:239], v[140:143]
  s_add_u32 s33, s33, s65
  v_mul_f32 v44, s68, v44
  v_mul_f32 v45, s68, v45
  v_mfma_f32_16x16x32_bf16 v[140:143], v[236:239], a[252:255], v[140:143]
  s_waitcnt vmcnt(34) lgkmcnt(0)
  s_barrier
  v_mfma_f32_16x16x32_bf16 v[144:147], v[240:243], a[192:195], v[144:147]
  ds_read_b64_tr_b16 v[224:225], v1 offset:49152
  s_add_u32 m0, s19, 32768
  v_mfma_f32_16x16x32_bf16 v[144:147], v[244:247], a[208:211], v[144:147]
  ds_read_b64_tr_b16 v[226:227], v1 offset:49664
  s_add_u32 s21, s24, 384
  v_mfma_f32_16x16x32_bf16 v[144:147], v[248:251], a[224:227], v[144:147]
  ds_read_b64_tr_b16 v[228:229], v1 offset:53248
  v_mul_f32 v46, s68, v46
  v_mfma_f32_16x16x32_bf16 v[144:147], v[252:255], a[240:243], v[144:147]
  buffer_load_dwordx4 v5, s[12:15], s21 offen offset:0 lds
  v_mul_f32 v47, s68, v47
  v_mfma_f32_16x16x32_bf16 v[148:151], v[240:243], a[196:199], v[148:151]
  ds_read_b64_tr_b16 v[230:231], v1 offset:53760
  v_mul_f32 v60, s68, v60
  v_mfma_f32_16x16x32_bf16 v[148:151], v[244:247], a[212:215], v[148:151]
  ds_read_b64_tr_b16 v[232:233], v1 offset:57344
  v_mul_f32 v61, s68, v61
  v_mfma_f32_16x16x32_bf16 v[148:151], v[248:251], a[228:231], v[148:151]
  ds_read_b64_tr_b16 v[234:235], v1 offset:57856
  v_mul_f32 v62, s68, v62
  v_mfma_f32_16x16x32_bf16 v[148:151], v[252:255], a[244:247], v[148:151]
  buffer_load_dwordx4 v6, s[12:15], s21 offen offset:1024 lds
  v_mul_f32 v63, s68, v63
  v_mfma_f32_16x16x32_bf16 v[152:155], v[240:243], a[200:203], v[152:155]
  ds_read_b64_tr_b16 v[236:237], v1 offset:61440
  v_cvt_pk_bf16_f32 v44, v44, v45
  v_mfma_f32_16x16x32_bf16 v[152:155], v[244:247], a[216:219], v[152:155]
  ds_read_b64_tr_b16 v[238:239], v1 offset:61952
  v_cvt_pk_bf16_f32 v45, v46, v47
  v_mfma_f32_16x16x32_bf16 v[152:155], v[248:251], a[232:235], v[152:155]
  v_permlane16_swap_b32 v40, v42
  v_mfma_f32_16x16x32_bf16 v[152:155], v[252:255], a[248:251], v[152:155]
  buffer_load_dwordx4 v7, s[12:15], s21 offen offset:2048 lds
  v_mfma_f32_16x16x32_bf16 v[156:159], v[240:243], a[204:207], v[156:159]
  v_permlane16_swap_b32 v41, v43
  v_mfma_f32_16x16x32_bf16 v[156:159], v[244:247], a[220:223], v[156:159]
  v_cvt_pk_bf16_f32 v46, v60, v61
  v_mfma_f32_16x16x32_bf16 v[156:159], v[248:251], a[236:239], v[156:159]
  buffer_store_dwordx4 v[40:43], v17, s[48:51], s34 offen sc1
  v_cvt_pk_bf16_f32 v47, v62, v63
  v_mfma_f32_16x16x32_bf16 v[156:159], v[252:255], a[252:255], v[156:159]
  buffer_load_dwordx4 v8, s[12:15], s21 offen offset:3072 lds
  s_waitcnt lgkmcnt(0)
  v_mfma_f32_16x16x32_bf16 v[160:163], v[224:227], a[192:195], v[160:163]
  ds_read_b64_tr_b16 v[240:241], v2 offset:49152
  v_mfma_f32_16x16x32_bf16 v[160:163], v[228:231], a[208:211], v[160:163]
  ds_read_b64_tr_b16 v[242:243], v2 offset:49664
  s_add_u32 s34, s34, s65
  v_mfma_f32_16x16x32_bf16 v[160:163], v[232:235], a[224:227], v[160:163]
  ds_read_b64_tr_b16 v[244:245], v2 offset:53248
  v_mul_f32 v64, s68, v64
  v_mfma_f32_16x16x32_bf16 v[160:163], v[236:239], a[240:243], v[160:163]
  v_mul_f32 v65, s68, v65
  v_mul_f32 v66, s68, v66
  v_mfma_f32_16x16x32_bf16 v[164:167], v[224:227], a[196:199], v[164:167]
  ds_read_b64_tr_b16 v[246:247], v2 offset:53760
  v_mul_f32 v67, s68, v67
  v_mfma_f32_16x16x32_bf16 v[164:167], v[228:231], a[212:215], v[164:167]
  ds_read_b64_tr_b16 v[248:249], v2 offset:57344
  v_mul_f32 v80, s68, v80
  v_mfma_f32_16x16x32_bf16 v[164:167], v[232:235], a[228:231], v[164:167]
  ds_read_b64_tr_b16 v[250:251], v2 offset:57856
  v_mul_f32 v81, s68, v81
  v_mfma_f32_16x16x32_bf16 v[164:167], v[236:239], a[244:247], v[164:167]
  v_mul_f32 v82, s68, v82
  v_mul_f32 v83, s68, v83
  v_mfma_f32_16x16x32_bf16 v[168:171], v[224:227], a[200:203], v[168:171]
  ds_read_b64_tr_b16 v[252:253], v2 offset:61440
  v_cvt_pk_bf16_f32 v64, v64, v65
  v_mfma_f32_16x16x32_bf16 v[168:171], v[228:231], a[216:219], v[168:171]
  ds_read_b64_tr_b16 v[254:255], v2 offset:61952
  v_cvt_pk_bf16_f32 v65, v66, v67
  v_mfma_f32_16x16x32_bf16 v[168:171], v[232:235], a[232:235], v[168:171]
  v_permlane16_swap_b32 v44, v46
  v_mfma_f32_16x16x32_bf16 v[168:171], v[236:239], a[248:251], v[168:171]
  v_permlane16_swap_b32 v45, v47
  v_mfma_f32_16x16x32_bf16 v[172:175], v[224:227], a[204:207], v[172:175]
  v_cvt_pk_bf16_f32 v66, v80, v81
  v_mfma_f32_16x16x32_bf16 v[172:175], v[228:231], a[220:223], v[172:175]
  buffer_store_dwordx4 v[44:47], v17, s[48:51], s35 offen sc1
  v_cvt_pk_bf16_f32 v67, v82, v83
  v_mfma_f32_16x16x32_bf16 v[172:175], v[232:235], a[236:239], v[172:175]
  s_add_u32 s35, s35, s65
  v_mul_f32 v68, s68, v68
  v_mfma_f32_16x16x32_bf16 v[172:175], v[236:239], a[252:255], v[172:175]
  v_mul_f32 v69, s68, v69
  s_waitcnt lgkmcnt(0)
  v_mfma_f32_16x16x32_bf16 v[176:179], v[240:243], a[192:195], v[176:179]
  ds_read_b64_tr_b16 v[224:225], v3 offset:49152
  v_mul_f32 v70, s68, v70
  v_mfma_f32_16x16x32_bf16 v[176:179], v[244:247], a[208:211], v[176:179]
  ds_read_b64_tr_b16 v[226:227], v3 offset:49664
  v_mul_f32 v71, s68, v71
  v_mfma_f32_16x16x32_bf16 v[176:179], v[248:251], a[224:227], v[176:179]
  ds_read_b64_tr_b16 v[228:229], v3 offset:53248
  v_mul_f32 v84, s68, v84
  v_mfma_f32_16x16x32_bf16 v[176:179], v[252:255], a[240:243], v[176:179]
  v_mul_f32 v85, s68, v85
  v_mul_f32 v86, s68, v86
  v_mfma_f32_16x16x32_bf16 v[180:183], v[240:243], a[196:199], v[180:183]
  ds_read_b64_tr_b16 v[230:231], v3 offset:53760
  v_mul_f32 v87, s68, v87
  v_mfma_f32_16x16x32_bf16 v[180:183], v[244:247], a[212:215], v[180:183]
  ds_read_b64_tr_b16 v[232:233], v3 offset:57344
  v_cvt_pk_bf16_f32 v68, v68, v69
  v_mfma_f32_16x16x32_bf16 v[180:183], v[248:251], a[228:231], v[180:183]
  ds_read_b64_tr_b16 v[234:235], v3 offset:57856
  v_cvt_pk_bf16_f32 v69, v70, v71
  v_mfma_f32_16x16x32_bf16 v[180:183], v[252:255], a[244:247], v[180:183]
  v_permlane16_swap_b32 v64, v66
  v_mfma_f32_16x16x32_bf16 v[184:187], v[240:243], a[200:203], v[184:187]
  ds_read_b64_tr_b16 v[236:237], v3 offset:61440
  v_mfma_f32_16x16x32_bf16 v[184:187], v[244:247], a[216:219], v[184:187]
  ds_read_b64_tr_b16 v[238:239], v3 offset:61952
  v_permlane16_swap_b32 v65, v67
  v_mfma_f32_16x16x32_bf16 v[184:187], v[248:251], a[232:235], v[184:187]
  v_cvt_pk_bf16_f32 v70, v84, v85
  v_cvt_pk_bf16_f32 v71, v86, v87
  v_mfma_f32_16x16x32_bf16 v[184:187], v[252:255], a[248:251], v[184:187]
  buffer_store_dwordx4 v[64:67], v17, s[48:51], s32 offen sc1
  v_mul_f32 v72, s68, v72
  v_mfma_f32_16x16x32_bf16 v[188:191], v[240:243], a[204:207], v[188:191]
  v_mul_f32 v73, s68, v73
  v_mul_f32 v74, s68, v74
  v_mfma_f32_16x16x32_bf16 v[188:191], v[244:247], a[220:223], v[188:191]
  v_mul_f32 v75, s68, v75
  v_mul_f32 v88, s68, v88
  v_mfma_f32_16x16x32_bf16 v[188:191], v[248:251], a[236:239], v[188:191]
  v_mul_f32 v89, s68, v89
  v_mul_f32 v90, s68, v90
  v_mfma_f32_16x16x32_bf16 v[188:191], v[252:255], a[252:255], v[188:191]
  v_mul_f32 v91, s68, v91
  s_waitcnt lgkmcnt(0)
  v_mfma_f32_16x16x32_bf16 v[192:195], v[224:227], a[192:195], v[192:195]
  ds_read_b64_tr_b16 v[240:241], v4 offset:49152
  v_cvt_pk_bf16_f32 v72, v72, v73
  v_mfma_f32_16x16x32_bf16 v[192:195], v[228:231], a[208:211], v[192:195]
  ds_read_b64_tr_b16 v[242:243], v4 offset:49664
  v_cvt_pk_bf16_f32 v73, v74, v75
  v_mfma_f32_16x16x32_bf16 v[192:195], v[232:235], a[224:227], v[192:195]
  ds_read_b64_tr_b16 v[244:245], v4 offset:53248
  v_permlane16_swap_b32 v68, v70
  v_mfma_f32_16x16x32_bf16 v[192:195], v[236:239], a[240:243], v[192:195]
  v_permlane16_swap_b32 v69, v71
  v_mfma_f32_16x16x32_bf16 v[196:199], v[224:227], a[196:199], v[196:199]
  ds_read_b64_tr_b16 v[246:247], v4 offset:53760
  v_cvt_pk_bf16_f32 v74, v88, v89
  v_mfma_f32_16x16x32_bf16 v[196:199], v[228:231], a[212:215], v[196:199]
  ds_read_b64_tr_b16 v[248:249], v4 offset:57344
  v_cvt_pk_bf16_f32 v75, v90, v91
  v_mfma_f32_16x16x32_bf16 v[196:199], v[232:235], a[228:231], v[196:199]
  ds_read_b64_tr_b16 v[250:251], v4 offset:57856
  buffer_store_dwordx4 v[68:71], v17, s[48:51], s33 offen sc1
  v_mfma_f32_16x16x32_bf16 v[196:199], v[236:239], a[244:247], v[196:199]
  v_mul_f32 v76, s68, v76
  v_mul_f32 v77, s68, v77
  v_mfma_f32_16x16x32_bf16 v[200:203], v[224:227], a[200:203], v[200:203]
  ds_read_b64_tr_b16 v[252:253], v4 offset:61440
  v_mul_f32 v78, s68, v78
  v_mfma_f32_16x16x32_bf16 v[200:203], v[228:231], a[216:219], v[200:203]
  ds_read_b64_tr_b16 v[254:255], v4 offset:61952
  v_mul_f32 v79, s68, v79
  v_mfma_f32_16x16x32_bf16 v[200:203], v[232:235], a[232:235], v[200:203]
  v_mul_f32 v92, s68, v92
  v_mul_f32 v93, s68, v93
  v_mfma_f32_16x16x32_bf16 v[200:203], v[236:239], a[248:251], v[200:203]
  v_mul_f32 v94, s68, v94
  v_mul_f32 v95, s68, v95
  v_mfma_f32_16x16x32_bf16 v[204:207], v[224:227], a[204:207], v[204:207]
  v_cvt_pk_bf16_f32 v76, v76, v77
  v_cvt_pk_bf16_f32 v77, v78, v79
  v_mfma_f32_16x16x32_bf16 v[204:207], v[228:231], a[220:223], v[204:207]
  v_permlane16_swap_b32 v72, v74
  v_mfma_f32_16x16x32_bf16 v[204:207], v[232:235], a[236:239], v[204:207]
  v_permlane16_swap_b32 v73, v75
  v_mfma_f32_16x16x32_bf16 v[204:207], v[236:239], a[252:255], v[204:207]
  s_waitcnt vmcnt(26) lgkmcnt(0)
  s_barrier
  v_mfma_f32_16x16x32_bf16 v[208:211], v[240:243], a[192:195], v[208:211]
  ds_read_b64_tr_b16 v[224:225], v1 offset:0
  s_add_u32 m0, s19, 49152
  v_mfma_f32_16x16x32_bf16 v[208:211], v[244:247], a[208:211], v[208:211]
  ds_read_b64_tr_b16 v[226:227], v1 offset:512
  s_add_u32 s21, s38, 384
  v_mfma_f32_16x16x32_bf16 v[208:211], v[248:251], a[224:227], v[208:211]
  ds_read_b64_tr_b16 v[228:229], v1 offset:4096
  v_mfma_f32_16x16x32_bf16 v[208:211], v[252:255], a[240:243], v[208:211]
  buffer_load_dwordx4 v5, s[12:15], s21 offen offset:0 lds
  v_mfma_f32_16x16x32_bf16 v[212:215], v[240:243], a[196:199], v[212:215]
  ds_read_b64_tr_b16 v[230:231], v1 offset:4608
  v_mfma_f32_16x16x32_bf16 v[212:215], v[244:247], a[212:215], v[212:215]
  ds_read_b64_tr_b16 v[232:233], v1 offset:8192
  v_mfma_f32_16x16x32_bf16 v[212:215], v[248:251], a[228:231], v[212:215]
  ds_read_b64_tr_b16 v[234:235], v1 offset:8704
  v_mfma_f32_16x16x32_bf16 v[212:215], v[252:255], a[244:247], v[212:215]
  buffer_load_dwordx4 v6, s[12:15], s21 offen offset:1024 lds
  v_cvt_pk_bf16_f32 v78, v92, v93
  v_mfma_f32_16x16x32_bf16 v[216:219], v[240:243], a[200:203], v[216:219]
  ds_read_b64_tr_b16 v[236:237], v1 offset:12288
  v_cvt_pk_bf16_f32 v79, v94, v95
  v_mfma_f32_16x16x32_bf16 v[216:219], v[244:247], a[216:219], v[216:219]
  ds_read_b64_tr_b16 v[238:239], v1 offset:12800
  buffer_store_dwordx4 v[72:75], v17, s[48:51], s34 offen sc1
  v_mfma_f32_16x16x32_bf16 v[216:219], v[248:251], a[232:235], v[216:219]
  s_nop 1
  v_mfma_f32_16x16x32_bf16 v[216:219], v[252:255], a[248:251], v[216:219]
  buffer_load_dwordx4 v7, s[12:15], s21 offen offset:2048 lds
  v_permlane16_swap_b32 v76, v78
  v_mfma_f32_16x16x32_bf16 v[220:223], v[240:243], a[204:207], v[220:223]
  v_permlane16_swap_b32 v77, v79
  v_mfma_f32_16x16x32_bf16 v[220:223], v[244:247], a[220:223], v[220:223]
  buffer_store_dwordx4 v[76:79], v17, s[48:51], s35 offen sc1
  v_mfma_f32_16x16x32_bf16 v[220:223], v[248:251], a[236:239], v[220:223]
  v_mfma_f32_16x16x32_bf16 v[220:223], v[252:255], a[252:255], v[220:223]
  buffer_load_dwordx4 v8, s[12:15], s21 offen offset:3072 lds
  s_bitcmp1_b32 s61, 0
  s_cbranch_scc1 P1_SK0
  s_waitcnt lgkmcnt(0)
  v_mfma_f32_16x16x32_bf16 v[32:35], v[224:227], a[0:3], 0
  ds_read_b64_tr_b16 v[240:241], v2 offset:0
  v_mfma_f32_16x16x32_bf16 v[32:35], v[228:231], a[16:19], v[32:35]
  ds_read_b64_tr_b16 v[242:243], v2 offset:512
  v_mfma_f32_16x16x32_bf16 v[32:35], v[232:235], a[32:35], v[32:35]
  ds_read_b64_tr_b16 v[244:245], v2 offset:4096
  v_mfma_f32_16x16x32_bf16 v[32:35], v[236:239], a[48:51], v[32:35]
  v_mfma_f32_16x16x32_bf16 v[36:39], v[224:227], a[4:7], 0
  ds_read_b64_tr_b16 v[246:247], v2 offset:4608
  v_mfma_f32_16x16x32_bf16 v[36:39], v[228:231], a[20:23], v[36:39]
  ds_read_b64_tr_b16 v[248:249], v2 offset:8192
  v_mfma_f32_16x16x32_bf16 v[36:39], v[232:235], a[36:39], v[36:39]
  ds_read_b64_tr_b16 v[250:251], v2 offset:8704
  v_mfma_f32_16x16x32_bf16 v[36:39], v[236:239], a[52:55], v[36:39]
  v_mfma_f32_16x16x32_bf16 v[40:43], v[224:227], a[8:11], 0
  ds_read_b64_tr_b16 v[252:253], v2 offset:12288
  s_lshr_b32 s29, s27, 1
  v_mfma_f32_16x16x32_bf16 v[40:43], v[228:231], a[24:27], v[40:43]
  ds_read_b64_tr_b16 v[254:255], v2 offset:12800
  s_mul_i32 s32, s29, s70
  v_mfma_f32_16x16x32_bf16 v[40:43], v[232:235], a[40:43], v[40:43]
  s_and_b32 s29, s27, 1
  s_mul_i32 s29, s29, s71
  s_add_u32 s32, s32, s29
  v_mfma_f32_16x16x32_bf16 v[40:43], v[236:239], a[56:59], v[40:43]
  s_add_u32 s32, s32, s36
  s_add_u32 s27, s27, 1
  s_add_u32 s33, s32, s67
  v_mfma_f32_16x16x32_bf16 v[44:47], v[224:227], a[12:15], 0
  s_add_u32 s34, s32, s66
  s_add_u32 s35, s34, s67
  v_mul_f32 v96, s68, v96
  v_mfma_f32_16x16x32_bf16 v[44:47], v[228:231], a[28:31], v[44:47]
  v_mul_f32 v97, s68, v97
  v_mul_f32 v98, s68, v98
  v_mfma_f32_16x16x32_bf16 v[44:47], v[232:235], a[44:47], v[44:47]
  v_mul_f32 v99, s68, v99
  v_mul_f32 v112, s68, v112
  v_mfma_f32_16x16x32_bf16 v[44:47], v[236:239], a[60:63], v[44:47]
  v_mul_f32 v113, s68, v113
  s_waitcnt lgkmcnt(0)
  v_mfma_f32_16x16x32_bf16 v[48:51], v[240:243], a[0:3], 0
  ds_read_b64_tr_b16 v[224:225], v3 offset:0
  v_mul_f32 v114, s68, v114
  v_mfma_f32_16x16x32_bf16 v[48:51], v[244:247], a[16:19], v[48:51]
  ds_read_b64_tr_b16 v[226:227], v3 offset:512
  v_mul_f32 v115, s68, v115
  v_mfma_f32_16x16x32_bf16 v[48:51], v[248:251], a[32:35], v[48:51]
  ds_read_b64_tr_b16 v[228:229], v3 offset:4096
  v_cvt_pk_bf16_f32 v96, v96, v97
  v_mfma_f32_16x16x32_bf16 v[48:51], v[252:255], a[48:51], v[48:51]
  v_cvt_pk_bf16_f32 v97, v98, v99
  v_cvt_pk_bf16_f32 v98, v112, v113
  v_mfma_f32_16x16x32_bf16 v[52:55], v[240:243], a[4:7], 0
  ds_read_b64_tr_b16 v[230:231], v3 offset:4608
  v_cvt_pk_bf16_f32 v99, v114, v115
  v_mfma_f32_16x16x32_bf16 v[52:55], v[244:247], a[20:23], v[52:55]
  ds_read_b64_tr_b16 v[232:233], v3 offset:8192
  v_mul_f32 v100, s68, v100
  v_mfma_f32_16x16x32_bf16 v[52:55], v[248:251], a[36:39], v[52:55]
  ds_read_b64_tr_b16 v[234:235], v3 offset:8704
  v_mul_f32 v101, s68, v101
  v_mfma_f32_16x16x32_bf16 v[52:55], v[252:255], a[52:55], v[52:55]
  v_mul_f32 v102, s68, v102
  v_mul_f32 v103, s68, v103
  v_mfma_f32_16x16x32_bf16 v[56:59], v[240:243], a[8:11], 0
  ds_read_b64_tr_b16 v[236:237], v3 offset:12288
  v_mul_f32 v116, s68, v116
  v_mfma_f32_16x16x32_bf16 v[56:59], v[244:247], a[24:27], v[56:59]
  ds_read_b64_tr_b16 v[238:239], v3 offset:12800
  v_mul_f32 v117, s68, v117
  v_mfma_f32_16x16x32_bf16 v[56:59], v[248:251], a[40:43], v[56:59]
  v_mul_f32 v118, s68, v118
  v_mul_f32 v119, s68, v119
  v_mfma_f32_16x16x32_bf16 v[56:59], v[252:255], a[56:59], v[56:59]
  v_cvt_pk_bf16_f32 v100, v100, v101
  v_cvt_pk_bf16_f32 v101, v102, v103
  v_mfma_f32_16x16x32_bf16 v[60:63], v[240:243], a[12:15], 0
  v_permlane16_swap_b32 v96, v98
  v_mfma_f32_16x16x32_bf16 v[60:63], v[244:247], a[28:31], v[60:63]
  v_permlane16_swap_b32 v97, v99
  v_mfma_f32_16x16x32_bf16 v[60:63], v[248:251], a[44:47], v[60:63]
  v_cvt_pk_bf16_f32 v102, v116, v117
  v_cvt_pk_bf16_f32 v103, v118, v119
  v_mfma_f32_16x16x32_bf16 v[60:63], v[252:255], a[60:63], v[60:63]
  buffer_store_dwordx4 v[96:99], v17, s[48:51], s32 offen sc1
  s_waitcnt lgkmcnt(0)
  v_mfma_f32_16x16x32_bf16 v[64:67], v[224:227], a[0:3], 0
  ds_read_b64_tr_b16 v[240:241], v4 offset:0
  v_mfma_f32_16x16x32_bf16 v[64:67], v[228:231], a[16:19], v[64:67]
  ds_read_b64_tr_b16 v[242:243], v4 offset:512
  v_mfma_f32_16x16x32_bf16 v[64:67], v[232:235], a[32:35], v[64:67]
  ds_read_b64_tr_b16 v[244:245], v4 offset:4096
  v_mfma_f32_16x16x32_bf16 v[64:67], v[236:239], a[48:51], v[64:67]
  s_add_u32 s32, s32, s65
  v_mul_f32 v104, s68, v104
  v_mfma_f32_16x16x32_bf16 v[68:71], v[224:227], a[4:7], 0
  ds_read_b64_tr_b16 v[246:247], v4 offset:4608
  v_mul_f32 v105, s68, v105
  v_mfma_f32_16x16x32_bf16 v[68:71], v[228:231], a[20:23], v[68:71]
  ds_read_b64_tr_b16 v[248:249], v4 offset:8192
  v_mul_f32 v106, s68, v106
  v_mfma_f32_16x16x32_bf16 v[68:71], v[232:235], a[36:39], v[68:71]
  ds_read_b64_tr_b16 v[250:251], v4 offset:8704
  v_mul_f32 v107, s68, v107
  v_mfma_f32_16x16x32_bf16 v[68:71], v[236:239], a[52:55], v[68:71]
  v_mul_f32 v120, s68, v120
  v_mul_f32 v121, s68, v121
  v_mfma_f32_16x16x32_bf16 v[72:75], v[224:227], a[8:11], 0
  ds_read_b64_tr_b16 v[252:253], v4 offset:12288
  v_mul_f32 v122, s68, v122
  v_mfma_f32_16x16x32_bf16 v[72:75], v[228:231], a[24:27], v[72:75]
  ds_read_b64_tr_b16 v[254:255], v4 offset:12800
  v_mul_f32 v123, s68, v123
  v_mfma_f32_16x16x32_bf16 v[72:75], v[232:235], a[40:43], v[72:75]
  v_cvt_pk_bf16_f32 v104, v104, v105
  v_cvt_pk_bf16_f32 v105, v106, v107
  v_mfma_f32_16x16x32_bf16 v[72:75], v[236:239], a[56:59], v[72:75]
  v_permlane16_swap_b32 v100, v102
  v_mfma_f32_16x16x32_bf16 v[76:79], v[224:227], a[12:15], 0
  v_permlane16_swap_b32 v101, v103
  v_mfma_f32_16x16x32_bf16 v[76:79], v[228:231], a[28:31], v[76:79]
  v_cvt_pk_bf16_f32 v106, v120, v121
  v_mfma_f32_16x16x32_bf16 v[76:79], v[232:235], a[44:47], v[76:79]
  buffer_store_dwordx4 v[100:103], v17, s[48:51], s33 offen sc1
  v_cvt_pk_bf16_f32 v107, v122, v123
  v_mfma_f32_16x16x32_bf16 v[76:79], v[236:239], a[60:63], v[76:79]
  s_waitcnt vmcnt(18) lgkmcnt(0)
  s_barrier
  v_mfma_f32_16x16x32_bf16 v[80:83], v[240:243], a[0:3], 0
  ds_read_b64_tr_b16 v[224:225], v1 offset:16384
  s_add_u32 m0, s19, 0
  v_mfma_f32_16x16x32_bf16 v[80:83], v[244:247], a[16:19], v[80:83]
  ds_read_b64_tr_b16 v[226:227], v1 offset:16896
  s_add_u32 s21, s22, 512
  v_mfma_f32_16x16x32_bf16 v[80:83], v[248:251], a[32:35], v[80:83]
  ds_read_b64_tr_b16 v[228:229], v1 offset:20480
  v_mfma_f32_16x16x32_bf16 v[80:83], v[252:255], a[48:51], v[80:83]
  buffer_load_dwordx4 v5, s[12:15], s21 offen offset:0 lds
  v_mfma_f32_16x16x32_bf16 v[84:87], v[240:243], a[4:7], 0
  ds_read_b64_tr_b16 v[230:231], v1 offset:20992
  s_add_u32 s33, s33, s65
  v_mfma_f32_16x16x32_bf16 v[84:87], v[244:247], a[20:23], v[84:87]
  ds_read_b64_tr_b16 v[232:233], v1 offset:24576
  v_mul_f32 v108, s68, v108
  v_mfma_f32_16x16x32_bf16 v[84:87], v[248:251], a[36:39], v[84:87]
  ds_read_b64_tr_b16 v[234:235], v1 offset:25088
  v_mul_f32 v109, s68, v109
  v_mfma_f32_16x16x32_bf16 v[84:87], v[252:255], a[52:55], v[84:87]
  buffer_load_dwordx4 v6, s[12:15], s21 offen offset:1024 lds
  v_mul_f32 v110, s68, v110
  v_mfma_f32_16x16x32_bf16 v[88:91], v[240:243], a[8:11], 0
  ds_read_b64_tr_b16 v[236:237], v1 offset:28672
  v_mul_f32 v111, s68, v111
  v_mfma_f32_16x16x32_bf16 v[88:91], v[244:247], a[24:27], v[88:91]
  ds_read_b64_tr_b16 v[238:239], v1 offset:29184
  v_mul_f32 v124, s68, v124
  v_mfma_f32_16x16x32_bf16 v[88:91], v[248:251], a[40:43], v[88:91]
  v_mul_f32 v125, s68, v125
  v_mul_f32 v126, s68, v126
  v_mfma_f32_16x16x32_bf16 v[88:91], v[252:255], a[56:59], v[88:91]
  buffer_load_dwordx4 v7, s[12:15], s21 offen offset:2048 lds
  v_mul_f32 v127, s68, v127
  v_mfma_f32_16x16x32_bf16 v[92:95], v[240:243], a[12:15], 0
  v_cvt_pk_bf16_f32 v108, v108, v109
  v_cvt_pk_bf16_f32 v109, v110, v111
  v_mfma_f32_16x16x32_bf16 v[92:95], v[244:247], a[28:31], v[92:95]
  v_permlane16_swap_b32 v104, v106
  v_mfma_f32_16x16x32_bf16 v[92:95], v[248:251], a[44:47], v[92:95]
  v_permlane16_swap_b32 v105, v107
  v_mfma_f32_16x16x32_bf16 v[92:95], v[252:255], a[60:63], v[92:95]
  buffer_load_dwordx4 v8, s[12:15], s21 offen offset:3072 lds
  s_waitcnt lgkmcnt(0)
  v_mfma_f32_16x16x32_bf16 v[32:35], v[224:227], a[64:67], v[32:35]
  ds_read_b64_tr_b16 v[240:241], v2 offset:16384
  v_mfma_f32_16x16x32_bf16 v[32:35], v[228:231], a[80:83], v[32:35]
  ds_read_b64_tr_b16 v[242:243], v2 offset:16896
  v_mfma_f32_16x16x32_bf16 v[32:35], v[232:235], a[96:99], v[32:35]
  ds_read_b64_tr_b16 v[244:245], v2 offset:20480
  v_cvt_pk_bf16_f32 v110, v124, v125
  v_mfma_f32_16x16x32_bf16 v[32:35], v[236:239], a[112:115], v[32:35]
  buffer_store_dwordx4 v[104:107], v17, s[48:51], s34 offen sc1
  v_cvt_pk_bf16_f32 v111, v126, v127
  v_mfma_f32_16x16x32_bf16 v[36:39], v[224:227], a[68:71], v[36:39]
  ds_read_b64_tr_b16 v[246:247], v2 offset:20992
  v_mfma_f32_16x16x32_bf16 v[36:39], v[228:231], a[84:87], v[36:39]
  ds_read_b64_tr_b16 v[248:249], v2 offset:24576
  v_mfma_f32_16x16x32_bf16 v[36:39], v[232:235], a[100:103], v[36:39]
  ds_read_b64_tr_b16 v[250:251], v2 offset:25088
  v_mfma_f32_16x16x32_bf16 v[36:39], v[236:239], a[116:119], v[36:39]
  s_add_u32 s34, s34, s65
  v_mul_f32 v128, s68, v128
  v_mul_f32 v129, s68, v129
  v_mfma_f32_16x16x32_bf16 v[40:43], v[224:227], a[72:75], v[40:43]
  ds_read_b64_tr_b16 v[252:253], v2 offset:28672
  v_mul_f32 v130, s68, v130
  v_mfma_f32_16x16x32_bf16 v[40:43], v[228:231], a[88:91], v[40:43]
  ds_read_b64_tr_b16 v[254:255], v2 offset:29184
  v_mul_f32 v131, s68, v131
  v_mfma_f32_16x16x32_bf16 v[40:43], v[232:235], a[104:107], v[40:43]
  v_mul_f32 v144, s68, v144
  v_mul_f32 v145, s68, v145
  v_mfma_f32_16x16x32_bf16 v[40:43], v[236:239], a[120:123], v[40:43]
  v_mul_f32 v146, s68, v146
  v_mul_f32 v147, s68, v147
  v_mfma_f32_16x16x32_bf16 v[44:47], v[224:227], a[76:79], v[44:47]
  v_cvt_pk_bf16_f32 v128, v128, v129
  v_cvt_pk_bf16_f32 v129, v130, v131
  v_mfma_f32_16x16x32_bf16 v[44:47], v[228:231], a[92:95], v[44:47]
  v_permlane16_swap_b32 v108, v110
  v_mfma_f32_16x16x32_bf16 v[44:47], v[232:235], a[108:111], v[44:47]
  v_permlane16_swap_b32 v109, v111
  v_mfma_f32_16x16x32_bf16 v[44:47], v[236:239], a[124:127], v[44:47]
  s_waitcnt lgkmcnt(0)
  v_mfma_f32_16x16x32_bf16 v[48:51], v[240:243], a[64:67], v[48:51]
  ds_read_b64_tr_b16 v[224:225], v3 offset:16384
  v_mfma_f32_16x16x32_bf16 v[48:51], v[244:247], a[80:83], v[48:51]
  ds_read_b64_tr_b16 v[226:227], v3 offset:16896
  v_mfma_f32_16x16x32_bf16 v[48:51], v[248:251], a[96:99], v[48:51]
  ds_read_b64_tr_b16 v[228:229], v3 offset:20480
  v_cvt_pk_bf16_f32 v130, v144, v145
  v_mfma_f32_16x16x32_bf16 v[48:51], v[252:255], a[112:115], v[48:51]
  buffer_store_dwordx4 v[108:111], v17, s[48:51], s35 offen sc1
  v_cvt_pk_bf16_f32 v131, v146, v147
  v_mfma_f32_16x16x32_bf16 v[52:55], v[240:243], a[68:71], v[52:55]
  ds_read_b64_tr_b16 v[230:231], v3 offset:20992
  v_mfma_f32_16x16x32_bf16 v[52:55], v[244:247], a[84:87], v[52:55]
  ds_read_b64_tr_b16 v[232:233], v3 offset:24576
  v_mfma_f32_16x16x32_bf16 v[52:55], v[248:251], a[100:103], v[52:55]
  ds_read_b64_tr_b16 v[234:235], v3 offset:25088
  v_mfma_f32_16x16x32_bf16 v[52:55], v[252:255], a[116:119], v[52:55]
  s_add_u32 s35, s35, s65
  v_mul_f32 v132, s68, v132
  v_mul_f32 v133, s68, v133
  v_mfma_f32_16x16x32_bf16 v[56:59], v[240:243], a[72:75], v[56:59]
  ds_read_b64_tr_b16 v[236:237], v3 offset:28672
  v_mul_f32 v134, s68, v134
  v_mfma_f32_16x16x32_bf16 v[56:59], v[244:247], a[88:91], v[56:59]
  ds_read_b64_tr_b16 v[238:239], v3 offset:29184
  v_mul_f32 v135, s68, v135
  v_mfma_f32_16x16x32_bf16 v[56:59], v[248:251], a[104:107], v[56:59]
  v_mul_f32 v148, s68, v148
  v_mul_f32 v149, s68, v149
  v_mfma_f32_16x16x32_bf16 v[56:59], v[252:255], a[120:123], v[56:59]
  v_mul_f32 v150, s68, v150
  v_mul_f32 v151, s68, v151
  v_mfma_f32_16x16x32_bf16 v[60:63], v[240:243], a[76:79], v[60:63]
  v_cvt_pk_bf16_f32 v132, v132, v133
  v_cvt_pk_bf16_f32 v133, v134, v135
  v_mfma_f32_16x16x32_bf16 v[60:63], v[244:247], a[92:95], v[60:63]
  v_permlane16_swap_b32 v128, v130
  v_mfma_f32_16x16x32_bf16 v[60:63], v[248:251], a[108:111], v[60:63]
  v_permlane16_swap_b32 v129, v131
  v_mfma_f32_16x16x32_bf16 v[60:63], v[252:255], a[124:127], v[60:63]
  s_waitcnt lgkmcnt(0)
  v_mfma_f32_16x16x32_bf16 v[64:67], v[224:227], a[64:67], v[64:67]
  ds_read_b64_tr_b16 v[240:241], v4 offset:16384
  v_mfma_f32_16x16x32_bf16 v[64:67], v[228:231], a[80:83], v[64:67]
  ds_read_b64_tr_b16 v[242:243], v4 offset:16896
  v_mfma_f32_16x16x32_bf16 v[64:67], v[232:235], a[96:99], v[64:67]
  ds_read_b64_tr_b16 v[244:245], v4 offset:20480
  v_cvt_pk_bf16_f32 v134, v148, v149
  v_mfma_f32_16x16x32_bf16 v[64:67], v[236:239], a[112:115], v[64:67]
  buffer_store_dwordx4 v[128:131], v17, s[48:51], s32 offen sc1
  v_cvt_pk_bf16_f32 v135, v150, v151
  v_mfma_f32_16x16x32_bf16 v[68:71], v[224:227], a[68:71], v[68:71]
  ds_read_b64_tr_b16 v[246:247], v4 offset:20992
  v_mfma_f32_16x16x32_bf16 v[68:71], v[228:231], a[84:87], v[68:71]
  ds_read_b64_tr_b16 v[248:249], v4 offset:24576
  v_mfma_f32_16x16x32_bf16 v[68:71], v[232:235], a[100:103], v[68:71]
  ds_read_b64_tr_b16 v[250:251], v4 offset:25088
  v_mfma_f32_16x16x32_bf16 v[68:71], v[236:239], a[116:119], v[68:71]
  v_mul_f32 v136, s68, v136
  v_mul_f32 v137, s68, v137
  v_mfma_f32_16x16x32_bf16 v[72:75], v[224:227], a[72:75], v[72:75]
  ds_read_b64_tr_b16 v[252:253], v4 offset:28672
  v_mul_f32 v138, s68, v138
  v_mfma_f32_16x16x32_bf16 v[72:75], v[228:231], a[88:91], v[72:75]
  ds_read_b64_tr_b16 v[254:255], v4 offset:29184
  v_mul_f32 v139, s68, v139
  v_mfma_f32_16x16x32_bf16 v[72:75], v[232:235], a[104:107], v[72:75]
  v_mul_f32 v152, s68, v152
  v_mul_f32 v153, s68, v153
  v_mfma_f32_16x16x32_bf16 v[72:75], v[236:239], a[120:123], v[72:75]
  v_mul_f32 v154, s68, v154
  v_mul_f32 v155, s68, v155
  v_mfma_f32_16x16x32_bf16 v[76:79], v[224:227], a[76:79], v[76:79]
  v_cvt_pk_bf16_f32 v136, v136, v137
  v_cvt_pk_bf16_f32 v137, v138, v139
  v_mfma_f32_16x16x32_bf16 v[76:79], v[228:231], a[92:95], v[76:79]
  v_permlane16_swap_b32 v132, v134
  v_mfma_f32_16x16x32_bf16 v[76:79], v[232:235], a[108:111], v[76:79]
  v_permlane16_swap_b32 v133, v135
  v_mfma_f32_16x16x32_bf16 v[76:79], v[236:239], a[124:127], v[76:79]
  s_waitcnt vmcnt(18) lgkmcnt(0)
  s_barrier
  v_mfma_f32_16x16x32_bf16 v[80:83], v[240:243], a[64:67], v[80:83]
  ds_read_b64_tr_b16 v[224:225], v1 offset:32768
  s_add_u32 m0, s19, 16384
  v_mfma_f32_16x16x32_bf16 v[80:83], v[244:247], a[80:83], v[80:83]
  ds_read_b64_tr_b16 v[226:227], v1 offset:33280
  s_add_u32 s21, s23, 512
  v_mfma_f32_16x16x32_bf16 v[80:83], v[248:251], a[96:99], v[80:83]
  ds_read_b64_tr_b16 v[228:229], v1 offset:36864
  v_mfma_f32_16x16x32_bf16 v[80:83], v[252:255], a[112:115], v[80:83]
  buffer_load_dwordx4 v5, s[12:15], s21 offen offset:0 lds
  v_mfma_f32_16x16x32_bf16 v[84:87], v[240:243], a[68:71], v[84:87]
  ds_read_b64_tr_b16 v[230:231], v1 offset:37376
  v_mfma_f32_16x16x32_bf16 v[84:87], v[244:247], a[84:87], v[84:87]
  ds_read_b64_tr_b16 v[232:233], v1 offset:40960
  v_mfma_f32_16x16x32_bf16 v[84:87], v[248:251], a[100:103], v[84:87]
  ds_read_b64_tr_b16 v[234:235], v1 offset:41472
  v_mfma_f32_16x16x32_bf16 v[84:87], v[252:255], a[116:119], v[84:87]
  buffer_load_dwordx4 v6, s[12:15], s21 offen offset:1024 lds
  v_mfma_f32_16x16x32_bf16 v[88:91], v[240:243], a[72:75], v[88:91]
  ds_read_b64_tr_b16 v[236:237], v1 offset:45056
  v_mfma_f32_16x16x32_bf16 v[88:91], v[244:247], a[88:91], v[88:91]
  ds_read_b64_tr_b16 v[238:239], v1 offset:45568
  v_cvt_pk_bf16_f32 v138, v152, v153
  v_mfma_f32_16x16x32_bf16 v[88:91], v[248:251], a[104:107], v[88:91]
  buffer_store_dwordx4 v[132:135], v17, s[48:51], s33 offen sc1
  v_cvt_pk_bf16_f32 v139, v154, v155
  v_mfma_f32_16x16x32_bf16 v[88:91], v[252:255], a[120:123], v[88:91]
  buffer_load_dwordx4 v7, s[12:15], s21 offen offset:2048 lds
  v_mul_f32 v140, s68, v140
  v_mfma_f32_16x16x32_bf16 v[92:95], v[240:243], a[76:79], v[92:95]
  v_mul_f32 v141, s68, v141
  v_mul_f32 v142, s68, v142
  v_mfma_f32_16x16x32_bf16 v[92:95], v[244:247], a[92:95], v[92:95]
  v_mul_f32 v143, s68, v143
  v_mul_f32 v156, s68, v156
  v_mfma_f32_16x16x32_bf16 v[92:95], v[248:251], a[108:111], v[92:95]
  v_mul_f32 v157, s68, v157
  v_mul_f32 v158, s68, v158
  v_mfma_f32_16x16x32_bf16 v[92:95], v[252:255], a[124:127], v[92:95]
  buffer_load_dwordx4 v8, s[12:15], s21 offen offset:3072 lds
  s_waitcnt lgkmcnt(0)
  v_mfma_f32_16x16x32_bf16 v[32:35], v[224:227], a[128:131], v[32:35]
  ds_read_b64_tr_b16 v[240:241], v2 offset:32768
  v_mul_f32 v159, s68, v159
  v_mfma_f32_16x16x32_bf16 v[32:35], v[228:231], a[144:147], v[32:35]
  ds_read_b64_tr_b16 v[242:243], v2 offset:33280
  v_cvt_pk_bf16_f32 v140, v140, v141
  v_mfma_f32_16x16x32_bf16 v[32:35], v[232:235], a[160:163], v[32:35]
  ds_read_b64_tr_b16 v[244:245], v2 offset:36864
  v_cvt_pk_bf16_f32 v141, v142, v143
  v_mfma_f32_16x16x32_bf16 v[32:35], v[236:239], a[176:179], v[32:35]
  v_permlane16_swap_b32 v136, v138
  v_mfma_f32_16x16x32_bf16 v[36:39], v[224:227], a[132:135], v[36:39]
  ds_read_b64_tr_b16 v[246:247], v2 offset:37376
  v_mfma_f32_16x16x32_bf16 v[36:39], v[228:231], a[148:151], v[36:39]
  ds_read_b64_tr_b16 v[248:249], v2 offset:40960
  v_mfma_f32_16x16x32_bf16 v[36:39], v[232:235], a[164:167], v[36:39]
  ds_read_b64_tr_b16 v[250:251], v2 offset:41472
  v_mfma_f32_16x16x32_bf16 v[36:39], v[236:239], a[180:183], v[36:39]
  v_permlane16_swap_b32 v137, v139
  v_mfma_f32_16x16x32_bf16 v[40:43], v[224:227], a[136:139], v[40:43]
  ds_read_b64_tr_b16 v[252:253], v2 offset:45056
  v_mfma_f32_16x16x32_bf16 v[40:43], v[228:231], a[152:155], v[40:43]
  ds_read_b64_tr_b16 v[254:255], v2 offset:45568
  v_mfma_f32_16x16x32_bf16 v[40:43], v[232:235], a[168:171], v[40:43]
  v_cvt_pk_bf16_f32 v142, v156, v157
  v_mfma_f32_16x16x32_bf16 v[40:43], v[236:239], a[184:187], v[40:43]
  buffer_store_dwordx4 v[136:139], v17, s[48:51], s34 offen sc1
  v_cvt_pk_bf16_f32 v143, v158, v159
  v_mfma_f32_16x16x32_bf16 v[44:47], v[224:227], a[140:143], v[44:47]
  s_nop 1
  v_mfma_f32_16x16x32_bf16 v[44:47], v[228:231], a[156:159], v[44:47]
  v_permlane16_swap_b32 v140, v142
  v_mfma_f32_16x16x32_bf16 v[44:47], v[232:235], a[172:175], v[44:47]
  v_permlane16_swap_b32 v141, v143
  v_mfma_f32_16x16x32_bf16 v[44:47], v[236:239], a[188:191], v[44:47]
  s_waitcnt lgkmcnt(0)
  v_mfma_f32_16x16x32_bf16 v[48:51], v[240:243], a[128:131], v[48:51]
  ds_read_b64_tr_b16 v[224:225], v3 offset:32768
  v_mfma_f32_16x16x32_bf16 v[48:51], v[244:247], a[144:147], v[48:51]
  ds_read_b64_tr_b16 v[226:227], v3 offset:33280
  v_mfma_f32_16x16x32_bf16 v[48:51], v[248:251], a[160:163], v[48:51]
  ds_read_b64_tr_b16 v[228:229], v3 offset:36864
  v_mfma_f32_16x16x32_bf16 v[48:51], v[252:255], a[176:179], v[48:51]
  buffer_store_dwordx4 v[140:143], v17, s[48:51], s35 offen sc1
  v_mfma_f32_16x16x32_bf16 v[52:55], v[240:243], a[132:135], v[52:55]
  ds_read_b64_tr_b16 v[230:231], v3 offset:37376
  v_mfma_f32_16x16x32_bf16 v[52:55], v[244:247], a[148:151], v[52:55]
  ds_read_b64_tr_b16 v[232:233], v3 offset:40960
  v_mfma_f32_16x16x32_bf16 v[52:55], v[248:251], a[164:167], v[52:55]
  ds_read_b64_tr_b16 v[234:235], v3 offset:41472
  v_mfma_f32_16x16x32_bf16 v[52:55], v[252:255], a[180:183], v[52:55]
  s_lshr_b32 s29, s27, 1
  s_mul_i32 s32, s29, s70
  s_and_b32 s29, s27, 1
  v_mfma_f32_16x16x32_bf16 v[56:59], v[240:243], a[136:139], v[56:59]
  ds_read_b64_tr_b16 v[236:237], v3 offset:45056
  s_mul_i32 s29, s29, s71
  v_mfma_f32_16x16x32_bf16 v[56:59], v[244:247], a[152:155], v[56:59]
  ds_read_b64_tr_b16 v[238:239], v3 offset:45568
  s_add_u32 s32, s32, s29
  v_mfma_f32_16x16x32_bf16 v[56:59], v[248:251], a[168:171], v[56:59]
  s_add_u32 s32, s32, s36
  s_add_u32 s27, s27, 1
  s_add_u32 s33, s32, s67
  v_mfma_f32_16x16x32_bf16 v[56:59], v[252:255], a[184:187], v[56:59]
  s_add_u32 s34, s32, s66
  s_add_u32 s35, s34, s67
  v_mul_f32 v160, s68, v160
  v_mfma_f32_16x16x32_bf16 v[60:63], v[240:243], a[140:143], v[60:63]
  v_mul_f32 v161, s68, v161
  v_mul_f32 v162, s68, v162
  v_mfma_f32_16x16x32_bf16 v[60:63], v[244:247], a[156:159], v[60:63]
  v_mul_f32 v163, s68, v163
  v_mul_f32 v176, s68, v176
  v_mfma_f32_16x16x32_bf16 v[60:63], v[248:251], a[172:175], v[60:63]
  v_mul_f32 v177, s68, v177
  v_mul_f32 v178, s68, v178
  v_mfma_f32_16x16x32_bf16 v[60:63], v[252:255], a[188:191], v[60:63]
  v_mul_f32 v179, s68, v179
  s_waitcnt lgkmcnt(0)
  v_mfma_f32_16x16x32_bf16 v[64:67], v[224:227], a[128:131], v[64:67]
  ds_read_b64_tr_b16 v[240:241], v4 offset:32768
  v_cvt_pk_bf16_f32 v160, v160, v161
  v_mfma_f32_16x16x32_bf16 v[64:67], v[228:231], a[144:147], v[64:67]
  ds_read_b64_tr_b16 v[242:243], v4 offset:33280
  v_cvt_pk_bf16_f32 v161, v162, v163
  v_mfma_f32_16x16x32_bf16 v[64:67], v[232:235], a[160:163], v[64:67]
  ds_read_b64_tr_b16 v[244:245], v4 offset:36864
  v_cvt_pk_bf16_f32 v162, v176, v177
  v_mfma_f32_16x16x32_bf16 v[64:67], v[236:239], a[176:179], v[64:67]
  v_cvt_pk_bf16_f32 v163, v178, v179
  v_mul_f32 v164, s68, v164
  v_mfma_f32_16x16x32_bf16 v[68:71], v[224:227], a[132:135], v[68:71]
  ds_read_b64_tr_b16 v[246:247], v4 offset:37376
  v_mul_f32 v165, s68, v165
  v_mfma_f32_16x16x32_bf16 v[68:71], v[228:231], a[148:151], v[68:71]
  ds_read_b64_tr_b16 v[248:249], v4 offset:40960
  v_mul_f32 v166, s68, v166
  v_mfma_f32_16x16x32_bf16 v[68:71], v[232:235], a[164:167], v[68:71]
  ds_read_b64_tr_b16 v[250:251], v4 offset:41472
  v_mul_f32 v167, s68, v167
  v_mfma_f32_16x16x32_bf16 v[68:71], v[236:239], a[180:183], v[68:71]
  v_mul_f32 v180, s68, v180
  v_mul_f32 v181, s68, v181
  v_mfma_f32_16x16x32_bf16 v[72:75], v[224:227], a[136:139], v[72:75]
  ds_read_b64_tr_b16 v[252:253], v4 offset:45056
  v_mul_f32 v182, s68, v182
  v_mfma_f32_16x16x32_bf16 v[72:75], v[228:231], a[152:155], v[72:75]
  ds_read_b64_tr_b16 v[254:255], v4 offset:45568
  v_mul_f32 v183, s68, v183
  v_mfma_f32_16x16x32_bf16 v[72:75], v[232:235], a[168:171], v[72:75]
  v_cvt_pk_bf16_f32 v164, v164, v165
  v_cvt_pk_bf16_f32 v165, v166, v167
  v_mfma_f32_16x16x32_bf16 v[72:75], v[236:239], a[184:187], v[72:75]
  v_permlane16_swap_b32 v160, v162
  v_mfma_f32_16x16x32_bf16 v[76:79], v[224:227], a[140:143], v[76:79]
  v_permlane16_swap_b32 v161, v163
  v_mfma_f32_16x16x32_bf16 v[76:79], v[228:231], a[156:159], v[76:79]
  v_cvt_pk_bf16_f32 v166, v180, v181
  v_mfma_f32_16x16x32_bf16 v[76:79], v[232:235], a[172:175], v[76:79]
  buffer_store_dwordx4 v[160:163], v17, s[48:51], s32 offen sc1
  v_cvt_pk_bf16_f32 v167, v182, v183
  v_mfma_f32_16x16x32_bf16 v[76:79], v[236:239], a[188:191], v[76:79]
  s_waitcnt vmcnt(17) lgkmcnt(0)
  s_barrier
  v_mfma_f32_16x16x32_bf16 v[80:83], v[240:243], a[128:131], v[80:83]
  ds_read_b64_tr_b16 v[224:225], v1 offset:49152
  s_add_u32 m0, s19, 32768
  v_mfma_f32_16x16x32_bf16 v[80:83], v[244:247], a[144:147], v[80:83]
  ds_read_b64_tr_b16 v[226:227], v1 offset:49664
  s_add_u32 s21, s24, 512
  v_mfma_f32_16x16x32_bf16 v[80:83], v[248:251], a[160:163], v[80:83]
  ds_read_b64_tr_b16 v[228:229], v1 offset:53248
  v_mfma_f32_16x16x32_bf16 v[80:83], v[252:255], a[176:179], v[80:83]
  buffer_load_dwordx4 v5, s[12:15], s21 offen offset:0 lds
  v_mfma_f32_16x16x32_bf16 v[84:87], v[240:243], a[132:135], v[84:87]
  ds_read_b64_tr_b16 v[230:231], v1 offset:53760
  s_add_u32 s32, s32, s65
  v_mfma_f32_16x16x32_bf16 v[84:87], v[244:247], a[148:151], v[84:87]
  ds_read_b64_tr_b16 v[232:233], v1 offset:57344
  v_mul_f32 v168, s68, v168
  v_mfma_f32_16x16x32_bf16 v[84:87], v[248:251], a[164:167], v[84:87]
  ds_read_b64_tr_b16 v[234:235], v1 offset:57856
  v_mul_f32 v169, s68, v169
  v_mfma_f32_16x16x32_bf16 v[84:87], v[252:255], a[180:183], v[84:87]
  buffer_load_dwordx4 v6, s[12:15], s21 offen offset:1024 lds
  v_mul_f32 v170, s68, v170
  v_mfma_f32_16x16x32_bf16 v[88:91], v[240:243], a[136:139], v[88:91]
  ds_read_b64_tr_b16 v[236:237], v1 offset:61440
  v_mul_f32 v171, s68, v171
  v_mfma_f32_16x16x32_bf16 v[88:91], v[244:247], a[152:155], v[88:91]
  ds_read_b64_tr_b16 v[238:239], v1 offset:61952
  v_mul_f32 v184, s68, v184
  v_mfma_f32_16x16x32_bf16 v[88:91], v[248:251], a[168:171], v[88:91]
  v_mul_f32 v185, s68, v185
  v_mul_f32 v186, s68, v186
  v_mfma_f32_16x16x32_bf16 v[88:91], v[252:255], a[184:187], v[88:91]
  buffer_load_dwordx4 v7, s[12:15], s21 offen offset:2048 lds
  v_mul_f32 v187, s68, v187
  v_mfma_f32_16x16x32_bf16 v[92:95], v[240:243], a[140:143], v[92:95]
  v_cvt_pk_bf16_f32 v168, v168, v169
  v_cvt_pk_bf16_f32 v169, v170, v171
  v_mfma_f32_16x16x32_bf16 v[92:95], v[244:247], a[156:159], v[92:95]
  v_permlane16_swap_b32 v164, v166
  v_mfma_f32_16x16x32_bf16 v[92:95], v[248:251], a[172:175], v[92:95]
  v_permlane16_swap_b32 v165, v167
  v_mfma_f32_16x16x32_bf16 v[92:95], v[252:255], a[188:191], v[92:95]
  buffer_load_dwordx4 v8, s[12:15], s21 offen offset:3072 lds
  s_waitcnt lgkmcnt(0)
  v_mfma_f32_16x16x32_bf16 v[32:35], v[224:227], a[192:195], v[32:35]
  ds_read_b64_tr_b16 v[240:241], v2 offset:49152
  v_mfma_f32_16x16x32_bf16 v[32:35], v[228:231], a[208:211], v[32:35]
  ds_read_b64_tr_b16 v[242:243], v2 offset:49664
  v_mfma_f32_16x16x32_bf16 v[32:35], v[232:235], a[224:227], v[32:35]
  ds_read_b64_tr_b16 v[244:245], v2 offset:53248
  v_cvt_pk_bf16_f32 v170, v184, v185
  v_mfma_f32_16x16x32_bf16 v[32:35], v[236:239], a[240:243], v[32:35]
  buffer_store_dwordx4 v[164:167], v17, s[48:51], s33 offen sc1
  v_cvt_pk_bf16_f32 v171, v186, v187
  v_mfma_f32_16x16x32_bf16 v[36:39], v[224:227], a[196:199], v[36:39]
  ds_read_b64_tr_b16 v[246:247], v2 offset:53760
  v_mfma_f32_16x16x32_bf16 v[36:39], v[228:231], a[212:215], v[36:39]
  ds_read_b64_tr_b16 v[248:249], v2 offset:57344
  v_mfma_f32_16x16x32_bf16 v[36:39], v[232:235], a[228:231], v[36:39]
  ds_read_b64_tr_b16 v[250:251], v2 offset:57856
  v_mfma_f32_16x16x32_bf16 v[36:39], v[236:239], a[244:247], v[36:39]
  s_add_u32 s33, s33, s65
  v_mul_f32 v172, s68, v172
  v_mul_f32 v173, s68, v173
  v_mfma_f32_16x16x32_bf16 v[40:43], v[224:227], a[200:203], v[40:43]
  ds_read_b64_tr_b16 v[252:253], v2 offset:61440
  v_mul_f32 v174, s68, v174
  v_mfma_f32_16x16x32_bf16 v[40:43], v[228:231], a[216:219], v[40:43]
  ds_read_b64_tr_b16 v[254:255], v2 offset:61952
  v_mul_f32 v175, s68, v175
  v_mfma_f32_16x16x32_bf16 v[40:43], v[232:235], a[232:235], v[40:43]
  v_mul_f32 v188, s68, v188
  v_mul_f32 v189, s68, v189
  v_mfma_f32_16x16x32_bf16 v[40:43], v[236:239], a[248:251], v[40:43]
  v_mul_f32 v190, s68, v190
  v_mul_f32 v191, s68, v191
  v_mfma_f32_16x16x32_bf16 v[44:47], v[224:227], a[204:207], v[44:47]
  v_cvt_pk_bf16_f32 v172, v172, v173
  v_cvt_pk_bf16_f32 v173, v174, v175
  v_mfma_f32_16x16x32_bf16 v[44:47], v[228:231], a[220:223], v[44:47]
  v_permlane16_swap_b32 v168, v170
  v_mfma_f32_16x16x32_bf16 v[44:47], v[232:235], a[236:239], v[44:47]
  v_permlane16_swap_b32 v169, v171
  v_mfma_f32_16x16x32_bf16 v[44:47], v[236:239], a[252:255], v[44:47]
  s_waitcnt lgkmcnt(0)
  v_mfma_f32_16x16x32_bf16 v[48:51], v[240:243], a[192:195], v[48:51]
  ds_read_b64_tr_b16 v[224:225], v3 offset:49152
  v_mfma_f32_16x16x32_bf16 v[48:51], v[244:247], a[208:211], v[48:51]
  ds_read_b64_tr_b16 v[226:227], v3 offset:49664
  v_mfma_f32_16x16x32_bf16 v[48:51], v[248:251], a[224:227], v[48:51]
  ds_read_b64_tr_b16 v[228:229], v3 offset:53248
  v_cvt_pk_bf16_f32 v174, v188, v189
  v_mfma_f32_16x16x32_bf16 v[48:51], v[252:255], a[240:243], v[48:51]
  buffer_store_dwordx4 v[168:171], v17, s[48:51], s34 offen sc1
  v_cvt_pk_bf16_f32 v175, v190, v191
  v_mfma_f32_16x16x32_bf16 v[52:55], v[240:243], a[196:199], v[52:55]
  ds_read_b64_tr_b16 v[230:231], v3 offset:53760
  s_add_u32 s34, s34, s65
  v_mfma_f32_16x16x32_bf16 v[52:55], v[244:247], a[212:215], v[52:55]
  ds_read_b64_tr_b16 v[232:233], v3 offset:57344
  v_mul_f32 v192, s68, v192
  v_mfma_f32_16x16x32_bf16 v[52:55], v[248:251], a[228:231], v[52:55]
  ds_read_b64_tr_b16 v[234:235], v3 offset:57856
  v_mul_f32 v193, s68, v193
  v_mfma_f32_16x16x32_bf16 v[52:55], v[252:255], a[244:247], v[52:55]
  v_mul_f32 v194, s68, v194
  v_mul_f32 v195, s68, v195
  v_mfma_f32_16x16x32_bf16 v[56:59], v[240:243], a[200:203], v[56:59]
  ds_read_b64_tr_b16 v[236:237], v3 offset:61440
  v_mul_f32 v208, s68, v208
  v_mfma_f32_16x16x32_bf16 v[56:59], v[244:247], a[216:219], v[56:59]
  ds_read_b64_tr_b16 v[238:239], v3 offset:61952
  v_mul_f32 v209, s68, v209
  v_mfma_f32_16x16x32_bf16 v[56:59], v[248:251], a[232:235], v[56:59]
  v_mul_f32 v210, s68, v210
  v_mul_f32 v211, s68, v211
  v_mfma_f32_16x16x32_bf16 v[56:59], v[252:255], a[248:251], v[56:59]
  v_cvt_pk_bf16_f32 v192, v192, v193
  v_cvt_pk_bf16_f32 v193, v194, v195
  v_mfma_f32_16x16x32_bf16 v[60:63], v[240:243], a[204:207], v[60:63]
  v_permlane16_swap_b32 v172, v174
  v_mfma_f32_16x16x32_bf16 v[60:63], v[244:247], a[220:223], v[60:63]
  v_permlane16_swap_b32 v173, v175
  v_mfma_f32_16x16x32_bf16 v[60:63], v[248:251], a[236:239], v[60:63]
  v_cvt_pk_bf16_f32 v194, v208, v209
  v_cvt_pk_bf16_f32 v195, v210, v211
  v_mfma_f32_16x16x32_bf16 v[60:63], v[252:255], a[252:255], v[60:63]
  buffer_store_dwordx4 v[172:175], v17, s[48:51], s35 offen sc1
  s_waitcnt lgkmcnt(0)
  v_mfma_f32_16x16x32_bf16 v[64:67], v[224:227], a[192:195], v[64:67]
  ds_read_b64_tr_b16 v[240:241], v4 offset:49152
  v_mfma_f32_16x16x32_bf16 v[64:67], v[228:231], a[208:211], v[64:67]
  ds_read_b64_tr_b16 v[242:243], v4 offset:49664
  s_add_u32 s35, s35, s65
  v_mfma_f32_16x16x32_bf16 v[64:67], v[232:235], a[224:227], v[64:67]
  ds_read_b64_tr_b16 v[244:245], v4 offset:53248
  v_mul_f32 v196, s68, v196
  v_mfma_f32_16x16x32_bf16 v[64:67], v[236:239], a[240:243], v[64:67]
  v_mul_f32 v197, s68, v197
  v_mul_f32 v198, s68, v198
  v_mfma_f32_16x16x32_bf16 v[68:71], v[224:227], a[196:199], v[68:71]
  ds_read_b64_tr_b16 v[246:247], v4 offset:53760
  v_mul_f32 v199, s68, v199
  v_mfma_f32_16x16x32_bf16 v[68:71], v[228:231], a[212:215], v[68:71]
  ds_read_b64_tr_b16 v[248:249], v4 offset:57344
  v_mul_f32 v212, s68, v212
  v_mfma_f32_16x16x32_bf16 v[68:71], v[232:235], a[228:231], v[68:71]
  ds_read_b64_tr_b16 v[250:251], v4 offset:57856
  v_mul_f32 v213, s68, v213
  v_mfma_f32_16x16x32_bf16 v[68:71], v[236:239], a[244:247], v[68:71]
  v_mul_f32 v214, s68, v214
  v_mul_f32 v215, s68, v215
  v_mfma_f32_16x16x32_bf16 v[72:75], v[224:227], a[200:203], v[72:75]
  ds_read_b64_tr_b16 v[252:253], v4 offset:61440
  v_cvt_pk_bf16_f32 v196, v196, v197
  v_mfma_f32_16x16x32_bf16 v[72:75], v[228:231], a[216:219], v[72:75]
  ds_read_b64_tr_b16 v[254:255], v4 offset:61952
  v_cvt_pk_bf16_f32 v197, v198, v199
  v_mfma_f32_16x16x32_bf16 v[72:75], v[232:235], a[232:235], v[72:75]
  v_permlane16_swap_b32 v192, v194
  v_mfma_f32_16x16x32_bf16 v[72:75], v[236:239], a[248:251], v[72:75]
  v_permlane16_swap_b32 v193, v195
  v_mfma_f32_16x16x32_bf16 v[76:79], v[224:227], a[204:207], v[76:79]
  v_cvt_pk_bf16_f32 v198, v212, v213
  v_mfma_f32_16x16x32_bf16 v[76:79], v[228:231], a[220:223], v[76:79]
  buffer_store_dwordx4 v[192:195], v17, s[48:51], s32 offen sc1
  v_cvt_pk_bf16_f32 v199, v214, v215
  v_mfma_f32_16x16x32_bf16 v[76:79], v[232:235], a[236:239], v[76:79]
  v_mul_f32 v200, s68, v200
  v_mul_f32 v201, s68, v201
  v_mfma_f32_16x16x32_bf16 v[76:79], v[236:239], a[252:255], v[76:79]
  s_waitcnt vmcnt(19) lgkmcnt(0)
  s_barrier
  v_mfma_f32_16x16x32_bf16 v[80:83], v[240:243], a[192:195], v[80:83]
  ds_read_b64_tr_b16 v[224:225], v1 offset:0
  s_add_u32 m0, s19, 49152
  v_mfma_f32_16x16x32_bf16 v[80:83], v[244:247], a[208:211], v[80:83]
  ds_read_b64_tr_b16 v[226:227], v1 offset:512
  s_add_u32 s21, s38, 512
  v_mfma_f32_16x16x32_bf16 v[80:83], v[248:251], a[224:227], v[80:83]
  ds_read_b64_tr_b16 v[228:229], v1 offset:4096
  v_mul_f32 v202, s68, v202
  v_mfma_f32_16x16x32_bf16 v[80:83], v[252:255], a[240:243], v[80:83]
  buffer_load_dwordx4 v5, s[12:15], s21 offen offset:0 lds
  v_mul_f32 v203, s68, v203
  v_mfma_f32_16x16x32_bf16 v[84:87], v[240:243], a[196:199], v[84:87]
  ds_read_b64_tr_b16 v[230:231], v1 offset:4608
  v_mul_f32 v216, s68, v216
  v_mfma_f32_16x16x32_bf16 v[84:87], v[244:247], a[212:215], v[84:87]
  ds_read_b64_tr_b16 v[232:233], v1 offset:8192
  v_mul_f32 v217, s68, v217
  v_mfma_f32_16x16x32_bf16 v[84:87], v[248:251], a[228:231], v[84:87]
  ds_read_b64_tr_b16 v[234:235], v1 offset:8704
  v_mul_f32 v218, s68, v218
  v_mfma_f32_16x16x32_bf16 v[84:87], v[252:255], a[244:247], v[84:87]
  buffer_load_dwordx4 v6, s[12:15], s21 offen offset:1024 lds
  v_mul_f32 v219, s68, v219
  v_mfma_f32_16x16x32_bf16 v[88:91], v[240:243], a[200:203], v[88:91]
  ds_read_b64_tr_b16 v[236:237], v1 offset:12288
  v_cvt_pk_bf16_f32 v200, v200, v201
  v_mfma_f32_16x16x32_bf16 v[88:91], v[244:247], a[216:219], v[88:91]
  ds_read_b64_tr_b16 v[238:239], v1 offset:12800
  v_cvt_pk_bf16_f32 v201, v202, v203
  v_mfma_f32_16x16x32_bf16 v[88:91], v[248:251], a[232:235], v[88:91]
  v_permlane16_swap_b32 v196, v198
  v_mfma_f32_16x16x32_bf16 v[88:91], v[252:255], a[248:251], v[88:91]
  buffer_load_dwordx4 v7, s[12:15], s21 offen offset:2048 lds
  v_permlane16_swap_b32 v197, v199
  v_mfma_f32_16x16x32_bf16 v[92:95], v[240:243], a[204:207], v[92:95]
  v_cvt_pk_bf16_f32 v202, v216, v217
  v_cvt_pk_bf16_f32 v203, v218, v219
  v_mfma_f32_16x16x32_bf16 v[92:95], v[244:247], a[220:223], v[92:95]
  buffer_store_dwordx4 v[196:199], v17, s[48:51], s33 offen sc1
  v_mul_f32 v204, s68, v204
  v_mfma_f32_16x16x32_bf16 v[92:95], v[248:251], a[236:239], v[92:95]
  v_mfma_f32_16x16x32_bf16 v[92:95], v[252:255], a[252:255], v[92:95]
  buffer_load_dwordx4 v8, s[12:15], s21 offen offset:3072 lds
P1_U40:
  s_waitcnt lgkmcnt(0)
  v_mfma_f32_16x16x32_bf16 v[96:99], v[224:227], a[0:3], 0
  ds_read_b64_tr_b16 v[240:241], v2 offset:0
  s_mov_b64 s[12:13], s[52:53]
  v_mfma_f32_16x16x32_bf16 v[96:99], v[228:231], a[16:19], v[96:99]
  ds_read_b64_tr_b16 v[242:243], v2 offset:512
  s_mov_b32 s14, 4194304
  v_mfma_f32_16x16x32_bf16 v[96:99], v[232:235], a[32:35], v[96:99]
  ds_read_b64_tr_b16 v[244:245], v2 offset:4096
  s_mov_b32 s58, 8192
  v_mfma_f32_16x16x32_bf16 v[96:99], v[236:239], a[48:51], v[96:99]
  s_lshl_b32 s62, s17, 8
  s_lshl_b32 s31, s58, 3
  v_mad_u32_u24 v5, v18, s58, v19
  v_mfma_f32_16x16x32_bf16 v[100:103], v[224:227], a[4:7], 0
  ds_read_b64_tr_b16 v[246:247], v2 offset:4608
  s_sub_u32 s31, s31, 1024
  v_mfma_f32_16x16x32_bf16 v[100:103], v[228:231], a[20:23], v[100:103]
  ds_read_b64_tr_b16 v[248:249], v2 offset:8192
  v_xor_b32 v6, 64, v5
  v_mfma_f32_16x16x32_bf16 v[100:103], v[232:235], a[36:39], v[100:103]
  ds_read_b64_tr_b16 v[250:251], v2 offset:8704
  v_add_u32 v6, s31, v6
  v_mfma_f32_16x16x32_bf16 v[100:103], v[236:239], a[52:55], v[100:103]
  s_lshl_b32 s31, s31, 1
  v_add_u32 v7, s31, v5
  v_add_u32 v8, s31, v6
  v_mfma_f32_16x16x32_bf16 v[104:107], v[224:227], a[8:11], 0
  ds_read_b64_tr_b16 v[252:253], v2 offset:12288
  s_mul_i32 s21, s58, s16
  v_mfma_f32_16x16x32_bf16 v[104:107], v[228:231], a[24:27], v[104:107]
  ds_read_b64_tr_b16 v[254:255], v2 offset:12800
  s_lshl_b32 s21, s21, 5
  v_mfma_f32_16x16x32_bf16 v[104:107], v[232:235], a[40:43], v[104:107]
  s_add_u32 s21, s21, s62
  s_lshr_b32 s31, s76, 1
  s_mul_i32 s31, s31, s58
  v_mfma_f32_16x16x32_bf16 v[104:107], v[236:239], a[56:59], v[104:107]
  s_add_u32 s22, s21, s31
  s_lshr_b32 s31, s77, 1
  s_mul_i32 s31, s31, s58
  v_mfma_f32_16x16x32_bf16 v[108:111], v[224:227], a[12:15], 0
  s_add_u32 s23, s21, s31
  s_lshr_b32 s31, s78, 1
  s_mul_i32 s31, s31, s58
  v_mfma_f32_16x16x32_bf16 v[108:111], v[228:231], a[28:31], v[108:111]
  s_add_u32 s24, s21, s31
  s_lshr_b32 s31, s79, 1
  s_mul_i32 s31, s31, s58
  v_mfma_f32_16x16x32_bf16 v[108:111], v[232:235], a[44:47], v[108:111]
  s_add_u32 s38, s21, s31
  v_mfma_f32_16x16x32_bf16 v[108:111], v[236:239], a[60:63], v[108:111]
  v_mul_f32 v205, s68, v205
  s_waitcnt lgkmcnt(0)
  v_mfma_f32_16x16x32_bf16 v[112:115], v[240:243], a[0:3], 0
  ds_read_b64_tr_b16 v[224:225], v3 offset:0
  v_mul_f32 v206, s68, v206
  v_mfma_f32_16x16x32_bf16 v[112:115], v[244:247], a[16:19], v[112:115]
  ds_read_b64_tr_b16 v[226:227], v3 offset:512
  v_mul_f32 v207, s68, v207
  v_mfma_f32_16x16x32_bf16 v[112:115], v[248:251], a[32:35], v[112:115]
  ds_read_b64_tr_b16 v[228:229], v3 offset:4096
  v_mul_f32 v220, s68, v220
  v_mfma_f32_16x16x32_bf16 v[112:115], v[252:255], a[48:51], v[112:115]
  v_mul_f32 v221, s68, v221
  v_mul_f32 v222, s68, v222
  v_mfma_f32_16x16x32_bf16 v[116:119], v[240:243], a[4:7], 0
  ds_read_b64_tr_b16 v[230:231], v3 offset:4608
  v_mul_f32 v223, s68, v223
  v_mfma_f32_16x16x32_bf16 v[116:119], v[244:247], a[20:23], v[116:119]
  ds_read_b64_tr_b16 v[232:233], v3 offset:8192
  v_cvt_pk_bf16_f32 v204, v204, v205
  v_mfma_f32_16x16x32_bf16 v[116:119], v[248:251], a[36:39], v[116:119]
  ds_read_b64_tr_b16 v[234:235], v3 offset:8704
  v_cvt_pk_bf16_f32 v205, v206, v207
  v_mfma_f32_16x16x32_bf16 v[116:119], v[252:255], a[52:55], v[116:119]
  v_permlane16_swap_b32 v200, v202
  v_mfma_f32_16x16x32_bf16 v[120:123], v[240:243], a[8:11], 0
  ds_read_b64_tr_b16 v[236:237], v3 offset:12288
  v_mfma_f32_16x16x32_bf16 v[120:123], v[244:247], a[24:27], v[120:123]
  ds_read_b64_tr_b16 v[238:239], v3 offset:12800
  v_mfma_f32_16x16x32_bf16 v[120:123], v[248:251], a[40:43], v[120:123]
  v_permlane16_swap_b32 v201, v203
  v_mfma_f32_16x16x32_bf16 v[120:123], v[252:255], a[56:59], v[120:123]
  v_cvt_pk_bf16_f32 v206, v220, v221
  v_mfma_f32_16x16x32_bf16 v[124:127], v[240:243], a[12:15], 0
  buffer_store_dwordx4 v[200:203], v17, s[48:51], s34 offen sc1
  v_cvt_pk_bf16_f32 v207, v222, v223
  v_mfma_f32_16x16x32_bf16 v[124:127], v[244:247], a[28:31], v[124:127]
  s_nop 1
  v_mfma_f32_16x16x32_bf16 v[124:127], v[248:251], a[44:47], v[124:127]
  v_permlane16_swap_b32 v204, v206
  v_mfma_f32_16x16x32_bf16 v[124:127], v[252:255], a[60:63], v[124:127]
  s_waitcnt lgkmcnt(0)
  v_mfma_f32_16x16x32_bf16 v[128:131], v[224:227], a[0:3], 0
  ds_read_b64_tr_b16 v[240:241], v4 offset:0
  v_mfma_f32_16x16x32_bf16 v[128:131], v[228:231], a[16:19], v[128:131]
  ds_read_b64_tr_b16 v[242:243], v4 offset:512
  v_mfma_f32_16x16x32_bf16 v[128:131], v[232:235], a[32:35], v[128:131]
  ds_read_b64_tr_b16 v[244:245], v4 offset:4096
  v_mfma_f32_16x16x32_bf16 v[128:131], v[236:239], a[48:51], v[128:131]
  v_permlane16_swap_b32 v205, v207
  v_mfma_f32_16x16x32_bf16 v[132:135], v[224:227], a[4:7], 0
  ds_read_b64_tr_b16 v[246:247], v4 offset:4608
  v_mfma_f32_16x16x32_bf16 v[132:135], v[228:231], a[20:23], v[132:135]
  ds_read_b64_tr_b16 v[248:249], v4 offset:8192
  buffer_store_dwordx4 v[204:207], v17, s[48:51], s35 offen sc1
  v_mfma_f32_16x16x32_bf16 v[132:135], v[232:235], a[36:39], v[132:135]
  ds_read_b64_tr_b16 v[250:251], v4 offset:8704
  s_mov_b32 s50, s39
  v_mfma_f32_16x16x32_bf16 v[132:135], v[236:239], a[52:55], v[132:135]
  s_lshr_b32 s29, s27, 1
  s_mul_i32 s32, s29, s70
  s_and_b32 s29, s27, 1
  v_mfma_f32_16x16x32_bf16 v[136:139], v[224:227], a[8:11], 0
  ds_read_b64_tr_b16 v[252:253], v4 offset:12288
  s_mul_i32 s29, s29, s71
  v_mfma_f32_16x16x32_bf16 v[136:139], v[228:231], a[24:27], v[136:139]
  ds_read_b64_tr_b16 v[254:255], v4 offset:12800
  s_add_u32 s32, s32, s29
  v_mfma_f32_16x16x32_bf16 v[136:139], v[232:235], a[40:43], v[136:139]
  s_add_u32 s32, s32, s36
  s_add_u32 s27, s27, 1
  s_add_u32 s33, s32, s67
  v_mfma_f32_16x16x32_bf16 v[136:139], v[236:239], a[56:59], v[136:139]
  s_add_u32 s34, s32, s66
  s_add_u32 s35, s34, s67
  v_mul_f32 v32, s68, v32
  v_mfma_f32_16x16x32_bf16 v[140:143], v[224:227], a[12:15], 0
  v_mul_f32 v33, s68, v33
  v_mul_f32 v34, s68, v34
  v_mfma_f32_16x16x32_bf16 v[140:143], v[228:231], a[28:31], v[140:143]
  v_mul_f32 v35, s68, v35
  v_mul_f32 v48, s68, v48
  v_mfma_f32_16x16x32_bf16 v[140:143], v[232:235], a[44:47], v[140:143]
  v_mul_f32 v49, s68, v49
  v_mul_f32 v50, s68, v50
  v_mfma_f32_16x16x32_bf16 v[140:143], v[236:239], a[60:63], v[140:143]
  s_waitcnt vmcnt(18) lgkmcnt(0)
  s_barrier
  v_mfma_f32_16x16x32_bf16 v[144:147], v[240:243], a[0:3], 0
  ds_read_b64_tr_b16 v[224:225], v1 offset:16384
  s_add_u32 m0, s19, 0
  v_mfma_f32_16x16x32_bf16 v[144:147], v[244:247], a[16:19], v[144:147]
  ds_read_b64_tr_b16 v[226:227], v1 offset:16896
  s_add_u32 s21, s22, 0
  v_mfma_f32_16x16x32_bf16 v[144:147], v[248:251], a[32:35], v[144:147]
  ds_read_b64_tr_b16 v[228:229], v1 offset:20480
  v_mul_f32 v51, s68, v51
  v_mfma_f32_16x16x32_bf16 v[144:147], v[252:255], a[48:51], v[144:147]
  buffer_load_dwordx4 v5, s[12:15], s21 offen offset:0 lds
  v_cvt_pk_bf16_f32 v32, v32, v33
  v_mfma_f32_16x16x32_bf16 v[148:151], v[240:243], a[4:7], 0
  ds_read_b64_tr_b16 v[230:231], v1 offset:20992
  v_cvt_pk_bf16_f32 v33, v34, v35
  v_mfma_f32_16x16x32_bf16 v[148:151], v[244:247], a[20:23], v[148:151]
  ds_read_b64_tr_b16 v[232:233], v1 offset:24576
  v_cvt_pk_bf16_f32 v34, v48, v49
  v_mfma_f32_16x16x32_bf16 v[148:151], v[248:251], a[36:39], v[148:151]
  ds_read_b64_tr_b16 v[234:235], v1 offset:25088
  v_cvt_pk_bf16_f32 v35, v50, v51
  v_mfma_f32_16x16x32_bf16 v[148:151], v[252:255], a[52:55], v[148:151]
  buffer_load_dwordx4 v6, s[12:15], s21 offen offset:1024 lds
  v_mul_f32 v36, s68, v36
  v_mfma_f32_16x16x32_bf16 v[152:155], v[240:243], a[8:11], 0
  ds_read_b64_tr_b16 v[236:237], v1 offset:28672
  v_mul_f32 v37, s68, v37
  v_mfma_f32_16x16x32_bf16 v[152:155], v[244:247], a[24:27], v[152:155]
  ds_read_b64_tr_b16 v[238:239], v1 offset:29184
  v_mul_f32 v38, s68, v38
  v_mfma_f32_16x16x32_bf16 v[152:155], v[248:251], a[40:43], v[152:155]
  v_mul_f32 v39, s68, v39
  v_mul_f32 v52, s68, v52
  v_mfma_f32_16x16x32_bf16 v[152:155], v[252:255], a[56:59], v[152:155]
  buffer_load_dwordx4 v7, s[12:15], s21 offen offset:2048 lds
  v_mul_f32 v53, s68, v53
  v_mfma_f32_16x16x32_bf16 v[156:159], v[240:243], a[12:15], 0
  v_mul_f32 v54, s68, v54
  v_mul_f32 v55, s68, v55
  v_mfma_f32_16x16x32_bf16 v[156:159], v[244:247], a[28:31], v[156:159]
  v_cvt_pk_bf16_f32 v36, v36, v37
  v_cvt_pk_bf16_f32 v37, v38, v39
  v_mfma_f32_16x16x32_bf16 v[156:159], v[248:251], a[44:47], v[156:159]
  v_permlane16_swap_b32 v32, v34
  v_mfma_f32_16x16x32_bf16 v[156:159], v[252:255], a[60:63], v[156:159]
  buffer_load_dwordx4 v8, s[12:15], s21 offen offset:3072 lds
  s_waitcnt lgkmcnt(0)
  v_mfma_f32_16x16x32_bf16 v[96:99], v[224:227], a[64:67], v[96:99]
  ds_read_b64_tr_b16 v[240:241], v2 offset:16384
  v_mfma_f32_16x16x32_bf16 v[96:99], v[228:231], a[80:83], v[96:99]
  ds_read_b64_tr_b16 v[242:243], v2 offset:16896
  v_mfma_f32_16x16x32_bf16 v[96:99], v[232:235], a[96:99], v[96:99]
  ds_read_b64_tr_b16 v[244:245], v2 offset:20480
  v_mfma_f32_16x16x32_bf16 v[96:99], v[236:239], a[112:115], v[96:99]
  v_permlane16_swap_b32 v33, v35
  v_mfma_f32_16x16x32_bf16 v[100:103], v[224:227], a[68:71], v[100:103]
  ds_read_b64_tr_b16 v[246:247], v2 offset:20992
  v_cvt_pk_bf16_f32 v38, v52, v53
  v_mfma_f32_16x16x32_bf16 v[100:103], v[228:231], a[84:87], v[100:103]
  ds_read_b64_tr_b16 v[248:249], v2 offset:24576
  v_cvt_pk_bf16_f32 v39, v54, v55
  v_mfma_f32_16x16x32_bf16 v[100:103], v[232:235], a[100:103], v[100:103]
  ds_read_b64_tr_b16 v[250:251], v2 offset:25088
  buffer_store_dwordx4 v[32:35], v17, s[48:51], s32 offen sc1
  v_mfma_f32_16x16x32_bf16 v[100:103], v[236:239], a[116:119], v[100:103]
  s_add_u32 s32, s32, s65
  v_mul_f32 v40, s68, v40
  v_mul_f32 v41, s68, v41
  v_mfma_f32_16x16x32_bf16 v[104:107], v[224:227], a[72:75], v[104:107]
  ds_read_b64_tr_b16 v[252:253], v2 offset:28672
  v_mul_f32 v42, s68, v42
  v_mfma_f32_16x16x32_bf16 v[104:107], v[228:231], a[88:91], v[104:107]
  ds_read_b64_tr_b16 v[254:255], v2 offset:29184
  v_mul_f32 v43, s68, v43
  v_mfma_f32_16x16x32_bf16 v[104:107], v[232:235], a[104:107], v[104:107]
  v_mul_f32 v56, s68, v56
  v_mul_f32 v57, s68, v57
  v_mfma_f32_16x16x32_bf16 v[104:107], v[236:239], a[120:123], v[104:107]
  v_mul_f32 v58, s68, v58
  v_mul_f32 v59, s68, v59
  v_mfma_f32_16x16x32_bf16 v[108:111], v[224:227], a[76:79], v[108:111]
  v_cvt_pk_bf16_f32 v40, v40, v41
  v_cvt_pk_bf16_f32 v41, v42, v43
  v_mfma_f32_16x16x32_bf16 v[108:111], v[228:231], a[92:95], v[108:111]
  v_permlane16_swap_b32 v36, v38
  v_mfma_f32_16x16x32_bf16 v[108:111], v[232:235], a[108:111], v[108:111]
  v_permlane16_swap_b32 v37, v39
  v_mfma_f32_16x16x32_bf16 v[108:111], v[236:239], a[124:127], v[108:111]
  s_waitcnt lgkmcnt(0)
  v_mfma_f32_16x16x32_bf16 v[112:115], v[240:243], a[64:67], v[112:115]
  ds_read_b64_tr_b16 v[224:225], v3 offset:16384
  v_mfma_f32_16x16x32_bf16 v[112:115], v[244:247], a[80:83], v[112:115]
  ds_read_b64_tr_b16 v[226:227], v3 offset:16896
  v_mfma_f32_16x16x32_bf16 v[112:115], v[248:251], a[96:99], v[112:115]
  ds_read_b64_tr_b16 v[228:229], v3 offset:20480
  v_cvt_pk_bf16_f32 v42, v56, v57
  v_mfma_f32_16x16x32_bf16 v[112:115], v[252:255], a[112:115], v[112:115]
  buffer_store_dwordx4 v[36:39], v17, s[48:51], s33 offen sc1
  v_cvt_pk_bf16_f32 v43, v58, v59
  v_mfma_f32_16x16x32_bf16 v[116:119], v[240:243], a[68:71], v[116:119]
  ds_read_b64_tr_b16 v[230:231], v3 offset:20992
  s_add_u32 s33, s33, s65
  v_mfma_f32_16x16x32_bf16 v[116:119], v[244:247], a[84:87], v[116:119]
  ds_read_b64_tr_b16 v[232:233], v3 offset:24576
  v_mul_f32 v44, s68, v44
  v_mfma_f32_16x16x32_bf16 v[116:119], v[248:251], a[100:103], v[116:119]
  ds_read_b64_tr_b16 v[234:235], v3 offset:25088
  v_mul_f32 v45, s68, v45
  v_mfma_f32_16x16x32_bf16 v[116:119], v[252:255], a[116:119], v[116:119]
  v_mul_f32 v46, s68, v46
  v_mul_f32 v47, s68, v47
  v_mfma_f32_16x16x32_bf16 v[120:123], v[240:243], a[72:75], v[120:123]
  ds_read_b64_tr_b16 v[236:237], v3 offset:28672
  v_mul_f32 v60, s68, v60
  v_mfma_f32_16x16x32_bf16 v[120:123], v[244:247], a[88:91], v[120:123]
  ds_read_b64_tr_b16 v[238:239], v3 offset:29184
  v_mul_f32 v61, s68, v61
  v_mfma_f32_16x16x32_bf16 v[120:123], v[248:251], a[104:107], v[120:123]
  v_mul_f32 v62, s68, v62
  v_mul_f32 v63, s68, v63
  v_mfma_f32_16x16x32_bf16 v[120:123], v[252:255], a[120:123], v[120:123]
  v_cvt_pk_bf16_f32 v44, v44, v45
  v_cvt_pk_bf16_f32 v45, v46, v47
  v_mfma_f32_16x16x32_bf16 v[124:127], v[240:243], a[76:79], v[124:127]
  v_permlane16_swap_b32 v40, v42
  v_mfma_f32_16x16x32_bf16 v[124:127], v[244:247], a[92:95], v[124:127]
  v_permlane16_swap_b32 v41, v43
  v_mfma_f32_16x16x32_bf16 v[124:127], v[248:251], a[108:111], v[124:127]
  v_cvt_pk_bf16_f32 v46, v60, v61
  v_cvt_pk_bf16_f32 v47, v62, v63
  v_mfma_f32_16x16x32_bf16 v[124:127], v[252:255], a[124:127], v[124:127]
  buffer_store_dwordx4 v[40:43], v17, s[48:51], s34 offen sc1
  s_waitcnt lgkmcnt(0)
  v_mfma_f32_16x16x32_bf16 v[128:131], v[224:227], a[64:67], v[128:131]
  ds_read_b64_tr_b16 v[240:241], v4 offset:16384
  v_mfma_f32_16x16x32_bf16 v[128:131], v[228:231], a[80:83], v[128:131]
  ds_read_b64_tr_b16 v[242:243], v4 offset:16896
  s_add_u32 s34, s34, s65
  v_mfma_f32_16x16x32_bf16 v[128:131], v[232:235], a[96:99], v[128:131]
  ds_read_b64_tr_b16 v[244:245], v4 offset:20480
  v_mul_f32 v64, s68, v64
  v_mfma_f32_16x16x32_bf16 v[128:131], v[236:239], a[112:115], v[128:131]
  v_mul_f32 v65, s68, v65
  v_mul_f32 v66, s68, v66
  v_mfma_f32_16x16x32_bf16 v[132:135], v[224:227], a[68:71], v[132:135]
  ds_read_b64_tr_b16 v[246:247], v4 offset:20992
  v_mul_f32 v67, s68, v67
  v_mfma_f32_16x16x32_bf16 v[132:135], v[228:231], a[84:87], v[132:135]
  ds_read_b64_tr_b16 v[248:249], v4 offset:24576
  v_mul_f32 v80, s68, v80
  v_mfma_f32_16x16x32_bf16 v[132:135], v[232:235], a[100:103], v[132:135]
  ds_read_b64_tr_b16 v[250:251], v4 offset:25088
  v_mul_f32 v81, s68, v81
  v_mfma_f32_16x16x32_bf16 v[132:135], v[236:239], a[116:119], v[132:135]
  v_mul_f32 v82, s68, v82
  v_mul_f32 v83, s68, v83
  v_mfma_f32_16x16x32_bf16 v[136:139], v[224:227], a[72:75], v[136:139]
  ds_read_b64_tr_b16 v[252:253], v4 offset:28672
  v_cvt_pk_bf16_f32 v64, v64, v65
  v_mfma_f32_16x16x32_bf16 v[136:139], v[228:231], a[88:91], v[136:139]
  ds_read_b64_tr_b16 v[254:255], v4 offset:29184
  v_cvt_pk_bf16_f32 v65, v66, v67
  v_mfma_f32_16x16x32_bf16 v[136:139], v[232:235], a[104:107], v[136:139]
  v_permlane16_swap_b32 v44, v46
  v_mfma_f32_16x16x32_bf16 v[136:139], v[236:239], a[120:123], v[136:139]
  v_permlane16_swap_b32 v45, v47
  v_mfma_f32_16x16x32_bf16 v[140:143], v[224:227], a[76:79], v[140:143]
  v_cvt_pk_bf16_f32 v66, v80, v81
  v_mfma_f32_16x16x32_bf16 v[140:143], v[228:231], a[92:95], v[140:143]
  buffer_store_dwordx4 v[44:47], v17, s[48:51], s35 offen sc1
  v_cvt_pk_bf16_f32 v67, v82, v83
  v_mfma_f32_16x16x32_bf16 v[140:143], v[232:235], a[108:111], v[140:143]
  s_add_u32 s35, s35, s65
  v_mul_f32 v68, s68, v68
  v_mul_f32 v69, s68, v69
  v_mfma_f32_16x16x32_bf16 v[140:143], v[236:239], a[124:127], v[140:143]
  s_waitcnt vmcnt(19) lgkmcnt(0)
  s_barrier
  v_mfma_f32_16x16x32_bf16 v[144:147], v[240:243], a[64:67], v[144:147]
  ds_read_b64_tr_b16 v[224:225], v1 offset:32768
  s_add_u32 m0, s19, 16384
  v_mfma_f32_16x16x32_bf16 v[144:147], v[244:247], a[80:83], v[144:147]
  ds_read_b64_tr_b16 v[226:227], v1 offset:33280
  s_add_u32 s21, s22, 128
  v_mfma_f32_16x16x32_bf16 v[144:147], v[248:251], a[96:99], v[144:147]
  ds_read_b64_tr_b16 v[228:229], v1 offset:36864
  v_mul_f32 v70, s68, v70
  v_mfma_f32_16x16x32_bf16 v[144:147], v[252:255], a[112:115], v[144:147]
  buffer_load_dwordx4 v5, s[12:15], s21 offen offset:0 lds
  v_mul_f32 v71, s68, v71
  v_mfma_f32_16x16x32_bf16 v[148:151], v[240:243], a[68:71], v[148:151]
  ds_read_b64_tr_b16 v[230:231], v1 offset:37376
  v_mul_f32 v84, s68, v84
  v_mfma_f32_16x16x32_bf16 v[148:151], v[244:247], a[84:87], v[148:151]
  ds_read_b64_tr_b16 v[232:233], v1 offset:40960
  v_mul_f32 v85, s68, v85
  v_mfma_f32_16x16x32_bf16 v[148:151], v[248:251], a[100:103], v[148:151]
  ds_read_b64_tr_b16 v[234:235], v1 offset:41472
  v_mul_f32 v86, s68, v86
  v_mfma_f32_16x16x32_bf16 v[148:151], v[252:255], a[116:119], v[148:151]
  buffer_load_dwordx4 v6, s[12:15], s21 offen offset:1024 lds
  v_mul_f32 v87, s68, v87
  v_mfma_f32_16x16x32_bf16 v[152:155], v[240:243], a[72:75], v[152:155]
  ds_read_b64_tr_b16 v[236:237], v1 offset:45056
  v_cvt_pk_bf16_f32 v68, v68, v69
  v_mfma_f32_16x16x32_bf16 v[152:155], v[244:247], a[88:91], v[152:155]
  ds_read_b64_tr_b16 v[238:239], v1 offset:45568
  v_cvt_pk_bf16_f32 v69, v70, v71
  v_mfma_f32_16x16x32_bf16 v[152:155], v[248:251], a[104:107], v[152:155]
  v_permlane16_swap_b32 v64, v66
  v_mfma_f32_16x16x32_bf16 v[152:155], v[252:255], a[120:123], v[152:155]
  buffer_load_dwordx4 v7, s[12:15], s21 offen offset:2048 lds
  v_mfma_f32_16x16x32_bf16 v[156:159], v[240:243], a[76:79], v[156:159]
  v_permlane16_swap_b32 v65, v67
  v_mfma_f32_16x16x32_bf16 v[156:159], v[244:247], a[92:95], v[156:159]
  v_cvt_pk_bf16_f32 v70, v84, v85
  v_mfma_f32_16x16x32_bf16 v[156:159], v[248:251], a[108:111], v[156:159]
  buffer_store_dwordx4 v[64:67], v17, s[48:51], s32 offen sc1
  v_cvt_pk_bf16_f32 v71, v86, v87
  v_mfma_f32_16x16x32_bf16 v[156:159], v[252:255], a[124:127], v[156:159]
  buffer_load_dwordx4 v8, s[12:15], s21 offen offset:3072 lds
  s_waitcnt vmcnt(63) lgkmcnt(0)
  v_mfma_f32_16x16x32_bf16 v[96:99], v[224:227], a[128:131], v[96:99]
  ds_read_b64_tr_b16 v[240:241], v2 offset:32768
  v_mfma_f32_16x16x32_bf16 v[96:99], v[228:231], a[144:147], v[96:99]
  ds_read_b64_tr_b16 v[242:243], v2 offset:33280
  v_mfma_f32_16x16x32_bf16 v[96:99], v[232:235], a[160:163], v[96:99]
  ds_read_b64_tr_b16 v[244:245], v2 offset:36864
  v_mfma_f32_16x16x32_bf16 v[96:99], v[236:239], a[176:179], v[96:99]
  ds_read_b128 a[0:3], v15 offset:0
  v_mul_f32 v72, s68, v72
  v_mfma_f32_16x16x32_bf16 v[100:103], v[224:227], a[132:135], v[100:103]
  ds_read_b64_tr_b16 v[246:247], v2 offset:37376
  v_mul_f32 v73, s68, v73
  v_mfma_f32_16x16x32_bf16 v[100:103], v[228:231], a[148:151], v[100:103]
  ds_read_b64_tr_b16 v[248:249], v2 offset:40960
  v_mul_f32 v74, s68, v74
  v_mfma_f32_16x16x32_bf16 v[100:103], v[232:235], a[164:167], v[100:103]
  ds_read_b64_tr_b16 v[250:251], v2 offset:41472
  v_mul_f32 v75, s68, v75
  v_mfma_f32_16x16x32_bf16 v[100:103], v[236:239], a[180:183], v[100:103]
  ds_read_b128 a[16:19], v16 offset:0
  v_mul_f32 v88, s68, v88
  v_mfma_f32_16x16x32_bf16 v[104:107], v[224:227], a[136:139], v[104:107]
  ds_read_b64_tr_b16 v[252:253], v2 offset:45056
  v_mul_f32 v89, s68, v89
  v_mfma_f32_16x16x32_bf16 v[104:107], v[228:231], a[152:155], v[104:107]
  ds_read_b64_tr_b16 v[254:255], v2 offset:45568
  v_mul_f32 v90, s68, v90
  v_mfma_f32_16x16x32_bf16 v[104:107], v[232:235], a[168:171], v[104:107]
  ds_read_b128 a[4:7], v15 offset:2048
  v_mul_f32 v91, s68, v91
  v_mfma_f32_16x16x32_bf16 v[104:107], v[236:239], a[184:187], v[104:107]
  ds_read_b128 a[20:23], v16 offset:2048
  v_cvt_pk_bf16_f32 v72, v72, v73
  v_mfma_f32_16x16x32_bf16 v[108:111], v[224:227], a[140:143], v[108:111]
  ds_read_b128 a[8:11], v15 offset:4096
  v_cvt_pk_bf16_f32 v73, v74, v75
  v_mfma_f32_16x16x32_bf16 v[108:111], v[228:231], a[156:159], v[108:111]
  ds_read_b128 a[24:27], v16 offset:4096
  v_permlane16_swap_b32 v68, v70
  v_mfma_f32_16x16x32_bf16 v[108:111], v[232:235], a[172:175], v[108:111]
  ds_read_b128 a[12:15], v15 offset:6144
  v_permlane16_swap_b32 v69, v71
  v_mfma_f32_16x16x32_bf16 v[108:111], v[236:239], a[188:191], v[108:111]
  ds_read_b128 a[28:31], v16 offset:6144
  s_waitcnt lgkmcnt(4)
  v_mfma_f32_16x16x32_bf16 v[112:115], v[240:243], a[128:131], v[112:115]
  ds_read_b64_tr_b16 v[224:225], v3 offset:32768
  s_add_u32 m0, s20, -128
  v_mfma_f32_16x16x32_bf16 v[112:115], v[244:247], a[144:147], v[112:115]
  ds_read_b64_tr_b16 v[226:227], v3 offset:33280
  s_add_u32 s28, s25, s77
  v_mfma_f32_16x16x32_bf16 v[112:115], v[248:251], a[160:163], v[112:115]
  ds_read_b64_tr_b16 v[228:229], v3 offset:36864
  v_cvt_pk_bf16_f32 v74, v88, v89
  v_mfma_f32_16x16x32_bf16 v[112:115], v[252:255], a[176:179], v[112:115]
  buffer_load_dwordx4 v9, s[44:47], s28 offen offset:128 lds
  v_cvt_pk_bf16_f32 v75, v90, v91
  v_mfma_f32_16x16x32_bf16 v[116:119], v[240:243], a[132:135], v[116:119]
  ds_read_b64_tr_b16 v[230:231], v3 offset:37376
  buffer_store_dwordx4 v[68:71], v17, s[48:51], s33 offen sc1
  v_mfma_f32_16x16x32_bf16 v[116:119], v[244:247], a[148:151], v[116:119]
  ds_read_b64_tr_b16 v[232:233], v3 offset:40960
  v_mul_f32 v76, s68, v76
  v_mfma_f32_16x16x32_bf16 v[116:119], v[248:251], a[164:167], v[116:119]
  ds_read_b64_tr_b16 v[234:235], v3 offset:41472
  v_mul_f32 v77, s68, v77
  v_mfma_f32_16x16x32_bf16 v[116:119], v[252:255], a[180:183], v[116:119]
  buffer_load_dwordx4 v10, s[44:47], s28 offen offset:1152 lds
  v_mul_f32 v78, s68, v78
  v_mfma_f32_16x16x32_bf16 v[120:123], v[240:243], a[136:139], v[120:123]
  ds_read_b64_tr_b16 v[236:237], v3 offset:45056
  v_mul_f32 v79, s68, v79
  v_mfma_f32_16x16x32_bf16 v[120:123], v[244:247], a[152:155], v[120:123]
  ds_read_b64_tr_b16 v[238:239], v3 offset:45568
  v_mul_f32 v92, s68, v92
  v_mfma_f32_16x16x32_bf16 v[120:123], v[248:251], a[168:171], v[120:123]
  v_mul_f32 v93, s68, v93
  v_mul_f32 v94, s68, v94
  v_mfma_f32_16x16x32_bf16 v[120:123], v[252:255], a[184:187], v[120:123]
  buffer_load_dwordx4 v11, s[44:47], s28 offen offset:2176 lds
  v_mul_f32 v95, s68, v95
  v_mfma_f32_16x16x32_bf16 v[124:127], v[240:243], a[140:143], v[124:127]
  v_cvt_pk_bf16_f32 v76, v76, v77
  v_cvt_pk_bf16_f32 v77, v78, v79
  v_mfma_f32_16x16x32_bf16 v[124:127], v[244:247], a[156:159], v[124:127]
  v_permlane16_swap_b32 v72, v74
  v_mfma_f32_16x16x32_bf16 v[124:127], v[248:251], a[172:175], v[124:127]
  v_permlane16_swap_b32 v73, v75
  v_mfma_f32_16x16x32_bf16 v[124:127], v[252:255], a[188:191], v[124:127]
  buffer_load_dwordx4 v12, s[44:47], s28 offen offset:3200 lds
  s_waitcnt lgkmcnt(0)
  v_mfma_f32_16x16x32_bf16 v[128:131], v[224:227], a[128:131], v[128:131]
  ds_read_b64_tr_b16 v[240:241], v4 offset:32768
  s_add_u32 m0, s20, 3968
  v_mfma_f32_16x16x32_bf16 v[128:131], v[228:231], a[144:147], v[128:131]
  ds_read_b64_tr_b16 v[242:243], v4 offset:33280
  s_add_u32 s28, s26, s77
  v_mfma_f32_16x16x32_bf16 v[128:131], v[232:235], a[160:163], v[128:131]
  ds_read_b64_tr_b16 v[244:245], v4 offset:36864
  v_mfma_f32_16x16x32_bf16 v[128:131], v[236:239], a[176:179], v[128:131]
  buffer_load_dwordx4 v9, s[44:47], s28 offen offset:128 lds
  v_mfma_f32_16x16x32_bf16 v[132:135], v[224:227], a[132:135], v[132:135]
  ds_read_b64_tr_b16 v[246:247], v4 offset:37376
  v_mfma_f32_16x16x32_bf16 v[132:135], v[228:231], a[148:151], v[132:135]
  ds_read_b64_tr_b16 v[248:249], v4 offset:40960
  v_mfma_f32_16x16x32_bf16 v[132:135], v[232:235], a[164:167], v[132:135]
  ds_read_b64_tr_b16 v[250:251], v4 offset:41472
  v_mfma_f32_16x16x32_bf16 v[132:135], v[236:239], a[180:183], v[132:135]
  buffer_load_dwordx4 v10, s[44:47], s28 offen offset:1152 lds
  v_cvt_pk_bf16_f32 v78, v92, v93
  v_mfma_f32_16x16x32_bf16 v[136:139], v[224:227], a[136:139], v[136:139]
  ds_read_b64_tr_b16 v[252:253], v4 offset:45056
  v_cvt_pk_bf16_f32 v79, v94, v95
  v_mfma_f32_16x16x32_bf16 v[136:139], v[228:231], a[152:155], v[136:139]
  ds_read_b64_tr_b16 v[254:255], v4 offset:45568
  buffer_store_dwordx4 v[72:75], v17, s[48:51], s34 offen sc1
  v_mfma_f32_16x16x32_bf16 v[136:139], v[232:235], a[168:171], v[136:139]
  s_nop 1
  v_mfma_f32_16x16x32_bf16 v[136:139], v[236:239], a[184:187], v[136:139]
  buffer_load_dwordx4 v11, s[44:47], s28 offen offset:2176 lds
  v_mfma_f32_16x16x32_bf16 v[140:143], v[224:227], a[140:143], v[140:143]
  v_permlane16_swap_b32 v76, v78
  v_mfma_f32_16x16x32_bf16 v[140:143], v[228:231], a[156:159], v[140:143]
  v_permlane16_swap_b32 v77, v79
  v_mfma_f32_16x16x32_bf16 v[140:143], v[232:235], a[172:175], v[140:143]
  buffer_store_dwordx4 v[76:79], v17, s[48:51], s35 offen sc1
  s_mov_b32 s50, 83886080
  v_mfma_f32_16x16x32_bf16 v[140:143], v[236:239], a[188:191], v[140:143]
  buffer_load_dwordx4 v12, s[44:47], s28 offen offset:3200 lds
  s_waitcnt vmcnt(26) lgkmcnt(0)
  s_barrier
  v_mfma_f32_16x16x32_bf16 v[144:147], v[240:243], a[128:131], v[144:147]
  ds_read_b64_tr_b16 v[224:225], v1 offset:49152
  s_add_u32 m0, s19, 32768
  v_mfma_f32_16x16x32_bf16 v[144:147], v[244:247], a[144:147], v[144:147]
  ds_read_b64_tr_b16 v[226:227], v1 offset:49664
  s_add_u32 s21, s23, 0
  v_mfma_f32_16x16x32_bf16 v[144:147], v[248:251], a[160:163], v[144:147]
  ds_read_b64_tr_b16 v[228:229], v1 offset:53248
  v_mfma_f32_16x16x32_bf16 v[144:147], v[252:255], a[176:179], v[144:147]
  buffer_load_dwordx4 v5, s[12:15], s21 offen offset:0 lds
  v_mfma_f32_16x16x32_bf16 v[148:151], v[240:243], a[132:135], v[148:151]
  ds_read_b64_tr_b16 v[230:231], v1 offset:53760
  v_mfma_f32_16x16x32_bf16 v[148:151], v[244:247], a[148:151], v[148:151]
  ds_read_b64_tr_b16 v[232:233], v1 offset:57344
  v_mfma_f32_16x16x32_bf16 v[148:151], v[248:251], a[164:167], v[148:151]
  ds_read_b64_tr_b16 v[234:235], v1 offset:57856
  v_mfma_f32_16x16x32_bf16 v[148:151], v[252:255], a[180:183], v[148:151]
  buffer_load_dwordx4 v6, s[12:15], s21 offen offset:1024 lds
  v_mfma_f32_16x16x32_bf16 v[152:155], v[240:243], a[136:139], v[152:155]
  ds_read_b64_tr_b16 v[236:237], v1 offset:61440
  v_mfma_f32_16x16x32_bf16 v[152:155], v[244:247], a[152:155], v[152:155]
  ds_read_b64_tr_b16 v[238:239], v1 offset:61952
  v_mfma_f32_16x16x32_bf16 v[152:155], v[248:251], a[168:171], v[152:155]
  v_mfma_f32_16x16x32_bf16 v[152:155], v[252:255], a[184:187], v[152:155]
  buffer_load_dwordx4 v7, s[12:15], s21 offen offset:2048 lds
  v_mfma_f32_16x16x32_bf16 v[156:159], v[240:243], a[140:143], v[156:159]
  v_mfma_f32_16x16x32_bf16 v[156:159], v[244:247], a[156:159], v[156:159]
  v_mfma_f32_16x16x32_bf16 v[156:159], v[248:251], a[172:175], v[156:159]
  v_mfma_f32_16x16x32_bf16 v[156:159], v[252:255], a[188:191], v[156:159]
  buffer_load_dwordx4 v8, s[12:15], s21 offen offset:3072 lds
  s_waitcnt vmcnt(63) lgkmcnt(0)
  v_mfma_f32_16x16x32_bf16 v[96:99], v[224:227], a[192:195], v[96:99]
  ds_read_b64_tr_b16 v[240:241], v2 offset:49152
  v_mfma_f32_16x16x32_bf16 v[96:99], v[228:231], a[208:211], v[96:99]
  ds_read_b64_tr_b16 v[242:243], v2 offset:49664
  v_mfma_f32_16x16x32_bf16 v[96:99], v[232:235], a[224:227], v[96:99]
  ds_read_b64_tr_b16 v[244:245], v2 offset:53248
  v_mfma_f32_16x16x32_bf16 v[96:99], v[236:239], a[240:243], v[96:99]
  ds_read_b128 a[32:35], v15 offset:8192
  v_mfma_f32_16x16x32_bf16 v[100:103], v[224:227], a[196:199], v[100:103]
  ds_read_b64_tr_b16 v[246:247], v2 offset:53760
  v_mfma_f32_16x16x32_bf16 v[100:103], v[228:231], a[212:215], v[100:103]
  ds_read_b64_tr_b16 v[248:249], v2 offset:57344
  v_mfma_f32_16x16x32_bf16 v[100:103], v[232:235], a[228:231], v[100:103]
  ds_read_b64_tr_b16 v[250:251], v2 offset:57856
  v_mfma_f32_16x16x32_bf16 v[100:103], v[236:239], a[244:247], v[100:103]
  ds_read_b128 a[48:51], v16 offset:8192
  v_mfma_f32_16x16x32_bf16 v[104:107], v[224:227], a[200:203], v[104:107]
  ds_read_b64_tr_b16 v[252:253], v2 offset:61440
  v_mfma_f32_16x16x32_bf16 v[104:107], v[228:231], a[216:219], v[104:107]
  ds_read_b64_tr_b16 v[254:255], v2 offset:61952
  v_mfma_f32_16x16x32_bf16 v[104:107], v[232:235], a[232:235], v[104:107]
  ds_read_b128 a[36:39], v15 offset:10240
  v_mfma_f32_16x16x32_bf16 v[104:107], v[236:239], a[248:251], v[104:107]
  ds_read_b128 a[52:55], v16 offset:10240
  v_mfma_f32_16x16x32_bf16 v[108:111], v[224:227], a[204:207], v[108:111]
  ds_read_b128 a[40:43], v15 offset:12288
  v_mfma_f32_16x16x32_bf16 v[108:111], v[228:231], a[220:223], v[108:111]
  ds_read_b128 a[56:59], v16 offset:12288
  v_mfma_f32_16x16x32_bf16 v[108:111], v[232:235], a[236:239], v[108:111]
  ds_read_b128 a[44:47], v15 offset:14336
  v_mfma_f32_16x16x32_bf16 v[108:111], v[236:239], a[252:255], v[108:111]
  ds_read_b128 a[60:63], v16 offset:14336
  s_waitcnt lgkmcnt(4)
  v_mfma_f32_16x16x32_bf16 v[112:115], v[240:243], a[192:195], v[112:115]
  ds_read_b64_tr_b16 v[224:225], v3 offset:49152
  s_add_u32 m0, s20, 8192
  v_mfma_f32_16x16x32_bf16 v[112:115], v[244:247], a[208:211], v[112:115]
  ds_read_b64_tr_b16 v[226:227], v3 offset:49664
  s_add_u32 s28, s25, s78
  v_mfma_f32_16x16x32_bf16 v[112:115], v[248:251], a[224:227], v[112:115]
  ds_read_b64_tr_b16 v[228:229], v3 offset:53248
  v_mfma_f32_16x16x32_bf16 v[112:115], v[252:255], a[240:243], v[112:115]
  buffer_load_dwordx4 v9, s[44:47], s28 offen offset:0 lds
  v_mfma_f32_16x16x32_bf16 v[116:119], v[240:243], a[196:199], v[116:119]
  ds_read_b64_tr_b16 v[230:231], v3 offset:53760
  v_mfma_f32_16x16x32_bf16 v[116:119], v[244:247], a[212:215], v[116:119]
  ds_read_b64_tr_b16 v[232:233], v3 offset:57344
  v_mfma_f32_16x16x32_bf16 v[116:119], v[248:251], a[228:231], v[116:119]
  ds_read_b64_tr_b16 v[234:235], v3 offset:57856
  v_mfma_f32_16x16x32_bf16 v[116:119], v[252:255], a[244:247], v[116:119]
  buffer_load_dwordx4 v10, s[44:47], s28 offen offset:1024 lds
  v_mfma_f32_16x16x32_bf16 v[120:123], v[240:243], a[200:203], v[120:123]
  ds_read_b64_tr_b16 v[236:237], v3 offset:61440
  v_mfma_f32_16x16x32_bf16 v[120:123], v[244:247], a[216:219], v[120:123]
  ds_read_b64_tr_b16 v[238:239], v3 offset:61952
  v_mfma_f32_16x16x32_bf16 v[120:123], v[248:251], a[232:235], v[120:123]
  v_mfma_f32_16x16x32_bf16 v[120:123], v[252:255], a[248:251], v[120:123]
  buffer_load_dwordx4 v11, s[44:47], s28 offen offset:2048 lds
  v_mfma_f32_16x16x32_bf16 v[124:127], v[240:243], a[204:207], v[124:127]
  v_mfma_f32_16x16x32_bf16 v[124:127], v[244:247], a[220:223], v[124:127]
  v_mfma_f32_16x16x32_bf16 v[124:127], v[248:251], a[236:239], v[124:127]
  v_mfma_f32_16x16x32_bf16 v[124:127], v[252:255], a[252:255], v[124:127]
  buffer_load_dwordx4 v12, s[44:47], s28 offen offset:3072 lds
  s_waitcnt lgkmcnt(0)
  v_mfma_f32_16x16x32_bf16 v[128:131], v[224:227], a[192:195], v[128:131]
  ds_read_b64_tr_b16 v[240:241], v4 offset:49152
  s_add_u32 m0, s20, 12288
  v_mfma_f32_16x16x32_bf16 v[128:131], v[228:231], a[208:211], v[128:131]
  ds_read_b64_tr_b16 v[242:243], v4 offset:49664
  s_add_u32 s28, s26, s78
  v_mfma_f32_16x16x32_bf16 v[128:131], v[232:235], a[224:227], v[128:131]
  ds_read_b64_tr_b16 v[244:245], v4 offset:53248
  v_mfma_f32_16x16x32_bf16 v[128:131], v[236:239], a[240:243], v[128:131]
  buffer_load_dwordx4 v9, s[44:47], s28 offen offset:0 lds
  v_mfma_f32_16x16x32_bf16 v[132:135], v[224:227], a[196:199], v[132:135]
  ds_read_b64_tr_b16 v[246:247], v4 offset:53760
  v_mfma_f32_16x16x32_bf16 v[132:135], v[228:231], a[212:215], v[132:135]
  ds_read_b64_tr_b16 v[248:249], v4 offset:57344
  v_mfma_f32_16x16x32_bf16 v[132:135], v[232:235], a[228:231], v[132:135]
  ds_read_b64_tr_b16 v[250:251], v4 offset:57856
  v_mfma_f32_16x16x32_bf16 v[132:135], v[236:239], a[244:247], v[132:135]
  buffer_load_dwordx4 v10, s[44:47], s28 offen offset:1024 lds
  v_mfma_f32_16x16x32_bf16 v[136:139], v[224:227], a[200:203], v[136:139]
  ds_read_b64_tr_b16 v[252:253], v4 offset:61440
  v_mfma_f32_16x16x32_bf16 v[136:139], v[228:231], a[216:219], v[136:139]
  ds_read_b64_tr_b16 v[254:255], v4 offset:61952
  v_mfma_f32_16x16x32_bf16 v[136:139], v[232:235], a[232:235], v[136:139]
  v_mfma_f32_16x16x32_bf16 v[136:139], v[236:239], a[248:251], v[136:139]
  buffer_load_dwordx4 v11, s[44:47], s28 offen offset:2048 lds
  v_mfma_f32_16x16x32_bf16 v[140:143], v[224:227], a[204:207], v[140:143]
  v_mfma_f32_16x16x32_bf16 v[140:143], v[228:231], a[220:223], v[140:143]
  v_mfma_f32_16x16x32_bf16 v[140:143], v[232:235], a[236:239], v[140:143]
  v_mfma_f32_16x16x32_bf16 v[140:143], v[236:239], a[252:255], v[140:143]
  buffer_load_dwordx4 v12, s[44:47], s28 offen offset:3072 lds
  s_waitcnt vmcnt(32) lgkmcnt(0)
  s_barrier
  v_mfma_f32_16x16x32_bf16 v[144:147], v[240:243], a[192:195], v[144:147]
  ds_read_b64_tr_b16 v[224:225], v1 offset:0
  s_add_u32 m0, s19, 49152
  v_mfma_f32_16x16x32_bf16 v[144:147], v[244:247], a[208:211], v[144:147]
  ds_read_b64_tr_b16 v[226:227], v1 offset:512
  s_add_u32 s21, s23, 128
  v_mfma_f32_16x16x32_bf16 v[144:147], v[248:251], a[224:227], v[144:147]
  ds_read_b64_tr_b16 v[228:229], v1 offset:4096
  v_mfma_f32_16x16x32_bf16 v[144:147], v[252:255], a[240:243], v[144:147]
  buffer_load_dwordx4 v5, s[12:15], s21 offen offset:0 lds
  v_mfma_f32_16x16x32_bf16 v[148:151], v[240:243], a[196:199], v[148:151]
  ds_read_b64_tr_b16 v[230:231], v1 offset:4608
  v_mfma_f32_16x16x32_bf16 v[148:151], v[244:247], a[212:215], v[148:151]
  ds_read_b64_tr_b16 v[232:233], v1 offset:8192
  v_mfma_f32_16x16x32_bf16 v[148:151], v[248:251], a[228:231], v[148:151]
  ds_read_b64_tr_b16 v[234:235], v1 offset:8704
  v_mfma_f32_16x16x32_bf16 v[148:151], v[252:255], a[244:247], v[148:151]
  buffer_load_dwordx4 v6, s[12:15], s21 offen offset:1024 lds
  v_mfma_f32_16x16x32_bf16 v[152:155], v[240:243], a[200:203], v[152:155]
  ds_read_b64_tr_b16 v[236:237], v1 offset:12288
  v_mfma_f32_16x16x32_bf16 v[152:155], v[244:247], a[216:219], v[152:155]
  ds_read_b64_tr_b16 v[238:239], v1 offset:12800
  v_mfma_f32_16x16x32_bf16 v[152:155], v[248:251], a[232:235], v[152:155]
  v_mfma_f32_16x16x32_bf16 v[152:155], v[252:255], a[248:251], v[152:155]
  buffer_load_dwordx4 v7, s[12:15], s21 offen offset:2048 lds
  v_mfma_f32_16x16x32_bf16 v[156:159], v[240:243], a[204:207], v[156:159]
  v_mfma_f32_16x16x32_bf16 v[156:159], v[244:247], a[220:223], v[156:159]
  v_mfma_f32_16x16x32_bf16 v[156:159], v[248:251], a[236:239], v[156:159]
  v_mfma_f32_16x16x32_bf16 v[156:159], v[252:255], a[252:255], v[156:159]
  buffer_load_dwordx4 v8, s[12:15], s21 offen offset:3072 lds
P2:
  s_waitcnt vmcnt(63) lgkmcnt(0)
  v_mfma_f32_16x16x32_bf16 v[160:163], v[224:227], a[0:3], 0
  ds_read_b64_tr_b16 v[240:241], v2 offset:0
  v_mfma_f32_16x16x32_bf16 v[160:163], v[228:231], a[16:19], v[160:163]
  ds_read_b64_tr_b16 v[242:243], v2 offset:512
  v_mfma_f32_16x16x32_bf16 v[160:163], v[232:235], a[32:35], v[160:163]
  ds_read_b64_tr_b16 v[244:245], v2 offset:4096
  v_mfma_f32_16x16x32_bf16 v[160:163], v[236:239], a[48:51], v[160:163]
  ds_read_b128 a[64:67], v15 offset:16384
  s_lshr_b32 s29, s27, 1
  v_mfma_f32_16x16x32_bf16 v[164:167], v[224:227], a[4:7], 0
  ds_read_b64_tr_b16 v[246:247], v2 offset:4608
  s_mul_i32 s32, s29, s70
  v_mfma_f32_16x16x32_bf16 v[164:167], v[228:231], a[20:23], v[164:167]
  ds_read_b64_tr_b16 v[248:249], v2 offset:8192
  s_and_b32 s29, s27, 1
  v_mfma_f32_16x16x32_bf16 v[164:167], v[232:235], a[36:39], v[164:167]
  ds_read_b64_tr_b16 v[250:251], v2 offset:8704
  s_mul_i32 s29, s29, s71
  v_mfma_f32_16x16x32_bf16 v[164:167], v[236:239], a[52:55], v[164:167]
  ds_read_b128 a[80:83], v16 offset:16384
  s_add_u32 s32, s32, s29
  v_mfma_f32_16x16x32_bf16 v[168:171], v[224:227], a[8:11], 0
  ds_read_b64_tr_b16 v[252:253], v2 offset:12288
  s_add_u32 s32, s32, s36
  v_mfma_f32_16x16x32_bf16 v[168:171], v[228:231], a[24:27], v[168:171]
  ds_read_b64_tr_b16 v[254:255], v2 offset:12800
  s_add_u32 s27, s27, 1
  v_mfma_f32_16x16x32_bf16 v[168:171], v[232:235], a[40:43], v[168:171]
  ds_read_b128 a[68:71], v15 offset:18432
  s_add_u32 s33, s32, s67
  v_mfma_f32_16x16x32_bf16 v[168:171], v[236:239], a[56:59], v[168:171]
  ds_read_b128 a[84:87], v16 offset:18432
  s_add_u32 s34, s32, s66
  v_mfma_f32_16x16x32_bf16 v[172:175], v[224:227], a[12:15], 0
  ds_read_b128 a[72:75], v15 offset:20480
  s_add_u32 s35, s34, s67
  v_mfma_f32_16x16x32_bf16 v[172:175], v[228:231], a[28:31], v[172:175]
  ds_read_b128 a[88:91], v16 offset:20480
  v_mul_f32 v96, s68, v96
  v_mfma_f32_16x16x32_bf16 v[172:175], v[232:235], a[44:47], v[172:175]
  ds_read_b128 a[76:79], v15 offset:22528
  v_mul_f32 v97, s68, v97
  v_mfma_f32_16x16x32_bf16 v[172:175], v[236:239], a[60:63], v[172:175]
  ds_read_b128 a[92:95], v16 offset:22528
  s_waitcnt lgkmcnt(4)
  v_mfma_f32_16x16x32_bf16 v[176:179], v[240:243], a[0:3], 0
  ds_read_b64_tr_b16 v[224:225], v3 offset:0
  v_mul_f32 v98, s68, v98
  v_mfma_f32_16x16x32_bf16 v[176:179], v[244:247], a[16:19], v[176:179]
  ds_read_b64_tr_b16 v[226:227], v3 offset:512
  v_mul_f32 v99, s68, v99
  v_mfma_f32_16x16x32_bf16 v[176:179], v[248:251], a[32:35], v[176:179]
  ds_read_b64_tr_b16 v[228:229], v3 offset:4096
  v_mul_f32 v112, s68, v112
  v_mfma_f32_16x16x32_bf16 v[176:179], v[252:255], a[48:51], v[176:179]
  v_mul_f32 v113, s68, v113
  v_mul_f32 v114, s68, v114
  v_mfma_f32_16x16x32_bf16 v[180:183], v[240:243], a[4:7], 0
  ds_read_b64_tr_b16 v[230:231], v3 offset:4608
  v_mul_f32 v115, s68, v115
  v_mfma_f32_16x16x32_bf16 v[180:183], v[244:247], a[20:23], v[180:183]
  ds_read_b64_tr_b16 v[232:233], v3 offset:8192
  v_cvt_pk_bf16_f32 v96, v96, v97
  v_mfma_f32_16x16x32_bf16 v[180:183], v[248:251], a[36:39], v[180:183]
  ds_read_b64_tr_b16 v[234:235], v3 offset:8704
  v_cvt_pk_bf16_f32 v97, v98, v99
  v_mfma_f32_16x16x32_bf16 v[180:183], v[252:255], a[52:55], v[180:183]
  v_cvt_pk_bf16_f32 v98, v112, v113
  v_cvt_pk_bf16_f32 v99, v114, v115
  v_mfma_f32_16x16x32_bf16 v[184:187], v[240:243], a[8:11], 0
  ds_read_b64_tr_b16 v[236:237], v3 offset:12288
  v_mul_f32 v100, s68, v100
  v_mfma_f32_16x16x32_bf16 v[184:187], v[244:247], a[24:27], v[184:187]
  ds_read_b64_tr_b16 v[238:239], v3 offset:12800
  v_mul_f32 v101, s68, v101
  v_mfma_f32_16x16x32_bf16 v[184:187], v[248:251], a[40:43], v[184:187]
  v_mul_f32 v102, s68, v102
  v_mul_f32 v103, s68, v103
  v_mfma_f32_16x16x32_bf16 v[184:187], v[252:255], a[56:59], v[184:187]
  v_mul_f32 v116, s68, v116
  v_mul_f32 v117, s68, v117
  v_mfma_f32_16x16x32_bf16 v[188:191], v[240:243], a[12:15], 0
  v_mul_f32 v118, s68, v118
  v_mul_f32 v119, s68, v119
  v_mfma_f32_16x16x32_bf16 v[188:191], v[244:247], a[28:31], v[188:191]
  v_cvt_pk_bf16_f32 v100, v100, v101
  v_cvt_pk_bf16_f32 v101, v102, v103
  v_mfma_f32_16x16x32_bf16 v[188:191], v[248:251], a[44:47], v[188:191]
  v_permlane16_swap_b32 v96, v98
  v_mfma_f32_16x16x32_bf16 v[188:191], v[252:255], a[60:63], v[188:191]
  v_permlane16_swap_b32 v97, v99
  s_waitcnt lgkmcnt(0)
  v_mfma_f32_16x16x32_bf16 v[192:195], v[224:227], a[0:3], 0
  ds_read_b64_tr_b16 v[240:241], v4 offset:0
  v_cvt_pk_bf16_f32 v102, v116, v117
  v_mfma_f32_16x16x32_bf16 v[192:195], v[228:231], a[16:19], v[192:195]
  ds_read_b64_tr_b16 v[242:243], v4 offset:512
  v_cvt_pk_bf16_f32 v103, v118, v119
  v_mfma_f32_16x16x32_bf16 v[192:195], v[232:235], a[32:35], v[192:195]
  ds_read_b64_tr_b16 v[244:245], v4 offset:4096
  buffer_store_dwordx4 v[96:99], v17, s[48:51], s32 offen sc1
  v_mfma_f32_16x16x32_bf16 v[192:195], v[236:239], a[48:51], v[192:195]
  s_add_u32 s32, s32, s65
  v_mul_f32 v104, s68, v104
  v_mfma_f32_16x16x32_bf16 v[196:199], v[224:227], a[4:7], 0
  ds_read_b64_tr_b16 v[246:247], v4 offset:4608
  v_mul_f32 v105, s68, v105
  v_mfma_f32_16x16x32_bf16 v[196:199], v[228:231], a[20:23], v[196:199]
  ds_read_b64_tr_b16 v[248:249], v4 offset:8192
  v_mul_f32 v106, s68, v106
  v_mfma_f32_16x16x32_bf16 v[196:199], v[232:235], a[36:39], v[196:199]
  ds_read_b64_tr_b16 v[250:251], v4 offset:8704
  v_mul_f32 v107, s68, v107
  v_mfma_f32_16x16x32_bf16 v[196:199], v[236:239], a[52:55], v[196:199]
  v_mul_f32 v120, s68, v120
  v_mul_f32 v121, s68, v121
  v_mfma_f32_16x16x32_bf16 v[200:203], v[224:227], a[8:11], 0
  ds_read_b64_tr_b16 v[252:253], v4 offset:12288
  v_mul_f32 v122, s68, v122
  v_mfma_f32_16x16x32_bf16 v[200:203], v[228:231], a[24:27], v[200:203]
  ds_read_b64_tr_b16 v[254:255], v4 offset:12800
  v_mul_f32 v123, s68, v123
  v_mfma_f32_16x16x32_bf16 v[200:203], v[232:235], a[40:43], v[200:203]
  v_cvt_pk_bf16_f32 v104, v104, v105
  v_cvt_pk_bf16_f32 v105, v106, v107
  v_mfma_f32_16x16x32_bf16 v[200:203], v[236:239], a[56:59], v[200:203]
  v_permlane16_swap_b32 v100, v102
  v_mfma_f32_16x16x32_bf16 v[204:207], v[224:227], a[12:15], 0
  v_permlane16_swap_b32 v101, v103
  v_mfma_f32_16x16x32_bf16 v[204:207], v[228:231], a[28:31], v[204:207]
  v_cvt_pk_bf16_f32 v106, v120, v121
  v_mfma_f32_16x16x32_bf16 v[204:207], v[232:235], a[44:47], v[204:207]
  buffer_store_dwordx4 v[100:103], v17, s[48:51], s33 offen sc1
  v_cvt_pk_bf16_f32 v107, v122, v123
  v_mfma_f32_16x16x32_bf16 v[204:207], v[236:239], a[60:63], v[204:207]
  s_add_u32 s33, s33, s65
  s_waitcnt vmcnt(28) lgkmcnt(0)
  s_barrier
  v_mfma_f32_16x16x32_bf16 v[208:211], v[240:243], a[0:3], 0
  ds_read_b64_tr_b16 v[224:225], v1 offset:16384
  s_add_u32 m0, s19, 0
  v_mfma_f32_16x16x32_bf16 v[208:211], v[244:247], a[16:19], v[208:211]
  ds_read_b64_tr_b16 v[226:227], v1 offset:16896
  s_add_u32 s21, s24, 0
  v_mfma_f32_16x16x32_bf16 v[208:211], v[248:251], a[32:35], v[208:211]
  ds_read_b64_tr_b16 v[228:229], v1 offset:20480
  v_mul_f32 v108, s68, v108
  v_mfma_f32_16x16x32_bf16 v[208:211], v[252:255], a[48:51], v[208:211]
  buffer_load_dwordx4 v5, s[12:15], s21 offen offset:0 lds
  v_mul_f32 v109, s68, v109
  v_mfma_f32_16x16x32_bf16 v[212:215], v[240:243], a[4:7], 0
  ds_read_b64_tr_b16 v[230:231], v1 offset:20992
  v_mul_f32 v110, s68, v110
  v_mfma_f32_16x16x32_bf16 v[212:215], v[244:247], a[20:23], v[212:215]
  ds_read_b64_tr_b16 v[232:233], v1 offset:24576
  v_mul_f32 v111, s68, v111
  v_mfma_f32_16x16x32_bf16 v[212:215], v[248:251], a[36:39], v[212:215]
  ds_read_b64_tr_b16 v[234:235], v1 offset:25088
  v_mul_f32 v124, s68, v124
  v_mfma_f32_16x16x32_bf16 v[212:215], v[252:255], a[52:55], v[212:215]
  buffer_load_dwordx4 v6, s[12:15], s21 offen offset:1024 lds
  v_mul_f32 v125, s68, v125
  v_mfma_f32_16x16x32_bf16 v[216:219], v[240:243], a[8:11], 0
  ds_read_b64_tr_b16 v[236:237], v1 offset:28672
  v_mul_f32 v126, s68, v126
  v_mfma_f32_16x16x32_bf16 v[216:219], v[244:247], a[24:27], v[216:219]
  ds_read_b64_tr_b16 v[238:239], v1 offset:29184
  v_mul_f32 v127, s68, v127
  v_mfma_f32_16x16x32_bf16 v[216:219], v[248:251], a[40:43], v[216:219]
  v_cvt_pk_bf16_f32 v108, v108, v109
  v_cvt_pk_bf16_f32 v109, v110, v111
  v_mfma_f32_16x16x32_bf16 v[216:219], v[252:255], a[56:59], v[216:219]
  buffer_load_dwordx4 v7, s[12:15], s21 offen offset:2048 lds
  v_permlane16_swap_b32 v104, v106
  v_mfma_f32_16x16x32_bf16 v[220:223], v[240:243], a[12:15], 0
  v_permlane16_swap_b32 v105, v107
  v_mfma_f32_16x16x32_bf16 v[220:223], v[244:247], a[28:31], v[220:223]
  v_cvt_pk_bf16_f32 v110, v124, v125
  v_cvt_pk_bf16_f32 v111, v126, v127
  v_mfma_f32_16x16x32_bf16 v[220:223], v[248:251], a[44:47], v[220:223]
  buffer_store_dwordx4 v[104:107], v17, s[48:51], s34 offen sc1
  s_add_u32 s34, s34, s65
  v_mfma_f32_16x16x32_bf16 v[220:223], v[252:255], a[60:63], v[220:223]
  buffer_load_dwordx4 v8, s[12:15], s21 offen offset:3072 lds
  s_waitcnt vmcnt(23) lgkmcnt(0)
  v_mfma_f32_16x16x32_bf16 v[32:35], v[224:227], a[0:3], 0
  ds_read_b64_tr_b16 v[240:241], v2 offset:16384
  v_mul_f32 v128, s68, v128
  v_mfma_f32_16x16x32_bf16 v[32:35], v[228:231], a[16:19], v[32:35]
  ds_read_b64_tr_b16 v[242:243], v2 offset:16896
  v_mul_f32 v129, s68, v129
  v_mfma_f32_16x16x32_bf16 v[32:35], v[232:235], a[32:35], v[32:35]
  ds_read_b64_tr_b16 v[244:245], v2 offset:20480
  v_mul_f32 v130, s68, v130
  v_mfma_f32_16x16x32_bf16 v[32:35], v[236:239], a[48:51], v[32:35]
  ds_read_b128 a[96:99], v15 offset:0
  v_mul_f32 v131, s68, v131
  v_mfma_f32_16x16x32_bf16 v[36:39], v[224:227], a[4:7], 0
  ds_read_b64_tr_b16 v[246:247], v2 offset:20992
  v_mul_f32 v144, s68, v144
  v_mfma_f32_16x16x32_bf16 v[36:39], v[228:231], a[20:23], v[36:39]
  ds_read_b64_tr_b16 v[248:249], v2 offset:24576
  v_mul_f32 v145, s68, v145
  v_mfma_f32_16x16x32_bf16 v[36:39], v[232:235], a[36:39], v[36:39]
  ds_read_b64_tr_b16 v[250:251], v2 offset:25088
  v_mul_f32 v146, s68, v146
  v_mfma_f32_16x16x32_bf16 v[36:39], v[236:239], a[52:55], v[36:39]
  ds_read_b128 a[112:115], v16 offset:0
  v_mul_f32 v147, s68, v147
  v_mfma_f32_16x16x32_bf16 v[40:43], v[224:227], a[8:11], 0
  ds_read_b64_tr_b16 v[252:253], v2 offset:28672
  v_cvt_pk_bf16_f32 v128, v128, v129
  v_mfma_f32_16x16x32_bf16 v[40:43], v[228:231], a[24:27], v[40:43]
  ds_read_b64_tr_b16 v[254:255], v2 offset:29184
  v_cvt_pk_bf16_f32 v129, v130, v131
  v_mfma_f32_16x16x32_bf16 v[40:43], v[232:235], a[40:43], v[40:43]
  ds_read_b128 a[100:103], v15 offset:2048
  v_permlane16_swap_b32 v108, v110
  v_mfma_f32_16x16x32_bf16 v[40:43], v[236:239], a[56:59], v[40:43]
  ds_read_b128 a[116:119], v16 offset:2048
  v_permlane16_swap_b32 v109, v111
  v_mfma_f32_16x16x32_bf16 v[44:47], v[224:227], a[12:15], 0
  ds_read_b128 a[104:107], v15 offset:4096
  v_cvt_pk_bf16_f32 v130, v144, v145
  v_mfma_f32_16x16x32_bf16 v[44:47], v[228:231], a[28:31], v[44:47]
  ds_read_b128 a[120:123], v16 offset:4096
  v_cvt_pk_bf16_f32 v131, v146, v147
  v_mfma_f32_16x16x32_bf16 v[44:47], v[232:235], a[44:47], v[44:47]
  ds_read_b128 a[108:111], v15 offset:6144
  buffer_store_dwordx4 v[108:111], v17, s[48:51], s35 offen sc1
  v_mfma_f32_16x16x32_bf16 v[44:47], v[236:239], a[60:63], v[44:47]
  ds_read_b128 a[124:127], v16 offset:6144
  s_waitcnt lgkmcnt(4)
  v_mfma_f32_16x16x32_bf16 v[48:51], v[240:243], a[0:3], 0
  ds_read_b64_tr_b16 v[224:225], v3 offset:16384
  s_add_u32 s35, s35, s65
  v_mfma_f32_16x16x32_bf16 v[48:51], v[244:247], a[16:19], v[48:51]
  ds_read_b64_tr_b16 v[226:227], v3 offset:16896
  v_mul_f32 v132, s68, v132
  v_mfma_f32_16x16x32_bf16 v[48:51], v[248:251], a[32:35], v[48:51]
  ds_read_b64_tr_b16 v[228:229], v3 offset:20480
  v_mul_f32 v133, s68, v133
  v_mfma_f32_16x16x32_bf16 v[48:51], v[252:255], a[48:51], v[48:51]
  v_mul_f32 v134, s68, v134
  v_mul_f32 v135, s68, v135
  v_mfma_f32_16x16x32_bf16 v[52:55], v[240:243], a[4:7], 0
  ds_read_b64_tr_b16 v[230:231], v3 offset:20992
  v_mul_f32 v148, s68, v148
  v_mfma_f32_16x16x32_bf16 v[52:55], v[244:247], a[20:23], v[52:55]
  ds_read_b64_tr_b16 v[232:233], v3 offset:24576
  v_mul_f32 v149, s68, v149
  v_mfma_f32_16x16x32_bf16 v[52:55], v[248:251], a[36:39], v[52:55]
  ds_read_b64_tr_b16 v[234:235], v3 offset:25088
  v_mul_f32 v150, s68, v150
  v_mfma_f32_16x16x32_bf16 v[52:55], v[252:255], a[52:55], v[52:55]
  v_mul_f32 v151, s68, v151
  v_cvt_pk_bf16_f32 v132, v132, v133
  v_mfma_f32_16x16x32_bf16 v[56:59], v[240:243], a[8:11], 0
  ds_read_b64_tr_b16 v[236:237], v3 offset:28672
  v_cvt_pk_bf16_f32 v133, v134, v135
  v_mfma_f32_16x16x32_bf16 v[56:59], v[244:247], a[24:27], v[56:59]
  ds_read_b64_tr_b16 v[238:239], v3 offset:29184
  v_permlane16_swap_b32 v128, v130
  v_mfma_f32_16x16x32_bf16 v[56:59], v[248:251], a[40:43], v[56:59]
  v_permlane16_swap_b32 v129, v131
  v_mfma_f32_16x16x32_bf16 v[56:59], v[252:255], a[56:59], v[56:59]
  v_cvt_pk_bf16_f32 v134, v148, v149
  v_cvt_pk_bf16_f32 v135, v150, v151
  v_mfma_f32_16x16x32_bf16 v[60:63], v[240:243], a[12:15], 0
  buffer_store_dwordx4 v[128:131], v17, s[48:51], s32 offen sc1
  v_mul_f32 v136, s68, v136
  v_mfma_f32_16x16x32_bf16 v[60:63], v[244:247], a[28:31], v[60:63]
  v_mul_f32 v137, s68, v137
  v_mul_f32 v138, s68, v138
  v_mfma_f32_16x16x32_bf16 v[60:63], v[248:251], a[44:47], v[60:63]
  v_mul_f32 v139, s68, v139
  v_mul_f32 v152, s68, v152
  v_mfma_f32_16x16x32_bf16 v[60:63], v[252:255], a[60:63], v[60:63]
  v_mul_f32 v153, s68, v153
  s_waitcnt lgkmcnt(0)
  v_mfma_f32_16x16x32_bf16 v[64:67], v[224:227], a[0:3], 0
  ds_read_b64_tr_b16 v[240:241], v4 offset:16384
  v_mul_f32 v154, s68, v154
  v_mfma_f32_16x16x32_bf16 v[64:67], v[228:231], a[16:19], v[64:67]
  ds_read_b64_tr_b16 v[242:243], v4 offset:16896
  v_mul_f32 v155, s68, v155
  v_mfma_f32_16x16x32_bf16 v[64:67], v[232:235], a[32:35], v[64:67]
  ds_read_b64_tr_b16 v[244:245], v4 offset:20480
  v_cvt_pk_bf16_f32 v136, v136, v137
  v_mfma_f32_16x16x32_bf16 v[64:67], v[236:239], a[48:51], v[64:67]
  v_cvt_pk_bf16_f32 v137, v138, v139
  v_permlane16_swap_b32 v132, v134
  v_mfma_f32_16x16x32_bf16 v[68:71], v[224:227], a[4:7], 0
  ds_read_b64_tr_b16 v[246:247], v4 offset:20992
  v_permlane16_swap_b32 v133, v135
  v_mfma_f32_16x16x32_bf16 v[68:71], v[228:231], a[20:23], v[68:71]
  ds_read_b64_tr_b16 v[248:249], v4 offset:24576
  v_cvt_pk_bf16_f32 v138, v152, v153
  v_mfma_f32_16x16x32_bf16 v[68:71], v[232:235], a[36:39], v[68:71]
  ds_read_b64_tr_b16 v[250:251], v4 offset:25088
  v_cvt_pk_bf16_f32 v139, v154, v155
  v_mfma_f32_16x16x32_bf16 v[68:71], v[236:239], a[52:55], v[68:71]
  buffer_store_dwordx4 v[132:135], v17, s[48:51], s33 offen sc1
  v_mul_f32 v140, s68, v140
  v_mfma_f32_16x16x32_bf16 v[72:75], v[224:227], a[8:11], 0
  ds_read_b64_tr_b16 v[252:253], v4 offset:28672
  v_mul_f32 v141, s68, v141
  v_mfma_f32_16x16x32_bf16 v[72:75], v[228:231], a[24:27], v[72:75]
  ds_read_b64_tr_b16 v[254:255], v4 offset:29184
  v_mul_f32 v142, s68, v142
  v_mfma_f32_16x16x32_bf16 v[72:75], v[232:235], a[40:43], v[72:75]
  v_mul_f32 v143, s68, v143
  v_mul_f32 v156, s68, v156
  v_mfma_f32_16x16x32_bf16 v[72:75], v[236:239], a[56:59], v[72:75]
  v_mul_f32 v157, s68, v157
  v_mul_f32 v158, s68, v158
  v_mfma_f32_16x16x32_bf16 v[76:79], v[224:227], a[12:15], 0
  v_mul_f32 v159, s68, v159
  v_cvt_pk_bf16_f32 v140, v140, v141
  v_mfma_f32_16x16x32_bf16 v[76:79], v[228:231], a[28:31], v[76:79]
  v_cvt_pk_bf16_f32 v141, v142, v143
  v_permlane16_swap_b32 v136, v138
  v_mfma_f32_16x16x32_bf16 v[76:79], v[232:235], a[44:47], v[76:79]
  v_permlane16_swap_b32 v137, v139
  v_mfma_f32_16x16x32_bf16 v[76:79], v[236:239], a[60:63], v[76:79]
  s_waitcnt vmcnt(22) lgkmcnt(0)
  s_barrier
  v_mfma_f32_16x16x32_bf16 v[80:83], v[240:243], a[0:3], 0
  ds_read_b64_tr_b16 v[224:225], v1 offset:32768
  s_add_u32 m0, s19, 16384
  v_mfma_f32_16x16x32_bf16 v[80:83], v[244:247], a[16:19], v[80:83]
  ds_read_b64_tr_b16 v[226:227], v1 offset:33280
  s_add_u32 s21, s24, 128
  v_mfma_f32_16x16x32_bf16 v[80:83], v[248:251], a[32:35], v[80:83]
  ds_read_b64_tr_b16 v[228:229], v1 offset:36864
  v_cvt_pk_bf16_f32 v142, v156, v157
  v_mfma_f32_16x16x32_bf16 v[80:83], v[252:255], a[48:51], v[80:83]
  buffer_load_dwordx4 v5, s[12:15], s21 offen offset:0 lds
  v_cvt_pk_bf16_f32 v143, v158, v159
  v_mfma_f32_16x16x32_bf16 v[84:87], v[240:243], a[4:7], 0
  ds_read_b64_tr_b16 v[230:231], v1 offset:37376
  buffer_store_dwordx4 v[136:139], v17, s[48:51], s34 offen sc1
  v_mfma_f32_16x16x32_bf16 v[84:87], v[244:247], a[20:23], v[84:87]
  ds_read_b64_tr_b16 v[232:233], v1 offset:40960
  s_nop 1
  v_mfma_f32_16x16x32_bf16 v[84:87], v[248:251], a[36:39], v[84:87]
  ds_read_b64_tr_b16 v[234:235], v1 offset:41472
  v_permlane16_swap_b32 v140, v142
  v_permlane16_swap_b32 v141, v143
  v_mfma_f32_16x16x32_bf16 v[84:87], v[252:255], a[52:55], v[84:87]
  buffer_load_dwordx4 v6, s[12:15], s21 offen offset:1024 lds
  buffer_store_dwordx4 v[140:143], v17, s[48:51], s35 offen sc1
  v_mfma_f32_16x16x32_bf16 v[88:91], v[240:243], a[8:11], 0
  ds_read_b64_tr_b16 v[236:237], v1 offset:45056
  v_mfma_f32_16x16x32_bf16 v[88:91], v[244:247], a[24:27], v[88:91]
  ds_read_b64_tr_b16 v[238:239], v1 offset:45568
  v_mfma_f32_16x16x32_bf16 v[88:91], v[248:251], a[40:43], v[88:91]
  v_mfma_f32_16x16x32_bf16 v[88:91], v[252:255], a[56:59], v[88:91]
  buffer_load_dwordx4 v7, s[12:15], s21 offen offset:2048 lds
  v_mfma_f32_16x16x32_bf16 v[92:95], v[240:243], a[12:15], 0
  v_mfma_f32_16x16x32_bf16 v[92:95], v[244:247], a[28:31], v[92:95]
  v_mfma_f32_16x16x32_bf16 v[92:95], v[248:251], a[44:47], v[92:95]
  v_mfma_f32_16x16x32_bf16 v[92:95], v[252:255], a[60:63], v[92:95]
  buffer_load_dwordx4 v8, s[12:15], s21 offen offset:3072 lds
  s_waitcnt vmcnt(20) lgkmcnt(0)
  v_mfma_f32_16x16x32_bf16 v[160:163], v[224:227], a[64:67], v[160:163]
  ds_read_b64_tr_b16 v[240:241], v2 offset:32768
  v_mfma_f32_16x16x32_bf16 v[160:163], v[228:231], a[80:83], v[160:163]
  ds_read_b64_tr_b16 v[242:243], v2 offset:33280
  v_mfma_f32_16x16x32_bf16 v[160:163], v[232:235], a[96:99], v[160:163]
  ds_read_b64_tr_b16 v[244:245], v2 offset:36864
  v_mfma_f32_16x16x32_bf16 v[160:163], v[236:239], a[112:115], v[160:163]
  ds_read_b128 a[128:131], v15 offset:8192
  v_mfma_f32_16x16x32_bf16 v[164:167], v[224:227], a[68:71], v[164:167]
  ds_read_b64_tr_b16 v[246:247], v2 offset:37376
  v_mfma_f32_16x16x32_bf16 v[164:167], v[228:231], a[84:87], v[164:167]
  ds_read_b64_tr_b16 v[248:249], v2 offset:40960
  v_mfma_f32_16x16x32_bf16 v[164:167], v[232:235], a[100:103], v[164:167]
  ds_read_b64_tr_b16 v[250:251], v2 offset:41472
  v_mfma_f32_16x16x32_bf16 v[164:167], v[236:239], a[116:119], v[164:167]
  ds_read_b128 a[144:147], v16 offset:8192
  v_mfma_f32_16x16x32_bf16 v[168:171], v[224:227], a[72:75], v[168:171]
  ds_read_b64_tr_b16 v[252:253], v2 offset:45056
  v_mfma_f32_16x16x32_bf16 v[168:171], v[228:231], a[88:91], v[168:171]
  ds_read_b64_tr_b16 v[254:255], v2 offset:45568
  v_mfma_f32_16x16x32_bf16 v[168:171], v[232:235], a[104:107], v[168:171]
  ds_read_b128 a[132:135], v15 offset:10240
  v_mfma_f32_16x16x32_bf16 v[168:171], v[236:239], a[120:123], v[168:171]
  ds_read_b128 a[148:151], v16 offset:10240
  v_mfma_f32_16x16x32_bf16 v[172:175], v[224:227], a[76:79], v[172:175]
  ds_read_b128 a[136:139], v15 offset:12288
  v_mfma_f32_16x16x32_bf16 v[172:175], v[228:231], a[92:95], v[172:175]
  ds_read_b128 a[152:155], v16 offset:12288
  v_mfma_f32_16x16x32_bf16 v[172:175], v[232:235], a[108:111], v[172:175]
  ds_read_b128 a[140:143], v15 offset:14336
  v_mfma_f32_16x16x32_bf16 v[172:175], v[236:239], a[124:127], v[172:175]
  ds_read_b128 a[156:159], v16 offset:14336
  s_waitcnt lgkmcnt(4)
  v_mfma_f32_16x16x32_bf16 v[176:179], v[240:243], a[64:67], v[176:179]
  ds_read_b64_tr_b16 v[224:225], v3 offset:32768
  s_add_u32 m0, s20, 16256
  v_mfma_f32_16x16x32_bf16 v[176:179], v[244:247], a[80:83], v[176:179]
  ds_read_b64_tr_b16 v[226:227], v3 offset:33280
  s_add_u32 s28, s25, s78
  v_mfma_f32_16x16x32_bf16 v[176:179], v[248:251], a[96:99], v[176:179]
  ds_read_b64_tr_b16 v[228:229], v3 offset:36864
  v_mfma_f32_16x16x32_bf16 v[176:179], v[252:255], a[112:115], v[176:179]
  buffer_load_dwordx4 v9, s[44:47], s28 offen offset:128 lds
  v_mfma_f32_16x16x32_bf16 v[180:183], v[240:243], a[68:71], v[180:183]
  ds_read_b64_tr_b16 v[230:231], v3 offset:37376
  v_mfma_f32_16x16x32_bf16 v[180:183], v[244:247], a[84:87], v[180:183]
  ds_read_b64_tr_b16 v[232:233], v3 offset:40960
  v_mfma_f32_16x16x32_bf16 v[180:183], v[248:251], a[100:103], v[180:183]
  ds_read_b64_tr_b16 v[234:235], v3 offset:41472
  v_mfma_f32_16x16x32_bf16 v[180:183], v[252:255], a[116:119], v[180:183]
  buffer_load_dwordx4 v10, s[44:47], s28 offen offset:1152 lds
  v_mfma_f32_16x16x32_bf16 v[184:187], v[240:243], a[72:75], v[184:187]
  ds_read_b64_tr_b16 v[236:237], v3 offset:45056
  v_mfma_f32_16x16x32_bf16 v[184:187], v[244:247], a[88:91], v[184:187]
  ds_read_b64_tr_b16 v[238:239], v3 offset:45568
  v_mfma_f32_16x16x32_bf16 v[184:187], v[248:251], a[104:107], v[184:187]
  v_mfma_f32_16x16x32_bf16 v[184:187], v[252:255], a[120:123], v[184:187]
  buffer_load_dwordx4 v11, s[44:47], s28 offen offset:2176 lds
  v_mfma_f32_16x16x32_bf16 v[188:191], v[240:243], a[76:79], v[188:191]
  v_mfma_f32_16x16x32_bf16 v[188:191], v[244:247], a[92:95], v[188:191]
  v_mfma_f32_16x16x32_bf16 v[188:191], v[248:251], a[108:111], v[188:191]
  v_mfma_f32_16x16x32_bf16 v[188:191], v[252:255], a[124:127], v[188:191]
  buffer_load_dwordx4 v12, s[44:47], s28 offen offset:3200 lds
  s_waitcnt lgkmcnt(0)
  v_mfma_f32_16x16x32_bf16 v[192:195], v[224:227], a[64:67], v[192:195]
  ds_read_b64_tr_b16 v[240:241], v4 offset:32768
  s_add_u32 m0, s20, 20352
  v_mfma_f32_16x16x32_bf16 v[192:195], v[228:231], a[80:83], v[192:195]
  ds_read_b64_tr_b16 v[242:243], v4 offset:33280
  s_add_u32 s28, s26, s78
  v_mfma_f32_16x16x32_bf16 v[192:195], v[232:235], a[96:99], v[192:195]
  ds_read_b64_tr_b16 v[244:245], v4 offset:36864
  v_mfma_f32_16x16x32_bf16 v[192:195], v[236:239], a[112:115], v[192:195]
  buffer_load_dwordx4 v9, s[44:47], s28 offen offset:128 lds
  v_mfma_f32_16x16x32_bf16 v[196:199], v[224:227], a[68:71], v[196:199]
  ds_read_b64_tr_b16 v[246:247], v4 offset:37376
  v_mfma_f32_16x16x32_bf16 v[196:199], v[228:231], a[84:87], v[196:199]
  ds_read_b64_tr_b16 v[248:249], v4 offset:40960
  v_mfma_f32_16x16x32_bf16 v[196:199], v[232:235], a[100:103], v[196:199]
  ds_read_b64_tr_b16 v[250:251], v4 offset:41472
  v_mfma_f32_16x16x32_bf16 v[196:199], v[236:239], a[116:119], v[196:199]
  buffer_load_dwordx4 v10, s[44:47], s28 offen offset:1152 lds
  v_mfma_f32_16x16x32_bf16 v[200:203], v[224:227], a[72:75], v[200:203]
  ds_read_b64_tr_b16 v[252:253], v4 offset:45056
  v_mfma_f32_16x16x32_bf16 v[200:203], v[228:231], a[88:91], v[200:203]
  ds_read_b64_tr_b16 v[254:255], v4 offset:45568
  v_mfma_f32_16x16x32_bf16 v[200:203], v[232:235], a[104:107], v[200:203]
  v_mfma_f32_16x16x32_bf16 v[200:203], v[236:239], a[120:123], v[200:203]
  buffer_load_dwordx4 v11, s[44:47], s28 offen offset:2176 lds
  v_mfma_f32_16x16x32_bf16 v[204:207], v[224:227], a[76:79], v[204:207]
  v_mfma_f32_16x16x32_bf16 v[204:207], v[228:231], a[92:95], v[204:207]
  v_mfma_f32_16x16x32_bf16 v[204:207], v[232:235], a[108:111], v[204:207]
  v_mfma_f32_16x16x32_bf16 v[204:207], v[236:239], a[124:127], v[204:207]
  buffer_load_dwordx4 v12, s[44:47], s28 offen offset:3200 lds
  s_waitcnt vmcnt(24)
  s_waitcnt vmcnt(10) lgkmcnt(0)
  s_barrier
  s_cmp_lg_u32 s16, 0
  s_cbranch_scc1 P2_S
  s_lshl_b32 s37, s4, 7
  s_lshr_b32 s31, s30, 1
  s_add_u32 s37, s37, s31
  s_add_u32 s37, s37, 81788928
  v_mov_b32 v26, 1
  s_mov_b64 exec, 1
  buffer_store_dword v26, off, s[8:11], s37 sc1
  s_mov_b64 exec, -1
P2_S:
  v_mfma_f32_16x16x32_bf16 v[208:211], v[240:243], a[64:67], v[208:211]
  ds_read_b64_tr_b16 v[224:225], v1 offset:49152
  s_add_u32 m0, s19, 32768
  v_mfma_f32_16x16x32_bf16 v[208:211], v[244:247], a[80:83], v[208:211]
  ds_read_b64_tr_b16 v[226:227], v1 offset:49664
  s_add_u32 s21, s38, 0
  v_mfma_f32_16x16x32_bf16 v[208:211], v[248:251], a[96:99], v[208:211]
  ds_read_b64_tr_b16 v[228:229], v1 offset:53248
  v_mfma_f32_16x16x32_bf16 v[208:211], v[252:255], a[112:115], v[208:211]
  buffer_load_dwordx4 v5, s[12:15], s21 offen offset:0 lds
  v_mfma_f32_16x16x32_bf16 v[212:215], v[240:243], a[68:71], v[212:215]
  ds_read_b64_tr_b16 v[230:231], v1 offset:53760
  v_mfma_f32_16x16x32_bf16 v[212:215], v[244:247], a[84:87], v[212:215]
  ds_read_b64_tr_b16 v[232:233], v1 offset:57344
  v_mfma_f32_16x16x32_bf16 v[212:215], v[248:251], a[100:103], v[212:215]
  ds_read_b64_tr_b16 v[234:235], v1 offset:57856
  v_mfma_f32_16x16x32_bf16 v[212:215], v[252:255], a[116:119], v[212:215]
  buffer_load_dwordx4 v6, s[12:15], s21 offen offset:1024 lds
  v_mfma_f32_16x16x32_bf16 v[216:219], v[240:243], a[72:75], v[216:219]
  ds_read_b64_tr_b16 v[236:237], v1 offset:61440
  v_mfma_f32_16x16x32_bf16 v[216:219], v[244:247], a[88:91], v[216:219]
  ds_read_b64_tr_b16 v[238:239], v1 offset:61952
  v_mfma_f32_16x16x32_bf16 v[216:219], v[248:251], a[104:107], v[216:219]
  v_mfma_f32_16x16x32_bf16 v[216:219], v[252:255], a[120:123], v[216:219]
  buffer_load_dwordx4 v7, s[12:15], s21 offen offset:2048 lds
  v_mfma_f32_16x16x32_bf16 v[220:223], v[240:243], a[76:79], v[220:223]
  v_mfma_f32_16x16x32_bf16 v[220:223], v[244:247], a[92:95], v[220:223]
  v_mfma_f32_16x16x32_bf16 v[220:223], v[248:251], a[108:111], v[220:223]
  v_mfma_f32_16x16x32_bf16 v[220:223], v[252:255], a[124:127], v[220:223]
  buffer_load_dwordx4 v8, s[12:15], s21 offen offset:3072 lds
  s_waitcnt lgkmcnt(0)
  v_mfma_f32_16x16x32_bf16 v[32:35], v[224:227], a[64:67], v[32:35]
  ds_read_b64_tr_b16 v[240:241], v2 offset:49152
  s_add_u32 m0, s20, 0
  v_mfma_f32_16x16x32_bf16 v[32:35], v[228:231], a[80:83], v[32:35]
  ds_read_b64_tr_b16 v[242:243], v2 offset:49664
  s_add_u32 s28, s25, s79
  v_mfma_f32_16x16x32_bf16 v[32:35], v[232:235], a[96:99], v[32:35]
  ds_read_b64_tr_b16 v[244:245], v2 offset:53248
  s_lshl_b32 s29, s17, 1
  v_mfma_f32_16x16x32_bf16 v[32:35], v[236:239], a[112:115], v[32:35]
  buffer_load_dwordx4 v9, s[44:47], s28 offen offset:0 lds
  s_mul_hi_u32 s72, s29, 858993460
  v_mfma_f32_16x16x32_bf16 v[36:39], v[224:227], a[68:71], v[36:39]
  ds_read_b64_tr_b16 v[246:247], v2 offset:53760
  s_add_u32 s29, s29, 1
  v_mfma_f32_16x16x32_bf16 v[36:39], v[228:231], a[84:87], v[36:39]
  ds_read_b64_tr_b16 v[248:249], v2 offset:57344
  s_mul_hi_u32 s73, s29, 858993460
  v_mfma_f32_16x16x32_bf16 v[36:39], v[232:235], a[100:103], v[36:39]
  ds_read_b64_tr_b16 v[250:251], v2 offset:57856
  s_add_u32 s74, s72, 13
  v_mfma_f32_16x16x32_bf16 v[36:39], v[236:239], a[116:119], v[36:39]
  buffer_load_dwordx4 v10, s[44:47], s28 offen offset:1024 lds
  s_add_u32 s75, s73, 13
  v_mfma_f32_16x16x32_bf16 v[40:43], v[224:227], a[72:75], v[40:43]
  ds_read_b64_tr_b16 v[252:253], v2 offset:61440
  s_lshr_b32 s29, s17, 4
  v_mfma_f32_16x16x32_bf16 v[40:43], v[228:231], a[88:91], v[40:43]
  ds_read_b64_tr_b16 v[254:255], v2 offset:61952
  s_add_u32 s32, s29, 26
  v_mfma_f32_16x16x32_bf16 v[40:43], v[232:235], a[104:107], v[40:43]
  s_add_u32 s33, s29, 28
  s_add_u32 s34, s29, 30
  v_mov_b32 v27, 28
  v_mfma_f32_16x16x32_bf16 v[40:43], v[236:239], a[120:123], v[40:43]
  buffer_load_dwordx4 v11, s[44:47], s28 offen offset:2048 lds
  v_cmp_eq_u32 vcc, 0, v18
  v_mfma_f32_16x16x32_bf16 v[44:47], v[224:227], a[76:79], v[44:47]
  v_mov_b32 v29, s72
  s_nop 0
  v_mfma_f32_16x16x32_bf16 v[44:47], v[228:231], a[92:95], v[44:47]
  v_cndmask_b32 v27, v27, v29, vcc
  v_cmp_eq_u32 vcc, 1, v18
  v_mfma_f32_16x16x32_bf16 v[44:47], v[232:235], a[108:111], v[44:47]
  v_mov_b32 v29, s73
  v_mfma_f32_16x16x32_bf16 v[44:47], v[236:239], a[124:127], v[44:47]
  buffer_load_dwordx4 v12, s[44:47], s28 offen offset:3072 lds
  s_waitcnt lgkmcnt(0)
  v_mfma_f32_16x16x32_bf16 v[48:51], v[240:243], a[64:67], v[48:51]
  ds_read_b64_tr_b16 v[224:225], v3 offset:49152
  s_add_u32 m0, s20, 4096
  v_mfma_f32_16x16x32_bf16 v[48:51], v[244:247], a[80:83], v[48:51]
  ds_read_b64_tr_b16 v[226:227], v3 offset:49664
  s_add_u32 s28, s26, s79
  v_mfma_f32_16x16x32_bf16 v[48:51], v[248:251], a[96:99], v[48:51]
  ds_read_b64_tr_b16 v[228:229], v3 offset:53248
  s_nop 0
  v_mfma_f32_16x16x32_bf16 v[48:51], v[252:255], a[112:115], v[48:51]
  buffer_load_dwordx4 v9, s[44:47], s28 offen offset:0 lds
  v_cndmask_b32 v27, v27, v29, vcc
  v_mfma_f32_16x16x32_bf16 v[52:55], v[240:243], a[68:71], v[52:55]
  ds_read_b64_tr_b16 v[230:231], v3 offset:53760
  v_cmp_eq_u32 vcc, 2, v18
  v_mfma_f32_16x16x32_bf16 v[52:55], v[244:247], a[84:87], v[52:55]
  ds_read_b64_tr_b16 v[232:233], v3 offset:57344
  v_mov_b32 v29, s74
  v_mfma_f32_16x16x32_bf16 v[52:55], v[248:251], a[100:103], v[52:55]
  ds_read_b64_tr_b16 v[234:235], v3 offset:57856
  s_nop 0
  v_mfma_f32_16x16x32_bf16 v[52:55], v[252:255], a[116:119], v[52:55]
  buffer_load_dwordx4 v10, s[44:47], s28 offen offset:1024 lds
  v_cndmask_b32 v27, v27, v29, vcc
  v_mfma_f32_16x16x32_bf16 v[56:59], v[240:243], a[72:75], v[56:59]
  ds_read_b64_tr_b16 v[236:237], v3 offset:61440
  v_cmp_eq_u32 vcc, 3, v18
  v_mfma_f32_16x16x32_bf16 v[56:59], v[244:247], a[88:91], v[56:59]
  ds_read_b64_tr_b16 v[238:239], v3 offset:61952
  v_mov_b32 v29, s75
  v_mfma_f32_16x16x32_bf16 v[56:59], v[248:251], a[104:107], v[56:59]
  s_nop 0
  v_cndmask_b32 v27, v27, v29, vcc
  v_cmp_eq_u32 vcc, 4, v18
  v_mfma_f32_16x16x32_bf16 v[56:59], v[252:255], a[120:123], v[56:59]
  buffer_load_dwordx4 v11, s[44:47], s28 offen offset:2048 lds
  v_mov_b32 v29, s32
  v_mfma_f32_16x16x32_bf16 v[60:63], v[240:243], a[76:79], v[60:63]
  s_nop 0
  v_cndmask_b32 v27, v27, v29, vcc
  v_cmp_eq_u32 vcc, 5, v18
  v_mfma_f32_16x16x32_bf16 v[60:63], v[244:247], a[92:95], v[60:63]
  v_mov_b32 v29, s33
  s_nop 0
  v_mfma_f32_16x16x32_bf16 v[60:63], v[248:251], a[108:111], v[60:63]
  v_cndmask_b32 v27, v27, v29, vcc
  v_mfma_f32_16x16x32_bf16 v[60:63], v[252:255], a[124:127], v[60:63]
  buffer_load_dwordx4 v12, s[44:47], s28 offen offset:3072 lds
  s_waitcnt vmcnt(12) lgkmcnt(0)
  v_mfma_f32_16x16x32_bf16 v[64:67], v[224:227], a[64:67], v[64:67]
  ds_read_b64_tr_b16 v[240:241], v4 offset:49152
  v_cmp_eq_u32 vcc, 6, v18
  v_mfma_f32_16x16x32_bf16 v[64:67], v[228:231], a[80:83], v[64:67]
  ds_read_b64_tr_b16 v[242:243], v4 offset:49664
  v_mov_b32 v29, s34
  v_mfma_f32_16x16x32_bf16 v[64:67], v[232:235], a[96:99], v[64:67]
  ds_read_b64_tr_b16 v[244:245], v4 offset:53248
  s_nop 0
  v_mfma_f32_16x16x32_bf16 v[64:67], v[236:239], a[112:115], v[64:67]
  ds_read_b128 a[160:163], v15 offset:16384
  v_cndmask_b32 v27, v27, v29, vcc
  v_mfma_f32_16x16x32_bf16 v[68:71], v[224:227], a[68:71], v[68:71]
  ds_read_b64_tr_b16 v[246:247], v4 offset:53760
  v_and_b32 v29, 7, v20
  v_mfma_f32_16x16x32_bf16 v[68:71], v[228:231], a[84:87], v[68:71]
  ds_read_b64_tr_b16 v[248:249], v4 offset:57344
  v_lshlrev_b32 v29, 2, v29
  v_mfma_f32_16x16x32_bf16 v[68:71], v[232:235], a[100:103], v[68:71]
  ds_read_b64_tr_b16 v[250:251], v4 offset:57856
  v_lshl_add_u32 v27, v27, 7, v29
  v_mfma_f32_16x16x32_bf16 v[68:71], v[236:239], a[116:119], v[68:71]
  ds_read_b128 a[176:179], v16 offset:16384
  v_add_u32 v27, 81788928, v27
  v_mfma_f32_16x16x32_bf16 v[72:75], v[224:227], a[72:75], v[72:75]
  ds_read_b64_tr_b16 v[252:253], v4 offset:61440
  v_and_b32 v29, 1, v20
  v_mfma_f32_16x16x32_bf16 v[72:75], v[228:231], a[88:91], v[72:75]
  ds_read_b64_tr_b16 v[254:255], v4 offset:61952
  v_lshlrev_b32 v29, 7, v29
  v_mfma_f32_16x16x32_bf16 v[72:75], v[232:235], a[104:107], v[72:75]
  ds_read_b128 a[164:167], v15 offset:18432
  v_mov_b32 v30, 128
  v_mfma_f32_16x16x32_bf16 v[72:75], v[236:239], a[120:123], v[72:75]
  ds_read_b128 a[180:183], v16 offset:18432
  v_mfma_f32_16x16x32_bf16 v[76:79], v[224:227], a[76:79], v[76:79]
  ds_read_b128 a[168:171], v15 offset:20480
  v_mfma_f32_16x16x32_bf16 v[76:79], v[228:231], a[92:95], v[76:79]
  ds_read_b128 a[184:187], v16 offset:20480
  v_mfma_f32_16x16x32_bf16 v[76:79], v[232:235], a[108:111], v[76:79]
  ds_read_b128 a[172:175], v15 offset:22528
  v_mfma_f32_16x16x32_bf16 v[76:79], v[236:239], a[124:127], v[76:79]
  ds_read_b128 a[188:191], v16 offset:22528
  s_waitcnt vmcnt(29) lgkmcnt(4)
  s_barrier
  s_cmp_lg_u32 s16, 0
  s_cbranch_scc1 P2_L0
  buffer_load_dword v31, v29, s[40:43], 0 offen sc1
P2_L0:
  v_mfma_f32_16x16x32_bf16 v[80:83], v[240:243], a[64:67], v[80:83]
  ds_read_b64_tr_b16 v[224:225], v1 offset:0
  s_add_u32 m0, s19, 49152
  v_mfma_f32_16x16x32_bf16 v[80:83], v[244:247], a[80:83], v[80:83]
  ds_read_b64_tr_b16 v[226:227], v1 offset:512
  s_add_u32 s21, s38, 128
  v_mfma_f32_16x16x32_bf16 v[80:83], v[248:251], a[96:99], v[80:83]
  ds_read_b64_tr_b16 v[228:229], v1 offset:4096
  s_mov_b64 s[52:53], s[6:7]
  v_mfma_f32_16x16x32_bf16 v[80:83], v[252:255], a[112:115], v[80:83]
  buffer_load_dwordx4 v5, s[12:15], s21 offen offset:0 lds
  s_load_dwordx2 s[96:97], s[0:1], 40
  v_mfma_f32_16x16x32_bf16 v[84:87], v[240:243], a[68:71], v[84:87]
  ds_read_b64_tr_b16 v[230:231], v1 offset:4608
  s_load_dwordx2 s[48:49], s[0:1], 64
  v_mfma_f32_16x16x32_bf16 v[84:87], v[244:247], a[84:87], v[84:87]
  ds_read_b64_tr_b16 v[232:233], v1 offset:8192
  s_mov_b32 s54, P1_TAB-P1_PC
  v_mfma_f32_16x16x32_bf16 v[84:87], v[248:251], a[100:103], v[84:87]
  ds_read_b64_tr_b16 v[234:235], v1 offset:8704
  s_mov_b32 s98, 4194304
  v_mfma_f32_16x16x32_bf16 v[84:87], v[252:255], a[116:119], v[84:87]
  buffer_load_dwordx4 v6, s[12:15], s21 offen offset:1024 lds
  v_mfma_f32_16x16x32_bf16 v[88:91], v[240:243], a[72:75], v[88:91]
  ds_read_b64_tr_b16 v[236:237], v1 offset:12288
  v_mfma_f32_16x16x32_bf16 v[88:91], v[244:247], a[88:91], v[88:91]
  ds_read_b64_tr_b16 v[238:239], v1 offset:12800
  s_mov_b32 s55, 0x20000
  v_mfma_f32_16x16x32_bf16 v[88:91], v[248:251], a[104:107], v[88:91]
  s_mov_b32 s99, 0x20000
  v_mfma_f32_16x16x32_bf16 v[88:91], v[252:255], a[120:123], v[88:91]
  buffer_load_dwordx4 v7, s[12:15], s21 offen offset:2048 lds
  s_mov_b32 s50, 524288
  v_mfma_f32_16x16x32_bf16 v[92:95], v[240:243], a[76:79], v[92:95]
  buffer_load_dword v23, v22, s[52:55], 0 offen
  v_mfma_f32_16x16x32_bf16 v[92:95], v[244:247], a[92:95], v[92:95]
  v_mfma_f32_16x16x32_bf16 v[92:95], v[248:251], a[108:111], v[92:95]
  v_mfma_f32_16x16x32_bf16 v[92:95], v[252:255], a[124:127], v[92:95]
  buffer_load_dwordx4 v8, s[12:15], s21 offen offset:3072 lds
  s_waitcnt lgkmcnt(0)
  v_mfma_f32_16x16x32_bf16 v[160:163], v[224:227], a[128:131], v[160:163]
  ds_read_b64_tr_b16 v[240:241], v2 offset:0
  s_add_u32 m0, s20, 8064
  v_mfma_f32_16x16x32_bf16 v[160:163], v[228:231], a[144:147], v[160:163]
  ds_read_b64_tr_b16 v[242:243], v2 offset:512
  s_add_u32 s28, s25, s79
  v_mfma_f32_16x16x32_bf16 v[160:163], v[232:235], a[160:163], v[160:163]
  ds_read_b64_tr_b16 v[244:245], v2 offset:4096
  s_lshl_b32 s69, s18, 1
  v_mfma_f32_16x16x32_bf16 v[160:163], v[236:239], a[176:179], v[160:163]
  buffer_load_dwordx4 v9, s[44:47], s28 offen offset:128 lds
  v_mfma_f32_16x16x32_bf16 v[164:167], v[224:227], a[132:135], v[164:167]
  ds_read_b64_tr_b16 v[246:247], v2 offset:4608
  v_mfma_f32_16x16x32_bf16 v[164:167], v[228:231], a[148:151], v[164:167]
  ds_read_b64_tr_b16 v[248:249], v2 offset:8192
  v_mfma_f32_16x16x32_bf16 v[164:167], v[232:235], a[164:167], v[164:167]
  ds_read_b64_tr_b16 v[250:251], v2 offset:8704
  s_lshl_b32 s61, s16, 13
  v_mfma_f32_16x16x32_bf16 v[164:167], v[236:239], a[180:183], v[164:167]
  buffer_load_dwordx4 v10, s[44:47], s28 offen offset:1152 lds
  v_mfma_f32_16x16x32_bf16 v[168:171], v[224:227], a[136:139], v[168:171]
  ds_read_b64_tr_b16 v[252:253], v2 offset:12288
  v_mfma_f32_16x16x32_bf16 v[168:171], v[228:231], a[152:155], v[168:171]
  ds_read_b64_tr_b16 v[254:255], v2 offset:12800
  v_mfma_f32_16x16x32_bf16 v[168:171], v[232:235], a[168:171], v[168:171]
  v_mfma_f32_16x16x32_bf16 v[168:171], v[236:239], a[184:187], v[168:171]
  buffer_load_dwordx4 v11, s[44:47], s28 offen offset:2176 lds
  v_mfma_f32_16x16x32_bf16 v[172:175], v[224:227], a[140:143], v[172:175]
  v_mfma_f32_16x16x32_bf16 v[172:175], v[228:231], a[156:159], v[172:175]
  v_lshlrev_b32 v24, 4, v20
  v_mfma_f32_16x16x32_bf16 v[172:175], v[232:235], a[172:175], v[172:175]
  v_mfma_f32_16x16x32_bf16 v[172:175], v[236:239], a[188:191], v[172:175]
  buffer_load_dwordx4 v12, s[44:47], s28 offen offset:3200 lds
  s_waitcnt lgkmcnt(0)
  v_mfma_f32_16x16x32_bf16 v[176:179], v[240:243], a[128:131], v[176:179]
  ds_read_b64_tr_b16 v[224:225], v3 offset:0
  s_add_u32 m0, s20, 12160
  v_mfma_f32_16x16x32_bf16 v[176:179], v[244:247], a[144:147], v[176:179]
  ds_read_b64_tr_b16 v[226:227], v3 offset:512
  s_add_u32 s28, s26, s79
  v_mfma_f32_16x16x32_bf16 v[176:179], v[248:251], a[160:163], v[176:179]
  ds_read_b64_tr_b16 v[228:229], v3 offset:4096
  v_mfma_f32_16x16x32_bf16 v[176:179], v[252:255], a[176:179], v[176:179]
  buffer_load_dwordx4 v9, s[44:47], s28 offen offset:128 lds
  v_add_u32 v24, s61, v24
  v_mfma_f32_16x16x32_bf16 v[180:183], v[240:243], a[132:135], v[180:183]
  ds_read_b64_tr_b16 v[230:231], v3 offset:4608
  v_mfma_f32_16x16x32_bf16 v[180:183], v[244:247], a[148:151], v[180:183]
  ds_read_b64_tr_b16 v[232:233], v3 offset:8192
  v_mfma_f32_16x16x32_bf16 v[180:183], v[248:251], a[164:167], v[180:183]
  ds_read_b64_tr_b16 v[234:235], v3 offset:8704
  v_mfma_f32_16x16x32_bf16 v[180:183], v[252:255], a[180:183], v[180:183]
  buffer_load_dwordx4 v10, s[44:47], s28 offen offset:1152 lds
  v_mfma_f32_16x16x32_bf16 v[184:187], v[240:243], a[136:139], v[184:187]
  ds_read_b64_tr_b16 v[236:237], v3 offset:12288
  v_mfma_f32_16x16x32_bf16 v[184:187], v[244:247], a[152:155], v[184:187]
  ds_read_b64_tr_b16 v[238:239], v3 offset:12800
  v_mfma_f32_16x16x32_bf16 v[184:187], v[248:251], a[168:171], v[184:187]
  s_lshl_b32 s65, s18, 2
  v_mfma_f32_16x16x32_bf16 v[184:187], v[252:255], a[184:187], v[184:187]
  buffer_load_dwordx4 v11, s[44:47], s28 offen offset:2176 lds
  v_mfma_f32_16x16x32_bf16 v[188:191], v[240:243], a[140:143], v[188:191]
  v_mfma_f32_16x16x32_bf16 v[188:191], v[244:247], a[156:159], v[188:191]
  v_mfma_f32_16x16x32_bf16 v[188:191], v[248:251], a[172:175], v[188:191]
  v_mfma_f32_16x16x32_bf16 v[188:191], v[252:255], a[188:191], v[188:191]
  buffer_load_dwordx4 v12, s[44:47], s28 offen offset:3200 lds
  s_waitcnt lgkmcnt(0)
  v_mfma_f32_16x16x32_bf16 v[192:195], v[224:227], a[128:131], v[192:195]
  ds_read_b64_tr_b16 v[240:241], v4 offset:0
  v_lshrrev_b32 v9, 3, v20
  v_mfma_f32_16x16x32_bf16 v[192:195], v[228:231], a[144:147], v[192:195]
  ds_read_b64_tr_b16 v[242:243], v4 offset:512
  v_and_b32 v10, 7, v20
  v_mfma_f32_16x16x32_bf16 v[192:195], v[232:235], a[160:163], v[192:195]
  ds_read_b64_tr_b16 v[244:245], v4 offset:4096
  v_bfe_u32 v11, v20, 4, 1
  v_mfma_f32_16x16x32_bf16 v[192:195], v[236:239], a[176:179], v[192:195]
  s_load_dwordx2 s[44:45], s[0:1], 80
  s_add_u32 s65, s65, s16
  v_lshlrev_b32 v11, 2, v11
  v_mfma_f32_16x16x32_bf16 v[196:199], v[224:227], a[132:135], v[196:199]
  ds_read_b64_tr_b16 v[246:247], v4 offset:4608
  v_xor_b32 v10, v10, v11
  v_mfma_f32_16x16x32_bf16 v[196:199], v[228:231], a[148:151], v[196:199]
  ds_read_b64_tr_b16 v[248:249], v4 offset:8192
  v_mfma_f32_16x16x32_bf16 v[196:199], v[232:235], a[164:167], v[196:199]
  ds_read_b64_tr_b16 v[250:251], v4 offset:8704
  v_lshlrev_b32 v10, 4, v10
  v_mfma_f32_16x16x32_bf16 v[196:199], v[236:239], a[180:183], v[196:199]
  s_sub_u32 s66, 63, s65
  v_lshl_add_u32 v9, v9, 10, v10
  v_mfma_f32_16x16x32_bf16 v[200:203], v[224:227], a[136:139], v[200:203]
  ds_read_b64_tr_b16 v[252:253], v4 offset:12288
  s_lshl_b32 s100, s17, 2
  v_mfma_f32_16x16x32_bf16 v[200:203], v[228:231], a[152:155], v[200:203]
  ds_read_b64_tr_b16 v[254:255], v4 offset:12800
  s_add_u32 s100, s100, s16
  v_mfma_f32_16x16x32_bf16 v[200:203], v[232:235], a[168:171], v[200:203]
  v_mfma_f32_16x16x32_bf16 v[200:203], v[236:239], a[184:187], v[200:203]
  s_lshl_b32 s101, s100, 15
  v_mfma_f32_16x16x32_bf16 v[204:207], v[224:227], a[140:143], v[204:207]
  s_lshl_b32 s7, s18, 7
  v_mfma_f32_16x16x32_bf16 v[204:207], v[228:231], a[156:159], v[204:207]
  s_add_u32 s101, s101, s7
  s_sub_u32 s64, 32, s69
  v_mfma_f32_16x16x32_bf16 v[204:207], v[232:235], a[172:175], v[204:207]
  s_lshl_b32 s7, s16, 12
  v_mfma_f32_16x16x32_bf16 v[204:207], v[236:239], a[188:191], v[204:207]
  s_waitcnt vmcnt(33) lgkmcnt(0)
  s_cmp_lg_u32 s16, 0
  s_cbranch_scc1 P2_C
  s_mov_b32 s31, 0x100000
  s_waitcnt vmcnt(13)
P2_CL:
  v_cmp_gt_u32 vcc, v30, v31
  s_cmp_eq_u32 vcc_lo, 0
  s_cbranch_scc1 P2_C
  s_sleep 8
  buffer_load_dword v31, v29, s[40:43], 0 offen sc1
  s_waitcnt vmcnt(0)
  s_sub_u32 s31, s31, 1
  s_cmp_lg_u32 s31, 0
  s_cbranch_scc1 P2_CL
P2_C:
  s_barrier
  s_cmp_lg_u32 s16, 0
  s_cbranch_scc1 P2_L1
  buffer_load_dword v31, v27, s[8:11], 0 offen sc1
P2_L1:
  v_mfma_f32_16x16x32_bf16 v[208:211], v[240:243], a[128:131], v[208:211]
  ds_read_b64_tr_b16 v[224:225], v1 offset:16384
  s_add_u32 m0, s7, 0
  v_mfma_f32_16x16x32_bf16 v[208:211], v[244:247], a[144:147], v[208:211]
  ds_read_b64_tr_b16 v[226:227], v1 offset:16896
  s_add_u32 s6, s101, 0
  v_mfma_f32_16x16x32_bf16 v[208:211], v[248:251], a[160:163], v[208:211]
  ds_read_b64_tr_b16 v[228:229], v1 offset:20480
  v_mfma_f32_16x16x32_bf16 v[208:211], v[252:255], a[176:179], v[208:211]
  buffer_load_dwordx4 v9, s[96:99], s6 offen nt lds
  s_add_u32 m0, s7, 1024
  v_mfma_f32_16x16x32_bf16 v[212:215], v[240:243], a[132:135], v[212:215]
  ds_read_b64_tr_b16 v[230:231], v1 offset:20992
  s_add_u32 s6, s101, 8192
  v_mfma_f32_16x16x32_bf16 v[212:215], v[244:247], a[148:151], v[212:215]
  ds_read_b64_tr_b16 v[232:233], v1 offset:24576
  s_lshl_b32 s63, s17, 20
  v_mfma_f32_16x16x32_bf16 v[212:215], v[248:251], a[164:167], v[212:215]
  ds_read_b64_tr_b16 v[234:235], v1 offset:25088
  v_mfma_f32_16x16x32_bf16 v[212:215], v[252:255], a[180:183], v[212:215]
  buffer_load_dwordx4 v9, s[96:99], s6 offen nt lds
  s_add_u32 m0, s7, 2048
  v_mfma_f32_16x16x32_bf16 v[216:219], v[240:243], a[136:139], v[216:219]
  ds_read_b64_tr_b16 v[236:237], v1 offset:28672
  s_add_u32 s6, s101, 16384
  v_mfma_f32_16x16x32_bf16 v[216:219], v[244:247], a[152:155], v[216:219]
  ds_read_b64_tr_b16 v[238:239], v1 offset:29184
  v_mfma_f32_16x16x32_bf16 v[216:219], v[248:251], a[168:171], v[216:219]
  buffer_load_dwordx4 v9, s[96:99], s6 offen nt lds
  s_add_u32 m0, s7, 3072
  v_mfma_f32_16x16x32_bf16 v[216:219], v[252:255], a[184:187], v[216:219]
  s_add_u32 s6, s101, 24576
  buffer_load_dwordx4 v9, s[96:99], s6 offen nt lds
  v_mfma_f32_16x16x32_bf16 v[220:223], v[240:243], a[140:143], v[220:223]
  s_lshl_b32 s6, s2, 2
  v_and_b32 v10, 3, v20
  v_lshlrev_b32 v10, 7, v10
  v_mfma_f32_16x16x32_bf16 v[220:223], v[244:247], a[156:159], v[220:223]
  s_add_u32 s6, s6, s16
  s_lshl_b32 s6, s6, 9
  s_add_u32 s63, s63, 16777216
  v_mfma_f32_16x16x32_bf16 v[220:223], v[248:251], a[172:175], v[220:223]
  buffer_load_dword v23, v10, s[48:51], s6 offen
  v_mfma_f32_16x16x32_bf16 v[220:223], v[252:255], a[188:191], v[220:223]
  v_lshrrev_b32 v9, 5, v20
  s_waitcnt vmcnt(18) lgkmcnt(0)
  v_mfma_f32_16x16x32_bf16 v[32:35], v[224:227], a[128:131], v[32:35]
  ds_read_b64_tr_b16 v[240:241], v2 offset:16384
  v_bfe_u32 v10, v20, 2, 2
  v_mfma_f32_16x16x32_bf16 v[32:35], v[228:231], a[144:147], v[32:35]
  ds_read_b64_tr_b16 v[242:243], v2 offset:16896
  v_lshl_add_u32 v9, v9, 2, v10
  v_mfma_f32_16x16x32_bf16 v[32:35], v[232:235], a[160:163], v[32:35]
  ds_read_b64_tr_b16 v[244:245], v2 offset:20480
  v_lshlrev_b32 v9, 7, v9
  v_mfma_f32_16x16x32_bf16 v[32:35], v[236:239], a[176:179], v[32:35]
  ds_read_b128 a[192:195], v15 offset:0
  v_bfe_u32 v10, v20, 3, 1
  v_mfma_f32_16x16x32_bf16 v[36:39], v[224:227], a[132:135], v[36:39]
  ds_read_b64_tr_b16 v[246:247], v2 offset:20992
  v_lshl_add_u32 v9, v10, 6, v9
  v_mfma_f32_16x16x32_bf16 v[36:39], v[228:231], a[148:151], v[36:39]
  ds_read_b64_tr_b16 v[248:249], v2 offset:24576
  v_bfe_u32 v10, v20, 4, 1
  v_mfma_f32_16x16x32_bf16 v[36:39], v[232:235], a[164:167], v[36:39]
  ds_read_b64_tr_b16 v[250:251], v2 offset:25088
  v_lshl_add_u32 v9, v10, 5, v9
  v_mfma_f32_16x16x32_bf16 v[36:39], v[236:239], a[180:183], v[36:39]
  ds_read_b128 a[208:211], v16 offset:0
  v_and_b32 v10, 3, v20
  v_mfma_f32_16x16x32_bf16 v[40:43], v[224:227], a[136:139], v[40:43]
  ds_read_b64_tr_b16 v[252:253], v2 offset:28672
  v_lshl_add_u32 v9, v10, 3, v9
  v_mfma_f32_16x16x32_bf16 v[40:43], v[228:231], a[152:155], v[40:43]
  ds_read_b64_tr_b16 v[254:255], v2 offset:29184
  v_add_u32 v9, s7, v9
  v_mfma_f32_16x16x32_bf16 v[40:43], v[232:235], a[168:171], v[40:43]
  ds_read_b128 a[196:199], v15 offset:2048
  v_xor_b32 v10, 64, v9
  v_mfma_f32_16x16x32_bf16 v[40:43], v[236:239], a[184:187], v[40:43]
  ds_read_b128 a[212:215], v16 offset:2048
  s_lshl_b32 s100, s100, 12
  v_mfma_f32_16x16x32_bf16 v[44:47], v[224:227], a[140:143], v[44:47]
  ds_read_b128 a[200:203], v15 offset:4096
  s_lshl_b32 s101, s18, 19
  v_mfma_f32_16x16x32_bf16 v[44:47], v[228:231], a[156:159], v[44:47]
  ds_read_b128 a[216:219], v16 offset:4096
  s_add_u32 s100, s100, s101
  v_mfma_f32_16x16x32_bf16 v[44:47], v[232:235], a[172:175], v[44:47]
  ds_read_b128 a[204:207], v15 offset:6144
  s_lshl_b32 s14, s64, 15
  v_mfma_f32_16x16x32_bf16 v[44:47], v[236:239], a[188:191], v[44:47]
  ds_read_b128 a[220:223], v16 offset:6144
  s_waitcnt vmcnt(5) lgkmcnt(4)
  v_mfma_f32_16x16x32_bf16 v[48:51], v[240:243], a[128:131], v[48:51]
  ds_read_b64_tr_b16 v[224:225], v3 offset:16384
  v_mfma_f32_16x16x32_bf16 v[48:51], v[244:247], a[144:147], v[48:51]
  ds_read_b64_tr_b16 v[226:227], v3 offset:16896
  v_mfma_f32_16x16x32_bf16 v[48:51], v[248:251], a[160:163], v[48:51]
  ds_read_b64_tr_b16 v[228:229], v3 offset:20480
  v_mfma_f32_16x16x32_bf16 v[48:51], v[252:255], a[176:179], v[48:51]
  ds_read_b128 a[224:227], v15 offset:8192
  v_mfma_f32_16x16x32_bf16 v[52:55], v[240:243], a[132:135], v[52:55]
  ds_read_b64_tr_b16 v[230:231], v3 offset:20992
  v_lshrrev_b32 v136, 5, v20
  v_mfma_f32_16x16x32_bf16 v[52:55], v[244:247], a[148:151], v[52:55]
  ds_read_b64_tr_b16 v[232:233], v3 offset:24576
  v_lshlrev_b32 v136, 4, v136
  v_mfma_f32_16x16x32_bf16 v[52:55], v[248:251], a[164:167], v[52:55]
  ds_read_b64_tr_b16 v[234:235], v3 offset:25088
  v_and_b32 v137, 15, v20
  v_mfma_f32_16x16x32_bf16 v[52:55], v[252:255], a[180:183], v[52:55]
  ds_read_b128 a[240:243], v16 offset:8192
  v_sub_u32 v136, v137, v136
  v_mfma_f32_16x16x32_bf16 v[56:59], v[240:243], a[136:139], v[56:59]
  ds_read_b64_tr_b16 v[236:237], v3 offset:28672
  v_bfe_u32 v137, v20, 4, 1
  v_mfma_f32_16x16x32_bf16 v[56:59], v[244:247], a[152:155], v[56:59]
  ds_read_b64_tr_b16 v[238:239], v3 offset:29184
  v_lshlrev_b32 v137, 2, v137
  v_mfma_f32_16x16x32_bf16 v[56:59], v[248:251], a[168:171], v[56:59]
  ds_read_b128 a[228:231], v15 offset:10240
  v_sub_u32 v136, v136, v137
  v_mfma_f32_16x16x32_bf16 v[56:59], v[252:255], a[184:187], v[56:59]
  ds_read_b128 a[244:247], v16 offset:10240
  v_mov_b32 v137, 0xf149f2ca
  v_mfma_f32_16x16x32_bf16 v[60:63], v[240:243], a[140:143], v[60:63]
  ds_read_b128 a[232:235], v15 offset:12288
  v_cmp_gt_i32 s[72:73], 0, v136
  v_mfma_f32_16x16x32_bf16 v[60:63], v[244:247], a[156:159], v[60:63]
  ds_read_b128 a[248:251], v16 offset:12288
  v_cmp_gt_i32 s[74:75], 1, v136
  v_mfma_f32_16x16x32_bf16 v[60:63], v[248:251], a[172:175], v[60:63]
  ds_read_b128 a[236:239], v15 offset:14336
  v_cmp_gt_i32 s[32:33], 2, v136
  v_mfma_f32_16x16x32_bf16 v[60:63], v[252:255], a[188:191], v[60:63]
  ds_read_b128 a[252:255], v16 offset:14336
  s_waitcnt lgkmcnt(4)
  v_mfma_f32_16x16x32_bf16 v[64:67], v[224:227], a[128:131], v[64:67]
  ds_read_b64_tr_b16 v[240:241], v4 offset:16384
  v_cmp_gt_i32 s[70:71], 3, v136
  v_mfma_f32_16x16x32_bf16 v[64:67], v[228:231], a[144:147], v[64:67]
  ds_read_b64_tr_b16 v[242:243], v4 offset:16896
  v_cndmask_b32 v96, 0, v137, s[72:73]
  v_mfma_f32_16x16x32_bf16 v[64:67], v[232:235], a[160:163], v[64:67]
  ds_read_b64_tr_b16 v[244:245], v4 offset:20480
  v_cndmask_b32 v97, 0, v137, s[74:75]
  v_mfma_f32_16x16x32_bf16 v[64:67], v[236:239], a[176:179], v[64:67]
  s_add_u32 s12, s8, s63
  s_addc_u32 s13, s9, 0
  s_add_u32 s58, s61, 65536
  v_mfma_f32_16x16x32_bf16 v[68:71], v[224:227], a[132:135], v[68:71]
  ds_read_b64_tr_b16 v[246:247], v4 offset:20992
  s_mov_b32 s57, 0
  v_mfma_f32_16x16x32_bf16 v[68:71], v[228:231], a[148:151], v[68:71]
  ds_read_b64_tr_b16 v[248:249], v4 offset:24576
  s_mov_b32 s59, 65536
  v_mfma_f32_16x16x32_bf16 v[68:71], v[232:235], a[164:167], v[68:71]
  ds_read_b64_tr_b16 v[250:251], v4 offset:25088
  s_mov_b32 s60, 32768
  v_mfma_f32_16x16x32_bf16 v[68:71], v[236:239], a[180:183], v[68:71]
  v_cndmask_b32 v98, 0, v137, s[32:33]
  v_cndmask_b32 v99, 0, v137, s[70:71]
  v_mfma_f32_16x16x32_bf16 v[72:75], v[224:227], a[136:139], v[72:75]
  ds_read_b64_tr_b16 v[252:253], v4 offset:28672
  v_cmp_gt_i32 s[72:73], 8, v136
  v_mfma_f32_16x16x32_bf16 v[72:75], v[228:231], a[152:155], v[72:75]
  ds_read_b64_tr_b16 v[254:255], v4 offset:29184
  v_cmp_gt_i32 s[74:75], 9, v136
  v_mfma_f32_16x16x32_bf16 v[72:75], v[232:235], a[168:171], v[72:75]
  v_cmp_gt_i32 s[32:33], 10, v136
  v_cmp_gt_i32 s[70:71], 11, v136
  v_mfma_f32_16x16x32_bf16 v[72:75], v[236:239], a[184:187], v[72:75]
  v_cndmask_b32 v100, 0, v137, s[72:73]
  v_cndmask_b32 v101, 0, v137, s[74:75]
  v_mfma_f32_16x16x32_bf16 v[76:79], v[224:227], a[140:143], v[76:79]
  v_cndmask_b32 v102, 0, v137, s[32:33]
  v_cndmask_b32 v103, 0, v137, s[70:71]
  v_mfma_f32_16x16x32_bf16 v[76:79], v[228:231], a[156:159], v[76:79]
  v_cmp_gt_i32 s[72:73], -16, v136
  v_cmp_gt_i32 s[74:75], -15, v136
  v_mfma_f32_16x16x32_bf16 v[76:79], v[232:235], a[172:175], v[76:79]
  v_cmp_gt_i32 s[32:33], -14, v136
  v_cmp_gt_i32 s[70:71], -13, v136
  v_mfma_f32_16x16x32_bf16 v[76:79], v[236:239], a[188:191], v[76:79]
  s_waitcnt vmcnt(26) lgkmcnt(0)
  s_cmp_lg_u32 s16, 0
  s_cbranch_scc1 P2_D
  s_mov_b32 s31, 0x100000
  s_waitcnt vmcnt(5)
P2_DL:
  v_cmp_ne_u32 vcc, 1, v31
  s_cmp_eq_u32 vcc_lo, 0
  s_cbranch_scc1 P2_D
  s_sleep 8
  buffer_load_dword v31, v27, s[8:11], 0 offen sc1
  s_waitcnt vmcnt(0)
  s_sub_u32 s31, s31, 1
  s_cmp_lg_u32 s31, 0
  s_cbranch_scc1 P2_DL
P2_D:
  s_barrier
  v_mfma_f32_16x16x32_bf16 v[80:83], v[240:243], a[128:131], v[80:83]
  ds_read_b64_tr_b16 v[224:225], v1 offset:32768
  v_cndmask_b32 v104, 0, v137, s[72:73]
  v_mfma_f32_16x16x32_bf16 v[80:83], v[244:247], a[144:147], v[80:83]
  ds_read_b64_tr_b16 v[226:227], v1 offset:33280
  v_cndmask_b32 v105, 0, v137, s[74:75]
  v_mfma_f32_16x16x32_bf16 v[80:83], v[248:251], a[160:163], v[80:83]
  ds_read_b64_tr_b16 v[228:229], v1 offset:36864
  v_cndmask_b32 v106, 0, v137, s[32:33]
  v_mfma_f32_16x16x32_bf16 v[80:83], v[252:255], a[176:179], v[80:83]
  v_cndmask_b32 v107, 0, v137, s[70:71]
  v_cmp_gt_i32 s[72:73], -8, v136
  v_mfma_f32_16x16x32_bf16 v[84:87], v[240:243], a[132:135], v[84:87]
  ds_read_b64_tr_b16 v[230:231], v1 offset:37376
  v_cmp_gt_i32 s[74:75], -7, v136
  v_mfma_f32_16x16x32_bf16 v[84:87], v[244:247], a[148:151], v[84:87]
  ds_read_b64_tr_b16 v[232:233], v1 offset:40960
  v_cmp_gt_i32 s[32:33], -6, v136
  v_mfma_f32_16x16x32_bf16 v[84:87], v[248:251], a[164:167], v[84:87]
  ds_read_b64_tr_b16 v[234:235], v1 offset:41472
  v_cmp_gt_i32 s[70:71], -5, v136
  v_mfma_f32_16x16x32_bf16 v[84:87], v[252:255], a[180:183], v[84:87]
  v_cndmask_b32 v108, 0, v137, s[72:73]
  v_cndmask_b32 v109, 0, v137, s[74:75]
  v_mfma_f32_16x16x32_bf16 v[88:91], v[240:243], a[136:139], v[88:91]
  ds_read_b64_tr_b16 v[236:237], v1 offset:45056
  s_sub_u32 s68, 32, s57
  v_mfma_f32_16x16x32_bf16 v[88:91], v[244:247], a[152:155], v[88:91]
  ds_read_b64_tr_b16 v[238:239], v1 offset:45568
  v_cndmask_b32 v110, 0, v137, s[32:33]
  v_mfma_f32_16x16x32_bf16 v[88:91], v[248:251], a[168:171], v[88:91]
  s_sub_u32 s67, 0, s16
  v_cndmask_b32 v111, 0, v137, s[70:71]
  v_mfma_f32_16x16x32_bf16 v[88:91], v[252:255], a[184:187], v[88:91]
  s_cmp_le_u32 s57, s69
  s_cselect_b32 s68, s57, s68
  v_mfma_f32_16x16x32_bf16 v[92:95], v[240:243], a[140:143], v[92:95]
  s_cmp_lt_i32 s67, 0
  s_cselect_b32 s62, 0, 0xf149f2ca
  v_mov_b32 v25, s62
  v_mfma_f32_16x16x32_bf16 v[92:95], v[244:247], a[156:159], v[92:95]
  s_cmp_le_i32 s67, 0
  s_cselect_b32 s62, 0, 0xf149f2ca
  v_mov_b32 v28, s62
  v_mfma_f32_16x16x32_bf16 v[92:95], v[248:251], a[172:175], v[92:95]
  s_lshl_b32 s68, s68, 15
  s_add_u32 s67, s67, 1
  v_med3_f32 v112, v96, v25, v28
  v_mfma_f32_16x16x32_bf16 v[92:95], v[252:255], a[188:191], v[92:95]
  v_med3_f32 v113, v97, v25, v28
  s_waitcnt lgkmcnt(0)
  v_mfma_f32_16x16x32_bf16 v[160:163], v[224:227], a[192:195], v[160:163]
  ds_read_b64_tr_b16 v[240:241], v2 offset:32768
  v_med3_f32 v114, v98, v25, v28
  v_mfma_f32_16x16x32_bf16 v[160:163], v[228:231], a[208:211], v[160:163]
  ds_read_b64_tr_b16 v[242:243], v2 offset:33280
  s_mov_b32 m0, s58
  v_mfma_f32_16x16x32_bf16 v[160:163], v[232:235], a[224:227], v[160:163]
  ds_read_b64_tr_b16 v[244:245], v2 offset:36864
  v_med3_f32 v115, v99, v25, v28
  v_mfma_f32_16x16x32_bf16 v[160:163], v[236:239], a[240:243], v[160:163]
  v_med3_f32 v116, v100, v25, v28
  v_med3_f32 v117, v101, v25, v28
  v_mfma_f32_16x16x32_bf16 v[164:167], v[224:227], a[196:199], v[164:167]
  ds_read_b64_tr_b16 v[246:247], v2 offset:37376
  v_med3_f32 v118, v102, v25, v28
  v_mfma_f32_16x16x32_bf16 v[164:167], v[228:231], a[212:215], v[164:167]
  ds_read_b64_tr_b16 v[248:249], v2 offset:40960
  s_add_u32 s57, s57, 1
  v_mfma_f32_16x16x32_bf16 v[164:167], v[232:235], a[228:231], v[164:167]
  ds_read_b64_tr_b16 v[250:251], v2 offset:41472
  v_med3_f32 v119, v103, v25, v28
  v_mfma_f32_16x16x32_bf16 v[164:167], v[236:239], a[244:247], v[164:167]
  v_med3_f32 v120, v104, v25, v28
  v_med3_f32 v121, v105, v25, v28
  v_mfma_f32_16x16x32_bf16 v[168:171], v[224:227], a[200:203], v[168:171]
  ds_read_b64_tr_b16 v[252:253], v2 offset:45056
  v_med3_f32 v122, v106, v25, v28
  v_mfma_f32_16x16x32_bf16 v[168:171], v[228:231], a[216:219], v[168:171]
  ds_read_b64_tr_b16 v[254:255], v2 offset:45568
  v_med3_f32 v123, v107, v25, v28
  v_mfma_f32_16x16x32_bf16 v[168:171], v[232:235], a[232:235], v[168:171]
  buffer_load_dwordx4 v24, s[12:15], s68 offen offset:0 sc1 lds
  v_med3_f32 v124, v108, v25, v28
  v_mfma_f32_16x16x32_bf16 v[168:171], v[236:239], a[248:251], v[168:171]
  buffer_load_dwordx4 v24, s[12:15], s68 offen offset:1024 sc1 lds
  v_med3_f32 v125, v109, v25, v28
  v_mfma_f32_16x16x32_bf16 v[172:175], v[224:227], a[204:207], v[172:175]
  v_med3_f32 v126, v110, v25, v28
  v_med3_f32 v127, v111, v25, v28
  v_mfma_f32_16x16x32_bf16 v[172:175], v[228:231], a[220:223], v[172:175]
  v_mov_b32 v128, 0
  v_mov_b32 v129, 0
  v_mfma_f32_16x16x32_bf16 v[172:175], v[232:235], a[236:239], v[172:175]
  v_mov_b32 v130, 0
  v_mov_b32 v131, 0
  v_mfma_f32_16x16x32_bf16 v[172:175], v[236:239], a[252:255], v[172:175]
  buffer_load_dwordx4 v24, s[12:15], s68 offen offset:2048 sc1 lds
  s_waitcnt lgkmcnt(0)
  v_mfma_f32_16x16x32_bf16 v[176:179], v[240:243], a[192:195], v[176:179]
  ds_read_b64_tr_b16 v[224:225], v3 offset:32768
  v_mov_b32 v132, 0
  v_mfma_f32_16x16x32_bf16 v[176:179], v[244:247], a[208:211], v[176:179]
  ds_read_b64_tr_b16 v[226:227], v3 offset:33280
  v_mov_b32 v133, 0
  v_mfma_f32_16x16x32_bf16 v[176:179], v[248:251], a[224:227], v[176:179]
  ds_read_b64_tr_b16 v[228:229], v3 offset:36864
  v_mov_b32 v134, 0
  v_mfma_f32_16x16x32_bf16 v[176:179], v[252:255], a[240:243], v[176:179]
  buffer_load_dwordx4 v24, s[12:15], s68 offen offset:3072 sc1 lds
  v_mov_b32 v135, 0
  v_mfma_f32_16x16x32_bf16 v[180:183], v[240:243], a[196:199], v[180:183]
  ds_read_b64_tr_b16 v[230:231], v3 offset:37376
  v_mov_b32 v136, 0
  v_mfma_f32_16x16x32_bf16 v[180:183], v[244:247], a[212:215], v[180:183]
  ds_read_b64_tr_b16 v[232:233], v3 offset:40960
  s_add_u32 m0, s58, 4096
  v_mfma_f32_16x16x32_bf16 v[180:183], v[248:251], a[228:231], v[180:183]
  ds_read_b64_tr_b16 v[234:235], v3 offset:41472
  v_mov_b32 v137, 0
  v_mfma_f32_16x16x32_bf16 v[180:183], v[252:255], a[244:247], v[180:183]
  v_mov_b32 v138, 0
  v_mov_b32 v139, 0
  v_mfma_f32_16x16x32_bf16 v[184:187], v[240:243], a[200:203], v[184:187]
  ds_read_b64_tr_b16 v[236:237], v3 offset:45056
  s_add_u32 s68, s68, 4096
  v_mfma_f32_16x16x32_bf16 v[184:187], v[244:247], a[216:219], v[184:187]
  ds_read_b64_tr_b16 v[238:239], v3 offset:45568
  v_mov_b32 v140, 0
  v_mfma_f32_16x16x32_bf16 v[184:187], v[248:251], a[232:235], v[184:187]
  v_mov_b32 v141, 0
  v_mov_b32 v142, 0
  v_mfma_f32_16x16x32_bf16 v[184:187], v[252:255], a[248:251], v[184:187]
  v_mov_b32 v143, 0
  v_mfma_f32_16x16x32_bf16 v[188:191], v[240:243], a[204:207], v[188:191]
  buffer_load_dwordx4 v24, s[12:15], s68 offen offset:0 sc1 lds
  v_mfma_f32_16x16x32_bf16 v[188:191], v[244:247], a[220:223], v[188:191]
  v_mfma_f32_16x16x32_bf16 v[188:191], v[248:251], a[236:239], v[188:191]
  v_mfma_f32_16x16x32_bf16 v[188:191], v[252:255], a[252:255], v[188:191]
  buffer_load_dwordx4 v24, s[12:15], s68 offen offset:1024 sc1 lds
  s_waitcnt lgkmcnt(0)
  v_mfma_f32_16x16x32_bf16 v[192:195], v[224:227], a[192:195], v[192:195]
  ds_read_b64_tr_b16 v[240:241], v4 offset:32768
  v_mfma_f32_16x16x32_bf16 v[192:195], v[228:231], a[208:211], v[192:195]
  ds_read_b64_tr_b16 v[242:243], v4 offset:33280
  v_mfma_f32_16x16x32_bf16 v[192:195], v[232:235], a[224:227], v[192:195]
  ds_read_b64_tr_b16 v[244:245], v4 offset:36864
  v_cvt_pk_bf16_f32 v160, v160, v161
  v_mfma_f32_16x16x32_bf16 v[192:195], v[236:239], a[240:243], v[192:195]
  buffer_load_dwordx4 v24, s[12:15], s68 offen offset:2048 sc1 lds
  v_cvt_pk_bf16_f32 v161, v162, v163
  v_mfma_f32_16x16x32_bf16 v[196:199], v[224:227], a[196:199], v[196:199]
  ds_read_b64_tr_b16 v[246:247], v4 offset:37376
  v_cvt_pk_bf16_f32 v162, v176, v177
  v_mfma_f32_16x16x32_bf16 v[196:199], v[228:231], a[212:215], v[196:199]
  ds_read_b64_tr_b16 v[248:249], v4 offset:40960
  v_cvt_pk_bf16_f32 v163, v178, v179
  v_mfma_f32_16x16x32_bf16 v[196:199], v[232:235], a[228:231], v[196:199]
  ds_read_b64_tr_b16 v[250:251], v4 offset:41472
  v_cvt_pk_bf16_f32 v164, v164, v165
  v_mfma_f32_16x16x32_bf16 v[196:199], v[236:239], a[244:247], v[196:199]
  buffer_load_dwordx4 v24, s[12:15], s68 offen offset:3072 sc1 lds
  v_cvt_pk_bf16_f32 v165, v166, v167
  v_mfma_f32_16x16x32_bf16 v[200:203], v[224:227], a[200:203], v[200:203]
  ds_read_b64_tr_b16 v[252:253], v4 offset:45056
  v_permlane16_swap_b32 v160, v162
  v_mfma_f32_16x16x32_bf16 v[200:203], v[228:231], a[216:219], v[200:203]
  ds_read_b64_tr_b16 v[254:255], v4 offset:45568
  s_add_u32 s58, s58, 32768
  v_mfma_f32_16x16x32_bf16 v[200:203], v[232:235], a[232:235], v[200:203]
  v_permlane16_swap_b32 v161, v163
  v_mfma_f32_16x16x32_bf16 v[200:203], v[236:239], a[248:251], v[200:203]
  v_cvt_pk_bf16_f32 v166, v180, v181
  v_cvt_pk_bf16_f32 v167, v182, v183
  v_mfma_f32_16x16x32_bf16 v[204:207], v[224:227], a[204:207], v[204:207]
  s_cmp_ge_u32 s58, 163840
  s_cselect_b32 s58, s61, s58
  v_accvgpr_write_b32 a0, v160
  v_mfma_f32_16x16x32_bf16 v[204:207], v[228:231], a[220:223], v[204:207]
  v_accvgpr_write_b32 a1, v161
  v_accvgpr_write_b32 a2, v162
  v_mfma_f32_16x16x32_bf16 v[204:207], v[232:235], a[236:239], v[204:207]
  v_accvgpr_write_b32 a3, v163
  v_cvt_pk_bf16_f32 v168, v168, v169
  v_mfma_f32_16x16x32_bf16 v[204:207], v[236:239], a[252:255], v[204:207]
  s_waitcnt vmcnt(21) lgkmcnt(0)
  s_barrier
  v_mfma_f32_16x16x32_bf16 v[208:211], v[240:243], a[192:195], v[208:211]
  ds_read_b64_tr_b16 v[224:225], v1 offset:49152
  s_sub_u32 s68, 32, s57
  v_mfma_f32_16x16x32_bf16 v[208:211], v[244:247], a[208:211], v[208:211]
  ds_read_b64_tr_b16 v[226:227], v1 offset:49664
  v_cvt_pk_bf16_f32 v169, v170, v171
  v_mfma_f32_16x16x32_bf16 v[208:211], v[248:251], a[224:227], v[208:211]
  ds_read_b64_tr_b16 v[228:229], v1 offset:53248
  v_permlane16_swap_b32 v164, v166
  v_mfma_f32_16x16x32_bf16 v[208:211], v[252:255], a[240:243], v[208:211]
  s_cmp_le_u32 s57, s69
  s_cselect_b32 s68, s57, s68
  v_permlane16_swap_b32 v165, v167
  v_mfma_f32_16x16x32_bf16 v[212:215], v[240:243], a[196:199], v[212:215]
  ds_read_b64_tr_b16 v[230:231], v1 offset:53760
  v_cvt_pk_bf16_f32 v170, v184, v185
  v_mfma_f32_16x16x32_bf16 v[212:215], v[244:247], a[212:215], v[212:215]
  ds_read_b64_tr_b16 v[232:233], v1 offset:57344
  v_cvt_pk_bf16_f32 v171, v186, v187
  v_mfma_f32_16x16x32_bf16 v[212:215], v[248:251], a[228:231], v[212:215]
  ds_read_b64_tr_b16 v[234:235], v1 offset:57856
  v_accvgpr_write_b32 a16, v164
  v_mfma_f32_16x16x32_bf16 v[212:215], v[252:255], a[244:247], v[212:215]
  s_lshl_b32 s68, s68, 15
  v_accvgpr_write_b32 a17, v165
  v_accvgpr_write_b32 a18, v166
  v_mfma_f32_16x16x32_bf16 v[216:219], v[240:243], a[200:203], v[216:219]
  ds_read_b64_tr_b16 v[236:237], v1 offset:61440
  v_accvgpr_write_b32 a19, v167
  v_mfma_f32_16x16x32_bf16 v[216:219], v[244:247], a[216:219], v[216:219]
  ds_read_b64_tr_b16 v[238:239], v1 offset:61952
  v_cvt_pk_bf16_f32 v172, v172, v173
  v_mfma_f32_16x16x32_bf16 v[216:219], v[248:251], a[232:235], v[216:219]
  s_mov_b32 m0, s58
  v_cvt_pk_bf16_f32 v173, v174, v175
  v_permlane16_swap_b32 v168, v170
  v_mfma_f32_16x16x32_bf16 v[216:219], v[252:255], a[248:251], v[216:219]
  v_permlane16_swap_b32 v169, v171
  v_mfma_f32_16x16x32_bf16 v[220:223], v[240:243], a[204:207], v[220:223]
  v_cvt_pk_bf16_f32 v174, v188, v189
  v_cvt_pk_bf16_f32 v175, v190, v191
  v_mfma_f32_16x16x32_bf16 v[220:223], v[244:247], a[220:223], v[220:223]
  v_accvgpr_write_b32 a32, v168
  v_accvgpr_write_b32 a33, v169
  v_mfma_f32_16x16x32_bf16 v[220:223], v[248:251], a[236:239], v[220:223]
  s_add_u32 s57, s57, 1
  v_accvgpr_write_b32 a34, v170
  v_accvgpr_write_b32 a35, v171
  v_mfma_f32_16x16x32_bf16 v[220:223], v[252:255], a[252:255], v[220:223]
  s_nop 1
  s_waitcnt lgkmcnt(0)
  v_mfma_f32_16x16x32_bf16 v[32:35], v[224:227], a[192:195], v[32:35]
  ds_read_b64_tr_b16 v[240:241], v2 offset:49152
  v_lshlrev_b32 v1, 4, v20
  v_mfma_f32_16x16x32_bf16 v[32:35], v[228:231], a[208:211], v[32:35]
  ds_read_b64_tr_b16 v[242:243], v2 offset:49664
  v_permlane16_swap_b32 v172, v174
  v_permlane16_swap_b32 v173, v175
  v_accvgpr_write_b32 a48, v172
  v_accvgpr_write_b32 a49, v173
  v_accvgpr_write_b32 a50, v174
  v_accvgpr_write_b32 a51, v175
  v_mfma_f32_16x16x32_bf16 v[32:35], v[232:235], a[224:227], v[32:35]
  ds_read_b64_tr_b16 v[244:245], v2 offset:53248
  v_mfma_f32_16x16x32_bf16 v[32:35], v[236:239], a[240:243], v[32:35]
  buffer_load_dwordx4 v24, s[12:15], s68 offen offset:0 sc1 lds
  v_cvt_pk_bf16_f32 v192, v192, v193
  v_mfma_f32_16x16x32_bf16 v[36:39], v[224:227], a[196:199], v[36:39]
  ds_read_b64_tr_b16 v[246:247], v2 offset:53760
  v_cvt_pk_bf16_f32 v193, v194, v195
  v_mfma_f32_16x16x32_bf16 v[36:39], v[228:231], a[212:215], v[36:39]
  ds_read_b64_tr_b16 v[248:249], v2 offset:57344
  v_cvt_pk_bf16_f32 v194, v208, v209
  v_mfma_f32_16x16x32_bf16 v[36:39], v[232:235], a[228:231], v[36:39]
  ds_read_b64_tr_b16 v[250:251], v2 offset:57856
  v_cvt_pk_bf16_f32 v195, v210, v211
  v_mfma_f32_16x16x32_bf16 v[36:39], v[236:239], a[244:247], v[36:39]
  buffer_load_dwordx4 v24, s[12:15], s68 offen offset:1024 sc1 lds
  v_cvt_pk_bf16_f32 v196, v196, v197
  v_mfma_f32_16x16x32_bf16 v[40:43], v[224:227], a[200:203], v[40:43]
  ds_read_b64_tr_b16 v[252:253], v2 offset:61440
  v_add_u32 v1, s59, v1
  v_mfma_f32_16x16x32_bf16 v[40:43], v[228:231], a[216:219], v[40:43]
  ds_read_b64_tr_b16 v[254:255], v2 offset:61952
  v_cvt_pk_bf16_f32 v197, v198, v199
  v_mfma_f32_16x16x32_bf16 v[40:43], v[232:235], a[232:235], v[40:43]
  buffer_load_dwordx4 v24, s[12:15], s68 offen offset:2048 sc1 lds
  v_permlane16_swap_b32 v192, v194
  v_mfma_f32_16x16x32_bf16 v[40:43], v[236:239], a[248:251], v[40:43]
  v_permlane16_swap_b32 v193, v195
  v_mfma_f32_16x16x32_bf16 v[44:47], v[224:227], a[204:207], v[44:47]
  v_cvt_pk_bf16_f32 v198, v212, v213
  v_cvt_pk_bf16_f32 v199, v214, v215
  v_mfma_f32_16x16x32_bf16 v[44:47], v[228:231], a[220:223], v[44:47]
  buffer_load_dwordx4 v24, s[12:15], s68 offen offset:3072 sc1 lds
  v_accvgpr_write_b32 a4, v192
  v_mfma_f32_16x16x32_bf16 v[44:47], v[232:235], a[236:239], v[44:47]
  v_accvgpr_write_b32 a5, v193
  v_accvgpr_write_b32 a6, v194
  v_mfma_f32_16x16x32_bf16 v[44:47], v[236:239], a[252:255], v[44:47]
  s_waitcnt lgkmcnt(0)
  s_waitcnt vmcnt(13)
  v_mfma_f32_16x16x32_bf16 v[48:51], v[240:243], a[192:195], v[48:51]
  ds_read_b64_tr_b16 v[224:225], v3 offset:49152
  s_add_u32 m0, s58, 4096
  v_mfma_f32_16x16x32_bf16 v[48:51], v[244:247], a[208:211], v[48:51]
  ds_read_b64_tr_b16 v[226:227], v3 offset:49664
  v_accvgpr_write_b32 a7, v195
  v_mfma_f32_16x16x32_bf16 v[48:51], v[248:251], a[224:227], v[48:51]
  ds_read_b64_tr_b16 v[228:229], v3 offset:53248
  v_cvt_pk_bf16_f32 v200, v200, v201
  v_mfma_f32_16x16x32_bf16 v[48:51], v[252:255], a[240:243], v[48:51]
  v_cvt_pk_bf16_f32 v201, v202, v203
  v_permlane16_swap_b32 v196, v198
  v_mfma_f32_16x16x32_bf16 v[52:55], v[240:243], a[196:199], v[52:55]
  ds_read_b64_tr_b16 v[230:231], v3 offset:53760
  s_add_u32 s68, s68, 4096
  v_mfma_f32_16x16x32_bf16 v[52:55], v[244:247], a[212:215], v[52:55]
  ds_read_b64_tr_b16 v[232:233], v3 offset:57344
  v_permlane16_swap_b32 v197, v199
  v_mfma_f32_16x16x32_bf16 v[52:55], v[248:251], a[228:231], v[52:55]
  ds_read_b64_tr_b16 v[234:235], v3 offset:57856
  v_cvt_pk_bf16_f32 v202, v216, v217
  v_mfma_f32_16x16x32_bf16 v[52:55], v[252:255], a[244:247], v[52:55]
  v_cvt_pk_bf16_f32 v203, v218, v219
  v_accvgpr_write_b32 a20, v196
  v_mfma_f32_16x16x32_bf16 v[56:59], v[240:243], a[200:203], v[56:59]
  ds_read_b64_tr_b16 v[236:237], v3 offset:61440
  v_accvgpr_write_b32 a21, v197
  v_mfma_f32_16x16x32_bf16 v[56:59], v[244:247], a[216:219], v[56:59]
  ds_read_b64_tr_b16 v[238:239], v3 offset:61952
  v_accvgpr_write_b32 a22, v198
  v_mfma_f32_16x16x32_bf16 v[56:59], v[248:251], a[232:235], v[56:59]
  buffer_load_dwordx4 v24, s[12:15], s68 offen offset:0 sc1 lds
  ds_read_b64_tr_b16 a[128:129], v9 offset:0
  v_mfma_f32_16x16x32_bf16 v[56:59], v[252:255], a[248:251], v[56:59]
  buffer_load_dwordx4 v24, s[12:15], s68 offen offset:1024 sc1 lds
  ds_read_b64_tr_b16 a[130:131], v9 offset:2048
  v_mfma_f32_16x16x32_bf16 v[60:63], v[240:243], a[204:207], v[60:63]
  ds_read_b64_tr_b16 a[132:133], v10 offset:0
  v_accvgpr_write_b32 a23, v199
  v_cvt_pk_bf16_f32 v204, v204, v205
  v_cvt_pk_bf16_f32 v205, v206, v207
  v_permlane16_swap_b32 v200, v202
  v_permlane16_swap_b32 v201, v203
  v_mfma_f32_16x16x32_bf16 v[60:63], v[244:247], a[220:223], v[60:63]
  ds_read_b64_tr_b16 a[134:135], v10 offset:2048
  v_cvt_pk_bf16_f32 v206, v220, v221
  v_cvt_pk_bf16_f32 v207, v222, v223
  v_accvgpr_write_b32 a36, v200
  v_accvgpr_write_b32 a37, v201
  v_accvgpr_write_b32 a38, v202
  v_accvgpr_write_b32 a39, v203
  v_mfma_f32_16x16x32_bf16 v[60:63], v[248:251], a[236:239], v[60:63]
  s_nop 1
  v_permlane16_swap_b32 v204, v206
  v_mfma_f32_16x16x32_bf16 v[60:63], v[252:255], a[252:255], v[60:63]
  buffer_load_dwordx4 v24, s[12:15], s68 offen offset:2048 sc1 lds
  s_waitcnt lgkmcnt(0)
  v_mfma_f32_16x16x32_bf16 v[64:67], v[224:227], a[192:195], v[64:67]
  ds_read_b64_tr_b16 v[240:241], v4 offset:49152
  v_permlane16_swap_b32 v205, v207
  v_mfma_f32_16x16x32_bf16 v[64:67], v[228:231], a[208:211], v[64:67]
  ds_read_b64_tr_b16 v[242:243], v4 offset:49664
  v_accvgpr_write_b32 a52, v204
  v_accvgpr_write_b32 a53, v205
  v_accvgpr_write_b32 a54, v206
  v_accvgpr_write_b32 a55, v207
  v_mfma_f32_16x16x32_bf16 v[64:67], v[232:235], a[224:227], v[64:67]
  ds_read_b64_tr_b16 v[244:245], v4 offset:53248
  v_mfma_f32_16x16x32_bf16 v[64:67], v[236:239], a[240:243], v[64:67]
  buffer_load_dwordx4 v24, s[12:15], s68 offen offset:3072 sc1 lds
  v_cvt_pk_bf16_f32 v32, v32, v33
  v_mfma_f32_16x16x32_bf16 v[68:71], v[224:227], a[196:199], v[68:71]
  ds_read_b64_tr_b16 v[246:247], v4 offset:53760
  v_cvt_pk_bf16_f32 v33, v34, v35
  v_mfma_f32_16x16x32_bf16 v[68:71], v[228:231], a[212:215], v[68:71]
  ds_read_b64_tr_b16 v[248:249], v4 offset:57344
  v_cvt_pk_bf16_f32 v34, v48, v49
  v_mfma_f32_16x16x32_bf16 v[68:71], v[232:235], a[228:231], v[68:71]
  ds_read_b64_tr_b16 v[250:251], v4 offset:57856
  s_add_u32 s58, s58, 32768
  v_mfma_f32_16x16x32_bf16 v[68:71], v[236:239], a[244:247], v[68:71]
  v_cvt_pk_bf16_f32 v35, v50, v51
  v_cvt_pk_bf16_f32 v36, v36, v37
  v_mfma_f32_16x16x32_bf16 v[72:75], v[224:227], a[200:203], v[72:75]
  ds_read_b64_tr_b16 v[252:253], v4 offset:61440
  v_cvt_pk_bf16_f32 v37, v38, v39
  v_mfma_f32_16x16x32_bf16 v[72:75], v[228:231], a[216:219], v[72:75]
  ds_read_b64_tr_b16 v[254:255], v4 offset:61952
  v_permlane16_swap_b32 v32, v34
  v_mfma_f32_16x16x32_bf16 v[72:75], v[232:235], a[232:235], v[72:75]
  s_cmp_ge_u32 s58, 163840
  s_cselect_b32 s58, s61, s58
  ds_read_b64_tr_b16 a[136:137], v9 offset:1024
  v_mfma_f32_16x16x32_bf16 v[72:75], v[236:239], a[248:251], v[72:75]
  ds_read_b64_tr_b16 a[138:139], v9 offset:3072
  v_permlane16_swap_b32 v33, v35
  v_mfma_f32_16x16x32_bf16 v[76:79], v[224:227], a[204:207], v[76:79]
  ds_read_b64_tr_b16 a[140:141], v10 offset:1024
  ds_read_b64_tr_b16 a[142:143], v10 offset:3072
  v_mfma_f32_16x16x32_bf16 v[76:79], v[228:231], a[220:223], v[76:79]
  v_cvt_pk_bf16_f32 v38, v52, v53
  v_cvt_pk_bf16_f32 v39, v54, v55
  v_mfma_f32_16x16x32_bf16 v[76:79], v[232:235], a[236:239], v[76:79]
  v_accvgpr_write_b32 a8, v32
  v_accvgpr_write_b32 a9, v33
  v_mfma_f32_16x16x32_bf16 v[76:79], v[236:239], a[252:255], v[76:79]
  s_waitcnt vmcnt(8) lgkmcnt(0)
  s_barrier
  v_mfma_f32_16x16x32_bf16 v[80:83], v[240:243], a[192:195], v[80:83]
  ds_read_b128 a[64:67], v1 offset:0
  v_lshlrev_b32 v3, 4, v20
  v_mfma_f32_16x16x32_bf16 v[80:83], v[244:247], a[208:211], v[80:83]
  ds_read_b128 a[68:71], v1 offset:1024
  v_and_b32 v21, 3, v20
  v_mfma_f32_16x16x32_bf16 v[80:83], v[248:251], a[224:227], v[80:83]
  ds_read_b128 a[72:75], v1 offset:2048
  v_cmp_eq_u32 vcc, 0, v21
  v_mfma_f32_16x16x32_bf16 v[80:83], v[252:255], a[240:243], v[80:83]
  v_mov_b32 v21, 0x3f803f80
  s_nop 0
  v_mfma_f32_16x16x32_bf16 v[84:87], v[240:243], a[196:199], v[84:87]
  ds_read_b128 a[76:79], v1 offset:3072
  v_cndmask_b32 v4, 0, v21, vcc
  v_mfma_f32_16x16x32_bf16 v[84:87], v[244:247], a[212:215], v[84:87]
  ds_read_b128 a[80:83], v1 offset:4096
  v_cndmask_b32 v5, 0, v21, vcc
  v_mfma_f32_16x16x32_bf16 v[84:87], v[248:251], a[228:231], v[84:87]
  ds_read_b128 a[84:87], v1 offset:5120
  v_cndmask_b32 v6, 0, v21, vcc
  v_mfma_f32_16x16x32_bf16 v[84:87], v[252:255], a[244:247], v[84:87]
  v_cndmask_b32 v7, 0, v21, vcc
  v_accvgpr_write_b32 a10, v34
  v_mfma_f32_16x16x32_bf16 v[88:91], v[240:243], a[200:203], v[88:91]
  ds_read_b128 a[88:91], v1 offset:6144
  s_sub_u32 s68, 32, s57
  v_mfma_f32_16x16x32_bf16 v[88:91], v[244:247], a[216:219], v[88:91]
  ds_read_b128 a[92:95], v1 offset:7168
  v_accvgpr_write_b32 a11, v35
  v_mfma_f32_16x16x32_bf16 v[88:91], v[248:251], a[232:235], v[88:91]
  s_cmp_le_u32 s57, s69
  s_cselect_b32 s68, s57, s68
  s_lshl_b32 s68, s68, 15
  v_mfma_f32_16x16x32_bf16 v[88:91], v[252:255], a[248:251], v[88:91]
  s_mov_b32 m0, s58
  s_add_u32 s57, s57, 1
  v_cvt_pk_bf16_f32 v40, v40, v41
  v_cvt_pk_bf16_f32 v41, v42, v43
  v_permlane16_swap_b32 v36, v38
  v_mfma_f32_16x16x32_bf16 v[92:95], v[240:243], a[204:207], v[92:95]
  buffer_load_dwordx4 v24, s[12:15], s68 offen offset:0 sc1 lds
  v_permlane16_swap_b32 v37, v39
  v_cvt_pk_bf16_f32 v42, v56, v57
  v_cvt_pk_bf16_f32 v43, v58, v59
  v_accvgpr_write_b32 a24, v36
  v_accvgpr_write_b32 a25, v37
  v_accvgpr_write_b32 a26, v38
  v_mfma_f32_16x16x32_bf16 v[92:95], v[244:247], a[220:223], v[92:95]
  buffer_load_dwordx4 v24, s[12:15], s68 offen offset:1024 sc1 lds
  v_accvgpr_write_b32 a27, v39
  v_cvt_pk_bf16_f32 v44, v44, v45
  v_cvt_pk_bf16_f32 v45, v46, v47
  v_permlane16_swap_b32 v40, v42
  v_permlane16_swap_b32 v41, v43
  v_cvt_pk_bf16_f32 v46, v60, v61
  v_mfma_f32_16x16x32_bf16 v[92:95], v[248:251], a[236:239], v[92:95]
  buffer_load_dwordx4 v24, s[12:15], s68 offen offset:2048 sc1 lds
  v_cvt_pk_bf16_f32 v47, v62, v63
  v_accvgpr_write_b32 a40, v40
  v_accvgpr_write_b32 a41, v41
  v_accvgpr_write_b32 a42, v42
  v_accvgpr_write_b32 a43, v43
  s_nop 1
  v_mfma_f32_16x16x32_bf16 v[92:95], v[252:255], a[252:255], v[92:95]
  buffer_load_dwordx4 v24, s[12:15], s68 offen offset:3072 sc1 lds
  v_permlane16_swap_b32 v44, v46
  v_permlane16_swap_b32 v45, v47
  v_accvgpr_write_b32 a56, v44
  v_accvgpr_write_b32 a57, v45
  v_accvgpr_write_b32 a58, v46
  v_accvgpr_write_b32 a59, v47
  s_nop 1
  v_cvt_pk_bf16_f32 v64, v64, v65
  v_cvt_pk_bf16_f32 v65, v66, v67
  v_cvt_pk_bf16_f32 v66, v80, v81
  v_cvt_pk_bf16_f32 v67, v82, v83
  v_cvt_pk_bf16_f32 v68, v68, v69
  v_cvt_pk_bf16_f32 v69, v70, v71
  v_permlane16_swap_b32 v64, v66
  v_permlane16_swap_b32 v65, v67
  v_cvt_pk_bf16_f32 v70, v84, v85
  v_cvt_pk_bf16_f32 v71, v86, v87
  v_accvgpr_write_b32 a12, v64
  v_accvgpr_write_b32 a13, v65
  v_accvgpr_write_b32 a14, v66
  v_accvgpr_write_b32 a15, v67
  v_cvt_pk_bf16_f32 v72, v72, v73
  v_cvt_pk_bf16_f32 v73, v74, v75
  v_permlane16_swap_b32 v68, v70
  v_permlane16_swap_b32 v69, v71
  v_cvt_pk_bf16_f32 v74, v88, v89
  v_cvt_pk_bf16_f32 v75, v90, v91
  v_accvgpr_write_b32 a28, v68
  v_accvgpr_write_b32 a29, v69
  v_accvgpr_write_b32 a30, v70
  v_accvgpr_write_b32 a31, v71
  v_cvt_pk_bf16_f32 v76, v76, v77
  v_cvt_pk_bf16_f32 v77, v78, v79
  v_permlane16_swap_b32 v72, v74
  v_permlane16_swap_b32 v73, v75
  v_cvt_pk_bf16_f32 v78, v92, v93
  v_cvt_pk_bf16_f32 v79, v94, v95
  v_accvgpr_write_b32 a44, v72
  v_accvgpr_write_b32 a45, v73
  v_accvgpr_write_b32 a46, v74
  v_accvgpr_write_b32 a47, v75
  s_nop 1
  v_permlane16_swap_b32 v76, v78
  v_permlane16_swap_b32 v77, v79
  v_accvgpr_write_b32 a60, v76
  v_accvgpr_write_b32 a61, v77
  v_accvgpr_write_b32 a62, v78
  v_accvgpr_write_b32 a63, v79
  s_waitcnt lgkmcnt(0)
  s_sub_u32 s56, s18, 1
  s_cbranch_scc1 K2_G
  v_mfma_f32_16x16x32_bf16 v[224:227], a[64:67], a[0:3], 0
  s_add_u32 m0, s58, 4096
  v_and_b32 v21, 15, v20
  v_lshlrev_b32 v18, 2, v21
  v_mfma_f32_16x16x32_bf16 v[224:227], a[68:71], a[4:7], v[224:227]
  s_add_u32 s68, s68, 4096
  buffer_load_dwordx4 v24, s[12:15], s68 offen offset:0 sc1 lds
  v_mfma_f32_16x16x32_bf16 v[224:227], a[72:75], a[8:11], v[224:227]
  v_lshrrev_b32 v30, 4, v20
  v_lshlrev_b32 v30, 9, v30
  v_mfma_f32_16x16x32_bf16 v[224:227], a[76:79], a[12:15], v[224:227]
  v_lshl_add_u32 v30, v21, 4, v30
  v_and_b32 v250, 63, v0
  v_mfma_f32_16x16x32_bf16 v[232:235], a[64:67], a[16:19], 0
  v_and_b32 v251, 15, v250
  v_lshrrev_b32 v252, 5, v250
  v_mfma_f32_16x16x32_bf16 v[232:235], a[68:71], a[20:23], v[232:235]
  v_lshl_add_u32 v251, v252, 4, v251
  v_lshlrev_b32 v240, 4, v251
  v_mfma_f32_16x16x32_bf16 v[232:235], a[72:75], a[24:27], v[232:235]
  v_and_b32 v253, 27, v250
  v_cmp_eq_u32 vcc, 16, v253
  v_mfma_f32_16x16x32_bf16 v[232:235], a[76:79], a[28:31], v[232:235]
  v_and_b32 v253, 31, v250
  v_mov_b32 v252, 0x3f803f80
  v_mfma_f32_16x16x32_bf16 v[228:231], a[80:83], a[0:3], 0
  v_lshlrev_b32 v253, 2, v253
  v_cndmask_b32 v252, 0, v252, vcc
  v_mfma_f32_16x16x32_bf16 v[228:231], a[84:87], a[4:7], v[228:231]
  v_accvgpr_write_b32 a176, v252
  v_accvgpr_write_b32 a177, v252
  v_mfma_f32_16x16x32_bf16 v[228:231], a[88:91], a[8:11], v[228:231]
  v_accvgpr_write_b32 a178, v252
  v_accvgpr_write_b32 a179, v252
  v_mfma_f32_16x16x32_bf16 v[228:231], a[92:95], a[12:15], v[228:231]
  v_accvgpr_write_b32 a180, v252
  v_accvgpr_write_b32 a181, v252
  v_mfma_f32_16x16x32_bf16 v[236:239], a[80:83], a[16:19], 0
  v_accvgpr_write_b32 a182, v252
  v_mfma_f32_16x16x32_bf16 v[236:239], a[84:87], a[20:23], v[236:239]
  s_waitcnt lgkmcnt(15)
  v_accvgpr_write_b32 a183, v252
  v_accvgpr_write_b32 a184, v252
  v_mfma_f32_16x16x32_bf16 v[236:239], a[88:91], a[24:27], v[236:239]
  v_accvgpr_write_b32 a185, v252
  v_accvgpr_write_b32 a186, v252
  v_mfma_f32_16x16x32_bf16 v[236:239], a[92:95], a[28:31], v[236:239]
  v_accvgpr_write_b32 a187, v252
  v_accvgpr_write_b32 a188, v252
  v_mfma_f32_16x16x32_bf16 v[32:35], a[96:99], v[128:131], 0
  v_accvgpr_write_b32 a189, v252
  v_mfma_f32_16x16x32_bf16 v[36:39], a[96:99], v[132:135], 0
  buffer_load_dwordx4 v24, s[12:15], s68 offen offset:1024 sc1 lds
  v_accvgpr_write_b32 a190, v252
  v_mfma_f32_16x16x32_bf16 v[40:43], a[100:103], v[128:131], 0
  v_accvgpr_write_b32 a191, v252
  v_accvgpr_write_b32 a192, v252
  v_mfma_f32_16x16x32_bf16 v[44:47], a[100:103], v[132:135], 0
  v_accvgpr_write_b32 a193, v252
  v_accvgpr_write_b32 a194, v252
  v_mfma_f32_16x16x32_bf16 v[48:51], a[104:107], v[128:131], 0
  v_accvgpr_write_b32 a195, v252
  v_accvgpr_write_b32 a196, v252
  v_mfma_f32_16x16x32_bf16 v[52:55], a[104:107], v[132:135], 0
  v_accvgpr_write_b32 a197, v252
  v_accvgpr_write_b32 a198, v252
  v_mfma_f32_16x16x32_bf16 v[56:59], a[108:111], v[128:131], 0
  v_accvgpr_write_b32 a199, v252
  v_accvgpr_write_b32 a200, v252
  v_mfma_f32_16x16x32_bf16 v[60:63], a[108:111], v[132:135], 0
  v_accvgpr_write_b32 a201, v252
  v_accvgpr_write_b32 a202, v252
  v_mfma_f32_16x16x32_bf16 v[64:67], a[112:115], v[128:131], 0
  v_accvgpr_write_b32 a203, v252
  v_accvgpr_write_b32 a204, v252
  v_mfma_f32_16x16x32_bf16 v[68:71], a[112:115], v[132:135], 0
  v_accvgpr_write_b32 a205, v252
  v_mfma_f32_16x16x32_bf16 v[72:75], a[116:119], v[128:131], 0
  v_accvgpr_write_b32 a206, v252
  v_accvgpr_write_b32 a207, v252
  v_mfma_f32_16x16x32_bf16 v[76:79], a[116:119], v[132:135], 0
  v_add_u32 v243, 294912, v3
  v_lshrrev_b32 v254, 3, v250
  v_mfma_f32_16x16x32_bf16 v[80:83], a[120:123], v[128:131], 0
  s_waitcnt lgkmcnt(15)
  v_and_b32 v255, 7, v250
  v_bfe_u32 v247, v250, 4, 1
  v_mfma_f32_16x16x32_bf16 v[84:87], a[120:123], v[132:135], 0
  v_lshlrev_b32 v247, 2, v247
  v_mfma_f32_16x16x32_bf16 v[88:91], a[124:127], v[128:131], 0
  v_xor_b32 v255, v255, v247
  v_lshlrev_b32 v255, 4, v255
  v_mfma_f32_16x16x32_bf16 v[92:95], a[124:127], v[132:135], 0
  v_lshl_add_u32 v246, v254, 10, v255
  v_add_u32 v247, 7168, v246
  v_mfma_f32_16x16x32_bf16 a[208:211], v[4:7], v[128:131], 0
  v_add_u32 v248, 14336, v246
  v_add_u32 v249, 21504, v246
  v_mfma_f32_16x16x32_bf16 a[212:215], v[4:7], v[132:135], 0
  v_lshrrev_b32 v254, 5, v250
  v_mfma_f32_16x16x32_bf16 v[144:147], a[64:67], a[32:35], 0
  v_exp_f32 v224, v224
  v_mfma_f32_16x16x32_bf16 v[144:147], a[68:71], a[36:39], v[144:147]
  v_mfma_f32_16x16x32_bf16 v[144:147], a[72:75], a[40:43], v[144:147]
  v_exp_f32 v225, v225
  v_mfma_f32_16x16x32_bf16 v[144:147], a[76:79], a[44:47], v[144:147]
  v_exp_f32 v226, v226
  v_mfma_f32_16x16x32_bf16 v[152:155], a[64:67], a[48:51], 0
  ds_read_b128 a[64:67], v1 offset:16384
  v_cvt_pk_bf16_f32 v128, v224, v225
  v_mfma_f32_16x16x32_bf16 v[152:155], a[68:71], a[52:55], v[152:155]
  v_exp_f32 v227, v227
  v_mfma_f32_16x16x32_bf16 v[152:155], a[72:75], a[56:59], v[152:155]
  ds_read_b128 a[68:71], v1 offset:17408
  v_cvt_pk_bf16_f32 v129, v226, v227
  v_mfma_f32_16x16x32_bf16 v[152:155], a[76:79], a[60:63], v[152:155]
  v_exp_f32 v228, v228
  v_mfma_f32_16x16x32_bf16 v[148:151], a[80:83], a[32:35], 0
  ds_read_b128 a[72:75], v1 offset:18432
  v_mfma_f32_16x16x32_bf16 v[148:151], a[84:87], a[36:39], v[148:151]
  s_add_u32 s60, s60, 32768
  v_exp_f32 v229, v229
  v_mfma_f32_16x16x32_bf16 v[148:151], a[88:91], a[40:43], v[148:151]
  ds_read_b128 a[76:79], v1 offset:19456
  v_cvt_pk_bf16_f32 v130, v228, v229
  v_mfma_f32_16x16x32_bf16 v[148:151], a[92:95], a[44:47], v[148:151]
  s_cmp_ge_u32 s60, 163840
  v_exp_f32 v230, v230
  v_mfma_f32_16x16x32_bf16 v[156:159], a[80:83], a[48:51], 0
  ds_read_b128 a[80:83], v1 offset:20480
  s_cselect_b32 s60, 0, s60
  v_mfma_f32_16x16x32_bf16 v[156:159], a[84:87], a[52:55], v[156:159]
  s_waitcnt lgkmcnt(15)
  v_exp_f32 v231, v231
  v_mfma_f32_16x16x32_bf16 v[156:159], a[88:91], a[56:59], v[156:159]
  ds_read_b128 a[84:87], v1 offset:21504
  v_cvt_pk_bf16_f32 v131, v230, v231
  v_mfma_f32_16x16x32_bf16 v[156:159], a[92:95], a[60:63], v[156:159]
  ds_read_b128 a[88:91], v1 offset:22528
  v_add_u32 v2, s60, v3
  v_mfma_f32_16x16x32_bf16 v[160:163], a[96:99], v[136:139], 0
  v_exp_f32 v232, v232
  v_mfma_f32_16x16x32_bf16 v[164:167], a[96:99], v[140:143], 0
  ds_read_b128 a[92:95], v1 offset:23552
  v_mfma_f32_16x16x32_bf16 v[168:171], a[100:103], v[136:139], 0
  v_exp_f32 v233, v233
  v_mfma_f32_16x16x32_bf16 v[172:175], a[100:103], v[140:143], 0
  ds_read_b128 a[96:99], v2 offset:8192
  v_cvt_pk_bf16_f32 v132, v232, v233
  v_mfma_f32_16x16x32_bf16 v[176:179], a[104:107], v[136:139], 0
  v_exp_f32 v234, v234
  v_mfma_f32_16x16x32_bf16 v[180:183], a[104:107], v[140:143], 0
  ds_read_b128 a[100:103], v2 offset:9216
  v_mfma_f32_16x16x32_bf16 v[184:187], a[108:111], v[136:139], 0
  v_exp_f32 v235, v235
  v_mfma_f32_16x16x32_bf16 v[188:191], a[108:111], v[140:143], 0
  ds_read_b128 a[104:107], v2 offset:10240
  v_cvt_pk_bf16_f32 v133, v234, v235
  v_mfma_f32_16x16x32_bf16 v[192:195], a[112:115], v[136:139], 0
  v_exp_f32 v236, v236
  v_mfma_f32_16x16x32_bf16 v[196:199], a[112:115], v[140:143], 0
  ds_read_b128 a[108:111], v2 offset:11264
  v_mfma_f32_16x16x32_bf16 v[200:203], a[116:119], v[136:139], 0
  v_exp_f32 v237, v237
  v_mfma_f32_16x16x32_bf16 v[204:207], a[116:119], v[140:143], 0
  ds_read_b128 a[112:115], v2 offset:12288
  v_cvt_pk_bf16_f32 v134, v236, v237
  v_mfma_f32_16x16x32_bf16 v[208:211], a[120:123], v[136:139], 0
  s_waitcnt lgkmcnt(5)
  v_exp_f32 v238, v238
  v_mfma_f32_16x16x32_bf16 v[212:215], a[120:123], v[140:143], 0
  ds_read_b128 a[116:119], v2 offset:13312
  v_mfma_f32_16x16x32_bf16 v[216:219], a[124:127], v[136:139], 0
  v_exp_f32 v239, v239
  v_mfma_f32_16x16x32_bf16 v[220:223], a[124:127], v[140:143], 0
  ds_read_b128 a[120:123], v2 offset:14336
  v_cvt_pk_bf16_f32 v135, v238, v239
  v_mfma_f32_16x16x32_bf16 a[216:219], v[4:7], v[136:139], 0
  ds_read_b128 a[124:127], v2 offset:15360
  v_mfma_f32_16x16x32_bf16 a[220:223], v[4:7], v[140:143], 0
  s_branch K2_DB
.p2align 4
K2_DL:
  v_mfma_f32_16x16x32_bf16 v[224:227], a[64:67], a[0:3], 0
  s_add_u32 m0, s58, 4096
  v_exp_f32 v144, v144
  v_mfma_f32_16x16x32_bf16 v[224:227], a[68:71], a[4:7], v[224:227]
  s_add_u32 s68, s68, 4096
  buffer_load_dwordx4 v24, s[12:15], s68 offen offset:0 sc1 lds
  v_mfma_f32_16x16x32_bf16 v[224:227], a[72:75], a[8:11], v[224:227]
  v_exp_f32 v145, v145
  v_mfma_f32_16x16x32_bf16 v[224:227], a[76:79], a[12:15], v[224:227]
  v_exp_f32 v146, v146
  v_mfma_f32_16x16x32_bf16 v[232:235], a[64:67], a[16:19], 0
  v_cvt_pk_bf16_f32 v136, v144, v145
  v_mfma_f32_16x16x32_bf16 v[232:235], a[68:71], a[20:23], v[232:235]
  v_exp_f32 v147, v147
  v_mfma_f32_16x16x32_bf16 v[232:235], a[72:75], a[24:27], v[232:235]
  v_cvt_pk_bf16_f32 v137, v146, v147
  v_mfma_f32_16x16x32_bf16 v[232:235], a[76:79], a[28:31], v[232:235]
  v_exp_f32 v148, v148
  v_mfma_f32_16x16x32_bf16 v[228:231], a[80:83], a[0:3], 0
  v_mfma_f32_16x16x32_bf16 v[228:231], a[84:87], a[4:7], v[228:231]
  v_exp_f32 v149, v149
  v_mfma_f32_16x16x32_bf16 v[228:231], a[88:91], a[8:11], v[228:231]
  v_cvt_pk_bf16_f32 v138, v148, v149
  v_mfma_f32_16x16x32_bf16 v[228:231], a[92:95], a[12:15], v[228:231]
  v_exp_f32 v150, v150
  v_mfma_f32_16x16x32_bf16 v[236:239], a[80:83], a[16:19], 0
  v_mfma_f32_16x16x32_bf16 v[236:239], a[84:87], a[20:23], v[236:239]
  s_waitcnt lgkmcnt(0)
  v_exp_f32 v151, v151
  v_mfma_f32_16x16x32_bf16 v[236:239], a[88:91], a[24:27], v[236:239]
  v_cvt_pk_bf16_f32 v139, v150, v151
  v_mfma_f32_16x16x32_bf16 v[236:239], a[92:95], a[28:31], v[236:239]
  v_mfma_f32_16x16x32_bf16 v[32:35], a[96:99], v[128:131], v[32:35]
  v_exp_f32 v152, v152
  v_mfma_f32_16x16x32_bf16 v[36:39], a[96:99], v[132:135], v[36:39]
  buffer_load_dwordx4 v24, s[12:15], s68 offen offset:1024 sc1 lds
  v_mfma_f32_16x16x32_bf16 v[40:43], a[100:103], v[128:131], v[40:43]
  v_exp_f32 v153, v153
  v_mfma_f32_16x16x32_bf16 v[44:47], a[100:103], v[132:135], v[44:47]
  v_cvt_pk_bf16_f32 v140, v152, v153
  v_mfma_f32_16x16x32_bf16 v[48:51], a[104:107], v[128:131], v[48:51]
  v_exp_f32 v154, v154
  v_mfma_f32_16x16x32_bf16 v[52:55], a[104:107], v[132:135], v[52:55]
  v_mfma_f32_16x16x32_bf16 v[56:59], a[108:111], v[128:131], v[56:59]
  v_exp_f32 v155, v155
  v_mfma_f32_16x16x32_bf16 v[60:63], a[108:111], v[132:135], v[60:63]
  v_cvt_pk_bf16_f32 v141, v154, v155
  v_mfma_f32_16x16x32_bf16 v[64:67], a[112:115], v[128:131], v[64:67]
  v_exp_f32 v156, v156
  v_mfma_f32_16x16x32_bf16 v[68:71], a[112:115], v[132:135], v[68:71]
  v_mfma_f32_16x16x32_bf16 v[72:75], a[116:119], v[128:131], v[72:75]
  v_exp_f32 v157, v157
  v_mfma_f32_16x16x32_bf16 v[76:79], a[116:119], v[132:135], v[76:79]
  v_cvt_pk_bf16_f32 v142, v156, v157
  v_mfma_f32_16x16x32_bf16 v[80:83], a[120:123], v[128:131], v[80:83]
  s_waitcnt lgkmcnt(8)
  v_exp_f32 v158, v158
  v_mfma_f32_16x16x32_bf16 v[84:87], a[120:123], v[132:135], v[84:87]
  v_mfma_f32_16x16x32_bf16 v[88:91], a[124:127], v[128:131], v[88:91]
  v_exp_f32 v159, v159
  v_mfma_f32_16x16x32_bf16 v[92:95], a[124:127], v[132:135], v[92:95]
  v_cvt_pk_bf16_f32 v143, v158, v159
  v_mfma_f32_16x16x32_bf16 a[208:211], v[4:7], v[128:131], a[208:211]
  v_mfma_f32_16x16x32_bf16 a[212:215], v[4:7], v[132:135], a[212:215]
  v_mfma_f32_16x16x32_bf16 v[144:147], a[64:67], a[32:35], 0
  v_exp_f32 v224, v224
  v_mfma_f32_16x16x32_bf16 v[144:147], a[68:71], a[36:39], v[144:147]
  v_mfma_f32_16x16x32_bf16 v[144:147], a[72:75], a[40:43], v[144:147]
  v_exp_f32 v225, v225
  v_mfma_f32_16x16x32_bf16 v[144:147], a[76:79], a[44:47], v[144:147]
  v_exp_f32 v226, v226
  v_mfma_f32_16x16x32_bf16 v[152:155], a[64:67], a[48:51], 0
  ds_read_b128 a[64:67], v1 offset:16384
  v_cvt_pk_bf16_f32 v128, v224, v225
  v_mfma_f32_16x16x32_bf16 v[152:155], a[68:71], a[52:55], v[152:155]
  v_exp_f32 v227, v227
  v_mfma_f32_16x16x32_bf16 v[152:155], a[72:75], a[56:59], v[152:155]
  ds_read_b128 a[68:71], v1 offset:17408
  v_cvt_pk_bf16_f32 v129, v226, v227
  v_mfma_f32_16x16x32_bf16 v[152:155], a[76:79], a[60:63], v[152:155]
  v_exp_f32 v228, v228
  v_mfma_f32_16x16x32_bf16 v[148:151], a[80:83], a[32:35], 0
  ds_read_b128 a[72:75], v1 offset:18432
  v_mfma_f32_16x16x32_bf16 v[148:151], a[84:87], a[36:39], v[148:151]
  s_add_u32 s60, s60, 32768
  v_exp_f32 v229, v229
  v_mfma_f32_16x16x32_bf16 v[148:151], a[88:91], a[40:43], v[148:151]
  ds_read_b128 a[76:79], v1 offset:19456
  v_cvt_pk_bf16_f32 v130, v228, v229
  v_mfma_f32_16x16x32_bf16 v[148:151], a[92:95], a[44:47], v[148:151]
  s_cmp_ge_u32 s60, 163840
  v_exp_f32 v230, v230
  v_mfma_f32_16x16x32_bf16 v[156:159], a[80:83], a[48:51], 0
  ds_read_b128 a[80:83], v1 offset:20480
  s_cselect_b32 s60, 0, s60
  v_mfma_f32_16x16x32_bf16 v[156:159], a[84:87], a[52:55], v[156:159]
  s_waitcnt lgkmcnt(5)
  v_exp_f32 v231, v231
  v_mfma_f32_16x16x32_bf16 v[156:159], a[88:91], a[56:59], v[156:159]
  ds_read_b128 a[84:87], v1 offset:21504
  v_cvt_pk_bf16_f32 v131, v230, v231
  v_mfma_f32_16x16x32_bf16 v[156:159], a[92:95], a[60:63], v[156:159]
  ds_read_b128 a[88:91], v1 offset:22528
  v_add_u32 v2, s60, v3
  v_mfma_f32_16x16x32_bf16 v[160:163], a[96:99], v[136:139], v[160:163]
  v_exp_f32 v232, v232
  v_mfma_f32_16x16x32_bf16 v[164:167], a[96:99], v[140:143], v[164:167]
  ds_read_b128 a[92:95], v1 offset:23552
  v_mfma_f32_16x16x32_bf16 v[168:171], a[100:103], v[136:139], v[168:171]
  v_exp_f32 v233, v233
  v_mfma_f32_16x16x32_bf16 v[172:175], a[100:103], v[140:143], v[172:175]
  ds_read_b128 a[96:99], v2 offset:8192
  v_cvt_pk_bf16_f32 v132, v232, v233
  v_mfma_f32_16x16x32_bf16 v[176:179], a[104:107], v[136:139], v[176:179]
  v_exp_f32 v234, v234
  v_mfma_f32_16x16x32_bf16 v[180:183], a[104:107], v[140:143], v[180:183]
  ds_read_b128 a[100:103], v2 offset:9216
  v_mfma_f32_16x16x32_bf16 v[184:187], a[108:111], v[136:139], v[184:187]
  v_exp_f32 v235, v235
  v_mfma_f32_16x16x32_bf16 v[188:191], a[108:111], v[140:143], v[188:191]
  ds_read_b128 a[104:107], v2 offset:10240
  v_cvt_pk_bf16_f32 v133, v234, v235
  v_mfma_f32_16x16x32_bf16 v[192:195], a[112:115], v[136:139], v[192:195]
  v_exp_f32 v236, v236
  v_mfma_f32_16x16x32_bf16 v[196:199], a[112:115], v[140:143], v[196:199]
  ds_read_b128 a[108:111], v2 offset:11264
  v_mfma_f32_16x16x32_bf16 v[200:203], a[116:119], v[136:139], v[200:203]
  v_exp_f32 v237, v237
  v_mfma_f32_16x16x32_bf16 v[204:207], a[116:119], v[140:143], v[204:207]
  ds_read_b128 a[112:115], v2 offset:12288
  v_cvt_pk_bf16_f32 v134, v236, v237
  v_mfma_f32_16x16x32_bf16 v[208:211], a[120:123], v[136:139], v[208:211]
  s_waitcnt lgkmcnt(5)
  v_exp_f32 v238, v238
  v_mfma_f32_16x16x32_bf16 v[212:215], a[120:123], v[140:143], v[212:215]
  ds_read_b128 a[116:119], v2 offset:13312
  v_mfma_f32_16x16x32_bf16 v[216:219], a[124:127], v[136:139], v[216:219]
  v_exp_f32 v239, v239
  v_mfma_f32_16x16x32_bf16 v[220:223], a[124:127], v[140:143], v[220:223]
  ds_read_b128 a[120:123], v2 offset:14336
  v_cvt_pk_bf16_f32 v135, v238, v239
  v_mfma_f32_16x16x32_bf16 a[216:219], v[4:7], v[136:139], a[216:219]
  ds_read_b128 a[124:127], v2 offset:15360
  v_mfma_f32_16x16x32_bf16 a[220:223], v[4:7], v[140:143], a[220:223]
K2_DB:
  v_mfma_f32_16x16x32_bf16 v[224:227], a[64:67], a[0:3], 0
  v_exp_f32 v144, v144
  v_mfma_f32_16x16x32_bf16 v[224:227], a[68:71], a[4:7], v[224:227]
  buffer_load_dwordx4 v24, s[12:15], s68 offen offset:2048 sc1 lds
  v_mfma_f32_16x16x32_bf16 v[224:227], a[72:75], a[8:11], v[224:227]
  v_exp_f32 v145, v145
  v_mfma_f32_16x16x32_bf16 v[224:227], a[76:79], a[12:15], v[224:227]
  v_exp_f32 v146, v146
  v_mfma_f32_16x16x32_bf16 v[232:235], a[64:67], a[16:19], 0
  v_cvt_pk_bf16_f32 v136, v144, v145
  v_mfma_f32_16x16x32_bf16 v[232:235], a[68:71], a[20:23], v[232:235]
  v_exp_f32 v147, v147
  v_mfma_f32_16x16x32_bf16 v[232:235], a[72:75], a[24:27], v[232:235]
  v_cvt_pk_bf16_f32 v137, v146, v147
  v_mfma_f32_16x16x32_bf16 v[232:235], a[76:79], a[28:31], v[232:235]
  v_exp_f32 v148, v148
  v_mfma_f32_16x16x32_bf16 v[228:231], a[80:83], a[0:3], 0
  v_mfma_f32_16x16x32_bf16 v[228:231], a[84:87], a[4:7], v[228:231]
  v_exp_f32 v149, v149
  v_mfma_f32_16x16x32_bf16 v[228:231], a[88:91], a[8:11], v[228:231]
  v_cvt_pk_bf16_f32 v138, v148, v149
  v_mfma_f32_16x16x32_bf16 v[228:231], a[92:95], a[12:15], v[228:231]
  v_exp_f32 v150, v150
  v_mfma_f32_16x16x32_bf16 v[236:239], a[80:83], a[16:19], 0
  v_mfma_f32_16x16x32_bf16 v[236:239], a[84:87], a[20:23], v[236:239]
  s_waitcnt lgkmcnt(0)
  v_exp_f32 v151, v151
  v_mfma_f32_16x16x32_bf16 v[236:239], a[88:91], a[24:27], v[236:239]
  v_cvt_pk_bf16_f32 v139, v150, v151
  v_mfma_f32_16x16x32_bf16 v[236:239], a[92:95], a[28:31], v[236:239]
  v_mfma_f32_16x16x32_bf16 v[32:35], a[96:99], v[128:131], v[32:35]
  s_add_u32 s59, s59, 32768
  v_exp_f32 v152, v152
  v_mfma_f32_16x16x32_bf16 v[36:39], a[96:99], v[132:135], v[36:39]
  v_mfma_f32_16x16x32_bf16 v[40:43], a[100:103], v[128:131], v[40:43]
  s_cmp_ge_u32 s59, 163840
  v_exp_f32 v153, v153
  v_mfma_f32_16x16x32_bf16 v[44:47], a[100:103], v[132:135], v[44:47]
  v_cvt_pk_bf16_f32 v140, v152, v153
  v_mfma_f32_16x16x32_bf16 v[48:51], a[104:107], v[128:131], v[48:51]
  s_cselect_b32 s59, 0, s59
  v_exp_f32 v154, v154
  v_mfma_f32_16x16x32_bf16 v[52:55], a[104:107], v[132:135], v[52:55]
  v_add_u32 v1, s59, v3
  v_mfma_f32_16x16x32_bf16 v[56:59], a[108:111], v[128:131], v[56:59]
  s_add_u32 s58, s58, 32768
  v_exp_f32 v155, v155
  v_mfma_f32_16x16x32_bf16 v[60:63], a[108:111], v[132:135], v[60:63]
  v_cvt_pk_bf16_f32 v141, v154, v155
  v_mfma_f32_16x16x32_bf16 v[64:67], a[112:115], v[128:131], v[64:67]
  s_cmp_ge_u32 s58, 163840
  v_exp_f32 v156, v156
  v_mfma_f32_16x16x32_bf16 v[68:71], a[112:115], v[132:135], v[68:71]
  v_mfma_f32_16x16x32_bf16 v[72:75], a[116:119], v[128:131], v[72:75]
  s_cselect_b32 s58, s61, s58
  v_exp_f32 v157, v157
  v_mfma_f32_16x16x32_bf16 v[76:79], a[116:119], v[132:135], v[76:79]
  v_cvt_pk_bf16_f32 v142, v156, v157
  v_mfma_f32_16x16x32_bf16 v[80:83], a[120:123], v[128:131], v[80:83]
  s_waitcnt lgkmcnt(8)
  v_exp_f32 v158, v158
  v_mfma_f32_16x16x32_bf16 v[84:87], a[120:123], v[132:135], v[84:87]
  v_mfma_f32_16x16x32_bf16 v[88:91], a[124:127], v[128:131], v[88:91]
  v_exp_f32 v159, v159
  v_mfma_f32_16x16x32_bf16 v[92:95], a[124:127], v[132:135], v[92:95]
  v_cvt_pk_bf16_f32 v143, v158, v159
  v_mfma_f32_16x16x32_bf16 a[208:211], v[4:7], v[128:131], a[208:211]
  v_mfma_f32_16x16x32_bf16 a[212:215], v[4:7], v[132:135], a[212:215]
  buffer_load_dwordx4 v24, s[12:15], s68 offen offset:3072 sc1 lds
  v_mfma_f32_16x16x32_bf16 v[144:147], a[64:67], a[32:35], 0
  s_waitcnt vmcnt(8)
  v_exp_f32 v224, v224
  v_mfma_f32_16x16x32_bf16 v[144:147], a[68:71], a[36:39], v[144:147]
  s_barrier
  v_mfma_f32_16x16x32_bf16 v[144:147], a[72:75], a[40:43], v[144:147]
  s_sub_u32 s68, 32, s57
  v_exp_f32 v225, v225
  v_mfma_f32_16x16x32_bf16 v[144:147], a[76:79], a[44:47], v[144:147]
  s_cmp_le_u32 s57, s69
  v_exp_f32 v226, v226
  v_mfma_f32_16x16x32_bf16 v[152:155], a[64:67], a[48:51], 0
  ds_read_b128 a[64:67], v1 offset:0
  v_cvt_pk_bf16_f32 v128, v224, v225
  v_mfma_f32_16x16x32_bf16 v[152:155], a[68:71], a[52:55], v[152:155]
  s_cselect_b32 s68, s57, s68
  v_exp_f32 v227, v227
  v_mfma_f32_16x16x32_bf16 v[152:155], a[72:75], a[56:59], v[152:155]
  ds_read_b128 a[68:71], v1 offset:1024
  v_cvt_pk_bf16_f32 v129, v226, v227
  v_mfma_f32_16x16x32_bf16 v[152:155], a[76:79], a[60:63], v[152:155]
  s_lshl_b32 s68, s68, 15
  v_exp_f32 v228, v228
  v_mfma_f32_16x16x32_bf16 v[148:151], a[80:83], a[32:35], 0
  ds_read_b128 a[72:75], v1 offset:2048
  v_mfma_f32_16x16x32_bf16 v[148:151], a[84:87], a[36:39], v[148:151]
  s_mov_b32 m0, s58
  v_exp_f32 v229, v229
  v_mfma_f32_16x16x32_bf16 v[148:151], a[88:91], a[40:43], v[148:151]
  ds_read_b128 a[76:79], v1 offset:3072
  v_cvt_pk_bf16_f32 v130, v228, v229
  v_mfma_f32_16x16x32_bf16 v[148:151], a[92:95], a[44:47], v[148:151]
  v_exp_f32 v230, v230
  v_mfma_f32_16x16x32_bf16 v[156:159], a[80:83], a[48:51], 0
  ds_read_b128 a[80:83], v1 offset:4096
  buffer_load_dwordx4 v24, s[12:15], s68 offen offset:0 sc1 lds
  v_mfma_f32_16x16x32_bf16 v[156:159], a[84:87], a[52:55], v[156:159]
  s_waitcnt lgkmcnt(5)
  v_exp_f32 v231, v231
  v_mfma_f32_16x16x32_bf16 v[156:159], a[88:91], a[56:59], v[156:159]
  ds_read_b128 a[84:87], v1 offset:5120
  v_cvt_pk_bf16_f32 v131, v230, v231
  v_mfma_f32_16x16x32_bf16 v[156:159], a[92:95], a[60:63], v[156:159]
  ds_read_b128 a[88:91], v1 offset:6144
  v_mfma_f32_16x16x32_bf16 v[160:163], a[96:99], v[136:139], v[160:163]
  s_add_u32 s57, s57, 1
  v_exp_f32 v232, v232
  v_mfma_f32_16x16x32_bf16 v[164:167], a[96:99], v[140:143], v[164:167]
  ds_read_b128 a[92:95], v1 offset:7168
  buffer_load_dwordx4 v24, s[12:15], s68 offen offset:1024 sc1 lds
  v_mfma_f32_16x16x32_bf16 v[168:171], a[100:103], v[136:139], v[168:171]
  v_exp_f32 v233, v233
  v_mfma_f32_16x16x32_bf16 v[172:175], a[100:103], v[140:143], v[172:175]
  ds_read_b128 a[96:99], v2 offset:24576
  v_cvt_pk_bf16_f32 v132, v232, v233
  v_mfma_f32_16x16x32_bf16 v[176:179], a[104:107], v[136:139], v[176:179]
  v_exp_f32 v234, v234
  v_mfma_f32_16x16x32_bf16 v[180:183], a[104:107], v[140:143], v[180:183]
  ds_read_b128 a[100:103], v2 offset:25600
  v_mfma_f32_16x16x32_bf16 v[184:187], a[108:111], v[136:139], v[184:187]
  v_exp_f32 v235, v235
  v_mfma_f32_16x16x32_bf16 v[188:191], a[108:111], v[140:143], v[188:191]
  ds_read_b128 a[104:107], v2 offset:26624
  v_cvt_pk_bf16_f32 v133, v234, v235
  v_mfma_f32_16x16x32_bf16 v[192:195], a[112:115], v[136:139], v[192:195]
  v_exp_f32 v236, v236
  v_mfma_f32_16x16x32_bf16 v[196:199], a[112:115], v[140:143], v[196:199]
  ds_read_b128 a[108:111], v2 offset:27648
  buffer_load_dwordx4 v24, s[12:15], s68 offen offset:2048 sc1 lds
  v_mfma_f32_16x16x32_bf16 v[200:203], a[116:119], v[136:139], v[200:203]
  v_exp_f32 v237, v237
  v_mfma_f32_16x16x32_bf16 v[204:207], a[116:119], v[140:143], v[204:207]
  ds_read_b128 a[112:115], v2 offset:28672
  v_cvt_pk_bf16_f32 v134, v236, v237
  v_mfma_f32_16x16x32_bf16 v[208:211], a[120:123], v[136:139], v[208:211]
  s_waitcnt lgkmcnt(5)
  v_exp_f32 v238, v238
  v_mfma_f32_16x16x32_bf16 v[212:215], a[120:123], v[140:143], v[212:215]
  ds_read_b128 a[116:119], v2 offset:29696
  v_mfma_f32_16x16x32_bf16 v[216:219], a[124:127], v[136:139], v[216:219]
  v_exp_f32 v239, v239
  v_mfma_f32_16x16x32_bf16 v[220:223], a[124:127], v[140:143], v[220:223]
  ds_read_b128 a[120:123], v2 offset:30720
  v_cvt_pk_bf16_f32 v135, v238, v239
  v_mfma_f32_16x16x32_bf16 a[216:219], v[4:7], v[136:139], a[216:219]
  ds_read_b128 a[124:127], v2 offset:31744
  v_mfma_f32_16x16x32_bf16 a[220:223], v[4:7], v[140:143], a[220:223]
  buffer_load_dwordx4 v24, s[12:15], s68 offen offset:3072 sc1 lds
  v_mfma_f32_16x16x32_bf16 v[224:227], a[64:67], a[0:3], 0
  s_add_u32 m0, s58, 4096
  v_exp_f32 v144, v144
  v_mfma_f32_16x16x32_bf16 v[224:227], a[68:71], a[4:7], v[224:227]
  s_add_u32 s68, s68, 4096
  buffer_load_dwordx4 v24, s[12:15], s68 offen offset:0 sc1 lds
  v_mfma_f32_16x16x32_bf16 v[224:227], a[72:75], a[8:11], v[224:227]
  v_exp_f32 v145, v145
  v_mfma_f32_16x16x32_bf16 v[224:227], a[76:79], a[12:15], v[224:227]
  v_exp_f32 v146, v146
  v_mfma_f32_16x16x32_bf16 v[232:235], a[64:67], a[16:19], 0
  v_cvt_pk_bf16_f32 v136, v144, v145
  v_mfma_f32_16x16x32_bf16 v[232:235], a[68:71], a[20:23], v[232:235]
  v_exp_f32 v147, v147
  v_mfma_f32_16x16x32_bf16 v[232:235], a[72:75], a[24:27], v[232:235]
  v_cvt_pk_bf16_f32 v137, v146, v147
  v_mfma_f32_16x16x32_bf16 v[232:235], a[76:79], a[28:31], v[232:235]
  v_exp_f32 v148, v148
  v_mfma_f32_16x16x32_bf16 v[228:231], a[80:83], a[0:3], 0
  v_mfma_f32_16x16x32_bf16 v[228:231], a[84:87], a[4:7], v[228:231]
  v_exp_f32 v149, v149
  v_mfma_f32_16x16x32_bf16 v[228:231], a[88:91], a[8:11], v[228:231]
  v_cvt_pk_bf16_f32 v138, v148, v149
  v_mfma_f32_16x16x32_bf16 v[228:231], a[92:95], a[12:15], v[228:231]
  v_exp_f32 v150, v150
  v_mfma_f32_16x16x32_bf16 v[236:239], a[80:83], a[16:19], 0
  v_mfma_f32_16x16x32_bf16 v[236:239], a[84:87], a[20:23], v[236:239]
  s_waitcnt lgkmcnt(0)
  v_exp_f32 v151, v151
  v_mfma_f32_16x16x32_bf16 v[236:239], a[88:91], a[24:27], v[236:239]
  v_cvt_pk_bf16_f32 v139, v150, v151
  v_mfma_f32_16x16x32_bf16 v[236:239], a[92:95], a[28:31], v[236:239]
  v_mfma_f32_16x16x32_bf16 v[32:35], a[96:99], v[128:131], v[32:35]
  v_exp_f32 v152, v152
  v_mfma_f32_16x16x32_bf16 v[36:39], a[96:99], v[132:135], v[36:39]
  buffer_load_dwordx4 v24, s[12:15], s68 offen offset:1024 sc1 lds
  v_mfma_f32_16x16x32_bf16 v[40:43], a[100:103], v[128:131], v[40:43]
  v_exp_f32 v153, v153
  v_mfma_f32_16x16x32_bf16 v[44:47], a[100:103], v[132:135], v[44:47]
  v_cvt_pk_bf16_f32 v140, v152, v153
  v_mfma_f32_16x16x32_bf16 v[48:51], a[104:107], v[128:131], v[48:51]
  v_exp_f32 v154, v154
  v_mfma_f32_16x16x32_bf16 v[52:55], a[104:107], v[132:135], v[52:55]
  v_mfma_f32_16x16x32_bf16 v[56:59], a[108:111], v[128:131], v[56:59]
  v_exp_f32 v155, v155
  v_mfma_f32_16x16x32_bf16 v[60:63], a[108:111], v[132:135], v[60:63]
  v_cvt_pk_bf16_f32 v141, v154, v155
  v_mfma_f32_16x16x32_bf16 v[64:67], a[112:115], v[128:131], v[64:67]
  v_exp_f32 v156, v156
  v_mfma_f32_16x16x32_bf16 v[68:71], a[112:115], v[132:135], v[68:71]
  v_mfma_f32_16x16x32_bf16 v[72:75], a[116:119], v[128:131], v[72:75]
  v_exp_f32 v157, v157
  v_mfma_f32_16x16x32_bf16 v[76:79], a[116:119], v[132:135], v[76:79]
  v_cvt_pk_bf16_f32 v142, v156, v157
  v_mfma_f32_16x16x32_bf16 v[80:83], a[120:123], v[128:131], v[80:83]
  s_waitcnt lgkmcnt(8)
  v_exp_f32 v158, v158
  v_mfma_f32_16x16x32_bf16 v[84:87], a[120:123], v[132:135], v[84:87]
  v_mfma_f32_16x16x32_bf16 v[88:91], a[124:127], v[128:131], v[88:91]
  v_exp_f32 v159, v159
  v_mfma_f32_16x16x32_bf16 v[92:95], a[124:127], v[132:135], v[92:95]
  v_cvt_pk_bf16_f32 v143, v158, v159
  v_mfma_f32_16x16x32_bf16 a[208:211], v[4:7], v[128:131], a[208:211]
  v_mfma_f32_16x16x32_bf16 a[212:215], v[4:7], v[132:135], a[212:215]
  v_mfma_f32_16x16x32_bf16 v[144:147], a[64:67], a[32:35], 0
  v_exp_f32 v224, v224
  v_mfma_f32_16x16x32_bf16 v[144:147], a[68:71], a[36:39], v[144:147]
  v_mfma_f32_16x16x32_bf16 v[144:147], a[72:75], a[40:43], v[144:147]
  v_exp_f32 v225, v225
  v_mfma_f32_16x16x32_bf16 v[144:147], a[76:79], a[44:47], v[144:147]
  v_exp_f32 v226, v226
  v_mfma_f32_16x16x32_bf16 v[152:155], a[64:67], a[48:51], 0
  ds_read_b128 a[64:67], v1 offset:16384
  v_cvt_pk_bf16_f32 v128, v224, v225
  v_mfma_f32_16x16x32_bf16 v[152:155], a[68:71], a[52:55], v[152:155]
  v_exp_f32 v227, v227
  v_mfma_f32_16x16x32_bf16 v[152:155], a[72:75], a[56:59], v[152:155]
  ds_read_b128 a[68:71], v1 offset:17408
  v_cvt_pk_bf16_f32 v129, v226, v227
  v_mfma_f32_16x16x32_bf16 v[152:155], a[76:79], a[60:63], v[152:155]
  v_exp_f32 v228, v228
  v_mfma_f32_16x16x32_bf16 v[148:151], a[80:83], a[32:35], 0
  ds_read_b128 a[72:75], v1 offset:18432
  v_mfma_f32_16x16x32_bf16 v[148:151], a[84:87], a[36:39], v[148:151]
  s_add_u32 s60, s60, 32768
  v_exp_f32 v229, v229
  v_mfma_f32_16x16x32_bf16 v[148:151], a[88:91], a[40:43], v[148:151]
  ds_read_b128 a[76:79], v1 offset:19456
  v_cvt_pk_bf16_f32 v130, v228, v229
  v_mfma_f32_16x16x32_bf16 v[148:151], a[92:95], a[44:47], v[148:151]
  s_cmp_ge_u32 s60, 163840
  v_exp_f32 v230, v230
  v_mfma_f32_16x16x32_bf16 v[156:159], a[80:83], a[48:51], 0
  ds_read_b128 a[80:83], v1 offset:20480
  s_cselect_b32 s60, 0, s60
  v_mfma_f32_16x16x32_bf16 v[156:159], a[84:87], a[52:55], v[156:159]
  s_waitcnt lgkmcnt(5)
  v_exp_f32 v231, v231
  v_mfma_f32_16x16x32_bf16 v[156:159], a[88:91], a[56:59], v[156:159]
  ds_read_b128 a[84:87], v1 offset:21504
  v_cvt_pk_bf16_f32 v131, v230, v231
  v_mfma_f32_16x16x32_bf16 v[156:159], a[92:95], a[60:63], v[156:159]
  ds_read_b128 a[88:91], v1 offset:22528
  v_add_u32 v2, s60, v3
  v_mfma_f32_16x16x32_bf16 v[160:163], a[96:99], v[136:139], v[160:163]
  v_exp_f32 v232, v232
  v_mfma_f32_16x16x32_bf16 v[164:167], a[96:99], v[140:143], v[164:167]
  ds_read_b128 a[92:95], v1 offset:23552
  v_mfma_f32_16x16x32_bf16 v[168:171], a[100:103], v[136:139], v[168:171]
  v_exp_f32 v233, v233
  v_mfma_f32_16x16x32_bf16 v[172:175], a[100:103], v[140:143], v[172:175]
  ds_read_b128 a[96:99], v2 offset:8192
  v_cvt_pk_bf16_f32 v132, v232, v233
  v_mfma_f32_16x16x32_bf16 v[176:179], a[104:107], v[136:139], v[176:179]
  v_exp_f32 v234, v234
  v_mfma_f32_16x16x32_bf16 v[180:183], a[104:107], v[140:143], v[180:183]
  ds_read_b128 a[100:103], v2 offset:9216
  v_mfma_f32_16x16x32_bf16 v[184:187], a[108:111], v[136:139], v[184:187]
  v_exp_f32 v235, v235
  v_mfma_f32_16x16x32_bf16 v[188:191], a[108:111], v[140:143], v[188:191]
  ds_read_b128 a[104:107], v2 offset:10240
  v_cvt_pk_bf16_f32 v133, v234, v235
  v_mfma_f32_16x16x32_bf16 v[192:195], a[112:115], v[136:139], v[192:195]
  v_exp_f32 v236, v236
  v_mfma_f32_16x16x32_bf16 v[196:199], a[112:115], v[140:143], v[196:199]
  ds_read_b128 a[108:111], v2 offset:11264
  v_mfma_f32_16x16x32_bf16 v[200:203], a[116:119], v[136:139], v[200:203]
  v_exp_f32 v237, v237
  v_mfma_f32_16x16x32_bf16 v[204:207], a[116:119], v[140:143], v[204:207]
  ds_read_b128 a[112:115], v2 offset:12288
  v_cvt_pk_bf16_f32 v134, v236, v237
  v_mfma_f32_16x16x32_bf16 v[208:211], a[120:123], v[136:139], v[208:211]
  s_waitcnt lgkmcnt(5)
  v_exp_f32 v238, v238
  v_mfma_f32_16x16x32_bf16 v[212:215], a[120:123], v[140:143], v[212:215]
  ds_read_b128 a[116:119], v2 offset:13312
  v_mfma_f32_16x16x32_bf16 v[216:219], a[124:127], v[136:139], v[216:219]
  v_exp_f32 v239, v239
  v_mfma_f32_16x16x32_bf16 v[220:223], a[124:127], v[140:143], v[220:223]
  ds_read_b128 a[120:123], v2 offset:14336
  v_cvt_pk_bf16_f32 v135, v238, v239
  v_mfma_f32_16x16x32_bf16 a[216:219], v[4:7], v[136:139], a[216:219]
  ds_read_b128 a[124:127], v2 offset:15360
  v_mfma_f32_16x16x32_bf16 a[220:223], v[4:7], v[140:143], a[220:223]
  v_mfma_f32_16x16x32_bf16 v[224:227], a[64:67], a[0:3], 0
  v_exp_f32 v144, v144
  v_mfma_f32_16x16x32_bf16 v[224:227], a[68:71], a[4:7], v[224:227]
  buffer_load_dwordx4 v24, s[12:15], s68 offen offset:2048 sc1 lds
  v_mfma_f32_16x16x32_bf16 v[224:227], a[72:75], a[8:11], v[224:227]
  v_exp_f32 v145, v145
  v_mfma_f32_16x16x32_bf16 v[224:227], a[76:79], a[12:15], v[224:227]
  v_exp_f32 v146, v146
  v_mfma_f32_16x16x32_bf16 v[232:235], a[64:67], a[16:19], 0
  v_cvt_pk_bf16_f32 v136, v144, v145
  v_mfma_f32_16x16x32_bf16 v[232:235], a[68:71], a[20:23], v[232:235]
  v_exp_f32 v147, v147
  v_mfma_f32_16x16x32_bf16 v[232:235], a[72:75], a[24:27], v[232:235]
  v_cvt_pk_bf16_f32 v137, v146, v147
  v_mfma_f32_16x16x32_bf16 v[232:235], a[76:79], a[28:31], v[232:235]
  v_exp_f32 v148, v148
  v_mfma_f32_16x16x32_bf16 v[228:231], a[80:83], a[0:3], 0
  v_mfma_f32_16x16x32_bf16 v[228:231], a[84:87], a[4:7], v[228:231]
  v_exp_f32 v149, v149
  v_mfma_f32_16x16x32_bf16 v[228:231], a[88:91], a[8:11], v[228:231]
  v_cvt_pk_bf16_f32 v138, v148, v149
  v_mfma_f32_16x16x32_bf16 v[228:231], a[92:95], a[12:15], v[228:231]
  v_exp_f32 v150, v150
  v_mfma_f32_16x16x32_bf16 v[236:239], a[80:83], a[16:19], 0
  v_mfma_f32_16x16x32_bf16 v[236:239], a[84:87], a[20:23], v[236:239]
  s_waitcnt lgkmcnt(0)
  v_exp_f32 v151, v151
  v_mfma_f32_16x16x32_bf16 v[236:239], a[88:91], a[24:27], v[236:239]
  v_cvt_pk_bf16_f32 v139, v150, v151
  v_mfma_f32_16x16x32_bf16 v[236:239], a[92:95], a[28:31], v[236:239]
  v_mfma_f32_16x16x32_bf16 v[32:35], a[96:99], v[128:131], v[32:35]
  s_add_u32 s59, s59, 32768
  v_exp_f32 v152, v152
  v_mfma_f32_16x16x32_bf16 v[36:39], a[96:99], v[132:135], v[36:39]
  v_mfma_f32_16x16x32_bf16 v[40:43], a[100:103], v[128:131], v[40:43]
  s_cmp_ge_u32 s59, 163840
  v_exp_f32 v153, v153
  v_mfma_f32_16x16x32_bf16 v[44:47], a[100:103], v[132:135], v[44:47]
  v_cvt_pk_bf16_f32 v140, v152, v153
  v_mfma_f32_16x16x32_bf16 v[48:51], a[104:107], v[128:131], v[48:51]
  s_cselect_b32 s59, 0, s59
  v_exp_f32 v154, v154
  v_mfma_f32_16x16x32_bf16 v[52:55], a[104:107], v[132:135], v[52:55]
  v_add_u32 v1, s59, v3
  v_mfma_f32_16x16x32_bf16 v[56:59], a[108:111], v[128:131], v[56:59]
  s_add_u32 s58, s58, 32768
  v_exp_f32 v155, v155
  v_mfma_f32_16x16x32_bf16 v[60:63], a[108:111], v[132:135], v[60:63]
  v_cvt_pk_bf16_f32 v141, v154, v155
  v_mfma_f32_16x16x32_bf16 v[64:67], a[112:115], v[128:131], v[64:67]
  s_cmp_ge_u32 s58, 163840
  v_exp_f32 v156, v156
  v_mfma_f32_16x16x32_bf16 v[68:71], a[112:115], v[132:135], v[68:71]
  v_mfma_f32_16x16x32_bf16 v[72:75], a[116:119], v[128:131], v[72:75]
  s_cselect_b32 s58, s61, s58
  v_exp_f32 v157, v157
  v_mfma_f32_16x16x32_bf16 v[76:79], a[116:119], v[132:135], v[76:79]
  v_cvt_pk_bf16_f32 v142, v156, v157
  v_mfma_f32_16x16x32_bf16 v[80:83], a[120:123], v[128:131], v[80:83]
  s_waitcnt lgkmcnt(8)
  v_exp_f32 v158, v158
  v_mfma_f32_16x16x32_bf16 v[84:87], a[120:123], v[132:135], v[84:87]
  v_mfma_f32_16x16x32_bf16 v[88:91], a[124:127], v[128:131], v[88:91]
  v_exp_f32 v159, v159
  v_mfma_f32_16x16x32_bf16 v[92:95], a[124:127], v[132:135], v[92:95]
  v_cvt_pk_bf16_f32 v143, v158, v159
  v_mfma_f32_16x16x32_bf16 a[208:211], v[4:7], v[128:131], a[208:211]
  v_mfma_f32_16x16x32_bf16 a[212:215], v[4:7], v[132:135], a[212:215]
  buffer_load_dwordx4 v24, s[12:15], s68 offen offset:3072 sc1 lds
  v_mfma_f32_16x16x32_bf16 v[144:147], a[64:67], a[32:35], 0
  s_waitcnt vmcnt(8)
  v_exp_f32 v224, v224
  v_mfma_f32_16x16x32_bf16 v[144:147], a[68:71], a[36:39], v[144:147]
  s_barrier
  v_mfma_f32_16x16x32_bf16 v[144:147], a[72:75], a[40:43], v[144:147]
  s_sub_u32 s68, 32, s57
  v_exp_f32 v225, v225
  v_mfma_f32_16x16x32_bf16 v[144:147], a[76:79], a[44:47], v[144:147]
  s_cmp_le_u32 s57, s69
  v_exp_f32 v226, v226
  v_mfma_f32_16x16x32_bf16 v[152:155], a[64:67], a[48:51], 0
  ds_read_b128 a[64:67], v1 offset:0
  v_cvt_pk_bf16_f32 v128, v224, v225
  v_mfma_f32_16x16x32_bf16 v[152:155], a[68:71], a[52:55], v[152:155]
  s_cselect_b32 s68, s57, s68
  v_exp_f32 v227, v227
  v_mfma_f32_16x16x32_bf16 v[152:155], a[72:75], a[56:59], v[152:155]
  ds_read_b128 a[68:71], v1 offset:1024
  v_cvt_pk_bf16_f32 v129, v226, v227
  v_mfma_f32_16x16x32_bf16 v[152:155], a[76:79], a[60:63], v[152:155]
  s_lshl_b32 s68, s68, 15
  v_exp_f32 v228, v228
  v_mfma_f32_16x16x32_bf16 v[148:151], a[80:83], a[32:35], 0
  ds_read_b128 a[72:75], v1 offset:2048
  v_mfma_f32_16x16x32_bf16 v[148:151], a[84:87], a[36:39], v[148:151]
  s_mov_b32 m0, s58
  v_exp_f32 v229, v229
  v_mfma_f32_16x16x32_bf16 v[148:151], a[88:91], a[40:43], v[148:151]
  ds_read_b128 a[76:79], v1 offset:3072
  v_cvt_pk_bf16_f32 v130, v228, v229
  v_mfma_f32_16x16x32_bf16 v[148:151], a[92:95], a[44:47], v[148:151]
  v_exp_f32 v230, v230
  v_mfma_f32_16x16x32_bf16 v[156:159], a[80:83], a[48:51], 0
  ds_read_b128 a[80:83], v1 offset:4096
  buffer_load_dwordx4 v24, s[12:15], s68 offen offset:0 sc1 lds
  v_mfma_f32_16x16x32_bf16 v[156:159], a[84:87], a[52:55], v[156:159]
  s_waitcnt lgkmcnt(5)
  v_exp_f32 v231, v231
  v_mfma_f32_16x16x32_bf16 v[156:159], a[88:91], a[56:59], v[156:159]
  ds_read_b128 a[84:87], v1 offset:5120
  v_cvt_pk_bf16_f32 v131, v230, v231
  v_mfma_f32_16x16x32_bf16 v[156:159], a[92:95], a[60:63], v[156:159]
  ds_read_b128 a[88:91], v1 offset:6144
  v_mfma_f32_16x16x32_bf16 v[160:163], a[96:99], v[136:139], v[160:163]
  s_add_u32 s57, s57, 1
  v_exp_f32 v232, v232
  v_mfma_f32_16x16x32_bf16 v[164:167], a[96:99], v[140:143], v[164:167]
  ds_read_b128 a[92:95], v1 offset:7168
  buffer_load_dwordx4 v24, s[12:15], s68 offen offset:1024 sc1 lds
  v_mfma_f32_16x16x32_bf16 v[168:171], a[100:103], v[136:139], v[168:171]
  v_exp_f32 v233, v233
  v_mfma_f32_16x16x32_bf16 v[172:175], a[100:103], v[140:143], v[172:175]
  ds_read_b128 a[96:99], v2 offset:24576
  v_cvt_pk_bf16_f32 v132, v232, v233
  v_mfma_f32_16x16x32_bf16 v[176:179], a[104:107], v[136:139], v[176:179]
  v_exp_f32 v234, v234
  v_mfma_f32_16x16x32_bf16 v[180:183], a[104:107], v[140:143], v[180:183]
  ds_read_b128 a[100:103], v2 offset:25600
  v_mfma_f32_16x16x32_bf16 v[184:187], a[108:111], v[136:139], v[184:187]
  v_exp_f32 v235, v235
  v_mfma_f32_16x16x32_bf16 v[188:191], a[108:111], v[140:143], v[188:191]
  ds_read_b128 a[104:107], v2 offset:26624
  v_cvt_pk_bf16_f32 v133, v234, v235
  v_mfma_f32_16x16x32_bf16 v[192:195], a[112:115], v[136:139], v[192:195]
  v_exp_f32 v236, v236
  v_mfma_f32_16x16x32_bf16 v[196:199], a[112:115], v[140:143], v[196:199]
  ds_read_b128 a[108:111], v2 offset:27648
  buffer_load_dwordx4 v24, s[12:15], s68 offen offset:2048 sc1 lds
  v_mfma_f32_16x16x32_bf16 v[200:203], a[116:119], v[136:139], v[200:203]
  v_exp_f32 v237, v237
  v_mfma_f32_16x16x32_bf16 v[204:207], a[116:119], v[140:143], v[204:207]
  ds_read_b128 a[112:115], v2 offset:28672
  v_cvt_pk_bf16_f32 v134, v236, v237
  v_mfma_f32_16x16x32_bf16 v[208:211], a[120:123], v[136:139], v[208:211]
  s_waitcnt lgkmcnt(5)
  v_exp_f32 v238, v238
  v_mfma_f32_16x16x32_bf16 v[212:215], a[120:123], v[140:143], v[212:215]
  ds_read_b128 a[116:119], v2 offset:29696
  buffer_load_dwordx4 v24, s[12:15], s68 offen offset:3072 sc1 lds
  v_mfma_f32_16x16x32_bf16 v[216:219], a[124:127], v[136:139], v[216:219]
  s_sub_u32 s56, s56, 1
  v_exp_f32 v239, v239
  v_mfma_f32_16x16x32_bf16 v[220:223], a[124:127], v[140:143], v[220:223]
  ds_read_b128 a[120:123], v2 offset:30720
  v_cvt_pk_bf16_f32 v135, v238, v239
  v_mfma_f32_16x16x32_bf16 a[216:219], v[4:7], v[136:139], a[216:219]
  ds_read_b128 a[124:127], v2 offset:31744
  v_mfma_f32_16x16x32_bf16 a[220:223], v[4:7], v[140:143], a[220:223]
  s_cbranch_scc0 K2_DL
K2_B:
  s_cmp_lg_u32 s16, 0
  s_cbranch_scc1 K2_F
  buffer_load_dword v31, v27, s[8:11], 0 offen sc1
K2_F:
  v_mfma_f32_16x16x32_bf16 v[224:227], a[64:67], a[0:3], v[112:115]
  s_add_u32 m0, s58, 4096
  v_exp_f32 v144, v144
  v_mfma_f32_16x16x32_bf16 v[224:227], a[68:71], a[4:7], v[224:227]
  s_add_u32 s68, s68, 4096
  buffer_load_dwordx4 v24, s[12:15], s68 offen offset:0 sc1 lds
  v_mfma_f32_16x16x32_bf16 v[224:227], a[72:75], a[8:11], v[224:227]
  s_add_u32 s58, s58, 32768
  v_exp_f32 v145, v145
  v_mfma_f32_16x16x32_bf16 v[224:227], a[76:79], a[12:15], v[224:227]
  s_cmp_ge_u32 s58, 163840
  v_exp_f32 v146, v146
  v_mfma_f32_16x16x32_bf16 v[232:235], a[64:67], a[16:19], v[120:123]
  v_cvt_pk_bf16_f32 v136, v144, v145
  v_mfma_f32_16x16x32_bf16 v[232:235], a[68:71], a[20:23], v[232:235]
  s_cselect_b32 s58, s61, s58
  v_exp_f32 v147, v147
  v_mfma_f32_16x16x32_bf16 v[232:235], a[72:75], a[24:27], v[232:235]
  buffer_load_dwordx4 v24, s[12:15], s68 offen offset:1024 sc1 lds
  v_cvt_pk_bf16_f32 v137, v146, v147
  v_mfma_f32_16x16x32_bf16 v[232:235], a[76:79], a[28:31], v[232:235]
  s_add_u32 s72, s59, 32768
  v_exp_f32 v148, v148
  v_mfma_f32_16x16x32_bf16 v[228:231], a[80:83], a[0:3], v[116:119]
  buffer_load_dwordx4 v24, s[12:15], s68 offen offset:2048 sc1 lds
  v_mfma_f32_16x16x32_bf16 v[228:231], a[84:87], a[4:7], v[228:231]
  s_cmp_ge_u32 s72, 163840
  v_exp_f32 v149, v149
  v_mfma_f32_16x16x32_bf16 v[228:231], a[88:91], a[8:11], v[228:231]
  v_cvt_pk_bf16_f32 v138, v148, v149
  v_mfma_f32_16x16x32_bf16 v[228:231], a[92:95], a[12:15], v[228:231]
  s_cselect_b32 s72, 0, s72
  v_exp_f32 v150, v150
  v_mfma_f32_16x16x32_bf16 v[236:239], a[80:83], a[16:19], v[124:127]
  buffer_load_dwordx4 v24, s[12:15], s68 offen offset:3072 sc1 lds
  v_mfma_f32_16x16x32_bf16 v[236:239], a[84:87], a[20:23], v[236:239]
  s_waitcnt lgkmcnt(0)
  v_exp_f32 v151, v151
  v_mfma_f32_16x16x32_bf16 v[236:239], a[88:91], a[24:27], v[236:239]
  v_cvt_pk_bf16_f32 v139, v150, v151
  v_mfma_f32_16x16x32_bf16 v[236:239], a[92:95], a[28:31], v[236:239]
  v_mfma_f32_16x16x32_bf16 v[32:35], a[96:99], v[128:131], v[32:35]
  s_sub_u32 s57, s57, 2
  v_exp_f32 v152, v152
  v_mfma_f32_16x16x32_bf16 v[36:39], a[96:99], v[132:135], v[36:39]
  v_mfma_f32_16x16x32_bf16 v[40:43], a[100:103], v[128:131], v[40:43]
  s_lshl_b32 s68, s57, 15
  v_exp_f32 v153, v153
  v_mfma_f32_16x16x32_bf16 v[44:47], a[100:103], v[132:135], v[44:47]
  v_cvt_pk_bf16_f32 v140, v152, v153
  v_mfma_f32_16x16x32_bf16 v[48:51], a[104:107], v[128:131], v[48:51]
  s_mov_b32 m0, s58
  v_exp_f32 v154, v154
  v_mfma_f32_16x16x32_bf16 v[52:55], a[104:107], v[132:135], v[52:55]
  buffer_load_dwordx4 v24, s[12:15], s68 offen offset:0 sc1 lds
  v_mfma_f32_16x16x32_bf16 v[56:59], a[108:111], v[128:131], v[56:59]
  s_add_u32 s57, s57, 1
  v_exp_f32 v155, v155
  v_mfma_f32_16x16x32_bf16 v[60:63], a[108:111], v[132:135], v[60:63]
  v_cvt_pk_bf16_f32 v141, v154, v155
  v_mfma_f32_16x16x32_bf16 v[64:67], a[112:115], v[128:131], v[64:67]
  s_sub_u32 s14, s14, 65536
  v_exp_f32 v156, v156
  v_mfma_f32_16x16x32_bf16 v[68:71], a[112:115], v[132:135], v[68:71]
  buffer_load_dwordx4 v24, s[12:15], s68 offen offset:1024 sc1 lds
  v_mfma_f32_16x16x32_bf16 v[72:75], a[116:119], v[128:131], v[72:75]
  s_add_u32 s73, s72, 32768
  v_exp_f32 v157, v157
  v_mfma_f32_16x16x32_bf16 v[76:79], a[116:119], v[132:135], v[76:79]
  v_cvt_pk_bf16_f32 v142, v156, v157
  v_mfma_f32_16x16x32_bf16 v[80:83], a[120:123], v[128:131], v[80:83]
  s_waitcnt lgkmcnt(8)
  v_exp_f32 v158, v158
  v_mfma_f32_16x16x32_bf16 v[84:87], a[120:123], v[132:135], v[84:87]
  buffer_load_dwordx4 v24, s[12:15], s68 offen offset:2048 sc1 lds
  v_mfma_f32_16x16x32_bf16 v[88:91], a[124:127], v[128:131], v[88:91]
  s_cmp_ge_u32 s73, 163840
  v_exp_f32 v159, v159
  v_mfma_f32_16x16x32_bf16 v[92:95], a[124:127], v[132:135], v[92:95]
  v_cvt_pk_bf16_f32 v143, v158, v159
  v_mfma_f32_16x16x32_bf16 a[208:211], v[4:7], v[128:131], a[208:211]
  s_cselect_b32 s73, 0, s73
  v_mfma_f32_16x16x32_bf16 a[212:215], v[4:7], v[132:135], a[212:215]
  buffer_load_dwordx4 v24, s[12:15], s68 offen offset:3072 sc1 lds
  v_mfma_f32_16x16x32_bf16 v[144:147], a[64:67], a[32:35], 0
  s_add_u32 m0, s58, 4096
  v_exp_f32 v224, v224
  v_mfma_f32_16x16x32_bf16 v[144:147], a[68:71], a[36:39], v[144:147]
  s_add_u32 s68, s68, 4096
  buffer_load_dwordx4 v24, s[12:15], s68 offen offset:0 sc1 lds
  v_mfma_f32_16x16x32_bf16 v[144:147], a[72:75], a[40:43], v[144:147]
  s_add_u32 s74, s73, 32768
  v_exp_f32 v225, v225
  v_mfma_f32_16x16x32_bf16 v[144:147], a[76:79], a[44:47], v[144:147]
  s_cmp_ge_u32 s74, 163840
  v_exp_f32 v226, v226
  v_mfma_f32_16x16x32_bf16 v[152:155], a[64:67], a[48:51], 0
  ds_read_b128 a[64:67], v1 offset:16384
  v_cvt_pk_bf16_f32 v128, v224, v225
  v_mfma_f32_16x16x32_bf16 v[152:155], a[68:71], a[52:55], v[152:155]
  s_cselect_b32 s74, 0, s74
  v_exp_f32 v227, v227
  v_mfma_f32_16x16x32_bf16 v[152:155], a[72:75], a[56:59], v[152:155]
  ds_read_b128 a[68:71], v1 offset:17408
  v_cvt_pk_bf16_f32 v129, v226, v227
  v_mfma_f32_16x16x32_bf16 v[152:155], a[76:79], a[60:63], v[152:155]
  s_cmp_eq_u32 s16, 0
  v_exp_f32 v228, v228
  v_mfma_f32_16x16x32_bf16 v[148:151], a[80:83], a[32:35], 0
  ds_read_b128 a[72:75], v1 offset:18432
  v_mfma_f32_16x16x32_bf16 v[148:151], a[84:87], a[36:39], v[148:151]
  s_cselect_b32 s75, s72, s59
  v_exp_f32 v229, v229
  v_mfma_f32_16x16x32_bf16 v[148:151], a[88:91], a[40:43], v[148:151]
  ds_read_b128 a[76:79], v1 offset:19456
  v_cvt_pk_bf16_f32 v130, v228, v229
  v_mfma_f32_16x16x32_bf16 v[148:151], a[92:95], a[44:47], v[148:151]
  s_add_u32 s75, s75, 16384
  v_exp_f32 v230, v230
  v_mfma_f32_16x16x32_bf16 v[156:159], a[80:83], a[48:51], 0
  ds_read_b128 a[80:83], v1 offset:20480
  buffer_load_dwordx4 v24, s[12:15], s68 offen offset:1024 sc1 lds
  v_mfma_f32_16x16x32_bf16 v[156:159], a[84:87], a[52:55], v[156:159]
  s_waitcnt lgkmcnt(5)
  v_exp_f32 v231, v231
  v_mfma_f32_16x16x32_bf16 v[156:159], a[88:91], a[56:59], v[156:159]
  ds_read_b128 a[84:87], v1 offset:21504
  v_cvt_pk_bf16_f32 v131, v230, v231
  v_mfma_f32_16x16x32_bf16 v[156:159], a[92:95], a[60:63], v[156:159]
  ds_read_b128 a[88:91], v1 offset:22528
  v_add_u32 v2, s59, v3
  v_mfma_f32_16x16x32_bf16 v[160:163], a[96:99], v[136:139], v[160:163]
  s_cmp_lt_u32 s16, 2
  v_exp_f32 v232, v232
  v_mfma_f32_16x16x32_bf16 v[164:167], a[96:99], v[140:143], v[164:167]
  ds_read_b128 a[92:95], v1 offset:23552
  v_mfma_f32_16x16x32_bf16 v[168:171], a[100:103], v[136:139], v[168:171]
  s_cselect_b32 s62, s72, s74
  v_exp_f32 v233, v233
  v_mfma_f32_16x16x32_bf16 v[172:175], a[100:103], v[140:143], v[172:175]
  ds_read_b128 a[96:99], v2 offset:8192
  v_cvt_pk_bf16_f32 v132, v232, v233
  v_mfma_f32_16x16x32_bf16 v[176:179], a[104:107], v[136:139], v[176:179]
  v_exp_f32 v234, v234
  v_mfma_f32_16x16x32_bf16 v[180:183], a[104:107], v[140:143], v[180:183]
  ds_read_b128 a[100:103], v2 offset:9216
  v_add_u32 v1, s75, v3
  v_mfma_f32_16x16x32_bf16 v[184:187], a[108:111], v[136:139], v[184:187]
  s_add_u32 s58, s58, 32768
  v_exp_f32 v235, v235
  v_mfma_f32_16x16x32_bf16 v[188:191], a[108:111], v[140:143], v[188:191]
  ds_read_b128 a[104:107], v2 offset:10240
  v_cvt_pk_bf16_f32 v133, v234, v235
  v_mfma_f32_16x16x32_bf16 v[192:195], a[112:115], v[136:139], v[192:195]
  s_cmp_ge_u32 s58, 163840
  v_exp_f32 v236, v236
  v_mfma_f32_16x16x32_bf16 v[196:199], a[112:115], v[140:143], v[196:199]
  ds_read_b128 a[108:111], v2 offset:11264
  buffer_load_dwordx4 v24, s[12:15], s68 offen offset:2048 sc1 lds
  v_mfma_f32_16x16x32_bf16 v[200:203], a[116:119], v[136:139], v[200:203]
  s_cselect_b32 s58, s61, s58
  v_exp_f32 v237, v237
  v_mfma_f32_16x16x32_bf16 v[204:207], a[116:119], v[140:143], v[204:207]
  ds_read_b128 a[112:115], v2 offset:12288
  v_cvt_pk_bf16_f32 v134, v236, v237
  v_mfma_f32_16x16x32_bf16 v[208:211], a[120:123], v[136:139], v[208:211]
  s_waitcnt lgkmcnt(5)
  v_exp_f32 v238, v238
  v_mfma_f32_16x16x32_bf16 v[212:215], a[120:123], v[140:143], v[212:215]
  ds_read_b128 a[116:119], v2 offset:13312
  v_mfma_f32_16x16x32_bf16 v[216:219], a[124:127], v[136:139], v[216:219]
  v_exp_f32 v239, v239
  v_mfma_f32_16x16x32_bf16 v[220:223], a[124:127], v[140:143], v[220:223]
  ds_read_b128 a[120:123], v2 offset:14336
  v_cvt_pk_bf16_f32 v135, v238, v239
  v_mfma_f32_16x16x32_bf16 a[216:219], v[4:7], v[136:139], a[216:219]
  ds_read_b128 a[124:127], v2 offset:15360
  v_mfma_f32_16x16x32_bf16 a[220:223], v[4:7], v[140:143], a[220:223]
  buffer_load_dwordx4 v24, s[12:15], s68 offen offset:3072 sc1 lds
K2_D2:
  v_mfma_f32_16x16x32_bf16 v[224:227], a[64:67], a[32:35], 0
  s_waitcnt vmcnt(16)
  v_exp_f32 v144, v144
  v_mfma_f32_16x16x32_bf16 v[224:227], a[68:71], a[36:39], v[224:227]
  s_cmp_lg_u32 s16, 0
  s_cbranch_scc1 K2_C
  s_mov_b32 s67, 0x100000
  s_waitcnt vmcnt(12)
K2_CL:
  v_cmp_ne_u32 s[70:71], 1, v31
  s_cmp_eq_u64 s[70:71], 0
  s_cbranch_scc1 K2_C
  s_sleep 8
  buffer_load_dword v31, v27, s[8:11], 0 offen sc1
  s_waitcnt vmcnt(0)
  s_sub_u32 s67, s67, 1
  s_cmp_lg_u32 s67, 0
  s_cbranch_scc1 K2_CL
K2_C:
  s_barrier
  v_mfma_f32_16x16x32_bf16 v[224:227], a[72:75], a[40:43], v[224:227]
  s_lshl_b32 s78, s65, 7
  v_exp_f32 v145, v145
  v_mfma_f32_16x16x32_bf16 v[224:227], a[76:79], a[44:47], v[224:227]
  s_add_u32 s78, s78, 56623104
  v_exp_f32 v146, v146
  v_mfma_f32_16x16x32_bf16 v[232:235], a[64:67], a[48:51], 0
  ds_read_b128 a[64:67], v1 offset:0
  v_cvt_pk_bf16_f32 v136, v144, v145
  v_mfma_f32_16x16x32_bf16 v[232:235], a[68:71], a[52:55], v[232:235]
  s_lshl_b32 s79, s66, 7
  v_exp_f32 v147, v147
  v_mfma_f32_16x16x32_bf16 v[232:235], a[72:75], a[56:59], v[232:235]
  ds_read_b128 a[68:71], v1 offset:1024
  v_cvt_pk_bf16_f32 v137, v146, v147
  v_mfma_f32_16x16x32_bf16 v[232:235], a[76:79], a[60:63], v[232:235]
  s_add_u32 s79, s79, 56623104
  v_exp_f32 v148, v148
  v_mfma_f32_16x16x32_bf16 v[228:231], a[80:83], a[32:35], 0
  ds_read_b128 a[72:75], v1 offset:2048
  v_bfe_u32 v255, v250, 2, 2
  v_mfma_f32_16x16x32_bf16 v[228:231], a[84:87], a[36:39], v[228:231]
  s_mov_b32 s30, 0xffff
  v_exp_f32 v149, v149
  v_mfma_f32_16x16x32_bf16 v[228:231], a[88:91], a[40:43], v[228:231]
  ds_read_b128 a[76:79], v1 offset:3072
  v_cvt_pk_bf16_f32 v138, v148, v149
  v_mfma_f32_16x16x32_bf16 v[228:231], a[92:95], a[44:47], v[228:231]
  s_mov_b32 s31, 0xffff
  v_exp_f32 v150, v150
  v_mfma_f32_16x16x32_bf16 v[236:239], a[80:83], a[48:51], 0
  ds_read_b128 a[80:83], v1 offset:4096
  v_lshl_add_u32 v254, v254, 3, v255
  v_mfma_f32_16x16x32_bf16 v[236:239], a[84:87], a[52:55], v[236:239]
  s_waitcnt lgkmcnt(5)
  v_exp_f32 v151, v151
  v_mfma_f32_16x16x32_bf16 v[236:239], a[88:91], a[56:59], v[236:239]
  ds_read_b128 a[84:87], v1 offset:5120
  v_cvt_pk_bf16_f32 v139, v150, v151
  v_mfma_f32_16x16x32_bf16 v[236:239], a[92:95], a[60:63], v[236:239]
  ds_read_b128 a[88:91], v1 offset:6144
  v_lshlrev_b32 v254, 7, v254
  v_mfma_f32_16x16x32_bf16 v[32:35], a[96:99], v[128:131], v[32:35]
  s_lshl_b32 s36, s17, 17
  v_exp_f32 v152, v152
  v_mfma_f32_16x16x32_bf16 v[36:39], a[96:99], v[132:135], v[36:39]
  ds_read_b128 a[92:95], v1 offset:7168
  buffer_load_dword v29, v18, s[8:11], s78 offen offset:0 sc1
  v_mfma_f32_16x16x32_bf16 v[40:43], a[100:103], v[128:131], v[40:43]
  s_lshl_b32 s22, s16, 15
  v_exp_f32 v153, v153
  v_mfma_f32_16x16x32_bf16 v[44:47], a[100:103], v[132:135], v[44:47]
  v_cvt_pk_bf16_f32 v140, v152, v153
  v_bfe_u32 v255, v250, 3, 1
  v_mfma_f32_16x16x32_bf16 v[48:51], a[104:107], v[128:131], v[48:51]
  s_add_u32 s36, s36, s22
  v_exp_f32 v154, v154
  v_mfma_f32_16x16x32_bf16 v[52:55], a[104:107], v[132:135], v[52:55]
  buffer_load_dword v8, v18, s[8:11], s78 offen offset:64 sc1
  v_add_u32 v1, s62, v3
  v_mfma_f32_16x16x32_bf16 v[56:59], a[108:111], v[128:131], v[56:59]
  s_add_u32 s36, s36, 52428800
  v_exp_f32 v155, v155
  v_mfma_f32_16x16x32_bf16 v[60:63], a[108:111], v[132:135], v[60:63]
  v_cvt_pk_bf16_f32 v141, v154, v155
  v_lshl_add_u32 v254, v255, 6, v254
  v_mfma_f32_16x16x32_bf16 v[64:67], a[112:115], v[128:131], v[64:67]
  s_add_u32 s37, s36, 4096
  v_exp_f32 v156, v156
  v_mfma_f32_16x16x32_bf16 v[68:71], a[112:115], v[132:135], v[68:71]
  buffer_load_dword v9, v18, s[8:11], s79 offen offset:0 sc1
  v_bfe_u32 v255, v250, 4, 1
  v_mfma_f32_16x16x32_bf16 v[72:75], a[116:119], v[128:131], v[72:75]
  s_lshl_b32 s22, s18, 10
  v_exp_f32 v157, v157
  v_mfma_f32_16x16x32_bf16 v[76:79], a[116:119], v[132:135], v[76:79]
  v_cvt_pk_bf16_f32 v142, v156, v157
  v_lshl_add_u32 v254, v255, 5, v254
  v_mfma_f32_16x16x32_bf16 v[80:83], a[120:123], v[128:131], v[80:83]
  s_waitcnt lgkmcnt(0)
  v_exp_f32 v158, v158
  v_mfma_f32_16x16x32_bf16 v[84:87], a[120:123], v[132:135], v[84:87]
  buffer_load_dword v10, v18, s[8:11], s79 offen offset:64 sc1
  v_and_b32 v255, 3, v250
  v_mfma_f32_16x16x32_bf16 v[88:91], a[124:127], v[128:131], v[88:91]
  s_lshl_b32 s23, s16, 8
  v_exp_f32 v159, v159
  v_mfma_f32_16x16x32_bf16 v[92:95], a[124:127], v[132:135], v[92:95]
  v_cvt_pk_bf16_f32 v143, v158, v159
  v_lshl_add_u32 v254, v255, 3, v254
  v_mfma_f32_16x16x32_bf16 a[208:211], v[4:7], v[128:131], a[208:211]
  v_lshrrev_b32 v255, 6, v0
  v_lshl_add_u32 v244, v255, 14, v254
  v_mfma_f32_16x16x32_bf16 a[212:215], v[4:7], v[132:135], a[212:215]
  v_xor_b32 v245, 64, v244
  s_cmp_eq_u32 s16, 1
  s_cbranch_scc1 K2_V1
  s_cmp_eq_u32 s16, 2
  s_cbranch_scc1 K2_V2
  s_cmp_eq_u32 s16, 3
  s_cbranch_scc1 K2_V3
  v_mfma_f32_16x16x32_bf16 v[144:147], a[64:67], a[32:35], v[96:99]
  s_waitcnt vmcnt(4)
  v_exp_f32 v224, v224
  v_mfma_f32_16x16x32_bf16 v[144:147], a[68:71], a[36:39], v[144:147]
  s_barrier
  v_mfma_f32_16x16x32_bf16 v[144:147], a[72:75], a[40:43], v[144:147]
  s_lshl_b32 s68, s57, 15
  v_exp_f32 v225, v225
  v_mfma_f32_16x16x32_bf16 v[144:147], a[76:79], a[44:47], v[144:147]
  s_mov_b32 m0, s58
  v_exp_f32 v226, v226
  v_mfma_f32_16x16x32_bf16 v[152:155], a[64:67], a[48:51], v[104:107]
  ds_read_b128 a[64:67], v1 offset:0
  v_cvt_pk_bf16_f32 v128, v224, v225
  v_mfma_f32_16x16x32_bf16 v[152:155], a[68:71], a[52:55], v[152:155]
  s_add_u32 s22, s22, s23
  v_exp_f32 v227, v227
  v_mfma_f32_16x16x32_bf16 v[152:155], a[72:75], a[56:59], v[152:155]
  ds_read_b128 a[68:71], v1 offset:1024
  v_cvt_pk_bf16_f32 v129, v226, v227
  v_mfma_f32_16x16x32_bf16 v[152:155], a[76:79], a[60:63], v[152:155]
  s_add_u32 s19, s22, 56623104
  v_exp_f32 v228, v228
  v_mfma_f32_16x16x32_bf16 v[148:151], a[80:83], a[32:35], v[100:103]
  ds_read_b128 a[72:75], v1 offset:2048
  buffer_load_dwordx4 v24, s[12:15], s68 offen offset:0 sc1 lds
  v_mfma_f32_16x16x32_bf16 v[148:151], a[84:87], a[36:39], v[148:151]
  s_lshl_b32 s22, s17, 16
  v_exp_f32 v229, v229
  v_mfma_f32_16x16x32_bf16 v[148:151], a[88:91], a[40:43], v[148:151]
  ds_read_b128 a[76:79], v1 offset:3072
  v_cvt_pk_bf16_f32 v130, v228, v229
  v_mfma_f32_16x16x32_bf16 v[148:151], a[92:95], a[44:47], v[148:151]
  s_lshl_b32 s23, s18, 13
  v_exp_f32 v230, v230
  v_mfma_f32_16x16x32_bf16 v[156:159], a[80:83], a[48:51], v[108:111]
  ds_read_b128 a[80:83], v1 offset:4096
  buffer_store_dwordx4 a[128:131], v3, s[8:11], s100 offen offset:0 sc1
  v_mfma_f32_16x16x32_bf16 v[156:159], a[84:87], a[52:55], v[156:159]
  s_waitcnt lgkmcnt(13)
  v_exp_f32 v231, v231
  v_mfma_f32_16x16x32_bf16 v[156:159], a[88:91], a[56:59], v[156:159]
  ds_read_b128 a[84:87], v1 offset:5120
  v_cvt_pk_bf16_f32 v131, v230, v231
  v_mfma_f32_16x16x32_bf16 v[156:159], a[92:95], a[60:63], v[156:159]
  ds_read_b128 a[88:91], v1 offset:6144
  v_add_u32 v2, s59, v3
  v_mfma_f32_16x16x32_bf16 v[160:163], a[96:99], v[136:139], v[160:163]
  s_add_u32 s57, s57, 1
  v_exp_f32 v232, v232
  v_mfma_f32_16x16x32_bf16 v[164:167], a[96:99], v[140:143], v[164:167]
  ds_read_b128 a[92:95], v1 offset:7168
  buffer_load_dwordx4 v24, s[12:15], s68 offen offset:1024 sc1 lds
  v_mfma_f32_16x16x32_bf16 v[168:171], a[100:103], v[136:139], v[168:171]
  s_add_u32 s22, s22, s23
  v_exp_f32 v233, v233
  v_mfma_f32_16x16x32_bf16 v[172:175], a[100:103], v[140:143], v[172:175]
  ds_read_b128 a[96:99], v2 offset:24576
  v_cvt_pk_bf16_f32 v132, v232, v233
  v_mfma_f32_16x16x32_bf16 v[176:179], a[104:107], v[136:139], v[176:179]
  s_add_u32 s22, s22, 50331648
  v_exp_f32 v234, v234
  v_mfma_f32_16x16x32_bf16 v[180:183], a[104:107], v[140:143], v[180:183]
  ds_read_b128 a[100:103], v2 offset:25600
  buffer_store_dwordx4 a[132:135], v3, s[8:11], s100 offen offset:1024 sc1
  v_add_u32 v1, s73, v3
  v_mfma_f32_16x16x32_bf16 v[184:187], a[108:111], v[136:139], v[184:187]
  s_add_u32 s23, s22, 4096
  v_exp_f32 v235, v235
  v_mfma_f32_16x16x32_bf16 v[188:191], a[108:111], v[140:143], v[188:191]
  ds_read_b128 a[104:107], v2 offset:26624
  v_cvt_pk_bf16_f32 v133, v234, v235
  v_mfma_f32_16x16x32_bf16 v[192:195], a[112:115], v[136:139], v[192:195]
  v_exp_f32 v236, v236
  v_mfma_f32_16x16x32_bf16 v[196:199], a[112:115], v[140:143], v[196:199]
  ds_read_b128 a[108:111], v2 offset:27648
  buffer_load_dwordx4 v24, s[12:15], s68 offen offset:2048 sc1 lds
  v_mfma_f32_16x16x32_bf16 v[200:203], a[116:119], v[136:139], v[200:203]
  v_exp_f32 v237, v237
  v_mfma_f32_16x16x32_bf16 v[204:207], a[116:119], v[140:143], v[204:207]
  ds_read_b128 a[112:115], v2 offset:28672
  v_cvt_pk_bf16_f32 v134, v236, v237
  v_mfma_f32_16x16x32_bf16 v[208:211], a[120:123], v[136:139], v[208:211]
  s_waitcnt lgkmcnt(5)
  v_exp_f32 v238, v238
  v_mfma_f32_16x16x32_bf16 v[212:215], a[120:123], v[140:143], v[212:215]
  ds_read_b128 a[116:119], v2 offset:29696
  buffer_store_dwordx4 a[136:139], v3, s[8:11], s100 offen offset:2048 sc1
  v_mfma_f32_16x16x32_bf16 v[216:219], a[124:127], v[136:139], v[216:219]
  v_exp_f32 v239, v239
  v_mfma_f32_16x16x32_bf16 v[220:223], a[124:127], v[140:143], v[220:223]
  ds_read_b128 a[120:123], v2 offset:30720
  v_cvt_pk_bf16_f32 v135, v238, v239
  v_mfma_f32_16x16x32_bf16 a[216:219], v[4:7], v[136:139], a[216:219]
  ds_read_b128 a[124:127], v2 offset:31744
  buffer_store_dwordx4 a[140:143], v3, s[8:11], s100 offen offset:3072 sc1
  v_mfma_f32_16x16x32_bf16 a[220:223], v[4:7], v[140:143], a[220:223]
  buffer_load_dwordx4 v24, s[12:15], s68 offen offset:3072 sc1 lds
  v_mfma_f32_16x16x32_bf16 v[224:227], a[64:67], a[32:35], 0
  s_add_u32 m0, s58, 4096
  v_exp_f32 v144, v144
  v_mfma_f32_16x16x32_bf16 v[224:227], a[68:71], a[36:39], v[224:227]
  s_add_u32 s68, s68, 4096
  buffer_load_dwordx4 v24, s[12:15], s68 offen offset:0 sc1 lds
  v_mfma_f32_16x16x32_bf16 v[224:227], a[72:75], a[40:43], v[224:227]
  v_exp_f32 v145, v145
  v_mfma_f32_16x16x32_bf16 v[224:227], a[76:79], a[44:47], v[224:227]
  v_exp_f32 v146, v146
  v_mfma_f32_16x16x32_bf16 v[232:235], a[64:67], a[48:51], 0
  ds_read_b128 a[64:67], v1 offset:16384
  v_cvt_pk_bf16_f32 v136, v144, v145
  v_mfma_f32_16x16x32_bf16 v[232:235], a[68:71], a[52:55], v[232:235]
  v_exp_f32 v147, v147
  v_mfma_f32_16x16x32_bf16 v[232:235], a[72:75], a[56:59], v[232:235]
  ds_read_b128 a[68:71], v1 offset:17408
  v_cvt_pk_bf16_f32 v137, v146, v147
  v_mfma_f32_16x16x32_bf16 v[232:235], a[76:79], a[60:63], v[232:235]
  v_exp_f32 v148, v148
  v_mfma_f32_16x16x32_bf16 v[228:231], a[80:83], a[32:35], 0
  ds_read_b128 a[72:75], v1 offset:18432
  buffer_load_dwordx4 a[128:131], v3, s[8:11], s22 offen offset:0 sc1
  v_mfma_f32_16x16x32_bf16 v[228:231], a[84:87], a[36:39], v[228:231]
  v_exp_f32 v149, v149
  v_mfma_f32_16x16x32_bf16 v[228:231], a[88:91], a[40:43], v[228:231]
  ds_read_b128 a[76:79], v1 offset:19456
  v_cvt_pk_bf16_f32 v138, v148, v149
  v_mfma_f32_16x16x32_bf16 v[228:231], a[92:95], a[44:47], v[228:231]
  v_exp_f32 v150, v150
  v_mfma_f32_16x16x32_bf16 v[236:239], a[80:83], a[48:51], 0
  ds_read_b128 a[80:83], v1 offset:20480
  buffer_load_dwordx4 v24, s[12:15], s68 offen offset:1024 sc1 lds
  v_mfma_f32_16x16x32_bf16 v[236:239], a[84:87], a[52:55], v[236:239]
  s_waitcnt lgkmcnt(5)
  v_exp_f32 v151, v151
  v_mfma_f32_16x16x32_bf16 v[236:239], a[88:91], a[56:59], v[236:239]
  ds_read_b128 a[84:87], v1 offset:21504
  v_cvt_pk_bf16_f32 v139, v150, v151
  v_mfma_f32_16x16x32_bf16 v[236:239], a[92:95], a[60:63], v[236:239]
  ds_read_b128 a[88:91], v1 offset:22528
  v_add_u32 v2, s72, v3
  v_mfma_f32_16x16x32_bf16 v[160:163], a[96:99], v[128:131], v[160:163]
  v_exp_f32 v152, v152
  v_mfma_f32_16x16x32_bf16 v[164:167], a[96:99], v[132:135], v[164:167]
  ds_read_b128 a[92:95], v1 offset:23552
  buffer_load_dwordx4 a[132:135], v3, s[8:11], s22 offen offset:1024 sc1
  v_mfma_f32_16x16x32_bf16 v[168:171], a[100:103], v[128:131], v[168:171]
  v_exp_f32 v153, v153
  v_mfma_f32_16x16x32_bf16 v[172:175], a[100:103], v[132:135], v[172:175]
  ds_read_b128 a[96:99], v2 offset:24576
  v_cvt_pk_bf16_f32 v140, v152, v153
  v_mfma_f32_16x16x32_bf16 v[176:179], a[104:107], v[128:131], v[176:179]
  v_exp_f32 v154, v154
  v_mfma_f32_16x16x32_bf16 v[180:183], a[104:107], v[132:135], v[180:183]
  ds_read_b128 a[100:103], v2 offset:25600
  v_add_u32 v1, s73, v3
  v_mfma_f32_16x16x32_bf16 v[184:187], a[108:111], v[128:131], v[184:187]
  s_add_u32 s58, s58, 32768
  v_exp_f32 v155, v155
  v_mfma_f32_16x16x32_bf16 v[188:191], a[108:111], v[132:135], v[188:191]
  ds_read_b128 a[104:107], v2 offset:26624
  v_cvt_pk_bf16_f32 v141, v154, v155
  v_mfma_f32_16x16x32_bf16 v[192:195], a[112:115], v[128:131], v[192:195]
  s_cmp_ge_u32 s58, 163840
  v_exp_f32 v156, v156
  v_mfma_f32_16x16x32_bf16 v[196:199], a[112:115], v[132:135], v[196:199]
  ds_read_b128 a[108:111], v2 offset:27648
  buffer_load_dwordx4 v24, s[12:15], s68 offen offset:2048 sc1 lds
  buffer_load_dwordx4 a[136:139], v3, s[8:11], s22 offen offset:2048 sc1
  v_mfma_f32_16x16x32_bf16 v[200:203], a[116:119], v[128:131], v[200:203]
  s_cselect_b32 s58, s61, s58
  v_exp_f32 v157, v157
  v_mfma_f32_16x16x32_bf16 v[204:207], a[116:119], v[132:135], v[204:207]
  ds_read_b128 a[112:115], v2 offset:28672
  v_cvt_pk_bf16_f32 v142, v156, v157
  v_mfma_f32_16x16x32_bf16 v[208:211], a[120:123], v[128:131], v[208:211]
  s_waitcnt lgkmcnt(5)
  v_exp_f32 v158, v158
  v_mfma_f32_16x16x32_bf16 v[212:215], a[120:123], v[132:135], v[212:215]
  ds_read_b128 a[116:119], v2 offset:29696
  v_mfma_f32_16x16x32_bf16 v[216:219], a[124:127], v[128:131], v[216:219]
  v_exp_f32 v159, v159
  v_mfma_f32_16x16x32_bf16 v[220:223], a[124:127], v[132:135], v[220:223]
  ds_read_b128 a[120:123], v2 offset:30720
  v_cvt_pk_bf16_f32 v143, v158, v159
  v_mfma_f32_16x16x32_bf16 a[216:219], v[4:7], v[128:131], a[216:219]
  ds_read_b128 a[124:127], v2 offset:31744
  buffer_load_dwordx4 a[140:143], v3, s[8:11], s22 offen offset:3072 sc1
  v_mfma_f32_16x16x32_bf16 a[220:223], v[4:7], v[132:135], a[220:223]
  buffer_load_dwordx4 v24, s[12:15], s68 offen offset:3072 sc1 lds
  v_mfma_f32_16x16x32_bf16 v[144:147], a[64:67], a[32:35], 0
  s_mov_b64 s[32:33], s[48:49]
  v_exp_f32 v224, v224
  v_mfma_f32_16x16x32_bf16 v[144:147], a[68:71], a[36:39], v[144:147]
  s_lshl_b32 s26, s16, 14
  s_mul_i32 s27, s17, 589824
  s_add_u32 s27, s27, 57671680
  v_mfma_f32_16x16x32_bf16 v[144:147], a[72:75], a[40:43], v[144:147]
  s_lshl_b32 s24, s16, 16
  v_exp_f32 v225, v225
  v_mfma_f32_16x16x32_bf16 v[144:147], a[76:79], a[44:47], v[144:147]
  s_add_u32 s24, s24, s27
  v_exp_f32 v226, v226
  v_mfma_f32_16x16x32_bf16 v[152:155], a[64:67], a[48:51], 0
  ds_read_b128 a[64:67], v1 offset:0
  v_cvt_pk_bf16_f32 v128, v224, v225
  v_mfma_f32_16x16x32_bf16 v[152:155], a[68:71], a[52:55], v[152:155]
  s_lshl_b32 s39, s18, 19
  v_exp_f32 v227, v227
  v_mfma_f32_16x16x32_bf16 v[152:155], a[72:75], a[56:59], v[152:155]
  ds_read_b128 a[68:71], v1 offset:1024
  v_cvt_pk_bf16_f32 v129, v226, v227
  v_mfma_f32_16x16x32_bf16 v[152:155], a[76:79], a[60:63], v[152:155]
  s_lshl_b32 s25, s16, 17
  v_exp_f32 v228, v228
  v_mfma_f32_16x16x32_bf16 v[148:151], a[80:83], a[32:35], 0
  ds_read_b128 a[72:75], v1 offset:2048
  buffer_load_dwordx4 a[144:147], v3, s[8:11], s23 offen offset:0 sc1
  v_mfma_f32_16x16x32_bf16 v[148:151], a[84:87], a[36:39], v[148:151]
  s_add_u32 s39, s39, s25
  v_exp_f32 v229, v229
  v_mfma_f32_16x16x32_bf16 v[148:151], a[88:91], a[40:43], v[148:151]
  ds_read_b128 a[76:79], v1 offset:3072
  v_cvt_pk_bf16_f32 v130, v228, v229
  v_mfma_f32_16x16x32_bf16 v[148:151], a[92:95], a[44:47], v[148:151]
  s_lshl_b32 s28, s18, 7
  v_exp_f32 v230, v230
  v_mfma_f32_16x16x32_bf16 v[156:159], a[80:83], a[48:51], 0
  ds_read_b128 a[80:83], v1 offset:4096
  buffer_load_dwordx4 a[148:151], v3, s[8:11], s23 offen offset:1024 sc1
  v_mfma_f32_16x16x32_bf16 v[156:159], a[84:87], a[52:55], v[156:159]
  s_waitcnt lgkmcnt(5)
  v_exp_f32 v231, v231
  v_mfma_f32_16x16x32_bf16 v[156:159], a[88:91], a[56:59], v[156:159]
  ds_read_b128 a[84:87], v1 offset:5120
  v_cvt_pk_bf16_f32 v131, v230, v231
  v_mfma_f32_16x16x32_bf16 v[156:159], a[92:95], a[60:63], v[156:159]
  ds_read_b128 a[88:91], v1 offset:6144
  v_add_u32 v2, s72, v3
  v_mfma_f32_16x16x32_bf16 v[160:163], a[96:99], v[136:139], v[160:163]
  s_sub_u32 s28, s28, 32768
  v_exp_f32 v232, v232
  v_mfma_f32_16x16x32_bf16 v[164:167], a[96:99], v[140:143], v[164:167]
  ds_read_b128 a[92:95], v1 offset:7168
  buffer_load_dwordx4 a[152:155], v3, s[8:11], s23 offen offset:2048 sc1
  v_mfma_f32_16x16x32_bf16 v[168:171], a[100:103], v[136:139], v[168:171]
  s_add_u32 s25, s25, s28
  v_exp_f32 v233, v233
  v_mfma_f32_16x16x32_bf16 v[172:175], a[100:103], v[140:143], v[172:175]
  ds_read_b128 a[96:99], v2 offset:8192
  v_cvt_pk_bf16_f32 v132, v232, v233
  v_mfma_f32_16x16x32_bf16 v[176:179], a[104:107], v[136:139], v[176:179]
  s_add_u32 s20, s36, 8192
  v_exp_f32 v234, v234
  v_mfma_f32_16x16x32_bf16 v[180:183], a[104:107], v[140:143], v[180:183]
  ds_read_b128 a[100:103], v2 offset:9216
  buffer_load_dwordx4 a[156:159], v3, s[8:11], s23 offen offset:3072 sc1
  v_add_u32 v1, s74, v3
  v_mfma_f32_16x16x32_bf16 v[184:187], a[108:111], v[136:139], v[184:187]
  s_mov_b32 s21, s20
  v_exp_f32 v235, v235
  v_mfma_f32_16x16x32_bf16 v[188:191], a[108:111], v[140:143], v[188:191]
  ds_read_b128 a[104:107], v2 offset:10240
  v_cvt_pk_bf16_f32 v133, v234, v235
  v_mfma_f32_16x16x32_bf16 v[192:195], a[112:115], v[136:139], v[192:195]
  v_exp_f32 v236, v236
  v_mfma_f32_16x16x32_bf16 v[196:199], a[112:115], v[140:143], v[196:199]
  ds_read_b128 a[108:111], v2 offset:11264
  buffer_load_dwordx4 a[160:163], v3, s[8:11], s36 offen offset:0 sc1
  v_mfma_f32_16x16x32_bf16 v[200:203], a[116:119], v[136:139], v[200:203]
  v_exp_f32 v237, v237
  v_mfma_f32_16x16x32_bf16 v[204:207], a[116:119], v[140:143], v[204:207]
  ds_read_b128 a[112:115], v2 offset:12288
  v_cvt_pk_bf16_f32 v134, v236, v237
  v_mfma_f32_16x16x32_bf16 v[208:211], a[120:123], v[136:139], v[208:211]
  s_waitcnt lgkmcnt(5)
  v_exp_f32 v238, v238
  v_mfma_f32_16x16x32_bf16 v[212:215], a[120:123], v[140:143], v[212:215]
  ds_read_b128 a[116:119], v2 offset:13312
  s_mov_b64 exec, s[30:31]
  buffer_load_dwordx4 a[176:179], v240, s[8:11], s36 offen offset:1024 sc1
  buffer_load_dwordx4 a[180:183], v240, s[8:11], s36 offen offset:1536 sc1
  s_mov_b64 exec, -1
  v_mfma_f32_16x16x32_bf16 v[216:219], a[124:127], v[136:139], v[216:219]
  v_exp_f32 v239, v239
  v_mfma_f32_16x16x32_bf16 v[220:223], a[124:127], v[140:143], v[220:223]
  ds_read_b128 a[120:123], v2 offset:14336
  v_cvt_pk_bf16_f32 v135, v238, v239
  v_mfma_f32_16x16x32_bf16 a[216:219], v[4:7], v[136:139], a[216:219]
  ds_read_b128 a[124:127], v2 offset:15360
  buffer_load_dwordx4 a[164:167], v3, s[8:11], s36 offen offset:2048 sc1
  v_mfma_f32_16x16x32_bf16 a[220:223], v[4:7], v[140:143], a[220:223]
  s_mov_b64 exec, s[30:31]
  buffer_load_dwordx4 a[184:187], v240, s[8:11], s36 offen offset:3072 sc1
  buffer_load_dwordx4 a[188:191], v240, s[8:11], s36 offen offset:3584 sc1
  s_mov_b64 exec, -1
  v_mfma_f32_16x16x32_bf16 v[224:227], a[64:67], a[32:35], 0
  v_exp_f32 v144, v144
  v_mfma_f32_16x16x32_bf16 v[224:227], a[68:71], a[36:39], v[224:227]
  s_barrier
  v_mfma_f32_16x16x32_bf16 v[224:227], a[72:75], a[40:43], v[224:227]
  s_lshl_b32 s68, s57, 15
  v_exp_f32 v145, v145
  v_mfma_f32_16x16x32_bf16 v[224:227], a[76:79], a[44:47], v[224:227]
  s_mov_b32 m0, s58
  v_exp_f32 v146, v146
  v_mfma_f32_16x16x32_bf16 v[232:235], a[64:67], a[48:51], 0
  ds_read_b128 a[64:67], v1 offset:0
  v_cvt_pk_bf16_f32 v136, v144, v145
  v_mfma_f32_16x16x32_bf16 v[232:235], a[68:71], a[52:55], v[232:235]
  v_exp_f32 v147, v147
  v_mfma_f32_16x16x32_bf16 v[232:235], a[72:75], a[56:59], v[232:235]
  ds_read_b128 a[68:71], v1 offset:1024
  v_cvt_pk_bf16_f32 v137, v146, v147
  v_mfma_f32_16x16x32_bf16 v[232:235], a[76:79], a[60:63], v[232:235]
  v_exp_f32 v148, v148
  v_mfma_f32_16x16x32_bf16 v[228:231], a[80:83], a[32:35], 0
  ds_read_b128 a[72:75], v1 offset:2048
  buffer_load_dwordx4 v24, s[12:15], s68 offen offset:0 sc1 lds
  buffer_load_dwordx4 a[168:171], v3, s[8:11], s37 offen offset:0 sc1
  v_mfma_f32_16x16x32_bf16 v[228:231], a[84:87], a[36:39], v[228:231]
  v_exp_f32 v149, v149
  v_mfma_f32_16x16x32_bf16 v[228:231], a[88:91], a[40:43], v[228:231]
  ds_read_b128 a[76:79], v1 offset:3072
  v_cvt_pk_bf16_f32 v138, v148, v149
  v_mfma_f32_16x16x32_bf16 v[228:231], a[92:95], a[44:47], v[228:231]
  v_exp_f32 v150, v150
  v_mfma_f32_16x16x32_bf16 v[236:239], a[80:83], a[48:51], 0
  ds_read_b128 a[80:83], v1 offset:4096
  v_mfma_f32_16x16x32_bf16 v[236:239], a[84:87], a[52:55], v[236:239]
  s_waitcnt lgkmcnt(5)
  v_exp_f32 v151, v151
  v_mfma_f32_16x16x32_bf16 v[236:239], a[88:91], a[56:59], v[236:239]
  ds_read_b128 a[84:87], v1 offset:5120
  v_cvt_pk_bf16_f32 v139, v150, v151
  v_mfma_f32_16x16x32_bf16 v[236:239], a[92:95], a[60:63], v[236:239]
  ds_read_b128 a[88:91], v1 offset:6144
  v_add_u32 v2, s73, v3
  v_mfma_f32_16x16x32_bf16 v[160:163], a[96:99], v[128:131], v[160:163]
  s_add_u32 s57, s57, 1
  v_exp_f32 v152, v152
  v_mfma_f32_16x16x32_bf16 v[164:167], a[96:99], v[132:135], v[164:167]
  ds_read_b128 a[92:95], v1 offset:7168
  buffer_load_dwordx4 v24, s[12:15], s68 offen offset:1024 sc1 lds
  s_mov_b64 exec, s[30:31]
  buffer_load_dwordx4 a[192:195], v240, s[8:11], s37 offen offset:1024 sc1
  buffer_load_dwordx4 a[196:199], v240, s[8:11], s37 offen offset:1536 sc1
  s_mov_b64 exec, -1
  v_mfma_f32_16x16x32_bf16 v[168:171], a[100:103], v[128:131], v[168:171]
  v_exp_f32 v153, v153
  v_mfma_f32_16x16x32_bf16 v[172:175], a[100:103], v[132:135], v[172:175]
  ds_read_b128 a[96:99], v2 offset:24576
  v_cvt_pk_bf16_f32 v140, v152, v153
  v_mfma_f32_16x16x32_bf16 v[176:179], a[104:107], v[128:131], v[176:179]
  v_exp_f32 v154, v154
  v_mfma_f32_16x16x32_bf16 v[180:183], a[104:107], v[132:135], v[180:183]
  ds_read_b128 a[100:103], v2 offset:25600
  v_add_u32 v1, s74, v3
  v_mfma_f32_16x16x32_bf16 v[184:187], a[108:111], v[128:131], v[184:187]
  v_exp_f32 v155, v155
  v_mfma_f32_16x16x32_bf16 v[188:191], a[108:111], v[132:135], v[188:191]
  ds_read_b128 a[104:107], v2 offset:26624
  v_cvt_pk_bf16_f32 v141, v154, v155
  v_mfma_f32_16x16x32_bf16 v[192:195], a[112:115], v[128:131], v[192:195]
  v_exp_f32 v156, v156
  v_mfma_f32_16x16x32_bf16 v[196:199], a[112:115], v[132:135], v[196:199]
  ds_read_b128 a[108:111], v2 offset:27648
  buffer_load_dwordx4 v24, s[12:15], s68 offen offset:2048 sc1 lds
  v_mfma_f32_16x16x32_bf16 v[200:203], a[116:119], v[128:131], v[200:203]
  v_exp_f32 v157, v157
  v_mfma_f32_16x16x32_bf16 v[204:207], a[116:119], v[132:135], v[204:207]
  ds_read_b128 a[112:115], v2 offset:28672
  v_cvt_pk_bf16_f32 v142, v156, v157
  v_mfma_f32_16x16x32_bf16 v[208:211], a[120:123], v[128:131], v[208:211]
  s_waitcnt lgkmcnt(5)
  v_exp_f32 v158, v158
  v_mfma_f32_16x16x32_bf16 v[212:215], a[120:123], v[132:135], v[212:215]
  ds_read_b128 a[116:119], v2 offset:29696
  buffer_load_dwordx4 a[172:175], v3, s[8:11], s37 offen offset:2048 sc1
  v_mfma_f32_16x16x32_bf16 v[216:219], a[124:127], v[128:131], v[216:219]
  v_exp_f32 v159, v159
  v_mfma_f32_16x16x32_bf16 v[220:223], a[124:127], v[132:135], v[220:223]
  ds_read_b128 a[120:123], v2 offset:30720
  v_cvt_pk_bf16_f32 v143, v158, v159
  v_mfma_f32_16x16x32_bf16 a[216:219], v[4:7], v[128:131], a[216:219]
  ds_read_b128 a[124:127], v2 offset:31744
  v_mfma_f32_16x16x32_bf16 a[220:223], v[4:7], v[132:135], a[220:223]
  buffer_load_dwordx4 v24, s[12:15], s68 offen offset:3072 sc1 lds
  v_mfma_f32_16x16x32_bf16 v[144:147], a[64:67], a[32:35], 0
  s_add_u32 m0, s58, 4096
  v_exp_f32 v224, v224
  v_mfma_f32_16x16x32_bf16 v[144:147], a[68:71], a[36:39], v[144:147]
  s_add_u32 s68, s68, 4096
  buffer_load_dwordx4 v24, s[12:15], s68 offen offset:0 sc1 lds
  v_mfma_f32_16x16x32_bf16 v[144:147], a[72:75], a[40:43], v[144:147]
  s_mov_b32 s60, s74
  v_exp_f32 v225, v225
  v_mfma_f32_16x16x32_bf16 v[144:147], a[76:79], a[44:47], v[144:147]
  v_exp_f32 v226, v226
  v_mfma_f32_16x16x32_bf16 v[152:155], a[64:67], a[48:51], 0
  ds_read_b128 a[64:67], v1 offset:16384
  v_cvt_pk_bf16_f32 v128, v224, v225
  v_mfma_f32_16x16x32_bf16 v[152:155], a[68:71], a[52:55], v[152:155]
  v_exp_f32 v227, v227
  v_mfma_f32_16x16x32_bf16 v[152:155], a[72:75], a[56:59], v[152:155]
  ds_read_b128 a[68:71], v1 offset:17408
  v_cvt_pk_bf16_f32 v129, v226, v227
  v_mfma_f32_16x16x32_bf16 v[152:155], a[76:79], a[60:63], v[152:155]
  v_exp_f32 v228, v228
  v_mfma_f32_16x16x32_bf16 v[148:151], a[80:83], a[32:35], 0
  ds_read_b128 a[72:75], v1 offset:18432
  s_mov_b64 exec, s[30:31]
  buffer_load_dwordx4 a[200:203], v240, s[8:11], s37 offen offset:3072 sc1
  buffer_load_dwordx4 a[204:207], v240, s[8:11], s37 offen offset:3584 sc1
  s_mov_b64 exec, -1
  v_mfma_f32_16x16x32_bf16 v[148:151], a[84:87], a[36:39], v[148:151]
  v_exp_f32 v229, v229
  v_mfma_f32_16x16x32_bf16 v[148:151], a[88:91], a[40:43], v[148:151]
  ds_read_b128 a[76:79], v1 offset:19456
  v_cvt_pk_bf16_f32 v130, v228, v229
  v_mfma_f32_16x16x32_bf16 v[148:151], a[92:95], a[44:47], v[148:151]
  v_exp_f32 v230, v230
  v_mfma_f32_16x16x32_bf16 v[156:159], a[80:83], a[48:51], 0
  ds_read_b128 a[80:83], v1 offset:20480
  buffer_load_dwordx4 v24, s[12:15], s68 offen offset:1024 sc1 lds
  v_mfma_f32_16x16x32_bf16 v[156:159], a[84:87], a[52:55], v[156:159]
  s_waitcnt lgkmcnt(5)
  v_exp_f32 v231, v231
  v_mfma_f32_16x16x32_bf16 v[156:159], a[88:91], a[56:59], v[156:159]
  ds_read_b128 a[84:87], v1 offset:21504
  v_cvt_pk_bf16_f32 v131, v230, v231
  v_mfma_f32_16x16x32_bf16 v[156:159], a[92:95], a[60:63], v[156:159]
  ds_read_b128 a[88:91], v1 offset:22528
  s_mov_b32 s59, s74
  v_add_u32 v2, s73, v3
  v_mfma_f32_16x16x32_bf16 v[160:163], a[96:99], v[136:139], v[160:163]
  s_add_u32 s59, s59, 32768
  v_exp_f32 v232, v232
  v_mfma_f32_16x16x32_bf16 v[164:167], a[96:99], v[140:143], v[164:167]
  ds_read_b128 a[92:95], v1 offset:23552
  buffer_load_dword v241, v253, s[8:11], s19 offen offset:0 sc1
  v_mfma_f32_16x16x32_bf16 v[168:171], a[100:103], v[136:139], v[168:171]
  s_cmp_ge_u32 s59, 163840
  v_exp_f32 v233, v233
  v_mfma_f32_16x16x32_bf16 v[172:175], a[100:103], v[140:143], v[172:175]
  ds_read_b128 a[96:99], v2 offset:8192
  v_cvt_pk_bf16_f32 v132, v232, v233
  v_mfma_f32_16x16x32_bf16 v[176:179], a[104:107], v[136:139], v[176:179]
  s_cselect_b32 s59, 0, s59
  v_exp_f32 v234, v234
  v_mfma_f32_16x16x32_bf16 v[180:183], a[104:107], v[140:143], v[180:183]
  ds_read_b128 a[100:103], v2 offset:9216
  v_add_u32 v1, s59, v3
  v_mfma_f32_16x16x32_bf16 v[184:187], a[108:111], v[136:139], v[184:187]
  s_add_u32 s58, s58, 32768
  v_exp_f32 v235, v235
  v_mfma_f32_16x16x32_bf16 v[188:191], a[108:111], v[140:143], v[188:191]
  ds_read_b128 a[104:107], v2 offset:10240
  v_cvt_pk_bf16_f32 v133, v234, v235
  v_mfma_f32_16x16x32_bf16 v[192:195], a[112:115], v[136:139], v[192:195]
  s_cmp_ge_u32 s58, 163840
  v_exp_f32 v236, v236
  v_mfma_f32_16x16x32_bf16 v[196:199], a[112:115], v[140:143], v[196:199]
  ds_read_b128 a[108:111], v2 offset:11264
  buffer_load_dwordx4 v24, s[12:15], s68 offen offset:2048 sc1 lds
  v_mfma_f32_16x16x32_bf16 v[200:203], a[116:119], v[136:139], v[200:203]
  s_cselect_b32 s58, s61, s58
  v_exp_f32 v237, v237
  v_mfma_f32_16x16x32_bf16 v[204:207], a[116:119], v[140:143], v[204:207]
  ds_read_b128 a[112:115], v2 offset:12288
  v_cvt_pk_bf16_f32 v134, v236, v237
  v_mfma_f32_16x16x32_bf16 v[208:211], a[120:123], v[136:139], v[208:211]
  s_waitcnt lgkmcnt(5)
  v_exp_f32 v238, v238
  v_mfma_f32_16x16x32_bf16 v[212:215], a[120:123], v[140:143], v[212:215]
  ds_read_b128 a[116:119], v2 offset:13312
  buffer_load_dword v242, v253, s[8:11], s19 offen offset:128 sc1
  v_mfma_f32_16x16x32_bf16 v[216:219], a[124:127], v[136:139], v[216:219]
  v_exp_f32 v239, v239
  v_mfma_f32_16x16x32_bf16 v[220:223], a[124:127], v[140:143], v[220:223]
  ds_read_b128 a[120:123], v2 offset:14336
  v_cvt_pk_bf16_f32 v135, v238, v239
  v_mfma_f32_16x16x32_bf16 a[216:219], v[4:7], v[136:139], a[216:219]
  ds_read_b128 a[124:127], v2 offset:15360
  v_mfma_f32_16x16x32_bf16 a[220:223], v[4:7], v[140:143], a[220:223]
  buffer_load_dwordx4 v24, s[12:15], s68 offen offset:3072 sc1 lds
K2_J:
  s_waitcnt vmcnt(42)
  s_nop 4
  v_accvgpr_read_b32 v11, a208
  v_accvgpr_read_b32 v12, a212
  v_cmp_nle_f32 vcc, 0x2b800000, v11
  s_mov_b64 s[70:71], vcc
  v_cmp_nge_f32 vcc, 0x5f800000, v11
  s_or_b64 s[70:71], s[70:71], vcc
  v_cmp_nle_f32 vcc, 0x2b800000, v12
  s_or_b64 s[70:71], s[70:71], vcc
  v_cmp_nge_f32 vcc, 0x5f800000, v12
  s_or_b64 s[70:71], s[70:71], vcc
  v_rcp_f32 v14, v11
  v_rcp_f32 v15, v12
  s_mul_i32 s76, s65, 294912
  s_lshl_b32 s77, s17, 13
  s_add_u32 s76, s76, s77
  s_add_u32 s76, s76, 57671680
  s_add_u32 s77, s76, 4096
  v_mul_f32 v14, v14, v29
  v_mul_f32 v15, v15, v8
  v_pk_mul_f32 v[32:33], v[32:33], v[14:15] op_sel:[0,0] op_sel_hi:[1,0]
  v_pk_mul_f32 v[34:35], v[34:35], v[14:15] op_sel:[0,0] op_sel_hi:[1,0]
  v_pk_mul_f32 v[40:41], v[40:41], v[14:15] op_sel:[0,0] op_sel_hi:[1,0]
  v_pk_mul_f32 v[42:43], v[42:43], v[14:15] op_sel:[0,0] op_sel_hi:[1,0]
  v_cvt_pk_bf16_f32 v32, v32, v33
  v_cvt_pk_bf16_f32 v33, v34, v35
  v_cvt_pk_bf16_f32 v34, v40, v41
  v_cvt_pk_bf16_f32 v35, v42, v43
  buffer_store_dwordx4 v[32:35], v30, s[8:11], s76 offen offset:0 sc1
  v_pk_mul_f32 v[36:37], v[36:37], v[14:15] op_sel:[0,1] op_sel_hi:[1,1]
  v_pk_mul_f32 v[38:39], v[38:39], v[14:15] op_sel:[0,1] op_sel_hi:[1,1]
  v_pk_mul_f32 v[44:45], v[44:45], v[14:15] op_sel:[0,1] op_sel_hi:[1,1]
  v_pk_mul_f32 v[46:47], v[46:47], v[14:15] op_sel:[0,1] op_sel_hi:[1,1]
  v_cvt_pk_bf16_f32 v36, v36, v37
  v_cvt_pk_bf16_f32 v37, v38, v39
  v_cvt_pk_bf16_f32 v38, v44, v45
  v_cvt_pk_bf16_f32 v39, v46, v47
  buffer_store_dwordx4 v[36:39], v30, s[8:11], s76 offen offset:256 sc1
  v_pk_mul_f32 v[48:49], v[48:49], v[14:15] op_sel:[0,0] op_sel_hi:[1,0]
  v_pk_mul_f32 v[50:51], v[50:51], v[14:15] op_sel:[0,0] op_sel_hi:[1,0]
  v_pk_mul_f32 v[56:57], v[56:57], v[14:15] op_sel:[0,0] op_sel_hi:[1,0]
  v_pk_mul_f32 v[58:59], v[58:59], v[14:15] op_sel:[0,0] op_sel_hi:[1,0]
  v_cvt_pk_bf16_f32 v48, v48, v49
  v_cvt_pk_bf16_f32 v49, v50, v51
  v_cvt_pk_bf16_f32 v50, v56, v57
  v_cvt_pk_bf16_f32 v51, v58, v59
  buffer_store_dwordx4 v[48:51], v30, s[8:11], s76 offen offset:2048 sc1
  v_pk_mul_f32 v[52:53], v[52:53], v[14:15] op_sel:[0,1] op_sel_hi:[1,1]
  v_pk_mul_f32 v[54:55], v[54:55], v[14:15] op_sel:[0,1] op_sel_hi:[1,1]
  v_pk_mul_f32 v[60:61], v[60:61], v[14:15] op_sel:[0,1] op_sel_hi:[1,1]
  v_pk_mul_f32 v[62:63], v[62:63], v[14:15] op_sel:[0,1] op_sel_hi:[1,1]
  v_cvt_pk_bf16_f32 v52, v52, v53
  v_cvt_pk_bf16_f32 v53, v54, v55
  v_cvt_pk_bf16_f32 v54, v60, v61
  v_cvt_pk_bf16_f32 v55, v62, v63
  buffer_store_dwordx4 v[52:55], v30, s[8:11], s76 offen offset:2304 sc1
  v_pk_mul_f32 v[64:65], v[64:65], v[14:15] op_sel:[0,0] op_sel_hi:[1,0]
  v_pk_mul_f32 v[66:67], v[66:67], v[14:15] op_sel:[0,0] op_sel_hi:[1,0]
  v_pk_mul_f32 v[72:73], v[72:73], v[14:15] op_sel:[0,0] op_sel_hi:[1,0]
  v_pk_mul_f32 v[74:75], v[74:75], v[14:15] op_sel:[0,0] op_sel_hi:[1,0]
  v_cvt_pk_bf16_f32 v64, v64, v65
  v_cvt_pk_bf16_f32 v65, v66, v67
  v_cvt_pk_bf16_f32 v66, v72, v73
  v_cvt_pk_bf16_f32 v67, v74, v75
  buffer_store_dwordx4 v[64:67], v30, s[8:11], s77 offen offset:0 sc1
  v_pk_mul_f32 v[68:69], v[68:69], v[14:15] op_sel:[0,1] op_sel_hi:[1,1]
  v_pk_mul_f32 v[70:71], v[70:71], v[14:15] op_sel:[0,1] op_sel_hi:[1,1]
  v_pk_mul_f32 v[76:77], v[76:77], v[14:15] op_sel:[0,1] op_sel_hi:[1,1]
  v_pk_mul_f32 v[78:79], v[78:79], v[14:15] op_sel:[0,1] op_sel_hi:[1,1]
  v_cvt_pk_bf16_f32 v68, v68, v69
  v_cvt_pk_bf16_f32 v69, v70, v71
  v_cvt_pk_bf16_f32 v70, v76, v77
  v_cvt_pk_bf16_f32 v71, v78, v79
  buffer_store_dwordx4 v[68:71], v30, s[8:11], s77 offen offset:256 sc1
  v_pk_mul_f32 v[80:81], v[80:81], v[14:15] op_sel:[0,0] op_sel_hi:[1,0]
  v_pk_mul_f32 v[82:83], v[82:83], v[14:15] op_sel:[0,0] op_sel_hi:[1,0]
  v_pk_mul_f32 v[88:89], v[88:89], v[14:15] op_sel:[0,0] op_sel_hi:[1,0]
  v_pk_mul_f32 v[90:91], v[90:91], v[14:15] op_sel:[0,0] op_sel_hi:[1,0]
  v_cvt_pk_bf16_f32 v80, v80, v81
  v_cvt_pk_bf16_f32 v81, v82, v83
  v_cvt_pk_bf16_f32 v82, v88, v89
  v_cvt_pk_bf16_f32 v83, v90, v91
  buffer_store_dwordx4 v[80:83], v30, s[8:11], s77 offen offset:2048 sc1
  v_pk_mul_f32 v[84:85], v[84:85], v[14:15] op_sel:[0,1] op_sel_hi:[1,1]
  v_pk_mul_f32 v[86:87], v[86:87], v[14:15] op_sel:[0,1] op_sel_hi:[1,1]
  v_pk_mul_f32 v[92:93], v[92:93], v[14:15] op_sel:[0,1] op_sel_hi:[1,1]
  v_pk_mul_f32 v[94:95], v[94:95], v[14:15] op_sel:[0,1] op_sel_hi:[1,1]
  v_cvt_pk_bf16_f32 v84, v84, v85
  v_cvt_pk_bf16_f32 v85, v86, v87
  v_cvt_pk_bf16_f32 v86, v92, v93
  v_cvt_pk_bf16_f32 v87, v94, v95
  buffer_store_dwordx4 v[84:87], v30, s[8:11], s77 offen offset:2304 sc1
  v_mfma_f32_16x16x32_bf16 v[224:227], a[64:67], a[32:35], 0
  s_waitcnt vmcnt(34)
  v_exp_f32 v144, v144
  v_mfma_f32_16x16x32_bf16 v[224:227], a[68:71], a[36:39], v[224:227]
  s_barrier
  v_mfma_f32_16x16x32_bf16 v[224:227], a[72:75], a[40:43], v[224:227]
  s_lshl_b32 s68, s57, 15
  v_exp_f32 v145, v145
  v_mfma_f32_16x16x32_bf16 v[224:227], a[76:79], a[44:47], v[224:227]
  s_mov_b32 m0, s58
  v_exp_f32 v146, v146
  v_mfma_f32_16x16x32_bf16 v[232:235], a[64:67], a[48:51], 0
  ds_read_b128 a[64:67], v1 offset:0
  v_cvt_pk_bf16_f32 v136, v144, v145
  v_mfma_f32_16x16x32_bf16 v[232:235], a[68:71], a[52:55], v[232:235]
  v_exp_f32 v147, v147
  v_mfma_f32_16x16x32_bf16 v[232:235], a[72:75], a[56:59], v[232:235]
  ds_read_b128 a[68:71], v1 offset:1024
  v_cvt_pk_bf16_f32 v137, v146, v147
  v_mfma_f32_16x16x32_bf16 v[232:235], a[76:79], a[60:63], v[232:235]
  v_exp_f32 v148, v148
  v_mfma_f32_16x16x32_bf16 v[228:231], a[80:83], a[32:35], 0
  ds_read_b128 a[72:75], v1 offset:2048
  buffer_load_dwordx4 v24, s[12:15], s68 offen offset:0 sc1 lds
  v_mfma_f32_16x16x32_bf16 v[228:231], a[84:87], a[36:39], v[228:231]
  v_exp_f32 v149, v149
  v_mfma_f32_16x16x32_bf16 v[228:231], a[88:91], a[40:43], v[228:231]
  ds_read_b128 a[76:79], v1 offset:3072
  v_cvt_pk_bf16_f32 v138, v148, v149
  v_mfma_f32_16x16x32_bf16 v[228:231], a[92:95], a[44:47], v[228:231]
  v_exp_f32 v150, v150
  v_mfma_f32_16x16x32_bf16 v[236:239], a[80:83], a[48:51], 0
  ds_read_b128 a[80:83], v1 offset:4096
  v_mfma_f32_16x16x32_bf16 v[236:239], a[84:87], a[52:55], v[236:239]
  s_waitcnt lgkmcnt(5)
  v_exp_f32 v151, v151
  v_mfma_f32_16x16x32_bf16 v[236:239], a[88:91], a[56:59], v[236:239]
  ds_read_b128 a[84:87], v1 offset:5120
  v_cvt_pk_bf16_f32 v139, v150, v151
  v_mfma_f32_16x16x32_bf16 v[236:239], a[92:95], a[60:63], v[236:239]
  ds_read_b128 a[88:91], v1 offset:6144
  v_add_u32 v2, s74, v3
  v_mfma_f32_16x16x32_bf16 v[160:163], a[96:99], v[128:131], v[160:163]
  s_add_u32 s57, s57, 1
  v_exp_f32 v152, v152
  v_mfma_f32_16x16x32_bf16 v[164:167], a[96:99], v[132:135], v[164:167]
  ds_read_b128 a[92:95], v1 offset:7168
  buffer_load_dwordx4 v24, s[12:15], s68 offen offset:1024 sc1 lds
  v_mfma_f32_16x16x32_bf16 v[168:171], a[100:103], v[128:131], v[168:171]
  v_exp_f32 v153, v153
  v_mfma_f32_16x16x32_bf16 v[172:175], a[100:103], v[132:135], v[172:175]
  ds_read_b128 a[96:99], v2 offset:8192
  v_cvt_pk_bf16_f32 v140, v152, v153
  v_mfma_f32_16x16x32_bf16 v[176:179], a[104:107], v[128:131], v[176:179]
  v_exp_f32 v154, v154
  v_mfma_f32_16x16x32_bf16 v[180:183], a[104:107], v[132:135], v[180:183]
  ds_read_b128 a[100:103], v2 offset:9216
  v_mfma_f32_16x16x32_bf16 v[184:187], a[108:111], v[128:131], v[184:187]
  v_exp_f32 v155, v155
  v_mfma_f32_16x16x32_bf16 v[188:191], a[108:111], v[132:135], v[188:191]
  ds_read_b128 a[104:107], v2 offset:10240
  v_cvt_pk_bf16_f32 v141, v154, v155
  v_mfma_f32_16x16x32_bf16 v[192:195], a[112:115], v[128:131], v[192:195]
  v_exp_f32 v156, v156
  v_mfma_f32_16x16x32_bf16 v[196:199], a[112:115], v[132:135], v[196:199]
  ds_read_b128 a[108:111], v2 offset:11264
  buffer_load_dwordx4 v24, s[12:15], s68 offen offset:2048 sc1 lds
  v_mfma_f32_16x16x32_bf16 v[200:203], a[116:119], v[128:131], v[200:203]
  v_exp_f32 v157, v157
  v_mfma_f32_16x16x32_bf16 v[204:207], a[116:119], v[132:135], v[204:207]
  ds_read_b128 a[112:115], v2 offset:12288
  v_cvt_pk_bf16_f32 v142, v156, v157
  v_mfma_f32_16x16x32_bf16 v[208:211], a[120:123], v[128:131], v[208:211]
  s_waitcnt lgkmcnt(5)
  v_exp_f32 v158, v158
  v_mfma_f32_16x16x32_bf16 v[212:215], a[120:123], v[132:135], v[212:215]
  ds_read_b128 a[116:119], v2 offset:13312
  v_mfma_f32_16x16x32_bf16 v[216:219], a[124:127], v[128:131], v[216:219]
  v_exp_f32 v159, v159
  v_mfma_f32_16x16x32_bf16 v[220:223], a[124:127], v[132:135], v[220:223]
  ds_read_b128 a[120:123], v2 offset:14336
  v_cvt_pk_bf16_f32 v143, v158, v159
  v_mfma_f32_16x16x32_bf16 a[216:219], v[4:7], v[128:131], a[216:219]
  ds_read_b128 a[124:127], v2 offset:15360
  v_mfma_f32_16x16x32_bf16 a[220:223], v[4:7], v[132:135], a[220:223]
  buffer_load_dwordx4 v24, s[12:15], s68 offen offset:3072 sc1 lds
  s_sub_u32 s56, 6, s18
  s_cbranch_scc1 K2_E
.p2align 4
K2_SL:
  v_mfma_f32_16x16x32_bf16 v[144:147], a[64:67], a[32:35], 0
  s_add_u32 m0, s58, 4096
  v_exp_f32 v224, v224
  v_mfma_f32_16x16x32_bf16 v[144:147], a[68:71], a[36:39], v[144:147]
  s_add_u32 s68, s68, 4096
  buffer_load_dwordx4 v24, s[12:15], s68 offen offset:0 sc1 lds
  v_mfma_f32_16x16x32_bf16 v[144:147], a[72:75], a[40:43], v[144:147]
  v_exp_f32 v225, v225
  v_mfma_f32_16x16x32_bf16 v[144:147], a[76:79], a[44:47], v[144:147]
  v_exp_f32 v226, v226
  v_mfma_f32_16x16x32_bf16 v[152:155], a[64:67], a[48:51], 0
  ds_read_b128 a[64:67], v1 offset:16384
  v_cvt_pk_bf16_f32 v128, v224, v225
  v_mfma_f32_16x16x32_bf16 v[152:155], a[68:71], a[52:55], v[152:155]
  v_exp_f32 v227, v227
  v_mfma_f32_16x16x32_bf16 v[152:155], a[72:75], a[56:59], v[152:155]
  ds_read_b128 a[68:71], v1 offset:17408
  v_cvt_pk_bf16_f32 v129, v226, v227
  v_mfma_f32_16x16x32_bf16 v[152:155], a[76:79], a[60:63], v[152:155]
  v_exp_f32 v228, v228
  v_mfma_f32_16x16x32_bf16 v[148:151], a[80:83], a[32:35], 0
  ds_read_b128 a[72:75], v1 offset:18432
  v_mfma_f32_16x16x32_bf16 v[148:151], a[84:87], a[36:39], v[148:151]
  v_exp_f32 v229, v229
  v_mfma_f32_16x16x32_bf16 v[148:151], a[88:91], a[40:43], v[148:151]
  ds_read_b128 a[76:79], v1 offset:19456
  v_cvt_pk_bf16_f32 v130, v228, v229
  v_mfma_f32_16x16x32_bf16 v[148:151], a[92:95], a[44:47], v[148:151]
  v_exp_f32 v230, v230
  v_mfma_f32_16x16x32_bf16 v[156:159], a[80:83], a[48:51], 0
  ds_read_b128 a[80:83], v1 offset:20480
  buffer_load_dwordx4 v24, s[12:15], s68 offen offset:1024 sc1 lds
  v_mfma_f32_16x16x32_bf16 v[156:159], a[84:87], a[52:55], v[156:159]
  s_waitcnt lgkmcnt(5)
  v_exp_f32 v231, v231
  v_mfma_f32_16x16x32_bf16 v[156:159], a[88:91], a[56:59], v[156:159]
  ds_read_b128 a[84:87], v1 offset:21504
  v_cvt_pk_bf16_f32 v131, v230, v231
  v_mfma_f32_16x16x32_bf16 v[156:159], a[92:95], a[60:63], v[156:159]
  ds_read_b128 a[88:91], v1 offset:22528
  v_mfma_f32_16x16x32_bf16 v[160:163], a[96:99], v[136:139], v[160:163]
  s_add_u32 s59, s59, 32768
  v_exp_f32 v232, v232
  v_mfma_f32_16x16x32_bf16 v[164:167], a[96:99], v[140:143], v[164:167]
  ds_read_b128 a[92:95], v1 offset:23552
  v_mfma_f32_16x16x32_bf16 v[168:171], a[100:103], v[136:139], v[168:171]
  s_cmp_ge_u32 s59, 163840
  v_exp_f32 v233, v233
  v_mfma_f32_16x16x32_bf16 v[172:175], a[100:103], v[140:143], v[172:175]
  ds_read_b128 a[96:99], v2 offset:24576
  v_cvt_pk_bf16_f32 v132, v232, v233
  v_mfma_f32_16x16x32_bf16 v[176:179], a[104:107], v[136:139], v[176:179]
  s_cselect_b32 s59, 0, s59
  v_exp_f32 v234, v234
  v_mfma_f32_16x16x32_bf16 v[180:183], a[104:107], v[140:143], v[180:183]
  ds_read_b128 a[100:103], v2 offset:25600
  v_add_u32 v1, s59, v3
  v_mfma_f32_16x16x32_bf16 v[184:187], a[108:111], v[136:139], v[184:187]
  s_add_u32 s58, s58, 32768
  v_exp_f32 v235, v235
  v_mfma_f32_16x16x32_bf16 v[188:191], a[108:111], v[140:143], v[188:191]
  ds_read_b128 a[104:107], v2 offset:26624
  v_cvt_pk_bf16_f32 v133, v234, v235
  v_mfma_f32_16x16x32_bf16 v[192:195], a[112:115], v[136:139], v[192:195]
  s_cmp_ge_u32 s58, 163840
  v_exp_f32 v236, v236
  v_mfma_f32_16x16x32_bf16 v[196:199], a[112:115], v[140:143], v[196:199]
  ds_read_b128 a[108:111], v2 offset:27648
  buffer_load_dwordx4 v24, s[12:15], s68 offen offset:2048 sc1 lds
  v_mfma_f32_16x16x32_bf16 v[200:203], a[116:119], v[136:139], v[200:203]
  s_cselect_b32 s58, s61, s58
  v_exp_f32 v237, v237
  v_mfma_f32_16x16x32_bf16 v[204:207], a[116:119], v[140:143], v[204:207]
  ds_read_b128 a[112:115], v2 offset:28672
  v_cvt_pk_bf16_f32 v134, v236, v237
  v_mfma_f32_16x16x32_bf16 v[208:211], a[120:123], v[136:139], v[208:211]
  s_waitcnt lgkmcnt(5)
  v_exp_f32 v238, v238
  v_mfma_f32_16x16x32_bf16 v[212:215], a[120:123], v[140:143], v[212:215]
  ds_read_b128 a[116:119], v2 offset:29696
  v_mfma_f32_16x16x32_bf16 v[216:219], a[124:127], v[136:139], v[216:219]
  v_exp_f32 v239, v239
  v_mfma_f32_16x16x32_bf16 v[220:223], a[124:127], v[140:143], v[220:223]
  ds_read_b128 a[120:123], v2 offset:30720
  v_cvt_pk_bf16_f32 v135, v238, v239
  v_mfma_f32_16x16x32_bf16 a[216:219], v[4:7], v[136:139], a[216:219]
  ds_read_b128 a[124:127], v2 offset:31744
  v_mfma_f32_16x16x32_bf16 a[220:223], v[4:7], v[140:143], a[220:223]
  buffer_load_dwordx4 v24, s[12:15], s68 offen offset:3072 sc1 lds
  v_mfma_f32_16x16x32_bf16 v[224:227], a[64:67], a[32:35], 0
  s_waitcnt vmcnt(8)
  v_exp_f32 v144, v144
  v_mfma_f32_16x16x32_bf16 v[224:227], a[68:71], a[36:39], v[224:227]
  s_barrier
  v_mfma_f32_16x16x32_bf16 v[224:227], a[72:75], a[40:43], v[224:227]
  s_lshl_b32 s68, s57, 15
  v_exp_f32 v145, v145
  v_mfma_f32_16x16x32_bf16 v[224:227], a[76:79], a[44:47], v[224:227]
  s_mov_b32 m0, s58
  v_exp_f32 v146, v146
  v_mfma_f32_16x16x32_bf16 v[232:235], a[64:67], a[48:51], 0
  ds_read_b128 a[64:67], v1 offset:0
  v_cvt_pk_bf16_f32 v136, v144, v145
  v_mfma_f32_16x16x32_bf16 v[232:235], a[68:71], a[52:55], v[232:235]
  v_exp_f32 v147, v147
  v_mfma_f32_16x16x32_bf16 v[232:235], a[72:75], a[56:59], v[232:235]
  ds_read_b128 a[68:71], v1 offset:1024
  v_cvt_pk_bf16_f32 v137, v146, v147
  v_mfma_f32_16x16x32_bf16 v[232:235], a[76:79], a[60:63], v[232:235]
  v_exp_f32 v148, v148
  v_mfma_f32_16x16x32_bf16 v[228:231], a[80:83], a[32:35], 0
  ds_read_b128 a[72:75], v1 offset:2048
  buffer_load_dwordx4 v24, s[12:15], s68 offen offset:0 sc1 lds
  v_mfma_f32_16x16x32_bf16 v[228:231], a[84:87], a[36:39], v[228:231]
  s_add_u32 s60, s60, 32768
  v_exp_f32 v149, v149
  v_mfma_f32_16x16x32_bf16 v[228:231], a[88:91], a[40:43], v[228:231]
  ds_read_b128 a[76:79], v1 offset:3072
  v_cvt_pk_bf16_f32 v138, v148, v149
  v_mfma_f32_16x16x32_bf16 v[228:231], a[92:95], a[44:47], v[228:231]
  s_cmp_ge_u32 s60, 163840
  v_exp_f32 v150, v150
  v_mfma_f32_16x16x32_bf16 v[236:239], a[80:83], a[48:51], 0
  ds_read_b128 a[80:83], v1 offset:4096
  s_cselect_b32 s60, 0, s60
  v_mfma_f32_16x16x32_bf16 v[236:239], a[84:87], a[52:55], v[236:239]
  s_waitcnt lgkmcnt(5)
  v_exp_f32 v151, v151
  v_mfma_f32_16x16x32_bf16 v[236:239], a[88:91], a[56:59], v[236:239]
  ds_read_b128 a[84:87], v1 offset:5120
  v_cvt_pk_bf16_f32 v139, v150, v151
  v_mfma_f32_16x16x32_bf16 v[236:239], a[92:95], a[60:63], v[236:239]
  ds_read_b128 a[88:91], v1 offset:6144
  v_add_u32 v2, s60, v3
  v_mfma_f32_16x16x32_bf16 v[160:163], a[96:99], v[128:131], v[160:163]
  s_add_u32 s57, s57, 1
  v_exp_f32 v152, v152
  v_mfma_f32_16x16x32_bf16 v[164:167], a[96:99], v[132:135], v[164:167]
  ds_read_b128 a[92:95], v1 offset:7168
  buffer_load_dwordx4 v24, s[12:15], s68 offen offset:1024 sc1 lds
  v_mfma_f32_16x16x32_bf16 v[168:171], a[100:103], v[128:131], v[168:171]
  v_exp_f32 v153, v153
  v_mfma_f32_16x16x32_bf16 v[172:175], a[100:103], v[132:135], v[172:175]
  ds_read_b128 a[96:99], v2 offset:8192
  v_cvt_pk_bf16_f32 v140, v152, v153
  v_mfma_f32_16x16x32_bf16 v[176:179], a[104:107], v[128:131], v[176:179]
  v_exp_f32 v154, v154
  v_mfma_f32_16x16x32_bf16 v[180:183], a[104:107], v[132:135], v[180:183]
  ds_read_b128 a[100:103], v2 offset:9216
  v_mfma_f32_16x16x32_bf16 v[184:187], a[108:111], v[128:131], v[184:187]
  v_exp_f32 v155, v155
  v_mfma_f32_16x16x32_bf16 v[188:191], a[108:111], v[132:135], v[188:191]
  ds_read_b128 a[104:107], v2 offset:10240
  v_cvt_pk_bf16_f32 v141, v154, v155
  v_mfma_f32_16x16x32_bf16 v[192:195], a[112:115], v[128:131], v[192:195]
  v_exp_f32 v156, v156
  v_mfma_f32_16x16x32_bf16 v[196:199], a[112:115], v[132:135], v[196:199]
  ds_read_b128 a[108:111], v2 offset:11264
  buffer_load_dwordx4 v24, s[12:15], s68 offen offset:2048 sc1 lds
  v_mfma_f32_16x16x32_bf16 v[200:203], a[116:119], v[128:131], v[200:203]
  v_exp_f32 v157, v157
  v_mfma_f32_16x16x32_bf16 v[204:207], a[116:119], v[132:135], v[204:207]
  ds_read_b128 a[112:115], v2 offset:12288
  v_cvt_pk_bf16_f32 v142, v156, v157
  v_mfma_f32_16x16x32_bf16 v[208:211], a[120:123], v[128:131], v[208:211]
  s_waitcnt lgkmcnt(5)
  v_exp_f32 v158, v158
  v_mfma_f32_16x16x32_bf16 v[212:215], a[120:123], v[132:135], v[212:215]
  ds_read_b128 a[116:119], v2 offset:13312
  v_mfma_f32_16x16x32_bf16 v[216:219], a[124:127], v[128:131], v[216:219]
  v_exp_f32 v159, v159
  v_mfma_f32_16x16x32_bf16 v[220:223], a[124:127], v[132:135], v[220:223]
  ds_read_b128 a[120:123], v2 offset:14336
  v_cvt_pk_bf16_f32 v143, v158, v159
  v_mfma_f32_16x16x32_bf16 a[216:219], v[4:7], v[128:131], a[216:219]
  ds_read_b128 a[124:127], v2 offset:15360
  v_mfma_f32_16x16x32_bf16 a[220:223], v[4:7], v[132:135], a[220:223]
  buffer_load_dwordx4 v24, s[12:15], s68 offen offset:3072 sc1 lds
  v_mfma_f32_16x16x32_bf16 v[144:147], a[64:67], a[32:35], 0
  s_add_u32 m0, s58, 4096
  v_exp_f32 v224, v224
  v_mfma_f32_16x16x32_bf16 v[144:147], a[68:71], a[36:39], v[144:147]
  s_add_u32 s68, s68, 4096
  buffer_load_dwordx4 v24, s[12:15], s68 offen offset:0 sc1 lds
  v_mfma_f32_16x16x32_bf16 v[144:147], a[72:75], a[40:43], v[144:147]
  v_exp_f32 v225, v225
  v_mfma_f32_16x16x32_bf16 v[144:147], a[76:79], a[44:47], v[144:147]
  v_exp_f32 v226, v226
  v_mfma_f32_16x16x32_bf16 v[152:155], a[64:67], a[48:51], 0
  ds_read_b128 a[64:67], v1 offset:16384
  v_cvt_pk_bf16_f32 v128, v224, v225
  v_mfma_f32_16x16x32_bf16 v[152:155], a[68:71], a[52:55], v[152:155]
  v_exp_f32 v227, v227
  v_mfma_f32_16x16x32_bf16 v[152:155], a[72:75], a[56:59], v[152:155]
  ds_read_b128 a[68:71], v1 offset:17408
  v_cvt_pk_bf16_f32 v129, v226, v227
  v_mfma_f32_16x16x32_bf16 v[152:155], a[76:79], a[60:63], v[152:155]
  v_exp_f32 v228, v228
  v_mfma_f32_16x16x32_bf16 v[148:151], a[80:83], a[32:35], 0
  ds_read_b128 a[72:75], v1 offset:18432
  v_mfma_f32_16x16x32_bf16 v[148:151], a[84:87], a[36:39], v[148:151]
  v_exp_f32 v229, v229
  v_mfma_f32_16x16x32_bf16 v[148:151], a[88:91], a[40:43], v[148:151]
  ds_read_b128 a[76:79], v1 offset:19456
  v_cvt_pk_bf16_f32 v130, v228, v229
  v_mfma_f32_16x16x32_bf16 v[148:151], a[92:95], a[44:47], v[148:151]
  v_exp_f32 v230, v230
  v_mfma_f32_16x16x32_bf16 v[156:159], a[80:83], a[48:51], 0
  ds_read_b128 a[80:83], v1 offset:20480
  buffer_load_dwordx4 v24, s[12:15], s68 offen offset:1024 sc1 lds
  v_mfma_f32_16x16x32_bf16 v[156:159], a[84:87], a[52:55], v[156:159]
  s_waitcnt lgkmcnt(5)
  v_exp_f32 v231, v231
  v_mfma_f32_16x16x32_bf16 v[156:159], a[88:91], a[56:59], v[156:159]
  ds_read_b128 a[84:87], v1 offset:21504
  v_cvt_pk_bf16_f32 v131, v230, v231
  v_mfma_f32_16x16x32_bf16 v[156:159], a[92:95], a[60:63], v[156:159]
  ds_read_b128 a[88:91], v1 offset:22528
  v_mfma_f32_16x16x32_bf16 v[160:163], a[96:99], v[136:139], v[160:163]
  s_add_u32 s59, s59, 32768
  v_exp_f32 v232, v232
  v_mfma_f32_16x16x32_bf16 v[164:167], a[96:99], v[140:143], v[164:167]
  ds_read_b128 a[92:95], v1 offset:23552
  v_mfma_f32_16x16x32_bf16 v[168:171], a[100:103], v[136:139], v[168:171]
  s_cmp_ge_u32 s59, 163840
  v_exp_f32 v233, v233
  v_mfma_f32_16x16x32_bf16 v[172:175], a[100:103], v[140:143], v[172:175]
  ds_read_b128 a[96:99], v2 offset:24576
  v_cvt_pk_bf16_f32 v132, v232, v233
  v_mfma_f32_16x16x32_bf16 v[176:179], a[104:107], v[136:139], v[176:179]
  s_cselect_b32 s59, 0, s59
  v_exp_f32 v234, v234
  v_mfma_f32_16x16x32_bf16 v[180:183], a[104:107], v[140:143], v[180:183]
  ds_read_b128 a[100:103], v2 offset:25600
  v_add_u32 v1, s59, v3
  v_mfma_f32_16x16x32_bf16 v[184:187], a[108:111], v[136:139], v[184:187]
  s_add_u32 s58, s58, 32768
  v_exp_f32 v235, v235
  v_mfma_f32_16x16x32_bf16 v[188:191], a[108:111], v[140:143], v[188:191]
  ds_read_b128 a[104:107], v2 offset:26624
  v_cvt_pk_bf16_f32 v133, v234, v235
  v_mfma_f32_16x16x32_bf16 v[192:195], a[112:115], v[136:139], v[192:195]
  s_cmp_ge_u32 s58, 163840
  v_exp_f32 v236, v236
  v_mfma_f32_16x16x32_bf16 v[196:199], a[112:115], v[140:143], v[196:199]
  ds_read_b128 a[108:111], v2 offset:27648
  buffer_load_dwordx4 v24, s[12:15], s68 offen offset:2048 sc1 lds
  v_mfma_f32_16x16x32_bf16 v[200:203], a[116:119], v[136:139], v[200:203]
  s_cselect_b32 s58, s61, s58
  v_exp_f32 v237, v237
  v_mfma_f32_16x16x32_bf16 v[204:207], a[116:119], v[140:143], v[204:207]
  ds_read_b128 a[112:115], v2 offset:28672
  v_cvt_pk_bf16_f32 v134, v236, v237
  v_mfma_f32_16x16x32_bf16 v[208:211], a[120:123], v[136:139], v[208:211]
  s_waitcnt lgkmcnt(5)
  v_exp_f32 v238, v238
  v_mfma_f32_16x16x32_bf16 v[212:215], a[120:123], v[140:143], v[212:215]
  ds_read_b128 a[116:119], v2 offset:29696
  v_mfma_f32_16x16x32_bf16 v[216:219], a[124:127], v[136:139], v[216:219]
  v_exp_f32 v239, v239
  v_mfma_f32_16x16x32_bf16 v[220:223], a[124:127], v[140:143], v[220:223]
  ds_read_b128 a[120:123], v2 offset:30720
  v_cvt_pk_bf16_f32 v135, v238, v239
  v_mfma_f32_16x16x32_bf16 a[216:219], v[4:7], v[136:139], a[216:219]
  ds_read_b128 a[124:127], v2 offset:31744
  v_mfma_f32_16x16x32_bf16 a[220:223], v[4:7], v[140:143], a[220:223]
  buffer_load_dwordx4 v24, s[12:15], s68 offen offset:3072 sc1 lds
  v_mfma_f32_16x16x32_bf16 v[224:227], a[64:67], a[32:35], 0
  s_waitcnt vmcnt(8)
  v_exp_f32 v144, v144
  v_mfma_f32_16x16x32_bf16 v[224:227], a[68:71], a[36:39], v[224:227]
  s_barrier
  v_mfma_f32_16x16x32_bf16 v[224:227], a[72:75], a[40:43], v[224:227]
  s_lshl_b32 s68, s57, 15
  v_exp_f32 v145, v145
  v_mfma_f32_16x16x32_bf16 v[224:227], a[76:79], a[44:47], v[224:227]
  s_mov_b32 m0, s58
  v_exp_f32 v146, v146
  v_mfma_f32_16x16x32_bf16 v[232:235], a[64:67], a[48:51], 0
  ds_read_b128 a[64:67], v1 offset:0
  v_cvt_pk_bf16_f32 v136, v144, v145
  v_mfma_f32_16x16x32_bf16 v[232:235], a[68:71], a[52:55], v[232:235]
  v_exp_f32 v147, v147
  v_mfma_f32_16x16x32_bf16 v[232:235], a[72:75], a[56:59], v[232:235]
  ds_read_b128 a[68:71], v1 offset:1024
  v_cvt_pk_bf16_f32 v137, v146, v147
  v_mfma_f32_16x16x32_bf16 v[232:235], a[76:79], a[60:63], v[232:235]
  v_exp_f32 v148, v148
  v_mfma_f32_16x16x32_bf16 v[228:231], a[80:83], a[32:35], 0
  ds_read_b128 a[72:75], v1 offset:2048
  buffer_load_dwordx4 v24, s[12:15], s68 offen offset:0 sc1 lds
  v_mfma_f32_16x16x32_bf16 v[228:231], a[84:87], a[36:39], v[228:231]
  s_add_u32 s60, s60, 32768
  v_exp_f32 v149, v149
  v_mfma_f32_16x16x32_bf16 v[228:231], a[88:91], a[40:43], v[228:231]
  ds_read_b128 a[76:79], v1 offset:3072
  v_cvt_pk_bf16_f32 v138, v148, v149
  v_mfma_f32_16x16x32_bf16 v[228:231], a[92:95], a[44:47], v[228:231]
  s_cmp_ge_u32 s60, 163840
  v_exp_f32 v150, v150
  v_mfma_f32_16x16x32_bf16 v[236:239], a[80:83], a[48:51], 0
  ds_read_b128 a[80:83], v1 offset:4096
  s_cselect_b32 s60, 0, s60
  v_mfma_f32_16x16x32_bf16 v[236:239], a[84:87], a[52:55], v[236:239]
  s_waitcnt lgkmcnt(5)
  v_exp_f32 v151, v151
  v_mfma_f32_16x16x32_bf16 v[236:239], a[88:91], a[56:59], v[236:239]
  ds_read_b128 a[84:87], v1 offset:5120
  v_cvt_pk_bf16_f32 v139, v150, v151
  v_mfma_f32_16x16x32_bf16 v[236:239], a[92:95], a[60:63], v[236:239]
  ds_read_b128 a[88:91], v1 offset:6144
  v_add_u32 v2, s60, v3
  v_mfma_f32_16x16x32_bf16 v[160:163], a[96:99], v[128:131], v[160:163]
  s_add_u32 s57, s57, 1
  v_exp_f32 v152, v152
  v_mfma_f32_16x16x32_bf16 v[164:167], a[96:99], v[132:135], v[164:167]
  ds_read_b128 a[92:95], v1 offset:7168
  buffer_load_dwordx4 v24, s[12:15], s68 offen offset:1024 sc1 lds
  v_mfma_f32_16x16x32_bf16 v[168:171], a[100:103], v[128:131], v[168:171]
  v_exp_f32 v153, v153
  v_mfma_f32_16x16x32_bf16 v[172:175], a[100:103], v[132:135], v[172:175]
  ds_read_b128 a[96:99], v2 offset:8192
  v_cvt_pk_bf16_f32 v140, v152, v153
  v_mfma_f32_16x16x32_bf16 v[176:179], a[104:107], v[128:131], v[176:179]
  v_exp_f32 v154, v154
  v_mfma_f32_16x16x32_bf16 v[180:183], a[104:107], v[132:135], v[180:183]
  ds_read_b128 a[100:103], v2 offset:9216
  v_mfma_f32_16x16x32_bf16 v[184:187], a[108:111], v[128:131], v[184:187]
  v_exp_f32 v155, v155
  v_mfma_f32_16x16x32_bf16 v[188:191], a[108:111], v[132:135], v[188:191]
  ds_read_b128 a[104:107], v2 offset:10240
  v_cvt_pk_bf16_f32 v141, v154, v155
  v_mfma_f32_16x16x32_bf16 v[192:195], a[112:115], v[128:131], v[192:195]
  v_exp_f32 v156, v156
  v_mfma_f32_16x16x32_bf16 v[196:199], a[112:115], v[132:135], v[196:199]
  ds_read_b128 a[108:111], v2 offset:11264
  buffer_load_dwordx4 v24, s[12:15], s68 offen offset:2048 sc1 lds
  v_mfma_f32_16x16x32_bf16 v[200:203], a[116:119], v[128:131], v[200:203]
  v_exp_f32 v157, v157
  v_mfma_f32_16x16x32_bf16 v[204:207], a[116:119], v[132:135], v[204:207]
  ds_read_b128 a[112:115], v2 offset:12288
  v_cvt_pk_bf16_f32 v142, v156, v157
  v_mfma_f32_16x16x32_bf16 v[208:211], a[120:123], v[128:131], v[208:211]
  s_waitcnt lgkmcnt(5)
  v_exp_f32 v158, v158
  v_mfma_f32_16x16x32_bf16 v[212:215], a[120:123], v[132:135], v[212:215]
  ds_read_b128 a[116:119], v2 offset:13312
  v_mfma_f32_16x16x32_bf16 v[216:219], a[124:127], v[128:131], v[216:219]
  v_exp_f32 v159, v159
  v_mfma_f32_16x16x32_bf16 v[220:223], a[124:127], v[132:135], v[220:223]
  ds_read_b128 a[120:123], v2 offset:14336
  v_cvt_pk_bf16_f32 v143, v158, v159
  v_mfma_f32_16x16x32_bf16 a[216:219], v[4:7], v[128:131], a[216:219]
  ds_read_b128 a[124:127], v2 offset:15360
  v_mfma_f32_16x16x32_bf16 a[220:223], v[4:7], v[132:135], a[220:223]
  buffer_load_dwordx4 v24, s[12:15], s68 offen offset:3072 sc1 lds
  v_mfma_f32_16x16x32_bf16 v[144:147], a[64:67], a[32:35], 0
  s_add_u32 m0, s58, 4096
  v_exp_f32 v224, v224
  v_mfma_f32_16x16x32_bf16 v[144:147], a[68:71], a[36:39], v[144:147]
  s_add_u32 s68, s68, 4096
  buffer_load_dwordx4 v24, s[12:15], s68 offen offset:0 sc1 lds
  v_mfma_f32_16x16x32_bf16 v[144:147], a[72:75], a[40:43], v[144:147]
  v_exp_f32 v225, v225
  v_mfma_f32_16x16x32_bf16 v[144:147], a[76:79], a[44:47], v[144:147]
  v_exp_f32 v226, v226
  v_mfma_f32_16x16x32_bf16 v[152:155], a[64:67], a[48:51], 0
  ds_read_b128 a[64:67], v1 offset:16384
  v_cvt_pk_bf16_f32 v128, v224, v225
  v_mfma_f32_16x16x32_bf16 v[152:155], a[68:71], a[52:55], v[152:155]
  v_exp_f32 v227, v227
  v_mfma_f32_16x16x32_bf16 v[152:155], a[72:75], a[56:59], v[152:155]
  ds_read_b128 a[68:71], v1 offset:17408
  v_cvt_pk_bf16_f32 v129, v226, v227
  v_mfma_f32_16x16x32_bf16 v[152:155], a[76:79], a[60:63], v[152:155]
  v_exp_f32 v228, v228
  v_mfma_f32_16x16x32_bf16 v[148:151], a[80:83], a[32:35], 0
  ds_read_b128 a[72:75], v1 offset:18432
  v_mfma_f32_16x16x32_bf16 v[148:151], a[84:87], a[36:39], v[148:151]
  v_exp_f32 v229, v229
  v_mfma_f32_16x16x32_bf16 v[148:151], a[88:91], a[40:43], v[148:151]
  ds_read_b128 a[76:79], v1 offset:19456
  v_cvt_pk_bf16_f32 v130, v228, v229
  v_mfma_f32_16x16x32_bf16 v[148:151], a[92:95], a[44:47], v[148:151]
  v_exp_f32 v230, v230
  v_mfma_f32_16x16x32_bf16 v[156:159], a[80:83], a[48:51], 0
  ds_read_b128 a[80:83], v1 offset:20480
  buffer_load_dwordx4 v24, s[12:15], s68 offen offset:1024 sc1 lds
  v_mfma_f32_16x16x32_bf16 v[156:159], a[84:87], a[52:55], v[156:159]
  s_waitcnt lgkmcnt(5)
  v_exp_f32 v231, v231
  v_mfma_f32_16x16x32_bf16 v[156:159], a[88:91], a[56:59], v[156:159]
  ds_read_b128 a[84:87], v1 offset:21504
  v_cvt_pk_bf16_f32 v131, v230, v231
  v_mfma_f32_16x16x32_bf16 v[156:159], a[92:95], a[60:63], v[156:159]
  ds_read_b128 a[88:91], v1 offset:22528
  v_mfma_f32_16x16x32_bf16 v[160:163], a[96:99], v[136:139], v[160:163]
  s_add_u32 s59, s59, 32768
  v_exp_f32 v232, v232
  v_mfma_f32_16x16x32_bf16 v[164:167], a[96:99], v[140:143], v[164:167]
  ds_read_b128 a[92:95], v1 offset:23552
  v_mfma_f32_16x16x32_bf16 v[168:171], a[100:103], v[136:139], v[168:171]
  s_cmp_ge_u32 s59, 163840
  v_exp_f32 v233, v233
  v_mfma_f32_16x16x32_bf16 v[172:175], a[100:103], v[140:143], v[172:175]
  ds_read_b128 a[96:99], v2 offset:24576
  v_cvt_pk_bf16_f32 v132, v232, v233
  v_mfma_f32_16x16x32_bf16 v[176:179], a[104:107], v[136:139], v[176:179]
  s_cselect_b32 s59, 0, s59
  v_exp_f32 v234, v234
  v_mfma_f32_16x16x32_bf16 v[180:183], a[104:107], v[140:143], v[180:183]
  ds_read_b128 a[100:103], v2 offset:25600
  v_add_u32 v1, s59, v3
  v_mfma_f32_16x16x32_bf16 v[184:187], a[108:111], v[136:139], v[184:187]
  s_add_u32 s58, s58, 32768
  v_exp_f32 v235, v235
  v_mfma_f32_16x16x32_bf16 v[188:191], a[108:111], v[140:143], v[188:191]
  ds_read_b128 a[104:107], v2 offset:26624
  v_cvt_pk_bf16_f32 v133, v234, v235
  v_mfma_f32_16x16x32_bf16 v[192:195], a[112:115], v[136:139], v[192:195]
  s_cmp_ge_u32 s58, 163840
  v_exp_f32 v236, v236
  v_mfma_f32_16x16x32_bf16 v[196:199], a[112:115], v[140:143], v[196:199]
  ds_read_b128 a[108:111], v2 offset:27648
  buffer_load_dwordx4 v24, s[12:15], s68 offen offset:2048 sc1 lds
  v_mfma_f32_16x16x32_bf16 v[200:203], a[116:119], v[136:139], v[200:203]
  s_cselect_b32 s58, s61, s58
  v_exp_f32 v237, v237
  v_mfma_f32_16x16x32_bf16 v[204:207], a[116:119], v[140:143], v[204:207]
  ds_read_b128 a[112:115], v2 offset:28672
  v_cvt_pk_bf16_f32 v134, v236, v237
  v_mfma_f32_16x16x32_bf16 v[208:211], a[120:123], v[136:139], v[208:211]
  s_waitcnt lgkmcnt(5)
  v_exp_f32 v238, v238
  v_mfma_f32_16x16x32_bf16 v[212:215], a[120:123], v[140:143], v[212:215]
  ds_read_b128 a[116:119], v2 offset:29696
  v_mfma_f32_16x16x32_bf16 v[216:219], a[124:127], v[136:139], v[216:219]
  v_exp_f32 v239, v239
  v_mfma_f32_16x16x32_bf16 v[220:223], a[124:127], v[140:143], v[220:223]
  ds_read_b128 a[120:123], v2 offset:30720
  v_cvt_pk_bf16_f32 v135, v238, v239
  v_mfma_f32_16x16x32_bf16 a[216:219], v[4:7], v[136:139], a[216:219]
  ds_read_b128 a[124:127], v2 offset:31744
  v_mfma_f32_16x16x32_bf16 a[220:223], v[4:7], v[140:143], a[220:223]
  buffer_load_dwordx4 v24, s[12:15], s68 offen offset:3072 sc1 lds
  v_mfma_f32_16x16x32_bf16 v[224:227], a[64:67], a[32:35], 0
  s_waitcnt vmcnt(8)
  v_exp_f32 v144, v144
  v_mfma_f32_16x16x32_bf16 v[224:227], a[68:71], a[36:39], v[224:227]
  s_barrier
  v_mfma_f32_16x16x32_bf16 v[224:227], a[72:75], a[40:43], v[224:227]
  s_lshl_b32 s68, s57, 15
  v_exp_f32 v145, v145
  v_mfma_f32_16x16x32_bf16 v[224:227], a[76:79], a[44:47], v[224:227]
  s_mov_b32 m0, s58
  v_exp_f32 v146, v146
  v_mfma_f32_16x16x32_bf16 v[232:235], a[64:67], a[48:51], 0
  ds_read_b128 a[64:67], v1 offset:0
  v_cvt_pk_bf16_f32 v136, v144, v145
  v_mfma_f32_16x16x32_bf16 v[232:235], a[68:71], a[52:55], v[232:235]
  v_exp_f32 v147, v147
  v_mfma_f32_16x16x32_bf16 v[232:235], a[72:75], a[56:59], v[232:235]
  ds_read_b128 a[68:71], v1 offset:1024
  v_cvt_pk_bf16_f32 v137, v146, v147
  v_mfma_f32_16x16x32_bf16 v[232:235], a[76:79], a[60:63], v[232:235]
  v_exp_f32 v148, v148
  v_mfma_f32_16x16x32_bf16 v[228:231], a[80:83], a[32:35], 0
  ds_read_b128 a[72:75], v1 offset:2048
  buffer_load_dwordx4 v24, s[12:15], s68 offen offset:0 sc1 lds
  v_mfma_f32_16x16x32_bf16 v[228:231], a[84:87], a[36:39], v[228:231]
  s_add_u32 s60, s60, 32768
  v_exp_f32 v149, v149
  v_mfma_f32_16x16x32_bf16 v[228:231], a[88:91], a[40:43], v[228:231]
  ds_read_b128 a[76:79], v1 offset:3072
  v_cvt_pk_bf16_f32 v138, v148, v149
  v_mfma_f32_16x16x32_bf16 v[228:231], a[92:95], a[44:47], v[228:231]
  s_cmp_ge_u32 s60, 163840
  v_exp_f32 v150, v150
  v_mfma_f32_16x16x32_bf16 v[236:239], a[80:83], a[48:51], 0
  ds_read_b128 a[80:83], v1 offset:4096
  s_cselect_b32 s60, 0, s60
  v_mfma_f32_16x16x32_bf16 v[236:239], a[84:87], a[52:55], v[236:239]
  s_waitcnt lgkmcnt(5)
  v_exp_f32 v151, v151
  v_mfma_f32_16x16x32_bf16 v[236:239], a[88:91], a[56:59], v[236:239]
  ds_read_b128 a[84:87], v1 offset:5120
  v_cvt_pk_bf16_f32 v139, v150, v151
  v_mfma_f32_16x16x32_bf16 v[236:239], a[92:95], a[60:63], v[236:239]
  ds_read_b128 a[88:91], v1 offset:6144
  v_add_u32 v2, s60, v3
  v_mfma_f32_16x16x32_bf16 v[160:163], a[96:99], v[128:131], v[160:163]
  s_add_u32 s57, s57, 1
  v_exp_f32 v152, v152
  v_mfma_f32_16x16x32_bf16 v[164:167], a[96:99], v[132:135], v[164:167]
  ds_read_b128 a[92:95], v1 offset:7168
  buffer_load_dwordx4 v24, s[12:15], s68 offen offset:1024 sc1 lds
  v_mfma_f32_16x16x32_bf16 v[168:171], a[100:103], v[128:131], v[168:171]
  v_exp_f32 v153, v153
  v_mfma_f32_16x16x32_bf16 v[172:175], a[100:103], v[132:135], v[172:175]
  ds_read_b128 a[96:99], v2 offset:8192
  v_cvt_pk_bf16_f32 v140, v152, v153
  v_mfma_f32_16x16x32_bf16 v[176:179], a[104:107], v[128:131], v[176:179]
  v_exp_f32 v154, v154
  v_mfma_f32_16x16x32_bf16 v[180:183], a[104:107], v[132:135], v[180:183]
  ds_read_b128 a[100:103], v2 offset:9216
  v_mfma_f32_16x16x32_bf16 v[184:187], a[108:111], v[128:131], v[184:187]
  v_exp_f32 v155, v155
  v_mfma_f32_16x16x32_bf16 v[188:191], a[108:111], v[132:135], v[188:191]
  ds_read_b128 a[104:107], v2 offset:10240
  v_cvt_pk_bf16_f32 v141, v154, v155
  v_mfma_f32_16x16x32_bf16 v[192:195], a[112:115], v[128:131], v[192:195]
  v_exp_f32 v156, v156
  v_mfma_f32_16x16x32_bf16 v[196:199], a[112:115], v[132:135], v[196:199]
  ds_read_b128 a[108:111], v2 offset:11264
  buffer_load_dwordx4 v24, s[12:15], s68 offen offset:2048 sc1 lds
  v_mfma_f32_16x16x32_bf16 v[200:203], a[116:119], v[128:131], v[200:203]
  v_exp_f32 v157, v157
  v_mfma_f32_16x16x32_bf16 v[204:207], a[116:119], v[132:135], v[204:207]
  ds_read_b128 a[112:115], v2 offset:12288
  v_cvt_pk_bf16_f32 v142, v156, v157
  v_mfma_f32_16x16x32_bf16 v[208:211], a[120:123], v[128:131], v[208:211]
  s_waitcnt lgkmcnt(5)
  v_exp_f32 v158, v158
  v_mfma_f32_16x16x32_bf16 v[212:215], a[120:123], v[132:135], v[212:215]
  ds_read_b128 a[116:119], v2 offset:13312
  v_mfma_f32_16x16x32_bf16 v[216:219], a[124:127], v[128:131], v[216:219]
  v_exp_f32 v159, v159
  v_mfma_f32_16x16x32_bf16 v[220:223], a[124:127], v[132:135], v[220:223]
  ds_read_b128 a[120:123], v2 offset:14336
  v_cvt_pk_bf16_f32 v143, v158, v159
  v_mfma_f32_16x16x32_bf16 a[216:219], v[4:7], v[128:131], a[216:219]
  ds_read_b128 a[124:127], v2 offset:15360
  v_mfma_f32_16x16x32_bf16 a[220:223], v[4:7], v[132:135], a[220:223]
  buffer_load_dwordx4 v24, s[12:15], s68 offen offset:3072 sc1 lds
  v_mfma_f32_16x16x32_bf16 v[144:147], a[64:67], a[32:35], 0
  s_add_u32 m0, s58, 4096
  v_exp_f32 v224, v224
  v_mfma_f32_16x16x32_bf16 v[144:147], a[68:71], a[36:39], v[144:147]
  s_add_u32 s68, s68, 4096
  buffer_load_dwordx4 v24, s[12:15], s68 offen offset:0 sc1 lds
  v_mfma_f32_16x16x32_bf16 v[144:147], a[72:75], a[40:43], v[144:147]
  v_exp_f32 v225, v225
  v_mfma_f32_16x16x32_bf16 v[144:147], a[76:79], a[44:47], v[144:147]
  v_exp_f32 v226, v226
  v_mfma_f32_16x16x32_bf16 v[152:155], a[64:67], a[48:51], 0
  ds_read_b128 a[64:67], v1 offset:16384
  v_cvt_pk_bf16_f32 v128, v224, v225
  v_mfma_f32_16x16x32_bf16 v[152:155], a[68:71], a[52:55], v[152:155]
  v_exp_f32 v227, v227
  v_mfma_f32_16x16x32_bf16 v[152:155], a[72:75], a[56:59], v[152:155]
  ds_read_b128 a[68:71], v1 offset:17408
  v_cvt_pk_bf16_f32 v129, v226, v227
  v_mfma_f32_16x16x32_bf16 v[152:155], a[76:79], a[60:63], v[152:155]
  v_exp_f32 v228, v228
  v_mfma_f32_16x16x32_bf16 v[148:151], a[80:83], a[32:35], 0
  ds_read_b128 a[72:75], v1 offset:18432
  v_mfma_f32_16x16x32_bf16 v[148:151], a[84:87], a[36:39], v[148:151]
  v_exp_f32 v229, v229
  v_mfma_f32_16x16x32_bf16 v[148:151], a[88:91], a[40:43], v[148:151]
  ds_read_b128 a[76:79], v1 offset:19456
  v_cvt_pk_bf16_f32 v130, v228, v229
  v_mfma_f32_16x16x32_bf16 v[148:151], a[92:95], a[44:47], v[148:151]
  v_exp_f32 v230, v230
  v_mfma_f32_16x16x32_bf16 v[156:159], a[80:83], a[48:51], 0
  ds_read_b128 a[80:83], v1 offset:20480
  buffer_load_dwordx4 v24, s[12:15], s68 offen offset:1024 sc1 lds
  v_mfma_f32_16x16x32_bf16 v[156:159], a[84:87], a[52:55], v[156:159]
  s_waitcnt lgkmcnt(5)
  v_exp_f32 v231, v231
  v_mfma_f32_16x16x32_bf16 v[156:159], a[88:91], a[56:59], v[156:159]
  ds_read_b128 a[84:87], v1 offset:21504
  v_cvt_pk_bf16_f32 v131, v230, v231
  v_mfma_f32_16x16x32_bf16 v[156:159], a[92:95], a[60:63], v[156:159]
  ds_read_b128 a[88:91], v1 offset:22528
  v_mfma_f32_16x16x32_bf16 v[160:163], a[96:99], v[136:139], v[160:163]
  s_add_u32 s59, s59, 32768
  v_exp_f32 v232, v232
  v_mfma_f32_16x16x32_bf16 v[164:167], a[96:99], v[140:143], v[164:167]
  ds_read_b128 a[92:95], v1 offset:23552
  v_mfma_f32_16x16x32_bf16 v[168:171], a[100:103], v[136:139], v[168:171]
  s_cmp_ge_u32 s59, 163840
  v_exp_f32 v233, v233
  v_mfma_f32_16x16x32_bf16 v[172:175], a[100:103], v[140:143], v[172:175]
  ds_read_b128 a[96:99], v2 offset:24576
  v_cvt_pk_bf16_f32 v132, v232, v233
  v_mfma_f32_16x16x32_bf16 v[176:179], a[104:107], v[136:139], v[176:179]
  s_cselect_b32 s59, 0, s59
  v_exp_f32 v234, v234
  v_mfma_f32_16x16x32_bf16 v[180:183], a[104:107], v[140:143], v[180:183]
  ds_read_b128 a[100:103], v2 offset:25600
  v_add_u32 v1, s59, v3
  v_mfma_f32_16x16x32_bf16 v[184:187], a[108:111], v[136:139], v[184:187]
  s_add_u32 s58, s58, 32768
  v_exp_f32 v235, v235
  v_mfma_f32_16x16x32_bf16 v[188:191], a[108:111], v[140:143], v[188:191]
  ds_read_b128 a[104:107], v2 offset:26624
  v_cvt_pk_bf16_f32 v133, v234, v235
  v_mfma_f32_16x16x32_bf16 v[192:195], a[112:115], v[136:139], v[192:195]
  s_cmp_ge_u32 s58, 163840
  v_exp_f32 v236, v236
  v_mfma_f32_16x16x32_bf16 v[196:199], a[112:115], v[140:143], v[196:199]
  ds_read_b128 a[108:111], v2 offset:27648
  buffer_load_dwordx4 v24, s[12:15], s68 offen offset:2048 sc1 lds
  v_mfma_f32_16x16x32_bf16 v[200:203], a[116:119], v[136:139], v[200:203]
  s_cselect_b32 s58, s61, s58
  v_exp_f32 v237, v237
  v_mfma_f32_16x16x32_bf16 v[204:207], a[116:119], v[140:143], v[204:207]
  ds_read_b128 a[112:115], v2 offset:28672
  v_cvt_pk_bf16_f32 v134, v236, v237
  v_mfma_f32_16x16x32_bf16 v[208:211], a[120:123], v[136:139], v[208:211]
  s_waitcnt lgkmcnt(5)
  v_exp_f32 v238, v238
  v_mfma_f32_16x16x32_bf16 v[212:215], a[120:123], v[140:143], v[212:215]
  ds_read_b128 a[116:119], v2 offset:29696
  v_mfma_f32_16x16x32_bf16 v[216:219], a[124:127], v[136:139], v[216:219]
  v_exp_f32 v239, v239
  v_mfma_f32_16x16x32_bf16 v[220:223], a[124:127], v[140:143], v[220:223]
  ds_read_b128 a[120:123], v2 offset:30720
  v_cvt_pk_bf16_f32 v135, v238, v239
  v_mfma_f32_16x16x32_bf16 a[216:219], v[4:7], v[136:139], a[216:219]
  ds_read_b128 a[124:127], v2 offset:31744
  v_mfma_f32_16x16x32_bf16 a[220:223], v[4:7], v[140:143], a[220:223]
  buffer_load_dwordx4 v24, s[12:15], s68 offen offset:3072 sc1 lds
  v_mfma_f32_16x16x32_bf16 v[224:227], a[64:67], a[32:35], 0
  s_waitcnt vmcnt(8)
  v_exp_f32 v144, v144
  v_mfma_f32_16x16x32_bf16 v[224:227], a[68:71], a[36:39], v[224:227]
  s_barrier
  v_mfma_f32_16x16x32_bf16 v[224:227], a[72:75], a[40:43], v[224:227]
  s_lshl_b32 s68, s57, 15
  v_exp_f32 v145, v145
  v_mfma_f32_16x16x32_bf16 v[224:227], a[76:79], a[44:47], v[224:227]
  s_mov_b32 m0, s58
  v_exp_f32 v146, v146
  v_mfma_f32_16x16x32_bf16 v[232:235], a[64:67], a[48:51], 0
  ds_read_b128 a[64:67], v1 offset:0
  v_cvt_pk_bf16_f32 v136, v144, v145
  v_mfma_f32_16x16x32_bf16 v[232:235], a[68:71], a[52:55], v[232:235]
  v_exp_f32 v147, v147
  v_mfma_f32_16x16x32_bf16 v[232:235], a[72:75], a[56:59], v[232:235]
  ds_read_b128 a[68:71], v1 offset:1024
  v_cvt_pk_bf16_f32 v137, v146, v147
  v_mfma_f32_16x16x32_bf16 v[232:235], a[76:79], a[60:63], v[232:235]
  v_exp_f32 v148, v148
  v_mfma_f32_16x16x32_bf16 v[228:231], a[80:83], a[32:35], 0
  ds_read_b128 a[72:75], v1 offset:2048
  buffer_load_dwordx4 v24, s[12:15], s68 offen offset:0 sc1 lds
  v_mfma_f32_16x16x32_bf16 v[228:231], a[84:87], a[36:39], v[228:231]
  s_add_u32 s60, s60, 32768
  v_exp_f32 v149, v149
  v_mfma_f32_16x16x32_bf16 v[228:231], a[88:91], a[40:43], v[228:231]
  ds_read_b128 a[76:79], v1 offset:3072
  v_cvt_pk_bf16_f32 v138, v148, v149
  v_mfma_f32_16x16x32_bf16 v[228:231], a[92:95], a[44:47], v[228:231]
  s_cmp_ge_u32 s60, 163840
  v_exp_f32 v150, v150
  v_mfma_f32_16x16x32_bf16 v[236:239], a[80:83], a[48:51], 0
  ds_read_b128 a[80:83], v1 offset:4096
  s_cselect_b32 s60, 0, s60
  v_mfma_f32_16x16x32_bf16 v[236:239], a[84:87], a[52:55], v[236:239]
  s_waitcnt lgkmcnt(5)
  v_exp_f32 v151, v151
  v_mfma_f32_16x16x32_bf16 v[236:239], a[88:91], a[56:59], v[236:239]
  ds_read_b128 a[84:87], v1 offset:5120
  v_cvt_pk_bf16_f32 v139, v150, v151
  v_mfma_f32_16x16x32_bf16 v[236:239], a[92:95], a[60:63], v[236:239]
  ds_read_b128 a[88:91], v1 offset:6144
  v_add_u32 v2, s60, v3
  v_mfma_f32_16x16x32_bf16 v[160:163], a[96:99], v[128:131], v[160:163]
  s_add_u32 s57, s57, 1
  v_exp_f32 v152, v152
  v_mfma_f32_16x16x32_bf16 v[164:167], a[96:99], v[132:135], v[164:167]
  ds_read_b128 a[92:95], v1 offset:7168
  buffer_load_dwordx4 v24, s[12:15], s68 offen offset:1024 sc1 lds
  v_mfma_f32_16x16x32_bf16 v[168:171], a[100:103], v[128:131], v[168:171]
  v_exp_f32 v153, v153
  v_mfma_f32_16x16x32_bf16 v[172:175], a[100:103], v[132:135], v[172:175]
  ds_read_b128 a[96:99], v2 offset:8192
  v_cvt_pk_bf16_f32 v140, v152, v153
  v_mfma_f32_16x16x32_bf16 v[176:179], a[104:107], v[128:131], v[176:179]
  v_exp_f32 v154, v154
  v_mfma_f32_16x16x32_bf16 v[180:183], a[104:107], v[132:135], v[180:183]
  ds_read_b128 a[100:103], v2 offset:9216
  v_mfma_f32_16x16x32_bf16 v[184:187], a[108:111], v[128:131], v[184:187]
  v_exp_f32 v155, v155
  v_mfma_f32_16x16x32_bf16 v[188:191], a[108:111], v[132:135], v[188:191]
  ds_read_b128 a[104:107], v2 offset:10240
  v_cvt_pk_bf16_f32 v141, v154, v155
  v_mfma_f32_16x16x32_bf16 v[192:195], a[112:115], v[128:131], v[192:195]
  v_exp_f32 v156, v156
  v_mfma_f32_16x16x32_bf16 v[196:199], a[112:115], v[132:135], v[196:199]
  ds_read_b128 a[108:111], v2 offset:11264
  buffer_load_dwordx4 v24, s[12:15], s68 offen offset:2048 sc1 lds
  v_mfma_f32_16x16x32_bf16 v[200:203], a[116:119], v[128:131], v[200:203]
  v_exp_f32 v157, v157
  v_mfma_f32_16x16x32_bf16 v[204:207], a[116:119], v[132:135], v[204:207]
  ds_read_b128 a[112:115], v2 offset:12288
  v_cvt_pk_bf16_f32 v142, v156, v157
  v_mfma_f32_16x16x32_bf16 v[208:211], a[120:123], v[128:131], v[208:211]
  s_waitcnt lgkmcnt(5)
  v_exp_f32 v158, v158
  v_mfma_f32_16x16x32_bf16 v[212:215], a[120:123], v[132:135], v[212:215]
  ds_read_b128 a[116:119], v2 offset:13312
  buffer_load_dwordx4 v24, s[12:15], s68 offen offset:3072 sc1 lds
  v_mfma_f32_16x16x32_bf16 v[216:219], a[124:127], v[128:131], v[216:219]
  s_sub_u32 s56, s56, 1
  v_exp_f32 v159, v159
  v_mfma_f32_16x16x32_bf16 v[220:223], a[124:127], v[132:135], v[220:223]
  ds_read_b128 a[120:123], v2 offset:14336
  v_cvt_pk_bf16_f32 v143, v158, v159
  v_mfma_f32_16x16x32_bf16 a[216:219], v[4:7], v[128:131], a[216:219]
  ds_read_b128 a[124:127], v2 offset:15360
  v_mfma_f32_16x16x32_bf16 a[220:223], v[4:7], v[132:135], a[220:223]
  s_cbranch_scc0 K2_SL
K2_E:
  s_waitcnt lgkmcnt(0)
  v_mfma_f32_16x16x32_bf16 v[160:163], a[96:99], v[136:139], v[160:163]
  v_exp_f32 v224, v224
  v_mfma_f32_16x16x32_bf16 v[164:167], a[96:99], v[140:143], v[164:167]
  ds_read_b128 a[96:99], v2 offset:24576
  v_exp_f32 v225, v225
  v_mfma_f32_16x16x32_bf16 v[168:171], a[100:103], v[136:139], v[168:171]
  v_exp_f32 v226, v226
  v_mfma_f32_16x16x32_bf16 v[172:175], a[100:103], v[140:143], v[172:175]
  ds_read_b128 a[100:103], v2 offset:25600
  v_cvt_pk_bf16_f32 v128, v224, v225
  v_mfma_f32_16x16x32_bf16 v[176:179], a[104:107], v[136:139], v[176:179]
  v_exp_f32 v227, v227
  v_mfma_f32_16x16x32_bf16 v[180:183], a[104:107], v[140:143], v[180:183]
  ds_read_b128 a[104:107], v2 offset:26624
  v_exp_f32 v228, v228
  v_mfma_f32_16x16x32_bf16 v[184:187], a[108:111], v[136:139], v[184:187]
  v_cvt_pk_bf16_f32 v129, v226, v227
  v_exp_f32 v229, v229
  v_mfma_f32_16x16x32_bf16 v[188:191], a[108:111], v[140:143], v[188:191]
  ds_read_b128 a[108:111], v2 offset:27648
  v_exp_f32 v230, v230
  v_mfma_f32_16x16x32_bf16 v[192:195], a[112:115], v[136:139], v[192:195]
  v_cvt_pk_bf16_f32 v130, v228, v229
  v_exp_f32 v231, v231
  v_mfma_f32_16x16x32_bf16 v[196:199], a[112:115], v[140:143], v[196:199]
  ds_read_b128 a[112:115], v2 offset:28672
  v_exp_f32 v232, v232
  v_mfma_f32_16x16x32_bf16 v[200:203], a[116:119], v[136:139], v[200:203]
  v_cvt_pk_bf16_f32 v131, v230, v231
  v_exp_f32 v233, v233
  v_mfma_f32_16x16x32_bf16 v[204:207], a[116:119], v[140:143], v[204:207]
  ds_read_b128 a[116:119], v2 offset:29696
  v_exp_f32 v234, v234
  v_mfma_f32_16x16x32_bf16 v[208:211], a[120:123], v[136:139], v[208:211]
  v_cvt_pk_bf16_f32 v132, v232, v233
  v_exp_f32 v235, v235
  v_mfma_f32_16x16x32_bf16 v[212:215], a[120:123], v[140:143], v[212:215]
  ds_read_b128 a[120:123], v2 offset:30720
  v_exp_f32 v236, v236
  v_mfma_f32_16x16x32_bf16 v[216:219], a[124:127], v[136:139], v[216:219]
  v_cvt_pk_bf16_f32 v133, v234, v235
  v_exp_f32 v237, v237
  v_mfma_f32_16x16x32_bf16 v[220:223], a[124:127], v[140:143], v[220:223]
  ds_read_b128 a[124:127], v2 offset:31744
  v_exp_f32 v238, v238
  v_mfma_f32_16x16x32_bf16 a[216:219], v[4:7], v[136:139], a[216:219]
  v_exp_f32 v239, v239
  v_mfma_f32_16x16x32_bf16 a[220:223], v[4:7], v[140:143], a[220:223]
  v_cvt_pk_bf16_f32 v134, v236, v237
  v_cvt_pk_bf16_f32 v135, v238, v239
  v_mfma_f32_16x16x32_bf16 a[216:219], v[4:7], v[128:131], a[216:219]
  s_nop 0
  v_mfma_f32_16x16x32_bf16 a[220:223], v[4:7], v[132:135], a[220:223]
  s_waitcnt lgkmcnt(0)
  v_mfma_f32_16x16x32_bf16 v[160:163], a[96:99], v[128:131], v[160:163]
  v_mfma_f32_16x16x32_bf16 v[164:167], a[96:99], v[132:135], v[164:167]
  v_mfma_f32_16x16x32_bf16 v[168:171], a[100:103], v[128:131], v[168:171]
  v_mfma_f32_16x16x32_bf16 v[172:175], a[100:103], v[132:135], v[172:175]
  v_mfma_f32_16x16x32_bf16 v[176:179], a[104:107], v[128:131], v[176:179]
  v_mfma_f32_16x16x32_bf16 v[180:183], a[104:107], v[132:135], v[180:183]
  v_mfma_f32_16x16x32_bf16 v[184:187], a[108:111], v[128:131], v[184:187]
  v_mfma_f32_16x16x32_bf16 v[188:191], a[108:111], v[132:135], v[188:191]
  v_accvgpr_read_b32 v11, a216
  v_mfma_f32_16x16x32_bf16 v[192:195], a[112:115], v[128:131], v[192:195]
  v_accvgpr_read_b32 v12, a220
  v_cmp_nle_f32 vcc, 0x2b800000, v11
  v_mfma_f32_16x16x32_bf16 v[196:199], a[112:115], v[132:135], v[196:199]
  s_or_b64 s[70:71], s[70:71], vcc
  v_cmp_nge_f32 vcc, 0x5f800000, v11
  v_mfma_f32_16x16x32_bf16 v[200:203], a[116:119], v[128:131], v[200:203]
  s_or_b64 s[70:71], s[70:71], vcc
  v_cmp_nle_f32 vcc, 0x2b800000, v12
  v_mfma_f32_16x16x32_bf16 v[204:207], a[116:119], v[132:135], v[204:207]
  s_or_b64 s[70:71], s[70:71], vcc
  v_cmp_nge_f32 vcc, 0x5f800000, v12
  v_mfma_f32_16x16x32_bf16 v[208:211], a[120:123], v[128:131], v[208:211]
  s_or_b64 s[70:71], s[70:71], vcc
  v_rcp_f32 v14, v11
  v_mfma_f32_16x16x32_bf16 v[212:215], a[120:123], v[132:135], v[212:215]
  s_mul_i32 s76, s66, 294912
  v_rcp_f32 v15, v12
  v_mfma_f32_16x16x32_bf16 v[216:219], a[124:127], v[128:131], v[216:219]
  s_lshl_b32 s77, s17, 13
  s_add_u32 s76, s76, s77
  s_add_u32 s76, s76, 57671680
  v_mfma_f32_16x16x32_bf16 v[220:223], a[124:127], v[132:135], v[220:223]
  s_add_u32 s77, s76, 4096
  v_mul_f32 v14, v14, v9
  v_mul_f32 v15, v15, v10
  s_cmp_lg_u64 s[70:71], 0
  s_cbranch_scc1 K2_SLOW
K2_STORE:
  v_pk_mul_f32 v[160:161], v[160:161], v[14:15] op_sel:[0,0] op_sel_hi:[1,0]
  v_pk_mul_f32 v[162:163], v[162:163], v[14:15] op_sel:[0,0] op_sel_hi:[1,0]
  v_pk_mul_f32 v[168:169], v[168:169], v[14:15] op_sel:[0,0] op_sel_hi:[1,0]
  v_pk_mul_f32 v[170:171], v[170:171], v[14:15] op_sel:[0,0] op_sel_hi:[1,0]
  v_cvt_pk_bf16_f32 v32, v160, v161
  v_cvt_pk_bf16_f32 v33, v162, v163
  v_cvt_pk_bf16_f32 v34, v168, v169
  v_cvt_pk_bf16_f32 v35, v170, v171
  v_pk_mul_f32 v[164:165], v[164:165], v[14:15] op_sel:[0,1] op_sel_hi:[1,1]
  v_pk_mul_f32 v[166:167], v[166:167], v[14:15] op_sel:[0,1] op_sel_hi:[1,1]
  v_pk_mul_f32 v[172:173], v[172:173], v[14:15] op_sel:[0,1] op_sel_hi:[1,1]
  v_pk_mul_f32 v[174:175], v[174:175], v[14:15] op_sel:[0,1] op_sel_hi:[1,1]
  v_cvt_pk_bf16_f32 v36, v164, v165
  v_cvt_pk_bf16_f32 v37, v166, v167
  v_cvt_pk_bf16_f32 v38, v172, v173
  v_cvt_pk_bf16_f32 v39, v174, v175
  v_pk_mul_f32 v[176:177], v[176:177], v[14:15] op_sel:[0,0] op_sel_hi:[1,0]
  v_pk_mul_f32 v[178:179], v[178:179], v[14:15] op_sel:[0,0] op_sel_hi:[1,0]
  v_pk_mul_f32 v[184:185], v[184:185], v[14:15] op_sel:[0,0] op_sel_hi:[1,0]
  v_pk_mul_f32 v[186:187], v[186:187], v[14:15] op_sel:[0,0] op_sel_hi:[1,0]
  v_cvt_pk_bf16_f32 v40, v176, v177
  v_cvt_pk_bf16_f32 v41, v178, v179
  v_cvt_pk_bf16_f32 v42, v184, v185
  v_cvt_pk_bf16_f32 v43, v186, v187
  v_pk_mul_f32 v[180:181], v[180:181], v[14:15] op_sel:[0,1] op_sel_hi:[1,1]
  v_pk_mul_f32 v[182:183], v[182:183], v[14:15] op_sel:[0,1] op_sel_hi:[1,1]
  v_pk_mul_f32 v[188:189], v[188:189], v[14:15] op_sel:[0,1] op_sel_hi:[1,1]
  v_pk_mul_f32 v[190:191], v[190:191], v[14:15] op_sel:[0,1] op_sel_hi:[1,1]
  v_cvt_pk_bf16_f32 v44, v180, v181
  v_cvt_pk_bf16_f32 v45, v182, v183
  v_cvt_pk_bf16_f32 v46, v188, v189
  v_cvt_pk_bf16_f32 v47, v190, v191
  v_pk_mul_f32 v[192:193], v[192:193], v[14:15] op_sel:[0,0] op_sel_hi:[1,0]
  v_pk_mul_f32 v[194:195], v[194:195], v[14:15] op_sel:[0,0] op_sel_hi:[1,0]
  v_pk_mul_f32 v[200:201], v[200:201], v[14:15] op_sel:[0,0] op_sel_hi:[1,0]
  v_pk_mul_f32 v[202:203], v[202:203], v[14:15] op_sel:[0,0] op_sel_hi:[1,0]
  v_cvt_pk_bf16_f32 v48, v192, v193
  v_cvt_pk_bf16_f32 v49, v194, v195
  v_cvt_pk_bf16_f32 v50, v200, v201
  v_cvt_pk_bf16_f32 v51, v202, v203
  v_pk_mul_f32 v[196:197], v[196:197], v[14:15] op_sel:[0,1] op_sel_hi:[1,1]
  v_pk_mul_f32 v[198:199], v[198:199], v[14:15] op_sel:[0,1] op_sel_hi:[1,1]
  v_pk_mul_f32 v[204:205], v[204:205], v[14:15] op_sel:[0,1] op_sel_hi:[1,1]
  v_pk_mul_f32 v[206:207], v[206:207], v[14:15] op_sel:[0,1] op_sel_hi:[1,1]
  v_cvt_pk_bf16_f32 v52, v196, v197
  v_cvt_pk_bf16_f32 v53, v198, v199
  v_cvt_pk_bf16_f32 v54, v204, v205
  v_cvt_pk_bf16_f32 v55, v206, v207
  v_pk_mul_f32 v[208:209], v[208:209], v[14:15] op_sel:[0,0] op_sel_hi:[1,0]
  v_pk_mul_f32 v[210:211], v[210:211], v[14:15] op_sel:[0,0] op_sel_hi:[1,0]
  v_pk_mul_f32 v[216:217], v[216:217], v[14:15] op_sel:[0,0] op_sel_hi:[1,0]
  v_pk_mul_f32 v[218:219], v[218:219], v[14:15] op_sel:[0,0] op_sel_hi:[1,0]
  v_cvt_pk_bf16_f32 v56, v208, v209
  v_cvt_pk_bf16_f32 v57, v210, v211
  v_cvt_pk_bf16_f32 v58, v216, v217
  v_cvt_pk_bf16_f32 v59, v218, v219
  v_pk_mul_f32 v[212:213], v[212:213], v[14:15] op_sel:[0,1] op_sel_hi:[1,1]
  v_pk_mul_f32 v[214:215], v[214:215], v[14:15] op_sel:[0,1] op_sel_hi:[1,1]
  v_pk_mul_f32 v[220:221], v[220:221], v[14:15] op_sel:[0,1] op_sel_hi:[1,1]
  v_pk_mul_f32 v[222:223], v[222:223], v[14:15] op_sel:[0,1] op_sel_hi:[1,1]
  v_cvt_pk_bf16_f32 v60, v212, v213
  v_cvt_pk_bf16_f32 v61, v214, v215
  v_cvt_pk_bf16_f32 v62, v220, v221
  v_cvt_pk_bf16_f32 v63, v222, v223
  s_waitcnt vmcnt(33)
  v_mfma_f32_32x32x16_bf16 v[192:207], a[160:163], a[128:131], 0
  buffer_store_dwordx4 v[32:35], v30, s[8:11], s76 offen offset:0 sc1
  buffer_store_dwordx4 v[36:39], v30, s[8:11], s76 offen offset:256 sc1
  v_mov_b32 v232, 0
  v_mov_b32 v233, 0
  v_mov_b32 v234, 0
  v_mov_b32 v235, 0
  s_mov_b64 s[12:13], s[32:33]
  s_mov_b32 s14, 524288
  v_mov_b32 v12, v22
  s_nop 0
  v_mfma_f32_32x32x16_bf16 a[0:15], v[232:235], v[232:235], 0
  buffer_store_dwordx4 v[40:43], v30, s[8:11], s76 offen offset:2048 sc1
  v_mfma_f32_32x32x16_bf16 v[208:223], a[160:163], a[132:135], 0
  v_exp_f32 v192, v192
  v_exp_f32 v193, v193
  v_exp_f32 v194, v194
  v_cvt_pk_bf16_f32 v224, v192, v193
  v_exp_f32 v195, v195
  v_exp_f32 v196, v196
  v_cvt_pk_bf16_f32 v225, v194, v195
  v_exp_f32 v197, v197
  v_mfma_f32_32x32x16_bf16 a[16:31], v[232:235], v[232:235], 0
  buffer_store_dwordx4 v[44:47], v30, s[8:11], s76 offen offset:2304 sc1
  v_exp_f32 v198, v198
  v_cvt_pk_bf16_f32 v226, v196, v197
  v_exp_f32 v199, v199
  v_exp_f32 v200, v200
  v_cvt_pk_bf16_f32 v227, v198, v199
  v_exp_f32 v201, v201
  v_exp_f32 v202, v202
  v_cvt_pk_bf16_f32 v228, v200, v201
  v_mfma_f32_32x32x16_bf16 a[32:47], v[232:235], v[232:235], 0
  v_exp_f32 v203, v203
  v_exp_f32 v204, v204
  v_cvt_pk_bf16_f32 v229, v202, v203
  v_exp_f32 v205, v205
  v_mfma_f32_32x32x16_bf16 a[48:63], v[232:235], v[232:235], 0
  v_exp_f32 v206, v206
  v_exp_f32 v207, v207
  v_cvt_pk_bf16_f32 v230, v204, v205
  v_cvt_pk_bf16_f32 v231, v206, v207
  v_mfma_f32_32x32x16_bf16 v[192:207], a[160:163], a[136:139], 0
  s_waitcnt vmcnt(35)
  buffer_store_dwordx4 v[48:51], v30, s[8:11], s77 offen offset:0 sc1
  v_exp_f32 v208, v208
  v_exp_f32 v209, v209
  v_exp_f32 v210, v210
  v_cvt_pk_bf16_f32 v232, v208, v209
  v_exp_f32 v211, v211
  v_exp_f32 v212, v212
  v_cvt_pk_bf16_f32 v233, v210, v211
  v_exp_f32 v213, v213
  v_mfma_f32_32x32x16_bf16 v[64:79], a[176:179], v[224:227], 0
  v_exp_f32 v214, v214
  v_cvt_pk_bf16_f32 v234, v212, v213
  v_exp_f32 v215, v215
  v_exp_f32 v216, v216
  v_cvt_pk_bf16_f32 v235, v214, v215
  v_exp_f32 v217, v217
  v_exp_f32 v218, v218
  v_cvt_pk_bf16_f32 v236, v216, v217
  v_mfma_f32_32x32x16_bf16 v[64:79], a[180:183], v[228:231], v[64:79]
  buffer_store_dwordx4 v[52:55], v30, s[8:11], s77 offen offset:256 sc1
  v_exp_f32 v219, v219
  v_exp_f32 v220, v220
  v_cvt_pk_bf16_f32 v237, v218, v219
  v_exp_f32 v221, v221
  v_exp_f32 v222, v222
  v_exp_f32 v223, v223
  v_cvt_pk_bf16_f32 v238, v220, v221
  v_cvt_pk_bf16_f32 v239, v222, v223
  v_mfma_f32_32x32x16_bf16 v[208:223], a[160:163], a[140:143], 0
  buffer_store_dwordx4 v[56:59], v30, s[8:11], s77 offen offset:2048 sc1
  v_exp_f32 v192, v192
  v_exp_f32 v193, v193
  v_exp_f32 v194, v194
  v_cvt_pk_bf16_f32 v224, v192, v193
  v_exp_f32 v195, v195
  v_exp_f32 v196, v196
  v_cvt_pk_bf16_f32 v225, v194, v195
  v_exp_f32 v197, v197
  v_mfma_f32_32x32x16_bf16 v[80:95], a[176:179], v[232:235], 0
  v_exp_f32 v198, v198
  v_cvt_pk_bf16_f32 v226, v196, v197
  v_exp_f32 v199, v199
  v_exp_f32 v200, v200
  v_cvt_pk_bf16_f32 v227, v198, v199
  v_exp_f32 v201, v201
  v_exp_f32 v202, v202
  v_cvt_pk_bf16_f32 v228, v200, v201
  v_mfma_f32_32x32x16_bf16 v[80:95], a[180:183], v[236:239], v[80:95]
  v_exp_f32 v203, v203
  v_exp_f32 v204, v204
  v_cvt_pk_bf16_f32 v229, v202, v203
  v_exp_f32 v205, v205
  v_exp_f32 v206, v206
  v_exp_f32 v207, v207
  v_cvt_pk_bf16_f32 v230, v204, v205
  v_cvt_pk_bf16_f32 v231, v206, v207
  v_mfma_f32_32x32x16_bf16 v[192:207], a[160:163], a[144:147], 0
  buffer_store_dwordx4 v[60:63], v30, s[8:11], s77 offen offset:2304 sc1
  v_exp_f32 v208, v208
  v_exp_f32 v209, v209
  v_exp_f32 v210, v210
  v_cvt_pk_bf16_f32 v232, v208, v209
  v_exp_f32 v211, v211
  v_exp_f32 v212, v212
  v_cvt_pk_bf16_f32 v233, v210, v211
  v_exp_f32 v213, v213
  v_mfma_f32_32x32x16_bf16 v[96:111], a[176:179], v[224:227], 0
  v_exp_f32 v214, v214
  v_cvt_pk_bf16_f32 v234, v212, v213
  v_exp_f32 v215, v215
  v_exp_f32 v216, v216
  v_cvt_pk_bf16_f32 v235, v214, v215
  v_exp_f32 v217, v217
  v_exp_f32 v218, v218
  v_cvt_pk_bf16_f32 v236, v216, v217
  v_mfma_f32_32x32x16_bf16 v[96:111], a[180:183], v[228:231], v[96:111]
  v_exp_f32 v219, v219
  v_exp_f32 v220, v220
  v_cvt_pk_bf16_f32 v237, v218, v219
  v_exp_f32 v221, v221
  v_exp_f32 v222, v222
  v_exp_f32 v223, v223
  v_cvt_pk_bf16_f32 v238, v220, v221
  v_cvt_pk_bf16_f32 v239, v222, v223
  v_mfma_f32_32x32x16_bf16 v[208:223], a[160:163], a[148:151], 0
  v_exp_f32 v192, v192
  v_exp_f32 v193, v193
  v_exp_f32 v194, v194
  v_cvt_pk_bf16_f32 v224, v192, v193
  v_exp_f32 v195, v195
  v_exp_f32 v196, v196
  v_cvt_pk_bf16_f32 v225, v194, v195
  v_exp_f32 v197, v197
  v_mfma_f32_32x32x16_bf16 v[112:127], a[176:179], v[232:235], 0
  v_exp_f32 v198, v198
  v_cvt_pk_bf16_f32 v226, v196, v197
  v_exp_f32 v199, v199
  v_exp_f32 v200, v200
  v_cvt_pk_bf16_f32 v227, v198, v199
  v_exp_f32 v201, v201
  v_exp_f32 v202, v202
  v_cvt_pk_bf16_f32 v228, v200, v201
  v_mfma_f32_32x32x16_bf16 v[112:127], a[180:183], v[236:239], v[112:127]
  v_exp_f32 v203, v203
  v_exp_f32 v204, v204
  v_cvt_pk_bf16_f32 v229, v202, v203
  v_exp_f32 v205, v205
  v_exp_f32 v206, v206
  v_exp_f32 v207, v207
  v_cvt_pk_bf16_f32 v230, v204, v205
  v_cvt_pk_bf16_f32 v231, v206, v207
  v_mfma_f32_32x32x16_bf16 v[192:207], a[160:163], a[152:155], 0
  v_exp_f32 v208, v208
  v_exp_f32 v209, v209
  v_exp_f32 v210, v210
  v_cvt_pk_bf16_f32 v232, v208, v209
  v_exp_f32 v211, v211
  v_exp_f32 v212, v212
  v_cvt_pk_bf16_f32 v233, v210, v211
  v_exp_f32 v213, v213
  v_mfma_f32_32x32x16_bf16 v[128:143], a[176:179], v[224:227], 0
  v_exp_f32 v214, v214
  v_cvt_pk_bf16_f32 v234, v212, v213
  v_exp_f32 v215, v215
  v_exp_f32 v216, v216
  v_cvt_pk_bf16_f32 v235, v214, v215
  v_exp_f32 v217, v217
  v_exp_f32 v218, v218
  v_cvt_pk_bf16_f32 v236, v216, v217
  v_mfma_f32_32x32x16_bf16 v[128:143], a[180:183], v[228:231], v[128:143]
  v_exp_f32 v219, v219
  v_exp_f32 v220, v220
  v_cvt_pk_bf16_f32 v237, v218, v219
  v_exp_f32 v221, v221
  v_exp_f32 v222, v222
  v_exp_f32 v223, v223
  v_cvt_pk_bf16_f32 v238, v220, v221
  v_cvt_pk_bf16_f32 v239, v222, v223
  v_mfma_f32_32x32x16_bf16 v[208:223], a[160:163], a[156:159], 0
  buffer_load_dwordx4 a[160:163], v3, s[8:11], s20 offen sc1
  s_add_u32 s20, s20, 2048
  v_exp_f32 v192, v192
  v_exp_f32 v193, v193
  v_exp_f32 v194, v194
  v_cvt_pk_bf16_f32 v224, v192, v193
  v_exp_f32 v195, v195
  v_exp_f32 v196, v196
  v_cvt_pk_bf16_f32 v225, v194, v195
  v_exp_f32 v197, v197
  v_mfma_f32_32x32x16_bf16 v[144:159], a[176:179], v[232:235], 0
  v_exp_f32 v198, v198
  v_cvt_pk_bf16_f32 v226, v196, v197
  v_exp_f32 v199, v199
  v_exp_f32 v200, v200
  v_cvt_pk_bf16_f32 v227, v198, v199
  v_exp_f32 v201, v201
  v_exp_f32 v202, v202
  v_cvt_pk_bf16_f32 v228, v200, v201
  v_mfma_f32_32x32x16_bf16 v[144:159], a[180:183], v[236:239], v[144:159]
  s_waitcnt vmcnt(39)
  v_exp_f32 v203, v203
  v_exp_f32 v204, v204
  v_cvt_pk_bf16_f32 v229, v202, v203
  v_exp_f32 v205, v205
  v_exp_f32 v206, v206
  v_exp_f32 v207, v207
  v_cvt_pk_bf16_f32 v230, v204, v205
  v_cvt_pk_bf16_f32 v231, v206, v207
  v_mfma_f32_32x32x16_bf16 v[192:207], a[164:167], a[128:131], 0
  v_exp_f32 v208, v208
  v_exp_f32 v209, v209
  v_exp_f32 v210, v210
  v_cvt_pk_bf16_f32 v232, v208, v209
  v_exp_f32 v211, v211
  v_exp_f32 v212, v212
  v_cvt_pk_bf16_f32 v233, v210, v211
  v_exp_f32 v213, v213
  v_mfma_f32_32x32x16_bf16 v[160:175], a[176:179], v[224:227], 0
  v_exp_f32 v214, v214
  v_cvt_pk_bf16_f32 v234, v212, v213
  v_exp_f32 v215, v215
  v_exp_f32 v216, v216
  v_cvt_pk_bf16_f32 v235, v214, v215
  v_exp_f32 v217, v217
  v_exp_f32 v218, v218
  v_cvt_pk_bf16_f32 v236, v216, v217
  v_mfma_f32_32x32x16_bf16 v[160:175], a[180:183], v[228:231], v[160:175]
  v_exp_f32 v219, v219
  v_exp_f32 v220, v220
  v_cvt_pk_bf16_f32 v237, v218, v219
  v_exp_f32 v221, v221
  v_exp_f32 v222, v222
  v_exp_f32 v223, v223
  v_cvt_pk_bf16_f32 v238, v220, v221
  v_cvt_pk_bf16_f32 v239, v222, v223
  v_mfma_f32_32x32x16_bf16 v[208:223], a[164:167], a[132:135], 0
  v_exp_f32 v192, v192
  v_exp_f32 v193, v193
  v_exp_f32 v194, v194
  v_cvt_pk_bf16_f32 v224, v192, v193
  v_exp_f32 v195, v195
  v_exp_f32 v196, v196
  v_cvt_pk_bf16_f32 v225, v194, v195
  v_exp_f32 v197, v197
  v_mfma_f32_32x32x16_bf16 v[176:191], a[176:179], v[232:235], 0
  v_exp_f32 v198, v198
  v_cvt_pk_bf16_f32 v226, v196, v197
  v_exp_f32 v199, v199
  v_exp_f32 v200, v200
  v_cvt_pk_bf16_f32 v227, v198, v199
  v_exp_f32 v201, v201
  v_exp_f32 v202, v202
  v_cvt_pk_bf16_f32 v228, v200, v201
  v_mfma_f32_32x32x16_bf16 v[176:191], a[180:183], v[236:239], v[176:191]
  s_mov_b64 exec, s[30:31]
  buffer_load_dwordx4 a[176:179], v240, s[8:11], s21 offen offset:1024 sc1
  buffer_load_dwordx4 a[180:183], v240, s[8:11], s21 offen offset:1536 sc1
  s_mov_b64 exec, -1
  s_add_u32 s21, s21, 2048
  v_exp_f32 v203, v203
  v_exp_f32 v204, v204
  v_cvt_pk_bf16_f32 v229, v202, v203
  v_exp_f32 v205, v205
  v_exp_f32 v206, v206
  v_exp_f32 v207, v207
  v_cvt_pk_bf16_f32 v230, v204, v205
  v_cvt_pk_bf16_f32 v231, v206, v207
  v_mfma_f32_32x32x16_bf16 v[192:207], a[164:167], a[136:139], 0
  s_waitcnt vmcnt(39)
  v_exp_f32 v208, v208
  v_exp_f32 v209, v209
  v_exp_f32 v210, v210
  v_cvt_pk_bf16_f32 v232, v208, v209
  v_exp_f32 v211, v211
  v_exp_f32 v212, v212
  v_cvt_pk_bf16_f32 v233, v210, v211
  v_exp_f32 v213, v213
  v_mfma_f32_32x32x16_bf16 v[64:79], a[184:187], v[224:227], v[64:79]
  v_exp_f32 v214, v214
  v_cvt_pk_bf16_f32 v234, v212, v213
  v_exp_f32 v215, v215
  v_exp_f32 v216, v216
  v_cvt_pk_bf16_f32 v235, v214, v215
  v_exp_f32 v217, v217
  v_exp_f32 v218, v218
  v_cvt_pk_bf16_f32 v236, v216, v217
  v_mfma_f32_32x32x16_bf16 v[64:79], a[188:191], v[228:231], v[64:79]
  v_exp_f32 v219, v219
  v_exp_f32 v220, v220
  v_cvt_pk_bf16_f32 v237, v218, v219
  v_exp_f32 v221, v221
  v_exp_f32 v222, v222
  v_exp_f32 v223, v223
  v_cvt_pk_bf16_f32 v238, v220, v221
  v_cvt_pk_bf16_f32 v239, v222, v223
  v_mfma_f32_32x32x16_bf16 v[208:223], a[164:167], a[140:143], 0
  v_exp_f32 v192, v192
  v_exp_f32 v193, v193
  v_exp_f32 v194, v194
  v_cvt_pk_bf16_f32 v224, v192, v193
  v_exp_f32 v195, v195
  v_exp_f32 v196, v196
  v_cvt_pk_bf16_f32 v225, v194, v195
  v_exp_f32 v197, v197
  v_mfma_f32_32x32x16_bf16 v[80:95], a[184:187], v[232:235], v[80:95]
  s_waitcnt vmcnt(3)
  s_barrier
  s_cmp_lg_u32 s16, 0
  s_cbranch_scc1 P4_S3
  s_lshl_b32 s36, s18, 7
  s_lshl_b32 s37, s17, 2
  s_add_u32 s36, s36, s37
  s_add_u32 s36, s36, 81793024
  v_mov_b32 v252, 1
  s_mov_b64 exec, 1
  buffer_store_dword v252, off, s[8:11], s36 sc1
  s_mov_b64 exec, -1
P4_S3:
  v_exp_f32 v198, v198
  v_cvt_pk_bf16_f32 v226, v196, v197
  v_exp_f32 v199, v199
  v_exp_f32 v200, v200
  v_cvt_pk_bf16_f32 v227, v198, v199
  v_exp_f32 v201, v201
  v_exp_f32 v202, v202
  v_cvt_pk_bf16_f32 v228, v200, v201
  v_mfma_f32_32x32x16_bf16 v[80:95], a[188:191], v[236:239], v[80:95]
  v_exp_f32 v203, v203
  v_exp_f32 v204, v204
  v_cvt_pk_bf16_f32 v229, v202, v203
  v_exp_f32 v205, v205
  v_exp_f32 v206, v206
  v_exp_f32 v207, v207
  v_cvt_pk_bf16_f32 v230, v204, v205
  v_cvt_pk_bf16_f32 v231, v206, v207
  v_mfma_f32_32x32x16_bf16 v[192:207], a[164:167], a[144:147], 0
  s_add_u32 m0, s26, 0
  s_add_u32 s25, s25, 32768
  buffer_load_dwordx4 v246, s[12:15], s25 offen offset:0 lds
  v_exp_f32 v208, v208
  v_exp_f32 v209, v209
  v_exp_f32 v210, v210
  v_cvt_pk_bf16_f32 v232, v208, v209
  v_exp_f32 v211, v211
  v_exp_f32 v212, v212
  v_cvt_pk_bf16_f32 v233, v210, v211
  v_exp_f32 v213, v213
  v_mfma_f32_32x32x16_bf16 v[96:111], a[184:187], v[224:227], v[96:111]
  buffer_load_dwordx4 v247, s[12:15], s25 offen offset:1024 lds
  v_exp_f32 v214, v214
  v_cvt_pk_bf16_f32 v234, v212, v213
  v_exp_f32 v215, v215
  v_exp_f32 v216, v216
  v_cvt_pk_bf16_f32 v235, v214, v215
  v_exp_f32 v217, v217
  v_exp_f32 v218, v218
  v_cvt_pk_bf16_f32 v236, v216, v217
  v_mfma_f32_32x32x16_bf16 v[96:111], a[188:191], v[228:231], v[96:111]
  buffer_load_dwordx4 v248, s[12:15], s25 offen offset:2048 lds
  v_exp_f32 v219, v219
  v_exp_f32 v220, v220
  v_cvt_pk_bf16_f32 v237, v218, v219
  v_exp_f32 v221, v221
  v_exp_f32 v222, v222
  v_exp_f32 v223, v223
  v_cvt_pk_bf16_f32 v238, v220, v221
  v_cvt_pk_bf16_f32 v239, v222, v223
  v_mfma_f32_32x32x16_bf16 v[208:223], a[164:167], a[148:151], 0
  buffer_load_dwordx4 v249, s[12:15], s25 offen offset:3072 lds
  v_exp_f32 v192, v192
  v_exp_f32 v193, v193
  v_exp_f32 v194, v194
  v_cvt_pk_bf16_f32 v224, v192, v193
  v_exp_f32 v195, v195
  v_exp_f32 v196, v196
  v_cvt_pk_bf16_f32 v225, v194, v195
  v_exp_f32 v197, v197
  v_mfma_f32_32x32x16_bf16 v[112:127], a[184:187], v[232:235], v[112:127]
  v_exp_f32 v198, v198
  v_cvt_pk_bf16_f32 v226, v196, v197
  v_exp_f32 v199, v199
  v_exp_f32 v200, v200
  v_cvt_pk_bf16_f32 v227, v198, v199
  v_exp_f32 v201, v201
  v_exp_f32 v202, v202
  v_cvt_pk_bf16_f32 v228, v200, v201
  v_mfma_f32_32x32x16_bf16 v[112:127], a[188:191], v[236:239], v[112:127]
  s_add_u32 m0, s26, 4096
  s_add_u32 s25, s25, 32768
  buffer_load_dwordx4 v246, s[12:15], s25 offen offset:0 lds
  v_exp_f32 v203, v203
  v_exp_f32 v204, v204
  v_cvt_pk_bf16_f32 v229, v202, v203
  v_exp_f32 v205, v205
  v_exp_f32 v206, v206
  v_exp_f32 v207, v207
  v_cvt_pk_bf16_f32 v230, v204, v205
  v_cvt_pk_bf16_f32 v231, v206, v207
  v_mfma_f32_32x32x16_bf16 v[192:207], a[164:167], a[152:155], 0
  buffer_load_dwordx4 v247, s[12:15], s25 offen offset:1024 lds
  v_exp_f32 v208, v208
  v_exp_f32 v209, v209
  v_exp_f32 v210, v210
  v_cvt_pk_bf16_f32 v232, v208, v209
  v_exp_f32 v211, v211
  v_exp_f32 v212, v212
  v_cvt_pk_bf16_f32 v233, v210, v211
  v_exp_f32 v213, v213
  v_mfma_f32_32x32x16_bf16 v[128:143], a[184:187], v[224:227], v[128:143]
  buffer_load_dwordx4 v248, s[12:15], s25 offen offset:2048 lds
  v_exp_f32 v214, v214
  v_cvt_pk_bf16_f32 v234, v212, v213
  v_exp_f32 v215, v215
  v_exp_f32 v216, v216
  v_cvt_pk_bf16_f32 v235, v214, v215
  v_exp_f32 v217, v217
  v_exp_f32 v218, v218
  v_cvt_pk_bf16_f32 v236, v216, v217
  v_mfma_f32_32x32x16_bf16 v[128:143], a[188:191], v[228:231], v[128:143]
  buffer_load_dwordx4 v249, s[12:15], s25 offen offset:3072 lds
  v_exp_f32 v219, v219
  v_exp_f32 v220, v220
  v_cvt_pk_bf16_f32 v237, v218, v219
  v_exp_f32 v221, v221
  v_exp_f32 v222, v222
  v_exp_f32 v223, v223
  v_cvt_pk_bf16_f32 v238, v220, v221
  v_cvt_pk_bf16_f32 v239, v222, v223
  v_mfma_f32_32x32x16_bf16 v[208:223], a[164:167], a[156:159], 0
  buffer_load_dwordx4 a[164:167], v3, s[8:11], s20 offen sc1
  s_add_u32 s20, s20, 2048
  v_exp_f32 v192, v192
  v_exp_f32 v193, v193
  v_exp_f32 v194, v194
  v_cvt_pk_bf16_f32 v224, v192, v193
  v_exp_f32 v195, v195
  v_exp_f32 v196, v196
  v_cvt_pk_bf16_f32 v225, v194, v195
  v_exp_f32 v197, v197
  v_mfma_f32_32x32x16_bf16 v[144:159], a[184:187], v[232:235], v[144:159]
  s_add_u32 m0, s26, 8192
  s_add_u32 s25, s25, 32768
  buffer_load_dwordx4 v246, s[12:15], s25 offen offset:0 lds
  v_exp_f32 v198, v198
  v_cvt_pk_bf16_f32 v226, v196, v197
  v_exp_f32 v199, v199
  v_exp_f32 v200, v200
  v_cvt_pk_bf16_f32 v227, v198, v199
  v_exp_f32 v201, v201
  v_exp_f32 v202, v202
  v_cvt_pk_bf16_f32 v228, v200, v201
  v_mfma_f32_32x32x16_bf16 v[144:159], a[188:191], v[236:239], v[144:159]
  s_waitcnt vmcnt(47)
  buffer_load_dwordx4 v247, s[12:15], s25 offen offset:1024 lds
  v_exp_f32 v203, v203
  v_exp_f32 v204, v204
  v_cvt_pk_bf16_f32 v229, v202, v203
  v_exp_f32 v205, v205
  v_exp_f32 v206, v206
  v_exp_f32 v207, v207
  v_cvt_pk_bf16_f32 v230, v204, v205
  v_cvt_pk_bf16_f32 v231, v206, v207
  v_mfma_f32_32x32x16_bf16 v[192:207], a[168:171], a[128:131], 0
  buffer_load_dwordx4 v248, s[12:15], s25 offen offset:2048 lds
  v_exp_f32 v208, v208
  v_exp_f32 v209, v209
  v_exp_f32 v210, v210
  v_cvt_pk_bf16_f32 v232, v208, v209
  v_exp_f32 v211, v211
  v_exp_f32 v212, v212
  v_cvt_pk_bf16_f32 v233, v210, v211
  v_exp_f32 v213, v213
  v_mfma_f32_32x32x16_bf16 v[160:175], a[184:187], v[224:227], v[160:175]
  buffer_load_dwordx4 v249, s[12:15], s25 offen offset:3072 lds
  v_exp_f32 v214, v214
  v_cvt_pk_bf16_f32 v234, v212, v213
  v_exp_f32 v215, v215
  v_exp_f32 v216, v216
  v_cvt_pk_bf16_f32 v235, v214, v215
  v_exp_f32 v217, v217
  v_exp_f32 v218, v218
  v_cvt_pk_bf16_f32 v236, v216, v217
  v_mfma_f32_32x32x16_bf16 v[160:175], a[188:191], v[228:231], v[160:175]
  v_exp_f32 v219, v219
  v_exp_f32 v220, v220
  v_cvt_pk_bf16_f32 v237, v218, v219
  v_exp_f32 v221, v221
  v_exp_f32 v222, v222
  v_exp_f32 v223, v223
  v_cvt_pk_bf16_f32 v238, v220, v221
  v_cvt_pk_bf16_f32 v239, v222, v223
  v_mfma_f32_32x32x16_bf16 v[208:223], a[168:171], a[132:135], 0
  s_add_u32 m0, s26, 12288
  s_add_u32 s25, s25, 32768
  buffer_load_dwordx4 v246, s[12:15], s25 offen offset:0 lds
  v_exp_f32 v192, v192
  v_exp_f32 v193, v193
  v_exp_f32 v194, v194
  v_cvt_pk_bf16_f32 v224, v192, v193
  v_exp_f32 v195, v195
  v_exp_f32 v196, v196
  v_cvt_pk_bf16_f32 v225, v194, v195
  v_exp_f32 v197, v197
  v_mfma_f32_32x32x16_bf16 v[176:191], a[184:187], v[232:235], v[176:191]
  buffer_load_dwordx4 v247, s[12:15], s25 offen offset:1024 lds
  v_exp_f32 v198, v198
  v_cvt_pk_bf16_f32 v226, v196, v197
  v_exp_f32 v199, v199
  v_exp_f32 v200, v200
  v_cvt_pk_bf16_f32 v227, v198, v199
  v_exp_f32 v201, v201
  v_exp_f32 v202, v202
  v_cvt_pk_bf16_f32 v228, v200, v201
  v_mfma_f32_32x32x16_bf16 v[176:191], a[188:191], v[236:239], v[176:191]
  s_mov_b64 exec, s[30:31]
  buffer_load_dwordx4 a[184:187], v240, s[8:11], s21 offen offset:1024 sc1
  buffer_load_dwordx4 a[188:191], v240, s[8:11], s21 offen offset:1536 sc1
  s_mov_b64 exec, -1
  s_add_u32 s21, s21, 2048
  buffer_load_dwordx4 v248, s[12:15], s25 offen offset:2048 lds
  v_exp_f32 v203, v203
  v_exp_f32 v204, v204
  v_cvt_pk_bf16_f32 v229, v202, v203
  v_exp_f32 v205, v205
  v_exp_f32 v206, v206
  v_exp_f32 v207, v207
  v_cvt_pk_bf16_f32 v230, v204, v205
  v_cvt_pk_bf16_f32 v231, v206, v207
  v_mfma_f32_32x32x16_bf16 v[192:207], a[168:171], a[136:139], 0
  s_waitcnt vmcnt(52)
  buffer_load_dwordx4 v249, s[12:15], s25 offen offset:3072 lds
  v_exp_f32 v208, v208
  v_exp_f32 v209, v209
  v_exp_f32 v210, v210
  v_cvt_pk_bf16_f32 v232, v208, v209
  v_exp_f32 v211, v211
  v_exp_f32 v212, v212
  v_cvt_pk_bf16_f32 v233, v210, v211
  v_exp_f32 v213, v213
  v_mfma_f32_32x32x16_bf16 v[64:79], a[192:195], v[224:227], v[64:79]
  v_exp_f32 v214, v214
  v_cvt_pk_bf16_f32 v234, v212, v213
  v_exp_f32 v215, v215
  v_exp_f32 v216, v216
  v_cvt_pk_bf16_f32 v235, v214, v215
  v_exp_f32 v217, v217
  v_exp_f32 v218, v218
  v_cvt_pk_bf16_f32 v236, v216, v217
  v_mfma_f32_32x32x16_bf16 v[64:79], a[196:199], v[228:231], v[64:79]
  s_cmp_lg_u32 s16, 0
  s_cbranch_scc1 P4_L3
  s_lshr_b32 s36, s17, 1
  s_sub_u32 s37, 15, s36
  s_min_u32 s36, s36, s37
  v_mov_b32 v254, s36
  v_mov_b32 v255, s18
  v_cmp_gt_u32 vcc, 32, v250
  s_mov_b32 s36, 81793024
  v_and_b32 v253, 31, v250
  v_lshlrev_b32 v253, 2, v253
  v_cndmask_b32 v254, v255, v254, vcc
  v_lshl_add_u32 v253, v254, 7, v253
  buffer_load_dword v252, v253, s[8:11], s36 offen sc1
P4_L3:
  v_exp_f32 v219, v219
  v_exp_f32 v220, v220
  v_cvt_pk_bf16_f32 v237, v218, v219
  v_exp_f32 v221, v221
  v_exp_f32 v222, v222
  v_exp_f32 v223, v223
  v_cvt_pk_bf16_f32 v238, v220, v221
  v_cvt_pk_bf16_f32 v239, v222, v223
  v_mfma_f32_32x32x16_bf16 v[208:223], a[168:171], a[140:143], 0
  v_exp_f32 v192, v192
  v_exp_f32 v193, v193
  v_exp_f32 v194, v194
  v_cvt_pk_bf16_f32 v224, v192, v193
  v_exp_f32 v195, v195
  v_exp_f32 v196, v196
  v_cvt_pk_bf16_f32 v225, v194, v195
  v_exp_f32 v197, v197
  v_mfma_f32_32x32x16_bf16 v[80:95], a[192:195], v[232:235], v[80:95]
  v_exp_f32 v198, v198
  v_cvt_pk_bf16_f32 v226, v196, v197
  v_exp_f32 v199, v199
  v_exp_f32 v200, v200
  v_cvt_pk_bf16_f32 v227, v198, v199
  v_exp_f32 v201, v201
  v_exp_f32 v202, v202
  v_cvt_pk_bf16_f32 v228, v200, v201
  v_mfma_f32_32x32x16_bf16 v[80:95], a[196:199], v[236:239], v[80:95]
  v_exp_f32 v203, v203
  v_exp_f32 v204, v204
  v_cvt_pk_bf16_f32 v229, v202, v203
  v_exp_f32 v205, v205
  v_exp_f32 v206, v206
  v_exp_f32 v207, v207
  v_cvt_pk_bf16_f32 v230, v204, v205
  v_cvt_pk_bf16_f32 v231, v206, v207
  v_mfma_f32_32x32x16_bf16 v[192:207], a[168:171], a[144:147], 0
  v_exp_f32 v208, v208
  v_exp_f32 v209, v209
  v_exp_f32 v210, v210
  v_cvt_pk_bf16_f32 v232, v208, v209
  v_exp_f32 v211, v211
  v_exp_f32 v212, v212
  v_cvt_pk_bf16_f32 v233, v210, v211
  v_exp_f32 v213, v213
  v_mfma_f32_32x32x16_bf16 v[96:111], a[192:195], v[224:227], v[96:111]
  v_exp_f32 v214, v214
  v_cvt_pk_bf16_f32 v234, v212, v213
  v_exp_f32 v215, v215
  v_exp_f32 v216, v216
  v_cvt_pk_bf16_f32 v235, v214, v215
  v_exp_f32 v217, v217
  v_exp_f32 v218, v218
  v_cvt_pk_bf16_f32 v236, v216, v217
  v_mfma_f32_32x32x16_bf16 v[96:111], a[196:199], v[228:231], v[96:111]
  v_exp_f32 v219, v219
  v_exp_f32 v220, v220
  v_cvt_pk_bf16_f32 v237, v218, v219
  v_exp_f32 v221, v221
  v_exp_f32 v222, v222
  v_exp_f32 v223, v223
  v_cvt_pk_bf16_f32 v238, v220, v221
  v_cvt_pk_bf16_f32 v239, v222, v223
  v_mfma_f32_32x32x16_bf16 v[208:223], a[168:171], a[148:151], 0
  v_exp_f32 v192, v192
  v_exp_f32 v193, v193
  v_exp_f32 v194, v194
  v_cvt_pk_bf16_f32 v224, v192, v193
  v_exp_f32 v195, v195
  v_exp_f32 v196, v196
  v_cvt_pk_bf16_f32 v225, v194, v195
  v_exp_f32 v197, v197
  v_mfma_f32_32x32x16_bf16 v[112:127], a[192:195], v[232:235], v[112:127]
  v_exp_f32 v198, v198
  v_cvt_pk_bf16_f32 v226, v196, v197
  v_exp_f32 v199, v199
  v_exp_f32 v200, v200
  v_cvt_pk_bf16_f32 v227, v198, v199
  v_exp_f32 v201, v201
  v_exp_f32 v202, v202
  v_cvt_pk_bf16_f32 v228, v200, v201
  v_mfma_f32_32x32x16_bf16 v[112:127], a[196:199], v[236:239], v[112:127]
  v_exp_f32 v203, v203
  v_exp_f32 v204, v204
  v_cvt_pk_bf16_f32 v229, v202, v203
  v_exp_f32 v205, v205
  v_exp_f32 v206, v206
  v_exp_f32 v207, v207
  v_cvt_pk_bf16_f32 v230, v204, v205
  v_cvt_pk_bf16_f32 v231, v206, v207
  v_mfma_f32_32x32x16_bf16 v[192:207], a[168:171], a[152:155], 0
  v_exp_f32 v208, v208
  v_exp_f32 v209, v209
  v_exp_f32 v210, v210
  v_cvt_pk_bf16_f32 v232, v208, v209
  v_exp_f32 v211, v211
  v_exp_f32 v212, v212
  v_cvt_pk_bf16_f32 v233, v210, v211
  v_exp_f32 v213, v213
  v_mfma_f32_32x32x16_bf16 v[128:143], a[192:195], v[224:227], v[128:143]
  s_cmp_lg_u32 s16, 0
  s_cbranch_scc1 P4_C3
  s_mov_b32 s37, 0x100000
  s_waitcnt vmcnt(0)
P4_C3L:
  v_cmp_ne_u32 vcc, 1, v252
  s_nop 0
  s_cbranch_vccz P4_C3
  s_sleep 4
  buffer_load_dword v252, v253, s[8:11], s36 offen sc1
  s_waitcnt vmcnt(0)
  s_sub_u32 s37, s37, 1
  s_cmp_lg_u32 s37, 0
  s_cbranch_scc1 P4_C3L
P4_C3:
  s_barrier
  v_exp_f32 v214, v214
  v_cvt_pk_bf16_f32 v234, v212, v213
  v_exp_f32 v215, v215
  v_exp_f32 v216, v216
  v_cvt_pk_bf16_f32 v235, v214, v215
  v_exp_f32 v217, v217
  v_exp_f32 v218, v218
  v_cvt_pk_bf16_f32 v236, v216, v217
  v_mfma_f32_32x32x16_bf16 v[128:143], a[196:199], v[228:231], v[128:143]
  buffer_load_dwordx4 a[64:67], v3, s[8:11], s24 offen offset:0 sc1
  v_exp_f32 v219, v219
  v_exp_f32 v220, v220
  v_cvt_pk_bf16_f32 v237, v218, v219
  v_exp_f32 v221, v221
  v_exp_f32 v222, v222
  v_exp_f32 v223, v223
  v_cvt_pk_bf16_f32 v238, v220, v221
  v_cvt_pk_bf16_f32 v239, v222, v223
  v_mfma_f32_32x32x16_bf16 v[208:223], a[168:171], a[156:159], 0
  buffer_load_dwordx4 a[168:171], v3, s[8:11], s20 offen sc1
  s_add_u32 s20, s20, 2048
  buffer_load_dwordx4 a[208:211], v3, s[8:11], s39 offen offset:0 sc1
  v_exp_f32 v192, v192
  v_exp_f32 v193, v193
  v_exp_f32 v194, v194
  v_cvt_pk_bf16_f32 v224, v192, v193
  v_exp_f32 v195, v195
  v_exp_f32 v196, v196
  v_cvt_pk_bf16_f32 v225, v194, v195
  v_exp_f32 v197, v197
  v_mfma_f32_32x32x16_bf16 v[144:159], a[192:195], v[232:235], v[144:159]
  v_exp_f32 v198, v198
  v_cvt_pk_bf16_f32 v226, v196, v197
  v_exp_f32 v199, v199
  v_exp_f32 v200, v200
  v_cvt_pk_bf16_f32 v227, v198, v199
  v_exp_f32 v201, v201
  v_exp_f32 v202, v202
  v_cvt_pk_bf16_f32 v228, v200, v201
  v_mfma_f32_32x32x16_bf16 v[144:159], a[196:199], v[236:239], v[144:159]
  s_waitcnt vmcnt(54)
  buffer_load_dwordx4 a[212:215], v3, s[8:11], s39 offen offset:1024 sc1
  v_exp_f32 v203, v203
  v_exp_f32 v204, v204
  v_cvt_pk_bf16_f32 v229, v202, v203
  v_exp_f32 v205, v205
  v_exp_f32 v206, v206
  v_exp_f32 v207, v207
  v_cvt_pk_bf16_f32 v230, v204, v205
  v_cvt_pk_bf16_f32 v231, v206, v207
  v_mfma_f32_32x32x16_bf16 v[192:207], a[172:175], a[128:131], 0
  v_exp_f32 v208, v208
  v_exp_f32 v209, v209
  v_exp_f32 v210, v210
  v_cvt_pk_bf16_f32 v232, v208, v209
  v_exp_f32 v211, v211
  v_exp_f32 v212, v212
  v_cvt_pk_bf16_f32 v233, v210, v211
  v_exp_f32 v213, v213
  v_mfma_f32_32x32x16_bf16 v[160:175], a[192:195], v[224:227], v[160:175]
  buffer_load_dwordx4 a[68:71], v243, s[8:11], s24 offen offset:0 sc1
  v_exp_f32 v214, v214
  v_cvt_pk_bf16_f32 v234, v212, v213
  v_exp_f32 v215, v215
  v_exp_f32 v216, v216
  v_cvt_pk_bf16_f32 v235, v214, v215
  v_exp_f32 v217, v217
  v_exp_f32 v218, v218
  v_cvt_pk_bf16_f32 v236, v216, v217
  v_mfma_f32_32x32x16_bf16 v[160:175], a[196:199], v[228:231], v[160:175]
  v_exp_f32 v219, v219
  v_exp_f32 v220, v220
  v_cvt_pk_bf16_f32 v237, v218, v219
  v_exp_f32 v221, v221
  v_exp_f32 v222, v222
  v_exp_f32 v223, v223
  v_cvt_pk_bf16_f32 v238, v220, v221
  v_cvt_pk_bf16_f32 v239, v222, v223
  v_mfma_f32_32x32x16_bf16 v[208:223], a[172:175], a[132:135], 0
  buffer_load_dwordx4 a[72:75], v3, s[8:11], s24 offen offset:1024 sc1
  v_exp_f32 v192, v192
  v_exp_f32 v193, v193
  v_exp_f32 v194, v194
  v_cvt_pk_bf16_f32 v224, v192, v193
  v_exp_f32 v195, v195
  v_exp_f32 v196, v196
  v_cvt_pk_bf16_f32 v225, v194, v195
  v_exp_f32 v197, v197
  v_mfma_f32_32x32x16_bf16 v[176:191], a[192:195], v[232:235], v[176:191]
  v_exp_f32 v198, v198
  v_cvt_pk_bf16_f32 v226, v196, v197
  v_exp_f32 v199, v199
  v_exp_f32 v200, v200
  v_cvt_pk_bf16_f32 v227, v198, v199
  v_exp_f32 v201, v201
  v_exp_f32 v202, v202
  v_cvt_pk_bf16_f32 v228, v200, v201
  v_mfma_f32_32x32x16_bf16 v[176:191], a[196:199], v[236:239], v[176:191]
  s_mov_b64 exec, s[30:31]
  buffer_load_dwordx4 a[192:195], v240, s[8:11], s21 offen offset:1024 sc1
  buffer_load_dwordx4 a[196:199], v240, s[8:11], s21 offen offset:1536 sc1
  s_mov_b64 exec, -1
  s_add_u32 s21, s21, 2048
  buffer_load_dwordx4 a[216:219], v3, s[8:11], s39 offen offset:2048 sc1
  v_exp_f32 v203, v203
  v_exp_f32 v204, v204
  v_cvt_pk_bf16_f32 v229, v202, v203
  v_exp_f32 v205, v205
  v_exp_f32 v206, v206
  v_exp_f32 v207, v207
  v_cvt_pk_bf16_f32 v230, v204, v205
  v_cvt_pk_bf16_f32 v231, v206, v207
  v_mfma_f32_32x32x16_bf16 v[192:207], a[172:175], a[136:139], 0
  s_waitcnt vmcnt(56)
  buffer_load_dwordx4 a[220:223], v3, s[8:11], s39 offen offset:3072 sc1
  v_exp_f32 v208, v208
  v_exp_f32 v209, v209
  v_exp_f32 v210, v210
  v_cvt_pk_bf16_f32 v232, v208, v209
  v_exp_f32 v211, v211
  v_exp_f32 v212, v212
  v_cvt_pk_bf16_f32 v233, v210, v211
  v_exp_f32 v213, v213
  v_mfma_f32_32x32x16_bf16 v[64:79], a[200:203], v[224:227], v[64:79]
  v_exp_f32 v214, v214
  v_cvt_pk_bf16_f32 v234, v212, v213
  v_exp_f32 v215, v215
  v_exp_f32 v216, v216
  v_cvt_pk_bf16_f32 v235, v214, v215
  v_exp_f32 v217, v217
  v_exp_f32 v218, v218
  v_cvt_pk_bf16_f32 v236, v216, v217
  v_mfma_f32_32x32x16_bf16 v[64:79], a[204:207], v[228:231], v[64:79]
  buffer_load_dwordx4 a[76:79], v243, s[8:11], s24 offen offset:1024 sc1
  s_add_u32 s39, s39, 4096
  v_exp_f32 v219, v219
  v_exp_f32 v220, v220
  v_cvt_pk_bf16_f32 v237, v218, v219
  v_exp_f32 v221, v221
  v_exp_f32 v222, v222
  v_exp_f32 v223, v223
  v_cvt_pk_bf16_f32 v238, v220, v221
  v_cvt_pk_bf16_f32 v239, v222, v223
  v_mfma_f32_32x32x16_bf16 v[208:223], a[172:175], a[140:143], 0
  v_exp_f32 v192, v192
  v_exp_f32 v193, v193
  v_exp_f32 v194, v194
  v_cvt_pk_bf16_f32 v224, v192, v193
  v_exp_f32 v195, v195
  v_exp_f32 v196, v196
  v_cvt_pk_bf16_f32 v225, v194, v195
  v_exp_f32 v197, v197
  v_mfma_f32_32x32x16_bf16 v[80:95], a[200:203], v[232:235], v[80:95]
  buffer_load_dwordx4 a[80:83], v3, s[8:11], s24 offen offset:2048 sc1
  v_exp_f32 v198, v198
  v_cvt_pk_bf16_f32 v226, v196, v197
  v_exp_f32 v199, v199
  v_exp_f32 v200, v200
  v_cvt_pk_bf16_f32 v227, v198, v199
  v_exp_f32 v201, v201
  v_exp_f32 v202, v202
  v_cvt_pk_bf16_f32 v228, v200, v201
  v_mfma_f32_32x32x16_bf16 v[80:95], a[204:207], v[236:239], v[80:95]
  v_exp_f32 v203, v203
  v_exp_f32 v204, v204
  v_cvt_pk_bf16_f32 v229, v202, v203
  v_exp_f32 v205, v205
  v_exp_f32 v206, v206
  v_exp_f32 v207, v207
  v_cvt_pk_bf16_f32 v230, v204, v205
  v_cvt_pk_bf16_f32 v231, v206, v207
  v_mfma_f32_32x32x16_bf16 v[192:207], a[172:175], a[144:147], 0
  buffer_load_dwordx4 a[224:227], v3, s[8:11], s39 offen offset:0 sc1
  v_exp_f32 v208, v208
  v_exp_f32 v209, v209
  v_exp_f32 v210, v210
  v_cvt_pk_bf16_f32 v232, v208, v209
  v_exp_f32 v211, v211
  v_exp_f32 v212, v212
  v_cvt_pk_bf16_f32 v233, v210, v211
  v_exp_f32 v213, v213
  v_mfma_f32_32x32x16_bf16 v[96:111], a[200:203], v[224:227], v[96:111]
  v_exp_f32 v214, v214
  v_cvt_pk_bf16_f32 v234, v212, v213
  v_exp_f32 v215, v215
  v_exp_f32 v216, v216
  v_cvt_pk_bf16_f32 v235, v214, v215
  v_exp_f32 v217, v217
  v_exp_f32 v218, v218
  v_cvt_pk_bf16_f32 v236, v216, v217
  v_mfma_f32_32x32x16_bf16 v[96:111], a[204:207], v[228:231], v[96:111]
  buffer_load_dwordx4 a[228:231], v3, s[8:11], s39 offen offset:1024 sc1
  v_exp_f32 v219, v219
  v_exp_f32 v220, v220
  v_cvt_pk_bf16_f32 v237, v218, v219
  v_exp_f32 v221, v221
  v_exp_f32 v222, v222
  v_exp_f32 v223, v223
  v_cvt_pk_bf16_f32 v238, v220, v221
  v_cvt_pk_bf16_f32 v239, v222, v223
  v_mfma_f32_32x32x16_bf16 v[208:223], a[172:175], a[148:151], 0
  buffer_load_dwordx4 a[84:87], v243, s[8:11], s24 offen offset:2048 sc1
  v_exp_f32 v192, v192
  v_exp_f32 v193, v193
  v_exp_f32 v194, v194
  v_cvt_pk_bf16_f32 v224, v192, v193
  v_exp_f32 v195, v195
  v_exp_f32 v196, v196
  v_cvt_pk_bf16_f32 v225, v194, v195
  v_exp_f32 v197, v197
  v_mfma_f32_32x32x16_bf16 v[112:127], a[200:203], v[232:235], v[112:127]
  v_exp_f32 v198, v198
  v_cvt_pk_bf16_f32 v226, v196, v197
  v_exp_f32 v199, v199
  v_exp_f32 v200, v200
  v_cvt_pk_bf16_f32 v227, v198, v199
  v_exp_f32 v201, v201
  v_exp_f32 v202, v202
  v_cvt_pk_bf16_f32 v228, v200, v201
  v_mfma_f32_32x32x16_bf16 v[112:127], a[204:207], v[236:239], v[112:127]
  buffer_load_dwordx4 a[88:91], v3, s[8:11], s24 offen offset:3072 sc1
  v_exp_f32 v203, v203
  v_exp_f32 v204, v204
  v_cvt_pk_bf16_f32 v229, v202, v203
  v_exp_f32 v205, v205
  v_exp_f32 v206, v206
  v_exp_f32 v207, v207
  v_cvt_pk_bf16_f32 v230, v204, v205
  v_cvt_pk_bf16_f32 v231, v206, v207
  v_mfma_f32_32x32x16_bf16 v[192:207], a[172:175], a[152:155], 0
  v_exp_f32 v208, v208
  v_exp_f32 v209, v209
  v_exp_f32 v210, v210
  v_cvt_pk_bf16_f32 v232, v208, v209
  v_exp_f32 v211, v211
  v_exp_f32 v212, v212
  v_cvt_pk_bf16_f32 v233, v210, v211
  v_exp_f32 v213, v213
  v_mfma_f32_32x32x16_bf16 v[128:143], a[200:203], v[224:227], v[128:143]
  buffer_load_dwordx4 a[232:235], v3, s[8:11], s39 offen offset:2048 sc1
  v_exp_f32 v214, v214
  v_cvt_pk_bf16_f32 v234, v212, v213
  v_exp_f32 v215, v215
  v_exp_f32 v216, v216
  v_cvt_pk_bf16_f32 v235, v214, v215
  v_exp_f32 v217, v217
  v_exp_f32 v218, v218
  v_cvt_pk_bf16_f32 v236, v216, v217
  v_mfma_f32_32x32x16_bf16 v[128:143], a[204:207], v[228:231], v[128:143]
  v_exp_f32 v219, v219
  v_exp_f32 v220, v220
  v_cvt_pk_bf16_f32 v237, v218, v219
  v_exp_f32 v221, v221
  v_exp_f32 v222, v222
  v_exp_f32 v223, v223
  v_cvt_pk_bf16_f32 v238, v220, v221
  v_cvt_pk_bf16_f32 v239, v222, v223
  v_mfma_f32_32x32x16_bf16 v[208:223], a[172:175], a[156:159], 0
  buffer_load_dwordx4 a[172:175], v3, s[8:11], s20 offen sc1
  s_add_u32 s20, s20, 2048
  buffer_load_dwordx4 a[236:239], v3, s[8:11], s39 offen offset:3072 sc1
  v_exp_f32 v192, v192
  v_exp_f32 v193, v193
  v_exp_f32 v194, v194
  v_cvt_pk_bf16_f32 v224, v192, v193
  v_exp_f32 v195, v195
  v_exp_f32 v196, v196
  v_cvt_pk_bf16_f32 v225, v194, v195
  v_exp_f32 v197, v197
  v_mfma_f32_32x32x16_bf16 v[144:159], a[200:203], v[232:235], v[144:159]
  v_exp_f32 v198, v198
  v_cvt_pk_bf16_f32 v226, v196, v197
  v_exp_f32 v199, v199
  v_exp_f32 v200, v200
  v_cvt_pk_bf16_f32 v227, v198, v199
  v_exp_f32 v201, v201
  v_exp_f32 v202, v202
  v_cvt_pk_bf16_f32 v228, v200, v201
  v_mfma_f32_32x32x16_bf16 v[144:159], a[204:207], v[236:239], v[144:159]
  s_waitcnt vmcnt(40)
  buffer_load_dwordx4 a[92:95], v243, s[8:11], s24 offen offset:3072 sc1
  s_add_u32 s39, s39, 4096
  s_add_u32 s24, s24, 4096
  v_exp_f32 v203, v203
  v_exp_f32 v204, v204
  v_cvt_pk_bf16_f32 v229, v202, v203
  v_exp_f32 v205, v205
  v_exp_f32 v206, v206
  v_exp_f32 v207, v207
  v_cvt_pk_bf16_f32 v230, v204, v205
  v_cvt_pk_bf16_f32 v231, v206, v207
  v_mfma_f32_32x32x16_bf16 v[192:207], a[160:163], a[128:131], 0
  v_exp_f32 v208, v208
  v_exp_f32 v209, v209
  v_exp_f32 v210, v210
  v_cvt_pk_bf16_f32 v232, v208, v209
  v_exp_f32 v211, v211
  v_exp_f32 v212, v212
  v_cvt_pk_bf16_f32 v233, v210, v211
  v_exp_f32 v213, v213
  v_mfma_f32_32x32x16_bf16 v[160:175], a[200:203], v[224:227], v[160:175]
  v_exp_f32 v214, v214
  v_cvt_pk_bf16_f32 v234, v212, v213
  v_exp_f32 v215, v215
  v_exp_f32 v216, v216
  v_cvt_pk_bf16_f32 v235, v214, v215
  v_exp_f32 v217, v217
  v_exp_f32 v218, v218
  v_cvt_pk_bf16_f32 v236, v216, v217
  v_mfma_f32_32x32x16_bf16 v[160:175], a[204:207], v[228:231], v[160:175]
  v_exp_f32 v219, v219
  v_exp_f32 v220, v220
  v_cvt_pk_bf16_f32 v237, v218, v219
  v_exp_f32 v221, v221
  v_exp_f32 v222, v222
  v_exp_f32 v223, v223
  v_cvt_pk_bf16_f32 v238, v220, v221
  v_cvt_pk_bf16_f32 v239, v222, v223
  s_mov_b32 s19, 1
.p2align 4
P4_L:
  v_mfma_f32_32x32x16_bf16 v[208:223], a[160:163], a[132:135], 0
  s_waitcnt vmcnt(13)
  v_exp_f32 v192, v192
  v_exp_f32 v193, v193
  v_exp_f32 v194, v194
  v_cvt_pk_bf16_f32 v224, v192, v193
  v_mfma_f32_32x32x16_bf16 a[0:15], a[208:211], a[64:67], a[0:15]
  buffer_load_dwordx4 a[96:99], v3, s[8:11], s24 offen offset:0 sc1
  buffer_load_dwordx4 a[240:243], v3, s[8:11], s39 offen offset:0 sc1
  buffer_load_dwordx4 a[244:247], v3, s[8:11], s39 offen offset:1024 sc1
  buffer_load_dwordx4 a[100:103], v243, s[8:11], s24 offen offset:0 sc1
  v_exp_f32 v195, v195
  v_exp_f32 v196, v196
  v_cvt_pk_bf16_f32 v225, v194, v195
  v_exp_f32 v197, v197
  v_exp_f32 v198, v198
  v_mfma_f32_32x32x16_bf16 v[176:191], a[200:203], v[232:235], v[176:191]
  v_cvt_pk_bf16_f32 v226, v196, v197
  v_exp_f32 v199, v199
  v_exp_f32 v200, v200
  v_cvt_pk_bf16_f32 v227, v198, v199
  v_exp_f32 v201, v201
  v_mfma_f32_32x32x16_bf16 a[32:47], a[212:215], a[64:67], a[32:47]
  v_exp_f32 v202, v202
  v_cvt_pk_bf16_f32 v228, v200, v201
  v_exp_f32 v203, v203
  v_exp_f32 v204, v204
  v_cvt_pk_bf16_f32 v229, v202, v203
  v_mfma_f32_32x32x16_bf16 v[176:191], a[204:207], v[236:239], v[176:191]
  s_mov_b64 exec, s[30:31]
  buffer_load_dwordx4 a[200:203], v240, s[8:11], s21 offen offset:1024 sc1
  buffer_load_dwordx4 a[204:207], v240, s[8:11], s21 offen offset:1536 sc1
  s_mov_b64 exec, -1
  s_add_u32 s21, s21, 2048
  v_exp_f32 v205, v205
  v_exp_f32 v206, v206
  v_exp_f32 v207, v207
  v_cvt_pk_bf16_f32 v230, v204, v205
  v_cvt_pk_bf16_f32 v231, v206, v207
  v_mfma_f32_32x32x16_bf16 v[192:207], a[160:163], a[136:139], 0
  v_exp_f32 v208, v208
  v_exp_f32 v209, v209
  v_exp_f32 v210, v210
  v_cvt_pk_bf16_f32 v232, v208, v209
  v_mfma_f32_32x32x16_bf16 a[16:31], a[208:211], a[68:71], a[16:31]
  v_exp_f32 v211, v211
  v_exp_f32 v212, v212
  v_cvt_pk_bf16_f32 v233, v210, v211
  v_exp_f32 v213, v213
  v_mfma_f32_32x32x16_bf16 v[64:79], a[176:179], v[224:227], v[64:79]
  v_exp_f32 v214, v214
  v_cvt_pk_bf16_f32 v234, v212, v213
  v_exp_f32 v215, v215
  v_mfma_f32_32x32x16_bf16 a[48:63], a[212:215], a[68:71], a[48:63]
  v_exp_f32 v216, v216
  v_cvt_pk_bf16_f32 v235, v214, v215
  v_exp_f32 v217, v217
  v_exp_f32 v218, v218
  v_cvt_pk_bf16_f32 v236, v216, v217
  v_mfma_f32_32x32x16_bf16 v[64:79], a[180:183], v[228:231], v[64:79]
  s_waitcnt vmcnt(15)
  v_exp_f32 v219, v219
  v_exp_f32 v220, v220
  v_cvt_pk_bf16_f32 v237, v218, v219
  v_exp_f32 v221, v221
  v_mfma_f32_32x32x16_bf16 a[0:15], a[216:219], a[72:75], a[0:15]
  buffer_load_dwordx4 a[64:67], v3, s[8:11], s24 offen offset:1024 sc1
  buffer_load_dwordx4 a[208:211], v3, s[8:11], s39 offen offset:2048 sc1
  buffer_load_dwordx4 a[212:215], v3, s[8:11], s39 offen offset:3072 sc1
  buffer_load_dwordx4 a[68:71], v243, s[8:11], s24 offen offset:1024 sc1
  v_exp_f32 v222, v222
  v_exp_f32 v223, v223
  v_cvt_pk_bf16_f32 v238, v220, v221
  v_cvt_pk_bf16_f32 v239, v222, v223
  v_mfma_f32_32x32x16_bf16 v[208:223], a[160:163], a[140:143], 0
  s_add_u32 s39, s39, 4096
  v_exp_f32 v192, v192
  v_exp_f32 v193, v193
  v_exp_f32 v194, v194
  v_cvt_pk_bf16_f32 v224, v192, v193
  v_mfma_f32_32x32x16_bf16 a[32:47], a[220:223], a[72:75], a[32:47]
  v_exp_f32 v195, v195
  v_exp_f32 v196, v196
  v_cvt_pk_bf16_f32 v225, v194, v195
  v_exp_f32 v197, v197
  v_exp_f32 v198, v198
  v_mfma_f32_32x32x16_bf16 v[80:95], a[176:179], v[232:235], v[80:95]
  v_cvt_pk_bf16_f32 v226, v196, v197
  v_exp_f32 v199, v199
  v_exp_f32 v200, v200
  v_cvt_pk_bf16_f32 v227, v198, v199
  v_exp_f32 v201, v201
  v_mfma_f32_32x32x16_bf16 a[16:31], a[216:219], a[76:79], a[16:31]
  v_exp_f32 v202, v202
  v_cvt_pk_bf16_f32 v228, v200, v201
  v_exp_f32 v203, v203
  v_exp_f32 v204, v204
  v_cvt_pk_bf16_f32 v229, v202, v203
  v_mfma_f32_32x32x16_bf16 v[80:95], a[180:183], v[236:239], v[80:95]
  v_exp_f32 v205, v205
  v_exp_f32 v206, v206
  v_exp_f32 v207, v207
  v_cvt_pk_bf16_f32 v230, v204, v205
  v_cvt_pk_bf16_f32 v231, v206, v207
  v_mfma_f32_32x32x16_bf16 v[192:207], a[160:163], a[144:147], 0
  v_exp_f32 v208, v208
  v_exp_f32 v209, v209
  v_exp_f32 v210, v210
  v_cvt_pk_bf16_f32 v232, v208, v209
  v_mfma_f32_32x32x16_bf16 a[48:63], a[220:223], a[76:79], a[48:63]
  v_exp_f32 v211, v211
  v_exp_f32 v212, v212
  v_cvt_pk_bf16_f32 v233, v210, v211
  v_exp_f32 v213, v213
  v_mfma_f32_32x32x16_bf16 v[96:111], a[176:179], v[224:227], v[96:111]
  s_waitcnt vmcnt(15)
  v_exp_f32 v214, v214
  v_cvt_pk_bf16_f32 v234, v212, v213
  v_exp_f32 v215, v215
  v_mfma_f32_32x32x16_bf16 a[0:15], a[224:227], a[80:83], a[0:15]
  buffer_load_dwordx4 a[72:75], v3, s[8:11], s24 offen offset:2048 sc1
  buffer_load_dwordx4 a[216:219], v3, s[8:11], s39 offen offset:0 sc1
  buffer_load_dwordx4 a[220:223], v3, s[8:11], s39 offen offset:1024 sc1
  buffer_load_dwordx4 a[76:79], v243, s[8:11], s24 offen offset:2048 sc1
  v_exp_f32 v216, v216
  v_cvt_pk_bf16_f32 v235, v214, v215
  v_exp_f32 v217, v217
  v_exp_f32 v218, v218
  v_cvt_pk_bf16_f32 v236, v216, v217
  v_mfma_f32_32x32x16_bf16 v[96:111], a[180:183], v[228:231], v[96:111]
  v_exp_f32 v219, v219
  v_exp_f32 v220, v220
  v_cvt_pk_bf16_f32 v237, v218, v219
  v_exp_f32 v221, v221
  v_mfma_f32_32x32x16_bf16 a[32:47], a[228:231], a[80:83], a[32:47]
  v_exp_f32 v222, v222
  v_exp_f32 v223, v223
  v_cvt_pk_bf16_f32 v238, v220, v221
  v_cvt_pk_bf16_f32 v239, v222, v223
  v_mfma_f32_32x32x16_bf16 v[208:223], a[160:163], a[148:151], 0
  v_exp_f32 v192, v192
  v_exp_f32 v193, v193
  v_exp_f32 v194, v194
  v_cvt_pk_bf16_f32 v224, v192, v193
  v_mfma_f32_32x32x16_bf16 a[16:31], a[224:227], a[84:87], a[16:31]
  v_exp_f32 v195, v195
  v_exp_f32 v196, v196
  v_cvt_pk_bf16_f32 v225, v194, v195
  v_exp_f32 v197, v197
  v_exp_f32 v198, v198
  v_mfma_f32_32x32x16_bf16 v[112:127], a[176:179], v[232:235], v[112:127]
  v_cvt_pk_bf16_f32 v226, v196, v197
  v_exp_f32 v199, v199
  v_exp_f32 v200, v200
  v_cvt_pk_bf16_f32 v227, v198, v199
  v_exp_f32 v201, v201
  v_mfma_f32_32x32x16_bf16 a[48:63], a[228:231], a[84:87], a[48:63]
  v_exp_f32 v202, v202
  v_cvt_pk_bf16_f32 v228, v200, v201
  v_exp_f32 v203, v203
  v_exp_f32 v204, v204
  v_cvt_pk_bf16_f32 v229, v202, v203
  v_mfma_f32_32x32x16_bf16 v[112:127], a[180:183], v[236:239], v[112:127]
  v_exp_f32 v205, v205
  v_exp_f32 v206, v206
  v_exp_f32 v207, v207
  v_cvt_pk_bf16_f32 v230, v204, v205
  v_cvt_pk_bf16_f32 v231, v206, v207
  v_mfma_f32_32x32x16_bf16 v[192:207], a[160:163], a[152:155], 0
  s_waitcnt vmcnt(14)
  v_exp_f32 v208, v208
  v_exp_f32 v209, v209
  v_exp_f32 v210, v210
  v_cvt_pk_bf16_f32 v232, v208, v209
  v_mfma_f32_32x32x16_bf16 a[0:15], a[232:235], a[88:91], a[0:15]
  buffer_load_dwordx4 a[80:83], v3, s[8:11], s24 offen offset:3072 sc1
  buffer_load_dwordx4 a[224:227], v3, s[8:11], s39 offen offset:2048 sc1
  buffer_load_dwordx4 a[228:231], v3, s[8:11], s39 offen offset:3072 sc1
  buffer_load_dwordx4 a[84:87], v243, s[8:11], s24 offen offset:3072 sc1
  v_exp_f32 v211, v211
  v_exp_f32 v212, v212
  v_cvt_pk_bf16_f32 v233, v210, v211
  v_exp_f32 v213, v213
  v_mfma_f32_32x32x16_bf16 v[128:143], a[176:179], v[224:227], v[128:143]
  s_add_u32 s39, s39, 4096
  v_exp_f32 v214, v214
  v_cvt_pk_bf16_f32 v234, v212, v213
  v_exp_f32 v215, v215
  v_mfma_f32_32x32x16_bf16 a[32:47], a[236:239], a[88:91], a[32:47]
  s_add_u32 s24, s24, 4096
  v_exp_f32 v216, v216
  v_cvt_pk_bf16_f32 v235, v214, v215
  v_exp_f32 v217, v217
  v_exp_f32 v218, v218
  v_cvt_pk_bf16_f32 v236, v216, v217
  v_mfma_f32_32x32x16_bf16 v[128:143], a[180:183], v[228:231], v[128:143]
  v_exp_f32 v219, v219
  v_exp_f32 v220, v220
  v_cvt_pk_bf16_f32 v237, v218, v219
  v_exp_f32 v221, v221
  v_mfma_f32_32x32x16_bf16 a[16:31], a[232:235], a[92:95], a[16:31]
  v_exp_f32 v222, v222
  v_exp_f32 v223, v223
  v_cvt_pk_bf16_f32 v238, v220, v221
  v_cvt_pk_bf16_f32 v239, v222, v223
  v_mfma_f32_32x32x16_bf16 v[208:223], a[160:163], a[156:159], 0
  buffer_load_dwordx4 a[160:163], v3, s[8:11], s20 offen sc1
  s_add_u32 s20, s20, 2048
  v_exp_f32 v192, v192
  v_exp_f32 v193, v193
  v_exp_f32 v194, v194
  v_cvt_pk_bf16_f32 v224, v192, v193
  v_mfma_f32_32x32x16_bf16 a[48:63], a[236:239], a[92:95], a[48:63]
  v_exp_f32 v195, v195
  v_exp_f32 v196, v196
  v_cvt_pk_bf16_f32 v225, v194, v195
  v_exp_f32 v197, v197
  v_exp_f32 v198, v198
  v_mfma_f32_32x32x16_bf16 v[144:159], a[176:179], v[232:235], v[144:159]
  s_waitcnt vmcnt(15)
  v_cvt_pk_bf16_f32 v226, v196, v197
  v_exp_f32 v199, v199
  v_exp_f32 v200, v200
  v_cvt_pk_bf16_f32 v227, v198, v199
  v_exp_f32 v201, v201
  v_mfma_f32_32x32x16_bf16 a[0:15], a[240:243], a[96:99], a[0:15]
  buffer_load_dwordx4 a[88:91], v3, s[8:11], s24 offen offset:0 sc1
  buffer_load_dwordx4 a[232:235], v3, s[8:11], s39 offen offset:0 sc1
  buffer_load_dwordx4 a[236:239], v3, s[8:11], s39 offen offset:1024 sc1
  buffer_load_dwordx4 a[92:95], v243, s[8:11], s24 offen offset:0 sc1
  v_exp_f32 v202, v202
  v_cvt_pk_bf16_f32 v228, v200, v201
  v_exp_f32 v203, v203
  v_exp_f32 v204, v204
  v_cvt_pk_bf16_f32 v229, v202, v203
  v_mfma_f32_32x32x16_bf16 v[144:159], a[180:183], v[236:239], v[144:159]
  v_exp_f32 v205, v205
  v_exp_f32 v206, v206
  v_exp_f32 v207, v207
  v_cvt_pk_bf16_f32 v230, v204, v205
  v_cvt_pk_bf16_f32 v231, v206, v207
  v_mfma_f32_32x32x16_bf16 v[192:207], a[164:167], a[128:131], 0
  v_exp_f32 v208, v208
  v_exp_f32 v209, v209
  v_exp_f32 v210, v210
  v_cvt_pk_bf16_f32 v232, v208, v209
  v_mfma_f32_32x32x16_bf16 a[32:47], a[244:247], a[96:99], a[32:47]
  v_exp_f32 v211, v211
  v_exp_f32 v212, v212
  v_cvt_pk_bf16_f32 v233, v210, v211
  v_exp_f32 v213, v213
  v_mfma_f32_32x32x16_bf16 v[160:175], a[176:179], v[224:227], v[160:175]
  v_exp_f32 v214, v214
  v_cvt_pk_bf16_f32 v234, v212, v213
  v_exp_f32 v215, v215
  v_mfma_f32_32x32x16_bf16 a[16:31], a[240:243], a[100:103], a[16:31]
  v_exp_f32 v216, v216
  v_cvt_pk_bf16_f32 v235, v214, v215
  v_exp_f32 v217, v217
  v_exp_f32 v218, v218
  v_cvt_pk_bf16_f32 v236, v216, v217
  v_mfma_f32_32x32x16_bf16 v[160:175], a[180:183], v[228:231], v[160:175]
  v_exp_f32 v219, v219
  v_exp_f32 v220, v220
  v_cvt_pk_bf16_f32 v237, v218, v219
  v_exp_f32 v221, v221
  v_mfma_f32_32x32x16_bf16 a[48:63], a[244:247], a[100:103], a[48:63]
  v_exp_f32 v222, v222
  v_exp_f32 v223, v223
  v_cvt_pk_bf16_f32 v238, v220, v221
  v_cvt_pk_bf16_f32 v239, v222, v223
  v_mfma_f32_32x32x16_bf16 v[208:223], a[164:167], a[132:135], 0
  s_waitcnt vmcnt(13)
  v_exp_f32 v192, v192
  v_exp_f32 v193, v193
  v_exp_f32 v194, v194
  v_cvt_pk_bf16_f32 v224, v192, v193
  v_mfma_f32_32x32x16_bf16 a[0:15], a[208:211], a[64:67], a[0:15]
  buffer_load_dwordx4 a[96:99], v3, s[8:11], s24 offen offset:1024 sc1
  buffer_load_dwordx4 a[240:243], v3, s[8:11], s39 offen offset:2048 sc1
  buffer_load_dwordx4 a[244:247], v3, s[8:11], s39 offen offset:3072 sc1
  buffer_load_dwordx4 a[100:103], v243, s[8:11], s24 offen offset:1024 sc1
  v_exp_f32 v195, v195
  v_exp_f32 v196, v196
  v_cvt_pk_bf16_f32 v225, v194, v195
  v_exp_f32 v197, v197
  v_exp_f32 v198, v198
  v_mfma_f32_32x32x16_bf16 v[176:191], a[176:179], v[232:235], v[176:191]
  s_add_u32 s39, s39, 4096
  v_cvt_pk_bf16_f32 v226, v196, v197
  v_exp_f32 v199, v199
  v_exp_f32 v200, v200
  v_cvt_pk_bf16_f32 v227, v198, v199
  v_exp_f32 v201, v201
  v_mfma_f32_32x32x16_bf16 a[32:47], a[212:215], a[64:67], a[32:47]
  v_exp_f32 v202, v202
  v_cvt_pk_bf16_f32 v228, v200, v201
  v_exp_f32 v203, v203
  v_exp_f32 v204, v204
  v_cvt_pk_bf16_f32 v229, v202, v203
  v_mfma_f32_32x32x16_bf16 v[176:191], a[180:183], v[236:239], v[176:191]
  s_mov_b64 exec, s[30:31]
  buffer_load_dwordx4 a[176:179], v240, s[8:11], s21 offen offset:1024 sc1
  buffer_load_dwordx4 a[180:183], v240, s[8:11], s21 offen offset:1536 sc1
  s_mov_b64 exec, -1
  s_add_u32 s21, s21, 2048
  v_exp_f32 v205, v205
  v_exp_f32 v206, v206
  v_exp_f32 v207, v207
  v_cvt_pk_bf16_f32 v230, v204, v205
  v_cvt_pk_bf16_f32 v231, v206, v207
  v_mfma_f32_32x32x16_bf16 v[192:207], a[164:167], a[136:139], 0
  v_exp_f32 v208, v208
  v_exp_f32 v209, v209
  v_exp_f32 v210, v210
  v_cvt_pk_bf16_f32 v232, v208, v209
  v_mfma_f32_32x32x16_bf16 a[16:31], a[208:211], a[68:71], a[16:31]
  v_exp_f32 v211, v211
  v_exp_f32 v212, v212
  v_cvt_pk_bf16_f32 v233, v210, v211
  v_exp_f32 v213, v213
  v_mfma_f32_32x32x16_bf16 v[64:79], a[184:187], v[224:227], v[64:79]
  v_exp_f32 v214, v214
  v_cvt_pk_bf16_f32 v234, v212, v213
  v_exp_f32 v215, v215
  v_mfma_f32_32x32x16_bf16 a[48:63], a[212:215], a[68:71], a[48:63]
  v_exp_f32 v216, v216
  v_cvt_pk_bf16_f32 v235, v214, v215
  v_exp_f32 v217, v217
  v_exp_f32 v218, v218
  v_cvt_pk_bf16_f32 v236, v216, v217
  v_mfma_f32_32x32x16_bf16 v[64:79], a[188:191], v[228:231], v[64:79]
  s_waitcnt vmcnt(15)
  v_exp_f32 v219, v219
  v_exp_f32 v220, v220
  v_cvt_pk_bf16_f32 v237, v218, v219
  v_exp_f32 v221, v221
  v_mfma_f32_32x32x16_bf16 a[0:15], a[216:219], a[72:75], a[0:15]
  buffer_load_dwordx4 a[64:67], v3, s[8:11], s24 offen offset:2048 sc1
  buffer_load_dwordx4 a[208:211], v3, s[8:11], s39 offen offset:0 sc1
  buffer_load_dwordx4 a[212:215], v3, s[8:11], s39 offen offset:1024 sc1
  buffer_load_dwordx4 a[68:71], v243, s[8:11], s24 offen offset:2048 sc1
  v_exp_f32 v222, v222
  v_exp_f32 v223, v223
  v_cvt_pk_bf16_f32 v238, v220, v221
  v_cvt_pk_bf16_f32 v239, v222, v223
  v_mfma_f32_32x32x16_bf16 v[208:223], a[164:167], a[140:143], 0
  v_exp_f32 v192, v192
  v_exp_f32 v193, v193
  v_exp_f32 v194, v194
  v_cvt_pk_bf16_f32 v224, v192, v193
  v_mfma_f32_32x32x16_bf16 a[32:47], a[220:223], a[72:75], a[32:47]
  v_exp_f32 v195, v195
  v_exp_f32 v196, v196
  v_cvt_pk_bf16_f32 v225, v194, v195
  v_exp_f32 v197, v197
  v_exp_f32 v198, v198
  v_mfma_f32_32x32x16_bf16 v[80:95], a[184:187], v[232:235], v[80:95]
  v_cvt_pk_bf16_f32 v226, v196, v197
  v_exp_f32 v199, v199
  v_exp_f32 v200, v200
  v_cvt_pk_bf16_f32 v227, v198, v199
  v_exp_f32 v201, v201
  v_mfma_f32_32x32x16_bf16 a[16:31], a[216:219], a[76:79], a[16:31]
  v_exp_f32 v202, v202
  v_cvt_pk_bf16_f32 v228, v200, v201
  v_exp_f32 v203, v203
  v_exp_f32 v204, v204
  v_cvt_pk_bf16_f32 v229, v202, v203
  v_mfma_f32_32x32x16_bf16 v[80:95], a[188:191], v[236:239], v[80:95]
  v_exp_f32 v205, v205
  v_exp_f32 v206, v206
  v_exp_f32 v207, v207
  v_cvt_pk_bf16_f32 v230, v204, v205
  v_cvt_pk_bf16_f32 v231, v206, v207
  v_mfma_f32_32x32x16_bf16 v[192:207], a[164:167], a[144:147], 0
  v_exp_f32 v208, v208
  v_exp_f32 v209, v209
  v_exp_f32 v210, v210
  v_cvt_pk_bf16_f32 v232, v208, v209
  v_mfma_f32_32x32x16_bf16 a[48:63], a[220:223], a[76:79], a[48:63]
  v_exp_f32 v211, v211
  v_exp_f32 v212, v212
  v_cvt_pk_bf16_f32 v233, v210, v211
  v_exp_f32 v213, v213
  v_mfma_f32_32x32x16_bf16 v[96:111], a[184:187], v[224:227], v[96:111]
  s_waitcnt vmcnt(15)
  v_exp_f32 v214, v214
  v_cvt_pk_bf16_f32 v234, v212, v213
  v_exp_f32 v215, v215
  v_mfma_f32_32x32x16_bf16 a[0:15], a[224:227], a[80:83], a[0:15]
  buffer_load_dwordx4 a[72:75], v3, s[8:11], s24 offen offset:3072 sc1
  buffer_load_dwordx4 a[216:219], v3, s[8:11], s39 offen offset:2048 sc1
  buffer_load_dwordx4 a[220:223], v3, s[8:11], s39 offen offset:3072 sc1
  buffer_load_dwordx4 a[76:79], v243, s[8:11], s24 offen offset:3072 sc1
  v_exp_f32 v216, v216
  v_cvt_pk_bf16_f32 v235, v214, v215
  v_exp_f32 v217, v217
  v_exp_f32 v218, v218
  v_cvt_pk_bf16_f32 v236, v216, v217
  v_mfma_f32_32x32x16_bf16 v[96:111], a[188:191], v[228:231], v[96:111]
  s_add_u32 s39, s39, 4096
  v_exp_f32 v219, v219
  v_exp_f32 v220, v220
  v_cvt_pk_bf16_f32 v237, v218, v219
  v_exp_f32 v221, v221
  v_mfma_f32_32x32x16_bf16 a[32:47], a[228:231], a[80:83], a[32:47]
  s_add_u32 s24, s24, 4096
  v_exp_f32 v222, v222
  v_exp_f32 v223, v223
  v_cvt_pk_bf16_f32 v238, v220, v221
  v_cvt_pk_bf16_f32 v239, v222, v223
  v_mfma_f32_32x32x16_bf16 v[208:223], a[164:167], a[148:151], 0
  v_exp_f32 v192, v192
  v_exp_f32 v193, v193
  v_exp_f32 v194, v194
  v_cvt_pk_bf16_f32 v224, v192, v193
  v_mfma_f32_32x32x16_bf16 a[16:31], a[224:227], a[84:87], a[16:31]
  v_exp_f32 v195, v195
  v_exp_f32 v196, v196
  v_cvt_pk_bf16_f32 v225, v194, v195
  v_exp_f32 v197, v197
  v_exp_f32 v198, v198
  v_mfma_f32_32x32x16_bf16 v[112:127], a[184:187], v[232:235], v[112:127]
  v_cvt_pk_bf16_f32 v226, v196, v197
  v_exp_f32 v199, v199
  v_exp_f32 v200, v200
  v_cvt_pk_bf16_f32 v227, v198, v199
  v_exp_f32 v201, v201
  v_mfma_f32_32x32x16_bf16 a[48:63], a[228:231], a[84:87], a[48:63]
  v_exp_f32 v202, v202
  v_cvt_pk_bf16_f32 v228, v200, v201
  v_exp_f32 v203, v203
  v_exp_f32 v204, v204
  v_cvt_pk_bf16_f32 v229, v202, v203
  v_mfma_f32_32x32x16_bf16 v[112:127], a[188:191], v[236:239], v[112:127]
  v_exp_f32 v205, v205
  v_exp_f32 v206, v206
  v_exp_f32 v207, v207
  v_cvt_pk_bf16_f32 v230, v204, v205
  v_cvt_pk_bf16_f32 v231, v206, v207
  v_mfma_f32_32x32x16_bf16 v[192:207], a[164:167], a[152:155], 0
  s_waitcnt vmcnt(14)
  v_exp_f32 v208, v208
  v_exp_f32 v209, v209
  v_exp_f32 v210, v210
  v_cvt_pk_bf16_f32 v232, v208, v209
  v_mfma_f32_32x32x16_bf16 a[0:15], a[232:235], a[88:91], a[0:15]
  buffer_load_dwordx4 a[80:83], v3, s[8:11], s24 offen offset:0 sc1
  buffer_load_dwordx4 a[224:227], v3, s[8:11], s39 offen offset:0 sc1
  buffer_load_dwordx4 a[228:231], v3, s[8:11], s39 offen offset:1024 sc1
  buffer_load_dwordx4 a[84:87], v243, s[8:11], s24 offen offset:0 sc1
  v_exp_f32 v211, v211
  v_exp_f32 v212, v212
  v_cvt_pk_bf16_f32 v233, v210, v211
  v_exp_f32 v213, v213
  v_mfma_f32_32x32x16_bf16 v[128:143], a[184:187], v[224:227], v[128:143]
  v_exp_f32 v214, v214
  v_cvt_pk_bf16_f32 v234, v212, v213
  v_exp_f32 v215, v215
  v_mfma_f32_32x32x16_bf16 a[32:47], a[236:239], a[88:91], a[32:47]
  v_exp_f32 v216, v216
  v_cvt_pk_bf16_f32 v235, v214, v215
  v_exp_f32 v217, v217
  v_exp_f32 v218, v218
  v_cvt_pk_bf16_f32 v236, v216, v217
  v_mfma_f32_32x32x16_bf16 v[128:143], a[188:191], v[228:231], v[128:143]
  v_exp_f32 v219, v219
  v_exp_f32 v220, v220
  v_cvt_pk_bf16_f32 v237, v218, v219
  v_exp_f32 v221, v221
  v_mfma_f32_32x32x16_bf16 a[16:31], a[232:235], a[92:95], a[16:31]
  v_exp_f32 v222, v222
  v_exp_f32 v223, v223
  v_cvt_pk_bf16_f32 v238, v220, v221
  v_cvt_pk_bf16_f32 v239, v222, v223
  v_mfma_f32_32x32x16_bf16 v[208:223], a[164:167], a[156:159], 0
  buffer_load_dwordx4 a[164:167], v3, s[8:11], s20 offen sc1
  s_add_u32 s20, s20, 2048
  v_exp_f32 v192, v192
  v_exp_f32 v193, v193
  v_exp_f32 v194, v194
  v_cvt_pk_bf16_f32 v224, v192, v193
  v_mfma_f32_32x32x16_bf16 a[48:63], a[236:239], a[92:95], a[48:63]
  v_exp_f32 v195, v195
  v_exp_f32 v196, v196
  v_cvt_pk_bf16_f32 v225, v194, v195
  v_exp_f32 v197, v197
  v_exp_f32 v198, v198
  v_mfma_f32_32x32x16_bf16 v[144:159], a[184:187], v[232:235], v[144:159]
  s_waitcnt vmcnt(15)
  v_cvt_pk_bf16_f32 v226, v196, v197
  v_exp_f32 v199, v199
  v_exp_f32 v200, v200
  v_cvt_pk_bf16_f32 v227, v198, v199
  v_exp_f32 v201, v201
  v_mfma_f32_32x32x16_bf16 a[0:15], a[240:243], a[96:99], a[0:15]
  buffer_load_dwordx4 a[88:91], v3, s[8:11], s24 offen offset:1024 sc1
  buffer_load_dwordx4 a[232:235], v3, s[8:11], s39 offen offset:2048 sc1
  buffer_load_dwordx4 a[236:239], v3, s[8:11], s39 offen offset:3072 sc1
  buffer_load_dwordx4 a[92:95], v243, s[8:11], s24 offen offset:1024 sc1
  v_exp_f32 v202, v202
  v_cvt_pk_bf16_f32 v228, v200, v201
  v_exp_f32 v203, v203
  v_exp_f32 v204, v204
  v_cvt_pk_bf16_f32 v229, v202, v203
  v_mfma_f32_32x32x16_bf16 v[144:159], a[188:191], v[236:239], v[144:159]
  s_add_u32 s39, s39, 4096
  v_exp_f32 v205, v205
  v_exp_f32 v206, v206
  v_exp_f32 v207, v207
  v_cvt_pk_bf16_f32 v230, v204, v205
  v_cvt_pk_bf16_f32 v231, v206, v207
  v_mfma_f32_32x32x16_bf16 v[192:207], a[168:171], a[128:131], 0
  v_exp_f32 v208, v208
  v_exp_f32 v209, v209
  v_exp_f32 v210, v210
  v_cvt_pk_bf16_f32 v232, v208, v209
  v_mfma_f32_32x32x16_bf16 a[32:47], a[244:247], a[96:99], a[32:47]
  v_exp_f32 v211, v211
  v_exp_f32 v212, v212
  v_cvt_pk_bf16_f32 v233, v210, v211
  v_exp_f32 v213, v213
  v_mfma_f32_32x32x16_bf16 v[160:175], a[184:187], v[224:227], v[160:175]
  v_exp_f32 v214, v214
  v_cvt_pk_bf16_f32 v234, v212, v213
  v_exp_f32 v215, v215
  v_mfma_f32_32x32x16_bf16 a[16:31], a[240:243], a[100:103], a[16:31]
  v_exp_f32 v216, v216
  v_cvt_pk_bf16_f32 v235, v214, v215
  v_exp_f32 v217, v217
  v_exp_f32 v218, v218
  v_cvt_pk_bf16_f32 v236, v216, v217
  v_mfma_f32_32x32x16_bf16 v[160:175], a[188:191], v[228:231], v[160:175]
  v_exp_f32 v219, v219
  v_exp_f32 v220, v220
  v_cvt_pk_bf16_f32 v237, v218, v219
  v_exp_f32 v221, v221
  v_mfma_f32_32x32x16_bf16 a[48:63], a[244:247], a[100:103], a[48:63]
  v_exp_f32 v222, v222
  v_exp_f32 v223, v223
  v_cvt_pk_bf16_f32 v238, v220, v221
  v_cvt_pk_bf16_f32 v239, v222, v223
  v_mfma_f32_32x32x16_bf16 v[208:223], a[168:171], a[132:135], 0
  s_waitcnt vmcnt(13)
  v_exp_f32 v192, v192
  v_exp_f32 v193, v193
  v_exp_f32 v194, v194
  v_cvt_pk_bf16_f32 v224, v192, v193
  v_mfma_f32_32x32x16_bf16 a[0:15], a[208:211], a[64:67], a[0:15]
  buffer_load_dwordx4 a[96:99], v3, s[8:11], s24 offen offset:2048 sc1
  buffer_load_dwordx4 a[240:243], v3, s[8:11], s39 offen offset:0 sc1
  buffer_load_dwordx4 a[244:247], v3, s[8:11], s39 offen offset:1024 sc1
  buffer_load_dwordx4 a[100:103], v243, s[8:11], s24 offen offset:2048 sc1
  v_exp_f32 v195, v195
  v_exp_f32 v196, v196
  v_cvt_pk_bf16_f32 v225, v194, v195
  v_exp_f32 v197, v197
  v_exp_f32 v198, v198
  v_mfma_f32_32x32x16_bf16 v[176:191], a[184:187], v[232:235], v[176:191]
  v_cvt_pk_bf16_f32 v226, v196, v197
  v_exp_f32 v199, v199
  v_exp_f32 v200, v200
  v_cvt_pk_bf16_f32 v227, v198, v199
  v_exp_f32 v201, v201
  v_mfma_f32_32x32x16_bf16 a[32:47], a[212:215], a[64:67], a[32:47]
  v_exp_f32 v202, v202
  v_cvt_pk_bf16_f32 v228, v200, v201
  v_exp_f32 v203, v203
  v_exp_f32 v204, v204
  v_cvt_pk_bf16_f32 v229, v202, v203
  v_mfma_f32_32x32x16_bf16 v[176:191], a[188:191], v[236:239], v[176:191]
  s_mov_b64 exec, s[30:31]
  buffer_load_dwordx4 a[184:187], v240, s[8:11], s21 offen offset:1024 sc1
  buffer_load_dwordx4 a[188:191], v240, s[8:11], s21 offen offset:1536 sc1
  s_mov_b64 exec, -1
  s_add_u32 s21, s21, 2048
  v_exp_f32 v205, v205
  v_exp_f32 v206, v206
  v_exp_f32 v207, v207
  v_cvt_pk_bf16_f32 v230, v204, v205
  v_cvt_pk_bf16_f32 v231, v206, v207
  v_mfma_f32_32x32x16_bf16 v[192:207], a[168:171], a[136:139], 0
  v_exp_f32 v208, v208
  v_exp_f32 v209, v209
  v_exp_f32 v210, v210
  v_cvt_pk_bf16_f32 v232, v208, v209
  v_mfma_f32_32x32x16_bf16 a[16:31], a[208:211], a[68:71], a[16:31]
  v_exp_f32 v211, v211
  v_exp_f32 v212, v212
  v_cvt_pk_bf16_f32 v233, v210, v211
  v_exp_f32 v213, v213
  v_mfma_f32_32x32x16_bf16 v[64:79], a[192:195], v[224:227], v[64:79]
  v_exp_f32 v214, v214
  v_cvt_pk_bf16_f32 v234, v212, v213
  v_exp_f32 v215, v215
  v_mfma_f32_32x32x16_bf16 a[48:63], a[212:215], a[68:71], a[48:63]
  v_exp_f32 v216, v216
  v_cvt_pk_bf16_f32 v235, v214, v215
  v_exp_f32 v217, v217
  v_exp_f32 v218, v218
  v_cvt_pk_bf16_f32 v236, v216, v217
  v_mfma_f32_32x32x16_bf16 v[64:79], a[196:199], v[228:231], v[64:79]
  s_waitcnt vmcnt(15)
  v_exp_f32 v219, v219
  v_exp_f32 v220, v220
  v_cvt_pk_bf16_f32 v237, v218, v219
  v_exp_f32 v221, v221
  v_mfma_f32_32x32x16_bf16 a[0:15], a[216:219], a[72:75], a[0:15]
  buffer_load_dwordx4 a[64:67], v3, s[8:11], s24 offen offset:3072 sc1
  buffer_load_dwordx4 a[208:211], v3, s[8:11], s39 offen offset:2048 sc1
  buffer_load_dwordx4 a[212:215], v3, s[8:11], s39 offen offset:3072 sc1
  buffer_load_dwordx4 a[68:71], v243, s[8:11], s24 offen offset:3072 sc1
  v_exp_f32 v222, v222
  v_exp_f32 v223, v223
  v_cvt_pk_bf16_f32 v238, v220, v221
  v_cvt_pk_bf16_f32 v239, v222, v223
  v_mfma_f32_32x32x16_bf16 v[208:223], a[168:171], a[140:143], 0
  s_add_u32 s39, s39, 4096
  v_exp_f32 v192, v192
  v_exp_f32 v193, v193
  v_exp_f32 v194, v194
  v_cvt_pk_bf16_f32 v224, v192, v193
  v_mfma_f32_32x32x16_bf16 a[32:47], a[220:223], a[72:75], a[32:47]
  s_add_u32 s24, s24, 4096
  v_exp_f32 v195, v195
  v_exp_f32 v196, v196
  v_cvt_pk_bf16_f32 v225, v194, v195
  v_exp_f32 v197, v197
  v_exp_f32 v198, v198
  v_mfma_f32_32x32x16_bf16 v[80:95], a[192:195], v[232:235], v[80:95]
  v_cvt_pk_bf16_f32 v226, v196, v197
  v_exp_f32 v199, v199
  v_exp_f32 v200, v200
  v_cvt_pk_bf16_f32 v227, v198, v199
  v_exp_f32 v201, v201
  v_mfma_f32_32x32x16_bf16 a[16:31], a[216:219], a[76:79], a[16:31]
  v_exp_f32 v202, v202
  v_cvt_pk_bf16_f32 v228, v200, v201
  v_exp_f32 v203, v203
  v_exp_f32 v204, v204
  v_cvt_pk_bf16_f32 v229, v202, v203
  v_mfma_f32_32x32x16_bf16 v[80:95], a[196:199], v[236:239], v[80:95]
  v_exp_f32 v205, v205
  v_exp_f32 v206, v206
  v_exp_f32 v207, v207
  v_cvt_pk_bf16_f32 v230, v204, v205
  v_cvt_pk_bf16_f32 v231, v206, v207
  v_mfma_f32_32x32x16_bf16 v[192:207], a[168:171], a[144:147], 0
  v_exp_f32 v208, v208
  v_exp_f32 v209, v209
  v_exp_f32 v210, v210
  v_cvt_pk_bf16_f32 v232, v208, v209
  v_mfma_f32_32x32x16_bf16 a[48:63], a[220:223], a[76:79], a[48:63]
  v_exp_f32 v211, v211
  v_exp_f32 v212, v212
  v_cvt_pk_bf16_f32 v233, v210, v211
  v_exp_f32 v213, v213
  v_mfma_f32_32x32x16_bf16 v[96:111], a[192:195], v[224:227], v[96:111]
  s_waitcnt vmcnt(15)
  v_exp_f32 v214, v214
  v_cvt_pk_bf16_f32 v234, v212, v213
  v_exp_f32 v215, v215
  v_mfma_f32_32x32x16_bf16 a[0:15], a[224:227], a[80:83], a[0:15]
  buffer_load_dwordx4 a[72:75], v3, s[8:11], s24 offen offset:0 sc1
  buffer_load_dwordx4 a[216:219], v3, s[8:11], s39 offen offset:0 sc1
  buffer_load_dwordx4 a[220:223], v3, s[8:11], s39 offen offset:1024 sc1
  buffer_load_dwordx4 a[76:79], v243, s[8:11], s24 offen offset:0 sc1
  v_exp_f32 v216, v216
  v_cvt_pk_bf16_f32 v235, v214, v215
  v_exp_f32 v217, v217
  v_exp_f32 v218, v218
  v_cvt_pk_bf16_f32 v236, v216, v217
  v_mfma_f32_32x32x16_bf16 v[96:111], a[196:199], v[228:231], v[96:111]
  v_exp_f32 v219, v219
  v_exp_f32 v220, v220
  v_cvt_pk_bf16_f32 v237, v218, v219
  v_exp_f32 v221, v221
  v_mfma_f32_32x32x16_bf16 a[32:47], a[228:231], a[80:83], a[32:47]
  v_exp_f32 v222, v222
  v_exp_f32 v223, v223
  v_cvt_pk_bf16_f32 v238, v220, v221
  v_cvt_pk_bf16_f32 v239, v222, v223
  v_mfma_f32_32x32x16_bf16 v[208:223], a[168:171], a[148:151], 0
  v_exp_f32 v192, v192
  v_exp_f32 v193, v193
  v_exp_f32 v194, v194
  v_cvt_pk_bf16_f32 v224, v192, v193
  v_mfma_f32_32x32x16_bf16 a[16:31], a[224:227], a[84:87], a[16:31]
  v_exp_f32 v195, v195
  v_exp_f32 v196, v196
  v_cvt_pk_bf16_f32 v225, v194, v195
  v_exp_f32 v197, v197
  v_exp_f32 v198, v198
  v_mfma_f32_32x32x16_bf16 v[112:127], a[192:195], v[232:235], v[112:127]
  v_cvt_pk_bf16_f32 v226, v196, v197
  v_exp_f32 v199, v199
  v_exp_f32 v200, v200
  v_cvt_pk_bf16_f32 v227, v198, v199
  v_exp_f32 v201, v201
  v_mfma_f32_32x32x16_bf16 a[48:63], a[228:231], a[84:87], a[48:63]
  v_exp_f32 v202, v202
  v_cvt_pk_bf16_f32 v228, v200, v201
  v_exp_f32 v203, v203
  v_exp_f32 v204, v204
  v_cvt_pk_bf16_f32 v229, v202, v203
  v_mfma_f32_32x32x16_bf16 v[112:127], a[196:199], v[236:239], v[112:127]
  v_exp_f32 v205, v205
  v_exp_f32 v206, v206
  v_exp_f32 v207, v207
  v_cvt_pk_bf16_f32 v230, v204, v205
  v_cvt_pk_bf16_f32 v231, v206, v207
  v_mfma_f32_32x32x16_bf16 v[192:207], a[168:171], a[152:155], 0
  s_waitcnt vmcnt(14)
  v_exp_f32 v208, v208
  v_exp_f32 v209, v209
  v_exp_f32 v210, v210
  v_cvt_pk_bf16_f32 v232, v208, v209
  v_mfma_f32_32x32x16_bf16 a[0:15], a[232:235], a[88:91], a[0:15]
  buffer_load_dwordx4 a[80:83], v3, s[8:11], s24 offen offset:1024 sc1
  buffer_load_dwordx4 a[224:227], v3, s[8:11], s39 offen offset:2048 sc1
  buffer_load_dwordx4 a[228:231], v3, s[8:11], s39 offen offset:3072 sc1
  buffer_load_dwordx4 a[84:87], v243, s[8:11], s24 offen offset:1024 sc1
  v_exp_f32 v211, v211
  v_exp_f32 v212, v212
  v_cvt_pk_bf16_f32 v233, v210, v211
  v_exp_f32 v213, v213
  v_mfma_f32_32x32x16_bf16 v[128:143], a[192:195], v[224:227], v[128:143]
  s_add_u32 s39, s39, 4096
  v_exp_f32 v214, v214
  v_cvt_pk_bf16_f32 v234, v212, v213
  v_exp_f32 v215, v215
  v_mfma_f32_32x32x16_bf16 a[32:47], a[236:239], a[88:91], a[32:47]
  v_exp_f32 v216, v216
  v_cvt_pk_bf16_f32 v235, v214, v215
  v_exp_f32 v217, v217
  v_exp_f32 v218, v218
  v_cvt_pk_bf16_f32 v236, v216, v217
  v_mfma_f32_32x32x16_bf16 v[128:143], a[196:199], v[228:231], v[128:143]
  v_exp_f32 v219, v219
  v_exp_f32 v220, v220
  v_cvt_pk_bf16_f32 v237, v218, v219
  v_exp_f32 v221, v221
  v_mfma_f32_32x32x16_bf16 a[16:31], a[232:235], a[92:95], a[16:31]
  v_exp_f32 v222, v222
  v_exp_f32 v223, v223
  v_cvt_pk_bf16_f32 v238, v220, v221
  v_cvt_pk_bf16_f32 v239, v222, v223
  v_mfma_f32_32x32x16_bf16 v[208:223], a[168:171], a[156:159], 0
  buffer_load_dwordx4 a[168:171], v3, s[8:11], s20 offen sc1
  s_add_u32 s20, s20, 2048
  v_exp_f32 v192, v192
  v_exp_f32 v193, v193
  v_exp_f32 v194, v194
  v_cvt_pk_bf16_f32 v224, v192, v193
  v_mfma_f32_32x32x16_bf16 a[48:63], a[236:239], a[92:95], a[48:63]
  v_exp_f32 v195, v195
  v_exp_f32 v196, v196
  v_cvt_pk_bf16_f32 v225, v194, v195
  v_exp_f32 v197, v197
  v_exp_f32 v198, v198
  v_mfma_f32_32x32x16_bf16 v[144:159], a[192:195], v[232:235], v[144:159]
  s_waitcnt vmcnt(15)
  v_cvt_pk_bf16_f32 v226, v196, v197
  v_exp_f32 v199, v199
  v_exp_f32 v200, v200
  v_cvt_pk_bf16_f32 v227, v198, v199
  v_exp_f32 v201, v201
  v_mfma_f32_32x32x16_bf16 a[0:15], a[240:243], a[96:99], a[0:15]
  buffer_load_dwordx4 a[88:91], v3, s[8:11], s24 offen offset:2048 sc1
  buffer_load_dwordx4 a[232:235], v3, s[8:11], s39 offen offset:0 sc1
  buffer_load_dwordx4 a[236:239], v3, s[8:11], s39 offen offset:1024 sc1
  buffer_load_dwordx4 a[92:95], v243, s[8:11], s24 offen offset:2048 sc1
  v_exp_f32 v202, v202
  v_cvt_pk_bf16_f32 v228, v200, v201
  v_exp_f32 v203, v203
  v_exp_f32 v204, v204
  v_cvt_pk_bf16_f32 v229, v202, v203
  v_mfma_f32_32x32x16_bf16 v[144:159], a[196:199], v[236:239], v[144:159]
  v_exp_f32 v205, v205
  v_exp_f32 v206, v206
  v_exp_f32 v207, v207
  v_cvt_pk_bf16_f32 v230, v204, v205
  v_cvt_pk_bf16_f32 v231, v206, v207
  v_mfma_f32_32x32x16_bf16 v[192:207], a[172:175], a[128:131], 0
  v_exp_f32 v208, v208
  v_exp_f32 v209, v209
  v_exp_f32 v210, v210
  v_cvt_pk_bf16_f32 v232, v208, v209
  v_mfma_f32_32x32x16_bf16 a[32:47], a[244:247], a[96:99], a[32:47]
  v_exp_f32 v211, v211
  v_exp_f32 v212, v212
  v_cvt_pk_bf16_f32 v233, v210, v211
  v_exp_f32 v213, v213
  v_mfma_f32_32x32x16_bf16 v[160:175], a[192:195], v[224:227], v[160:175]
  v_exp_f32 v214, v214
  v_cvt_pk_bf16_f32 v234, v212, v213
  v_exp_f32 v215, v215
  v_mfma_f32_32x32x16_bf16 a[16:31], a[240:243], a[100:103], a[16:31]
  v_exp_f32 v216, v216
  v_cvt_pk_bf16_f32 v235, v214, v215
  v_exp_f32 v217, v217
  v_exp_f32 v218, v218
  v_cvt_pk_bf16_f32 v236, v216, v217
  v_mfma_f32_32x32x16_bf16 v[160:175], a[196:199], v[228:231], v[160:175]
  v_exp_f32 v219, v219
  v_exp_f32 v220, v220
  v_cvt_pk_bf16_f32 v237, v218, v219
  v_exp_f32 v221, v221
  v_mfma_f32_32x32x16_bf16 a[48:63], a[244:247], a[100:103], a[48:63]
  v_exp_f32 v222, v222
  v_exp_f32 v223, v223
  v_cvt_pk_bf16_f32 v238, v220, v221
  v_cvt_pk_bf16_f32 v239, v222, v223
  v_mfma_f32_32x32x16_bf16 v[208:223], a[172:175], a[132:135], 0
  s_waitcnt vmcnt(13)
  v_exp_f32 v192, v192
  v_exp_f32 v193, v193
  v_exp_f32 v194, v194
  v_cvt_pk_bf16_f32 v224, v192, v193
  v_mfma_f32_32x32x16_bf16 a[0:15], a[208:211], a[64:67], a[0:15]
  buffer_load_dwordx4 a[96:99], v3, s[8:11], s24 offen offset:3072 sc1
  buffer_load_dwordx4 a[240:243], v3, s[8:11], s39 offen offset:2048 sc1
  buffer_load_dwordx4 a[244:247], v3, s[8:11], s39 offen offset:3072 sc1
  buffer_load_dwordx4 a[100:103], v243, s[8:11], s24 offen offset:3072 sc1
  v_exp_f32 v195, v195
  v_exp_f32 v196, v196
  v_cvt_pk_bf16_f32 v225, v194, v195
  v_exp_f32 v197, v197
  v_exp_f32 v198, v198
  v_mfma_f32_32x32x16_bf16 v[176:191], a[192:195], v[232:235], v[176:191]
  s_add_u32 s39, s39, 4096
  v_cvt_pk_bf16_f32 v226, v196, v197
  v_exp_f32 v199, v199
  v_exp_f32 v200, v200
  v_cvt_pk_bf16_f32 v227, v198, v199
  v_exp_f32 v201, v201
  v_mfma_f32_32x32x16_bf16 a[32:47], a[212:215], a[64:67], a[32:47]
  s_add_u32 s24, s24, 4096
  v_exp_f32 v202, v202
  v_cvt_pk_bf16_f32 v228, v200, v201
  v_exp_f32 v203, v203
  v_exp_f32 v204, v204
  v_cvt_pk_bf16_f32 v229, v202, v203
  v_mfma_f32_32x32x16_bf16 v[176:191], a[196:199], v[236:239], v[176:191]
  s_mov_b64 exec, s[30:31]
  buffer_load_dwordx4 a[192:195], v240, s[8:11], s21 offen offset:1024 sc1
  buffer_load_dwordx4 a[196:199], v240, s[8:11], s21 offen offset:1536 sc1
  s_mov_b64 exec, -1
  s_add_u32 s21, s21, 2048
  v_exp_f32 v205, v205
  v_exp_f32 v206, v206
  v_exp_f32 v207, v207
  v_cvt_pk_bf16_f32 v230, v204, v205
  v_cvt_pk_bf16_f32 v231, v206, v207
  v_mfma_f32_32x32x16_bf16 v[192:207], a[172:175], a[136:139], 0
  v_exp_f32 v208, v208
  v_exp_f32 v209, v209
  v_exp_f32 v210, v210
  v_cvt_pk_bf16_f32 v232, v208, v209
  v_mfma_f32_32x32x16_bf16 a[16:31], a[208:211], a[68:71], a[16:31]
  v_exp_f32 v211, v211
  v_exp_f32 v212, v212
  v_cvt_pk_bf16_f32 v233, v210, v211
  v_exp_f32 v213, v213
  v_mfma_f32_32x32x16_bf16 v[64:79], a[200:203], v[224:227], v[64:79]
  v_exp_f32 v214, v214
  v_cvt_pk_bf16_f32 v234, v212, v213
  v_exp_f32 v215, v215
  v_mfma_f32_32x32x16_bf16 a[48:63], a[212:215], a[68:71], a[48:63]
  v_exp_f32 v216, v216
  v_cvt_pk_bf16_f32 v235, v214, v215
  v_exp_f32 v217, v217
  v_exp_f32 v218, v218
  v_cvt_pk_bf16_f32 v236, v216, v217
  v_mfma_f32_32x32x16_bf16 v[64:79], a[204:207], v[228:231], v[64:79]
  s_waitcnt vmcnt(15)
  v_exp_f32 v219, v219
  v_exp_f32 v220, v220
  v_cvt_pk_bf16_f32 v237, v218, v219
  v_exp_f32 v221, v221
  v_mfma_f32_32x32x16_bf16 a[0:15], a[216:219], a[72:75], a[0:15]
  buffer_load_dwordx4 a[64:67], v3, s[8:11], s24 offen offset:0 sc1
  buffer_load_dwordx4 a[208:211], v3, s[8:11], s39 offen offset:0 sc1
  buffer_load_dwordx4 a[212:215], v3, s[8:11], s39 offen offset:1024 sc1
  buffer_load_dwordx4 a[68:71], v243, s[8:11], s24 offen offset:0 sc1
  v_exp_f32 v222, v222
  v_exp_f32 v223, v223
  v_cvt_pk_bf16_f32 v238, v220, v221
  v_cvt_pk_bf16_f32 v239, v222, v223
  v_mfma_f32_32x32x16_bf16 v[208:223], a[172:175], a[140:143], 0
  v_exp_f32 v192, v192
  v_exp_f32 v193, v193
  v_exp_f32 v194, v194
  v_cvt_pk_bf16_f32 v224, v192, v193
  v_mfma_f32_32x32x16_bf16 a[32:47], a[220:223], a[72:75], a[32:47]
  v_exp_f32 v195, v195
  v_exp_f32 v196, v196
  v_cvt_pk_bf16_f32 v225, v194, v195
  v_exp_f32 v197, v197
  v_exp_f32 v198, v198
  v_mfma_f32_32x32x16_bf16 v[80:95], a[200:203], v[232:235], v[80:95]
  v_cvt_pk_bf16_f32 v226, v196, v197
  v_exp_f32 v199, v199
  v_exp_f32 v200, v200
  v_cvt_pk_bf16_f32 v227, v198, v199
  v_exp_f32 v201, v201
  v_mfma_f32_32x32x16_bf16 a[16:31], a[216:219], a[76:79], a[16:31]
  v_exp_f32 v202, v202
  v_cvt_pk_bf16_f32 v228, v200, v201
  v_exp_f32 v203, v203
  v_exp_f32 v204, v204
  v_cvt_pk_bf16_f32 v229, v202, v203
  v_mfma_f32_32x32x16_bf16 v[80:95], a[204:207], v[236:239], v[80:95]
  v_exp_f32 v205, v205
  v_exp_f32 v206, v206
  v_exp_f32 v207, v207
  v_cvt_pk_bf16_f32 v230, v204, v205
  v_cvt_pk_bf16_f32 v231, v206, v207
  v_mfma_f32_32x32x16_bf16 v[192:207], a[172:175], a[144:147], 0
  v_exp_f32 v208, v208
  v_exp_f32 v209, v209
  v_exp_f32 v210, v210
  v_cvt_pk_bf16_f32 v232, v208, v209
  v_mfma_f32_32x32x16_bf16 a[48:63], a[220:223], a[76:79], a[48:63]
  v_exp_f32 v211, v211
  v_exp_f32 v212, v212
  v_cvt_pk_bf16_f32 v233, v210, v211
  v_exp_f32 v213, v213
  v_mfma_f32_32x32x16_bf16 v[96:111], a[200:203], v[224:227], v[96:111]
  s_waitcnt vmcnt(15)
  v_exp_f32 v214, v214
  v_cvt_pk_bf16_f32 v234, v212, v213
  v_exp_f32 v215, v215
  v_mfma_f32_32x32x16_bf16 a[0:15], a[224:227], a[80:83], a[0:15]
  buffer_load_dwordx4 a[72:75], v3, s[8:11], s24 offen offset:1024 sc1
  buffer_load_dwordx4 a[216:219], v3, s[8:11], s39 offen offset:2048 sc1
  buffer_load_dwordx4 a[220:223], v3, s[8:11], s39 offen offset:3072 sc1
  buffer_load_dwordx4 a[76:79], v243, s[8:11], s24 offen offset:1024 sc1
  v_exp_f32 v216, v216
  v_cvt_pk_bf16_f32 v235, v214, v215
  v_exp_f32 v217, v217
  v_exp_f32 v218, v218
  v_cvt_pk_bf16_f32 v236, v216, v217
  v_mfma_f32_32x32x16_bf16 v[96:111], a[204:207], v[228:231], v[96:111]
  s_add_u32 s39, s39, 4096
  v_exp_f32 v219, v219
  v_exp_f32 v220, v220
  v_cvt_pk_bf16_f32 v237, v218, v219
  v_exp_f32 v221, v221
  v_mfma_f32_32x32x16_bf16 a[32:47], a[228:231], a[80:83], a[32:47]
  v_exp_f32 v222, v222
  v_exp_f32 v223, v223
  v_cvt_pk_bf16_f32 v238, v220, v221
  v_cvt_pk_bf16_f32 v239, v222, v223
  v_mfma_f32_32x32x16_bf16 v[208:223], a[172:175], a[148:151], 0
  v_exp_f32 v192, v192
  v_exp_f32 v193, v193
  v_exp_f32 v194, v194
  v_cvt_pk_bf16_f32 v224, v192, v193
  v_mfma_f32_32x32x16_bf16 a[16:31], a[224:227], a[84:87], a[16:31]
  v_exp_f32 v195, v195
  v_exp_f32 v196, v196
  v_cvt_pk_bf16_f32 v225, v194, v195
  v_exp_f32 v197, v197
  v_exp_f32 v198, v198
  v_mfma_f32_32x32x16_bf16 v[112:127], a[200:203], v[232:235], v[112:127]
  v_cvt_pk_bf16_f32 v226, v196, v197
  v_exp_f32 v199, v199
  v_exp_f32 v200, v200
  v_cvt_pk_bf16_f32 v227, v198, v199
  v_exp_f32 v201, v201
  v_mfma_f32_32x32x16_bf16 a[48:63], a[228:231], a[84:87], a[48:63]
  v_exp_f32 v202, v202
  v_cvt_pk_bf16_f32 v228, v200, v201
  v_exp_f32 v203, v203
  v_exp_f32 v204, v204
  v_cvt_pk_bf16_f32 v229, v202, v203
  v_mfma_f32_32x32x16_bf16 v[112:127], a[204:207], v[236:239], v[112:127]
  v_exp_f32 v205, v205
  v_exp_f32 v206, v206
  v_exp_f32 v207, v207
  v_cvt_pk_bf16_f32 v230, v204, v205
  v_cvt_pk_bf16_f32 v231, v206, v207
  v_mfma_f32_32x32x16_bf16 v[192:207], a[172:175], a[152:155], 0
  s_waitcnt vmcnt(14)
  v_exp_f32 v208, v208
  v_exp_f32 v209, v209
  v_exp_f32 v210, v210
  v_cvt_pk_bf16_f32 v232, v208, v209
  v_mfma_f32_32x32x16_bf16 a[0:15], a[232:235], a[88:91], a[0:15]
  buffer_load_dwordx4 a[80:83], v3, s[8:11], s24 offen offset:2048 sc1
  buffer_load_dwordx4 a[224:227], v3, s[8:11], s39 offen offset:0 sc1
  buffer_load_dwordx4 a[228:231], v3, s[8:11], s39 offen offset:1024 sc1
  buffer_load_dwordx4 a[84:87], v243, s[8:11], s24 offen offset:2048 sc1
  v_exp_f32 v211, v211
  v_exp_f32 v212, v212
  v_cvt_pk_bf16_f32 v233, v210, v211
  v_exp_f32 v213, v213
  v_mfma_f32_32x32x16_bf16 v[128:143], a[200:203], v[224:227], v[128:143]
  v_exp_f32 v214, v214
  v_cvt_pk_bf16_f32 v234, v212, v213
  v_exp_f32 v215, v215
  v_mfma_f32_32x32x16_bf16 a[32:47], a[236:239], a[88:91], a[32:47]
  v_exp_f32 v216, v216
  v_cvt_pk_bf16_f32 v235, v214, v215
  v_exp_f32 v217, v217
  v_exp_f32 v218, v218
  v_cvt_pk_bf16_f32 v236, v216, v217
  v_mfma_f32_32x32x16_bf16 v[128:143], a[204:207], v[228:231], v[128:143]
  v_exp_f32 v219, v219
  v_exp_f32 v220, v220
  v_cvt_pk_bf16_f32 v237, v218, v219
  v_exp_f32 v221, v221
  v_mfma_f32_32x32x16_bf16 a[16:31], a[232:235], a[92:95], a[16:31]
  v_exp_f32 v222, v222
  v_exp_f32 v223, v223
  v_cvt_pk_bf16_f32 v238, v220, v221
  v_cvt_pk_bf16_f32 v239, v222, v223
  v_mfma_f32_32x32x16_bf16 v[208:223], a[172:175], a[156:159], 0
  buffer_load_dwordx4 a[172:175], v3, s[8:11], s20 offen sc1
  s_add_u32 s20, s20, 2048
  v_exp_f32 v192, v192
  v_exp_f32 v193, v193
  v_exp_f32 v194, v194
  v_cvt_pk_bf16_f32 v224, v192, v193
  v_mfma_f32_32x32x16_bf16 a[48:63], a[236:239], a[92:95], a[48:63]
  v_exp_f32 v195, v195
  v_exp_f32 v196, v196
  v_cvt_pk_bf16_f32 v225, v194, v195
  v_exp_f32 v197, v197
  v_exp_f32 v198, v198
  v_mfma_f32_32x32x16_bf16 v[144:159], a[200:203], v[232:235], v[144:159]
  s_waitcnt vmcnt(15)
  v_cvt_pk_bf16_f32 v226, v196, v197
  v_exp_f32 v199, v199
  v_exp_f32 v200, v200
  v_cvt_pk_bf16_f32 v227, v198, v199
  v_exp_f32 v201, v201
  v_mfma_f32_32x32x16_bf16 a[0:15], a[240:243], a[96:99], a[0:15]
  buffer_load_dwordx4 a[88:91], v3, s[8:11], s24 offen offset:3072 sc1
  buffer_load_dwordx4 a[232:235], v3, s[8:11], s39 offen offset:2048 sc1
  buffer_load_dwordx4 a[236:239], v3, s[8:11], s39 offen offset:3072 sc1
  buffer_load_dwordx4 a[92:95], v243, s[8:11], s24 offen offset:3072 sc1
  v_exp_f32 v202, v202
  v_cvt_pk_bf16_f32 v228, v200, v201
  v_exp_f32 v203, v203
  v_exp_f32 v204, v204
  v_cvt_pk_bf16_f32 v229, v202, v203
  v_mfma_f32_32x32x16_bf16 v[144:159], a[204:207], v[236:239], v[144:159]
  s_add_u32 s39, s39, 4096
  v_exp_f32 v205, v205
  v_exp_f32 v206, v206
  v_exp_f32 v207, v207
  v_cvt_pk_bf16_f32 v230, v204, v205
  v_cvt_pk_bf16_f32 v231, v206, v207
  v_mfma_f32_32x32x16_bf16 v[192:207], a[160:163], a[128:131], 0
  s_add_u32 s24, s24, 4096
  v_exp_f32 v208, v208
  v_exp_f32 v209, v209
  v_exp_f32 v210, v210
  v_cvt_pk_bf16_f32 v232, v208, v209
  v_mfma_f32_32x32x16_bf16 a[32:47], a[244:247], a[96:99], a[32:47]
  v_exp_f32 v211, v211
  v_exp_f32 v212, v212
  v_cvt_pk_bf16_f32 v233, v210, v211
  v_exp_f32 v213, v213
  v_mfma_f32_32x32x16_bf16 v[160:175], a[200:203], v[224:227], v[160:175]
  v_exp_f32 v214, v214
  v_cvt_pk_bf16_f32 v234, v212, v213
  v_exp_f32 v215, v215
  v_mfma_f32_32x32x16_bf16 a[16:31], a[240:243], a[100:103], a[16:31]
  v_exp_f32 v216, v216
  v_cvt_pk_bf16_f32 v235, v214, v215
  v_exp_f32 v217, v217
  v_exp_f32 v218, v218
  v_cvt_pk_bf16_f32 v236, v216, v217
  v_mfma_f32_32x32x16_bf16 v[160:175], a[204:207], v[228:231], v[160:175]
  v_exp_f32 v219, v219
  v_exp_f32 v220, v220
  v_cvt_pk_bf16_f32 v237, v218, v219
  v_exp_f32 v221, v221
  v_mfma_f32_32x32x16_bf16 a[48:63], a[244:247], a[100:103], a[48:63]
  v_exp_f32 v222, v222
  v_exp_f32 v223, v223
  v_cvt_pk_bf16_f32 v238, v220, v221
  v_cvt_pk_bf16_f32 v239, v222, v223
  s_sub_u32 s19, s19, 1
  s_cbranch_scc0 P4_L
  s_add_u32 s22, s26, 65536
  v_add_u32 v251, s22, v3
  v_and_b32 v255, 0x1f0, v3
  v_lshrrev_b32 v252, 5, v250
  v_lshl_add_u32 v252, v252, 10, v255
  s_lshl_b32 s22, s16, 12
  s_add_u32 s22, s22, 65536
  v_add_u32 v252, s22, v252
  s_lshl_b32 s22, s16, 2
  s_add_u32 s22, s22, 131072
  v_add_u32 v254, s22, v255
  s_lshl_b32 s22, s16, 10
  s_add_u32 s22, s22, 131072
  v_add_u32 v253, s22, v255
  v_sub_f32 v241, 1.0, v241
  v_sub_f32 v242, 1.0, v242
  s_lshl_b32 s29, s18, 2
  s_add_u32 s29, s29, s16
  s_mul_i32 s29, s29, 589824
  s_lshl_b32 s23, s17, 10
  s_add_u32 s29, s29, s23
  s_add_u32 s29, s29, 57933824
  v_mfma_f32_32x32x16_bf16 v[208:223], a[160:163], a[132:135], 0
  s_waitcnt vmcnt(13)
  v_exp_f32 v192, v192
  v_exp_f32 v193, v193
  v_exp_f32 v194, v194
  v_cvt_pk_bf16_f32 v224, v192, v193
  v_mfma_f32_32x32x16_bf16 a[0:15], a[208:211], a[64:67], a[0:15]
  buffer_load_dwordx4 a[96:99], v3, s[8:11], s24 offen offset:0 sc1
  buffer_load_dwordx4 a[240:243], v3, s[8:11], s39 offen offset:0 sc1
  buffer_load_dwordx4 a[244:247], v3, s[8:11], s39 offen offset:1024 sc1
  buffer_load_dwordx4 a[100:103], v243, s[8:11], s24 offen offset:0 sc1
  v_exp_f32 v195, v195
  v_exp_f32 v196, v196
  v_cvt_pk_bf16_f32 v225, v194, v195
  v_exp_f32 v197, v197
  v_exp_f32 v198, v198
  v_mfma_f32_32x32x16_bf16 v[176:191], a[200:203], v[232:235], v[176:191]
  buffer_load_dwordx4 a[104:107], v3, s[8:11], s24 offen offset:1024 sc1
  buffer_load_dwordx4 a[248:251], v3, s[8:11], s39 offen offset:2048 sc1
  buffer_load_dwordx4 a[252:255], v3, s[8:11], s39 offen offset:3072 sc1
  buffer_load_dwordx4 a[108:111], v243, s[8:11], s24 offen offset:1024 sc1
  v_cvt_pk_bf16_f32 v226, v196, v197
  v_exp_f32 v199, v199
  v_exp_f32 v200, v200
  v_cvt_pk_bf16_f32 v227, v198, v199
  v_exp_f32 v201, v201
  v_mfma_f32_32x32x16_bf16 a[32:47], a[212:215], a[64:67], a[32:47]
  s_add_u32 s39, s39, 4096
  v_exp_f32 v202, v202
  v_cvt_pk_bf16_f32 v228, v200, v201
  v_exp_f32 v203, v203
  v_exp_f32 v204, v204
  v_cvt_pk_bf16_f32 v229, v202, v203
  v_mfma_f32_32x32x16_bf16 v[176:191], a[204:207], v[236:239], v[176:191]
  s_mov_b64 exec, s[30:31]
  buffer_load_dwordx4 a[200:203], v240, s[8:11], s21 offen offset:1024 sc1
  buffer_load_dwordx4 a[204:207], v240, s[8:11], s21 offen offset:1536 sc1
  s_mov_b64 exec, -1
  s_add_u32 s21, s21, 2048
  v_exp_f32 v205, v205
  v_exp_f32 v206, v206
  v_exp_f32 v207, v207
  v_cvt_pk_bf16_f32 v230, v204, v205
  v_cvt_pk_bf16_f32 v231, v206, v207
  v_mfma_f32_32x32x16_bf16 v[192:207], a[160:163], a[136:139], 0
  v_exp_f32 v208, v208
  v_exp_f32 v209, v209
  v_exp_f32 v210, v210
  v_cvt_pk_bf16_f32 v232, v208, v209
  v_mfma_f32_32x32x16_bf16 a[16:31], a[208:211], a[68:71], a[16:31]
  v_exp_f32 v211, v211
  v_exp_f32 v212, v212
  v_cvt_pk_bf16_f32 v233, v210, v211
  v_exp_f32 v213, v213
  v_exp_f32 v214, v214
  v_mfma_f32_32x32x16_bf16 v[64:79], a[176:179], v[224:227], v[64:79]
  v_cvt_pk_bf16_f32 v234, v212, v213
  v_exp_f32 v215, v215
  v_exp_f32 v216, v216
  v_cvt_pk_bf16_f32 v235, v214, v215
  v_exp_f32 v217, v217
  v_mfma_f32_32x32x16_bf16 a[48:63], a[212:215], a[68:71], a[48:63]
  v_exp_f32 v218, v218
  v_cvt_pk_bf16_f32 v236, v216, v217
  v_exp_f32 v219, v219
  v_exp_f32 v220, v220
  v_cvt_pk_bf16_f32 v237, v218, v219
  v_mfma_f32_32x32x16_bf16 v[64:79], a[180:183], v[228:231], v[64:79]
  v_exp_f32 v221, v221
  v_exp_f32 v222, v222
  v_exp_f32 v223, v223
  v_cvt_pk_bf16_f32 v238, v220, v221
  v_cvt_pk_bf16_f32 v239, v222, v223
  v_mfma_f32_32x32x16_bf16 v[208:223], a[160:163], a[140:143], 0
  s_waitcnt vmcnt(19)
  v_exp_f32 v192, v192
  v_exp_f32 v193, v193
  v_exp_f32 v194, v194
  v_cvt_pk_bf16_f32 v224, v192, v193
  v_mfma_f32_32x32x16_bf16 a[0:15], a[216:219], a[72:75], a[0:15]
  buffer_load_dwordx4 a[112:115], v3, s[8:11], s24 offen offset:2048 sc1
  buffer_load_dwordx4 v[16:19], v3, s[8:11], s39 offen offset:0 sc1
  buffer_load_dwordx4 v[20:23], v3, s[8:11], s39 offen offset:1024 sc1
  buffer_load_dwordx4 a[116:119], v243, s[8:11], s24 offen offset:2048 sc1
  v_exp_f32 v195, v195
  v_exp_f32 v196, v196
  v_cvt_pk_bf16_f32 v225, v194, v195
  v_exp_f32 v197, v197
  v_exp_f32 v198, v198
  v_mfma_f32_32x32x16_bf16 v[80:95], a[176:179], v[232:235], v[80:95]
  v_cvt_pk_bf16_f32 v226, v196, v197
  v_exp_f32 v199, v199
  v_exp_f32 v200, v200
  v_cvt_pk_bf16_f32 v227, v198, v199
  v_exp_f32 v201, v201
  v_mfma_f32_32x32x16_bf16 a[32:47], a[220:223], a[72:75], a[32:47]
  v_exp_f32 v202, v202
  v_cvt_pk_bf16_f32 v228, v200, v201
  v_exp_f32 v203, v203
  v_exp_f32 v204, v204
  v_cvt_pk_bf16_f32 v229, v202, v203
  v_mfma_f32_32x32x16_bf16 v[80:95], a[180:183], v[236:239], v[80:95]
  v_exp_f32 v205, v205
  v_exp_f32 v206, v206
  v_exp_f32 v207, v207
  v_cvt_pk_bf16_f32 v230, v204, v205
  v_cvt_pk_bf16_f32 v231, v206, v207
  v_mfma_f32_32x32x16_bf16 v[192:207], a[160:163], a[144:147], 0
  v_exp_f32 v208, v208
  v_exp_f32 v209, v209
  v_exp_f32 v210, v210
  v_cvt_pk_bf16_f32 v232, v208, v209
  v_mfma_f32_32x32x16_bf16 a[16:31], a[216:219], a[76:79], a[16:31]
  v_exp_f32 v211, v211
  v_exp_f32 v212, v212
  v_cvt_pk_bf16_f32 v233, v210, v211
  v_exp_f32 v213, v213
  v_exp_f32 v214, v214
  v_mfma_f32_32x32x16_bf16 v[96:111], a[176:179], v[224:227], v[96:111]
  v_cvt_pk_bf16_f32 v234, v212, v213
  v_exp_f32 v215, v215
  v_exp_f32 v216, v216
  v_cvt_pk_bf16_f32 v235, v214, v215
  v_exp_f32 v217, v217
  v_mfma_f32_32x32x16_bf16 a[48:63], a[220:223], a[76:79], a[48:63]
  v_exp_f32 v218, v218
  v_cvt_pk_bf16_f32 v236, v216, v217
  v_exp_f32 v219, v219
  v_exp_f32 v220, v220
  v_cvt_pk_bf16_f32 v237, v218, v219
  v_mfma_f32_32x32x16_bf16 v[96:111], a[180:183], v[228:231], v[96:111]
  v_exp_f32 v221, v221
  v_exp_f32 v222, v222
  v_exp_f32 v223, v223
  v_cvt_pk_bf16_f32 v238, v220, v221
  v_cvt_pk_bf16_f32 v239, v222, v223
  v_mfma_f32_32x32x16_bf16 v[208:223], a[160:163], a[148:151], 0
  s_waitcnt vmcnt(19)
  v_exp_f32 v192, v192
  v_exp_f32 v193, v193
  v_exp_f32 v194, v194
  v_cvt_pk_bf16_f32 v224, v192, v193
  v_mfma_f32_32x32x16_bf16 a[0:15], a[224:227], a[80:83], a[0:15]
  buffer_load_dwordx4 a[120:123], v3, s[8:11], s24 offen offset:3072 sc1
  buffer_load_dwordx4 v[24:27], v3, s[8:11], s39 offen offset:2048 sc1
  buffer_load_dwordx4 v[28:31], v3, s[8:11], s39 offen offset:3072 sc1
  buffer_load_dwordx4 a[124:127], v243, s[8:11], s24 offen offset:3072 sc1
  v_exp_f32 v195, v195
  v_exp_f32 v196, v196
  v_cvt_pk_bf16_f32 v225, v194, v195
  v_exp_f32 v197, v197
  v_exp_f32 v198, v198
  v_mfma_f32_32x32x16_bf16 v[112:127], a[176:179], v[232:235], v[112:127]
  s_add_u32 s39, s39, 4096
  v_cvt_pk_bf16_f32 v226, v196, v197
  v_exp_f32 v199, v199
  v_exp_f32 v200, v200
  v_cvt_pk_bf16_f32 v227, v198, v199
  v_exp_f32 v201, v201
  v_mfma_f32_32x32x16_bf16 a[32:47], a[228:231], a[80:83], a[32:47]
  s_add_u32 s24, s24, 4096
  v_exp_f32 v202, v202
  v_cvt_pk_bf16_f32 v228, v200, v201
  v_exp_f32 v203, v203
  v_exp_f32 v204, v204
  v_cvt_pk_bf16_f32 v229, v202, v203
  v_mfma_f32_32x32x16_bf16 v[112:127], a[180:183], v[236:239], v[112:127]
  v_exp_f32 v205, v205
  v_exp_f32 v206, v206
  v_exp_f32 v207, v207
  v_cvt_pk_bf16_f32 v230, v204, v205
  v_cvt_pk_bf16_f32 v231, v206, v207
  v_mfma_f32_32x32x16_bf16 v[192:207], a[160:163], a[152:155], 0
  v_exp_f32 v208, v208
  v_exp_f32 v209, v209
  v_exp_f32 v210, v210
  v_cvt_pk_bf16_f32 v232, v208, v209
  v_mfma_f32_32x32x16_bf16 a[16:31], a[224:227], a[84:87], a[16:31]
  v_exp_f32 v211, v211
  v_exp_f32 v212, v212
  v_cvt_pk_bf16_f32 v233, v210, v211
  v_exp_f32 v213, v213
  v_exp_f32 v214, v214
  v_mfma_f32_32x32x16_bf16 v[128:143], a[176:179], v[224:227], v[128:143]
  v_cvt_pk_bf16_f32 v234, v212, v213
  v_exp_f32 v215, v215
  v_exp_f32 v216, v216
  v_cvt_pk_bf16_f32 v235, v214, v215
  v_exp_f32 v217, v217
  v_mfma_f32_32x32x16_bf16 a[48:63], a[228:231], a[84:87], a[48:63]
  v_exp_f32 v218, v218
  v_cvt_pk_bf16_f32 v236, v216, v217
  v_exp_f32 v219, v219
  v_exp_f32 v220, v220
  v_cvt_pk_bf16_f32 v237, v218, v219
  v_mfma_f32_32x32x16_bf16 v[128:143], a[180:183], v[228:231], v[128:143]
  v_exp_f32 v221, v221
  v_exp_f32 v222, v222
  v_exp_f32 v223, v223
  v_cvt_pk_bf16_f32 v238, v220, v221
  v_cvt_pk_bf16_f32 v239, v222, v223
  v_mfma_f32_32x32x16_bf16 v[208:223], a[160:163], a[156:159], 0
  s_waitcnt vmcnt(18)
  v_exp_f32 v192, v192
  v_exp_f32 v193, v193
  v_exp_f32 v194, v194
  v_cvt_pk_bf16_f32 v224, v192, v193
  v_mfma_f32_32x32x16_bf16 a[0:15], a[232:235], a[88:91], a[0:15]
  buffer_load_dwordx4 a[64:67], v3, s[8:11], s24 offen offset:0 sc1
  buffer_load_dwordx4 a[208:211], v3, s[8:11], s39 offen offset:0 sc1
  buffer_load_dwordx4 a[212:215], v3, s[8:11], s39 offen offset:1024 sc1
  buffer_load_dwordx4 a[68:71], v243, s[8:11], s24 offen offset:0 sc1
  v_exp_f32 v195, v195
  v_exp_f32 v196, v196
  v_cvt_pk_bf16_f32 v225, v194, v195
  v_exp_f32 v197, v197
  v_exp_f32 v198, v198
  v_mfma_f32_32x32x16_bf16 v[144:159], a[176:179], v[232:235], v[144:159]
  v_cvt_pk_bf16_f32 v226, v196, v197
  v_exp_f32 v199, v199
  v_exp_f32 v200, v200
  v_cvt_pk_bf16_f32 v227, v198, v199
  v_exp_f32 v201, v201
  v_mfma_f32_32x32x16_bf16 a[32:47], a[236:239], a[88:91], a[32:47]
  v_exp_f32 v202, v202
  v_cvt_pk_bf16_f32 v228, v200, v201
  v_exp_f32 v203, v203
  v_exp_f32 v204, v204
  v_cvt_pk_bf16_f32 v229, v202, v203
  v_mfma_f32_32x32x16_bf16 v[144:159], a[180:183], v[236:239], v[144:159]
  v_exp_f32 v205, v205
  v_exp_f32 v206, v206
  v_exp_f32 v207, v207
  v_cvt_pk_bf16_f32 v230, v204, v205
  v_cvt_pk_bf16_f32 v231, v206, v207
  v_mfma_f32_32x32x16_bf16 v[192:207], a[164:167], a[128:131], 0
  v_exp_f32 v208, v208
  v_exp_f32 v209, v209
  v_exp_f32 v210, v210
  v_cvt_pk_bf16_f32 v232, v208, v209
  v_mfma_f32_32x32x16_bf16 a[16:31], a[232:235], a[92:95], a[16:31]
  v_exp_f32 v211, v211
  v_exp_f32 v212, v212
  v_cvt_pk_bf16_f32 v233, v210, v211
  v_exp_f32 v213, v213
  v_exp_f32 v214, v214
  v_mfma_f32_32x32x16_bf16 v[160:175], a[176:179], v[224:227], v[160:175]
  v_cvt_pk_bf16_f32 v234, v212, v213
  v_exp_f32 v215, v215
  v_exp_f32 v216, v216
  v_cvt_pk_bf16_f32 v235, v214, v215
  v_exp_f32 v217, v217
  v_mfma_f32_32x32x16_bf16 a[48:63], a[236:239], a[92:95], a[48:63]
  v_exp_f32 v218, v218
  v_cvt_pk_bf16_f32 v236, v216, v217
  v_exp_f32 v219, v219
  v_exp_f32 v220, v220
  v_cvt_pk_bf16_f32 v237, v218, v219
  v_mfma_f32_32x32x16_bf16 v[160:175], a[180:183], v[228:231], v[160:175]
  v_exp_f32 v221, v221
  v_exp_f32 v222, v222
  v_exp_f32 v223, v223
  v_cvt_pk_bf16_f32 v238, v220, v221
  v_cvt_pk_bf16_f32 v239, v222, v223
  v_mfma_f32_32x32x16_bf16 v[208:223], a[164:167], a[132:135], 0
  s_waitcnt vmcnt(18)
  v_exp_f32 v192, v192
  v_exp_f32 v193, v193
  v_exp_f32 v194, v194
  v_cvt_pk_bf16_f32 v224, v192, v193
  v_mfma_f32_32x32x16_bf16 a[0:15], a[240:243], a[96:99], a[0:15]
  buffer_load_dwordx4 a[72:75], v3, s[8:11], s24 offen offset:1024 sc1
  buffer_load_dwordx4 a[216:219], v3, s[8:11], s39 offen offset:2048 sc1
  buffer_load_dwordx4 a[220:223], v3, s[8:11], s39 offen offset:3072 sc1
  buffer_load_dwordx4 a[76:79], v243, s[8:11], s24 offen offset:1024 sc1
  v_exp_f32 v195, v195
  v_exp_f32 v196, v196
  v_cvt_pk_bf16_f32 v225, v194, v195
  v_exp_f32 v197, v197
  v_exp_f32 v198, v198
  v_mfma_f32_32x32x16_bf16 v[176:191], a[176:179], v[232:235], v[176:191]
  s_add_u32 s39, s39, 4096
  v_cvt_pk_bf16_f32 v226, v196, v197
  v_exp_f32 v199, v199
  v_exp_f32 v200, v200
  v_cvt_pk_bf16_f32 v227, v198, v199
  v_exp_f32 v201, v201
  v_mfma_f32_32x32x16_bf16 a[32:47], a[244:247], a[96:99], a[32:47]
  buffer_load_dwordx4 a[80:83], v3, s[8:11], s24 offen offset:2048 sc1
  buffer_load_dwordx4 a[224:227], v3, s[8:11], s39 offen offset:0 sc1
  buffer_load_dwordx4 a[228:231], v3, s[8:11], s39 offen offset:1024 sc1
  buffer_load_dwordx4 a[84:87], v243, s[8:11], s24 offen offset:2048 sc1
  v_exp_f32 v202, v202
  v_cvt_pk_bf16_f32 v228, v200, v201
  v_exp_f32 v203, v203
  v_exp_f32 v204, v204
  v_cvt_pk_bf16_f32 v229, v202, v203
  v_mfma_f32_32x32x16_bf16 v[176:191], a[180:183], v[236:239], v[176:191]
  v_exp_f32 v205, v205
  v_exp_f32 v206, v206
  v_exp_f32 v207, v207
  v_cvt_pk_bf16_f32 v230, v204, v205
  v_cvt_pk_bf16_f32 v231, v206, v207
  v_mfma_f32_32x32x16_bf16 v[192:207], a[164:167], a[136:139], 0
  v_exp_f32 v208, v208
  v_exp_f32 v209, v209
  v_exp_f32 v210, v210
  v_cvt_pk_bf16_f32 v232, v208, v209
  v_mfma_f32_32x32x16_bf16 a[16:31], a[240:243], a[100:103], a[16:31]
  v_exp_f32 v211, v211
  v_exp_f32 v212, v212
  v_cvt_pk_bf16_f32 v233, v210, v211
  v_exp_f32 v213, v213
  v_exp_f32 v214, v214
  v_mfma_f32_32x32x16_bf16 v[64:79], a[184:187], v[224:227], v[64:79]
  v_cvt_pk_bf16_f32 v234, v212, v213
  v_exp_f32 v215, v215
  v_exp_f32 v216, v216
  v_cvt_pk_bf16_f32 v235, v214, v215
  v_exp_f32 v217, v217
  v_mfma_f32_32x32x16_bf16 a[48:63], a[244:247], a[100:103], a[48:63]
  v_exp_f32 v218, v218
  v_cvt_pk_bf16_f32 v236, v216, v217
  v_exp_f32 v219, v219
  v_exp_f32 v220, v220
  v_cvt_pk_bf16_f32 v237, v218, v219
  v_mfma_f32_32x32x16_bf16 v[64:79], a[188:191], v[228:231], v[64:79]
  v_exp_f32 v221, v221
  v_exp_f32 v222, v222
  v_exp_f32 v223, v223
  v_cvt_pk_bf16_f32 v238, v220, v221
  v_cvt_pk_bf16_f32 v239, v222, v223
  v_mfma_f32_32x32x16_bf16 v[208:223], a[164:167], a[140:143], 0
  s_waitcnt vmcnt(22)
  v_exp_f32 v192, v192
  v_exp_f32 v193, v193
  v_exp_f32 v194, v194
  v_cvt_pk_bf16_f32 v224, v192, v193
  v_mfma_f32_32x32x16_bf16 a[0:15], a[248:251], a[104:107], a[0:15]
  buffer_load_dwordx4 a[88:91], v3, s[8:11], s24 offen offset:3072 sc1
  buffer_load_dwordx4 a[232:235], v3, s[8:11], s39 offen offset:2048 sc1
  buffer_load_dwordx4 a[236:239], v3, s[8:11], s39 offen offset:3072 sc1
  buffer_load_dwordx4 a[92:95], v243, s[8:11], s24 offen offset:3072 sc1
  v_exp_f32 v195, v195
  v_exp_f32 v196, v196
  v_cvt_pk_bf16_f32 v225, v194, v195
  v_exp_f32 v197, v197
  v_exp_f32 v198, v198
  v_mfma_f32_32x32x16_bf16 v[80:95], a[184:187], v[232:235], v[80:95]
  s_add_u32 s39, s39, 4096
  v_cvt_pk_bf16_f32 v226, v196, v197
  v_exp_f32 v199, v199
  v_exp_f32 v200, v200
  v_cvt_pk_bf16_f32 v227, v198, v199
  v_exp_f32 v201, v201
  v_mfma_f32_32x32x16_bf16 a[32:47], a[252:255], a[104:107], a[32:47]
  s_add_u32 s24, s24, 4096
  v_exp_f32 v202, v202
  v_cvt_pk_bf16_f32 v228, v200, v201
  v_exp_f32 v203, v203
  v_exp_f32 v204, v204
  v_cvt_pk_bf16_f32 v229, v202, v203
  v_mfma_f32_32x32x16_bf16 v[80:95], a[188:191], v[236:239], v[80:95]
  v_exp_f32 v205, v205
  v_exp_f32 v206, v206
  v_exp_f32 v207, v207
  v_cvt_pk_bf16_f32 v230, v204, v205
  v_cvt_pk_bf16_f32 v231, v206, v207
  v_mfma_f32_32x32x16_bf16 v[192:207], a[164:167], a[144:147], 0
  v_exp_f32 v208, v208
  v_exp_f32 v209, v209
  v_exp_f32 v210, v210
  v_cvt_pk_bf16_f32 v232, v208, v209
  v_mfma_f32_32x32x16_bf16 a[16:31], a[248:251], a[108:111], a[16:31]
  v_exp_f32 v211, v211
  v_exp_f32 v212, v212
  v_cvt_pk_bf16_f32 v233, v210, v211
  v_exp_f32 v213, v213
  v_exp_f32 v214, v214
  v_mfma_f32_32x32x16_bf16 v[96:111], a[184:187], v[224:227], v[96:111]
  v_cvt_pk_bf16_f32 v234, v212, v213
  v_exp_f32 v215, v215
  v_exp_f32 v216, v216
  v_cvt_pk_bf16_f32 v235, v214, v215
  v_exp_f32 v217, v217
  v_mfma_f32_32x32x16_bf16 a[48:63], a[252:255], a[108:111], a[48:63]
  v_exp_f32 v218, v218
  v_cvt_pk_bf16_f32 v236, v216, v217
  v_exp_f32 v219, v219
  v_exp_f32 v220, v220
  v_cvt_pk_bf16_f32 v237, v218, v219
  v_mfma_f32_32x32x16_bf16 v[96:111], a[188:191], v[228:231], v[96:111]
  v_exp_f32 v221, v221
  v_exp_f32 v222, v222
  v_exp_f32 v223, v223
  v_cvt_pk_bf16_f32 v238, v220, v221
  v_cvt_pk_bf16_f32 v239, v222, v223
  v_mfma_f32_32x32x16_bf16 v[208:223], a[164:167], a[148:151], 0
  s_waitcnt vmcnt(20)
  v_exp_f32 v192, v192
  v_exp_f32 v193, v193
  v_exp_f32 v194, v194
  v_cvt_pk_bf16_f32 v224, v192, v193
  v_mfma_f32_32x32x16_bf16 a[0:15], v[16:19], a[112:115], a[0:15]
  buffer_load_dwordx4 a[96:99], v3, s[8:11], s24 offen offset:0 sc1
  buffer_load_dwordx4 a[240:243], v3, s[8:11], s39 offen offset:0 sc1
  buffer_load_dwordx4 a[244:247], v3, s[8:11], s39 offen offset:1024 sc1
  buffer_load_dwordx4 a[100:103], v243, s[8:11], s24 offen offset:0 sc1
  v_exp_f32 v195, v195
  v_exp_f32 v196, v196
  v_cvt_pk_bf16_f32 v225, v194, v195
  v_exp_f32 v197, v197
  v_exp_f32 v198, v198
  v_mfma_f32_32x32x16_bf16 v[112:127], a[184:187], v[232:235], v[112:127]
  v_cvt_pk_bf16_f32 v226, v196, v197
  v_exp_f32 v199, v199
  v_exp_f32 v200, v200
  v_cvt_pk_bf16_f32 v227, v198, v199
  v_exp_f32 v201, v201
  v_mfma_f32_32x32x16_bf16 a[32:47], v[20:23], a[112:115], a[32:47]
  v_exp_f32 v202, v202
  v_cvt_pk_bf16_f32 v228, v200, v201
  v_exp_f32 v203, v203
  v_exp_f32 v204, v204
  v_cvt_pk_bf16_f32 v229, v202, v203
  v_mfma_f32_32x32x16_bf16 v[112:127], a[188:191], v[236:239], v[112:127]
  v_exp_f32 v205, v205
  v_exp_f32 v206, v206
  v_exp_f32 v207, v207
  v_cvt_pk_bf16_f32 v230, v204, v205
  v_cvt_pk_bf16_f32 v231, v206, v207
  v_mfma_f32_32x32x16_bf16 v[192:207], a[164:167], a[152:155], 0
  v_exp_f32 v208, v208
  v_exp_f32 v209, v209
  v_exp_f32 v210, v210
  v_cvt_pk_bf16_f32 v232, v208, v209
  v_mfma_f32_32x32x16_bf16 a[16:31], v[16:19], a[116:119], a[16:31]
  v_exp_f32 v211, v211
  v_exp_f32 v212, v212
  v_cvt_pk_bf16_f32 v233, v210, v211
  v_exp_f32 v213, v213
  v_exp_f32 v214, v214
  v_mfma_f32_32x32x16_bf16 v[128:143], a[184:187], v[224:227], v[128:143]
  v_cvt_pk_bf16_f32 v234, v212, v213
  v_exp_f32 v215, v215
  v_exp_f32 v216, v216
  v_cvt_pk_bf16_f32 v235, v214, v215
  v_exp_f32 v217, v217
  v_mfma_f32_32x32x16_bf16 a[48:63], v[20:23], a[116:119], a[48:63]
  v_exp_f32 v218, v218
  v_cvt_pk_bf16_f32 v236, v216, v217
  v_exp_f32 v219, v219
  v_exp_f32 v220, v220
  v_cvt_pk_bf16_f32 v237, v218, v219
  v_mfma_f32_32x32x16_bf16 v[128:143], a[188:191], v[228:231], v[128:143]
  v_exp_f32 v221, v221
  v_exp_f32 v222, v222
  v_exp_f32 v223, v223
  v_cvt_pk_bf16_f32 v238, v220, v221
  v_cvt_pk_bf16_f32 v239, v222, v223
  v_mfma_f32_32x32x16_bf16 v[208:223], a[164:167], a[156:159], 0
  s_waitcnt vmcnt(20)
  v_exp_f32 v192, v192
  v_exp_f32 v193, v193
  v_exp_f32 v194, v194
  v_cvt_pk_bf16_f32 v224, v192, v193
  v_mfma_f32_32x32x16_bf16 a[0:15], v[24:27], a[120:123], a[0:15]
  buffer_load_dwordx4 a[104:107], v3, s[8:11], s24 offen offset:1024 sc1
  buffer_load_dwordx4 a[248:251], v3, s[8:11], s39 offen offset:2048 sc1
  buffer_load_dwordx4 a[252:255], v3, s[8:11], s39 offen offset:3072 sc1
  buffer_load_dwordx4 a[108:111], v243, s[8:11], s24 offen offset:1024 sc1
  v_exp_f32 v195, v195
  v_exp_f32 v196, v196
  v_cvt_pk_bf16_f32 v225, v194, v195
  v_exp_f32 v197, v197
  v_exp_f32 v198, v198
  v_mfma_f32_32x32x16_bf16 v[144:159], a[184:187], v[232:235], v[144:159]
  s_add_u32 s39, s39, 4096
  v_cvt_pk_bf16_f32 v226, v196, v197
  v_exp_f32 v199, v199
  v_exp_f32 v200, v200
  v_cvt_pk_bf16_f32 v227, v198, v199
  v_exp_f32 v201, v201
  v_mfma_f32_32x32x16_bf16 a[32:47], v[28:31], a[120:123], a[32:47]
  v_exp_f32 v202, v202
  v_cvt_pk_bf16_f32 v228, v200, v201
  v_exp_f32 v203, v203
  v_exp_f32 v204, v204
  v_cvt_pk_bf16_f32 v229, v202, v203
  v_mfma_f32_32x32x16_bf16 v[144:159], a[188:191], v[236:239], v[144:159]
  v_exp_f32 v205, v205
  v_exp_f32 v206, v206
  v_exp_f32 v207, v207
  v_cvt_pk_bf16_f32 v230, v204, v205
  v_cvt_pk_bf16_f32 v231, v206, v207
  v_mfma_f32_32x32x16_bf16 v[192:207], a[168:171], a[128:131], 0
  v_exp_f32 v208, v208
  v_exp_f32 v209, v209
  v_exp_f32 v210, v210
  v_cvt_pk_bf16_f32 v232, v208, v209
  v_mfma_f32_32x32x16_bf16 a[16:31], v[24:27], a[124:127], a[16:31]
  v_exp_f32 v211, v211
  v_exp_f32 v212, v212
  v_cvt_pk_bf16_f32 v233, v210, v211
  v_exp_f32 v213, v213
  v_exp_f32 v214, v214
  v_mfma_f32_32x32x16_bf16 v[160:175], a[184:187], v[224:227], v[160:175]
  v_cvt_pk_bf16_f32 v234, v212, v213
  v_exp_f32 v215, v215
  v_exp_f32 v216, v216
  v_cvt_pk_bf16_f32 v235, v214, v215
  v_exp_f32 v217, v217
  v_mfma_f32_32x32x16_bf16 a[48:63], v[28:31], a[124:127], a[48:63]
  v_exp_f32 v218, v218
  v_cvt_pk_bf16_f32 v236, v216, v217
  v_exp_f32 v219, v219
  v_exp_f32 v220, v220
  v_cvt_pk_bf16_f32 v237, v218, v219
  v_mfma_f32_32x32x16_bf16 v[160:175], a[188:191], v[228:231], v[160:175]
  v_exp_f32 v221, v221
  v_exp_f32 v222, v222
  v_exp_f32 v223, v223
  v_cvt_pk_bf16_f32 v238, v220, v221
  v_cvt_pk_bf16_f32 v239, v222, v223
  v_mfma_f32_32x32x16_bf16 v[208:223], a[168:171], a[132:135], 0
  s_waitcnt vmcnt(20)
  v_exp_f32 v192, v192
  v_exp_f32 v193, v193
  v_exp_f32 v194, v194
  v_cvt_pk_bf16_f32 v224, v192, v193
  v_mfma_f32_32x32x16_bf16 a[0:15], a[208:211], a[64:67], a[0:15]
  buffer_load_dwordx4 a[112:115], v3, s[8:11], s24 offen offset:2048 sc1
  buffer_load_dwordx4 v[16:19], v3, s[8:11], s39 offen offset:0 sc1
  buffer_load_dwordx4 v[20:23], v3, s[8:11], s39 offen offset:1024 sc1
  buffer_load_dwordx4 a[116:119], v243, s[8:11], s24 offen offset:2048 sc1
  v_exp_f32 v195, v195
  v_exp_f32 v196, v196
  v_cvt_pk_bf16_f32 v225, v194, v195
  v_exp_f32 v197, v197
  v_exp_f32 v198, v198
  v_mfma_f32_32x32x16_bf16 v[176:191], a[184:187], v[232:235], v[176:191]
  buffer_load_dwordx4 a[120:123], v3, s[8:11], s24 offen offset:3072 sc1
  buffer_load_dwordx4 v[24:27], v3, s[8:11], s39 offen offset:2048 sc1
  buffer_load_dwordx4 v[28:31], v3, s[8:11], s39 offen offset:3072 sc1
  buffer_load_dwordx4 a[124:127], v243, s[8:11], s24 offen offset:3072 sc1
  v_cvt_pk_bf16_f32 v226, v196, v197
  v_exp_f32 v199, v199
  v_exp_f32 v200, v200
  v_cvt_pk_bf16_f32 v227, v198, v199
  v_exp_f32 v201, v201
  v_mfma_f32_32x32x16_bf16 a[32:47], a[212:215], a[64:67], a[32:47]
  s_add_u32 s39, s39, 4096
  v_exp_f32 v202, v202
  v_cvt_pk_bf16_f32 v228, v200, v201
  v_exp_f32 v203, v203
  v_exp_f32 v204, v204
  v_cvt_pk_bf16_f32 v229, v202, v203
  v_mfma_f32_32x32x16_bf16 v[176:191], a[188:191], v[236:239], v[176:191]
  s_add_u32 s24, s24, 4096
  v_exp_f32 v205, v205
  v_exp_f32 v206, v206
  v_exp_f32 v207, v207
  v_cvt_pk_bf16_f32 v230, v204, v205
  v_cvt_pk_bf16_f32 v231, v206, v207
  v_mfma_f32_32x32x16_bf16 v[192:207], a[168:171], a[136:139], 0
  v_exp_f32 v208, v208
  v_exp_f32 v209, v209
  v_exp_f32 v210, v210
  v_cvt_pk_bf16_f32 v232, v208, v209
  v_mfma_f32_32x32x16_bf16 a[16:31], a[208:211], a[68:71], a[16:31]
  v_exp_f32 v211, v211
  v_exp_f32 v212, v212
  v_cvt_pk_bf16_f32 v233, v210, v211
  v_exp_f32 v213, v213
  v_exp_f32 v214, v214
  v_mfma_f32_32x32x16_bf16 v[64:79], a[192:195], v[224:227], v[64:79]
  v_cvt_pk_bf16_f32 v234, v212, v213
  v_exp_f32 v215, v215
  v_exp_f32 v216, v216
  v_cvt_pk_bf16_f32 v235, v214, v215
  v_exp_f32 v217, v217
  v_mfma_f32_32x32x16_bf16 a[48:63], a[212:215], a[68:71], a[48:63]
  v_exp_f32 v218, v218
  v_cvt_pk_bf16_f32 v236, v216, v217
  v_exp_f32 v219, v219
  v_exp_f32 v220, v220
  v_cvt_pk_bf16_f32 v237, v218, v219
  v_mfma_f32_32x32x16_bf16 v[64:79], a[196:199], v[228:231], v[64:79]
  v_exp_f32 v221, v221
  v_exp_f32 v222, v222
  v_exp_f32 v223, v223
  v_cvt_pk_bf16_f32 v238, v220, v221
  v_cvt_pk_bf16_f32 v239, v222, v223
  v_mfma_f32_32x32x16_bf16 v[208:223], a[168:171], a[140:143], 0
  s_waitcnt vmcnt(24)
  v_exp_f32 v192, v192
  v_exp_f32 v193, v193
  v_exp_f32 v194, v194
  v_cvt_pk_bf16_f32 v224, v192, v193
  v_mfma_f32_32x32x16_bf16 a[0:15], a[216:219], a[72:75], a[0:15]
  buffer_load_dwordx4 a[64:67], v3, s[8:11], s24 offen offset:0 sc1
  buffer_load_dwordx4 a[208:211], v3, s[8:11], s39 offen offset:0 sc1
  buffer_load_dwordx4 a[212:215], v3, s[8:11], s39 offen offset:1024 sc1
  buffer_load_dwordx4 a[68:71], v243, s[8:11], s24 offen offset:0 sc1
  v_exp_f32 v195, v195
  v_exp_f32 v196, v196
  v_cvt_pk_bf16_f32 v225, v194, v195
  v_exp_f32 v197, v197
  v_exp_f32 v198, v198
  v_mfma_f32_32x32x16_bf16 v[80:95], a[192:195], v[232:235], v[80:95]
  v_cvt_pk_bf16_f32 v226, v196, v197
  v_exp_f32 v199, v199
  v_exp_f32 v200, v200
  v_cvt_pk_bf16_f32 v227, v198, v199
  v_exp_f32 v201, v201
  v_mfma_f32_32x32x16_bf16 a[32:47], a[220:223], a[72:75], a[32:47]
  v_exp_f32 v202, v202
  v_cvt_pk_bf16_f32 v228, v200, v201
  v_exp_f32 v203, v203
  v_exp_f32 v204, v204
  v_cvt_pk_bf16_f32 v229, v202, v203
  v_mfma_f32_32x32x16_bf16 v[80:95], a[196:199], v[236:239], v[80:95]
  v_exp_f32 v205, v205
  v_exp_f32 v206, v206
  v_exp_f32 v207, v207
  v_cvt_pk_bf16_f32 v230, v204, v205
  v_cvt_pk_bf16_f32 v231, v206, v207
  v_mfma_f32_32x32x16_bf16 v[192:207], a[168:171], a[144:147], 0
  v_exp_f32 v208, v208
  v_exp_f32 v209, v209
  v_exp_f32 v210, v210
  v_cvt_pk_bf16_f32 v232, v208, v209
  v_mfma_f32_32x32x16_bf16 a[16:31], a[216:219], a[76:79], a[16:31]
  v_exp_f32 v211, v211
  v_exp_f32 v212, v212
  v_cvt_pk_bf16_f32 v233, v210, v211
  v_exp_f32 v213, v213
  v_exp_f32 v214, v214
  v_mfma_f32_32x32x16_bf16 v[96:111], a[192:195], v[224:227], v[96:111]
  v_cvt_pk_bf16_f32 v234, v212, v213
  v_exp_f32 v215, v215
  v_exp_f32 v216, v216
  v_cvt_pk_bf16_f32 v235, v214, v215
  v_exp_f32 v217, v217
  v_mfma_f32_32x32x16_bf16 a[48:63], a[220:223], a[76:79], a[48:63]
  v_exp_f32 v218, v218
  v_cvt_pk_bf16_f32 v236, v216, v217
  v_exp_f32 v219, v219
  v_exp_f32 v220, v220
  v_cvt_pk_bf16_f32 v237, v218, v219
  v_mfma_f32_32x32x16_bf16 v[96:111], a[196:199], v[228:231], v[96:111]
  v_exp_f32 v221, v221
  v_exp_f32 v222, v222
  v_exp_f32 v223, v223
  v_cvt_pk_bf16_f32 v238, v220, v221
  v_cvt_pk_bf16_f32 v239, v222, v223
  v_mfma_f32_32x32x16_bf16 v[208:223], a[168:171], a[148:151], 0
  s_waitcnt vmcnt(24)
  v_exp_f32 v192, v192
  v_exp_f32 v193, v193
  v_exp_f32 v194, v194
  v_cvt_pk_bf16_f32 v224, v192, v193
  v_mfma_f32_32x32x16_bf16 a[0:15], a[224:227], a[80:83], a[0:15]
  buffer_load_dwordx4 a[72:75], v3, s[8:11], s24 offen offset:1024 sc1
  buffer_load_dwordx4 a[216:219], v3, s[8:11], s39 offen offset:2048 sc1
  buffer_load_dwordx4 a[220:223], v3, s[8:11], s39 offen offset:3072 sc1
  buffer_load_dwordx4 a[76:79], v243, s[8:11], s24 offen offset:1024 sc1
  v_exp_f32 v195, v195
  v_exp_f32 v196, v196
  v_cvt_pk_bf16_f32 v225, v194, v195
  v_exp_f32 v197, v197
  v_exp_f32 v198, v198
  v_mfma_f32_32x32x16_bf16 v[112:127], a[192:195], v[232:235], v[112:127]
  s_add_u32 s39, s39, 4096
  v_cvt_pk_bf16_f32 v226, v196, v197
  v_exp_f32 v199, v199
  v_exp_f32 v200, v200
  v_cvt_pk_bf16_f32 v227, v198, v199
  v_exp_f32 v201, v201
  v_mfma_f32_32x32x16_bf16 a[32:47], a[228:231], a[80:83], a[32:47]
  v_exp_f32 v202, v202
  v_cvt_pk_bf16_f32 v228, v200, v201
  v_exp_f32 v203, v203
  v_exp_f32 v204, v204
  v_cvt_pk_bf16_f32 v229, v202, v203
  v_mfma_f32_32x32x16_bf16 v[112:127], a[196:199], v[236:239], v[112:127]
  v_exp_f32 v205, v205
  v_exp_f32 v206, v206
  v_exp_f32 v207, v207
  v_cvt_pk_bf16_f32 v230, v204, v205
  v_cvt_pk_bf16_f32 v231, v206, v207
  v_mfma_f32_32x32x16_bf16 v[192:207], a[168:171], a[152:155], 0
  v_exp_f32 v208, v208
  v_exp_f32 v209, v209
  v_exp_f32 v210, v210
  v_cvt_pk_bf16_f32 v232, v208, v209
  v_mfma_f32_32x32x16_bf16 a[16:31], a[224:227], a[84:87], a[16:31]
  v_exp_f32 v211, v211
  v_exp_f32 v212, v212
  v_cvt_pk_bf16_f32 v233, v210, v211
  v_exp_f32 v213, v213
  v_exp_f32 v214, v214
  v_mfma_f32_32x32x16_bf16 v[128:143], a[192:195], v[224:227], v[128:143]
  v_cvt_pk_bf16_f32 v234, v212, v213
  v_exp_f32 v215, v215
  v_exp_f32 v216, v216
  v_cvt_pk_bf16_f32 v235, v214, v215
  v_exp_f32 v217, v217
  v_mfma_f32_32x32x16_bf16 a[48:63], a[228:231], a[84:87], a[48:63]
  v_exp_f32 v218, v218
  v_cvt_pk_bf16_f32 v236, v216, v217
  v_exp_f32 v219, v219
  v_exp_f32 v220, v220
  v_cvt_pk_bf16_f32 v237, v218, v219
  v_mfma_f32_32x32x16_bf16 v[128:143], a[196:199], v[228:231], v[128:143]
  v_exp_f32 v221, v221
  v_exp_f32 v222, v222
  v_exp_f32 v223, v223
  v_cvt_pk_bf16_f32 v238, v220, v221
  v_cvt_pk_bf16_f32 v239, v222, v223
  v_mfma_f32_32x32x16_bf16 v[208:223], a[168:171], a[156:159], 0
  s_waitcnt vmcnt(24)
  v_exp_f32 v192, v192
  v_exp_f32 v193, v193
  v_exp_f32 v194, v194
  v_cvt_pk_bf16_f32 v224, v192, v193
  v_mfma_f32_32x32x16_bf16 a[0:15], a[232:235], a[88:91], a[0:15]
  buffer_load_dwordx4 a[80:83], v3, s[8:11], s24 offen offset:2048 sc1
  buffer_load_dwordx4 a[224:227], v3, s[8:11], s39 offen offset:0 sc1
  buffer_load_dwordx4 a[228:231], v3, s[8:11], s39 offen offset:1024 sc1
  buffer_load_dwordx4 a[84:87], v243, s[8:11], s24 offen offset:2048 sc1
  v_exp_f32 v195, v195
  v_exp_f32 v196, v196
  v_cvt_pk_bf16_f32 v225, v194, v195
  v_exp_f32 v197, v197
  v_exp_f32 v198, v198
  v_mfma_f32_32x32x16_bf16 v[144:159], a[192:195], v[232:235], v[144:159]
  v_cvt_pk_bf16_f32 v226, v196, v197
  v_exp_f32 v199, v199
  v_exp_f32 v200, v200
  v_cvt_pk_bf16_f32 v227, v198, v199
  v_exp_f32 v201, v201
  v_mfma_f32_32x32x16_bf16 a[32:47], a[236:239], a[88:91], a[32:47]
  v_exp_f32 v202, v202
  v_cvt_pk_bf16_f32 v228, v200, v201
  v_exp_f32 v203, v203
  v_exp_f32 v204, v204
  v_cvt_pk_bf16_f32 v229, v202, v203
  v_mfma_f32_32x32x16_bf16 v[144:159], a[196:199], v[236:239], v[144:159]
  v_exp_f32 v205, v205
  v_exp_f32 v206, v206
  v_exp_f32 v207, v207
  v_cvt_pk_bf16_f32 v230, v204, v205
  v_cvt_pk_bf16_f32 v231, v206, v207
  v_mfma_f32_32x32x16_bf16 v[192:207], a[172:175], a[128:131], 0
  v_exp_f32 v208, v208
  v_exp_f32 v209, v209
  v_exp_f32 v210, v210
  v_cvt_pk_bf16_f32 v232, v208, v209
  v_mfma_f32_32x32x16_bf16 a[16:31], a[232:235], a[92:95], a[16:31]
  v_exp_f32 v211, v211
  v_exp_f32 v212, v212
  v_cvt_pk_bf16_f32 v233, v210, v211
  v_exp_f32 v213, v213
  v_exp_f32 v214, v214
  v_mfma_f32_32x32x16_bf16 v[160:175], a[192:195], v[224:227], v[160:175]
  v_cvt_pk_bf16_f32 v234, v212, v213
  v_exp_f32 v215, v215
  v_exp_f32 v216, v216
  v_cvt_pk_bf16_f32 v235, v214, v215
  v_exp_f32 v217, v217
  v_mfma_f32_32x32x16_bf16 a[48:63], a[236:239], a[92:95], a[48:63]
  v_exp_f32 v218, v218
  v_cvt_pk_bf16_f32 v236, v216, v217
  v_exp_f32 v219, v219
  v_exp_f32 v220, v220
  v_cvt_pk_bf16_f32 v237, v218, v219
  v_mfma_f32_32x32x16_bf16 v[160:175], a[196:199], v[228:231], v[160:175]
  v_exp_f32 v221, v221
  v_exp_f32 v222, v222
  v_exp_f32 v223, v223
  v_cvt_pk_bf16_f32 v238, v220, v221
  v_cvt_pk_bf16_f32 v239, v222, v223
  v_mfma_f32_32x32x16_bf16 v[208:223], a[172:175], a[132:135], 0
  s_waitcnt vmcnt(24)
  v_exp_f32 v192, v192
  v_exp_f32 v193, v193
  v_exp_f32 v194, v194
  v_cvt_pk_bf16_f32 v224, v192, v193
  v_mfma_f32_32x32x16_bf16 a[0:15], a[240:243], a[96:99], a[0:15]
  buffer_load_dwordx4 a[88:91], v3, s[8:11], s24 offen offset:3072 sc1
  buffer_load_dwordx4 a[232:235], v3, s[8:11], s39 offen offset:2048 sc1
  buffer_load_dwordx4 a[236:239], v3, s[8:11], s39 offen offset:3072 sc1
  buffer_load_dwordx4 a[92:95], v243, s[8:11], s24 offen offset:3072 sc1
  v_exp_f32 v195, v195
  v_exp_f32 v196, v196
  v_cvt_pk_bf16_f32 v225, v194, v195
  v_exp_f32 v197, v197
  v_exp_f32 v198, v198
  v_mfma_f32_32x32x16_bf16 v[176:191], a[192:195], v[232:235], v[176:191]
  s_add_u32 s39, s39, 4096
  v_cvt_pk_bf16_f32 v226, v196, v197
  v_exp_f32 v199, v199
  v_exp_f32 v200, v200
  v_cvt_pk_bf16_f32 v227, v198, v199
  v_exp_f32 v201, v201
  v_mfma_f32_32x32x16_bf16 a[32:47], a[244:247], a[96:99], a[32:47]
  s_add_u32 s24, s24, 4096
  v_exp_f32 v202, v202
  v_cvt_pk_bf16_f32 v228, v200, v201
  v_exp_f32 v203, v203
  v_exp_f32 v204, v204
  v_cvt_pk_bf16_f32 v229, v202, v203
  v_mfma_f32_32x32x16_bf16 v[176:191], a[196:199], v[236:239], v[176:191]
  v_exp_f32 v205, v205
  v_exp_f32 v206, v206
  v_exp_f32 v207, v207
  v_cvt_pk_bf16_f32 v230, v204, v205
  v_cvt_pk_bf16_f32 v231, v206, v207
  v_mfma_f32_32x32x16_bf16 v[192:207], a[172:175], a[136:139], 0
  v_exp_f32 v208, v208
  v_exp_f32 v209, v209
  v_exp_f32 v210, v210
  v_cvt_pk_bf16_f32 v232, v208, v209
  v_mfma_f32_32x32x16_bf16 a[16:31], a[240:243], a[100:103], a[16:31]
  v_exp_f32 v211, v211
  v_exp_f32 v212, v212
  v_cvt_pk_bf16_f32 v233, v210, v211
  v_exp_f32 v213, v213
  v_exp_f32 v214, v214
  v_mfma_f32_32x32x16_bf16 v[64:79], a[200:203], v[224:227], v[64:79]
  v_cvt_pk_bf16_f32 v234, v212, v213
  v_exp_f32 v215, v215
  v_exp_f32 v216, v216
  v_cvt_pk_bf16_f32 v235, v214, v215
  v_exp_f32 v217, v217
  v_mfma_f32_32x32x16_bf16 a[48:63], a[244:247], a[100:103], a[48:63]
  buffer_load_dwordx4 a[96:99], v3, s[8:11], s24 offen offset:0 sc1
  buffer_load_dwordx4 a[240:243], v3, s[8:11], s39 offen offset:0 sc1
  buffer_load_dwordx4 a[244:247], v3, s[8:11], s39 offen offset:1024 sc1
  buffer_load_dwordx4 a[100:103], v243, s[8:11], s24 offen offset:0 sc1
  v_exp_f32 v218, v218
  v_cvt_pk_bf16_f32 v236, v216, v217
  v_exp_f32 v219, v219
  v_exp_f32 v220, v220
  v_cvt_pk_bf16_f32 v237, v218, v219
  v_mfma_f32_32x32x16_bf16 v[64:79], a[204:207], v[228:231], v[64:79]
  v_exp_f32 v221, v221
  v_exp_f32 v222, v222
  v_exp_f32 v223, v223
  v_cvt_pk_bf16_f32 v238, v220, v221
  v_cvt_pk_bf16_f32 v239, v222, v223
  v_mfma_f32_32x32x16_bf16 v[208:223], a[172:175], a[140:143], 0
  s_waitcnt vmcnt(28)
  v_exp_f32 v192, v192
  v_exp_f32 v193, v193
  v_exp_f32 v194, v194
  v_cvt_pk_bf16_f32 v224, v192, v193
  v_mfma_f32_32x32x16_bf16 a[0:15], a[248:251], a[104:107], a[0:15]
  v_exp_f32 v195, v195
  v_exp_f32 v196, v196
  v_cvt_pk_bf16_f32 v225, v194, v195
  v_exp_f32 v197, v197
  v_exp_f32 v198, v198
  v_mfma_f32_32x32x16_bf16 v[80:95], a[200:203], v[232:235], v[80:95]
  ds_write_b128 v251, v[64:67] offset:0
  v_cvt_pk_bf16_f32 v226, v196, v197
  v_exp_f32 v199, v199
  v_exp_f32 v200, v200
  v_cvt_pk_bf16_f32 v227, v198, v199
  v_exp_f32 v201, v201
  v_mfma_f32_32x32x16_bf16 a[32:47], a[252:255], a[104:107], a[32:47]
  ds_write_b128 v251, v[68:71] offset:1024
  v_exp_f32 v202, v202
  v_cvt_pk_bf16_f32 v228, v200, v201
  v_exp_f32 v203, v203
  v_exp_f32 v204, v204
  v_cvt_pk_bf16_f32 v229, v202, v203
  v_mfma_f32_32x32x16_bf16 v[80:95], a[204:207], v[236:239], v[80:95]
  ds_write_b32 v254, v72 offset:0
  v_exp_f32 v205, v205
  v_exp_f32 v206, v206
  v_exp_f32 v207, v207
  v_cvt_pk_bf16_f32 v230, v204, v205
  v_cvt_pk_bf16_f32 v231, v206, v207
  v_mfma_f32_32x32x16_bf16 v[192:207], a[172:175], a[144:147], 0
  v_exp_f32 v208, v208
  v_exp_f32 v209, v209
  v_exp_f32 v210, v210
  v_cvt_pk_bf16_f32 v232, v208, v209
  v_mfma_f32_32x32x16_bf16 a[16:31], a[248:251], a[108:111], a[16:31]
  v_exp_f32 v211, v211
  v_exp_f32 v212, v212
  v_cvt_pk_bf16_f32 v233, v210, v211
  v_exp_f32 v213, v213
  v_exp_f32 v214, v214
  v_mfma_f32_32x32x16_bf16 v[96:111], a[200:203], v[224:227], v[96:111]
  ds_write_b128 v251, v[80:83] offset:2048
  v_cvt_pk_bf16_f32 v234, v212, v213
  v_exp_f32 v215, v215
  v_exp_f32 v216, v216
  v_cvt_pk_bf16_f32 v235, v214, v215
  v_exp_f32 v217, v217
  v_mfma_f32_32x32x16_bf16 a[48:63], a[252:255], a[108:111], a[48:63]
  ds_write_b128 v251, v[84:87] offset:3072
  v_exp_f32 v218, v218
  v_cvt_pk_bf16_f32 v236, v216, v217
  v_exp_f32 v219, v219
  v_exp_f32 v220, v220
  v_cvt_pk_bf16_f32 v237, v218, v219
  v_mfma_f32_32x32x16_bf16 v[96:111], a[204:207], v[228:231], v[96:111]
  ds_write_b32 v254, v88 offset:512
  v_exp_f32 v221, v221
  v_exp_f32 v222, v222
  v_exp_f32 v223, v223
  v_cvt_pk_bf16_f32 v238, v220, v221
  v_cvt_pk_bf16_f32 v239, v222, v223
  v_mfma_f32_32x32x16_bf16 v[208:223], a[172:175], a[148:151], 0
  s_waitcnt vmcnt(24)
  v_exp_f32 v192, v192
  v_exp_f32 v193, v193
  v_exp_f32 v194, v194
  v_cvt_pk_bf16_f32 v224, v192, v193
  v_mfma_f32_32x32x16_bf16 a[0:15], v[16:19], a[112:115], a[0:15]
  buffer_load_dwordx4 a[104:107], v3, s[8:11], s24 offen offset:1024 sc1
  buffer_load_dwordx4 a[248:251], v3, s[8:11], s39 offen offset:2048 sc1
  buffer_load_dwordx4 a[252:255], v3, s[8:11], s39 offen offset:3072 sc1
  buffer_load_dwordx4 a[108:111], v243, s[8:11], s24 offen offset:1024 sc1
  v_exp_f32 v195, v195
  v_exp_f32 v196, v196
  v_cvt_pk_bf16_f32 v225, v194, v195
  v_exp_f32 v197, v197
  v_exp_f32 v198, v198
  v_mfma_f32_32x32x16_bf16 v[112:127], a[200:203], v[232:235], v[112:127]
  ds_write_b128 v251, v[96:99] offset:4096
  v_cvt_pk_bf16_f32 v226, v196, v197
  v_exp_f32 v199, v199
  v_exp_f32 v200, v200
  v_cvt_pk_bf16_f32 v227, v198, v199
  v_exp_f32 v201, v201
  v_mfma_f32_32x32x16_bf16 a[32:47], v[20:23], a[112:115], a[32:47]
  ds_write_b128 v251, v[100:103] offset:5120
  v_exp_f32 v202, v202
  v_cvt_pk_bf16_f32 v228, v200, v201
  v_exp_f32 v203, v203
  v_exp_f32 v204, v204
  v_cvt_pk_bf16_f32 v229, v202, v203
  v_mfma_f32_32x32x16_bf16 v[112:127], a[204:207], v[236:239], v[112:127]
  ds_write_b32 v254, v104 offset:1024
  v_exp_f32 v205, v205
  v_exp_f32 v206, v206
  v_exp_f32 v207, v207
  v_cvt_pk_bf16_f32 v230, v204, v205
  v_cvt_pk_bf16_f32 v231, v206, v207
  v_mfma_f32_32x32x16_bf16 v[192:207], a[172:175], a[152:155], 0
  s_add_u32 s39, s39, 4096
  v_exp_f32 v208, v208
  v_exp_f32 v209, v209
  v_exp_f32 v210, v210
  v_cvt_pk_bf16_f32 v232, v208, v209
  v_mfma_f32_32x32x16_bf16 a[16:31], v[16:19], a[116:119], a[16:31]
  v_exp_f32 v211, v211
  v_exp_f32 v212, v212
  v_cvt_pk_bf16_f32 v233, v210, v211
  v_exp_f32 v213, v213
  v_exp_f32 v214, v214
  v_mfma_f32_32x32x16_bf16 v[128:143], a[200:203], v[224:227], v[128:143]
  ds_write_b128 v251, v[112:115] offset:6144
  v_cvt_pk_bf16_f32 v234, v212, v213
  v_exp_f32 v215, v215
  v_exp_f32 v216, v216
  v_cvt_pk_bf16_f32 v235, v214, v215
  v_exp_f32 v217, v217
  v_mfma_f32_32x32x16_bf16 a[48:63], v[20:23], a[116:119], a[48:63]
  ds_write_b128 v251, v[116:119] offset:7168
  v_exp_f32 v218, v218
  v_cvt_pk_bf16_f32 v236, v216, v217
  v_exp_f32 v219, v219
  v_exp_f32 v220, v220
  v_cvt_pk_bf16_f32 v237, v218, v219
  v_mfma_f32_32x32x16_bf16 v[128:143], a[204:207], v[228:231], v[128:143]
  ds_write_b32 v254, v120 offset:1536
  v_exp_f32 v221, v221
  v_exp_f32 v222, v222
  v_exp_f32 v223, v223
  v_cvt_pk_bf16_f32 v238, v220, v221
  v_cvt_pk_bf16_f32 v239, v222, v223
  v_mfma_f32_32x32x16_bf16 v[208:223], a[172:175], a[156:159], 0
  s_waitcnt vmcnt(24)
  v_exp_f32 v192, v192
  v_exp_f32 v193, v193
  v_exp_f32 v194, v194
  v_cvt_pk_bf16_f32 v224, v192, v193
  v_mfma_f32_32x32x16_bf16 a[0:15], v[24:27], a[120:123], a[0:15]
  buffer_load_dwordx4 a[112:115], v3, s[8:11], s24 offen offset:2048 sc1
  buffer_load_dwordx4 v[16:19], v3, s[8:11], s39 offen offset:0 sc1
  buffer_load_dwordx4 v[20:23], v3, s[8:11], s39 offen offset:1024 sc1
  buffer_load_dwordx4 a[116:119], v243, s[8:11], s24 offen offset:2048 sc1
  v_exp_f32 v195, v195
  v_exp_f32 v196, v196
  v_cvt_pk_bf16_f32 v225, v194, v195
  v_exp_f32 v197, v197
  v_exp_f32 v198, v198
  v_mfma_f32_32x32x16_bf16 v[144:159], a[200:203], v[232:235], v[144:159]
  ds_write_b128 v251, v[128:131] offset:8192
  v_cvt_pk_bf16_f32 v226, v196, v197
  v_exp_f32 v199, v199
  v_exp_f32 v200, v200
  v_cvt_pk_bf16_f32 v227, v198, v199
  v_exp_f32 v201, v201
  v_mfma_f32_32x32x16_bf16 a[32:47], v[28:31], a[120:123], a[32:47]
  ds_write_b128 v251, v[132:135] offset:9216
  v_exp_f32 v202, v202
  v_cvt_pk_bf16_f32 v228, v200, v201
  v_exp_f32 v203, v203
  v_exp_f32 v204, v204
  v_cvt_pk_bf16_f32 v229, v202, v203
  v_mfma_f32_32x32x16_bf16 v[144:159], a[204:207], v[236:239], v[144:159]
  ds_write_b32 v254, v136 offset:2048
  v_exp_f32 v205, v205
  v_exp_f32 v206, v206
  v_exp_f32 v207, v207
  v_cvt_pk_bf16_f32 v230, v204, v205
  v_cvt_pk_bf16_f32 v231, v206, v207
  v_exp_f32 v208, v208
  v_exp_f32 v209, v209
  v_exp_f32 v210, v210
  v_cvt_pk_bf16_f32 v232, v208, v209
  v_mfma_f32_32x32x16_bf16 a[16:31], v[24:27], a[124:127], a[16:31]
  v_exp_f32 v211, v211
  v_exp_f32 v212, v212
  v_cvt_pk_bf16_f32 v233, v210, v211
  v_exp_f32 v213, v213
  v_exp_f32 v214, v214
  v_mfma_f32_32x32x16_bf16 v[160:175], a[200:203], v[224:227], v[160:175]
  ds_write_b128 v251, v[144:147] offset:10240
  v_cvt_pk_bf16_f32 v234, v212, v213
  v_exp_f32 v215, v215
  v_exp_f32 v216, v216
  v_cvt_pk_bf16_f32 v235, v214, v215
  v_exp_f32 v217, v217
  v_mfma_f32_32x32x16_bf16 a[48:63], v[28:31], a[124:127], a[48:63]
  ds_write_b128 v251, v[148:151] offset:11264
  v_exp_f32 v218, v218
  v_cvt_pk_bf16_f32 v236, v216, v217
  v_exp_f32 v219, v219
  v_exp_f32 v220, v220
  v_cvt_pk_bf16_f32 v237, v218, v219
  v_mfma_f32_32x32x16_bf16 v[160:175], a[204:207], v[228:231], v[160:175]
  ds_write_b32 v254, v152 offset:2560
  v_exp_f32 v221, v221
  v_exp_f32 v222, v222
  v_exp_f32 v223, v223
  v_cvt_pk_bf16_f32 v238, v220, v221
  v_cvt_pk_bf16_f32 v239, v222, v223
  buffer_load_dwordx4 a[120:123], v3, s[8:11], s24 offen offset:3072 sc1
  buffer_load_dwordx4 v[24:27], v3, s[8:11], s39 offen offset:2048 sc1
  buffer_load_dwordx4 v[28:31], v3, s[8:11], s39 offen offset:3072 sc1
  buffer_load_dwordx4 a[124:127], v243, s[8:11], s24 offen offset:3072 sc1
  s_add_u32 s39, s39, 4096
  s_add_u32 s24, s24, 4096
  s_nop 0
  v_mfma_f32_32x32x16_bf16 v[176:191], a[200:203], v[232:235], v[176:191]
  v_mfma_f32_32x32x16_bf16 v[176:191], a[204:207], v[236:239], v[176:191]
  s_nop 3
  ds_write_b128 v251, v[160:163] offset:12288
  ds_write_b128 v251, v[164:167] offset:13312
  ds_write_b32 v254, v168 offset:3072
  s_nop 4
  ds_write_b128 v251, v[176:179] offset:14336
  ds_write_b128 v251, v[180:183] offset:15360
  ds_write_b32 v254, v184 offset:3584
  s_waitcnt vmcnt(63) lgkmcnt(0)
  s_barrier
  ds_read_b128 v[4:7], v253 offset:0
  ds_read_b128 v[8:11], v253 offset:512
  ds_read_b128 v[192:195], v252 offset:0
  ds_read_b128 v[196:199], v252 offset:512
  ds_read_b128 v[200:203], v252 offset:16384
  ds_read_b128 v[204:207], v252 offset:16896
  ds_read_b128 v[208:211], v252 offset:32768
  ds_read_b128 v[212:215], v252 offset:33280
  ds_read_b128 v[216:219], v252 offset:49152
  ds_read_b128 v[220:223], v252 offset:49664
  ds_read_b128 v[32:35], v252 offset:2048
  ds_read_b128 v[36:39], v252 offset:2560
  ds_read_b128 v[40:43], v252 offset:18432
  ds_read_b128 v[44:47], v252 offset:18944
  ds_read_b128 v[48:51], v252 offset:34816
  ds_read_b128 v[52:55], v252 offset:35328
  ds_read_b128 v[56:59], v252 offset:51200
  ds_read_b128 v[60:63], v252 offset:51712
  s_waitcnt lgkmcnt(15)
  v_pk_add_f32 v[4:5], v[4:5], v[6:7]
  v_pk_add_f32 v[8:9], v[8:9], v[10:11]
  v_add_f32 v4, v4, v5
  v_add_f32 v8, v8, v9
  v_rcp_f32 v6, v4
  v_rcp_f32 v10, v8
  s_nop 0
  v_mul_f32 v6, v6, v241
  v_mul_f32 v10, v10, v242
  s_waitcnt lgkmcnt(12)
  v_pk_add_f32 v[192:193], v[192:193], v[200:201]
  v_pk_add_f32 v[194:195], v[194:195], v[202:203]
  v_pk_add_f32 v[196:197], v[196:197], v[204:205]
  v_pk_add_f32 v[198:199], v[198:199], v[206:207]
  s_waitcnt lgkmcnt(8)
  v_pk_add_f32 v[208:209], v[208:209], v[216:217]
  v_pk_add_f32 v[210:211], v[210:211], v[218:219]
  v_pk_add_f32 v[212:213], v[212:213], v[220:221]
  v_pk_add_f32 v[214:215], v[214:215], v[222:223]
  v_pk_add_f32 v[192:193], v[192:193], v[208:209]
  v_pk_add_f32 v[194:195], v[194:195], v[210:211]
  v_pk_add_f32 v[196:197], v[196:197], v[212:213]
  v_pk_add_f32 v[198:199], v[198:199], v[214:215]
  v_pk_mul_f32 v[192:193], v[192:193], v[6:7] op_sel_hi:[1,0]
  v_pk_mul_f32 v[194:195], v[194:195], v[6:7] op_sel_hi:[1,0]
  v_pk_mul_f32 v[196:197], v[196:197], v[6:7] op_sel_hi:[1,0]
  v_pk_mul_f32 v[198:199], v[198:199], v[6:7] op_sel_hi:[1,0]
  v_cvt_pk_bf16_f32 v200, v192, v193
  v_cvt_pk_bf16_f32 v201, v194, v195
  v_cvt_pk_bf16_f32 v202, v196, v197
  v_cvt_pk_bf16_f32 v203, v198, v199
  buffer_store_dwordx4 v[200:203], v3, s[8:11], s29 offen sc1
  s_waitcnt lgkmcnt(4)
  v_pk_add_f32 v[32:33], v[32:33], v[40:41]
  v_pk_add_f32 v[34:35], v[34:35], v[42:43]
  v_pk_add_f32 v[36:37], v[36:37], v[44:45]
  v_pk_add_f32 v[38:39], v[38:39], v[46:47]
  s_waitcnt lgkmcnt(0)
  v_pk_add_f32 v[48:49], v[48:49], v[56:57]
  v_pk_add_f32 v[50:51], v[50:51], v[58:59]
  v_pk_add_f32 v[52:53], v[52:53], v[60:61]
  v_pk_add_f32 v[54:55], v[54:55], v[62:63]
  v_pk_add_f32 v[32:33], v[32:33], v[48:49]
  v_pk_add_f32 v[34:35], v[34:35], v[50:51]
  v_pk_add_f32 v[36:37], v[36:37], v[52:53]
  v_pk_add_f32 v[38:39], v[38:39], v[54:55]
  v_pk_mul_f32 v[32:33], v[32:33], v[10:11] op_sel_hi:[1,0]
  v_pk_mul_f32 v[34:35], v[34:35], v[10:11] op_sel_hi:[1,0]
  v_pk_mul_f32 v[36:37], v[36:37], v[10:11] op_sel_hi:[1,0]
  v_pk_mul_f32 v[38:39], v[38:39], v[10:11] op_sel_hi:[1,0]
  v_cvt_pk_bf16_f32 v40, v32, v33
  v_cvt_pk_bf16_f32 v41, v34, v35
  v_cvt_pk_bf16_f32 v42, v36, v37
  v_cvt_pk_bf16_f32 v43, v38, v39
  buffer_store_dwordx4 v[40:43], v243, s[8:11], s29 offen sc1
  v_cmp_nle_f32 vcc, 0x2b800000, v4
  s_mov_b64 s[70:71], vcc
  v_cmp_nge_f32 vcc, 0x5f800000, v4
  s_or_b64 s[70:71], s[70:71], vcc
  v_cmp_nle_f32 vcc, 0x2b800000, v8
  s_or_b64 s[70:71], s[70:71], vcc
  v_cmp_nge_f32 vcc, 0x5f800000, v8
  s_or_b64 s[70:71], s[70:71], vcc
  s_cbranch_scc1 P4_SLOW
P4_STORE:
  s_waitcnt vmcnt(2)
  v_mfma_f32_32x32x16_bf16 a[0:15], a[208:211], a[64:67], a[0:15]
  s_add_u32 s22, s26, 65536
  v_add_u32 v251, s22, v3
  s_lshl_b32 s22, s16, 12
  v_mfma_f32_32x32x16_bf16 a[0:15], a[216:219], a[72:75], a[0:15]
  s_add_u32 s22, s22, 65536
  v_add_u32 v254, s22, v3
  v_subrev_u32 v244, s26, v244
  v_mfma_f32_32x32x16_bf16 a[0:15], a[224:227], a[80:83], a[0:15]
  s_lshr_b32 s22, s16, 1
  s_lshl_b32 s22, s22, 6
  v_xor_b32 v244, s22, v244
  v_mfma_f32_32x32x16_bf16 a[0:15], a[232:235], a[88:91], a[0:15]
  s_and_b32 s22, s16, 1
  s_lshl_b32 s22, s22, 13
  s_add_u32 s22, s22, 65536
  v_mfma_f32_32x32x16_bf16 a[0:15], a[240:243], a[96:99], a[0:15]
  ds_read_b64_tr_b16 v[64:65], v244 offset:0
  ds_read_b64_tr_b16 v[66:67], v244 offset:512
  ds_read_b64_tr_b16 v[68:69], v244 offset:2048
  v_add_u32 v245, s22, v3
  v_add_u32 v255, 65536, v245
  s_lshr_b32 s22, s16, 1
  v_mfma_f32_32x32x16_bf16 a[0:15], a[248:251], a[104:107], a[0:15]
  ds_read_b64_tr_b16 v[70:71], v244 offset:2560
  ds_read_b64_tr_b16 v[72:73], v244 offset:4096
  ds_read_b64_tr_b16 v[74:75], v244 offset:4608
  s_mul_i32 s22, s22, 294912
  s_add_u32 s24, s27, s22
  s_and_b32 s22, s16, 1
  v_mfma_f32_32x32x16_bf16 a[0:15], v[16:19], a[112:115], a[0:15]
  ds_read_b64_tr_b16 v[76:77], v244 offset:6144
  ds_read_b64_tr_b16 v[78:79], v244 offset:6656
  ds_read_b64_tr_b16 v[80:81], v244 offset:8192
  s_lshl_b32 s22, s22, 12
  s_add_u32 s24, s24, s22
  s_add_u32 s24, s24, 262144
  v_mfma_f32_32x32x16_bf16 a[0:15], v[24:27], a[120:123], a[0:15]
  ds_read_b64_tr_b16 v[82:83], v244 offset:8704
  ds_read_b64_tr_b16 v[84:85], v244 offset:10240
  ds_read_b64_tr_b16 v[86:87], v244 offset:10752
  s_lshr_b32 s26, s26, 2
  s_waitcnt vmcnt(0)
  s_barrier
  s_cmp_lg_u32 s16, 0
  s_cbranch_scc1 P4_S4
  s_lshl_b32 s36, s18, 7
  s_lshl_b32 s37, s17, 2
  s_add_u32 s36, s36, s37
  s_add_u32 s36, s36, 81794048
  v_mov_b32 v252, 1
  s_mov_b64 exec, 1
  buffer_store_dword v252, off, s[8:11], s36 sc1
  s_mov_b64 exec, -1
P4_S4:
  v_mfma_f32_32x32x16_bf16 a[16:31], a[208:211], a[68:71], a[16:31]
  ds_read_b64_tr_b16 v[88:89], v244 offset:12288
  ds_read_b64_tr_b16 v[90:91], v244 offset:12800
  ds_read_b64_tr_b16 v[92:93], v244 offset:14336
  v_mfma_f32_32x32x16_bf16 a[16:31], a[216:219], a[76:79], a[16:31]
  ds_read_b64_tr_b16 v[94:95], v244 offset:14848
  ds_read_b64_tr_b16 v[96:97], v244 offset:16384
  ds_read_b64_tr_b16 v[98:99], v244 offset:16896
  v_mfma_f32_32x32x16_bf16 a[16:31], a[224:227], a[84:87], a[16:31]
  ds_read_b64_tr_b16 v[100:101], v244 offset:18432
  ds_read_b64_tr_b16 v[102:103], v244 offset:18944
  ds_read_b64_tr_b16 v[104:105], v244 offset:20480
  v_mfma_f32_32x32x16_bf16 a[16:31], a[232:235], a[92:95], a[16:31]
  ds_read_b64_tr_b16 v[106:107], v244 offset:20992
  ds_read_b64_tr_b16 v[108:109], v244 offset:22528
  ds_read_b64_tr_b16 v[110:111], v244 offset:23040
  v_mfma_f32_32x32x16_bf16 a[16:31], a[240:243], a[100:103], a[16:31]
  ds_read_b64_tr_b16 v[112:113], v244 offset:24576
  ds_read_b64_tr_b16 v[114:115], v244 offset:25088
  ds_read_b64_tr_b16 v[116:117], v244 offset:26624
  ds_write_b128 v251, a[0:3] offset:0
  v_mfma_f32_32x32x16_bf16 a[16:31], a[248:251], a[108:111], a[16:31]
  ds_read_b64_tr_b16 v[118:119], v244 offset:27136
  ds_read_b64_tr_b16 v[120:121], v244 offset:28672
  ds_read_b64_tr_b16 v[122:123], v244 offset:29184
  ds_write_b128 v251, a[4:7] offset:1024
  v_mfma_f32_32x32x16_bf16 a[16:31], v[16:19], a[116:119], a[16:31]
  ds_read_b64_tr_b16 v[124:125], v244 offset:30720
  ds_read_b64_tr_b16 v[126:127], v244 offset:31232
  ds_read_b64_tr_b16 v[128:129], v244 offset:32768
  ds_write_b128 v251, a[8:11] offset:2048
  v_mfma_f32_32x32x16_bf16 a[16:31], v[24:27], a[124:127], a[16:31]
  ds_read_b64_tr_b16 v[130:131], v244 offset:33280
  ds_read_b64_tr_b16 v[132:133], v244 offset:34816
  ds_read_b64_tr_b16 v[134:135], v244 offset:35328
  ds_write_b128 v251, a[12:15] offset:3072
  v_mfma_f32_32x32x16_bf16 a[32:47], a[212:215], a[64:67], a[32:47]
  ds_read_b64_tr_b16 v[136:137], v244 offset:36864
  ds_read_b64_tr_b16 v[138:139], v244 offset:37376
  ds_read_b64_tr_b16 v[140:141], v244 offset:38912
  v_mfma_f32_32x32x16_bf16 a[32:47], a[220:223], a[72:75], a[32:47]
  ds_read_b64_tr_b16 v[142:143], v244 offset:39424
  ds_read_b64_tr_b16 v[144:145], v244 offset:40960
  ds_read_b64_tr_b16 v[146:147], v244 offset:41472
  v_mfma_f32_32x32x16_bf16 a[32:47], a[228:231], a[80:83], a[32:47]
  ds_read_b64_tr_b16 v[148:149], v244 offset:43008
  ds_read_b64_tr_b16 v[150:151], v244 offset:43520
  ds_read_b64_tr_b16 v[152:153], v244 offset:45056
  v_mfma_f32_32x32x16_bf16 a[32:47], a[236:239], a[88:91], a[32:47]
  ds_read_b64_tr_b16 v[154:155], v244 offset:45568
  ds_read_b64_tr_b16 v[156:157], v244 offset:47104
  ds_read_b64_tr_b16 v[158:159], v244 offset:47616
  v_mfma_f32_32x32x16_bf16 a[32:47], a[244:247], a[96:99], a[32:47]
  ds_read_b64_tr_b16 v[160:161], v244 offset:49152
  ds_read_b64_tr_b16 v[162:163], v244 offset:49664
  ds_read_b64_tr_b16 v[164:165], v244 offset:51200
  ds_write_b128 v251, a[16:19] offset:4096
  v_mfma_f32_32x32x16_bf16 a[32:47], a[252:255], a[104:107], a[32:47]
  ds_read_b64_tr_b16 v[166:167], v244 offset:51712
  ds_read_b64_tr_b16 v[168:169], v244 offset:53248
  ds_read_b64_tr_b16 v[170:171], v244 offset:53760
  ds_write_b128 v251, a[20:23] offset:5120
  v_mfma_f32_32x32x16_bf16 a[32:47], v[20:23], a[112:115], a[32:47]
  ds_read_b64_tr_b16 v[172:173], v244 offset:55296
  ds_read_b64_tr_b16 v[174:175], v244 offset:55808
  ds_read_b64_tr_b16 v[176:177], v244 offset:57344
  ds_write_b128 v251, a[24:27] offset:6144
  v_mfma_f32_32x32x16_bf16 a[32:47], v[28:31], a[120:123], a[32:47]
  ds_read_b64_tr_b16 v[178:179], v244 offset:57856
  ds_read_b64_tr_b16 v[180:181], v244 offset:59392
  ds_read_b64_tr_b16 v[182:183], v244 offset:59904
  ds_write_b128 v251, a[28:31] offset:7168
  v_mfma_f32_32x32x16_bf16 a[48:63], a[212:215], a[68:71], a[48:63]
  ds_read_b64_tr_b16 v[184:185], v244 offset:61440
  ds_read_b64_tr_b16 v[186:187], v244 offset:61952
  ds_read_b64_tr_b16 v[188:189], v244 offset:63488
  v_mfma_f32_32x32x16_bf16 a[48:63], a[220:223], a[76:79], a[48:63]
  ds_read_b64_tr_b16 v[190:191], v244 offset:64000
  s_nop 2
  s_cmp_lg_u32 s16, 0
  s_cbranch_scc1 P4_L4
  s_lshr_b32 s36, s17, 2
  s_lshl_b32 s36, s36, 7
  s_add_u32 s36, s36, 81794048
  v_and_b32 v253, 31, v250
  v_lshlrev_b32 v253, 2, v253
  buffer_load_dword v252, v253, s[8:11], s36 offen sc1
P4_L4:
  v_mfma_f32_32x32x16_bf16 a[48:63], a[228:231], a[84:87], a[48:63]
  s_nop 2
  v_mfma_f32_32x32x16_bf16 a[48:63], a[236:239], a[92:95], a[48:63]
  s_nop 2
  v_mfma_f32_32x32x16_bf16 a[48:63], a[244:247], a[100:103], a[48:63]
  ds_write_b128 v251, a[32:35] offset:8192
  v_mfma_f32_32x32x16_bf16 a[48:63], a[252:255], a[108:111], a[48:63]
  ds_write_b128 v251, a[36:39] offset:9216
  v_mfma_f32_32x32x16_bf16 a[48:63], v[20:23], a[116:119], a[48:63]
  ds_write_b128 v251, a[40:43] offset:10240
  v_mfma_f32_32x32x16_bf16 a[48:63], v[28:31], a[124:127], a[48:63]
  ds_write_b128 v251, a[44:47] offset:11264
  s_nop 11
  ds_write_b128 v251, a[48:51] offset:12288
  ds_write_b128 v251, a[52:55] offset:13312
  ds_write_b128 v251, a[56:59] offset:14336
  ds_write_b128 v251, a[60:63] offset:15360
  s_waitcnt lgkmcnt(0)
  s_cmp_lg_u32 s16, 0
  s_cbranch_scc1 P4_C4
  s_mov_b32 s37, 0x100000
  s_waitcnt vmcnt(0)
P4_C4L:
  v_cmp_ne_u32 vcc, 1, v252
  s_nop 0
  s_cbranch_vccz P4_C4
  s_sleep 4
  buffer_load_dword v252, v253, s[8:11], s36 offen sc1
  s_waitcnt vmcnt(0)
  s_sub_u32 s37, s37, 1
  s_cmp_lg_u32 s37, 0
  s_cbranch_scc1 P4_C4L
P4_C4:
  s_barrier
  s_add_u32 m0, s26, 131072
  s_add_u32 s23, s24, 0
  buffer_load_dwordx4 v3, s[8:11], s23 offen offset:0 sc1 lds
  ds_read_b128 v[192:195], v254 offset:0
  ds_read_b128 v[196:199], v254 offset:1024
  ds_read_b128 v[200:203], v254 offset:2048
  buffer_load_dwordx4 v3, s[8:11], s23 offen offset:1024 sc1 lds
  ds_read_b128 v[204:207], v254 offset:3072
  ds_read_b128 v[208:211], v254 offset:16384
  ds_read_b128 v[212:215], v254 offset:17408
  buffer_load_dwordx4 v3, s[8:11], s23 offen offset:2048 sc1 lds
  ds_read_b128 v[216:219], v254 offset:18432
  ds_read_b128 v[220:223], v254 offset:19456
  ds_read_b128 v[224:227], v254 offset:32768
  buffer_load_dwordx4 v3, s[8:11], s23 offen offset:3072 sc1 lds
  ds_read_b128 v[228:231], v254 offset:33792
  ds_read_b128 v[232:235], v254 offset:34816
  ds_read_b128 v[236:239], v254 offset:35840
  s_add_u32 m0, s26, 147456
  s_add_u32 s23, s24, 8192
  buffer_load_dwordx4 v3, s[8:11], s23 offen offset:0 sc1 lds
  ds_read_b128 v[32:35], v254 offset:49152
  ds_read_b128 v[36:39], v254 offset:50176
  ds_read_b128 v[40:43], v254 offset:51200
  buffer_load_dwordx4 v3, s[8:11], s23 offen offset:1024 sc1 lds
  ds_read_b128 v[44:47], v254 offset:52224
  buffer_load_dwordx4 v3, s[8:11], s23 offen offset:2048 sc1 lds
  buffer_load_dwordx4 v3, s[8:11], s23 offen offset:3072 sc1 lds
  s_waitcnt lgkmcnt(0)
  s_barrier
  s_add_u32 m0, s26, 65536
  s_add_u32 s23, s24, 16384
  buffer_load_dwordx4 v3, s[8:11], s23 offen offset:0 sc1 lds
  v_pk_add_f32 v[192:193], v[192:193], v[208:209]
  v_pk_add_f32 v[224:225], v[224:225], v[32:33]
  v_pk_add_f32 v[194:195], v[194:195], v[210:211]
  buffer_load_dwordx4 v3, s[8:11], s23 offen offset:1024 sc1 lds
  v_pk_add_f32 v[226:227], v[226:227], v[34:35]
  v_pk_add_f32 v[196:197], v[196:197], v[212:213]
  v_pk_add_f32 v[228:229], v[228:229], v[36:37]
  buffer_load_dwordx4 v3, s[8:11], s23 offen offset:2048 sc1 lds
  v_pk_add_f32 v[198:199], v[198:199], v[214:215]
  v_pk_add_f32 v[230:231], v[230:231], v[38:39]
  v_pk_add_f32 v[200:201], v[200:201], v[216:217]
  buffer_load_dwordx4 v3, s[8:11], s23 offen offset:3072 sc1 lds
  v_pk_add_f32 v[232:233], v[232:233], v[40:41]
  v_pk_add_f32 v[202:203], v[202:203], v[218:219]
  v_pk_add_f32 v[234:235], v[234:235], v[42:43]
  s_add_u32 m0, s26, 81920
  s_add_u32 s23, s24, 24576
  buffer_load_dwordx4 v3, s[8:11], s23 offen offset:0 sc1 lds
  v_pk_add_f32 v[204:205], v[204:205], v[220:221]
  v_pk_add_f32 v[236:237], v[236:237], v[44:45]
  v_pk_add_f32 v[206:207], v[206:207], v[222:223]
  buffer_load_dwordx4 v3, s[8:11], s23 offen offset:1024 sc1 lds
  v_pk_add_f32 v[238:239], v[238:239], v[46:47]
  v_pk_add_f32 v[192:193], v[192:193], v[224:225]
  v_pk_add_f32 v[194:195], v[194:195], v[226:227]
  buffer_load_dwordx4 v3, s[8:11], s23 offen offset:2048 sc1 lds
  v_pk_add_f32 v[196:197], v[196:197], v[228:229]
  v_pk_add_f32 v[198:199], v[198:199], v[230:231]
  v_pk_add_f32 v[200:201], v[200:201], v[232:233]
  buffer_load_dwordx4 v3, s[8:11], s23 offen offset:3072 sc1 lds
  v_pk_add_f32 v[202:203], v[202:203], v[234:235]
  v_pk_add_f32 v[204:205], v[204:205], v[236:237]
  v_pk_add_f32 v[206:207], v[206:207], v[238:239]
  s_waitcnt vmcnt(8)
  s_barrier
  ds_read_b128 a[64:67], v255 offset:0
  ds_read_b128 a[68:71], v255 offset:1024
  ds_read_b128 a[72:75], v255 offset:2048
  ds_read_b128 a[76:79], v255 offset:3072
  ds_read_b128 a[80:83], v255 offset:4096
  ds_read_b128 a[84:87], v255 offset:5120
  ds_read_b128 a[88:91], v255 offset:6144
  ds_read_b128 a[92:95], v255 offset:7168
  ds_read_b128 a[96:99], v255 offset:16384
  ds_read_b128 a[100:103], v255 offset:17408
  ds_read_b128 a[104:107], v255 offset:18432
  ds_read_b128 a[108:111], v255 offset:19456
  s_waitcnt lgkmcnt(10)
  v_mfma_f32_32x32x16_bf16 v[192:207], v[64:67], a[64:67], v[192:207]
  ds_read_b128 a[112:115], v255 offset:20480
  ds_read_b128 a[116:119], v255 offset:21504
  v_mfma_f32_32x32x16_bf16 v[192:207], v[68:71], a[68:71], v[192:207]
  ds_read_b128 a[120:123], v255 offset:22528
  ds_read_b128 a[124:127], v255 offset:23552
  s_waitcnt lgkmcnt(8)
  v_mfma_f32_32x32x16_bf16 v[192:207], v[72:75], a[72:75], v[192:207]
  v_mfma_f32_32x32x16_bf16 v[192:207], v[76:79], a[76:79], v[192:207]
  v_mfma_f32_32x32x16_bf16 v[192:207], v[80:83], a[80:83], v[192:207]
  v_mfma_f32_32x32x16_bf16 v[192:207], v[84:87], a[84:87], v[192:207]
  v_mfma_f32_32x32x16_bf16 v[192:207], v[88:91], a[88:91], v[192:207]
  v_mfma_f32_32x32x16_bf16 v[192:207], v[92:95], a[92:95], v[192:207]
  s_waitcnt lgkmcnt(0)
  v_mfma_f32_32x32x16_bf16 v[192:207], v[96:99], a[96:99], v[192:207]
  v_mfma_f32_32x32x16_bf16 v[192:207], v[100:103], a[100:103], v[192:207]
  s_waitcnt vmcnt(4)
  s_barrier
  v_mfma_f32_32x32x16_bf16 v[192:207], v[104:107], a[104:107], v[192:207]
  ds_read_b128 a[128:131], v245 offset:0
  ds_read_b128 a[132:135], v245 offset:1024
  v_mfma_f32_32x32x16_bf16 v[192:207], v[108:111], a[108:111], v[192:207]
  ds_read_b128 a[136:139], v245 offset:2048
  ds_read_b128 a[140:143], v245 offset:3072
  v_mfma_f32_32x32x16_bf16 v[192:207], v[112:115], a[112:115], v[192:207]
  ds_read_b128 a[144:147], v245 offset:4096
  ds_read_b128 a[148:151], v245 offset:5120
  v_mfma_f32_32x32x16_bf16 v[192:207], v[116:119], a[116:119], v[192:207]
  ds_read_b128 a[152:155], v245 offset:6144
  ds_read_b128 a[156:159], v245 offset:7168
  v_mfma_f32_32x32x16_bf16 v[192:207], v[120:123], a[120:123], v[192:207]
  v_mfma_f32_32x32x16_bf16 v[192:207], v[124:127], a[124:127], v[192:207]
  s_waitcnt lgkmcnt(0)
  v_mfma_f32_32x32x16_bf16 v[192:207], v[128:131], a[128:131], v[192:207]
  v_mfma_f32_32x32x16_bf16 v[192:207], v[132:135], a[132:135], v[192:207]
  s_waitcnt vmcnt(0)
  s_barrier
  v_mfma_f32_32x32x16_bf16 v[192:207], v[136:139], a[136:139], v[192:207]
  ds_read_b128 a[160:163], v245 offset:16384
  ds_read_b128 a[164:167], v245 offset:17408
  v_mfma_f32_32x32x16_bf16 v[192:207], v[140:143], a[140:143], v[192:207]
  ds_read_b128 a[168:171], v245 offset:18432
  ds_read_b128 a[172:175], v245 offset:19456
  v_mfma_f32_32x32x16_bf16 v[192:207], v[144:147], a[144:147], v[192:207]
  ds_read_b128 a[176:179], v245 offset:20480
  ds_read_b128 a[180:183], v245 offset:21504
  v_mfma_f32_32x32x16_bf16 v[192:207], v[148:151], a[148:151], v[192:207]
  ds_read_b128 a[184:187], v245 offset:22528
  ds_read_b128 a[188:191], v245 offset:23552
  v_mfma_f32_32x32x16_bf16 v[192:207], v[152:155], a[152:155], v[192:207]
  v_mfma_f32_32x32x16_bf16 v[192:207], v[156:159], a[156:159], v[192:207]
  s_waitcnt lgkmcnt(0)
  v_mfma_f32_32x32x16_bf16 v[192:207], v[160:163], a[160:163], v[192:207]
  v_and_b32 v253, 31, v250
  v_lshlrev_b32 v253, 10, v253
  v_lshrrev_b32 v251, 5, v250
  v_mfma_f32_32x32x16_bf16 v[192:207], v[164:167], a[164:167], v[192:207]
  v_lshl_add_u32 v253, v251, 4, v253
  s_lshl_b32 s22, s17, 16
  s_and_b32 s23, s16, 1
  v_mfma_f32_32x32x16_bf16 v[192:207], v[168:171], a[168:171], v[192:207]
  s_lshl_b32 s23, s23, 15
  s_add_u32 s22, s22, s23
  s_lshl_b32 s23, s18, 7
  v_mfma_f32_32x32x16_bf16 v[192:207], v[172:175], a[172:175], v[192:207]
  s_add_u32 s22, s22, s23
  s_lshr_b32 s23, s16, 1
  s_lshl_b32 s23, s23, 6
  v_mfma_f32_32x32x16_bf16 v[192:207], v[176:179], a[176:179], v[192:207]
  s_add_u32 s22, s22, s23
  v_mfma_f32_32x32x16_bf16 v[192:207], v[180:183], a[180:183], v[192:207]
  v_mfma_f32_32x32x16_bf16 v[192:207], v[184:187], a[184:187], v[192:207]
  v_mfma_f32_32x32x16_bf16 v[192:207], v[188:191], a[188:191], v[192:207]
  s_nop 11
  v_cvt_pk_bf16_f32 v32, v192, v193
  v_cvt_pk_bf16_f32 v33, v194, v195
  v_cvt_pk_bf16_f32 v34, v196, v197
  v_cvt_pk_bf16_f32 v35, v198, v199
  v_cvt_pk_bf16_f32 v36, v200, v201
  v_cvt_pk_bf16_f32 v37, v202, v203
  v_cvt_pk_bf16_f32 v38, v204, v205
  v_cvt_pk_bf16_f32 v39, v206, v207
  s_nop 0
  v_permlane32_swap_b32 v32, v34
  v_permlane32_swap_b32 v33, v35
  buffer_store_dwordx4 v[32:35], v253, s[44:47], s22 offen offset:0
  v_permlane32_swap_b32 v36, v38
  v_permlane32_swap_b32 v37, v39
  buffer_store_dwordx4 v[36:39], v253, s[44:47], s22 offen offset:32
F_END:
  s_endpgm
P1_V1:
  v_mad_u32_u24 v17, v24, s63, v26
  v_mad_u32_u24 v17, v25, s64, v17
  s_mul_i32 s29, s65, s30
  s_add_u32 s36, s69, s29
  s_waitcnt lgkmcnt(0)
  v_mfma_f32_16x16x32_bf16 v[32:35], a[0:3], v[224:227], 0
  ds_read_b64_tr_b16 v[240:241], v2 offset:0
  v_mfma_f32_16x16x32_bf16 v[32:35], a[16:19], v[228:231], v[32:35]
  ds_read_b64_tr_b16 v[242:243], v2 offset:512
  v_mfma_f32_16x16x32_bf16 v[32:35], a[32:35], v[232:235], v[32:35]
  ds_read_b64_tr_b16 v[244:245], v2 offset:4096
  v_mfma_f32_16x16x32_bf16 v[32:35], a[48:51], v[236:239], v[32:35]
  v_mfma_f32_16x16x32_bf16 v[48:51], a[4:7], v[224:227], 0
  ds_read_b64_tr_b16 v[246:247], v2 offset:4608
  v_mfma_f32_16x16x32_bf16 v[48:51], a[20:23], v[228:231], v[48:51]
  ds_read_b64_tr_b16 v[248:249], v2 offset:8192
  v_mfma_f32_16x16x32_bf16 v[48:51], a[36:39], v[232:235], v[48:51]
  ds_read_b64_tr_b16 v[250:251], v2 offset:8704
  v_mfma_f32_16x16x32_bf16 v[48:51], a[52:55], v[236:239], v[48:51]
  v_mfma_f32_16x16x32_bf16 v[64:67], a[8:11], v[224:227], 0
  ds_read_b64_tr_b16 v[252:253], v2 offset:12288
  v_mfma_f32_16x16x32_bf16 v[64:67], a[24:27], v[228:231], v[64:67]
  ds_read_b64_tr_b16 v[254:255], v2 offset:12800
  v_mfma_f32_16x16x32_bf16 v[64:67], a[40:43], v[232:235], v[64:67]
  v_mfma_f32_16x16x32_bf16 v[64:67], a[56:59], v[236:239], v[64:67]
  v_mfma_f32_16x16x32_bf16 v[80:83], a[12:15], v[224:227], 0
  v_mfma_f32_16x16x32_bf16 v[80:83], a[28:31], v[228:231], v[80:83]
  v_mfma_f32_16x16x32_bf16 v[80:83], a[44:47], v[232:235], v[80:83]
  v_mfma_f32_16x16x32_bf16 v[80:83], a[60:63], v[236:239], v[80:83]
  s_waitcnt lgkmcnt(0)
  v_mfma_f32_16x16x32_bf16 v[36:39], a[0:3], v[240:243], 0
  ds_read_b64_tr_b16 v[224:225], v3 offset:0
  v_mfma_f32_16x16x32_bf16 v[36:39], a[16:19], v[244:247], v[36:39]
  ds_read_b64_tr_b16 v[226:227], v3 offset:512
  v_mfma_f32_16x16x32_bf16 v[36:39], a[32:35], v[248:251], v[36:39]
  ds_read_b64_tr_b16 v[228:229], v3 offset:4096
  v_mfma_f32_16x16x32_bf16 v[36:39], a[48:51], v[252:255], v[36:39]
  v_mfma_f32_16x16x32_bf16 v[52:55], a[4:7], v[240:243], 0
  ds_read_b64_tr_b16 v[230:231], v3 offset:4608
  v_mfma_f32_16x16x32_bf16 v[52:55], a[20:23], v[244:247], v[52:55]
  ds_read_b64_tr_b16 v[232:233], v3 offset:8192
  v_mfma_f32_16x16x32_bf16 v[52:55], a[36:39], v[248:251], v[52:55]
  ds_read_b64_tr_b16 v[234:235], v3 offset:8704
  v_mfma_f32_16x16x32_bf16 v[52:55], a[52:55], v[252:255], v[52:55]
  v_mfma_f32_16x16x32_bf16 v[68:71], a[8:11], v[240:243], 0
  ds_read_b64_tr_b16 v[236:237], v3 offset:12288
  v_mfma_f32_16x16x32_bf16 v[68:71], a[24:27], v[244:247], v[68:71]
  ds_read_b64_tr_b16 v[238:239], v3 offset:12800
  v_mfma_f32_16x16x32_bf16 v[68:71], a[40:43], v[248:251], v[68:71]
  v_mfma_f32_16x16x32_bf16 v[68:71], a[56:59], v[252:255], v[68:71]
  v_mfma_f32_16x16x32_bf16 v[84:87], a[12:15], v[240:243], 0
  v_mfma_f32_16x16x32_bf16 v[84:87], a[28:31], v[244:247], v[84:87]
  v_mfma_f32_16x16x32_bf16 v[84:87], a[44:47], v[248:251], v[84:87]
  v_mfma_f32_16x16x32_bf16 v[84:87], a[60:63], v[252:255], v[84:87]
  s_waitcnt lgkmcnt(0)
  v_mfma_f32_16x16x32_bf16 v[40:43], a[0:3], v[224:227], 0
  ds_read_b64_tr_b16 v[240:241], v4 offset:0
  s_add_u32 m0, s19, 49152
  v_mfma_f32_16x16x32_bf16 v[40:43], a[16:19], v[228:231], v[40:43]
  ds_read_b64_tr_b16 v[242:243], v4 offset:512
  s_add_u32 s21, s23, 0
  v_mfma_f32_16x16x32_bf16 v[40:43], a[32:35], v[232:235], v[40:43]
  ds_read_b64_tr_b16 v[244:245], v4 offset:4096
  v_mfma_f32_16x16x32_bf16 v[40:43], a[48:51], v[236:239], v[40:43]
  buffer_load_dwordx4 v5, s[12:15], s21 offen offset:0 lds
  v_mfma_f32_16x16x32_bf16 v[56:59], a[4:7], v[224:227], 0
  ds_read_b64_tr_b16 v[246:247], v4 offset:4608
  v_mfma_f32_16x16x32_bf16 v[56:59], a[20:23], v[228:231], v[56:59]
  ds_read_b64_tr_b16 v[248:249], v4 offset:8192
  v_mfma_f32_16x16x32_bf16 v[56:59], a[36:39], v[232:235], v[56:59]
  ds_read_b64_tr_b16 v[250:251], v4 offset:8704
  v_mfma_f32_16x16x32_bf16 v[56:59], a[52:55], v[236:239], v[56:59]
  buffer_load_dwordx4 v6, s[12:15], s21 offen offset:1024 lds
  v_mfma_f32_16x16x32_bf16 v[72:75], a[8:11], v[224:227], 0
  ds_read_b64_tr_b16 v[252:253], v4 offset:12288
  v_mfma_f32_16x16x32_bf16 v[72:75], a[24:27], v[228:231], v[72:75]
  ds_read_b64_tr_b16 v[254:255], v4 offset:12800
  v_mfma_f32_16x16x32_bf16 v[72:75], a[40:43], v[232:235], v[72:75]
  v_mfma_f32_16x16x32_bf16 v[72:75], a[56:59], v[236:239], v[72:75]
  buffer_load_dwordx4 v7, s[12:15], s21 offen offset:2048 lds
  v_mfma_f32_16x16x32_bf16 v[88:91], a[12:15], v[224:227], 0
  v_mfma_f32_16x16x32_bf16 v[88:91], a[28:31], v[228:231], v[88:91]
  v_mfma_f32_16x16x32_bf16 v[88:91], a[44:47], v[232:235], v[88:91]
  v_mfma_f32_16x16x32_bf16 v[88:91], a[60:63], v[236:239], v[88:91]
  buffer_load_dwordx4 v8, s[12:15], s21 offen offset:3072 lds
  s_waitcnt vmcnt(10) lgkmcnt(0)
  s_barrier
  v_mfma_f32_16x16x32_bf16 v[44:47], a[0:3], v[240:243], 0
  ds_read_b64_tr_b16 v[224:225], v1 offset:16384
  s_add_u32 m0, s20, 16384
  v_mfma_f32_16x16x32_bf16 v[44:47], a[16:19], v[244:247], v[44:47]
  ds_read_b64_tr_b16 v[226:227], v1 offset:16896
  s_add_u32 s28, s25, s77
  v_mfma_f32_16x16x32_bf16 v[44:47], a[32:35], v[248:251], v[44:47]
  ds_read_b64_tr_b16 v[228:229], v1 offset:20480
  v_mfma_f32_16x16x32_bf16 v[44:47], a[48:51], v[252:255], v[44:47]
  buffer_load_dwordx4 v9, s[44:47], s28 offen offset:0 lds
  v_mfma_f32_16x16x32_bf16 v[60:63], a[4:7], v[240:243], 0
  ds_read_b64_tr_b16 v[230:231], v1 offset:20992
  v_mfma_f32_16x16x32_bf16 v[60:63], a[20:23], v[244:247], v[60:63]
  ds_read_b64_tr_b16 v[232:233], v1 offset:24576
  v_mfma_f32_16x16x32_bf16 v[60:63], a[36:39], v[248:251], v[60:63]
  ds_read_b64_tr_b16 v[234:235], v1 offset:25088
  v_mfma_f32_16x16x32_bf16 v[60:63], a[52:55], v[252:255], v[60:63]
  buffer_load_dwordx4 v10, s[44:47], s28 offen offset:1024 lds
  v_mfma_f32_16x16x32_bf16 v[76:79], a[8:11], v[240:243], 0
  ds_read_b64_tr_b16 v[236:237], v1 offset:28672
  v_mfma_f32_16x16x32_bf16 v[76:79], a[24:27], v[244:247], v[76:79]
  ds_read_b64_tr_b16 v[238:239], v1 offset:29184
  v_mfma_f32_16x16x32_bf16 v[76:79], a[40:43], v[248:251], v[76:79]
  v_mfma_f32_16x16x32_bf16 v[76:79], a[56:59], v[252:255], v[76:79]
  buffer_load_dwordx4 v11, s[44:47], s28 offen offset:2048 lds
  v_mfma_f32_16x16x32_bf16 v[92:95], a[12:15], v[240:243], 0
  v_mfma_f32_16x16x32_bf16 v[92:95], a[28:31], v[244:247], v[92:95]
  v_mfma_f32_16x16x32_bf16 v[92:95], a[44:47], v[248:251], v[92:95]
  v_mfma_f32_16x16x32_bf16 v[92:95], a[60:63], v[252:255], v[92:95]
  buffer_load_dwordx4 v12, s[44:47], s28 offen offset:3072 lds
  s_waitcnt lgkmcnt(0)
  v_mfma_f32_16x16x32_bf16 v[96:99], a[0:3], v[224:227], 0
  ds_read_b64_tr_b16 v[240:241], v2 offset:16384
  s_add_u32 m0, s20, 20480
  v_mfma_f32_16x16x32_bf16 v[96:99], a[16:19], v[228:231], v[96:99]
  ds_read_b64_tr_b16 v[242:243], v2 offset:16896
  s_add_u32 s28, s26, s77
  v_mfma_f32_16x16x32_bf16 v[96:99], a[32:35], v[232:235], v[96:99]
  ds_read_b64_tr_b16 v[244:245], v2 offset:20480
  v_mfma_f32_16x16x32_bf16 v[96:99], a[48:51], v[236:239], v[96:99]
  buffer_load_dwordx4 v9, s[44:47], s28 offen offset:0 lds
  v_mfma_f32_16x16x32_bf16 v[112:115], a[4:7], v[224:227], 0
  ds_read_b64_tr_b16 v[246:247], v2 offset:20992
  v_mfma_f32_16x16x32_bf16 v[112:115], a[20:23], v[228:231], v[112:115]
  ds_read_b64_tr_b16 v[248:249], v2 offset:24576
  v_mfma_f32_16x16x32_bf16 v[112:115], a[36:39], v[232:235], v[112:115]
  ds_read_b64_tr_b16 v[250:251], v2 offset:25088
  v_mfma_f32_16x16x32_bf16 v[112:115], a[52:55], v[236:239], v[112:115]
  buffer_load_dwordx4 v10, s[44:47], s28 offen offset:1024 lds
  v_mfma_f32_16x16x32_bf16 v[128:131], a[8:11], v[224:227], 0
  ds_read_b64_tr_b16 v[252:253], v2 offset:28672
  v_mfma_f32_16x16x32_bf16 v[128:131], a[24:27], v[228:231], v[128:131]
  ds_read_b64_tr_b16 v[254:255], v2 offset:29184
  v_mfma_f32_16x16x32_bf16 v[128:131], a[40:43], v[232:235], v[128:131]
  v_mfma_f32_16x16x32_bf16 v[128:131], a[56:59], v[236:239], v[128:131]
  buffer_load_dwordx4 v11, s[44:47], s28 offen offset:2048 lds
  v_mfma_f32_16x16x32_bf16 v[144:147], a[12:15], v[224:227], 0
  v_mfma_f32_16x16x32_bf16 v[144:147], a[28:31], v[228:231], v[144:147]
  v_mfma_f32_16x16x32_bf16 v[144:147], a[44:47], v[232:235], v[144:147]
  v_mfma_f32_16x16x32_bf16 v[144:147], a[60:63], v[236:239], v[144:147]
  buffer_load_dwordx4 v12, s[44:47], s28 offen offset:3072 lds
  s_waitcnt lgkmcnt(0)
  v_mfma_f32_16x16x32_bf16 v[100:103], a[0:3], v[240:243], 0
  ds_read_b64_tr_b16 v[224:225], v3 offset:16384
  s_add_u32 m0, s20, -128
  v_mfma_f32_16x16x32_bf16 v[100:103], a[16:19], v[244:247], v[100:103]
  ds_read_b64_tr_b16 v[226:227], v3 offset:16896
  s_add_u32 s28, s25, s77
  v_mfma_f32_16x16x32_bf16 v[100:103], a[32:35], v[248:251], v[100:103]
  ds_read_b64_tr_b16 v[228:229], v3 offset:20480
  v_mfma_f32_16x16x32_bf16 v[100:103], a[48:51], v[252:255], v[100:103]
  buffer_load_dwordx4 v9, s[44:47], s28 offen offset:128 lds
  v_mfma_f32_16x16x32_bf16 v[116:119], a[4:7], v[240:243], 0
  ds_read_b64_tr_b16 v[230:231], v3 offset:20992
  v_mfma_f32_16x16x32_bf16 v[116:119], a[20:23], v[244:247], v[116:119]
  ds_read_b64_tr_b16 v[232:233], v3 offset:24576
  v_mfma_f32_16x16x32_bf16 v[116:119], a[36:39], v[248:251], v[116:119]
  ds_read_b64_tr_b16 v[234:235], v3 offset:25088
  v_mfma_f32_16x16x32_bf16 v[116:119], a[52:55], v[252:255], v[116:119]
  buffer_load_dwordx4 v10, s[44:47], s28 offen offset:1152 lds
  v_mfma_f32_16x16x32_bf16 v[132:135], a[8:11], v[240:243], 0
  ds_read_b64_tr_b16 v[236:237], v3 offset:28672
  v_mfma_f32_16x16x32_bf16 v[132:135], a[24:27], v[244:247], v[132:135]
  ds_read_b64_tr_b16 v[238:239], v3 offset:29184
  v_mfma_f32_16x16x32_bf16 v[132:135], a[40:43], v[248:251], v[132:135]
  v_mfma_f32_16x16x32_bf16 v[132:135], a[56:59], v[252:255], v[132:135]
  buffer_load_dwordx4 v11, s[44:47], s28 offen offset:2176 lds
  v_mfma_f32_16x16x32_bf16 v[148:151], a[12:15], v[240:243], 0
  v_mfma_f32_16x16x32_bf16 v[148:151], a[28:31], v[244:247], v[148:151]
  v_mfma_f32_16x16x32_bf16 v[148:151], a[44:47], v[248:251], v[148:151]
  v_mfma_f32_16x16x32_bf16 v[148:151], a[60:63], v[252:255], v[148:151]
  buffer_load_dwordx4 v12, s[44:47], s28 offen offset:3200 lds
  s_waitcnt lgkmcnt(0)
  v_mfma_f32_16x16x32_bf16 v[104:107], a[0:3], v[224:227], 0
  ds_read_b64_tr_b16 v[240:241], v4 offset:16384
  s_add_u32 m0, s20, 3968
  v_mfma_f32_16x16x32_bf16 v[104:107], a[16:19], v[228:231], v[104:107]
  ds_read_b64_tr_b16 v[242:243], v4 offset:16896
  s_add_u32 s28, s26, s77
  v_mfma_f32_16x16x32_bf16 v[104:107], a[32:35], v[232:235], v[104:107]
  ds_read_b64_tr_b16 v[244:245], v4 offset:20480
  v_mfma_f32_16x16x32_bf16 v[104:107], a[48:51], v[236:239], v[104:107]
  buffer_load_dwordx4 v9, s[44:47], s28 offen offset:128 lds
  v_mfma_f32_16x16x32_bf16 v[120:123], a[4:7], v[224:227], 0
  ds_read_b64_tr_b16 v[246:247], v4 offset:20992
  v_mfma_f32_16x16x32_bf16 v[120:123], a[20:23], v[228:231], v[120:123]
  ds_read_b64_tr_b16 v[248:249], v4 offset:24576
  v_mfma_f32_16x16x32_bf16 v[120:123], a[36:39], v[232:235], v[120:123]
  ds_read_b64_tr_b16 v[250:251], v4 offset:25088
  v_mfma_f32_16x16x32_bf16 v[120:123], a[52:55], v[236:239], v[120:123]
  buffer_load_dwordx4 v10, s[44:47], s28 offen offset:1152 lds
  v_mfma_f32_16x16x32_bf16 v[136:139], a[8:11], v[224:227], 0
  ds_read_b64_tr_b16 v[252:253], v4 offset:28672
  v_mfma_f32_16x16x32_bf16 v[136:139], a[24:27], v[228:231], v[136:139]
  ds_read_b64_tr_b16 v[254:255], v4 offset:29184
  v_mfma_f32_16x16x32_bf16 v[136:139], a[40:43], v[232:235], v[136:139]
  v_mfma_f32_16x16x32_bf16 v[136:139], a[56:59], v[236:239], v[136:139]
  buffer_load_dwordx4 v11, s[44:47], s28 offen offset:2176 lds
  v_mfma_f32_16x16x32_bf16 v[152:155], a[12:15], v[224:227], 0
  v_mfma_f32_16x16x32_bf16 v[152:155], a[28:31], v[228:231], v[152:155]
  v_mfma_f32_16x16x32_bf16 v[152:155], a[44:47], v[232:235], v[152:155]
  v_mfma_f32_16x16x32_bf16 v[152:155], a[60:63], v[236:239], v[152:155]
  buffer_load_dwordx4 v12, s[44:47], s28 offen offset:3200 lds
  s_waitcnt vmcnt(22) lgkmcnt(0)
  s_barrier
  v_mfma_f32_16x16x32_bf16 v[108:111], a[0:3], v[240:243], 0
  ds_read_b64_tr_b16 v[224:225], v1 offset:32768
  s_add_u32 m0, s19, 0
  v_mfma_f32_16x16x32_bf16 v[108:111], a[16:19], v[244:247], v[108:111]
  ds_read_b64_tr_b16 v[226:227], v1 offset:33280
  s_add_u32 s21, s23, 128
  v_mfma_f32_16x16x32_bf16 v[108:111], a[32:35], v[248:251], v[108:111]
  ds_read_b64_tr_b16 v[228:229], v1 offset:36864
  v_mfma_f32_16x16x32_bf16 v[108:111], a[48:51], v[252:255], v[108:111]
  buffer_load_dwordx4 v5, s[12:15], s21 offen offset:0 lds
  v_mfma_f32_16x16x32_bf16 v[124:127], a[4:7], v[240:243], 0
  ds_read_b64_tr_b16 v[230:231], v1 offset:37376
  v_mfma_f32_16x16x32_bf16 v[124:127], a[20:23], v[244:247], v[124:127]
  ds_read_b64_tr_b16 v[232:233], v1 offset:40960
  v_mfma_f32_16x16x32_bf16 v[124:127], a[36:39], v[248:251], v[124:127]
  ds_read_b64_tr_b16 v[234:235], v1 offset:41472
  v_mfma_f32_16x16x32_bf16 v[124:127], a[52:55], v[252:255], v[124:127]
  buffer_load_dwordx4 v6, s[12:15], s21 offen offset:1024 lds
  v_mfma_f32_16x16x32_bf16 v[140:143], a[8:11], v[240:243], 0
  ds_read_b64_tr_b16 v[236:237], v1 offset:45056
  v_mfma_f32_16x16x32_bf16 v[140:143], a[24:27], v[244:247], v[140:143]
  ds_read_b64_tr_b16 v[238:239], v1 offset:45568
  v_mfma_f32_16x16x32_bf16 v[140:143], a[40:43], v[248:251], v[140:143]
  v_mfma_f32_16x16x32_bf16 v[140:143], a[56:59], v[252:255], v[140:143]
  buffer_load_dwordx4 v7, s[12:15], s21 offen offset:2048 lds
  v_mfma_f32_16x16x32_bf16 v[156:159], a[12:15], v[240:243], 0
  v_mfma_f32_16x16x32_bf16 v[156:159], a[28:31], v[244:247], v[156:159]
  v_mfma_f32_16x16x32_bf16 v[156:159], a[44:47], v[248:251], v[156:159]
  v_mfma_f32_16x16x32_bf16 v[156:159], a[60:63], v[252:255], v[156:159]
  buffer_load_dwordx4 v8, s[12:15], s21 offen offset:3072 lds
  s_waitcnt lgkmcnt(0)
  v_mfma_f32_16x16x32_bf16 v[160:163], a[0:3], v[224:227], 0
  ds_read_b64_tr_b16 v[240:241], v2 offset:32768
  s_add_u32 m0, s19, 16384
  v_mfma_f32_16x16x32_bf16 v[160:163], a[16:19], v[228:231], v[160:163]
  ds_read_b64_tr_b16 v[242:243], v2 offset:33280
  s_add_u32 s21, s23, 256
  v_mfma_f32_16x16x32_bf16 v[160:163], a[32:35], v[232:235], v[160:163]
  ds_read_b64_tr_b16 v[244:245], v2 offset:36864
  v_mfma_f32_16x16x32_bf16 v[160:163], a[48:51], v[236:239], v[160:163]
  buffer_load_dwordx4 v5, s[12:15], s21 offen offset:0 lds
  v_mfma_f32_16x16x32_bf16 v[176:179], a[4:7], v[224:227], 0
  ds_read_b64_tr_b16 v[246:247], v2 offset:37376
  v_mfma_f32_16x16x32_bf16 v[176:179], a[20:23], v[228:231], v[176:179]
  ds_read_b64_tr_b16 v[248:249], v2 offset:40960
  v_mfma_f32_16x16x32_bf16 v[176:179], a[36:39], v[232:235], v[176:179]
  ds_read_b64_tr_b16 v[250:251], v2 offset:41472
  v_mfma_f32_16x16x32_bf16 v[176:179], a[52:55], v[236:239], v[176:179]
  buffer_load_dwordx4 v6, s[12:15], s21 offen offset:1024 lds
  v_mfma_f32_16x16x32_bf16 v[192:195], a[8:11], v[224:227], 0
  ds_read_b64_tr_b16 v[252:253], v2 offset:45056
  v_mfma_f32_16x16x32_bf16 v[192:195], a[24:27], v[228:231], v[192:195]
  ds_read_b64_tr_b16 v[254:255], v2 offset:45568
  v_mfma_f32_16x16x32_bf16 v[192:195], a[40:43], v[232:235], v[192:195]
  v_mfma_f32_16x16x32_bf16 v[192:195], a[56:59], v[236:239], v[192:195]
  buffer_load_dwordx4 v7, s[12:15], s21 offen offset:2048 lds
  v_mfma_f32_16x16x32_bf16 v[208:211], a[12:15], v[224:227], 0
  v_mfma_f32_16x16x32_bf16 v[208:211], a[28:31], v[228:231], v[208:211]
  v_mfma_f32_16x16x32_bf16 v[208:211], a[44:47], v[232:235], v[208:211]
  v_mfma_f32_16x16x32_bf16 v[208:211], a[60:63], v[236:239], v[208:211]
  buffer_load_dwordx4 v8, s[12:15], s21 offen offset:3072 lds
  s_waitcnt vmcnt(16) lgkmcnt(0)
  v_mfma_f32_16x16x32_bf16 v[164:167], a[0:3], v[240:243], 0
  ds_read_b64_tr_b16 v[224:225], v3 offset:32768
  v_mfma_f32_16x16x32_bf16 v[164:167], a[16:19], v[244:247], v[164:167]
  ds_read_b64_tr_b16 v[226:227], v3 offset:33280
  v_mfma_f32_16x16x32_bf16 v[164:167], a[32:35], v[248:251], v[164:167]
  ds_read_b64_tr_b16 v[228:229], v3 offset:36864
  v_mfma_f32_16x16x32_bf16 v[164:167], a[48:51], v[252:255], v[164:167]
  ds_read_b128 a[64:67], v13 offset:16384
  v_mfma_f32_16x16x32_bf16 v[180:183], a[4:7], v[240:243], 0
  ds_read_b64_tr_b16 v[230:231], v3 offset:37376
  v_mfma_f32_16x16x32_bf16 v[180:183], a[20:23], v[244:247], v[180:183]
  ds_read_b64_tr_b16 v[232:233], v3 offset:40960
  v_mfma_f32_16x16x32_bf16 v[180:183], a[36:39], v[248:251], v[180:183]
  ds_read_b64_tr_b16 v[234:235], v3 offset:41472
  v_mfma_f32_16x16x32_bf16 v[180:183], a[52:55], v[252:255], v[180:183]
  ds_read_b128 a[80:83], v14 offset:16384
  v_mfma_f32_16x16x32_bf16 v[196:199], a[8:11], v[240:243], 0
  ds_read_b64_tr_b16 v[236:237], v3 offset:45056
  v_mfma_f32_16x16x32_bf16 v[196:199], a[24:27], v[244:247], v[196:199]
  ds_read_b64_tr_b16 v[238:239], v3 offset:45568
  v_mfma_f32_16x16x32_bf16 v[196:199], a[40:43], v[248:251], v[196:199]
  ds_read_b128 a[68:71], v13 offset:18432
  v_mfma_f32_16x16x32_bf16 v[196:199], a[56:59], v[252:255], v[196:199]
  ds_read_b128 a[84:87], v14 offset:18432
  v_mfma_f32_16x16x32_bf16 v[212:215], a[12:15], v[240:243], 0
  ds_read_b128 a[72:75], v13 offset:20480
  v_mfma_f32_16x16x32_bf16 v[212:215], a[28:31], v[244:247], v[212:215]
  ds_read_b128 a[88:91], v14 offset:20480
  v_mfma_f32_16x16x32_bf16 v[212:215], a[44:47], v[248:251], v[212:215]
  ds_read_b128 a[76:79], v13 offset:22528
  v_mfma_f32_16x16x32_bf16 v[212:215], a[60:63], v[252:255], v[212:215]
  ds_read_b128 a[92:95], v14 offset:22528
  s_waitcnt vmcnt(8) lgkmcnt(4)
  v_mfma_f32_16x16x32_bf16 v[168:171], a[0:3], v[224:227], 0
  ds_read_b64_tr_b16 v[240:241], v4 offset:32768
  v_mfma_f32_16x16x32_bf16 v[168:171], a[16:19], v[228:231], v[168:171]
  ds_read_b64_tr_b16 v[242:243], v4 offset:33280
  v_mfma_f32_16x16x32_bf16 v[168:171], a[32:35], v[232:235], v[168:171]
  ds_read_b64_tr_b16 v[244:245], v4 offset:36864
  v_mfma_f32_16x16x32_bf16 v[168:171], a[48:51], v[236:239], v[168:171]
  ds_read_b128 a[96:99], v13 offset:0
  v_mfma_f32_16x16x32_bf16 v[184:187], a[4:7], v[224:227], 0
  ds_read_b64_tr_b16 v[246:247], v4 offset:37376
  v_mfma_f32_16x16x32_bf16 v[184:187], a[20:23], v[228:231], v[184:187]
  ds_read_b64_tr_b16 v[248:249], v4 offset:40960
  v_mfma_f32_16x16x32_bf16 v[184:187], a[36:39], v[232:235], v[184:187]
  ds_read_b64_tr_b16 v[250:251], v4 offset:41472
  v_mfma_f32_16x16x32_bf16 v[184:187], a[52:55], v[236:239], v[184:187]
  ds_read_b128 a[112:115], v14 offset:0
  v_mfma_f32_16x16x32_bf16 v[200:203], a[8:11], v[224:227], 0
  ds_read_b64_tr_b16 v[252:253], v4 offset:45056
  v_mfma_f32_16x16x32_bf16 v[200:203], a[24:27], v[228:231], v[200:203]
  ds_read_b64_tr_b16 v[254:255], v4 offset:45568
  v_mfma_f32_16x16x32_bf16 v[200:203], a[40:43], v[232:235], v[200:203]
  ds_read_b128 a[100:103], v13 offset:2048
  v_mfma_f32_16x16x32_bf16 v[200:203], a[56:59], v[236:239], v[200:203]
  ds_read_b128 a[116:119], v14 offset:2048
  v_mfma_f32_16x16x32_bf16 v[216:219], a[12:15], v[224:227], 0
  ds_read_b128 a[104:107], v13 offset:4096
  v_mfma_f32_16x16x32_bf16 v[216:219], a[28:31], v[228:231], v[216:219]
  ds_read_b128 a[120:123], v14 offset:4096
  v_mfma_f32_16x16x32_bf16 v[216:219], a[44:47], v[232:235], v[216:219]
  ds_read_b128 a[108:111], v13 offset:6144
  v_mfma_f32_16x16x32_bf16 v[216:219], a[60:63], v[236:239], v[216:219]
  ds_read_b128 a[124:127], v14 offset:6144
  s_waitcnt vmcnt(24) lgkmcnt(4)
  s_barrier
  s_cmp_lg_u32 s16, 0
  s_cbranch_scc1 P1_CL1
  s_and_b32 s37, s2, 1
  s_lshl_b32 s37, s37, 7
  v_mov_b32 v26, 1
  s_mov_b64 exec, 1
  buffer_atomic_add v26, off, s[40:43], s37 sc1
  s_mov_b64 exec, -1
P1_CL1:
  v_mfma_f32_16x16x32_bf16 v[172:175], a[0:3], v[240:243], 0
  ds_read_b64_tr_b16 v[224:225], v1 offset:49152
  s_add_u32 m0, s19, 32768
  v_mfma_f32_16x16x32_bf16 v[172:175], a[16:19], v[244:247], v[172:175]
  ds_read_b64_tr_b16 v[226:227], v1 offset:49664
  s_add_u32 s21, s24, 0
  v_mfma_f32_16x16x32_bf16 v[172:175], a[32:35], v[248:251], v[172:175]
  ds_read_b64_tr_b16 v[228:229], v1 offset:53248
  v_mfma_f32_16x16x32_bf16 v[172:175], a[48:51], v[252:255], v[172:175]
  buffer_load_dwordx4 v5, s[12:15], s21 offen offset:0 lds
  v_mfma_f32_16x16x32_bf16 v[188:191], a[4:7], v[240:243], 0
  ds_read_b64_tr_b16 v[230:231], v1 offset:53760
  v_mfma_f32_16x16x32_bf16 v[188:191], a[20:23], v[244:247], v[188:191]
  ds_read_b64_tr_b16 v[232:233], v1 offset:57344
  v_mfma_f32_16x16x32_bf16 v[188:191], a[36:39], v[248:251], v[188:191]
  ds_read_b64_tr_b16 v[234:235], v1 offset:57856
  v_mfma_f32_16x16x32_bf16 v[188:191], a[52:55], v[252:255], v[188:191]
  buffer_load_dwordx4 v6, s[12:15], s21 offen offset:1024 lds
  v_mfma_f32_16x16x32_bf16 v[204:207], a[8:11], v[240:243], 0
  ds_read_b64_tr_b16 v[236:237], v1 offset:61440
  v_mfma_f32_16x16x32_bf16 v[204:207], a[24:27], v[244:247], v[204:207]
  ds_read_b64_tr_b16 v[238:239], v1 offset:61952
  v_mfma_f32_16x16x32_bf16 v[204:207], a[40:43], v[248:251], v[204:207]
  v_mfma_f32_16x16x32_bf16 v[204:207], a[56:59], v[252:255], v[204:207]
  buffer_load_dwordx4 v7, s[12:15], s21 offen offset:2048 lds
  v_mfma_f32_16x16x32_bf16 v[220:223], a[12:15], v[240:243], 0
  v_mfma_f32_16x16x32_bf16 v[220:223], a[28:31], v[244:247], v[220:223]
  v_mfma_f32_16x16x32_bf16 v[220:223], a[44:47], v[248:251], v[220:223]
  v_mfma_f32_16x16x32_bf16 v[220:223], a[60:63], v[252:255], v[220:223]
  buffer_load_dwordx4 v8, s[12:15], s21 offen offset:3072 lds
  s_waitcnt lgkmcnt(0)
  v_mfma_f32_16x16x32_bf16 v[32:35], a[64:67], v[224:227], v[32:35]
  ds_read_b64_tr_b16 v[240:241], v2 offset:49152
  v_mfma_f32_16x16x32_bf16 v[32:35], a[80:83], v[228:231], v[32:35]
  ds_read_b64_tr_b16 v[242:243], v2 offset:49664
  v_mfma_f32_16x16x32_bf16 v[32:35], a[96:99], v[232:235], v[32:35]
  ds_read_b64_tr_b16 v[244:245], v2 offset:53248
  v_mfma_f32_16x16x32_bf16 v[32:35], a[112:115], v[236:239], v[32:35]
  buffer_load_dword v23, v30, s[12:15], s62 offen offset:384
  v_mfma_f32_16x16x32_bf16 v[48:51], a[68:71], v[224:227], v[48:51]
  ds_read_b64_tr_b16 v[246:247], v2 offset:53760
  v_mfma_f32_16x16x32_bf16 v[48:51], a[84:87], v[228:231], v[48:51]
  ds_read_b64_tr_b16 v[248:249], v2 offset:57344
  v_mfma_f32_16x16x32_bf16 v[48:51], a[100:103], v[232:235], v[48:51]
  ds_read_b64_tr_b16 v[250:251], v2 offset:57856
  v_mfma_f32_16x16x32_bf16 v[48:51], a[116:119], v[236:239], v[48:51]
  v_mfma_f32_16x16x32_bf16 v[64:67], a[72:75], v[224:227], v[64:67]
  ds_read_b64_tr_b16 v[252:253], v2 offset:61440
  v_mfma_f32_16x16x32_bf16 v[64:67], a[88:91], v[228:231], v[64:67]
  ds_read_b64_tr_b16 v[254:255], v2 offset:61952
  v_mfma_f32_16x16x32_bf16 v[64:67], a[104:107], v[232:235], v[64:67]
  v_mfma_f32_16x16x32_bf16 v[64:67], a[120:123], v[236:239], v[64:67]
  v_mfma_f32_16x16x32_bf16 v[80:83], a[76:79], v[224:227], v[80:83]
  v_mfma_f32_16x16x32_bf16 v[80:83], a[92:95], v[228:231], v[80:83]
  v_mfma_f32_16x16x32_bf16 v[80:83], a[108:111], v[232:235], v[80:83]
  v_mfma_f32_16x16x32_bf16 v[80:83], a[124:127], v[236:239], v[80:83]
  s_waitcnt lgkmcnt(0)
  v_mfma_f32_16x16x32_bf16 v[36:39], a[64:67], v[240:243], v[36:39]
  ds_read_b64_tr_b16 v[224:225], v3 offset:49152
  v_mfma_f32_16x16x32_bf16 v[36:39], a[80:83], v[244:247], v[36:39]
  ds_read_b64_tr_b16 v[226:227], v3 offset:49664
  v_mfma_f32_16x16x32_bf16 v[36:39], a[96:99], v[248:251], v[36:39]
  ds_read_b64_tr_b16 v[228:229], v3 offset:53248
  v_mfma_f32_16x16x32_bf16 v[36:39], a[112:115], v[252:255], v[36:39]
  v_mfma_f32_16x16x32_bf16 v[52:55], a[68:71], v[240:243], v[52:55]
  ds_read_b64_tr_b16 v[230:231], v3 offset:53760
  v_mfma_f32_16x16x32_bf16 v[52:55], a[84:87], v[244:247], v[52:55]
  ds_read_b64_tr_b16 v[232:233], v3 offset:57344
  v_mfma_f32_16x16x32_bf16 v[52:55], a[100:103], v[248:251], v[52:55]
  ds_read_b64_tr_b16 v[234:235], v3 offset:57856
  v_mfma_f32_16x16x32_bf16 v[52:55], a[116:119], v[252:255], v[52:55]
  v_mfma_f32_16x16x32_bf16 v[68:71], a[72:75], v[240:243], v[68:71]
  ds_read_b64_tr_b16 v[236:237], v3 offset:61440
  v_mfma_f32_16x16x32_bf16 v[68:71], a[88:91], v[244:247], v[68:71]
  ds_read_b64_tr_b16 v[238:239], v3 offset:61952
  v_mfma_f32_16x16x32_bf16 v[68:71], a[104:107], v[248:251], v[68:71]
  v_mfma_f32_16x16x32_bf16 v[68:71], a[120:123], v[252:255], v[68:71]
  v_mfma_f32_16x16x32_bf16 v[84:87], a[76:79], v[240:243], v[84:87]
  v_mfma_f32_16x16x32_bf16 v[84:87], a[92:95], v[244:247], v[84:87]
  v_mfma_f32_16x16x32_bf16 v[84:87], a[108:111], v[248:251], v[84:87]
  v_mfma_f32_16x16x32_bf16 v[84:87], a[124:127], v[252:255], v[84:87]
  s_waitcnt lgkmcnt(0)
  v_mfma_f32_16x16x32_bf16 v[40:43], a[64:67], v[224:227], v[40:43]
  ds_read_b64_tr_b16 v[240:241], v4 offset:49152
  s_add_u32 m0, s20, 8192
  v_mfma_f32_16x16x32_bf16 v[40:43], a[80:83], v[228:231], v[40:43]
  ds_read_b64_tr_b16 v[242:243], v4 offset:49664
  s_add_u32 s28, s25, s78
  v_mfma_f32_16x16x32_bf16 v[40:43], a[96:99], v[232:235], v[40:43]
  ds_read_b64_tr_b16 v[244:245], v4 offset:53248
  v_mfma_f32_16x16x32_bf16 v[40:43], a[112:115], v[236:239], v[40:43]
  buffer_load_dwordx4 v9, s[44:47], s28 offen offset:0 lds
  v_mfma_f32_16x16x32_bf16 v[56:59], a[68:71], v[224:227], v[56:59]
  ds_read_b64_tr_b16 v[246:247], v4 offset:53760
  v_mfma_f32_16x16x32_bf16 v[56:59], a[84:87], v[228:231], v[56:59]
  ds_read_b64_tr_b16 v[248:249], v4 offset:57344
  v_mfma_f32_16x16x32_bf16 v[56:59], a[100:103], v[232:235], v[56:59]
  ds_read_b64_tr_b16 v[250:251], v4 offset:57856
  v_mfma_f32_16x16x32_bf16 v[56:59], a[116:119], v[236:239], v[56:59]
  buffer_load_dwordx4 v10, s[44:47], s28 offen offset:1024 lds
  v_mfma_f32_16x16x32_bf16 v[72:75], a[72:75], v[224:227], v[72:75]
  ds_read_b64_tr_b16 v[252:253], v4 offset:61440
  v_mfma_f32_16x16x32_bf16 v[72:75], a[88:91], v[228:231], v[72:75]
  ds_read_b64_tr_b16 v[254:255], v4 offset:61952
  v_mfma_f32_16x16x32_bf16 v[72:75], a[104:107], v[232:235], v[72:75]
  v_mfma_f32_16x16x32_bf16 v[72:75], a[120:123], v[236:239], v[72:75]
  buffer_load_dwordx4 v11, s[44:47], s28 offen offset:2048 lds
  v_mfma_f32_16x16x32_bf16 v[88:91], a[76:79], v[224:227], v[88:91]
  v_mfma_f32_16x16x32_bf16 v[88:91], a[92:95], v[228:231], v[88:91]
  v_mfma_f32_16x16x32_bf16 v[88:91], a[108:111], v[232:235], v[88:91]
  v_mfma_f32_16x16x32_bf16 v[88:91], a[124:127], v[236:239], v[88:91]
  buffer_load_dwordx4 v12, s[44:47], s28 offen offset:3072 lds
  s_waitcnt vmcnt(13) lgkmcnt(0)
  s_barrier
  v_mfma_f32_16x16x32_bf16 v[44:47], a[64:67], v[240:243], v[44:47]
  ds_read_b64_tr_b16 v[224:225], v1 offset:0
  s_add_u32 m0, s19, 49152
  v_mfma_f32_16x16x32_bf16 v[44:47], a[80:83], v[244:247], v[44:47]
  ds_read_b64_tr_b16 v[226:227], v1 offset:512
  s_add_u32 s21, s24, 128
  v_mfma_f32_16x16x32_bf16 v[44:47], a[96:99], v[248:251], v[44:47]
  ds_read_b64_tr_b16 v[228:229], v1 offset:4096
  v_mfma_f32_16x16x32_bf16 v[44:47], a[112:115], v[252:255], v[44:47]
  buffer_load_dwordx4 v5, s[12:15], s21 offen offset:0 lds
  v_mfma_f32_16x16x32_bf16 v[60:63], a[68:71], v[240:243], v[60:63]
  ds_read_b64_tr_b16 v[230:231], v1 offset:4608
  v_mfma_f32_16x16x32_bf16 v[60:63], a[84:87], v[244:247], v[60:63]
  ds_read_b64_tr_b16 v[232:233], v1 offset:8192
  v_mfma_f32_16x16x32_bf16 v[60:63], a[100:103], v[248:251], v[60:63]
  ds_read_b64_tr_b16 v[234:235], v1 offset:8704
  v_mfma_f32_16x16x32_bf16 v[60:63], a[116:119], v[252:255], v[60:63]
  buffer_load_dwordx4 v6, s[12:15], s21 offen offset:1024 lds
  v_mfma_f32_16x16x32_bf16 v[76:79], a[72:75], v[240:243], v[76:79]
  ds_read_b64_tr_b16 v[236:237], v1 offset:12288
  v_mfma_f32_16x16x32_bf16 v[76:79], a[88:91], v[244:247], v[76:79]
  ds_read_b64_tr_b16 v[238:239], v1 offset:12800
  v_mfma_f32_16x16x32_bf16 v[76:79], a[104:107], v[248:251], v[76:79]
  v_mfma_f32_16x16x32_bf16 v[76:79], a[120:123], v[252:255], v[76:79]
  buffer_load_dwordx4 v7, s[12:15], s21 offen offset:2048 lds
  v_mfma_f32_16x16x32_bf16 v[92:95], a[76:79], v[240:243], v[92:95]
  v_mfma_f32_16x16x32_bf16 v[92:95], a[92:95], v[244:247], v[92:95]
  v_mfma_f32_16x16x32_bf16 v[92:95], a[108:111], v[248:251], v[92:95]
  v_mfma_f32_16x16x32_bf16 v[92:95], a[124:127], v[252:255], v[92:95]
  buffer_load_dwordx4 v8, s[12:15], s21 offen offset:3072 lds
  s_waitcnt lgkmcnt(0)
  v_mfma_f32_16x16x32_bf16 v[96:99], a[64:67], v[224:227], v[96:99]
  ds_read_b64_tr_b16 v[240:241], v2 offset:0
  s_add_u32 m0, s20, 12288
  v_mfma_f32_16x16x32_bf16 v[96:99], a[80:83], v[228:231], v[96:99]
  ds_read_b64_tr_b16 v[242:243], v2 offset:512
  s_add_u32 s28, s26, s78
  v_mfma_f32_16x16x32_bf16 v[96:99], a[96:99], v[232:235], v[96:99]
  ds_read_b64_tr_b16 v[244:245], v2 offset:4096
  v_mfma_f32_16x16x32_bf16 v[96:99], a[112:115], v[236:239], v[96:99]
  buffer_load_dwordx4 v9, s[44:47], s28 offen offset:0 lds
  v_mfma_f32_16x16x32_bf16 v[112:115], a[68:71], v[224:227], v[112:115]
  ds_read_b64_tr_b16 v[246:247], v2 offset:4608
  v_mfma_f32_16x16x32_bf16 v[112:115], a[84:87], v[228:231], v[112:115]
  ds_read_b64_tr_b16 v[248:249], v2 offset:8192
  v_mfma_f32_16x16x32_bf16 v[112:115], a[100:103], v[232:235], v[112:115]
  ds_read_b64_tr_b16 v[250:251], v2 offset:8704
  v_mfma_f32_16x16x32_bf16 v[112:115], a[116:119], v[236:239], v[112:115]
  buffer_load_dwordx4 v10, s[44:47], s28 offen offset:1024 lds
  v_mfma_f32_16x16x32_bf16 v[128:131], a[72:75], v[224:227], v[128:131]
  ds_read_b64_tr_b16 v[252:253], v2 offset:12288
  v_mfma_f32_16x16x32_bf16 v[128:131], a[88:91], v[228:231], v[128:131]
  ds_read_b64_tr_b16 v[254:255], v2 offset:12800
  v_mfma_f32_16x16x32_bf16 v[128:131], a[104:107], v[232:235], v[128:131]
  v_mfma_f32_16x16x32_bf16 v[128:131], a[120:123], v[236:239], v[128:131]
  buffer_load_dwordx4 v11, s[44:47], s28 offen offset:2048 lds
  v_mfma_f32_16x16x32_bf16 v[144:147], a[76:79], v[224:227], v[144:147]
  v_mfma_f32_16x16x32_bf16 v[144:147], a[92:95], v[228:231], v[144:147]
  v_mfma_f32_16x16x32_bf16 v[144:147], a[108:111], v[232:235], v[144:147]
  v_mfma_f32_16x16x32_bf16 v[144:147], a[124:127], v[236:239], v[144:147]
  buffer_load_dwordx4 v12, s[44:47], s28 offen offset:3072 lds
  s_waitcnt lgkmcnt(0)
  v_mfma_f32_16x16x32_bf16 v[100:103], a[64:67], v[240:243], v[100:103]
  ds_read_b64_tr_b16 v[224:225], v3 offset:0
  s_add_u32 m0, s20, 16256
  v_mfma_f32_16x16x32_bf16 v[100:103], a[80:83], v[244:247], v[100:103]
  ds_read_b64_tr_b16 v[226:227], v3 offset:512
  s_add_u32 s28, s25, s78
  v_mfma_f32_16x16x32_bf16 v[100:103], a[96:99], v[248:251], v[100:103]
  ds_read_b64_tr_b16 v[228:229], v3 offset:4096
  v_mfma_f32_16x16x32_bf16 v[100:103], a[112:115], v[252:255], v[100:103]
  buffer_load_dwordx4 v9, s[44:47], s28 offen offset:128 lds
  v_mfma_f32_16x16x32_bf16 v[116:119], a[68:71], v[240:243], v[116:119]
  ds_read_b64_tr_b16 v[230:231], v3 offset:4608
  v_mfma_f32_16x16x32_bf16 v[116:119], a[84:87], v[244:247], v[116:119]
  ds_read_b64_tr_b16 v[232:233], v3 offset:8192
  v_mfma_f32_16x16x32_bf16 v[116:119], a[100:103], v[248:251], v[116:119]
  ds_read_b64_tr_b16 v[234:235], v3 offset:8704
  v_mfma_f32_16x16x32_bf16 v[116:119], a[116:119], v[252:255], v[116:119]
  buffer_load_dwordx4 v10, s[44:47], s28 offen offset:1152 lds
  v_mfma_f32_16x16x32_bf16 v[132:135], a[72:75], v[240:243], v[132:135]
  ds_read_b64_tr_b16 v[236:237], v3 offset:12288
  v_mfma_f32_16x16x32_bf16 v[132:135], a[88:91], v[244:247], v[132:135]
  ds_read_b64_tr_b16 v[238:239], v3 offset:12800
  v_mfma_f32_16x16x32_bf16 v[132:135], a[104:107], v[248:251], v[132:135]
  v_mfma_f32_16x16x32_bf16 v[132:135], a[120:123], v[252:255], v[132:135]
  buffer_load_dwordx4 v11, s[44:47], s28 offen offset:2176 lds
  v_mfma_f32_16x16x32_bf16 v[148:151], a[76:79], v[240:243], v[148:151]
  v_mfma_f32_16x16x32_bf16 v[148:151], a[92:95], v[244:247], v[148:151]
  v_mfma_f32_16x16x32_bf16 v[148:151], a[108:111], v[248:251], v[148:151]
  v_mfma_f32_16x16x32_bf16 v[148:151], a[124:127], v[252:255], v[148:151]
  buffer_load_dwordx4 v12, s[44:47], s28 offen offset:3200 lds
  s_waitcnt lgkmcnt(0)
  v_mfma_f32_16x16x32_bf16 v[104:107], a[64:67], v[224:227], v[104:107]
  ds_read_b64_tr_b16 v[240:241], v4 offset:0
  s_add_u32 m0, s20, 20352
  v_mfma_f32_16x16x32_bf16 v[104:107], a[80:83], v[228:231], v[104:107]
  ds_read_b64_tr_b16 v[242:243], v4 offset:512
  s_add_u32 s28, s26, s78
  v_mfma_f32_16x16x32_bf16 v[104:107], a[96:99], v[232:235], v[104:107]
  ds_read_b64_tr_b16 v[244:245], v4 offset:4096
  v_mfma_f32_16x16x32_bf16 v[104:107], a[112:115], v[236:239], v[104:107]
  buffer_load_dwordx4 v9, s[44:47], s28 offen offset:128 lds
  v_mfma_f32_16x16x32_bf16 v[120:123], a[68:71], v[224:227], v[120:123]
  ds_read_b64_tr_b16 v[246:247], v4 offset:4608
  v_mfma_f32_16x16x32_bf16 v[120:123], a[84:87], v[228:231], v[120:123]
  ds_read_b64_tr_b16 v[248:249], v4 offset:8192
  v_mfma_f32_16x16x32_bf16 v[120:123], a[100:103], v[232:235], v[120:123]
  ds_read_b64_tr_b16 v[250:251], v4 offset:8704
  v_mfma_f32_16x16x32_bf16 v[120:123], a[116:119], v[236:239], v[120:123]
  buffer_load_dwordx4 v10, s[44:47], s28 offen offset:1152 lds
  v_mfma_f32_16x16x32_bf16 v[136:139], a[72:75], v[224:227], v[136:139]
  ds_read_b64_tr_b16 v[252:253], v4 offset:12288
  v_mfma_f32_16x16x32_bf16 v[136:139], a[88:91], v[228:231], v[136:139]
  ds_read_b64_tr_b16 v[254:255], v4 offset:12800
  v_mfma_f32_16x16x32_bf16 v[136:139], a[104:107], v[232:235], v[136:139]
  v_mfma_f32_16x16x32_bf16 v[136:139], a[120:123], v[236:239], v[136:139]
  buffer_load_dwordx4 v11, s[44:47], s28 offen offset:2176 lds
  v_mfma_f32_16x16x32_bf16 v[152:155], a[76:79], v[224:227], v[152:155]
  v_mfma_f32_16x16x32_bf16 v[152:155], a[92:95], v[228:231], v[152:155]
  v_mfma_f32_16x16x32_bf16 v[152:155], a[108:111], v[232:235], v[152:155]
  v_mfma_f32_16x16x32_bf16 v[152:155], a[124:127], v[236:239], v[152:155]
  buffer_load_dwordx4 v12, s[44:47], s28 offen offset:3200 lds
  s_waitcnt vmcnt(25) lgkmcnt(0)
  s_barrier
  v_mfma_f32_16x16x32_bf16 v[108:111], a[64:67], v[240:243], v[108:111]
  ds_read_b64_tr_b16 v[224:225], v1 offset:16384
  s_add_u32 m0, s19, 0
  v_mfma_f32_16x16x32_bf16 v[108:111], a[80:83], v[244:247], v[108:111]
  ds_read_b64_tr_b16 v[226:227], v1 offset:16896
  s_add_u32 s21, s24, 256
  v_mfma_f32_16x16x32_bf16 v[108:111], a[96:99], v[248:251], v[108:111]
  ds_read_b64_tr_b16 v[228:229], v1 offset:20480
  v_mfma_f32_16x16x32_bf16 v[108:111], a[112:115], v[252:255], v[108:111]
  buffer_load_dwordx4 v5, s[12:15], s21 offen offset:0 lds
  v_mfma_f32_16x16x32_bf16 v[124:127], a[68:71], v[240:243], v[124:127]
  ds_read_b64_tr_b16 v[230:231], v1 offset:20992
  v_mfma_f32_16x16x32_bf16 v[124:127], a[84:87], v[244:247], v[124:127]
  ds_read_b64_tr_b16 v[232:233], v1 offset:24576
  v_mfma_f32_16x16x32_bf16 v[124:127], a[100:103], v[248:251], v[124:127]
  ds_read_b64_tr_b16 v[234:235], v1 offset:25088
  v_mfma_f32_16x16x32_bf16 v[124:127], a[116:119], v[252:255], v[124:127]
  buffer_load_dwordx4 v6, s[12:15], s21 offen offset:1024 lds
  v_mfma_f32_16x16x32_bf16 v[140:143], a[72:75], v[240:243], v[140:143]
  ds_read_b64_tr_b16 v[236:237], v1 offset:28672
  v_mfma_f32_16x16x32_bf16 v[140:143], a[88:91], v[244:247], v[140:143]
  ds_read_b64_tr_b16 v[238:239], v1 offset:29184
  v_mfma_f32_16x16x32_bf16 v[140:143], a[104:107], v[248:251], v[140:143]
  v_mfma_f32_16x16x32_bf16 v[140:143], a[120:123], v[252:255], v[140:143]
  buffer_load_dwordx4 v7, s[12:15], s21 offen offset:2048 lds
  v_mfma_f32_16x16x32_bf16 v[156:159], a[76:79], v[240:243], v[156:159]
  v_mfma_f32_16x16x32_bf16 v[156:159], a[92:95], v[244:247], v[156:159]
  v_mfma_f32_16x16x32_bf16 v[156:159], a[108:111], v[248:251], v[156:159]
  v_mfma_f32_16x16x32_bf16 v[156:159], a[124:127], v[252:255], v[156:159]
  buffer_load_dwordx4 v8, s[12:15], s21 offen offset:3072 lds
  s_waitcnt lgkmcnt(0)
  v_mfma_f32_16x16x32_bf16 v[160:163], a[64:67], v[224:227], v[160:163]
  ds_read_b64_tr_b16 v[240:241], v2 offset:16384
  s_add_u32 m0, s20, 0
  v_mfma_f32_16x16x32_bf16 v[160:163], a[80:83], v[228:231], v[160:163]
  ds_read_b64_tr_b16 v[242:243], v2 offset:16896
  s_add_u32 s28, s25, s79
  v_mfma_f32_16x16x32_bf16 v[160:163], a[96:99], v[232:235], v[160:163]
  ds_read_b64_tr_b16 v[244:245], v2 offset:20480
  v_mfma_f32_16x16x32_bf16 v[160:163], a[112:115], v[236:239], v[160:163]
  buffer_load_dwordx4 v9, s[44:47], s28 offen offset:0 lds
  v_mfma_f32_16x16x32_bf16 v[176:179], a[68:71], v[224:227], v[176:179]
  ds_read_b64_tr_b16 v[246:247], v2 offset:20992
  v_mfma_f32_16x16x32_bf16 v[176:179], a[84:87], v[228:231], v[176:179]
  ds_read_b64_tr_b16 v[248:249], v2 offset:24576
  v_mfma_f32_16x16x32_bf16 v[176:179], a[100:103], v[232:235], v[176:179]
  ds_read_b64_tr_b16 v[250:251], v2 offset:25088
  v_mfma_f32_16x16x32_bf16 v[176:179], a[116:119], v[236:239], v[176:179]
  buffer_load_dwordx4 v10, s[44:47], s28 offen offset:1024 lds
  v_mfma_f32_16x16x32_bf16 v[192:195], a[72:75], v[224:227], v[192:195]
  ds_read_b64_tr_b16 v[252:253], v2 offset:28672
  v_mfma_f32_16x16x32_bf16 v[192:195], a[88:91], v[228:231], v[192:195]
  ds_read_b64_tr_b16 v[254:255], v2 offset:29184
  v_mfma_f32_16x16x32_bf16 v[192:195], a[104:107], v[232:235], v[192:195]
  v_mfma_f32_16x16x32_bf16 v[192:195], a[120:123], v[236:239], v[192:195]
  buffer_load_dwordx4 v11, s[44:47], s28 offen offset:2048 lds
  v_mfma_f32_16x16x32_bf16 v[208:211], a[76:79], v[224:227], v[208:211]
  v_mfma_f32_16x16x32_bf16 v[208:211], a[92:95], v[228:231], v[208:211]
  v_mfma_f32_16x16x32_bf16 v[208:211], a[108:111], v[232:235], v[208:211]
  v_mfma_f32_16x16x32_bf16 v[208:211], a[124:127], v[236:239], v[208:211]
  buffer_load_dwordx4 v12, s[44:47], s28 offen offset:3072 lds
  s_waitcnt vmcnt(16) lgkmcnt(0)
  v_mfma_f32_16x16x32_bf16 v[164:167], a[64:67], v[240:243], v[164:167]
  ds_read_b64_tr_b16 v[224:225], v3 offset:16384
  s_add_u32 m0, s20, 4096
  v_mfma_f32_16x16x32_bf16 v[164:167], a[80:83], v[244:247], v[164:167]
  ds_read_b64_tr_b16 v[226:227], v3 offset:16896
  s_add_u32 s28, s26, s79
  v_mfma_f32_16x16x32_bf16 v[164:167], a[96:99], v[248:251], v[164:167]
  ds_read_b64_tr_b16 v[228:229], v3 offset:20480
  v_mfma_f32_16x16x32_bf16 v[164:167], a[112:115], v[252:255], v[164:167]
  ds_read_b128 a[128:131], v13 offset:8192
  buffer_load_dwordx4 v9, s[44:47], s28 offen offset:0 lds
  v_mfma_f32_16x16x32_bf16 v[180:183], a[68:71], v[240:243], v[180:183]
  ds_read_b64_tr_b16 v[230:231], v3 offset:20992
  v_mfma_f32_16x16x32_bf16 v[180:183], a[84:87], v[244:247], v[180:183]
  ds_read_b64_tr_b16 v[232:233], v3 offset:24576
  v_mfma_f32_16x16x32_bf16 v[180:183], a[100:103], v[248:251], v[180:183]
  ds_read_b64_tr_b16 v[234:235], v3 offset:25088
  v_mfma_f32_16x16x32_bf16 v[180:183], a[116:119], v[252:255], v[180:183]
  ds_read_b128 a[144:147], v14 offset:8192
  buffer_load_dwordx4 v10, s[44:47], s28 offen offset:1024 lds
  v_mfma_f32_16x16x32_bf16 v[196:199], a[72:75], v[240:243], v[196:199]
  ds_read_b64_tr_b16 v[236:237], v3 offset:28672
  v_mfma_f32_16x16x32_bf16 v[196:199], a[88:91], v[244:247], v[196:199]
  ds_read_b64_tr_b16 v[238:239], v3 offset:29184
  v_mfma_f32_16x16x32_bf16 v[196:199], a[104:107], v[248:251], v[196:199]
  ds_read_b128 a[132:135], v13 offset:10240
  v_mfma_f32_16x16x32_bf16 v[196:199], a[120:123], v[252:255], v[196:199]
  ds_read_b128 a[148:151], v14 offset:10240
  buffer_load_dwordx4 v11, s[44:47], s28 offen offset:2048 lds
  v_mfma_f32_16x16x32_bf16 v[212:215], a[76:79], v[240:243], v[212:215]
  ds_read_b128 a[136:139], v13 offset:12288
  v_mfma_f32_16x16x32_bf16 v[212:215], a[92:95], v[244:247], v[212:215]
  ds_read_b128 a[152:155], v14 offset:12288
  v_mfma_f32_16x16x32_bf16 v[212:215], a[108:111], v[248:251], v[212:215]
  ds_read_b128 a[140:143], v13 offset:14336
  v_mfma_f32_16x16x32_bf16 v[212:215], a[124:127], v[252:255], v[212:215]
  ds_read_b128 a[156:159], v14 offset:14336
  buffer_load_dwordx4 v12, s[44:47], s28 offen offset:3072 lds
  s_waitcnt vmcnt(12) lgkmcnt(4)
  v_mfma_f32_16x16x32_bf16 v[168:171], a[64:67], v[224:227], v[168:171]
  ds_read_b64_tr_b16 v[240:241], v4 offset:16384
  v_mfma_f32_16x16x32_bf16 v[168:171], a[80:83], v[228:231], v[168:171]
  ds_read_b64_tr_b16 v[242:243], v4 offset:16896
  v_mfma_f32_16x16x32_bf16 v[168:171], a[96:99], v[232:235], v[168:171]
  ds_read_b64_tr_b16 v[244:245], v4 offset:20480
  v_mfma_f32_16x16x32_bf16 v[168:171], a[112:115], v[236:239], v[168:171]
  ds_read_b128 a[160:163], v13 offset:16384
  v_mfma_f32_16x16x32_bf16 v[184:187], a[68:71], v[224:227], v[184:187]
  ds_read_b64_tr_b16 v[246:247], v4 offset:20992
  v_mfma_f32_16x16x32_bf16 v[184:187], a[84:87], v[228:231], v[184:187]
  ds_read_b64_tr_b16 v[248:249], v4 offset:24576
  v_mfma_f32_16x16x32_bf16 v[184:187], a[100:103], v[232:235], v[184:187]
  ds_read_b64_tr_b16 v[250:251], v4 offset:25088
  v_mfma_f32_16x16x32_bf16 v[184:187], a[116:119], v[236:239], v[184:187]
  ds_read_b128 a[176:179], v14 offset:16384
  v_mfma_f32_16x16x32_bf16 v[200:203], a[72:75], v[224:227], v[200:203]
  ds_read_b64_tr_b16 v[252:253], v4 offset:28672
  v_mfma_f32_16x16x32_bf16 v[200:203], a[88:91], v[228:231], v[200:203]
  ds_read_b64_tr_b16 v[254:255], v4 offset:29184
  v_mfma_f32_16x16x32_bf16 v[200:203], a[104:107], v[232:235], v[200:203]
  ds_read_b128 a[164:167], v13 offset:18432
  v_mfma_f32_16x16x32_bf16 v[200:203], a[120:123], v[236:239], v[200:203]
  ds_read_b128 a[180:183], v14 offset:18432
  v_mfma_f32_16x16x32_bf16 v[216:219], a[76:79], v[224:227], v[216:219]
  ds_read_b128 a[168:171], v13 offset:20480
  v_mfma_f32_16x16x32_bf16 v[216:219], a[92:95], v[228:231], v[216:219]
  ds_read_b128 a[184:187], v14 offset:20480
  v_mfma_f32_16x16x32_bf16 v[216:219], a[108:111], v[232:235], v[216:219]
  ds_read_b128 a[172:175], v13 offset:22528
  v_mfma_f32_16x16x32_bf16 v[216:219], a[124:127], v[236:239], v[216:219]
  ds_read_b128 a[188:191], v14 offset:22528
  s_waitcnt vmcnt(33) lgkmcnt(4)
  s_barrier
  v_mfma_f32_16x16x32_bf16 v[172:175], a[64:67], v[240:243], v[172:175]
  ds_read_b64_tr_b16 v[224:225], v1 offset:32768
  s_add_u32 m0, s19, 16384
  v_mfma_f32_16x16x32_bf16 v[172:175], a[80:83], v[244:247], v[172:175]
  ds_read_b64_tr_b16 v[226:227], v1 offset:33280
  s_add_u32 s21, s38, 0
  v_mfma_f32_16x16x32_bf16 v[172:175], a[96:99], v[248:251], v[172:175]
  ds_read_b64_tr_b16 v[228:229], v1 offset:36864
  v_mfma_f32_16x16x32_bf16 v[172:175], a[112:115], v[252:255], v[172:175]
  buffer_load_dwordx4 v5, s[12:15], s21 offen offset:0 lds
  v_mfma_f32_16x16x32_bf16 v[188:191], a[68:71], v[240:243], v[188:191]
  ds_read_b64_tr_b16 v[230:231], v1 offset:37376
  v_mfma_f32_16x16x32_bf16 v[188:191], a[84:87], v[244:247], v[188:191]
  ds_read_b64_tr_b16 v[232:233], v1 offset:40960
  v_mfma_f32_16x16x32_bf16 v[188:191], a[100:103], v[248:251], v[188:191]
  ds_read_b64_tr_b16 v[234:235], v1 offset:41472
  v_mfma_f32_16x16x32_bf16 v[188:191], a[116:119], v[252:255], v[188:191]
  buffer_load_dwordx4 v6, s[12:15], s21 offen offset:1024 lds
  v_mfma_f32_16x16x32_bf16 v[204:207], a[72:75], v[240:243], v[204:207]
  ds_read_b64_tr_b16 v[236:237], v1 offset:45056
  v_mfma_f32_16x16x32_bf16 v[204:207], a[88:91], v[244:247], v[204:207]
  ds_read_b64_tr_b16 v[238:239], v1 offset:45568
  v_mfma_f32_16x16x32_bf16 v[204:207], a[104:107], v[248:251], v[204:207]
  v_mfma_f32_16x16x32_bf16 v[204:207], a[120:123], v[252:255], v[204:207]
  buffer_load_dwordx4 v7, s[12:15], s21 offen offset:2048 lds
  v_mfma_f32_16x16x32_bf16 v[220:223], a[76:79], v[240:243], v[220:223]
  v_mfma_f32_16x16x32_bf16 v[220:223], a[92:95], v[244:247], v[220:223]
  v_mfma_f32_16x16x32_bf16 v[220:223], a[108:111], v[248:251], v[220:223]
  v_mfma_f32_16x16x32_bf16 v[220:223], a[124:127], v[252:255], v[220:223]
  buffer_load_dwordx4 v8, s[12:15], s21 offen offset:3072 lds
  s_waitcnt lgkmcnt(0)
  v_mfma_f32_16x16x32_bf16 v[32:35], a[128:131], v[224:227], v[32:35]
  ds_read_b64_tr_b16 v[240:241], v2 offset:32768
  s_add_u32 m0, s20, 8064
  v_mfma_f32_16x16x32_bf16 v[32:35], a[144:147], v[228:231], v[32:35]
  ds_read_b64_tr_b16 v[242:243], v2 offset:33280
  s_add_u32 s28, s25, s79
  v_mfma_f32_16x16x32_bf16 v[32:35], a[160:163], v[232:235], v[32:35]
  ds_read_b64_tr_b16 v[244:245], v2 offset:36864
  v_mfma_f32_16x16x32_bf16 v[32:35], a[176:179], v[236:239], v[32:35]
  buffer_load_dwordx4 v9, s[44:47], s28 offen offset:128 lds
  v_mfma_f32_16x16x32_bf16 v[48:51], a[132:135], v[224:227], v[48:51]
  ds_read_b64_tr_b16 v[246:247], v2 offset:37376
  v_mfma_f32_16x16x32_bf16 v[48:51], a[148:151], v[228:231], v[48:51]
  ds_read_b64_tr_b16 v[248:249], v2 offset:40960
  v_mfma_f32_16x16x32_bf16 v[48:51], a[164:167], v[232:235], v[48:51]
  ds_read_b64_tr_b16 v[250:251], v2 offset:41472
  v_mfma_f32_16x16x32_bf16 v[48:51], a[180:183], v[236:239], v[48:51]
  buffer_load_dwordx4 v10, s[44:47], s28 offen offset:1152 lds
  v_mfma_f32_16x16x32_bf16 v[64:67], a[136:139], v[224:227], v[64:67]
  ds_read_b64_tr_b16 v[252:253], v2 offset:45056
  v_mfma_f32_16x16x32_bf16 v[64:67], a[152:155], v[228:231], v[64:67]
  ds_read_b64_tr_b16 v[254:255], v2 offset:45568
  v_mfma_f32_16x16x32_bf16 v[64:67], a[168:171], v[232:235], v[64:67]
  v_mfma_f32_16x16x32_bf16 v[64:67], a[184:187], v[236:239], v[64:67]
  buffer_load_dwordx4 v11, s[44:47], s28 offen offset:2176 lds
  v_mfma_f32_16x16x32_bf16 v[80:83], a[140:143], v[224:227], v[80:83]
  v_mfma_f32_16x16x32_bf16 v[80:83], a[156:159], v[228:231], v[80:83]
  v_mfma_f32_16x16x32_bf16 v[80:83], a[172:175], v[232:235], v[80:83]
  v_mfma_f32_16x16x32_bf16 v[80:83], a[188:191], v[236:239], v[80:83]
  buffer_load_dwordx4 v12, s[44:47], s28 offen offset:3200 lds
  s_waitcnt lgkmcnt(0)
  v_mfma_f32_16x16x32_bf16 v[36:39], a[128:131], v[240:243], v[36:39]
  ds_read_b64_tr_b16 v[224:225], v3 offset:32768
  s_add_u32 m0, s20, 12160
  v_mfma_f32_16x16x32_bf16 v[36:39], a[144:147], v[244:247], v[36:39]
  ds_read_b64_tr_b16 v[226:227], v3 offset:33280
  s_add_u32 s28, s26, s79
  v_mfma_f32_16x16x32_bf16 v[36:39], a[160:163], v[248:251], v[36:39]
  ds_read_b64_tr_b16 v[228:229], v3 offset:36864
  v_mfma_f32_16x16x32_bf16 v[36:39], a[176:179], v[252:255], v[36:39]
  buffer_load_dwordx4 v9, s[44:47], s28 offen offset:128 lds
  v_mfma_f32_16x16x32_bf16 v[52:55], a[132:135], v[240:243], v[52:55]
  ds_read_b64_tr_b16 v[230:231], v3 offset:37376
  v_mfma_f32_16x16x32_bf16 v[52:55], a[148:151], v[244:247], v[52:55]
  ds_read_b64_tr_b16 v[232:233], v3 offset:40960
  v_mfma_f32_16x16x32_bf16 v[52:55], a[164:167], v[248:251], v[52:55]
  ds_read_b64_tr_b16 v[234:235], v3 offset:41472
  v_mfma_f32_16x16x32_bf16 v[52:55], a[180:183], v[252:255], v[52:55]
  buffer_load_dwordx4 v10, s[44:47], s28 offen offset:1152 lds
  v_mfma_f32_16x16x32_bf16 v[68:71], a[136:139], v[240:243], v[68:71]
  ds_read_b64_tr_b16 v[236:237], v3 offset:45056
  v_mfma_f32_16x16x32_bf16 v[68:71], a[152:155], v[244:247], v[68:71]
  ds_read_b64_tr_b16 v[238:239], v3 offset:45568
  v_mfma_f32_16x16x32_bf16 v[68:71], a[168:171], v[248:251], v[68:71]
  v_mfma_f32_16x16x32_bf16 v[68:71], a[184:187], v[252:255], v[68:71]
  buffer_load_dwordx4 v11, s[44:47], s28 offen offset:2176 lds
  v_mfma_f32_16x16x32_bf16 v[84:87], a[140:143], v[240:243], v[84:87]
  v_mfma_f32_16x16x32_bf16 v[84:87], a[156:159], v[244:247], v[84:87]
  v_mfma_f32_16x16x32_bf16 v[84:87], a[172:175], v[248:251], v[84:87]
  v_mfma_f32_16x16x32_bf16 v[84:87], a[188:191], v[252:255], v[84:87]
  buffer_load_dwordx4 v12, s[44:47], s28 offen offset:3200 lds
  s_waitcnt lgkmcnt(0)
  v_mfma_f32_16x16x32_bf16 v[40:43], a[128:131], v[224:227], v[40:43]
  ds_read_b64_tr_b16 v[240:241], v4 offset:32768
  s_mov_b64 s[96:97], s[52:53]
  v_mfma_f32_16x16x32_bf16 v[40:43], a[144:147], v[228:231], v[40:43]
  ds_read_b64_tr_b16 v[242:243], v4 offset:33280
  v_mfma_f32_16x16x32_bf16 v[40:43], a[160:163], v[232:235], v[40:43]
  ds_read_b64_tr_b16 v[244:245], v4 offset:36864
  v_mfma_f32_16x16x32_bf16 v[40:43], a[176:179], v[236:239], v[40:43]
  s_mov_b32 s98, 4194304
  v_mfma_f32_16x16x32_bf16 v[56:59], a[132:135], v[224:227], v[56:59]
  ds_read_b64_tr_b16 v[246:247], v4 offset:37376
  v_mfma_f32_16x16x32_bf16 v[56:59], a[148:151], v[228:231], v[56:59]
  ds_read_b64_tr_b16 v[248:249], v4 offset:40960
  v_mfma_f32_16x16x32_bf16 v[56:59], a[164:167], v[232:235], v[56:59]
  ds_read_b64_tr_b16 v[250:251], v4 offset:41472
  s_mov_b32 s99, 0x20000
  v_mfma_f32_16x16x32_bf16 v[56:59], a[180:183], v[236:239], v[56:59]
  v_mfma_f32_16x16x32_bf16 v[72:75], a[136:139], v[224:227], v[72:75]
  ds_read_b64_tr_b16 v[252:253], v4 offset:45056
  v_mfma_f32_16x16x32_bf16 v[72:75], a[152:155], v[228:231], v[72:75]
  ds_read_b64_tr_b16 v[254:255], v4 offset:45568
  s_lshl_b32 s101, s17, 8
  v_mfma_f32_16x16x32_bf16 v[72:75], a[168:171], v[232:235], v[72:75]
  v_mfma_f32_16x16x32_bf16 v[72:75], a[184:187], v[236:239], v[72:75]
  v_mfma_f32_16x16x32_bf16 v[88:91], a[140:143], v[224:227], v[88:91]
  buffer_load_dword v23, v29, s[96:99], s101 offen
  v_mfma_f32_16x16x32_bf16 v[88:91], a[156:159], v[228:231], v[88:91]
  v_mfma_f32_16x16x32_bf16 v[88:91], a[172:175], v[232:235], v[88:91]
  v_mfma_f32_16x16x32_bf16 v[88:91], a[188:191], v[236:239], v[88:91]
  s_waitcnt vmcnt(37) lgkmcnt(0)
  s_barrier
  v_mfma_f32_16x16x32_bf16 v[44:47], a[128:131], v[240:243], v[44:47]
  ds_read_b64_tr_b16 v[224:225], v1 offset:49152
  s_add_u32 m0, s19, 32768
  v_mfma_f32_16x16x32_bf16 v[44:47], a[144:147], v[244:247], v[44:47]
  ds_read_b64_tr_b16 v[226:227], v1 offset:49664
  s_add_u32 s21, s38, 128
  v_mfma_f32_16x16x32_bf16 v[44:47], a[160:163], v[248:251], v[44:47]
  ds_read_b64_tr_b16 v[228:229], v1 offset:53248
  v_mfma_f32_16x16x32_bf16 v[44:47], a[176:179], v[252:255], v[44:47]
  buffer_load_dwordx4 v5, s[12:15], s21 offen offset:0 lds
  v_mfma_f32_16x16x32_bf16 v[60:63], a[132:135], v[240:243], v[60:63]
  ds_read_b64_tr_b16 v[230:231], v1 offset:53760
  v_mfma_f32_16x16x32_bf16 v[60:63], a[148:151], v[244:247], v[60:63]
  ds_read_b64_tr_b16 v[232:233], v1 offset:57344
  v_mfma_f32_16x16x32_bf16 v[60:63], a[164:167], v[248:251], v[60:63]
  ds_read_b64_tr_b16 v[234:235], v1 offset:57856
  v_mfma_f32_16x16x32_bf16 v[60:63], a[180:183], v[252:255], v[60:63]
  buffer_load_dwordx4 v6, s[12:15], s21 offen offset:1024 lds
  v_mfma_f32_16x16x32_bf16 v[76:79], a[136:139], v[240:243], v[76:79]
  ds_read_b64_tr_b16 v[236:237], v1 offset:61440
  v_mfma_f32_16x16x32_bf16 v[76:79], a[152:155], v[244:247], v[76:79]
  ds_read_b64_tr_b16 v[238:239], v1 offset:61952
  v_mfma_f32_16x16x32_bf16 v[76:79], a[168:171], v[248:251], v[76:79]
  v_mfma_f32_16x16x32_bf16 v[76:79], a[184:187], v[252:255], v[76:79]
  buffer_load_dwordx4 v7, s[12:15], s21 offen offset:2048 lds
  v_mfma_f32_16x16x32_bf16 v[92:95], a[140:143], v[240:243], v[92:95]
  v_mfma_f32_16x16x32_bf16 v[92:95], a[156:159], v[244:247], v[92:95]
  v_mfma_f32_16x16x32_bf16 v[92:95], a[172:175], v[248:251], v[92:95]
  v_mfma_f32_16x16x32_bf16 v[92:95], a[188:191], v[252:255], v[92:95]
  buffer_load_dwordx4 v8, s[12:15], s21 offen offset:3072 lds
  s_waitcnt vmcnt(17) lgkmcnt(0)
  v_mfma_f32_16x16x32_bf16 v[96:99], a[128:131], v[224:227], v[96:99]
  ds_read_b64_tr_b16 v[240:241], v2 offset:49152
  v_mfma_f32_16x16x32_bf16 v[96:99], a[144:147], v[228:231], v[96:99]
  ds_read_b64_tr_b16 v[242:243], v2 offset:49664
  v_mfma_f32_16x16x32_bf16 v[96:99], a[160:163], v[232:235], v[96:99]
  ds_read_b64_tr_b16 v[244:245], v2 offset:53248
  v_mfma_f32_16x16x32_bf16 v[96:99], a[176:179], v[236:239], v[96:99]
  ds_read_b128 a[192:195], v13 offset:0
  v_mfma_f32_16x16x32_bf16 v[112:115], a[132:135], v[224:227], v[112:115]
  ds_read_b64_tr_b16 v[246:247], v2 offset:53760
  v_mfma_f32_16x16x32_bf16 v[112:115], a[148:151], v[228:231], v[112:115]
  ds_read_b64_tr_b16 v[248:249], v2 offset:57344
  v_mfma_f32_16x16x32_bf16 v[112:115], a[164:167], v[232:235], v[112:115]
  ds_read_b64_tr_b16 v[250:251], v2 offset:57856
  v_mfma_f32_16x16x32_bf16 v[112:115], a[180:183], v[236:239], v[112:115]
  ds_read_b128 a[208:211], v14 offset:0
  v_mfma_f32_16x16x32_bf16 v[128:131], a[136:139], v[224:227], v[128:131]
  ds_read_b64_tr_b16 v[252:253], v2 offset:61440
  v_mfma_f32_16x16x32_bf16 v[128:131], a[152:155], v[228:231], v[128:131]
  ds_read_b64_tr_b16 v[254:255], v2 offset:61952
  v_mfma_f32_16x16x32_bf16 v[128:131], a[168:171], v[232:235], v[128:131]
  ds_read_b128 a[196:199], v13 offset:2048
  v_mfma_f32_16x16x32_bf16 v[128:131], a[184:187], v[236:239], v[128:131]
  ds_read_b128 a[212:215], v14 offset:2048
  v_mfma_f32_16x16x32_bf16 v[144:147], a[140:143], v[224:227], v[144:147]
  ds_read_b128 a[200:203], v13 offset:4096
  v_mfma_f32_16x16x32_bf16 v[144:147], a[156:159], v[228:231], v[144:147]
  ds_read_b128 a[216:219], v14 offset:4096
  v_mfma_f32_16x16x32_bf16 v[144:147], a[172:175], v[232:235], v[144:147]
  ds_read_b128 a[204:207], v13 offset:6144
  v_mfma_f32_16x16x32_bf16 v[144:147], a[188:191], v[236:239], v[144:147]
  ds_read_b128 a[220:223], v14 offset:6144
  s_waitcnt lgkmcnt(4)
  v_mfma_f32_16x16x32_bf16 v[100:103], a[128:131], v[240:243], v[100:103]
  ds_read_b64_tr_b16 v[224:225], v3 offset:49152
  s_mov_b64 s[44:45], s[54:55]
  v_mfma_f32_16x16x32_bf16 v[100:103], a[144:147], v[244:247], v[100:103]
  ds_read_b64_tr_b16 v[226:227], v3 offset:49664
  s_lshl_b32 s25, s18, 2
  v_mfma_f32_16x16x32_bf16 v[100:103], a[160:163], v[248:251], v[100:103]
  ds_read_b64_tr_b16 v[228:229], v3 offset:53248
  s_add_u32 s25, s25, s16
  v_mfma_f32_16x16x32_bf16 v[100:103], a[176:179], v[252:255], v[100:103]
  s_sub_u32 s26, 63, s25
  s_lshl_b32 s25, s25, 15
  s_lshl_b32 s26, s26, 15
  v_mfma_f32_16x16x32_bf16 v[116:119], a[132:135], v[240:243], v[116:119]
  ds_read_b64_tr_b16 v[230:231], v3 offset:53760
  s_add_u32 s5, s17, s18
  v_mfma_f32_16x16x32_bf16 v[116:119], a[148:151], v[244:247], v[116:119]
  ds_read_b64_tr_b16 v[232:233], v3 offset:57344
  s_and_b32 s5, s5, 2
  v_mfma_f32_16x16x32_bf16 v[116:119], a[164:167], v[248:251], v[116:119]
  ds_read_b64_tr_b16 v[234:235], v3 offset:57856
  s_lshl_b32 s5, s5, 8
  v_mfma_f32_16x16x32_bf16 v[116:119], a[180:183], v[252:255], v[116:119]
  s_mov_b32 s3, s77
  s_xor_b32 s76, s5, 0
  s_xor_b32 s77, s5, 256
  v_mfma_f32_16x16x32_bf16 v[132:135], a[136:139], v[240:243], v[132:135]
  ds_read_b64_tr_b16 v[236:237], v3 offset:61440
  s_xor_b32 s78, s5, 512
  v_mfma_f32_16x16x32_bf16 v[132:135], a[152:155], v[244:247], v[132:135]
  ds_read_b64_tr_b16 v[238:239], v3 offset:61952
  s_xor_b32 s79, s5, 768
  v_mfma_f32_16x16x32_bf16 v[132:135], a[168:171], v[248:251], v[132:135]
  v_mfma_f32_16x16x32_bf16 v[132:135], a[184:187], v[252:255], v[132:135]
  v_mfma_f32_16x16x32_bf16 v[148:151], a[140:143], v[240:243], v[148:151]
  v_mfma_f32_16x16x32_bf16 v[148:151], a[156:159], v[244:247], v[148:151]
  v_mfma_f32_16x16x32_bf16 v[148:151], a[172:175], v[248:251], v[148:151]
  v_mfma_f32_16x16x32_bf16 v[148:151], a[188:191], v[252:255], v[148:151]
  s_waitcnt vmcnt(5) lgkmcnt(0)
  v_mfma_f32_16x16x32_bf16 v[104:107], a[128:131], v[224:227], v[104:107]
  ds_read_b64_tr_b16 v[240:241], v4 offset:49152
  v_mfma_f32_16x16x32_bf16 v[104:107], a[144:147], v[228:231], v[104:107]
  ds_read_b64_tr_b16 v[242:243], v4 offset:49664
  v_mfma_f32_16x16x32_bf16 v[104:107], a[160:163], v[232:235], v[104:107]
  ds_read_b64_tr_b16 v[244:245], v4 offset:53248
  v_mfma_f32_16x16x32_bf16 v[104:107], a[176:179], v[236:239], v[104:107]
  ds_read_b128 a[224:227], v13 offset:8192
  v_mfma_f32_16x16x32_bf16 v[120:123], a[132:135], v[224:227], v[120:123]
  ds_read_b64_tr_b16 v[246:247], v4 offset:53760
  v_mfma_f32_16x16x32_bf16 v[120:123], a[148:151], v[228:231], v[120:123]
  ds_read_b64_tr_b16 v[248:249], v4 offset:57344
  v_mfma_f32_16x16x32_bf16 v[120:123], a[164:167], v[232:235], v[120:123]
  ds_read_b64_tr_b16 v[250:251], v4 offset:57856
  v_mfma_f32_16x16x32_bf16 v[120:123], a[180:183], v[236:239], v[120:123]
  ds_read_b128 a[240:243], v14 offset:8192
  v_mfma_f32_16x16x32_bf16 v[136:139], a[136:139], v[224:227], v[136:139]
  ds_read_b64_tr_b16 v[252:253], v4 offset:61440
  v_mfma_f32_16x16x32_bf16 v[136:139], a[152:155], v[228:231], v[136:139]
  ds_read_b64_tr_b16 v[254:255], v4 offset:61952
  v_mfma_f32_16x16x32_bf16 v[136:139], a[168:171], v[232:235], v[136:139]
  ds_read_b128 a[228:231], v13 offset:10240
  v_mfma_f32_16x16x32_bf16 v[136:139], a[184:187], v[236:239], v[136:139]
  ds_read_b128 a[244:247], v14 offset:10240
  v_mfma_f32_16x16x32_bf16 v[152:155], a[140:143], v[224:227], v[152:155]
  ds_read_b128 a[232:235], v13 offset:12288
  v_mfma_f32_16x16x32_bf16 v[152:155], a[156:159], v[228:231], v[152:155]
  ds_read_b128 a[248:251], v14 offset:12288
  v_mfma_f32_16x16x32_bf16 v[152:155], a[172:175], v[232:235], v[152:155]
  ds_read_b128 a[236:239], v13 offset:14336
  v_mfma_f32_16x16x32_bf16 v[152:155], a[188:191], v[236:239], v[152:155]
  ds_read_b128 a[252:255], v14 offset:14336
  s_waitcnt vmcnt(25) lgkmcnt(4)
  s_barrier
  v_mfma_f32_16x16x32_bf16 v[108:111], a[128:131], v[240:243], v[108:111]
  ds_read_b64_tr_b16 v[224:225], v1 offset:0
  s_add_u32 m0, s19, 49152
  v_mfma_f32_16x16x32_bf16 v[108:111], a[144:147], v[244:247], v[108:111]
  ds_read_b64_tr_b16 v[226:227], v1 offset:512
  s_add_u32 s21, s38, 256
  v_mfma_f32_16x16x32_bf16 v[108:111], a[160:163], v[248:251], v[108:111]
  ds_read_b64_tr_b16 v[228:229], v1 offset:4096
  v_mfma_f32_16x16x32_bf16 v[108:111], a[176:179], v[252:255], v[108:111]
  buffer_load_dwordx4 v5, s[12:15], s21 offen offset:0 lds
  v_mfma_f32_16x16x32_bf16 v[124:127], a[132:135], v[240:243], v[124:127]
  ds_read_b64_tr_b16 v[230:231], v1 offset:4608
  v_mfma_f32_16x16x32_bf16 v[124:127], a[148:151], v[244:247], v[124:127]
  ds_read_b64_tr_b16 v[232:233], v1 offset:8192
  v_mfma_f32_16x16x32_bf16 v[124:127], a[164:167], v[248:251], v[124:127]
  ds_read_b64_tr_b16 v[234:235], v1 offset:8704
  v_mfma_f32_16x16x32_bf16 v[124:127], a[180:183], v[252:255], v[124:127]
  buffer_load_dwordx4 v6, s[12:15], s21 offen offset:1024 lds
  v_mfma_f32_16x16x32_bf16 v[140:143], a[136:139], v[240:243], v[140:143]
  ds_read_b64_tr_b16 v[236:237], v1 offset:12288
  v_mfma_f32_16x16x32_bf16 v[140:143], a[152:155], v[244:247], v[140:143]
  ds_read_b64_tr_b16 v[238:239], v1 offset:12800
  v_mfma_f32_16x16x32_bf16 v[140:143], a[168:171], v[248:251], v[140:143]
  v_mfma_f32_16x16x32_bf16 v[140:143], a[184:187], v[252:255], v[140:143]
  buffer_load_dwordx4 v7, s[12:15], s21 offen offset:2048 lds
  v_mfma_f32_16x16x32_bf16 v[156:159], a[140:143], v[240:243], v[156:159]
  v_mfma_f32_16x16x32_bf16 v[156:159], a[156:159], v[244:247], v[156:159]
  v_mfma_f32_16x16x32_bf16 v[156:159], a[172:175], v[248:251], v[156:159]
  v_mfma_f32_16x16x32_bf16 v[156:159], a[188:191], v[252:255], v[156:159]
  buffer_load_dwordx4 v8, s[12:15], s21 offen offset:3072 lds
  s_waitcnt lgkmcnt(0)
  v_mfma_f32_16x16x32_bf16 v[160:163], a[128:131], v[224:227], v[160:163]
  ds_read_b64_tr_b16 v[240:241], v2 offset:0
  s_add_u32 m0, s20, 0
  v_mfma_f32_16x16x32_bf16 v[160:163], a[144:147], v[228:231], v[160:163]
  ds_read_b64_tr_b16 v[242:243], v2 offset:512
  s_add_u32 s28, s25, s76
  v_mfma_f32_16x16x32_bf16 v[160:163], a[160:163], v[232:235], v[160:163]
  ds_read_b64_tr_b16 v[244:245], v2 offset:4096
  v_mfma_f32_16x16x32_bf16 v[160:163], a[176:179], v[236:239], v[160:163]
  buffer_load_dwordx4 v9, s[44:47], s28 offen offset:0 lds
  v_mfma_f32_16x16x32_bf16 v[176:179], a[132:135], v[224:227], v[176:179]
  ds_read_b64_tr_b16 v[246:247], v2 offset:4608
  v_mfma_f32_16x16x32_bf16 v[176:179], a[148:151], v[228:231], v[176:179]
  ds_read_b64_tr_b16 v[248:249], v2 offset:8192
  v_mfma_f32_16x16x32_bf16 v[176:179], a[164:167], v[232:235], v[176:179]
  ds_read_b64_tr_b16 v[250:251], v2 offset:8704
  v_mfma_f32_16x16x32_bf16 v[176:179], a[180:183], v[236:239], v[176:179]
  buffer_load_dwordx4 v10, s[44:47], s28 offen offset:1024 lds
  v_mfma_f32_16x16x32_bf16 v[192:195], a[136:139], v[224:227], v[192:195]
  ds_read_b64_tr_b16 v[252:253], v2 offset:12288
  v_mfma_f32_16x16x32_bf16 v[192:195], a[152:155], v[228:231], v[192:195]
  ds_read_b64_tr_b16 v[254:255], v2 offset:12800
  v_mfma_f32_16x16x32_bf16 v[192:195], a[168:171], v[232:235], v[192:195]
  v_mfma_f32_16x16x32_bf16 v[192:195], a[184:187], v[236:239], v[192:195]
  buffer_load_dwordx4 v11, s[44:47], s28 offen offset:2048 lds
  v_mfma_f32_16x16x32_bf16 v[208:211], a[140:143], v[224:227], v[208:211]
  v_mfma_f32_16x16x32_bf16 v[208:211], a[156:159], v[228:231], v[208:211]
  v_mfma_f32_16x16x32_bf16 v[208:211], a[172:175], v[232:235], v[208:211]
  v_mfma_f32_16x16x32_bf16 v[208:211], a[188:191], v[236:239], v[208:211]
  buffer_load_dwordx4 v12, s[44:47], s28 offen offset:3072 lds
  s_waitcnt lgkmcnt(0)
  v_mfma_f32_16x16x32_bf16 v[164:167], a[128:131], v[240:243], v[164:167]
  ds_read_b64_tr_b16 v[224:225], v3 offset:0
  s_add_u32 m0, s20, 4096
  v_mfma_f32_16x16x32_bf16 v[164:167], a[144:147], v[244:247], v[164:167]
  ds_read_b64_tr_b16 v[226:227], v3 offset:512
  s_add_u32 s28, s26, s76
  v_mfma_f32_16x16x32_bf16 v[164:167], a[160:163], v[248:251], v[164:167]
  ds_read_b64_tr_b16 v[228:229], v3 offset:4096
  v_mfma_f32_16x16x32_bf16 v[164:167], a[176:179], v[252:255], v[164:167]
  buffer_load_dwordx4 v9, s[44:47], s28 offen offset:0 lds
  v_mfma_f32_16x16x32_bf16 v[180:183], a[132:135], v[240:243], v[180:183]
  ds_read_b64_tr_b16 v[230:231], v3 offset:4608
  v_mfma_f32_16x16x32_bf16 v[180:183], a[148:151], v[244:247], v[180:183]
  ds_read_b64_tr_b16 v[232:233], v3 offset:8192
  v_mfma_f32_16x16x32_bf16 v[180:183], a[164:167], v[248:251], v[180:183]
  ds_read_b64_tr_b16 v[234:235], v3 offset:8704
  v_mfma_f32_16x16x32_bf16 v[180:183], a[180:183], v[252:255], v[180:183]
  buffer_load_dwordx4 v10, s[44:47], s28 offen offset:1024 lds
  v_mfma_f32_16x16x32_bf16 v[196:199], a[136:139], v[240:243], v[196:199]
  ds_read_b64_tr_b16 v[236:237], v3 offset:12288
  v_mfma_f32_16x16x32_bf16 v[196:199], a[152:155], v[244:247], v[196:199]
  ds_read_b64_tr_b16 v[238:239], v3 offset:12800
  v_mfma_f32_16x16x32_bf16 v[196:199], a[168:171], v[248:251], v[196:199]
  v_mfma_f32_16x16x32_bf16 v[196:199], a[184:187], v[252:255], v[196:199]
  buffer_load_dwordx4 v11, s[44:47], s28 offen offset:2048 lds
  v_mfma_f32_16x16x32_bf16 v[212:215], a[140:143], v[240:243], v[212:215]
  v_mfma_f32_16x16x32_bf16 v[212:215], a[156:159], v[244:247], v[212:215]
  v_mfma_f32_16x16x32_bf16 v[212:215], a[172:175], v[248:251], v[212:215]
  v_mfma_f32_16x16x32_bf16 v[212:215], a[188:191], v[252:255], v[212:215]
  buffer_load_dwordx4 v12, s[44:47], s28 offen offset:3072 lds
  s_waitcnt lgkmcnt(0)
  v_mfma_f32_16x16x32_bf16 v[168:171], a[128:131], v[224:227], v[168:171]
  ds_read_b64_tr_b16 v[240:241], v4 offset:0
  s_add_u32 m0, s20, 8064
  v_mfma_f32_16x16x32_bf16 v[168:171], a[144:147], v[228:231], v[168:171]
  ds_read_b64_tr_b16 v[242:243], v4 offset:512
  s_add_u32 s28, s25, s76
  v_mfma_f32_16x16x32_bf16 v[168:171], a[160:163], v[232:235], v[168:171]
  ds_read_b64_tr_b16 v[244:245], v4 offset:4096
  v_mfma_f32_16x16x32_bf16 v[168:171], a[176:179], v[236:239], v[168:171]
  buffer_load_dwordx4 v9, s[44:47], s28 offen offset:128 lds
  v_mfma_f32_16x16x32_bf16 v[184:187], a[132:135], v[224:227], v[184:187]
  ds_read_b64_tr_b16 v[246:247], v4 offset:4608
  v_mfma_f32_16x16x32_bf16 v[184:187], a[148:151], v[228:231], v[184:187]
  ds_read_b64_tr_b16 v[248:249], v4 offset:8192
  v_mfma_f32_16x16x32_bf16 v[184:187], a[164:167], v[232:235], v[184:187]
  ds_read_b64_tr_b16 v[250:251], v4 offset:8704
  v_mfma_f32_16x16x32_bf16 v[184:187], a[180:183], v[236:239], v[184:187]
  buffer_load_dwordx4 v10, s[44:47], s28 offen offset:1152 lds
  v_mfma_f32_16x16x32_bf16 v[200:203], a[136:139], v[224:227], v[200:203]
  ds_read_b64_tr_b16 v[252:253], v4 offset:12288
  v_mfma_f32_16x16x32_bf16 v[200:203], a[152:155], v[228:231], v[200:203]
  ds_read_b64_tr_b16 v[254:255], v4 offset:12800
  v_mfma_f32_16x16x32_bf16 v[200:203], a[168:171], v[232:235], v[200:203]
  v_mfma_f32_16x16x32_bf16 v[200:203], a[184:187], v[236:239], v[200:203]
  buffer_load_dwordx4 v11, s[44:47], s28 offen offset:2176 lds
  v_mfma_f32_16x16x32_bf16 v[216:219], a[140:143], v[224:227], v[216:219]
  v_mfma_f32_16x16x32_bf16 v[216:219], a[156:159], v[228:231], v[216:219]
  v_mfma_f32_16x16x32_bf16 v[216:219], a[172:175], v[232:235], v[216:219]
  v_mfma_f32_16x16x32_bf16 v[216:219], a[188:191], v[236:239], v[216:219]
  buffer_load_dwordx4 v12, s[44:47], s28 offen offset:3200 lds
  s_waitcnt vmcnt(29) lgkmcnt(0)
  s_barrier
  v_mfma_f32_16x16x32_bf16 v[172:175], a[128:131], v[240:243], v[172:175]
  ds_read_b64_tr_b16 v[224:225], v1 offset:16384
  s_add_u32 m0, s19, 0
  v_mfma_f32_16x16x32_bf16 v[172:175], a[144:147], v[244:247], v[172:175]
  ds_read_b64_tr_b16 v[226:227], v1 offset:16896
  s_add_u32 s21, s22, 384
  v_mfma_f32_16x16x32_bf16 v[172:175], a[160:163], v[248:251], v[172:175]
  ds_read_b64_tr_b16 v[228:229], v1 offset:20480
  v_mfma_f32_16x16x32_bf16 v[172:175], a[176:179], v[252:255], v[172:175]
  buffer_load_dwordx4 v5, s[12:15], s21 offen offset:0 lds
  v_mfma_f32_16x16x32_bf16 v[188:191], a[132:135], v[240:243], v[188:191]
  ds_read_b64_tr_b16 v[230:231], v1 offset:20992
  v_mfma_f32_16x16x32_bf16 v[188:191], a[148:151], v[244:247], v[188:191]
  ds_read_b64_tr_b16 v[232:233], v1 offset:24576
  v_mfma_f32_16x16x32_bf16 v[188:191], a[164:167], v[248:251], v[188:191]
  ds_read_b64_tr_b16 v[234:235], v1 offset:25088
  v_mfma_f32_16x16x32_bf16 v[188:191], a[180:183], v[252:255], v[188:191]
  buffer_load_dwordx4 v6, s[12:15], s21 offen offset:1024 lds
  v_mfma_f32_16x16x32_bf16 v[204:207], a[136:139], v[240:243], v[204:207]
  ds_read_b64_tr_b16 v[236:237], v1 offset:28672
  v_mfma_f32_16x16x32_bf16 v[204:207], a[152:155], v[244:247], v[204:207]
  ds_read_b64_tr_b16 v[238:239], v1 offset:29184
  v_mfma_f32_16x16x32_bf16 v[204:207], a[168:171], v[248:251], v[204:207]
  v_mfma_f32_16x16x32_bf16 v[204:207], a[184:187], v[252:255], v[204:207]
  buffer_load_dwordx4 v7, s[12:15], s21 offen offset:2048 lds
  v_mfma_f32_16x16x32_bf16 v[220:223], a[140:143], v[240:243], v[220:223]
  v_mfma_f32_16x16x32_bf16 v[220:223], a[156:159], v[244:247], v[220:223]
  v_mfma_f32_16x16x32_bf16 v[220:223], a[172:175], v[248:251], v[220:223]
  v_mfma_f32_16x16x32_bf16 v[220:223], a[188:191], v[252:255], v[220:223]
  buffer_load_dwordx4 v8, s[12:15], s21 offen offset:3072 lds
  s_waitcnt lgkmcnt(0)
  v_mfma_f32_16x16x32_bf16 v[32:35], a[192:195], v[224:227], v[32:35]
  ds_read_b64_tr_b16 v[240:241], v2 offset:16384
  s_add_u32 m0, s20, 12160
  v_mfma_f32_16x16x32_bf16 v[32:35], a[208:211], v[228:231], v[32:35]
  ds_read_b64_tr_b16 v[242:243], v2 offset:16896
  s_add_u32 s28, s26, s76
  v_mfma_f32_16x16x32_bf16 v[32:35], a[224:227], v[232:235], v[32:35]
  ds_read_b64_tr_b16 v[244:245], v2 offset:20480
  v_mfma_f32_16x16x32_bf16 v[32:35], a[240:243], v[236:239], v[32:35]
  buffer_load_dwordx4 v9, s[44:47], s28 offen offset:128 lds
  v_mfma_f32_16x16x32_bf16 v[48:51], a[196:199], v[224:227], v[48:51]
  ds_read_b64_tr_b16 v[246:247], v2 offset:20992
  v_mfma_f32_16x16x32_bf16 v[48:51], a[212:215], v[228:231], v[48:51]
  ds_read_b64_tr_b16 v[248:249], v2 offset:24576
  v_mfma_f32_16x16x32_bf16 v[48:51], a[228:231], v[232:235], v[48:51]
  ds_read_b64_tr_b16 v[250:251], v2 offset:25088
  v_mfma_f32_16x16x32_bf16 v[48:51], a[244:247], v[236:239], v[48:51]
  buffer_load_dwordx4 v10, s[44:47], s28 offen offset:1152 lds
  v_mfma_f32_16x16x32_bf16 v[64:67], a[200:203], v[224:227], v[64:67]
  ds_read_b64_tr_b16 v[252:253], v2 offset:28672
  v_mfma_f32_16x16x32_bf16 v[64:67], a[216:219], v[228:231], v[64:67]
  ds_read_b64_tr_b16 v[254:255], v2 offset:29184
  v_mfma_f32_16x16x32_bf16 v[64:67], a[232:235], v[232:235], v[64:67]
  v_mfma_f32_16x16x32_bf16 v[64:67], a[248:251], v[236:239], v[64:67]
  buffer_load_dwordx4 v11, s[44:47], s28 offen offset:2176 lds
  v_mfma_f32_16x16x32_bf16 v[80:83], a[204:207], v[224:227], v[80:83]
  v_mfma_f32_16x16x32_bf16 v[80:83], a[220:223], v[228:231], v[80:83]
  v_mfma_f32_16x16x32_bf16 v[80:83], a[236:239], v[232:235], v[80:83]
  v_mfma_f32_16x16x32_bf16 v[80:83], a[252:255], v[236:239], v[80:83]
  buffer_load_dwordx4 v12, s[44:47], s28 offen offset:3200 lds
  s_waitcnt lgkmcnt(0)
  v_mfma_f32_16x16x32_bf16 v[36:39], a[192:195], v[240:243], v[36:39]
  ds_read_b64_tr_b16 v[224:225], v3 offset:16384
  s_add_u32 m0, s20, 16384
  v_mfma_f32_16x16x32_bf16 v[36:39], a[208:211], v[244:247], v[36:39]
  ds_read_b64_tr_b16 v[226:227], v3 offset:16896
  s_add_u32 s28, s25, s77
  v_mfma_f32_16x16x32_bf16 v[36:39], a[224:227], v[248:251], v[36:39]
  ds_read_b64_tr_b16 v[228:229], v3 offset:20480
  v_mfma_f32_16x16x32_bf16 v[36:39], a[240:243], v[252:255], v[36:39]
  buffer_load_dwordx4 v9, s[44:47], s28 offen offset:0 lds
  v_mfma_f32_16x16x32_bf16 v[52:55], a[196:199], v[240:243], v[52:55]
  ds_read_b64_tr_b16 v[230:231], v3 offset:20992
  v_mfma_f32_16x16x32_bf16 v[52:55], a[212:215], v[244:247], v[52:55]
  ds_read_b64_tr_b16 v[232:233], v3 offset:24576
  v_mfma_f32_16x16x32_bf16 v[52:55], a[228:231], v[248:251], v[52:55]
  ds_read_b64_tr_b16 v[234:235], v3 offset:25088
  v_mfma_f32_16x16x32_bf16 v[52:55], a[244:247], v[252:255], v[52:55]
  buffer_load_dwordx4 v10, s[44:47], s28 offen offset:1024 lds
  v_mfma_f32_16x16x32_bf16 v[68:71], a[200:203], v[240:243], v[68:71]
  ds_read_b64_tr_b16 v[236:237], v3 offset:28672
  v_mfma_f32_16x16x32_bf16 v[68:71], a[216:219], v[244:247], v[68:71]
  ds_read_b64_tr_b16 v[238:239], v3 offset:29184
  v_mfma_f32_16x16x32_bf16 v[68:71], a[232:235], v[248:251], v[68:71]
  v_mfma_f32_16x16x32_bf16 v[68:71], a[248:251], v[252:255], v[68:71]
  buffer_load_dwordx4 v11, s[44:47], s28 offen offset:2048 lds
  v_mfma_f32_16x16x32_bf16 v[84:87], a[204:207], v[240:243], v[84:87]
  v_mfma_f32_16x16x32_bf16 v[84:87], a[220:223], v[244:247], v[84:87]
  v_mfma_f32_16x16x32_bf16 v[84:87], a[236:239], v[248:251], v[84:87]
  v_mfma_f32_16x16x32_bf16 v[84:87], a[252:255], v[252:255], v[84:87]
  buffer_load_dwordx4 v12, s[44:47], s28 offen offset:3072 lds
  s_waitcnt lgkmcnt(0)
  v_mfma_f32_16x16x32_bf16 v[40:43], a[192:195], v[224:227], v[40:43]
  ds_read_b64_tr_b16 v[240:241], v4 offset:16384
  s_add_u32 m0, s20, 20480
  v_mfma_f32_16x16x32_bf16 v[40:43], a[208:211], v[228:231], v[40:43]
  ds_read_b64_tr_b16 v[242:243], v4 offset:16896
  s_add_u32 s28, s26, s77
  v_mfma_f32_16x16x32_bf16 v[40:43], a[224:227], v[232:235], v[40:43]
  ds_read_b64_tr_b16 v[244:245], v4 offset:20480
  v_mfma_f32_16x16x32_bf16 v[40:43], a[240:243], v[236:239], v[40:43]
  buffer_load_dwordx4 v9, s[44:47], s28 offen offset:0 lds
  v_mfma_f32_16x16x32_bf16 v[56:59], a[196:199], v[224:227], v[56:59]
  ds_read_b64_tr_b16 v[246:247], v4 offset:20992
  v_mfma_f32_16x16x32_bf16 v[56:59], a[212:215], v[228:231], v[56:59]
  ds_read_b64_tr_b16 v[248:249], v4 offset:24576
  v_mfma_f32_16x16x32_bf16 v[56:59], a[228:231], v[232:235], v[56:59]
  ds_read_b64_tr_b16 v[250:251], v4 offset:25088
  v_mfma_f32_16x16x32_bf16 v[56:59], a[244:247], v[236:239], v[56:59]
  buffer_load_dwordx4 v10, s[44:47], s28 offen offset:1024 lds
  v_mfma_f32_16x16x32_bf16 v[72:75], a[200:203], v[224:227], v[72:75]
  ds_read_b64_tr_b16 v[252:253], v4 offset:28672
  v_mfma_f32_16x16x32_bf16 v[72:75], a[216:219], v[228:231], v[72:75]
  ds_read_b64_tr_b16 v[254:255], v4 offset:29184
  v_mfma_f32_16x16x32_bf16 v[72:75], a[232:235], v[232:235], v[72:75]
  v_mfma_f32_16x16x32_bf16 v[72:75], a[248:251], v[236:239], v[72:75]
  buffer_load_dwordx4 v11, s[44:47], s28 offen offset:2048 lds
  v_mfma_f32_16x16x32_bf16 v[88:91], a[204:207], v[224:227], v[88:91]
  v_mfma_f32_16x16x32_bf16 v[88:91], a[220:223], v[228:231], v[88:91]
  v_mfma_f32_16x16x32_bf16 v[88:91], a[236:239], v[232:235], v[88:91]
  v_mfma_f32_16x16x32_bf16 v[88:91], a[252:255], v[236:239], v[88:91]
  buffer_load_dwordx4 v12, s[44:47], s28 offen offset:3072 lds
  s_waitcnt vmcnt(32) lgkmcnt(0)
  s_barrier
  v_mfma_f32_16x16x32_bf16 v[44:47], a[192:195], v[240:243], v[44:47]
  ds_read_b64_tr_b16 v[224:225], v1 offset:32768
  s_add_u32 m0, s19, 16384
  v_mfma_f32_16x16x32_bf16 v[44:47], a[208:211], v[244:247], v[44:47]
  ds_read_b64_tr_b16 v[226:227], v1 offset:33280
  s_add_u32 s21, s23, 384
  v_mfma_f32_16x16x32_bf16 v[44:47], a[224:227], v[248:251], v[44:47]
  ds_read_b64_tr_b16 v[228:229], v1 offset:36864
  v_mfma_f32_16x16x32_bf16 v[44:47], a[240:243], v[252:255], v[44:47]
  buffer_load_dwordx4 v5, s[12:15], s21 offen offset:0 lds
  v_mfma_f32_16x16x32_bf16 v[60:63], a[196:199], v[240:243], v[60:63]
  ds_read_b64_tr_b16 v[230:231], v1 offset:37376
  v_mfma_f32_16x16x32_bf16 v[60:63], a[212:215], v[244:247], v[60:63]
  ds_read_b64_tr_b16 v[232:233], v1 offset:40960
  v_mfma_f32_16x16x32_bf16 v[60:63], a[228:231], v[248:251], v[60:63]
  ds_read_b64_tr_b16 v[234:235], v1 offset:41472
  v_mfma_f32_16x16x32_bf16 v[60:63], a[244:247], v[252:255], v[60:63]
  buffer_load_dwordx4 v6, s[12:15], s21 offen offset:1024 lds
  v_mfma_f32_16x16x32_bf16 v[76:79], a[200:203], v[240:243], v[76:79]
  ds_read_b64_tr_b16 v[236:237], v1 offset:45056
  v_mfma_f32_16x16x32_bf16 v[76:79], a[216:219], v[244:247], v[76:79]
  ds_read_b64_tr_b16 v[238:239], v1 offset:45568
  v_mfma_f32_16x16x32_bf16 v[76:79], a[232:235], v[248:251], v[76:79]
  v_mfma_f32_16x16x32_bf16 v[76:79], a[248:251], v[252:255], v[76:79]
  buffer_load_dwordx4 v7, s[12:15], s21 offen offset:2048 lds
  v_mfma_f32_16x16x32_bf16 v[92:95], a[204:207], v[240:243], v[92:95]
  v_mfma_f32_16x16x32_bf16 v[92:95], a[220:223], v[244:247], v[92:95]
  v_mfma_f32_16x16x32_bf16 v[92:95], a[236:239], v[248:251], v[92:95]
  v_mfma_f32_16x16x32_bf16 v[92:95], a[252:255], v[252:255], v[92:95]
  buffer_load_dwordx4 v8, s[12:15], s21 offen offset:3072 lds
  s_waitcnt lgkmcnt(0)
  v_mfma_f32_16x16x32_bf16 v[96:99], a[192:195], v[224:227], v[96:99]
  ds_read_b64_tr_b16 v[240:241], v2 offset:32768
  v_mfma_f32_16x16x32_bf16 v[96:99], a[208:211], v[228:231], v[96:99]
  ds_read_b64_tr_b16 v[242:243], v2 offset:33280
  v_mfma_f32_16x16x32_bf16 v[96:99], a[224:227], v[232:235], v[96:99]
  ds_read_b64_tr_b16 v[244:245], v2 offset:36864
  v_mfma_f32_16x16x32_bf16 v[96:99], a[240:243], v[236:239], v[96:99]
  s_lshr_b32 s29, s27, 1
  v_mfma_f32_16x16x32_bf16 v[112:115], a[196:199], v[224:227], v[112:115]
  ds_read_b64_tr_b16 v[246:247], v2 offset:37376
  s_mul_i32 s32, s29, s70
  v_mfma_f32_16x16x32_bf16 v[112:115], a[212:215], v[228:231], v[112:115]
  ds_read_b64_tr_b16 v[248:249], v2 offset:40960
  v_mfma_f32_16x16x32_bf16 v[112:115], a[228:231], v[232:235], v[112:115]
  ds_read_b64_tr_b16 v[250:251], v2 offset:41472
  s_and_b32 s29, s27, 1
  v_mfma_f32_16x16x32_bf16 v[112:115], a[244:247], v[236:239], v[112:115]
  s_mul_i32 s29, s29, s71
  v_mfma_f32_16x16x32_bf16 v[128:131], a[200:203], v[224:227], v[128:131]
  ds_read_b64_tr_b16 v[252:253], v2 offset:45056
  v_mfma_f32_16x16x32_bf16 v[128:131], a[216:219], v[228:231], v[128:131]
  ds_read_b64_tr_b16 v[254:255], v2 offset:45568
  s_add_u32 s32, s32, s29
  v_mfma_f32_16x16x32_bf16 v[128:131], a[232:235], v[232:235], v[128:131]
  s_add_u32 s32, s32, s36
  v_mfma_f32_16x16x32_bf16 v[128:131], a[248:251], v[236:239], v[128:131]
  v_mfma_f32_16x16x32_bf16 v[144:147], a[204:207], v[224:227], v[144:147]
  s_add_u32 s27, s27, 1
  v_mfma_f32_16x16x32_bf16 v[144:147], a[220:223], v[228:231], v[144:147]
  s_add_u32 s33, s32, s67
  v_mfma_f32_16x16x32_bf16 v[144:147], a[236:239], v[232:235], v[144:147]
  v_mfma_f32_16x16x32_bf16 v[144:147], a[252:255], v[236:239], v[144:147]
  s_add_u32 s34, s32, s66
  s_waitcnt lgkmcnt(0)
  v_mfma_f32_16x16x32_bf16 v[100:103], a[192:195], v[240:243], v[100:103]
  ds_read_b64_tr_b16 v[224:225], v3 offset:32768
  v_mfma_f32_16x16x32_bf16 v[100:103], a[208:211], v[244:247], v[100:103]
  ds_read_b64_tr_b16 v[226:227], v3 offset:33280
  s_add_u32 s35, s34, s67
  v_mfma_f32_16x16x32_bf16 v[100:103], a[224:227], v[248:251], v[100:103]
  ds_read_b64_tr_b16 v[228:229], v3 offset:36864
  v_cvt_pk_bf16_f32 v32, v32, v33
  v_mfma_f32_16x16x32_bf16 v[100:103], a[240:243], v[252:255], v[100:103]
  v_mfma_f32_16x16x32_bf16 v[116:119], a[196:199], v[240:243], v[116:119]
  ds_read_b64_tr_b16 v[230:231], v3 offset:37376
  v_cvt_pk_bf16_f32 v33, v34, v35
  v_mfma_f32_16x16x32_bf16 v[116:119], a[212:215], v[244:247], v[116:119]
  ds_read_b64_tr_b16 v[232:233], v3 offset:40960
  v_cvt_pk_bf16_f32 v34, v48, v49
  v_mfma_f32_16x16x32_bf16 v[116:119], a[228:231], v[248:251], v[116:119]
  ds_read_b64_tr_b16 v[234:235], v3 offset:41472
  v_mfma_f32_16x16x32_bf16 v[116:119], a[244:247], v[252:255], v[116:119]
  v_cvt_pk_bf16_f32 v35, v50, v51
  v_mfma_f32_16x16x32_bf16 v[132:135], a[200:203], v[240:243], v[132:135]
  ds_read_b64_tr_b16 v[236:237], v3 offset:45056
  v_cvt_pk_bf16_f32 v36, v36, v37
  v_mfma_f32_16x16x32_bf16 v[132:135], a[216:219], v[244:247], v[132:135]
  ds_read_b64_tr_b16 v[238:239], v3 offset:45568
  v_mfma_f32_16x16x32_bf16 v[132:135], a[232:235], v[248:251], v[132:135]
  v_cvt_pk_bf16_f32 v37, v38, v39
  v_mfma_f32_16x16x32_bf16 v[132:135], a[248:251], v[252:255], v[132:135]
  v_permlane16_swap_b32 v32, v34
  v_mfma_f32_16x16x32_bf16 v[148:151], a[204:207], v[240:243], v[148:151]
  v_mfma_f32_16x16x32_bf16 v[148:151], a[220:223], v[244:247], v[148:151]
  v_permlane16_swap_b32 v33, v35
  v_mfma_f32_16x16x32_bf16 v[148:151], a[236:239], v[248:251], v[148:151]
  v_mfma_f32_16x16x32_bf16 v[148:151], a[252:255], v[252:255], v[148:151]
  v_cvt_pk_bf16_f32 v38, v52, v53
  s_waitcnt lgkmcnt(0)
  v_mfma_f32_16x16x32_bf16 v[104:107], a[192:195], v[224:227], v[104:107]
  ds_read_b64_tr_b16 v[240:241], v4 offset:32768
  v_cvt_pk_bf16_f32 v39, v54, v55
  v_mfma_f32_16x16x32_bf16 v[104:107], a[208:211], v[228:231], v[104:107]
  ds_read_b64_tr_b16 v[242:243], v4 offset:33280
  v_mfma_f32_16x16x32_bf16 v[104:107], a[224:227], v[232:235], v[104:107]
  ds_read_b64_tr_b16 v[244:245], v4 offset:36864
  v_mfma_f32_16x16x32_bf16 v[104:107], a[240:243], v[236:239], v[104:107]
  buffer_store_dwordx4 v[32:35], v17, s[48:51], s32 offen sc1
  s_add_u32 s32, s32, s65
  v_mfma_f32_16x16x32_bf16 v[120:123], a[196:199], v[224:227], v[120:123]
  ds_read_b64_tr_b16 v[246:247], v4 offset:37376
  v_mfma_f32_16x16x32_bf16 v[120:123], a[212:215], v[228:231], v[120:123]
  ds_read_b64_tr_b16 v[248:249], v4 offset:40960
  v_cvt_pk_bf16_f32 v40, v40, v41
  v_mfma_f32_16x16x32_bf16 v[120:123], a[228:231], v[232:235], v[120:123]
  ds_read_b64_tr_b16 v[250:251], v4 offset:41472
  v_cvt_pk_bf16_f32 v41, v42, v43
  v_mfma_f32_16x16x32_bf16 v[120:123], a[244:247], v[236:239], v[120:123]
  v_mfma_f32_16x16x32_bf16 v[136:139], a[200:203], v[224:227], v[136:139]
  ds_read_b64_tr_b16 v[252:253], v4 offset:45056
  v_mfma_f32_16x16x32_bf16 v[136:139], a[216:219], v[228:231], v[136:139]
  ds_read_b64_tr_b16 v[254:255], v4 offset:45568
  v_mfma_f32_16x16x32_bf16 v[136:139], a[232:235], v[232:235], v[136:139]
  v_permlane16_swap_b32 v36, v38
  v_mfma_f32_16x16x32_bf16 v[136:139], a[248:251], v[236:239], v[136:139]
  v_permlane16_swap_b32 v37, v39
  v_mfma_f32_16x16x32_bf16 v[152:155], a[204:207], v[224:227], v[152:155]
  v_cvt_pk_bf16_f32 v42, v56, v57
  v_mfma_f32_16x16x32_bf16 v[152:155], a[220:223], v[228:231], v[152:155]
  v_cvt_pk_bf16_f32 v43, v58, v59
  v_mfma_f32_16x16x32_bf16 v[152:155], a[236:239], v[232:235], v[152:155]
  buffer_store_dwordx4 v[36:39], v17, s[48:51], s33 offen sc1
  v_mfma_f32_16x16x32_bf16 v[152:155], a[252:255], v[236:239], v[152:155]
  s_waitcnt vmcnt(34) lgkmcnt(0)
  s_barrier
  v_mfma_f32_16x16x32_bf16 v[108:111], a[192:195], v[240:243], v[108:111]
  ds_read_b64_tr_b16 v[224:225], v1 offset:49152
  s_add_u32 m0, s19, 32768
  v_mfma_f32_16x16x32_bf16 v[108:111], a[208:211], v[244:247], v[108:111]
  ds_read_b64_tr_b16 v[226:227], v1 offset:49664
  s_add_u32 s21, s24, 384
  v_mfma_f32_16x16x32_bf16 v[108:111], a[224:227], v[248:251], v[108:111]
  ds_read_b64_tr_b16 v[228:229], v1 offset:53248
  s_add_u32 s33, s33, s65
  v_mfma_f32_16x16x32_bf16 v[108:111], a[240:243], v[252:255], v[108:111]
  buffer_load_dwordx4 v5, s[12:15], s21 offen offset:0 lds
  v_cvt_pk_bf16_f32 v44, v44, v45
  v_mfma_f32_16x16x32_bf16 v[124:127], a[196:199], v[240:243], v[124:127]
  ds_read_b64_tr_b16 v[230:231], v1 offset:53760
  v_cvt_pk_bf16_f32 v45, v46, v47
  v_mfma_f32_16x16x32_bf16 v[124:127], a[212:215], v[244:247], v[124:127]
  ds_read_b64_tr_b16 v[232:233], v1 offset:57344
  v_mfma_f32_16x16x32_bf16 v[124:127], a[228:231], v[248:251], v[124:127]
  ds_read_b64_tr_b16 v[234:235], v1 offset:57856
  v_mfma_f32_16x16x32_bf16 v[124:127], a[244:247], v[252:255], v[124:127]
  buffer_load_dwordx4 v6, s[12:15], s21 offen offset:1024 lds
  v_mfma_f32_16x16x32_bf16 v[140:143], a[200:203], v[240:243], v[140:143]
  ds_read_b64_tr_b16 v[236:237], v1 offset:61440
  v_mfma_f32_16x16x32_bf16 v[140:143], a[216:219], v[244:247], v[140:143]
  ds_read_b64_tr_b16 v[238:239], v1 offset:61952
  v_mfma_f32_16x16x32_bf16 v[140:143], a[232:235], v[248:251], v[140:143]
  v_permlane16_swap_b32 v40, v42
  v_mfma_f32_16x16x32_bf16 v[140:143], a[248:251], v[252:255], v[140:143]
  buffer_load_dwordx4 v7, s[12:15], s21 offen offset:2048 lds
  v_mfma_f32_16x16x32_bf16 v[156:159], a[204:207], v[240:243], v[156:159]
  v_permlane16_swap_b32 v41, v43
  v_mfma_f32_16x16x32_bf16 v[156:159], a[220:223], v[244:247], v[156:159]
  v_cvt_pk_bf16_f32 v46, v60, v61
  v_cvt_pk_bf16_f32 v47, v62, v63
  v_mfma_f32_16x16x32_bf16 v[156:159], a[236:239], v[248:251], v[156:159]
  buffer_store_dwordx4 v[40:43], v17, s[48:51], s34 offen sc1
  s_add_u32 s34, s34, s65
  v_mfma_f32_16x16x32_bf16 v[156:159], a[252:255], v[252:255], v[156:159]
  buffer_load_dwordx4 v8, s[12:15], s21 offen offset:3072 lds
  s_waitcnt lgkmcnt(0)
  v_mfma_f32_16x16x32_bf16 v[160:163], a[192:195], v[224:227], v[160:163]
  ds_read_b64_tr_b16 v[240:241], v2 offset:49152
  v_cvt_pk_bf16_f32 v64, v64, v65
  v_mfma_f32_16x16x32_bf16 v[160:163], a[208:211], v[228:231], v[160:163]
  ds_read_b64_tr_b16 v[242:243], v2 offset:49664
  v_cvt_pk_bf16_f32 v65, v66, v67
  v_mfma_f32_16x16x32_bf16 v[160:163], a[224:227], v[232:235], v[160:163]
  ds_read_b64_tr_b16 v[244:245], v2 offset:53248
  v_mfma_f32_16x16x32_bf16 v[160:163], a[240:243], v[236:239], v[160:163]
  v_permlane16_swap_b32 v44, v46
  v_mfma_f32_16x16x32_bf16 v[176:179], a[196:199], v[224:227], v[176:179]
  ds_read_b64_tr_b16 v[246:247], v2 offset:53760
  v_mfma_f32_16x16x32_bf16 v[176:179], a[212:215], v[228:231], v[176:179]
  ds_read_b64_tr_b16 v[248:249], v2 offset:57344
  v_mfma_f32_16x16x32_bf16 v[176:179], a[228:231], v[232:235], v[176:179]
  ds_read_b64_tr_b16 v[250:251], v2 offset:57856
  v_mfma_f32_16x16x32_bf16 v[176:179], a[244:247], v[236:239], v[176:179]
  v_permlane16_swap_b32 v45, v47
  v_mfma_f32_16x16x32_bf16 v[192:195], a[200:203], v[224:227], v[192:195]
  ds_read_b64_tr_b16 v[252:253], v2 offset:61440
  v_cvt_pk_bf16_f32 v66, v80, v81
  v_mfma_f32_16x16x32_bf16 v[192:195], a[216:219], v[228:231], v[192:195]
  ds_read_b64_tr_b16 v[254:255], v2 offset:61952
  v_cvt_pk_bf16_f32 v67, v82, v83
  v_mfma_f32_16x16x32_bf16 v[192:195], a[232:235], v[232:235], v[192:195]
  buffer_store_dwordx4 v[44:47], v17, s[48:51], s35 offen sc1
  s_add_u32 s35, s35, s65
  v_mfma_f32_16x16x32_bf16 v[192:195], a[248:251], v[236:239], v[192:195]
  v_cvt_pk_bf16_f32 v68, v68, v69
  v_mfma_f32_16x16x32_bf16 v[208:211], a[204:207], v[224:227], v[208:211]
  v_cvt_pk_bf16_f32 v69, v70, v71
  v_mfma_f32_16x16x32_bf16 v[208:211], a[220:223], v[228:231], v[208:211]
  v_permlane16_swap_b32 v64, v66
  v_mfma_f32_16x16x32_bf16 v[208:211], a[236:239], v[232:235], v[208:211]
  v_mfma_f32_16x16x32_bf16 v[208:211], a[252:255], v[236:239], v[208:211]
  s_waitcnt lgkmcnt(0)
  v_mfma_f32_16x16x32_bf16 v[164:167], a[192:195], v[240:243], v[164:167]
  ds_read_b64_tr_b16 v[224:225], v3 offset:49152
  v_mfma_f32_16x16x32_bf16 v[164:167], a[208:211], v[244:247], v[164:167]
  ds_read_b64_tr_b16 v[226:227], v3 offset:49664
  v_mfma_f32_16x16x32_bf16 v[164:167], a[224:227], v[248:251], v[164:167]
  ds_read_b64_tr_b16 v[228:229], v3 offset:53248
  v_mfma_f32_16x16x32_bf16 v[164:167], a[240:243], v[252:255], v[164:167]
  v_permlane16_swap_b32 v65, v67
  v_mfma_f32_16x16x32_bf16 v[180:183], a[196:199], v[240:243], v[180:183]
  ds_read_b64_tr_b16 v[230:231], v3 offset:53760
  v_cvt_pk_bf16_f32 v70, v84, v85
  v_mfma_f32_16x16x32_bf16 v[180:183], a[212:215], v[244:247], v[180:183]
  ds_read_b64_tr_b16 v[232:233], v3 offset:57344
  v_cvt_pk_bf16_f32 v71, v86, v87
  v_mfma_f32_16x16x32_bf16 v[180:183], a[228:231], v[248:251], v[180:183]
  ds_read_b64_tr_b16 v[234:235], v3 offset:57856
  v_mfma_f32_16x16x32_bf16 v[180:183], a[244:247], v[252:255], v[180:183]
  buffer_store_dwordx4 v[64:67], v17, s[48:51], s32 offen sc1
  v_cvt_pk_bf16_f32 v72, v72, v73
  v_mfma_f32_16x16x32_bf16 v[196:199], a[200:203], v[240:243], v[196:199]
  ds_read_b64_tr_b16 v[236:237], v3 offset:61440
  v_cvt_pk_bf16_f32 v73, v74, v75
  v_mfma_f32_16x16x32_bf16 v[196:199], a[216:219], v[244:247], v[196:199]
  ds_read_b64_tr_b16 v[238:239], v3 offset:61952
  v_mfma_f32_16x16x32_bf16 v[196:199], a[232:235], v[248:251], v[196:199]
  v_permlane16_swap_b32 v68, v70
  v_mfma_f32_16x16x32_bf16 v[196:199], a[248:251], v[252:255], v[196:199]
  v_permlane16_swap_b32 v69, v71
  v_mfma_f32_16x16x32_bf16 v[212:215], a[204:207], v[240:243], v[212:215]
  v_cvt_pk_bf16_f32 v74, v88, v89
  v_mfma_f32_16x16x32_bf16 v[212:215], a[220:223], v[244:247], v[212:215]
  v_cvt_pk_bf16_f32 v75, v90, v91
  v_mfma_f32_16x16x32_bf16 v[212:215], a[236:239], v[248:251], v[212:215]
  buffer_store_dwordx4 v[68:71], v17, s[48:51], s33 offen sc1
  v_mfma_f32_16x16x32_bf16 v[212:215], a[252:255], v[252:255], v[212:215]
  s_waitcnt lgkmcnt(0)
  v_mfma_f32_16x16x32_bf16 v[168:171], a[192:195], v[224:227], v[168:171]
  ds_read_b64_tr_b16 v[240:241], v4 offset:49152
  v_cvt_pk_bf16_f32 v76, v76, v77
  v_mfma_f32_16x16x32_bf16 v[168:171], a[208:211], v[228:231], v[168:171]
  ds_read_b64_tr_b16 v[242:243], v4 offset:49664
  v_mfma_f32_16x16x32_bf16 v[168:171], a[224:227], v[232:235], v[168:171]
  ds_read_b64_tr_b16 v[244:245], v4 offset:53248
  v_cvt_pk_bf16_f32 v77, v78, v79
  v_mfma_f32_16x16x32_bf16 v[168:171], a[240:243], v[236:239], v[168:171]
  v_permlane16_swap_b32 v72, v74
  v_mfma_f32_16x16x32_bf16 v[184:187], a[196:199], v[224:227], v[184:187]
  ds_read_b64_tr_b16 v[246:247], v4 offset:53760
  v_mfma_f32_16x16x32_bf16 v[184:187], a[212:215], v[228:231], v[184:187]
  ds_read_b64_tr_b16 v[248:249], v4 offset:57344
  v_mfma_f32_16x16x32_bf16 v[184:187], a[228:231], v[232:235], v[184:187]
  ds_read_b64_tr_b16 v[250:251], v4 offset:57856
  v_mfma_f32_16x16x32_bf16 v[184:187], a[244:247], v[236:239], v[184:187]
  v_permlane16_swap_b32 v73, v75
  v_mfma_f32_16x16x32_bf16 v[200:203], a[200:203], v[224:227], v[200:203]
  ds_read_b64_tr_b16 v[252:253], v4 offset:61440
  v_cvt_pk_bf16_f32 v78, v92, v93
  v_mfma_f32_16x16x32_bf16 v[200:203], a[216:219], v[228:231], v[200:203]
  ds_read_b64_tr_b16 v[254:255], v4 offset:61952
  v_cvt_pk_bf16_f32 v79, v94, v95
  v_mfma_f32_16x16x32_bf16 v[200:203], a[232:235], v[232:235], v[200:203]
  buffer_store_dwordx4 v[72:75], v17, s[48:51], s34 offen sc1
  v_mfma_f32_16x16x32_bf16 v[200:203], a[248:251], v[236:239], v[200:203]
  s_nop 1
  v_mfma_f32_16x16x32_bf16 v[216:219], a[204:207], v[224:227], v[216:219]
  v_mfma_f32_16x16x32_bf16 v[216:219], a[220:223], v[228:231], v[216:219]
  v_permlane16_swap_b32 v76, v78
  v_mfma_f32_16x16x32_bf16 v[216:219], a[236:239], v[232:235], v[216:219]
  v_permlane16_swap_b32 v77, v79
  v_mfma_f32_16x16x32_bf16 v[216:219], a[252:255], v[236:239], v[216:219]
  s_waitcnt vmcnt(27) lgkmcnt(0)
  s_barrier
  v_mfma_f32_16x16x32_bf16 v[172:175], a[192:195], v[240:243], v[172:175]
  ds_read_b64_tr_b16 v[224:225], v1 offset:0
  s_add_u32 m0, s19, 49152
  v_mfma_f32_16x16x32_bf16 v[172:175], a[208:211], v[244:247], v[172:175]
  ds_read_b64_tr_b16 v[226:227], v1 offset:512
  s_add_u32 s21, s38, 384
  v_mfma_f32_16x16x32_bf16 v[172:175], a[224:227], v[248:251], v[172:175]
  ds_read_b64_tr_b16 v[228:229], v1 offset:4096
  v_mfma_f32_16x16x32_bf16 v[172:175], a[240:243], v[252:255], v[172:175]
  buffer_load_dwordx4 v5, s[12:15], s21 offen offset:0 lds
  v_mfma_f32_16x16x32_bf16 v[188:191], a[196:199], v[240:243], v[188:191]
  ds_read_b64_tr_b16 v[230:231], v1 offset:4608
  v_mfma_f32_16x16x32_bf16 v[188:191], a[212:215], v[244:247], v[188:191]
  ds_read_b64_tr_b16 v[232:233], v1 offset:8192
  v_mfma_f32_16x16x32_bf16 v[188:191], a[228:231], v[248:251], v[188:191]
  ds_read_b64_tr_b16 v[234:235], v1 offset:8704
  v_mfma_f32_16x16x32_bf16 v[188:191], a[244:247], v[252:255], v[188:191]
  buffer_load_dwordx4 v6, s[12:15], s21 offen offset:1024 lds
  v_mfma_f32_16x16x32_bf16 v[204:207], a[200:203], v[240:243], v[204:207]
  ds_read_b64_tr_b16 v[236:237], v1 offset:12288
  v_mfma_f32_16x16x32_bf16 v[204:207], a[216:219], v[244:247], v[204:207]
  ds_read_b64_tr_b16 v[238:239], v1 offset:12800
  v_mfma_f32_16x16x32_bf16 v[204:207], a[232:235], v[248:251], v[204:207]
  buffer_store_dwordx4 v[76:79], v17, s[48:51], s35 offen sc1
  v_mfma_f32_16x16x32_bf16 v[204:207], a[248:251], v[252:255], v[204:207]
  buffer_load_dwordx4 v7, s[12:15], s21 offen offset:2048 lds
  v_mfma_f32_16x16x32_bf16 v[220:223], a[204:207], v[240:243], v[220:223]
  v_mfma_f32_16x16x32_bf16 v[220:223], a[220:223], v[244:247], v[220:223]
  v_mfma_f32_16x16x32_bf16 v[220:223], a[236:239], v[248:251], v[220:223]
  v_mfma_f32_16x16x32_bf16 v[220:223], a[252:255], v[252:255], v[220:223]
  buffer_load_dwordx4 v8, s[12:15], s21 offen offset:3072 lds
  s_bitcmp1_b32 s61, 0
  s_cbranch_scc1 P1_SK1
  s_waitcnt lgkmcnt(0)
  v_mfma_f32_16x16x32_bf16 v[32:35], a[0:3], v[224:227], 0
  ds_read_b64_tr_b16 v[240:241], v2 offset:0
  v_mfma_f32_16x16x32_bf16 v[32:35], a[16:19], v[228:231], v[32:35]
  ds_read_b64_tr_b16 v[242:243], v2 offset:512
  v_mfma_f32_16x16x32_bf16 v[32:35], a[32:35], v[232:235], v[32:35]
  ds_read_b64_tr_b16 v[244:245], v2 offset:4096
  v_mfma_f32_16x16x32_bf16 v[32:35], a[48:51], v[236:239], v[32:35]
  s_lshr_b32 s29, s27, 1
  v_mfma_f32_16x16x32_bf16 v[48:51], a[4:7], v[224:227], 0
  ds_read_b64_tr_b16 v[246:247], v2 offset:4608
  s_mul_i32 s32, s29, s70
  v_mfma_f32_16x16x32_bf16 v[48:51], a[20:23], v[228:231], v[48:51]
  ds_read_b64_tr_b16 v[248:249], v2 offset:8192
  v_mfma_f32_16x16x32_bf16 v[48:51], a[36:39], v[232:235], v[48:51]
  ds_read_b64_tr_b16 v[250:251], v2 offset:8704
  s_and_b32 s29, s27, 1
  v_mfma_f32_16x16x32_bf16 v[48:51], a[52:55], v[236:239], v[48:51]
  v_mfma_f32_16x16x32_bf16 v[64:67], a[8:11], v[224:227], 0
  ds_read_b64_tr_b16 v[252:253], v2 offset:12288
  s_mul_i32 s29, s29, s71
  v_mfma_f32_16x16x32_bf16 v[64:67], a[24:27], v[228:231], v[64:67]
  ds_read_b64_tr_b16 v[254:255], v2 offset:12800
  s_add_u32 s32, s32, s29
  v_mfma_f32_16x16x32_bf16 v[64:67], a[40:43], v[232:235], v[64:67]
  v_mfma_f32_16x16x32_bf16 v[64:67], a[56:59], v[236:239], v[64:67]
  s_add_u32 s32, s32, s36
  v_mfma_f32_16x16x32_bf16 v[80:83], a[12:15], v[224:227], 0
  v_mfma_f32_16x16x32_bf16 v[80:83], a[28:31], v[228:231], v[80:83]
  s_add_u32 s27, s27, 1
  v_mfma_f32_16x16x32_bf16 v[80:83], a[44:47], v[232:235], v[80:83]
  s_add_u32 s33, s32, s67
  v_mfma_f32_16x16x32_bf16 v[80:83], a[60:63], v[236:239], v[80:83]
  s_waitcnt lgkmcnt(0)
  v_mfma_f32_16x16x32_bf16 v[36:39], a[0:3], v[240:243], 0
  ds_read_b64_tr_b16 v[224:225], v3 offset:0
  s_add_u32 s34, s32, s66
  v_mfma_f32_16x16x32_bf16 v[36:39], a[16:19], v[244:247], v[36:39]
  ds_read_b64_tr_b16 v[226:227], v3 offset:512
  v_mfma_f32_16x16x32_bf16 v[36:39], a[32:35], v[248:251], v[36:39]
  ds_read_b64_tr_b16 v[228:229], v3 offset:4096
  s_add_u32 s35, s34, s67
  v_mfma_f32_16x16x32_bf16 v[36:39], a[48:51], v[252:255], v[36:39]
  v_mfma_f32_16x16x32_bf16 v[52:55], a[4:7], v[240:243], 0
  ds_read_b64_tr_b16 v[230:231], v3 offset:4608
  v_cvt_pk_bf16_f32 v96, v96, v97
  v_mfma_f32_16x16x32_bf16 v[52:55], a[20:23], v[244:247], v[52:55]
  ds_read_b64_tr_b16 v[232:233], v3 offset:8192
  v_cvt_pk_bf16_f32 v97, v98, v99
  v_mfma_f32_16x16x32_bf16 v[52:55], a[36:39], v[248:251], v[52:55]
  ds_read_b64_tr_b16 v[234:235], v3 offset:8704
  v_mfma_f32_16x16x32_bf16 v[52:55], a[52:55], v[252:255], v[52:55]
  v_cvt_pk_bf16_f32 v98, v112, v113
  v_mfma_f32_16x16x32_bf16 v[68:71], a[8:11], v[240:243], 0
  ds_read_b64_tr_b16 v[236:237], v3 offset:12288
  v_mfma_f32_16x16x32_bf16 v[68:71], a[24:27], v[244:247], v[68:71]
  ds_read_b64_tr_b16 v[238:239], v3 offset:12800
  v_cvt_pk_bf16_f32 v99, v114, v115
  v_mfma_f32_16x16x32_bf16 v[68:71], a[40:43], v[248:251], v[68:71]
  v_cvt_pk_bf16_f32 v100, v100, v101
  v_mfma_f32_16x16x32_bf16 v[68:71], a[56:59], v[252:255], v[68:71]
  v_mfma_f32_16x16x32_bf16 v[84:87], a[12:15], v[240:243], 0
  v_cvt_pk_bf16_f32 v101, v102, v103
  v_mfma_f32_16x16x32_bf16 v[84:87], a[28:31], v[244:247], v[84:87]
  v_mfma_f32_16x16x32_bf16 v[84:87], a[44:47], v[248:251], v[84:87]
  v_permlane16_swap_b32 v96, v98
  v_mfma_f32_16x16x32_bf16 v[84:87], a[60:63], v[252:255], v[84:87]
  s_waitcnt lgkmcnt(0)
  v_mfma_f32_16x16x32_bf16 v[40:43], a[0:3], v[224:227], 0
  ds_read_b64_tr_b16 v[240:241], v4 offset:0
  v_mfma_f32_16x16x32_bf16 v[40:43], a[16:19], v[228:231], v[40:43]
  ds_read_b64_tr_b16 v[242:243], v4 offset:512
  v_mfma_f32_16x16x32_bf16 v[40:43], a[32:35], v[232:235], v[40:43]
  ds_read_b64_tr_b16 v[244:245], v4 offset:4096
  v_mfma_f32_16x16x32_bf16 v[40:43], a[48:51], v[236:239], v[40:43]
  v_permlane16_swap_b32 v97, v99
  v_mfma_f32_16x16x32_bf16 v[56:59], a[4:7], v[224:227], 0
  ds_read_b64_tr_b16 v[246:247], v4 offset:4608
  v_cvt_pk_bf16_f32 v102, v116, v117
  v_mfma_f32_16x16x32_bf16 v[56:59], a[20:23], v[228:231], v[56:59]
  ds_read_b64_tr_b16 v[248:249], v4 offset:8192
  v_cvt_pk_bf16_f32 v103, v118, v119
  v_mfma_f32_16x16x32_bf16 v[56:59], a[36:39], v[232:235], v[56:59]
  ds_read_b64_tr_b16 v[250:251], v4 offset:8704
  v_mfma_f32_16x16x32_bf16 v[56:59], a[52:55], v[236:239], v[56:59]
  buffer_store_dwordx4 v[96:99], v17, s[48:51], s32 offen sc1
  s_add_u32 s32, s32, s65
  v_mfma_f32_16x16x32_bf16 v[72:75], a[8:11], v[224:227], 0
  ds_read_b64_tr_b16 v[252:253], v4 offset:12288
  v_cvt_pk_bf16_f32 v104, v104, v105
  v_mfma_f32_16x16x32_bf16 v[72:75], a[24:27], v[228:231], v[72:75]
  ds_read_b64_tr_b16 v[254:255], v4 offset:12800
  v_mfma_f32_16x16x32_bf16 v[72:75], a[40:43], v[232:235], v[72:75]
  v_cvt_pk_bf16_f32 v105, v106, v107
  v_mfma_f32_16x16x32_bf16 v[72:75], a[56:59], v[236:239], v[72:75]
  v_mfma_f32_16x16x32_bf16 v[88:91], a[12:15], v[224:227], 0
  v_permlane16_swap_b32 v100, v102
  v_mfma_f32_16x16x32_bf16 v[88:91], a[28:31], v[228:231], v[88:91]
  v_permlane16_swap_b32 v101, v103
  v_mfma_f32_16x16x32_bf16 v[88:91], a[44:47], v[232:235], v[88:91]
  v_mfma_f32_16x16x32_bf16 v[88:91], a[60:63], v[236:239], v[88:91]
  s_waitcnt vmcnt(17) lgkmcnt(0)
  s_barrier
  v_mfma_f32_16x16x32_bf16 v[44:47], a[0:3], v[240:243], 0
  ds_read_b64_tr_b16 v[224:225], v1 offset:16384
  s_add_u32 m0, s19, 0
  v_mfma_f32_16x16x32_bf16 v[44:47], a[16:19], v[244:247], v[44:47]
  ds_read_b64_tr_b16 v[226:227], v1 offset:16896
  s_add_u32 s21, s22, 512
  v_mfma_f32_16x16x32_bf16 v[44:47], a[32:35], v[248:251], v[44:47]
  ds_read_b64_tr_b16 v[228:229], v1 offset:20480
  v_cvt_pk_bf16_f32 v106, v120, v121
  v_mfma_f32_16x16x32_bf16 v[44:47], a[48:51], v[252:255], v[44:47]
  buffer_load_dwordx4 v5, s[12:15], s21 offen offset:0 lds
  v_cvt_pk_bf16_f32 v107, v122, v123
  v_mfma_f32_16x16x32_bf16 v[60:63], a[4:7], v[240:243], 0
  ds_read_b64_tr_b16 v[230:231], v1 offset:20992
  v_mfma_f32_16x16x32_bf16 v[60:63], a[20:23], v[244:247], v[60:63]
  ds_read_b64_tr_b16 v[232:233], v1 offset:24576
  v_mfma_f32_16x16x32_bf16 v[60:63], a[36:39], v[248:251], v[60:63]
  ds_read_b64_tr_b16 v[234:235], v1 offset:25088
  v_mfma_f32_16x16x32_bf16 v[60:63], a[52:55], v[252:255], v[60:63]
  buffer_load_dwordx4 v6, s[12:15], s21 offen offset:1024 lds
  v_mfma_f32_16x16x32_bf16 v[76:79], a[8:11], v[240:243], 0
  ds_read_b64_tr_b16 v[236:237], v1 offset:28672
  v_mfma_f32_16x16x32_bf16 v[76:79], a[24:27], v[244:247], v[76:79]
  ds_read_b64_tr_b16 v[238:239], v1 offset:29184
  v_mfma_f32_16x16x32_bf16 v[76:79], a[40:43], v[248:251], v[76:79]
  buffer_store_dwordx4 v[100:103], v17, s[48:51], s33 offen sc1
  s_add_u32 s33, s33, s65
  v_mfma_f32_16x16x32_bf16 v[76:79], a[56:59], v[252:255], v[76:79]
  buffer_load_dwordx4 v7, s[12:15], s21 offen offset:2048 lds
  v_cvt_pk_bf16_f32 v108, v108, v109
  v_mfma_f32_16x16x32_bf16 v[92:95], a[12:15], v[240:243], 0
  v_cvt_pk_bf16_f32 v109, v110, v111
  v_mfma_f32_16x16x32_bf16 v[92:95], a[28:31], v[244:247], v[92:95]
  v_permlane16_swap_b32 v104, v106
  v_mfma_f32_16x16x32_bf16 v[92:95], a[44:47], v[248:251], v[92:95]
  v_permlane16_swap_b32 v105, v107
  v_mfma_f32_16x16x32_bf16 v[92:95], a[60:63], v[252:255], v[92:95]
  buffer_load_dwordx4 v8, s[12:15], s21 offen offset:3072 lds
  s_waitcnt lgkmcnt(0)
  v_mfma_f32_16x16x32_bf16 v[32:35], a[64:67], v[224:227], v[32:35]
  ds_read_b64_tr_b16 v[240:241], v2 offset:16384
  v_cvt_pk_bf16_f32 v110, v124, v125
  v_mfma_f32_16x16x32_bf16 v[32:35], a[80:83], v[228:231], v[32:35]
  ds_read_b64_tr_b16 v[242:243], v2 offset:16896
  v_cvt_pk_bf16_f32 v111, v126, v127
  v_mfma_f32_16x16x32_bf16 v[32:35], a[96:99], v[232:235], v[32:35]
  ds_read_b64_tr_b16 v[244:245], v2 offset:20480
  v_mfma_f32_16x16x32_bf16 v[32:35], a[112:115], v[236:239], v[32:35]
  buffer_store_dwordx4 v[104:107], v17, s[48:51], s34 offen sc1
  s_add_u32 s34, s34, s65
  v_mfma_f32_16x16x32_bf16 v[48:51], a[68:71], v[224:227], v[48:51]
  ds_read_b64_tr_b16 v[246:247], v2 offset:20992
  v_cvt_pk_bf16_f32 v128, v128, v129
  v_mfma_f32_16x16x32_bf16 v[48:51], a[84:87], v[228:231], v[48:51]
  ds_read_b64_tr_b16 v[248:249], v2 offset:24576
  v_cvt_pk_bf16_f32 v129, v130, v131
  v_mfma_f32_16x16x32_bf16 v[48:51], a[100:103], v[232:235], v[48:51]
  ds_read_b64_tr_b16 v[250:251], v2 offset:25088
  v_mfma_f32_16x16x32_bf16 v[48:51], a[116:119], v[236:239], v[48:51]
  v_permlane16_swap_b32 v108, v110
  v_mfma_f32_16x16x32_bf16 v[64:67], a[72:75], v[224:227], v[64:67]
  ds_read_b64_tr_b16 v[252:253], v2 offset:28672
  v_mfma_f32_16x16x32_bf16 v[64:67], a[88:91], v[228:231], v[64:67]
  ds_read_b64_tr_b16 v[254:255], v2 offset:29184
  v_mfma_f32_16x16x32_bf16 v[64:67], a[104:107], v[232:235], v[64:67]
  v_permlane16_swap_b32 v109, v111
  v_mfma_f32_16x16x32_bf16 v[64:67], a[120:123], v[236:239], v[64:67]
  v_cvt_pk_bf16_f32 v130, v144, v145
  v_mfma_f32_16x16x32_bf16 v[80:83], a[76:79], v[224:227], v[80:83]
  v_cvt_pk_bf16_f32 v131, v146, v147
  v_mfma_f32_16x16x32_bf16 v[80:83], a[92:95], v[228:231], v[80:83]
  v_mfma_f32_16x16x32_bf16 v[80:83], a[108:111], v[232:235], v[80:83]
  buffer_store_dwordx4 v[108:111], v17, s[48:51], s35 offen sc1
  v_mfma_f32_16x16x32_bf16 v[80:83], a[124:127], v[236:239], v[80:83]
  s_waitcnt lgkmcnt(0)
  v_mfma_f32_16x16x32_bf16 v[36:39], a[64:67], v[240:243], v[36:39]
  ds_read_b64_tr_b16 v[224:225], v3 offset:16384
  s_add_u32 s35, s35, s65
  v_mfma_f32_16x16x32_bf16 v[36:39], a[80:83], v[244:247], v[36:39]
  ds_read_b64_tr_b16 v[226:227], v3 offset:16896
  v_cvt_pk_bf16_f32 v132, v132, v133
  v_mfma_f32_16x16x32_bf16 v[36:39], a[96:99], v[248:251], v[36:39]
  ds_read_b64_tr_b16 v[228:229], v3 offset:20480
  v_mfma_f32_16x16x32_bf16 v[36:39], a[112:115], v[252:255], v[36:39]
  v_cvt_pk_bf16_f32 v133, v134, v135
  v_mfma_f32_16x16x32_bf16 v[52:55], a[68:71], v[240:243], v[52:55]
  ds_read_b64_tr_b16 v[230:231], v3 offset:20992
  v_mfma_f32_16x16x32_bf16 v[52:55], a[84:87], v[244:247], v[52:55]
  ds_read_b64_tr_b16 v[232:233], v3 offset:24576
  v_mfma_f32_16x16x32_bf16 v[52:55], a[100:103], v[248:251], v[52:55]
  ds_read_b64_tr_b16 v[234:235], v3 offset:25088
  v_mfma_f32_16x16x32_bf16 v[52:55], a[116:119], v[252:255], v[52:55]
  v_permlane16_swap_b32 v128, v130
  v_mfma_f32_16x16x32_bf16 v[68:71], a[72:75], v[240:243], v[68:71]
  ds_read_b64_tr_b16 v[236:237], v3 offset:28672
  v_mfma_f32_16x16x32_bf16 v[68:71], a[88:91], v[244:247], v[68:71]
  ds_read_b64_tr_b16 v[238:239], v3 offset:29184
  v_mfma_f32_16x16x32_bf16 v[68:71], a[104:107], v[248:251], v[68:71]
  v_permlane16_swap_b32 v129, v131
  v_mfma_f32_16x16x32_bf16 v[68:71], a[120:123], v[252:255], v[68:71]
  v_cvt_pk_bf16_f32 v134, v148, v149
  v_cvt_pk_bf16_f32 v135, v150, v151
  v_mfma_f32_16x16x32_bf16 v[84:87], a[76:79], v[240:243], v[84:87]
  buffer_store_dwordx4 v[128:131], v17, s[48:51], s32 offen sc1
  v_mfma_f32_16x16x32_bf16 v[84:87], a[92:95], v[244:247], v[84:87]
  v_cvt_pk_bf16_f32 v136, v136, v137
  v_mfma_f32_16x16x32_bf16 v[84:87], a[108:111], v[248:251], v[84:87]
  v_mfma_f32_16x16x32_bf16 v[84:87], a[124:127], v[252:255], v[84:87]
  v_cvt_pk_bf16_f32 v137, v138, v139
  s_waitcnt lgkmcnt(0)
  v_mfma_f32_16x16x32_bf16 v[40:43], a[64:67], v[224:227], v[40:43]
  ds_read_b64_tr_b16 v[240:241], v4 offset:16384
  v_mfma_f32_16x16x32_bf16 v[40:43], a[80:83], v[228:231], v[40:43]
  ds_read_b64_tr_b16 v[242:243], v4 offset:16896
  v_mfma_f32_16x16x32_bf16 v[40:43], a[96:99], v[232:235], v[40:43]
  ds_read_b64_tr_b16 v[244:245], v4 offset:20480
  v_mfma_f32_16x16x32_bf16 v[40:43], a[112:115], v[236:239], v[40:43]
  v_permlane16_swap_b32 v132, v134
  v_mfma_f32_16x16x32_bf16 v[56:59], a[68:71], v[224:227], v[56:59]
  ds_read_b64_tr_b16 v[246:247], v4 offset:20992
  v_mfma_f32_16x16x32_bf16 v[56:59], a[84:87], v[228:231], v[56:59]
  ds_read_b64_tr_b16 v[248:249], v4 offset:24576
  v_mfma_f32_16x16x32_bf16 v[56:59], a[100:103], v[232:235], v[56:59]
  ds_read_b64_tr_b16 v[250:251], v4 offset:25088
  v_mfma_f32_16x16x32_bf16 v[56:59], a[116:119], v[236:239], v[56:59]
  v_permlane16_swap_b32 v133, v135
  v_mfma_f32_16x16x32_bf16 v[72:75], a[72:75], v[224:227], v[72:75]
  ds_read_b64_tr_b16 v[252:253], v4 offset:28672
  v_cvt_pk_bf16_f32 v138, v152, v153
  v_mfma_f32_16x16x32_bf16 v[72:75], a[88:91], v[228:231], v[72:75]
  ds_read_b64_tr_b16 v[254:255], v4 offset:29184
  v_cvt_pk_bf16_f32 v139, v154, v155
  v_mfma_f32_16x16x32_bf16 v[72:75], a[104:107], v[232:235], v[72:75]
  buffer_store_dwordx4 v[132:135], v17, s[48:51], s33 offen sc1
  v_cvt_pk_bf16_f32 v140, v140, v141
  v_mfma_f32_16x16x32_bf16 v[72:75], a[120:123], v[236:239], v[72:75]
  v_cvt_pk_bf16_f32 v141, v142, v143
  v_mfma_f32_16x16x32_bf16 v[88:91], a[76:79], v[224:227], v[88:91]
  v_mfma_f32_16x16x32_bf16 v[88:91], a[92:95], v[228:231], v[88:91]
  v_permlane16_swap_b32 v136, v138
  v_mfma_f32_16x16x32_bf16 v[88:91], a[108:111], v[232:235], v[88:91]
  v_permlane16_swap_b32 v137, v139
  v_mfma_f32_16x16x32_bf16 v[88:91], a[124:127], v[236:239], v[88:91]
  s_waitcnt vmcnt(19) lgkmcnt(0)
  s_barrier
  v_mfma_f32_16x16x32_bf16 v[44:47], a[64:67], v[240:243], v[44:47]
  ds_read_b64_tr_b16 v[224:225], v1 offset:32768
  s_add_u32 m0, s19, 16384
  v_mfma_f32_16x16x32_bf16 v[44:47], a[80:83], v[244:247], v[44:47]
  ds_read_b64_tr_b16 v[226:227], v1 offset:33280
  s_add_u32 s21, s23, 512
  v_mfma_f32_16x16x32_bf16 v[44:47], a[96:99], v[248:251], v[44:47]
  ds_read_b64_tr_b16 v[228:229], v1 offset:36864
  v_cvt_pk_bf16_f32 v142, v156, v157
  v_mfma_f32_16x16x32_bf16 v[44:47], a[112:115], v[252:255], v[44:47]
  buffer_load_dwordx4 v5, s[12:15], s21 offen offset:0 lds
  v_cvt_pk_bf16_f32 v143, v158, v159
  v_mfma_f32_16x16x32_bf16 v[60:63], a[68:71], v[240:243], v[60:63]
  ds_read_b64_tr_b16 v[230:231], v1 offset:37376
  v_mfma_f32_16x16x32_bf16 v[60:63], a[84:87], v[244:247], v[60:63]
  ds_read_b64_tr_b16 v[232:233], v1 offset:40960
  v_mfma_f32_16x16x32_bf16 v[60:63], a[100:103], v[248:251], v[60:63]
  ds_read_b64_tr_b16 v[234:235], v1 offset:41472
  v_mfma_f32_16x16x32_bf16 v[60:63], a[116:119], v[252:255], v[60:63]
  buffer_load_dwordx4 v6, s[12:15], s21 offen offset:1024 lds
  v_mfma_f32_16x16x32_bf16 v[76:79], a[72:75], v[240:243], v[76:79]
  ds_read_b64_tr_b16 v[236:237], v1 offset:45056
  v_mfma_f32_16x16x32_bf16 v[76:79], a[88:91], v[244:247], v[76:79]
  ds_read_b64_tr_b16 v[238:239], v1 offset:45568
  v_mfma_f32_16x16x32_bf16 v[76:79], a[104:107], v[248:251], v[76:79]
  buffer_store_dwordx4 v[136:139], v17, s[48:51], s34 offen sc1
  v_mfma_f32_16x16x32_bf16 v[76:79], a[120:123], v[252:255], v[76:79]
  buffer_load_dwordx4 v7, s[12:15], s21 offen offset:2048 lds
  v_mfma_f32_16x16x32_bf16 v[92:95], a[76:79], v[240:243], v[92:95]
  s_nop 1
  v_mfma_f32_16x16x32_bf16 v[92:95], a[92:95], v[244:247], v[92:95]
  v_permlane16_swap_b32 v140, v142
  v_mfma_f32_16x16x32_bf16 v[92:95], a[108:111], v[248:251], v[92:95]
  v_permlane16_swap_b32 v141, v143
  v_mfma_f32_16x16x32_bf16 v[92:95], a[124:127], v[252:255], v[92:95]
  buffer_load_dwordx4 v8, s[12:15], s21 offen offset:3072 lds
  s_waitcnt lgkmcnt(0)
  v_mfma_f32_16x16x32_bf16 v[32:35], a[128:131], v[224:227], v[32:35]
  ds_read_b64_tr_b16 v[240:241], v2 offset:32768
  v_mfma_f32_16x16x32_bf16 v[32:35], a[144:147], v[228:231], v[32:35]
  ds_read_b64_tr_b16 v[242:243], v2 offset:33280
  v_mfma_f32_16x16x32_bf16 v[32:35], a[160:163], v[232:235], v[32:35]
  ds_read_b64_tr_b16 v[244:245], v2 offset:36864
  v_mfma_f32_16x16x32_bf16 v[32:35], a[176:179], v[236:239], v[32:35]
  buffer_store_dwordx4 v[140:143], v17, s[48:51], s35 offen sc1
  s_lshr_b32 s29, s27, 1
  v_mfma_f32_16x16x32_bf16 v[48:51], a[132:135], v[224:227], v[48:51]
  ds_read_b64_tr_b16 v[246:247], v2 offset:37376
  s_mul_i32 s32, s29, s70
  v_mfma_f32_16x16x32_bf16 v[48:51], a[148:151], v[228:231], v[48:51]
  ds_read_b64_tr_b16 v[248:249], v2 offset:40960
  s_and_b32 s29, s27, 1
  v_mfma_f32_16x16x32_bf16 v[48:51], a[164:167], v[232:235], v[48:51]
  ds_read_b64_tr_b16 v[250:251], v2 offset:41472
  s_mul_i32 s29, s29, s71
  v_mfma_f32_16x16x32_bf16 v[48:51], a[180:183], v[236:239], v[48:51]
  s_add_u32 s32, s32, s29
  s_add_u32 s32, s32, s36
  s_add_u32 s27, s27, 1
  v_mfma_f32_16x16x32_bf16 v[64:67], a[136:139], v[224:227], v[64:67]
  ds_read_b64_tr_b16 v[252:253], v2 offset:45056
  s_add_u32 s33, s32, s67
  v_mfma_f32_16x16x32_bf16 v[64:67], a[152:155], v[228:231], v[64:67]
  ds_read_b64_tr_b16 v[254:255], v2 offset:45568
  v_mfma_f32_16x16x32_bf16 v[64:67], a[168:171], v[232:235], v[64:67]
  s_add_u32 s34, s32, s66
  v_mfma_f32_16x16x32_bf16 v[64:67], a[184:187], v[236:239], v[64:67]
  s_add_u32 s35, s34, s67
  v_mfma_f32_16x16x32_bf16 v[80:83], a[140:143], v[224:227], v[80:83]
  v_mfma_f32_16x16x32_bf16 v[80:83], a[156:159], v[228:231], v[80:83]
  v_cvt_pk_bf16_f32 v160, v160, v161
  v_mfma_f32_16x16x32_bf16 v[80:83], a[172:175], v[232:235], v[80:83]
  v_mfma_f32_16x16x32_bf16 v[80:83], a[188:191], v[236:239], v[80:83]
  v_cvt_pk_bf16_f32 v161, v162, v163
  s_waitcnt lgkmcnt(0)
  v_mfma_f32_16x16x32_bf16 v[36:39], a[128:131], v[240:243], v[36:39]
  ds_read_b64_tr_b16 v[224:225], v3 offset:32768
  v_mfma_f32_16x16x32_bf16 v[36:39], a[144:147], v[244:247], v[36:39]
  ds_read_b64_tr_b16 v[226:227], v3 offset:33280
  v_cvt_pk_bf16_f32 v162, v176, v177
  v_mfma_f32_16x16x32_bf16 v[36:39], a[160:163], v[248:251], v[36:39]
  ds_read_b64_tr_b16 v[228:229], v3 offset:36864
  v_cvt_pk_bf16_f32 v163, v178, v179
  v_mfma_f32_16x16x32_bf16 v[36:39], a[176:179], v[252:255], v[36:39]
  v_mfma_f32_16x16x32_bf16 v[52:55], a[132:135], v[240:243], v[52:55]
  ds_read_b64_tr_b16 v[230:231], v3 offset:37376
  v_cvt_pk_bf16_f32 v164, v164, v165
  v_mfma_f32_16x16x32_bf16 v[52:55], a[148:151], v[244:247], v[52:55]
  ds_read_b64_tr_b16 v[232:233], v3 offset:40960
  v_mfma_f32_16x16x32_bf16 v[52:55], a[164:167], v[248:251], v[52:55]
  ds_read_b64_tr_b16 v[234:235], v3 offset:41472
  v_cvt_pk_bf16_f32 v165, v166, v167
  v_mfma_f32_16x16x32_bf16 v[52:55], a[180:183], v[252:255], v[52:55]
  v_permlane16_swap_b32 v160, v162
  v_mfma_f32_16x16x32_bf16 v[68:71], a[136:139], v[240:243], v[68:71]
  ds_read_b64_tr_b16 v[236:237], v3 offset:45056
  v_mfma_f32_16x16x32_bf16 v[68:71], a[152:155], v[244:247], v[68:71]
  ds_read_b64_tr_b16 v[238:239], v3 offset:45568
  v_mfma_f32_16x16x32_bf16 v[68:71], a[168:171], v[248:251], v[68:71]
  v_permlane16_swap_b32 v161, v163
  v_mfma_f32_16x16x32_bf16 v[68:71], a[184:187], v[252:255], v[68:71]
  v_cvt_pk_bf16_f32 v166, v180, v181
  v_mfma_f32_16x16x32_bf16 v[84:87], a[140:143], v[240:243], v[84:87]
  v_mfma_f32_16x16x32_bf16 v[84:87], a[156:159], v[244:247], v[84:87]
  v_cvt_pk_bf16_f32 v167, v182, v183
  v_mfma_f32_16x16x32_bf16 v[84:87], a[172:175], v[248:251], v[84:87]
  buffer_store_dwordx4 v[160:163], v17, s[48:51], s32 offen sc1
  v_mfma_f32_16x16x32_bf16 v[84:87], a[188:191], v[252:255], v[84:87]
  s_waitcnt lgkmcnt(0)
  v_mfma_f32_16x16x32_bf16 v[40:43], a[128:131], v[224:227], v[40:43]
  ds_read_b64_tr_b16 v[240:241], v4 offset:32768
  s_add_u32 s32, s32, s65
  v_mfma_f32_16x16x32_bf16 v[40:43], a[144:147], v[228:231], v[40:43]
  ds_read_b64_tr_b16 v[242:243], v4 offset:33280
  v_mfma_f32_16x16x32_bf16 v[40:43], a[160:163], v[232:235], v[40:43]
  ds_read_b64_tr_b16 v[244:245], v4 offset:36864
  v_cvt_pk_bf16_f32 v168, v168, v169
  v_mfma_f32_16x16x32_bf16 v[40:43], a[176:179], v[236:239], v[40:43]
  v_cvt_pk_bf16_f32 v169, v170, v171
  v_mfma_f32_16x16x32_bf16 v[56:59], a[132:135], v[224:227], v[56:59]
  ds_read_b64_tr_b16 v[246:247], v4 offset:37376
  v_mfma_f32_16x16x32_bf16 v[56:59], a[148:151], v[228:231], v[56:59]
  ds_read_b64_tr_b16 v[248:249], v4 offset:40960
  v_mfma_f32_16x16x32_bf16 v[56:59], a[164:167], v[232:235], v[56:59]
  ds_read_b64_tr_b16 v[250:251], v4 offset:41472
  v_mfma_f32_16x16x32_bf16 v[56:59], a[180:183], v[236:239], v[56:59]
  v_permlane16_swap_b32 v164, v166
  v_mfma_f32_16x16x32_bf16 v[72:75], a[136:139], v[224:227], v[72:75]
  ds_read_b64_tr_b16 v[252:253], v4 offset:45056
  v_mfma_f32_16x16x32_bf16 v[72:75], a[152:155], v[228:231], v[72:75]
  ds_read_b64_tr_b16 v[254:255], v4 offset:45568
  v_mfma_f32_16x16x32_bf16 v[72:75], a[168:171], v[232:235], v[72:75]
  v_permlane16_swap_b32 v165, v167
  v_mfma_f32_16x16x32_bf16 v[72:75], a[184:187], v[236:239], v[72:75]
  v_cvt_pk_bf16_f32 v170, v184, v185
  v_cvt_pk_bf16_f32 v171, v186, v187
  v_mfma_f32_16x16x32_bf16 v[88:91], a[140:143], v[224:227], v[88:91]
  buffer_store_dwordx4 v[164:167], v17, s[48:51], s33 offen sc1
  v_mfma_f32_16x16x32_bf16 v[88:91], a[156:159], v[228:231], v[88:91]
  v_mfma_f32_16x16x32_bf16 v[88:91], a[172:175], v[232:235], v[88:91]
  s_add_u32 s33, s33, s65
  v_mfma_f32_16x16x32_bf16 v[88:91], a[188:191], v[236:239], v[88:91]
  s_waitcnt vmcnt(18) lgkmcnt(0)
  s_barrier
  v_mfma_f32_16x16x32_bf16 v[44:47], a[128:131], v[240:243], v[44:47]
  ds_read_b64_tr_b16 v[224:225], v1 offset:49152
  s_add_u32 m0, s19, 32768
  v_mfma_f32_16x16x32_bf16 v[44:47], a[144:147], v[244:247], v[44:47]
  ds_read_b64_tr_b16 v[226:227], v1 offset:49664
  s_add_u32 s21, s24, 512
  v_mfma_f32_16x16x32_bf16 v[44:47], a[160:163], v[248:251], v[44:47]
  ds_read_b64_tr_b16 v[228:229], v1 offset:53248
  v_cvt_pk_bf16_f32 v172, v172, v173
  v_mfma_f32_16x16x32_bf16 v[44:47], a[176:179], v[252:255], v[44:47]
  buffer_load_dwordx4 v5, s[12:15], s21 offen offset:0 lds
  v_cvt_pk_bf16_f32 v173, v174, v175
  v_mfma_f32_16x16x32_bf16 v[60:63], a[132:135], v[240:243], v[60:63]
  ds_read_b64_tr_b16 v[230:231], v1 offset:53760
  v_mfma_f32_16x16x32_bf16 v[60:63], a[148:151], v[244:247], v[60:63]
  ds_read_b64_tr_b16 v[232:233], v1 offset:57344
  v_mfma_f32_16x16x32_bf16 v[60:63], a[164:167], v[248:251], v[60:63]
  ds_read_b64_tr_b16 v[234:235], v1 offset:57856
  v_mfma_f32_16x16x32_bf16 v[60:63], a[180:183], v[252:255], v[60:63]
  buffer_load_dwordx4 v6, s[12:15], s21 offen offset:1024 lds
  v_mfma_f32_16x16x32_bf16 v[76:79], a[136:139], v[240:243], v[76:79]
  ds_read_b64_tr_b16 v[236:237], v1 offset:61440
  v_mfma_f32_16x16x32_bf16 v[76:79], a[152:155], v[244:247], v[76:79]
  ds_read_b64_tr_b16 v[238:239], v1 offset:61952
  v_mfma_f32_16x16x32_bf16 v[76:79], a[168:171], v[248:251], v[76:79]
  v_permlane16_swap_b32 v168, v170
  v_mfma_f32_16x16x32_bf16 v[76:79], a[184:187], v[252:255], v[76:79]
  buffer_load_dwordx4 v7, s[12:15], s21 offen offset:2048 lds
  v_mfma_f32_16x16x32_bf16 v[92:95], a[140:143], v[240:243], v[92:95]
  v_permlane16_swap_b32 v169, v171
  v_mfma_f32_16x16x32_bf16 v[92:95], a[156:159], v[244:247], v[92:95]
  v_cvt_pk_bf16_f32 v174, v188, v189
  v_cvt_pk_bf16_f32 v175, v190, v191
  v_mfma_f32_16x16x32_bf16 v[92:95], a[172:175], v[248:251], v[92:95]
  buffer_store_dwordx4 v[168:171], v17, s[48:51], s34 offen sc1
  s_add_u32 s34, s34, s65
  v_mfma_f32_16x16x32_bf16 v[92:95], a[188:191], v[252:255], v[92:95]
  buffer_load_dwordx4 v8, s[12:15], s21 offen offset:3072 lds
  s_waitcnt lgkmcnt(0)
  v_mfma_f32_16x16x32_bf16 v[32:35], a[192:195], v[224:227], v[32:35]
  ds_read_b64_tr_b16 v[240:241], v2 offset:49152
  v_cvt_pk_bf16_f32 v192, v192, v193
  v_mfma_f32_16x16x32_bf16 v[32:35], a[208:211], v[228:231], v[32:35]
  ds_read_b64_tr_b16 v[242:243], v2 offset:49664
  v_cvt_pk_bf16_f32 v193, v194, v195
  v_mfma_f32_16x16x32_bf16 v[32:35], a[224:227], v[232:235], v[32:35]
  ds_read_b64_tr_b16 v[244:245], v2 offset:53248
  v_mfma_f32_16x16x32_bf16 v[32:35], a[240:243], v[236:239], v[32:35]
  v_permlane16_swap_b32 v172, v174
  v_mfma_f32_16x16x32_bf16 v[48:51], a[196:199], v[224:227], v[48:51]
  ds_read_b64_tr_b16 v[246:247], v2 offset:53760
  v_mfma_f32_16x16x32_bf16 v[48:51], a[212:215], v[228:231], v[48:51]
  ds_read_b64_tr_b16 v[248:249], v2 offset:57344
  v_mfma_f32_16x16x32_bf16 v[48:51], a[228:231], v[232:235], v[48:51]
  ds_read_b64_tr_b16 v[250:251], v2 offset:57856
  v_mfma_f32_16x16x32_bf16 v[48:51], a[244:247], v[236:239], v[48:51]
  v_permlane16_swap_b32 v173, v175
  v_mfma_f32_16x16x32_bf16 v[64:67], a[200:203], v[224:227], v[64:67]
  ds_read_b64_tr_b16 v[252:253], v2 offset:61440
  v_cvt_pk_bf16_f32 v194, v208, v209
  v_mfma_f32_16x16x32_bf16 v[64:67], a[216:219], v[228:231], v[64:67]
  ds_read_b64_tr_b16 v[254:255], v2 offset:61952
  v_cvt_pk_bf16_f32 v195, v210, v211
  v_mfma_f32_16x16x32_bf16 v[64:67], a[232:235], v[232:235], v[64:67]
  buffer_store_dwordx4 v[172:175], v17, s[48:51], s35 offen sc1
  s_add_u32 s35, s35, s65
  v_mfma_f32_16x16x32_bf16 v[64:67], a[248:251], v[236:239], v[64:67]
  v_cvt_pk_bf16_f32 v196, v196, v197
  v_mfma_f32_16x16x32_bf16 v[80:83], a[204:207], v[224:227], v[80:83]
  v_cvt_pk_bf16_f32 v197, v198, v199
  v_mfma_f32_16x16x32_bf16 v[80:83], a[220:223], v[228:231], v[80:83]
  v_mfma_f32_16x16x32_bf16 v[80:83], a[236:239], v[232:235], v[80:83]
  v_permlane16_swap_b32 v192, v194
  v_mfma_f32_16x16x32_bf16 v[80:83], a[252:255], v[236:239], v[80:83]
  s_waitcnt lgkmcnt(0)
  v_mfma_f32_16x16x32_bf16 v[36:39], a[192:195], v[240:243], v[36:39]
  ds_read_b64_tr_b16 v[224:225], v3 offset:49152
  v_mfma_f32_16x16x32_bf16 v[36:39], a[208:211], v[244:247], v[36:39]
  ds_read_b64_tr_b16 v[226:227], v3 offset:49664
  v_mfma_f32_16x16x32_bf16 v[36:39], a[224:227], v[248:251], v[36:39]
  ds_read_b64_tr_b16 v[228:229], v3 offset:53248
  v_mfma_f32_16x16x32_bf16 v[36:39], a[240:243], v[252:255], v[36:39]
  v_permlane16_swap_b32 v193, v195
  v_mfma_f32_16x16x32_bf16 v[52:55], a[196:199], v[240:243], v[52:55]
  ds_read_b64_tr_b16 v[230:231], v3 offset:53760
  v_cvt_pk_bf16_f32 v198, v212, v213
  v_mfma_f32_16x16x32_bf16 v[52:55], a[212:215], v[244:247], v[52:55]
  ds_read_b64_tr_b16 v[232:233], v3 offset:57344
  v_cvt_pk_bf16_f32 v199, v214, v215
  v_mfma_f32_16x16x32_bf16 v[52:55], a[228:231], v[248:251], v[52:55]
  ds_read_b64_tr_b16 v[234:235], v3 offset:57856
  v_mfma_f32_16x16x32_bf16 v[52:55], a[244:247], v[252:255], v[52:55]
  buffer_store_dwordx4 v[192:195], v17, s[48:51], s32 offen sc1
  v_cvt_pk_bf16_f32 v200, v200, v201
  v_mfma_f32_16x16x32_bf16 v[68:71], a[200:203], v[240:243], v[68:71]
  ds_read_b64_tr_b16 v[236:237], v3 offset:61440
  v_cvt_pk_bf16_f32 v201, v202, v203
  v_mfma_f32_16x16x32_bf16 v[68:71], a[216:219], v[244:247], v[68:71]
  ds_read_b64_tr_b16 v[238:239], v3 offset:61952
  v_mfma_f32_16x16x32_bf16 v[68:71], a[232:235], v[248:251], v[68:71]
  v_permlane16_swap_b32 v196, v198
  v_mfma_f32_16x16x32_bf16 v[68:71], a[248:251], v[252:255], v[68:71]
  v_mfma_f32_16x16x32_bf16 v[84:87], a[204:207], v[240:243], v[84:87]
  v_permlane16_swap_b32 v197, v199
  v_mfma_f32_16x16x32_bf16 v[84:87], a[220:223], v[244:247], v[84:87]
  v_mfma_f32_16x16x32_bf16 v[84:87], a[236:239], v[248:251], v[84:87]
  v_cvt_pk_bf16_f32 v202, v216, v217
  v_mfma_f32_16x16x32_bf16 v[84:87], a[252:255], v[252:255], v[84:87]
  v_cvt_pk_bf16_f32 v203, v218, v219
  s_waitcnt lgkmcnt(0)
  v_mfma_f32_16x16x32_bf16 v[40:43], a[192:195], v[224:227], v[40:43]
  ds_read_b64_tr_b16 v[240:241], v4 offset:49152
  v_mfma_f32_16x16x32_bf16 v[40:43], a[208:211], v[228:231], v[40:43]
  ds_read_b64_tr_b16 v[242:243], v4 offset:49664
  v_mfma_f32_16x16x32_bf16 v[40:43], a[224:227], v[232:235], v[40:43]
  ds_read_b64_tr_b16 v[244:245], v4 offset:53248
  v_mfma_f32_16x16x32_bf16 v[40:43], a[240:243], v[236:239], v[40:43]
  buffer_store_dwordx4 v[196:199], v17, s[48:51], s33 offen sc1
  v_cvt_pk_bf16_f32 v204, v204, v205
  v_mfma_f32_16x16x32_bf16 v[56:59], a[196:199], v[224:227], v[56:59]
  ds_read_b64_tr_b16 v[246:247], v4 offset:53760
  v_mfma_f32_16x16x32_bf16 v[56:59], a[212:215], v[228:231], v[56:59]
  ds_read_b64_tr_b16 v[248:249], v4 offset:57344
  v_mfma_f32_16x16x32_bf16 v[56:59], a[228:231], v[232:235], v[56:59]
  ds_read_b64_tr_b16 v[250:251], v4 offset:57856
  v_mfma_f32_16x16x32_bf16 v[56:59], a[244:247], v[236:239], v[56:59]
  v_mfma_f32_16x16x32_bf16 v[72:75], a[200:203], v[224:227], v[72:75]
  ds_read_b64_tr_b16 v[252:253], v4 offset:61440
  v_mfma_f32_16x16x32_bf16 v[72:75], a[216:219], v[228:231], v[72:75]
  ds_read_b64_tr_b16 v[254:255], v4 offset:61952
  v_mfma_f32_16x16x32_bf16 v[72:75], a[232:235], v[232:235], v[72:75]
  v_mfma_f32_16x16x32_bf16 v[72:75], a[248:251], v[236:239], v[72:75]
  v_mfma_f32_16x16x32_bf16 v[88:91], a[204:207], v[224:227], v[88:91]
  v_mfma_f32_16x16x32_bf16 v[88:91], a[220:223], v[228:231], v[88:91]
  v_mfma_f32_16x16x32_bf16 v[88:91], a[236:239], v[232:235], v[88:91]
  v_mfma_f32_16x16x32_bf16 v[88:91], a[252:255], v[236:239], v[88:91]
  s_waitcnt vmcnt(20) lgkmcnt(0)
  s_barrier
  v_mfma_f32_16x16x32_bf16 v[44:47], a[192:195], v[240:243], v[44:47]
  ds_read_b64_tr_b16 v[224:225], v1 offset:0
  s_add_u32 m0, s19, 49152
  v_mfma_f32_16x16x32_bf16 v[44:47], a[208:211], v[244:247], v[44:47]
  ds_read_b64_tr_b16 v[226:227], v1 offset:512
  s_add_u32 s21, s38, 512
  v_mfma_f32_16x16x32_bf16 v[44:47], a[224:227], v[248:251], v[44:47]
  ds_read_b64_tr_b16 v[228:229], v1 offset:4096
  v_mfma_f32_16x16x32_bf16 v[44:47], a[240:243], v[252:255], v[44:47]
  buffer_load_dwordx4 v5, s[12:15], s21 offen offset:0 lds
  v_mfma_f32_16x16x32_bf16 v[60:63], a[196:199], v[240:243], v[60:63]
  ds_read_b64_tr_b16 v[230:231], v1 offset:4608
  v_mfma_f32_16x16x32_bf16 v[60:63], a[212:215], v[244:247], v[60:63]
  ds_read_b64_tr_b16 v[232:233], v1 offset:8192
  v_mfma_f32_16x16x32_bf16 v[60:63], a[228:231], v[248:251], v[60:63]
  ds_read_b64_tr_b16 v[234:235], v1 offset:8704
  v_mfma_f32_16x16x32_bf16 v[60:63], a[244:247], v[252:255], v[60:63]
  buffer_load_dwordx4 v6, s[12:15], s21 offen offset:1024 lds
  v_mfma_f32_16x16x32_bf16 v[76:79], a[200:203], v[240:243], v[76:79]
  ds_read_b64_tr_b16 v[236:237], v1 offset:12288
  v_mfma_f32_16x16x32_bf16 v[76:79], a[216:219], v[244:247], v[76:79]
  ds_read_b64_tr_b16 v[238:239], v1 offset:12800
  v_mfma_f32_16x16x32_bf16 v[76:79], a[232:235], v[248:251], v[76:79]
  v_mfma_f32_16x16x32_bf16 v[76:79], a[248:251], v[252:255], v[76:79]
  buffer_load_dwordx4 v7, s[12:15], s21 offen offset:2048 lds
  v_mfma_f32_16x16x32_bf16 v[92:95], a[204:207], v[240:243], v[92:95]
  v_mfma_f32_16x16x32_bf16 v[92:95], a[220:223], v[244:247], v[92:95]
  v_mfma_f32_16x16x32_bf16 v[92:95], a[236:239], v[248:251], v[92:95]
  v_mfma_f32_16x16x32_bf16 v[92:95], a[252:255], v[252:255], v[92:95]
  buffer_load_dwordx4 v8, s[12:15], s21 offen offset:3072 lds
P1_U41:
  s_waitcnt lgkmcnt(0)
  v_mfma_f32_16x16x32_bf16 v[96:99], a[0:3], v[224:227], 0
  ds_read_b64_tr_b16 v[240:241], v2 offset:0
  s_mov_b64 s[12:13], s[52:53]
  v_mfma_f32_16x16x32_bf16 v[96:99], a[16:19], v[228:231], v[96:99]
  ds_read_b64_tr_b16 v[242:243], v2 offset:512
  s_mov_b32 s14, 4194304
  v_mfma_f32_16x16x32_bf16 v[96:99], a[32:35], v[232:235], v[96:99]
  ds_read_b64_tr_b16 v[244:245], v2 offset:4096
  s_mov_b32 s58, 8192
  v_mfma_f32_16x16x32_bf16 v[96:99], a[48:51], v[236:239], v[96:99]
  s_lshl_b32 s62, s17, 8
  s_lshl_b32 s31, s58, 3
  v_mad_u32_u24 v5, v18, s58, v19
  v_mfma_f32_16x16x32_bf16 v[112:115], a[4:7], v[224:227], 0
  ds_read_b64_tr_b16 v[246:247], v2 offset:4608
  s_sub_u32 s31, s31, 1024
  v_mfma_f32_16x16x32_bf16 v[112:115], a[20:23], v[228:231], v[112:115]
  ds_read_b64_tr_b16 v[248:249], v2 offset:8192
  v_xor_b32 v6, 64, v5
  v_mfma_f32_16x16x32_bf16 v[112:115], a[36:39], v[232:235], v[112:115]
  ds_read_b64_tr_b16 v[250:251], v2 offset:8704
  v_add_u32 v6, s31, v6
  v_mfma_f32_16x16x32_bf16 v[112:115], a[52:55], v[236:239], v[112:115]
  s_lshl_b32 s31, s31, 1
  v_add_u32 v7, s31, v5
  v_add_u32 v8, s31, v6
  v_mfma_f32_16x16x32_bf16 v[128:131], a[8:11], v[224:227], 0
  ds_read_b64_tr_b16 v[252:253], v2 offset:12288
  s_mul_i32 s21, s58, s16
  v_mfma_f32_16x16x32_bf16 v[128:131], a[24:27], v[228:231], v[128:131]
  ds_read_b64_tr_b16 v[254:255], v2 offset:12800
  s_lshl_b32 s21, s21, 5
  v_mfma_f32_16x16x32_bf16 v[128:131], a[40:43], v[232:235], v[128:131]
  s_add_u32 s21, s21, s62
  s_lshr_b32 s31, s76, 1
  s_mul_i32 s31, s31, s58
  v_mfma_f32_16x16x32_bf16 v[128:131], a[56:59], v[236:239], v[128:131]
  s_add_u32 s22, s21, s31
  s_lshr_b32 s31, s77, 1
  s_mul_i32 s31, s31, s58
  v_mfma_f32_16x16x32_bf16 v[144:147], a[12:15], v[224:227], 0
  s_add_u32 s23, s21, s31
  s_lshr_b32 s31, s78, 1
  s_mul_i32 s31, s31, s58
  v_mfma_f32_16x16x32_bf16 v[144:147], a[28:31], v[228:231], v[144:147]
  s_add_u32 s24, s21, s31
  s_lshr_b32 s31, s79, 1
  s_mul_i32 s31, s31, s58
  v_mfma_f32_16x16x32_bf16 v[144:147], a[44:47], v[232:235], v[144:147]
  s_add_u32 s38, s21, s31
  v_cvt_pk_bf16_f32 v205, v206, v207
  v_mfma_f32_16x16x32_bf16 v[144:147], a[60:63], v[236:239], v[144:147]
  s_waitcnt lgkmcnt(0)
  v_mfma_f32_16x16x32_bf16 v[100:103], a[0:3], v[240:243], 0
  ds_read_b64_tr_b16 v[224:225], v3 offset:0
  v_mfma_f32_16x16x32_bf16 v[100:103], a[16:19], v[244:247], v[100:103]
  ds_read_b64_tr_b16 v[226:227], v3 offset:512
  v_mfma_f32_16x16x32_bf16 v[100:103], a[32:35], v[248:251], v[100:103]
  ds_read_b64_tr_b16 v[228:229], v3 offset:4096
  v_mfma_f32_16x16x32_bf16 v[100:103], a[48:51], v[252:255], v[100:103]
  v_permlane16_swap_b32 v200, v202
  v_mfma_f32_16x16x32_bf16 v[116:119], a[4:7], v[240:243], 0
  ds_read_b64_tr_b16 v[230:231], v3 offset:4608
  v_mfma_f32_16x16x32_bf16 v[116:119], a[20:23], v[244:247], v[116:119]
  ds_read_b64_tr_b16 v[232:233], v3 offset:8192
  v_mfma_f32_16x16x32_bf16 v[116:119], a[36:39], v[248:251], v[116:119]
  ds_read_b64_tr_b16 v[234:235], v3 offset:8704
  v_mfma_f32_16x16x32_bf16 v[116:119], a[52:55], v[252:255], v[116:119]
  v_permlane16_swap_b32 v201, v203
  v_mfma_f32_16x16x32_bf16 v[132:135], a[8:11], v[240:243], 0
  ds_read_b64_tr_b16 v[236:237], v3 offset:12288
  v_cvt_pk_bf16_f32 v206, v220, v221
  v_mfma_f32_16x16x32_bf16 v[132:135], a[24:27], v[244:247], v[132:135]
  ds_read_b64_tr_b16 v[238:239], v3 offset:12800
  v_cvt_pk_bf16_f32 v207, v222, v223
  v_mfma_f32_16x16x32_bf16 v[132:135], a[40:43], v[248:251], v[132:135]
  buffer_store_dwordx4 v[200:203], v17, s[48:51], s34 offen sc1
  v_mfma_f32_16x16x32_bf16 v[132:135], a[56:59], v[252:255], v[132:135]
  s_nop 1
  v_mfma_f32_16x16x32_bf16 v[148:151], a[12:15], v[240:243], 0
  v_permlane16_swap_b32 v204, v206
  v_mfma_f32_16x16x32_bf16 v[148:151], a[28:31], v[244:247], v[148:151]
  v_permlane16_swap_b32 v205, v207
  v_mfma_f32_16x16x32_bf16 v[148:151], a[44:47], v[248:251], v[148:151]
  buffer_store_dwordx4 v[204:207], v17, s[48:51], s35 offen sc1
  s_mov_b32 s50, s39
  v_mfma_f32_16x16x32_bf16 v[148:151], a[60:63], v[252:255], v[148:151]
  s_lshr_b32 s29, s27, 1
  s_mul_i32 s32, s29, s70
  s_waitcnt lgkmcnt(0)
  v_mfma_f32_16x16x32_bf16 v[104:107], a[0:3], v[224:227], 0
  ds_read_b64_tr_b16 v[240:241], v4 offset:0
  s_and_b32 s29, s27, 1
  v_mfma_f32_16x16x32_bf16 v[104:107], a[16:19], v[228:231], v[104:107]
  ds_read_b64_tr_b16 v[242:243], v4 offset:512
  s_mul_i32 s29, s29, s71
  v_mfma_f32_16x16x32_bf16 v[104:107], a[32:35], v[232:235], v[104:107]
  ds_read_b64_tr_b16 v[244:245], v4 offset:4096
  s_add_u32 s32, s32, s29
  v_mfma_f32_16x16x32_bf16 v[104:107], a[48:51], v[236:239], v[104:107]
  s_add_u32 s32, s32, s36
  s_add_u32 s27, s27, 1
  s_add_u32 s33, s32, s67
  v_mfma_f32_16x16x32_bf16 v[120:123], a[4:7], v[224:227], 0
  ds_read_b64_tr_b16 v[246:247], v4 offset:4608
  s_add_u32 s34, s32, s66
  v_mfma_f32_16x16x32_bf16 v[120:123], a[20:23], v[228:231], v[120:123]
  ds_read_b64_tr_b16 v[248:249], v4 offset:8192
  s_add_u32 s35, s34, s67
  v_mfma_f32_16x16x32_bf16 v[120:123], a[36:39], v[232:235], v[120:123]
  ds_read_b64_tr_b16 v[250:251], v4 offset:8704
  v_cvt_pk_bf16_f32 v32, v32, v33
  v_mfma_f32_16x16x32_bf16 v[120:123], a[52:55], v[236:239], v[120:123]
  v_cvt_pk_bf16_f32 v33, v34, v35
  v_mfma_f32_16x16x32_bf16 v[136:139], a[8:11], v[224:227], 0
  ds_read_b64_tr_b16 v[252:253], v4 offset:12288
  v_mfma_f32_16x16x32_bf16 v[136:139], a[24:27], v[228:231], v[136:139]
  ds_read_b64_tr_b16 v[254:255], v4 offset:12800
  v_cvt_pk_bf16_f32 v34, v48, v49
  v_mfma_f32_16x16x32_bf16 v[136:139], a[40:43], v[232:235], v[136:139]
  v_mfma_f32_16x16x32_bf16 v[136:139], a[56:59], v[236:239], v[136:139]
  v_cvt_pk_bf16_f32 v35, v50, v51
  v_mfma_f32_16x16x32_bf16 v[152:155], a[12:15], v[224:227], 0
  v_cvt_pk_bf16_f32 v36, v36, v37
  v_mfma_f32_16x16x32_bf16 v[152:155], a[28:31], v[228:231], v[152:155]
  v_mfma_f32_16x16x32_bf16 v[152:155], a[44:47], v[232:235], v[152:155]
  v_cvt_pk_bf16_f32 v37, v38, v39
  v_mfma_f32_16x16x32_bf16 v[152:155], a[60:63], v[236:239], v[152:155]
  s_waitcnt vmcnt(17) lgkmcnt(0)
  s_barrier
  v_mfma_f32_16x16x32_bf16 v[108:111], a[0:3], v[240:243], 0
  ds_read_b64_tr_b16 v[224:225], v1 offset:16384
  s_add_u32 m0, s19, 0
  v_mfma_f32_16x16x32_bf16 v[108:111], a[16:19], v[244:247], v[108:111]
  ds_read_b64_tr_b16 v[226:227], v1 offset:16896
  s_add_u32 s21, s22, 0
  v_mfma_f32_16x16x32_bf16 v[108:111], a[32:35], v[248:251], v[108:111]
  ds_read_b64_tr_b16 v[228:229], v1 offset:20480
  v_mfma_f32_16x16x32_bf16 v[108:111], a[48:51], v[252:255], v[108:111]
  buffer_load_dwordx4 v5, s[12:15], s21 offen offset:0 lds
  v_mfma_f32_16x16x32_bf16 v[124:127], a[4:7], v[240:243], 0
  ds_read_b64_tr_b16 v[230:231], v1 offset:20992
  v_mfma_f32_16x16x32_bf16 v[124:127], a[20:23], v[244:247], v[124:127]
  ds_read_b64_tr_b16 v[232:233], v1 offset:24576
  v_mfma_f32_16x16x32_bf16 v[124:127], a[36:39], v[248:251], v[124:127]
  ds_read_b64_tr_b16 v[234:235], v1 offset:25088
  v_mfma_f32_16x16x32_bf16 v[124:127], a[52:55], v[252:255], v[124:127]
  buffer_load_dwordx4 v6, s[12:15], s21 offen offset:1024 lds
  v_mfma_f32_16x16x32_bf16 v[140:143], a[8:11], v[240:243], 0
  ds_read_b64_tr_b16 v[236:237], v1 offset:28672
  v_mfma_f32_16x16x32_bf16 v[140:143], a[24:27], v[244:247], v[140:143]
  ds_read_b64_tr_b16 v[238:239], v1 offset:29184
  v_mfma_f32_16x16x32_bf16 v[140:143], a[40:43], v[248:251], v[140:143]
  v_permlane16_swap_b32 v32, v34
  v_mfma_f32_16x16x32_bf16 v[140:143], a[56:59], v[252:255], v[140:143]
  buffer_load_dwordx4 v7, s[12:15], s21 offen offset:2048 lds
  v_mfma_f32_16x16x32_bf16 v[156:159], a[12:15], v[240:243], 0
  v_permlane16_swap_b32 v33, v35
  v_mfma_f32_16x16x32_bf16 v[156:159], a[28:31], v[244:247], v[156:159]
  v_cvt_pk_bf16_f32 v38, v52, v53
  v_cvt_pk_bf16_f32 v39, v54, v55
  v_mfma_f32_16x16x32_bf16 v[156:159], a[44:47], v[248:251], v[156:159]
  buffer_store_dwordx4 v[32:35], v17, s[48:51], s32 offen sc1
  s_add_u32 s32, s32, s65
  v_mfma_f32_16x16x32_bf16 v[156:159], a[60:63], v[252:255], v[156:159]
  buffer_load_dwordx4 v8, s[12:15], s21 offen offset:3072 lds
  s_waitcnt lgkmcnt(0)
  v_mfma_f32_16x16x32_bf16 v[96:99], a[64:67], v[224:227], v[96:99]
  ds_read_b64_tr_b16 v[240:241], v2 offset:16384
  v_cvt_pk_bf16_f32 v40, v40, v41
  v_mfma_f32_16x16x32_bf16 v[96:99], a[80:83], v[228:231], v[96:99]
  ds_read_b64_tr_b16 v[242:243], v2 offset:16896
  v_cvt_pk_bf16_f32 v41, v42, v43
  v_mfma_f32_16x16x32_bf16 v[96:99], a[96:99], v[232:235], v[96:99]
  ds_read_b64_tr_b16 v[244:245], v2 offset:20480
  v_mfma_f32_16x16x32_bf16 v[96:99], a[112:115], v[236:239], v[96:99]
  v_permlane16_swap_b32 v36, v38
  v_mfma_f32_16x16x32_bf16 v[112:115], a[68:71], v[224:227], v[112:115]
  ds_read_b64_tr_b16 v[246:247], v2 offset:20992
  v_mfma_f32_16x16x32_bf16 v[112:115], a[84:87], v[228:231], v[112:115]
  ds_read_b64_tr_b16 v[248:249], v2 offset:24576
  v_mfma_f32_16x16x32_bf16 v[112:115], a[100:103], v[232:235], v[112:115]
  ds_read_b64_tr_b16 v[250:251], v2 offset:25088
  v_mfma_f32_16x16x32_bf16 v[112:115], a[116:119], v[236:239], v[112:115]
  v_permlane16_swap_b32 v37, v39
  v_mfma_f32_16x16x32_bf16 v[128:131], a[72:75], v[224:227], v[128:131]
  ds_read_b64_tr_b16 v[252:253], v2 offset:28672
  v_cvt_pk_bf16_f32 v42, v56, v57
  v_mfma_f32_16x16x32_bf16 v[128:131], a[88:91], v[228:231], v[128:131]
  ds_read_b64_tr_b16 v[254:255], v2 offset:29184
  v_cvt_pk_bf16_f32 v43, v58, v59
  v_mfma_f32_16x16x32_bf16 v[128:131], a[104:107], v[232:235], v[128:131]
  buffer_store_dwordx4 v[36:39], v17, s[48:51], s33 offen sc1
  s_add_u32 s33, s33, s65
  v_mfma_f32_16x16x32_bf16 v[128:131], a[120:123], v[236:239], v[128:131]
  v_cvt_pk_bf16_f32 v44, v44, v45
  v_cvt_pk_bf16_f32 v45, v46, v47
  v_mfma_f32_16x16x32_bf16 v[144:147], a[76:79], v[224:227], v[144:147]
  v_permlane16_swap_b32 v40, v42
  v_mfma_f32_16x16x32_bf16 v[144:147], a[92:95], v[228:231], v[144:147]
  v_permlane16_swap_b32 v41, v43
  v_mfma_f32_16x16x32_bf16 v[144:147], a[108:111], v[232:235], v[144:147]
  v_cvt_pk_bf16_f32 v46, v60, v61
  v_mfma_f32_16x16x32_bf16 v[144:147], a[124:127], v[236:239], v[144:147]
  v_cvt_pk_bf16_f32 v47, v62, v63
  s_waitcnt lgkmcnt(0)
  v_mfma_f32_16x16x32_bf16 v[100:103], a[64:67], v[240:243], v[100:103]
  ds_read_b64_tr_b16 v[224:225], v3 offset:16384
  v_mfma_f32_16x16x32_bf16 v[100:103], a[80:83], v[244:247], v[100:103]
  ds_read_b64_tr_b16 v[226:227], v3 offset:16896
  v_mfma_f32_16x16x32_bf16 v[100:103], a[96:99], v[248:251], v[100:103]
  ds_read_b64_tr_b16 v[228:229], v3 offset:20480
  v_mfma_f32_16x16x32_bf16 v[100:103], a[112:115], v[252:255], v[100:103]
  buffer_store_dwordx4 v[40:43], v17, s[48:51], s34 offen sc1
  s_add_u32 s34, s34, s65
  v_mfma_f32_16x16x32_bf16 v[116:119], a[68:71], v[240:243], v[116:119]
  ds_read_b64_tr_b16 v[230:231], v3 offset:20992
  v_cvt_pk_bf16_f32 v64, v64, v65
  v_mfma_f32_16x16x32_bf16 v[116:119], a[84:87], v[244:247], v[116:119]
  ds_read_b64_tr_b16 v[232:233], v3 offset:24576
  v_mfma_f32_16x16x32_bf16 v[116:119], a[100:103], v[248:251], v[116:119]
  ds_read_b64_tr_b16 v[234:235], v3 offset:25088
  v_cvt_pk_bf16_f32 v65, v66, v67
  v_mfma_f32_16x16x32_bf16 v[116:119], a[116:119], v[252:255], v[116:119]
  v_mfma_f32_16x16x32_bf16 v[132:135], a[72:75], v[240:243], v[132:135]
  ds_read_b64_tr_b16 v[236:237], v3 offset:28672
  v_mfma_f32_16x16x32_bf16 v[132:135], a[88:91], v[244:247], v[132:135]
  ds_read_b64_tr_b16 v[238:239], v3 offset:29184
  v_mfma_f32_16x16x32_bf16 v[132:135], a[104:107], v[248:251], v[132:135]
  v_permlane16_swap_b32 v44, v46
  v_mfma_f32_16x16x32_bf16 v[132:135], a[120:123], v[252:255], v[132:135]
  v_permlane16_swap_b32 v45, v47
  v_mfma_f32_16x16x32_bf16 v[148:151], a[76:79], v[240:243], v[148:151]
  v_cvt_pk_bf16_f32 v66, v80, v81
  v_mfma_f32_16x16x32_bf16 v[148:151], a[92:95], v[244:247], v[148:151]
  v_cvt_pk_bf16_f32 v67, v82, v83
  v_mfma_f32_16x16x32_bf16 v[148:151], a[108:111], v[248:251], v[148:151]
  buffer_store_dwordx4 v[44:47], v17, s[48:51], s35 offen sc1
  v_mfma_f32_16x16x32_bf16 v[148:151], a[124:127], v[252:255], v[148:151]
  s_waitcnt lgkmcnt(0)
  v_mfma_f32_16x16x32_bf16 v[104:107], a[64:67], v[224:227], v[104:107]
  ds_read_b64_tr_b16 v[240:241], v4 offset:16384
  s_add_u32 s35, s35, s65
  v_mfma_f32_16x16x32_bf16 v[104:107], a[80:83], v[228:231], v[104:107]
  ds_read_b64_tr_b16 v[242:243], v4 offset:16896
  v_mfma_f32_16x16x32_bf16 v[104:107], a[96:99], v[232:235], v[104:107]
  ds_read_b64_tr_b16 v[244:245], v4 offset:20480
  v_cvt_pk_bf16_f32 v68, v68, v69
  v_mfma_f32_16x16x32_bf16 v[104:107], a[112:115], v[236:239], v[104:107]
  v_cvt_pk_bf16_f32 v69, v70, v71
  v_mfma_f32_16x16x32_bf16 v[120:123], a[68:71], v[224:227], v[120:123]
  ds_read_b64_tr_b16 v[246:247], v4 offset:20992
  v_mfma_f32_16x16x32_bf16 v[120:123], a[84:87], v[228:231], v[120:123]
  ds_read_b64_tr_b16 v[248:249], v4 offset:24576
  v_mfma_f32_16x16x32_bf16 v[120:123], a[100:103], v[232:235], v[120:123]
  ds_read_b64_tr_b16 v[250:251], v4 offset:25088
  v_mfma_f32_16x16x32_bf16 v[120:123], a[116:119], v[236:239], v[120:123]
  v_permlane16_swap_b32 v64, v66
  v_mfma_f32_16x16x32_bf16 v[136:139], a[72:75], v[224:227], v[136:139]
  ds_read_b64_tr_b16 v[252:253], v4 offset:28672
  v_mfma_f32_16x16x32_bf16 v[136:139], a[88:91], v[228:231], v[136:139]
  ds_read_b64_tr_b16 v[254:255], v4 offset:29184
  v_mfma_f32_16x16x32_bf16 v[136:139], a[104:107], v[232:235], v[136:139]
  v_permlane16_swap_b32 v65, v67
  v_mfma_f32_16x16x32_bf16 v[136:139], a[120:123], v[236:239], v[136:139]
  v_cvt_pk_bf16_f32 v70, v84, v85
  v_cvt_pk_bf16_f32 v71, v86, v87
  v_mfma_f32_16x16x32_bf16 v[152:155], a[76:79], v[224:227], v[152:155]
  buffer_store_dwordx4 v[64:67], v17, s[48:51], s32 offen sc1
  v_mfma_f32_16x16x32_bf16 v[152:155], a[92:95], v[228:231], v[152:155]
  v_cvt_pk_bf16_f32 v72, v72, v73
  v_mfma_f32_16x16x32_bf16 v[152:155], a[108:111], v[232:235], v[152:155]
  v_mfma_f32_16x16x32_bf16 v[152:155], a[124:127], v[236:239], v[152:155]
  s_waitcnt vmcnt(18) lgkmcnt(0)
  s_barrier
  v_mfma_f32_16x16x32_bf16 v[108:111], a[64:67], v[240:243], v[108:111]
  ds_read_b64_tr_b16 v[224:225], v1 offset:32768
  s_add_u32 m0, s19, 16384
  v_mfma_f32_16x16x32_bf16 v[108:111], a[80:83], v[244:247], v[108:111]
  ds_read_b64_tr_b16 v[226:227], v1 offset:33280
  s_add_u32 s21, s22, 128
  v_mfma_f32_16x16x32_bf16 v[108:111], a[96:99], v[248:251], v[108:111]
  ds_read_b64_tr_b16 v[228:229], v1 offset:36864
  v_cvt_pk_bf16_f32 v73, v74, v75
  v_mfma_f32_16x16x32_bf16 v[108:111], a[112:115], v[252:255], v[108:111]
  buffer_load_dwordx4 v5, s[12:15], s21 offen offset:0 lds
  v_mfma_f32_16x16x32_bf16 v[124:127], a[68:71], v[240:243], v[124:127]
  ds_read_b64_tr_b16 v[230:231], v1 offset:37376
  v_mfma_f32_16x16x32_bf16 v[124:127], a[84:87], v[244:247], v[124:127]
  ds_read_b64_tr_b16 v[232:233], v1 offset:40960
  v_mfma_f32_16x16x32_bf16 v[124:127], a[100:103], v[248:251], v[124:127]
  ds_read_b64_tr_b16 v[234:235], v1 offset:41472
  v_mfma_f32_16x16x32_bf16 v[124:127], a[116:119], v[252:255], v[124:127]
  buffer_load_dwordx4 v6, s[12:15], s21 offen offset:1024 lds
  v_mfma_f32_16x16x32_bf16 v[140:143], a[72:75], v[240:243], v[140:143]
  ds_read_b64_tr_b16 v[236:237], v1 offset:45056
  v_mfma_f32_16x16x32_bf16 v[140:143], a[88:91], v[244:247], v[140:143]
  ds_read_b64_tr_b16 v[238:239], v1 offset:45568
  v_mfma_f32_16x16x32_bf16 v[140:143], a[104:107], v[248:251], v[140:143]
  v_permlane16_swap_b32 v68, v70
  v_mfma_f32_16x16x32_bf16 v[140:143], a[120:123], v[252:255], v[140:143]
  buffer_load_dwordx4 v7, s[12:15], s21 offen offset:2048 lds
  v_mfma_f32_16x16x32_bf16 v[156:159], a[76:79], v[240:243], v[156:159]
  v_permlane16_swap_b32 v69, v71
  v_mfma_f32_16x16x32_bf16 v[156:159], a[92:95], v[244:247], v[156:159]
  v_cvt_pk_bf16_f32 v74, v88, v89
  v_cvt_pk_bf16_f32 v75, v90, v91
  v_mfma_f32_16x16x32_bf16 v[156:159], a[108:111], v[248:251], v[156:159]
  buffer_store_dwordx4 v[68:71], v17, s[48:51], s33 offen sc1
  v_cvt_pk_bf16_f32 v76, v76, v77
  v_mfma_f32_16x16x32_bf16 v[156:159], a[124:127], v[252:255], v[156:159]
  buffer_load_dwordx4 v8, s[12:15], s21 offen offset:3072 lds
  s_waitcnt vmcnt(63) lgkmcnt(0)
  v_mfma_f32_16x16x32_bf16 v[96:99], a[128:131], v[224:227], v[96:99]
  ds_read_b64_tr_b16 v[240:241], v2 offset:32768
  v_cvt_pk_bf16_f32 v77, v78, v79
  v_mfma_f32_16x16x32_bf16 v[96:99], a[144:147], v[228:231], v[96:99]
  ds_read_b64_tr_b16 v[242:243], v2 offset:33280
  v_mfma_f32_16x16x32_bf16 v[96:99], a[160:163], v[232:235], v[96:99]
  ds_read_b64_tr_b16 v[244:245], v2 offset:36864
  v_mfma_f32_16x16x32_bf16 v[96:99], a[176:179], v[236:239], v[96:99]
  ds_read_b128 a[0:3], v15 offset:0
  v_mfma_f32_16x16x32_bf16 v[112:115], a[132:135], v[224:227], v[112:115]
  ds_read_b64_tr_b16 v[246:247], v2 offset:37376
  v_mfma_f32_16x16x32_bf16 v[112:115], a[148:151], v[228:231], v[112:115]
  ds_read_b64_tr_b16 v[248:249], v2 offset:40960
  v_mfma_f32_16x16x32_bf16 v[112:115], a[164:167], v[232:235], v[112:115]
  ds_read_b64_tr_b16 v[250:251], v2 offset:41472
  v_mfma_f32_16x16x32_bf16 v[112:115], a[180:183], v[236:239], v[112:115]
  ds_read_b128 a[16:19], v16 offset:0
  v_mfma_f32_16x16x32_bf16 v[128:131], a[136:139], v[224:227], v[128:131]
  ds_read_b64_tr_b16 v[252:253], v2 offset:45056
  v_mfma_f32_16x16x32_bf16 v[128:131], a[152:155], v[228:231], v[128:131]
  ds_read_b64_tr_b16 v[254:255], v2 offset:45568
  v_mfma_f32_16x16x32_bf16 v[128:131], a[168:171], v[232:235], v[128:131]
  ds_read_b128 a[4:7], v15 offset:2048
  v_mfma_f32_16x16x32_bf16 v[128:131], a[184:187], v[236:239], v[128:131]
  ds_read_b128 a[20:23], v16 offset:2048
  v_mfma_f32_16x16x32_bf16 v[144:147], a[140:143], v[224:227], v[144:147]
  ds_read_b128 a[8:11], v15 offset:4096
  v_mfma_f32_16x16x32_bf16 v[144:147], a[156:159], v[228:231], v[144:147]
  ds_read_b128 a[24:27], v16 offset:4096
  v_mfma_f32_16x16x32_bf16 v[144:147], a[172:175], v[232:235], v[144:147]
  ds_read_b128 a[12:15], v15 offset:6144
  v_mfma_f32_16x16x32_bf16 v[144:147], a[188:191], v[236:239], v[144:147]
  ds_read_b128 a[28:31], v16 offset:6144
  s_waitcnt lgkmcnt(4)
  v_mfma_f32_16x16x32_bf16 v[100:103], a[128:131], v[240:243], v[100:103]
  ds_read_b64_tr_b16 v[224:225], v3 offset:32768
  s_add_u32 m0, s20, -128
  v_mfma_f32_16x16x32_bf16 v[100:103], a[144:147], v[244:247], v[100:103]
  ds_read_b64_tr_b16 v[226:227], v3 offset:33280
  s_add_u32 s28, s25, s77
  v_mfma_f32_16x16x32_bf16 v[100:103], a[160:163], v[248:251], v[100:103]
  ds_read_b64_tr_b16 v[228:229], v3 offset:36864
  v_mfma_f32_16x16x32_bf16 v[100:103], a[176:179], v[252:255], v[100:103]
  buffer_load_dwordx4 v9, s[44:47], s28 offen offset:128 lds
  v_mfma_f32_16x16x32_bf16 v[116:119], a[132:135], v[240:243], v[116:119]
  ds_read_b64_tr_b16 v[230:231], v3 offset:37376
  v_mfma_f32_16x16x32_bf16 v[116:119], a[148:151], v[244:247], v[116:119]
  ds_read_b64_tr_b16 v[232:233], v3 offset:40960
  v_mfma_f32_16x16x32_bf16 v[116:119], a[164:167], v[248:251], v[116:119]
  ds_read_b64_tr_b16 v[234:235], v3 offset:41472
  v_mfma_f32_16x16x32_bf16 v[116:119], a[180:183], v[252:255], v[116:119]
  buffer_load_dwordx4 v10, s[44:47], s28 offen offset:1152 lds
  v_mfma_f32_16x16x32_bf16 v[132:135], a[136:139], v[240:243], v[132:135]
  ds_read_b64_tr_b16 v[236:237], v3 offset:45056
  v_mfma_f32_16x16x32_bf16 v[132:135], a[152:155], v[244:247], v[132:135]
  ds_read_b64_tr_b16 v[238:239], v3 offset:45568
  v_mfma_f32_16x16x32_bf16 v[132:135], a[168:171], v[248:251], v[132:135]
  v_permlane16_swap_b32 v72, v74
  v_mfma_f32_16x16x32_bf16 v[132:135], a[184:187], v[252:255], v[132:135]
  buffer_load_dwordx4 v11, s[44:47], s28 offen offset:2176 lds
  v_mfma_f32_16x16x32_bf16 v[148:151], a[140:143], v[240:243], v[148:151]
  v_permlane16_swap_b32 v73, v75
  v_mfma_f32_16x16x32_bf16 v[148:151], a[156:159], v[244:247], v[148:151]
  v_cvt_pk_bf16_f32 v78, v92, v93
  v_cvt_pk_bf16_f32 v79, v94, v95
  v_mfma_f32_16x16x32_bf16 v[148:151], a[172:175], v[248:251], v[148:151]
  buffer_store_dwordx4 v[72:75], v17, s[48:51], s34 offen sc1
  v_mfma_f32_16x16x32_bf16 v[148:151], a[188:191], v[252:255], v[148:151]
  buffer_load_dwordx4 v12, s[44:47], s28 offen offset:3200 lds
  s_waitcnt lgkmcnt(0)
  v_mfma_f32_16x16x32_bf16 v[104:107], a[128:131], v[224:227], v[104:107]
  ds_read_b64_tr_b16 v[240:241], v4 offset:32768
  s_add_u32 m0, s20, 3968
  v_mfma_f32_16x16x32_bf16 v[104:107], a[144:147], v[228:231], v[104:107]
  ds_read_b64_tr_b16 v[242:243], v4 offset:33280
  s_add_u32 s28, s26, s77
  v_mfma_f32_16x16x32_bf16 v[104:107], a[160:163], v[232:235], v[104:107]
  ds_read_b64_tr_b16 v[244:245], v4 offset:36864
  v_mfma_f32_16x16x32_bf16 v[104:107], a[176:179], v[236:239], v[104:107]
  buffer_load_dwordx4 v9, s[44:47], s28 offen offset:128 lds
  v_mfma_f32_16x16x32_bf16 v[120:123], a[132:135], v[224:227], v[120:123]
  ds_read_b64_tr_b16 v[246:247], v4 offset:37376
  v_mfma_f32_16x16x32_bf16 v[120:123], a[148:151], v[228:231], v[120:123]
  ds_read_b64_tr_b16 v[248:249], v4 offset:40960
  v_mfma_f32_16x16x32_bf16 v[120:123], a[164:167], v[232:235], v[120:123]
  ds_read_b64_tr_b16 v[250:251], v4 offset:41472
  v_mfma_f32_16x16x32_bf16 v[120:123], a[180:183], v[236:239], v[120:123]
  buffer_load_dwordx4 v10, s[44:47], s28 offen offset:1152 lds
  v_mfma_f32_16x16x32_bf16 v[136:139], a[136:139], v[224:227], v[136:139]
  ds_read_b64_tr_b16 v[252:253], v4 offset:45056
  v_mfma_f32_16x16x32_bf16 v[136:139], a[152:155], v[228:231], v[136:139]
  ds_read_b64_tr_b16 v[254:255], v4 offset:45568
  v_mfma_f32_16x16x32_bf16 v[136:139], a[168:171], v[232:235], v[136:139]
  s_nop 1
  v_mfma_f32_16x16x32_bf16 v[136:139], a[184:187], v[236:239], v[136:139]
  buffer_load_dwordx4 v11, s[44:47], s28 offen offset:2176 lds
  v_mfma_f32_16x16x32_bf16 v[152:155], a[140:143], v[224:227], v[152:155]
  v_permlane16_swap_b32 v76, v78
  v_mfma_f32_16x16x32_bf16 v[152:155], a[156:159], v[228:231], v[152:155]
  v_permlane16_swap_b32 v77, v79
  v_mfma_f32_16x16x32_bf16 v[152:155], a[172:175], v[232:235], v[152:155]
  buffer_store_dwordx4 v[76:79], v17, s[48:51], s35 offen sc1
  s_mov_b32 s50, 83886080
  v_mfma_f32_16x16x32_bf16 v[152:155], a[188:191], v[236:239], v[152:155]
  buffer_load_dwordx4 v12, s[44:47], s28 offen offset:3200 lds
  s_waitcnt vmcnt(26) lgkmcnt(0)
  s_barrier
  v_mfma_f32_16x16x32_bf16 v[108:111], a[128:131], v[240:243], v[108:111]
  ds_read_b64_tr_b16 v[224:225], v1 offset:49152
  s_add_u32 m0, s19, 32768
  v_mfma_f32_16x16x32_bf16 v[108:111], a[144:147], v[244:247], v[108:111]
  ds_read_b64_tr_b16 v[226:227], v1 offset:49664
  s_add_u32 s21, s23, 0
  v_mfma_f32_16x16x32_bf16 v[108:111], a[160:163], v[248:251], v[108:111]
  ds_read_b64_tr_b16 v[228:229], v1 offset:53248
  v_mfma_f32_16x16x32_bf16 v[108:111], a[176:179], v[252:255], v[108:111]
  buffer_load_dwordx4 v5, s[12:15], s21 offen offset:0 lds
  v_mfma_f32_16x16x32_bf16 v[124:127], a[132:135], v[240:243], v[124:127]
  ds_read_b64_tr_b16 v[230:231], v1 offset:53760
  v_mfma_f32_16x16x32_bf16 v[124:127], a[148:151], v[244:247], v[124:127]
  ds_read_b64_tr_b16 v[232:233], v1 offset:57344
  v_mfma_f32_16x16x32_bf16 v[124:127], a[164:167], v[248:251], v[124:127]
  ds_read_b64_tr_b16 v[234:235], v1 offset:57856
  v_mfma_f32_16x16x32_bf16 v[124:127], a[180:183], v[252:255], v[124:127]
  buffer_load_dwordx4 v6, s[12:15], s21 offen offset:1024 lds
  v_mfma_f32_16x16x32_bf16 v[140:143], a[136:139], v[240:243], v[140:143]
  ds_read_b64_tr_b16 v[236:237], v1 offset:61440
  v_mfma_f32_16x16x32_bf16 v[140:143], a[152:155], v[244:247], v[140:143]
  ds_read_b64_tr_b16 v[238:239], v1 offset:61952
  v_mfma_f32_16x16x32_bf16 v[140:143], a[168:171], v[248:251], v[140:143]
  v_mfma_f32_16x16x32_bf16 v[140:143], a[184:187], v[252:255], v[140:143]
  buffer_load_dwordx4 v7, s[12:15], s21 offen offset:2048 lds
  v_mfma_f32_16x16x32_bf16 v[156:159], a[140:143], v[240:243], v[156:159]
  v_mfma_f32_16x16x32_bf16 v[156:159], a[156:159], v[244:247], v[156:159]
  v_mfma_f32_16x16x32_bf16 v[156:159], a[172:175], v[248:251], v[156:159]
  v_mfma_f32_16x16x32_bf16 v[156:159], a[188:191], v[252:255], v[156:159]
  buffer_load_dwordx4 v8, s[12:15], s21 offen offset:3072 lds
  s_waitcnt vmcnt(63) lgkmcnt(0)
  v_mfma_f32_16x16x32_bf16 v[96:99], a[192:195], v[224:227], v[96:99]
  ds_read_b64_tr_b16 v[240:241], v2 offset:49152
  v_mfma_f32_16x16x32_bf16 v[96:99], a[208:211], v[228:231], v[96:99]
  ds_read_b64_tr_b16 v[242:243], v2 offset:49664
  v_mfma_f32_16x16x32_bf16 v[96:99], a[224:227], v[232:235], v[96:99]
  ds_read_b64_tr_b16 v[244:245], v2 offset:53248
  v_mfma_f32_16x16x32_bf16 v[96:99], a[240:243], v[236:239], v[96:99]
  ds_read_b128 a[32:35], v15 offset:8192
  v_mfma_f32_16x16x32_bf16 v[112:115], a[196:199], v[224:227], v[112:115]
  ds_read_b64_tr_b16 v[246:247], v2 offset:53760
  v_mfma_f32_16x16x32_bf16 v[112:115], a[212:215], v[228:231], v[112:115]
  ds_read_b64_tr_b16 v[248:249], v2 offset:57344
  v_mfma_f32_16x16x32_bf16 v[112:115], a[228:231], v[232:235], v[112:115]
  ds_read_b64_tr_b16 v[250:251], v2 offset:57856
  v_mfma_f32_16x16x32_bf16 v[112:115], a[244:247], v[236:239], v[112:115]
  ds_read_b128 a[48:51], v16 offset:8192
  v_mfma_f32_16x16x32_bf16 v[128:131], a[200:203], v[224:227], v[128:131]
  ds_read_b64_tr_b16 v[252:253], v2 offset:61440
  v_mfma_f32_16x16x32_bf16 v[128:131], a[216:219], v[228:231], v[128:131]
  ds_read_b64_tr_b16 v[254:255], v2 offset:61952
  v_mfma_f32_16x16x32_bf16 v[128:131], a[232:235], v[232:235], v[128:131]
  ds_read_b128 a[36:39], v15 offset:10240
  v_mfma_f32_16x16x32_bf16 v[128:131], a[248:251], v[236:239], v[128:131]
  ds_read_b128 a[52:55], v16 offset:10240
  v_mfma_f32_16x16x32_bf16 v[144:147], a[204:207], v[224:227], v[144:147]
  ds_read_b128 a[40:43], v15 offset:12288
  v_mfma_f32_16x16x32_bf16 v[144:147], a[220:223], v[228:231], v[144:147]
  ds_read_b128 a[56:59], v16 offset:12288
  v_mfma_f32_16x16x32_bf16 v[144:147], a[236:239], v[232:235], v[144:147]
  ds_read_b128 a[44:47], v15 offset:14336
  v_mfma_f32_16x16x32_bf16 v[144:147], a[252:255], v[236:239], v[144:147]
  ds_read_b128 a[60:63], v16 offset:14336
  s_waitcnt lgkmcnt(4)
  v_mfma_f32_16x16x32_bf16 v[100:103], a[192:195], v[240:243], v[100:103]
  ds_read_b64_tr_b16 v[224:225], v3 offset:49152
  s_add_u32 m0, s20, 8192
  v_mfma_f32_16x16x32_bf16 v[100:103], a[208:211], v[244:247], v[100:103]
  ds_read_b64_tr_b16 v[226:227], v3 offset:49664
  s_add_u32 s28, s25, s78
  v_mfma_f32_16x16x32_bf16 v[100:103], a[224:227], v[248:251], v[100:103]
  ds_read_b64_tr_b16 v[228:229], v3 offset:53248
  v_mfma_f32_16x16x32_bf16 v[100:103], a[240:243], v[252:255], v[100:103]
  buffer_load_dwordx4 v9, s[44:47], s28 offen offset:0 lds
  v_mfma_f32_16x16x32_bf16 v[116:119], a[196:199], v[240:243], v[116:119]
  ds_read_b64_tr_b16 v[230:231], v3 offset:53760
  v_mfma_f32_16x16x32_bf16 v[116:119], a[212:215], v[244:247], v[116:119]
  ds_read_b64_tr_b16 v[232:233], v3 offset:57344
  v_mfma_f32_16x16x32_bf16 v[116:119], a[228:231], v[248:251], v[116:119]
  ds_read_b64_tr_b16 v[234:235], v3 offset:57856
  v_mfma_f32_16x16x32_bf16 v[116:119], a[244:247], v[252:255], v[116:119]
  buffer_load_dwordx4 v10, s[44:47], s28 offen offset:1024 lds
  v_mfma_f32_16x16x32_bf16 v[132:135], a[200:203], v[240:243], v[132:135]
  ds_read_b64_tr_b16 v[236:237], v3 offset:61440
  v_mfma_f32_16x16x32_bf16 v[132:135], a[216:219], v[244:247], v[132:135]
  ds_read_b64_tr_b16 v[238:239], v3 offset:61952
  v_mfma_f32_16x16x32_bf16 v[132:135], a[232:235], v[248:251], v[132:135]
  v_mfma_f32_16x16x32_bf16 v[132:135], a[248:251], v[252:255], v[132:135]
  buffer_load_dwordx4 v11, s[44:47], s28 offen offset:2048 lds
  v_mfma_f32_16x16x32_bf16 v[148:151], a[204:207], v[240:243], v[148:151]
  v_mfma_f32_16x16x32_bf16 v[148:151], a[220:223], v[244:247], v[148:151]
  v_mfma_f32_16x16x32_bf16 v[148:151], a[236:239], v[248:251], v[148:151]
  v_mfma_f32_16x16x32_bf16 v[148:151], a[252:255], v[252:255], v[148:151]
  buffer_load_dwordx4 v12, s[44:47], s28 offen offset:3072 lds
  s_waitcnt lgkmcnt(0)
  v_mfma_f32_16x16x32_bf16 v[104:107], a[192:195], v[224:227], v[104:107]
  ds_read_b64_tr_b16 v[240:241], v4 offset:49152
  s_add_u32 m0, s20, 12288
  v_mfma_f32_16x16x32_bf16 v[104:107], a[208:211], v[228:231], v[104:107]
  ds_read_b64_tr_b16 v[242:243], v4 offset:49664
  s_add_u32 s28, s26, s78
  v_mfma_f32_16x16x32_bf16 v[104:107], a[224:227], v[232:235], v[104:107]
  ds_read_b64_tr_b16 v[244:245], v4 offset:53248
  v_mfma_f32_16x16x32_bf16 v[104:107], a[240:243], v[236:239], v[104:107]
  buffer_load_dwordx4 v9, s[44:47], s28 offen offset:0 lds
  v_mfma_f32_16x16x32_bf16 v[120:123], a[196:199], v[224:227], v[120:123]
  ds_read_b64_tr_b16 v[246:247], v4 offset:53760
  v_mfma_f32_16x16x32_bf16 v[120:123], a[212:215], v[228:231], v[120:123]
  ds_read_b64_tr_b16 v[248:249], v4 offset:57344
  v_mfma_f32_16x16x32_bf16 v[120:123], a[228:231], v[232:235], v[120:123]
  ds_read_b64_tr_b16 v[250:251], v4 offset:57856
  v_mfma_f32_16x16x32_bf16 v[120:123], a[244:247], v[236:239], v[120:123]
  buffer_load_dwordx4 v10, s[44:47], s28 offen offset:1024 lds
  v_mfma_f32_16x16x32_bf16 v[136:139], a[200:203], v[224:227], v[136:139]
  ds_read_b64_tr_b16 v[252:253], v4 offset:61440
  v_mfma_f32_16x16x32_bf16 v[136:139], a[216:219], v[228:231], v[136:139]
  ds_read_b64_tr_b16 v[254:255], v4 offset:61952
  v_mfma_f32_16x16x32_bf16 v[136:139], a[232:235], v[232:235], v[136:139]
  v_mfma_f32_16x16x32_bf16 v[136:139], a[248:251], v[236:239], v[136:139]
  buffer_load_dwordx4 v11, s[44:47], s28 offen offset:2048 lds
  v_mfma_f32_16x16x32_bf16 v[152:155], a[204:207], v[224:227], v[152:155]
  v_mfma_f32_16x16x32_bf16 v[152:155], a[220:223], v[228:231], v[152:155]
  v_mfma_f32_16x16x32_bf16 v[152:155], a[236:239], v[232:235], v[152:155]
  v_mfma_f32_16x16x32_bf16 v[152:155], a[252:255], v[236:239], v[152:155]
  buffer_load_dwordx4 v12, s[44:47], s28 offen offset:3072 lds
  s_waitcnt vmcnt(31) lgkmcnt(0)
  s_barrier
  v_mfma_f32_16x16x32_bf16 v[108:111], a[192:195], v[240:243], v[108:111]
  ds_read_b64_tr_b16 v[224:225], v1 offset:0
  s_add_u32 m0, s19, 49152
  v_mfma_f32_16x16x32_bf16 v[108:111], a[208:211], v[244:247], v[108:111]
  ds_read_b64_tr_b16 v[226:227], v1 offset:512
  s_add_u32 s21, s23, 128
  v_mfma_f32_16x16x32_bf16 v[108:111], a[224:227], v[248:251], v[108:111]
  ds_read_b64_tr_b16 v[228:229], v1 offset:4096
  v_mfma_f32_16x16x32_bf16 v[108:111], a[240:243], v[252:255], v[108:111]
  buffer_load_dwordx4 v5, s[12:15], s21 offen offset:0 lds
  v_mfma_f32_16x16x32_bf16 v[124:127], a[196:199], v[240:243], v[124:127]
  ds_read_b64_tr_b16 v[230:231], v1 offset:4608
  v_mfma_f32_16x16x32_bf16 v[124:127], a[212:215], v[244:247], v[124:127]
  ds_read_b64_tr_b16 v[232:233], v1 offset:8192
  v_mfma_f32_16x16x32_bf16 v[124:127], a[228:231], v[248:251], v[124:127]
  ds_read_b64_tr_b16 v[234:235], v1 offset:8704
  v_mfma_f32_16x16x32_bf16 v[124:127], a[244:247], v[252:255], v[124:127]
  buffer_load_dwordx4 v6, s[12:15], s21 offen offset:1024 lds
  v_mfma_f32_16x16x32_bf16 v[140:143], a[200:203], v[240:243], v[140:143]
  ds_read_b64_tr_b16 v[236:237], v1 offset:12288
  v_mfma_f32_16x16x32_bf16 v[140:143], a[216:219], v[244:247], v[140:143]
  ds_read_b64_tr_b16 v[238:239], v1 offset:12800
  v_mfma_f32_16x16x32_bf16 v[140:143], a[232:235], v[248:251], v[140:143]
  v_mfma_f32_16x16x32_bf16 v[140:143], a[248:251], v[252:255], v[140:143]
  buffer_load_dwordx4 v7, s[12:15], s21 offen offset:2048 lds
  v_mfma_f32_16x16x32_bf16 v[156:159], a[204:207], v[240:243], v[156:159]
  v_mfma_f32_16x16x32_bf16 v[156:159], a[220:223], v[244:247], v[156:159]
  v_mfma_f32_16x16x32_bf16 v[156:159], a[236:239], v[248:251], v[156:159]
  v_mfma_f32_16x16x32_bf16 v[156:159], a[252:255], v[252:255], v[156:159]
  buffer_load_dwordx4 v8, s[12:15], s21 offen offset:3072 lds
  s_branch P2
P1_SK0:
  s_nop 7
  s_bitcmp1_b32 s61, 1
  s_cbranch_scc0 P1_NG0
  v_lshrrev_b32 v27, 4, v20
  v_lshlrev_b32 v28, 4, v27
  s_add_u32 s100, s3, 256
  s_cmp_eq_u32 s100, 1024
  s_cselect_b32 s100, 256, s100
  s_add_u32 s101, s100, 256
  s_cmp_eq_u32 s101, 1024
  s_cselect_b32 s101, 256, s101
  buffer_load_dwordx4 v[32:35], v28, s[72:75], 0 offen offset:0
  buffer_load_dwordx4 v[36:39], v28, s[72:75], 0 offen offset:64
  buffer_load_dwordx4 v[40:43], v28, s[72:75], 0 offen offset:128
  buffer_load_dwordx4 v[44:47], v28, s[72:75], 0 offen offset:192
  buffer_load_dwordx4 v[48:51], v28, s[72:75], s3 offen offset:0
  buffer_load_dwordx4 v[52:55], v28, s[72:75], s3 offen offset:64
  buffer_load_dwordx4 v[56:59], v28, s[72:75], s3 offen offset:128
  buffer_load_dwordx4 v[60:63], v28, s[72:75], s3 offen offset:192
  buffer_load_dwordx4 v[64:67], v28, s[72:75], s100 offen offset:0
  buffer_load_dwordx4 v[68:71], v28, s[72:75], s100 offen offset:64
  buffer_load_dwordx4 v[72:75], v28, s[72:75], s100 offen offset:128
  buffer_load_dwordx4 v[76:79], v28, s[72:75], s100 offen offset:192
  buffer_load_dwordx4 v[80:83], v28, s[72:75], s101 offen offset:0
  buffer_load_dwordx4 v[84:87], v28, s[72:75], s101 offen offset:64
  buffer_load_dwordx4 v[88:91], v28, s[72:75], s101 offen offset:128
  buffer_load_dwordx4 v[92:95], v28, s[72:75], s101 offen offset:192
P1_NG0:
  s_lshr_b32 s29, s27, 1
  s_mul_i32 s32, s29, s70
  s_and_b32 s29, s27, 1
  s_mul_i32 s29, s29, s71
  s_add_u32 s32, s32, s29
  s_add_u32 s32, s32, s36
  s_add_u32 s27, s27, 1
  s_add_u32 s33, s32, s67
  s_add_u32 s34, s32, s66
  s_add_u32 s35, s34, s67
  v_mul_f32 v96, s68, v96
  v_mul_f32 v97, s68, v97
  v_mul_f32 v98, s68, v98
  v_mul_f32 v99, s68, v99
  v_mul_f32 v112, s68, v112
  v_mul_f32 v113, s68, v113
  v_mul_f32 v114, s68, v114
  v_mul_f32 v115, s68, v115
  v_cvt_pk_bf16_f32 v96, v96, v97
  v_cvt_pk_bf16_f32 v97, v98, v99
  v_cvt_pk_bf16_f32 v98, v112, v113
  v_cvt_pk_bf16_f32 v99, v114, v115
  v_mul_f32 v100, s68, v100
  v_mul_f32 v101, s68, v101
  v_mul_f32 v102, s68, v102
  v_mul_f32 v103, s68, v103
  v_mul_f32 v116, s68, v116
  v_mul_f32 v117, s68, v117
  v_mul_f32 v118, s68, v118
  v_mul_f32 v119, s68, v119
  v_cvt_pk_bf16_f32 v100, v100, v101
  v_cvt_pk_bf16_f32 v101, v102, v103
  v_permlane16_swap_b32 v96, v98
  v_permlane16_swap_b32 v97, v99
  v_cvt_pk_bf16_f32 v102, v116, v117
  v_cvt_pk_bf16_f32 v103, v118, v119
  buffer_store_dwordx4 v[96:99], v17, s[48:51], s32 offen sc1
  s_add_u32 s32, s32, s65
  v_mul_f32 v104, s68, v104
  v_mul_f32 v105, s68, v105
  v_mul_f32 v106, s68, v106
  v_mul_f32 v107, s68, v107
  v_mul_f32 v120, s68, v120
  v_mul_f32 v121, s68, v121
  v_mul_f32 v122, s68, v122
  v_mul_f32 v123, s68, v123
  v_cvt_pk_bf16_f32 v104, v104, v105
  v_cvt_pk_bf16_f32 v105, v106, v107
  v_permlane16_swap_b32 v100, v102
  v_permlane16_swap_b32 v101, v103
  v_cvt_pk_bf16_f32 v106, v120, v121
  v_cvt_pk_bf16_f32 v107, v122, v123
  buffer_store_dwordx4 v[100:103], v17, s[48:51], s33 offen sc1
  s_add_u32 s33, s33, s65
  v_mul_f32 v108, s68, v108
  v_mul_f32 v109, s68, v109
  v_mul_f32 v110, s68, v110
  v_mul_f32 v111, s68, v111
  v_mul_f32 v124, s68, v124
  v_mul_f32 v125, s68, v125
  v_mul_f32 v126, s68, v126
  v_mul_f32 v127, s68, v127
  v_cvt_pk_bf16_f32 v108, v108, v109
  v_cvt_pk_bf16_f32 v109, v110, v111
  v_permlane16_swap_b32 v104, v106
  v_permlane16_swap_b32 v105, v107
  v_cvt_pk_bf16_f32 v110, v124, v125
  v_cvt_pk_bf16_f32 v111, v126, v127
  buffer_store_dwordx4 v[104:107], v17, s[48:51], s34 offen sc1
  s_add_u32 s34, s34, s65
  v_mul_f32 v128, s68, v128
  v_mul_f32 v129, s68, v129
  v_mul_f32 v130, s68, v130
  v_mul_f32 v131, s68, v131
  v_mul_f32 v144, s68, v144
  v_mul_f32 v145, s68, v145
  v_mul_f32 v146, s68, v146
  v_mul_f32 v147, s68, v147
  v_cvt_pk_bf16_f32 v128, v128, v129
  v_cvt_pk_bf16_f32 v129, v130, v131
  v_permlane16_swap_b32 v108, v110
  v_permlane16_swap_b32 v109, v111
  v_cvt_pk_bf16_f32 v130, v144, v145
  v_cvt_pk_bf16_f32 v131, v146, v147
  buffer_store_dwordx4 v[108:111], v17, s[48:51], s35 offen sc1
  s_add_u32 s35, s35, s65
  v_mul_f32 v132, s68, v132
  v_mul_f32 v133, s68, v133
  v_mul_f32 v134, s68, v134
  v_mul_f32 v135, s68, v135
  v_mul_f32 v148, s68, v148
  v_mul_f32 v149, s68, v149
  v_mul_f32 v150, s68, v150
  v_mul_f32 v151, s68, v151
  v_cvt_pk_bf16_f32 v132, v132, v133
  v_cvt_pk_bf16_f32 v133, v134, v135
  v_permlane16_swap_b32 v128, v130
  v_permlane16_swap_b32 v129, v131
  v_cvt_pk_bf16_f32 v134, v148, v149
  v_cvt_pk_bf16_f32 v135, v150, v151
  buffer_store_dwordx4 v[128:131], v17, s[48:51], s32 offen sc1
  v_mul_f32 v136, s68, v136
  v_mul_f32 v137, s68, v137
  v_mul_f32 v138, s68, v138
  v_mul_f32 v139, s68, v139
  v_mul_f32 v152, s68, v152
  v_mul_f32 v153, s68, v153
  v_mul_f32 v154, s68, v154
  v_mul_f32 v155, s68, v155
  v_cvt_pk_bf16_f32 v136, v136, v137
  v_cvt_pk_bf16_f32 v137, v138, v139
  v_permlane16_swap_b32 v132, v134
  v_permlane16_swap_b32 v133, v135
  v_cvt_pk_bf16_f32 v138, v152, v153
  v_cvt_pk_bf16_f32 v139, v154, v155
  buffer_store_dwordx4 v[132:135], v17, s[48:51], s33 offen sc1
  v_mul_f32 v140, s68, v140
  v_mul_f32 v141, s68, v141
  v_mul_f32 v142, s68, v142
  v_mul_f32 v143, s68, v143
  v_mul_f32 v156, s68, v156
  v_mul_f32 v157, s68, v157
  v_mul_f32 v158, s68, v158
  v_mul_f32 v159, s68, v159
  v_cvt_pk_bf16_f32 v140, v140, v141
  v_cvt_pk_bf16_f32 v141, v142, v143
  v_permlane16_swap_b32 v136, v138
  v_permlane16_swap_b32 v137, v139
  v_cvt_pk_bf16_f32 v142, v156, v157
  v_cvt_pk_bf16_f32 v143, v158, v159
  buffer_store_dwordx4 v[136:139], v17, s[48:51], s34 offen sc1
  s_nop 1
  v_permlane16_swap_b32 v140, v142
  v_permlane16_swap_b32 v141, v143
  buffer_store_dwordx4 v[140:143], v17, s[48:51], s35 offen sc1
  s_bitcmp1_b32 s61, 1
  s_cbranch_scc0 P1_NG
  s_waitcnt vmcnt(8)
  v_mfma_f32_16x16x32_bf16 v[240:243], v[32:35], a[0:3], 0
  v_mfma_f32_16x16x32_bf16 v[240:243], v[36:39], a[16:19], v[240:243]
  v_mfma_f32_16x16x32_bf16 v[240:243], v[40:43], a[32:35], v[240:243]
  v_mfma_f32_16x16x32_bf16 v[240:243], v[44:47], a[48:51], v[240:243]
  v_mfma_f32_16x16x32_bf16 v[240:243], v[48:51], a[64:67], v[240:243]
  v_mfma_f32_16x16x32_bf16 v[240:243], v[52:55], a[80:83], v[240:243]
  v_mfma_f32_16x16x32_bf16 v[240:243], v[56:59], a[96:99], v[240:243]
  v_mfma_f32_16x16x32_bf16 v[240:243], v[60:63], a[112:115], v[240:243]
  v_mfma_f32_16x16x32_bf16 v[240:243], v[64:67], a[128:131], v[240:243]
  v_mfma_f32_16x16x32_bf16 v[240:243], v[68:71], a[144:147], v[240:243]
  v_mfma_f32_16x16x32_bf16 v[240:243], v[72:75], a[160:163], v[240:243]
  v_mfma_f32_16x16x32_bf16 v[240:243], v[76:79], a[176:179], v[240:243]
  v_mfma_f32_16x16x32_bf16 v[240:243], v[80:83], a[192:195], v[240:243]
  v_mfma_f32_16x16x32_bf16 v[240:243], v[84:87], a[208:211], v[240:243]
  v_mfma_f32_16x16x32_bf16 v[240:243], v[88:91], a[224:227], v[240:243]
  v_mfma_f32_16x16x32_bf16 v[240:243], v[92:95], a[240:243], v[240:243]
  v_mfma_f32_16x16x32_bf16 v[244:247], v[32:35], a[4:7], 0
  v_mfma_f32_16x16x32_bf16 v[244:247], v[36:39], a[20:23], v[244:247]
  v_mfma_f32_16x16x32_bf16 v[244:247], v[40:43], a[36:39], v[244:247]
  v_mfma_f32_16x16x32_bf16 v[244:247], v[44:47], a[52:55], v[244:247]
  v_mfma_f32_16x16x32_bf16 v[244:247], v[48:51], a[68:71], v[244:247]
  v_mfma_f32_16x16x32_bf16 v[244:247], v[52:55], a[84:87], v[244:247]
  v_mfma_f32_16x16x32_bf16 v[244:247], v[56:59], a[100:103], v[244:247]
  v_mfma_f32_16x16x32_bf16 v[244:247], v[60:63], a[116:119], v[244:247]
  v_mfma_f32_16x16x32_bf16 v[244:247], v[64:67], a[132:135], v[244:247]
  v_mfma_f32_16x16x32_bf16 v[244:247], v[68:71], a[148:151], v[244:247]
  v_mfma_f32_16x16x32_bf16 v[244:247], v[72:75], a[164:167], v[244:247]
  v_mfma_f32_16x16x32_bf16 v[244:247], v[76:79], a[180:183], v[244:247]
  v_mfma_f32_16x16x32_bf16 v[244:247], v[80:83], a[196:199], v[244:247]
  v_mfma_f32_16x16x32_bf16 v[244:247], v[84:87], a[212:215], v[244:247]
  v_mfma_f32_16x16x32_bf16 v[244:247], v[88:91], a[228:231], v[244:247]
  v_mfma_f32_16x16x32_bf16 v[244:247], v[92:95], a[244:247], v[244:247]
  v_mfma_f32_16x16x32_bf16 v[248:251], v[32:35], a[8:11], 0
  v_mfma_f32_16x16x32_bf16 v[248:251], v[36:39], a[24:27], v[248:251]
  v_mfma_f32_16x16x32_bf16 v[248:251], v[40:43], a[40:43], v[248:251]
  v_mfma_f32_16x16x32_bf16 v[248:251], v[44:47], a[56:59], v[248:251]
  v_mfma_f32_16x16x32_bf16 v[248:251], v[48:51], a[72:75], v[248:251]
  v_mfma_f32_16x16x32_bf16 v[248:251], v[52:55], a[88:91], v[248:251]
  v_mfma_f32_16x16x32_bf16 v[248:251], v[56:59], a[104:107], v[248:251]
  v_mfma_f32_16x16x32_bf16 v[248:251], v[60:63], a[120:123], v[248:251]
  v_mfma_f32_16x16x32_bf16 v[248:251], v[64:67], a[136:139], v[248:251]
  v_mfma_f32_16x16x32_bf16 v[248:251], v[68:71], a[152:155], v[248:251]
  v_mfma_f32_16x16x32_bf16 v[248:251], v[72:75], a[168:171], v[248:251]
  v_mfma_f32_16x16x32_bf16 v[248:251], v[76:79], a[184:187], v[248:251]
  v_mfma_f32_16x16x32_bf16 v[248:251], v[80:83], a[200:203], v[248:251]
  v_mfma_f32_16x16x32_bf16 v[248:251], v[84:87], a[216:219], v[248:251]
  v_mfma_f32_16x16x32_bf16 v[248:251], v[88:91], a[232:235], v[248:251]
  v_mfma_f32_16x16x32_bf16 v[248:251], v[92:95], a[248:251], v[248:251]
  v_mfma_f32_16x16x32_bf16 v[252:255], v[32:35], a[12:15], 0
  v_mfma_f32_16x16x32_bf16 v[252:255], v[36:39], a[28:31], v[252:255]
  v_mfma_f32_16x16x32_bf16 v[252:255], v[40:43], a[44:47], v[252:255]
  v_mfma_f32_16x16x32_bf16 v[252:255], v[44:47], a[60:63], v[252:255]
  v_mfma_f32_16x16x32_bf16 v[252:255], v[48:51], a[76:79], v[252:255]
  v_mfma_f32_16x16x32_bf16 v[252:255], v[52:55], a[92:95], v[252:255]
  v_mfma_f32_16x16x32_bf16 v[252:255], v[56:59], a[108:111], v[252:255]
  v_mfma_f32_16x16x32_bf16 v[252:255], v[60:63], a[124:127], v[252:255]
  v_mfma_f32_16x16x32_bf16 v[252:255], v[64:67], a[140:143], v[252:255]
  v_mfma_f32_16x16x32_bf16 v[252:255], v[68:71], a[156:159], v[252:255]
  v_mfma_f32_16x16x32_bf16 v[252:255], v[72:75], a[172:175], v[252:255]
  v_mfma_f32_16x16x32_bf16 v[252:255], v[76:79], a[188:191], v[252:255]
  v_mfma_f32_16x16x32_bf16 v[252:255], v[80:83], a[204:207], v[252:255]
  v_mfma_f32_16x16x32_bf16 v[252:255], v[84:87], a[220:223], v[252:255]
  v_mfma_f32_16x16x32_bf16 v[252:255], v[88:91], a[236:239], v[252:255]
  v_mfma_f32_16x16x32_bf16 v[252:255], v[92:95], a[252:255], v[252:255]
  s_nop 7
  v_cmp_eq_u32 vcc, 1, v27
  s_nop 1
  v_cndmask_b32 v240, v240, v244, vcc
  v_cmp_eq_u32 vcc, 2, v27
  s_nop 1
  v_cndmask_b32 v240, v240, v248, vcc
  v_cmp_eq_u32 vcc, 3, v27
  s_nop 1
  v_cndmask_b32 v240, v240, v252, vcc
  v_mul_f32 v240, 0xbfb8aa3b, v240
  v_exp_f32 v240, v240
  s_nop 0
  v_add_f32 v240, 1.0, v240
  v_rcp_f32 v240, v240
  v_lshrrev_b32 v28, 2, v21
  v_lshl_add_u32 v28, v27, 6, v28
  s_lshl_b32 s28, s30, 7
  s_add_u32 s28, s28, 56623104
  buffer_store_dword v240, v28, s[8:11], s28 offen sc1
  s_nop 1
P1_NG:
  s_lshr_b32 s29, s27, 1
  s_mul_i32 s32, s29, s70
  s_and_b32 s29, s27, 1
  s_mul_i32 s29, s29, s71
  s_add_u32 s32, s32, s29
  s_add_u32 s32, s32, s36
  s_add_u32 s27, s27, 1
  s_add_u32 s33, s32, s67
  s_add_u32 s34, s32, s66
  s_add_u32 s35, s34, s67
  v_mul_f32 v160, s68, v160
  v_mul_f32 v161, s68, v161
  v_mul_f32 v162, s68, v162
  v_mul_f32 v163, s68, v163
  v_mul_f32 v176, s68, v176
  v_mul_f32 v177, s68, v177
  v_mul_f32 v178, s68, v178
  v_mul_f32 v179, s68, v179
  v_cvt_pk_bf16_f32 v160, v160, v161
  v_cvt_pk_bf16_f32 v161, v162, v163
  v_cvt_pk_bf16_f32 v162, v176, v177
  v_cvt_pk_bf16_f32 v163, v178, v179
  v_mul_f32 v164, s68, v164
  v_mul_f32 v165, s68, v165
  v_mul_f32 v166, s68, v166
  v_mul_f32 v167, s68, v167
  v_mul_f32 v180, s68, v180
  v_mul_f32 v181, s68, v181
  v_mul_f32 v182, s68, v182
  v_mul_f32 v183, s68, v183
  v_cvt_pk_bf16_f32 v164, v164, v165
  v_cvt_pk_bf16_f32 v165, v166, v167
  v_permlane16_swap_b32 v160, v162
  v_permlane16_swap_b32 v161, v163
  v_cvt_pk_bf16_f32 v166, v180, v181
  v_cvt_pk_bf16_f32 v167, v182, v183
  buffer_store_dwordx4 v[160:163], v17, s[48:51], s32 offen sc1
  s_add_u32 s32, s32, s65
  v_mul_f32 v168, s68, v168
  v_mul_f32 v169, s68, v169
  v_mul_f32 v170, s68, v170
  v_mul_f32 v171, s68, v171
  v_mul_f32 v184, s68, v184
  v_mul_f32 v185, s68, v185
  v_mul_f32 v186, s68, v186
  v_mul_f32 v187, s68, v187
  v_cvt_pk_bf16_f32 v168, v168, v169
  v_cvt_pk_bf16_f32 v169, v170, v171
  v_permlane16_swap_b32 v164, v166
  v_permlane16_swap_b32 v165, v167
  v_cvt_pk_bf16_f32 v170, v184, v185
  v_cvt_pk_bf16_f32 v171, v186, v187
  buffer_store_dwordx4 v[164:167], v17, s[48:51], s33 offen sc1
  s_add_u32 s33, s33, s65
  v_mul_f32 v172, s68, v172
  v_mul_f32 v173, s68, v173
  v_mul_f32 v174, s68, v174
  v_mul_f32 v175, s68, v175
  v_mul_f32 v188, s68, v188
  v_mul_f32 v189, s68, v189
  v_mul_f32 v190, s68, v190
  v_mul_f32 v191, s68, v191
  v_cvt_pk_bf16_f32 v172, v172, v173
  v_cvt_pk_bf16_f32 v173, v174, v175
  v_permlane16_swap_b32 v168, v170
  v_permlane16_swap_b32 v169, v171
  v_cvt_pk_bf16_f32 v174, v188, v189
  v_cvt_pk_bf16_f32 v175, v190, v191
  buffer_store_dwordx4 v[168:171], v17, s[48:51], s34 offen sc1
  s_add_u32 s34, s34, s65
  v_mul_f32 v192, s68, v192
  v_mul_f32 v193, s68, v193
  v_mul_f32 v194, s68, v194
  v_mul_f32 v195, s68, v195
  v_mul_f32 v208, s68, v208
  v_mul_f32 v209, s68, v209
  v_mul_f32 v210, s68, v210
  v_mul_f32 v211, s68, v211
  v_cvt_pk_bf16_f32 v192, v192, v193
  v_cvt_pk_bf16_f32 v193, v194, v195
  v_permlane16_swap_b32 v172, v174
  v_permlane16_swap_b32 v173, v175
  v_cvt_pk_bf16_f32 v194, v208, v209
  v_cvt_pk_bf16_f32 v195, v210, v211
  buffer_store_dwordx4 v[172:175], v17, s[48:51], s35 offen sc1
  s_add_u32 s35, s35, s65
  v_mul_f32 v196, s68, v196
  v_mul_f32 v197, s68, v197
  v_mul_f32 v198, s68, v198
  v_mul_f32 v199, s68, v199
  v_mul_f32 v212, s68, v212
  v_mul_f32 v213, s68, v213
  v_mul_f32 v214, s68, v214
  v_mul_f32 v215, s68, v215
  v_cvt_pk_bf16_f32 v196, v196, v197
  v_cvt_pk_bf16_f32 v197, v198, v199
  v_permlane16_swap_b32 v192, v194
  v_permlane16_swap_b32 v193, v195
  v_cvt_pk_bf16_f32 v198, v212, v213
  v_cvt_pk_bf16_f32 v199, v214, v215
  buffer_store_dwordx4 v[192:195], v17, s[48:51], s32 offen sc1
  v_mul_f32 v200, s68, v200
  v_mul_f32 v201, s68, v201
  v_mul_f32 v202, s68, v202
  v_mul_f32 v203, s68, v203
  v_mul_f32 v216, s68, v216
  v_mul_f32 v217, s68, v217
  v_mul_f32 v218, s68, v218
  v_mul_f32 v219, s68, v219
  v_cvt_pk_bf16_f32 v200, v200, v201
  v_cvt_pk_bf16_f32 v201, v202, v203
  v_permlane16_swap_b32 v196, v198
  v_permlane16_swap_b32 v197, v199
  v_cvt_pk_bf16_f32 v202, v216, v217
  v_cvt_pk_bf16_f32 v203, v218, v219
  buffer_store_dwordx4 v[196:199], v17, s[48:51], s33 offen sc1
  v_mul_f32 v204, s68, v204
  s_mov_b32 s39, 0
  s_sub_u32 s27, s27, 1
  s_branch P1_U40
P1_SK1:
  s_nop 7
  s_lshr_b32 s29, s27, 1
  s_mul_i32 s32, s29, s70
  s_and_b32 s29, s27, 1
  s_mul_i32 s29, s29, s71
  s_add_u32 s32, s32, s29
  s_add_u32 s32, s32, s36
  s_add_u32 s27, s27, 1
  s_add_u32 s33, s32, s67
  s_add_u32 s34, s32, s66
  s_add_u32 s35, s34, s67
  v_cvt_pk_bf16_f32 v96, v96, v97
  v_cvt_pk_bf16_f32 v97, v98, v99
  v_cvt_pk_bf16_f32 v98, v112, v113
  v_cvt_pk_bf16_f32 v99, v114, v115
  v_cvt_pk_bf16_f32 v100, v100, v101
  v_cvt_pk_bf16_f32 v101, v102, v103
  v_permlane16_swap_b32 v96, v98
  v_permlane16_swap_b32 v97, v99
  v_cvt_pk_bf16_f32 v102, v116, v117
  v_cvt_pk_bf16_f32 v103, v118, v119
  buffer_store_dwordx4 v[96:99], v17, s[48:51], s32 offen sc1
  s_add_u32 s32, s32, s65
  v_cvt_pk_bf16_f32 v104, v104, v105
  v_cvt_pk_bf16_f32 v105, v106, v107
  v_permlane16_swap_b32 v100, v102
  v_permlane16_swap_b32 v101, v103
  v_cvt_pk_bf16_f32 v106, v120, v121
  v_cvt_pk_bf16_f32 v107, v122, v123
  buffer_store_dwordx4 v[100:103], v17, s[48:51], s33 offen sc1
  s_add_u32 s33, s33, s65
  v_cvt_pk_bf16_f32 v108, v108, v109
  v_cvt_pk_bf16_f32 v109, v110, v111
  v_permlane16_swap_b32 v104, v106
  v_permlane16_swap_b32 v105, v107
  v_cvt_pk_bf16_f32 v110, v124, v125
  v_cvt_pk_bf16_f32 v111, v126, v127
  buffer_store_dwordx4 v[104:107], v17, s[48:51], s34 offen sc1
  s_add_u32 s34, s34, s65
  v_cvt_pk_bf16_f32 v128, v128, v129
  v_cvt_pk_bf16_f32 v129, v130, v131
  v_permlane16_swap_b32 v108, v110
  v_permlane16_swap_b32 v109, v111
  v_cvt_pk_bf16_f32 v130, v144, v145
  v_cvt_pk_bf16_f32 v131, v146, v147
  buffer_store_dwordx4 v[108:111], v17, s[48:51], s35 offen sc1
  s_add_u32 s35, s35, s65
  v_cvt_pk_bf16_f32 v132, v132, v133
  v_cvt_pk_bf16_f32 v133, v134, v135
  v_permlane16_swap_b32 v128, v130
  v_permlane16_swap_b32 v129, v131
  v_cvt_pk_bf16_f32 v134, v148, v149
  v_cvt_pk_bf16_f32 v135, v150, v151
  buffer_store_dwordx4 v[128:131], v17, s[48:51], s32 offen sc1
  v_cvt_pk_bf16_f32 v136, v136, v137
  v_cvt_pk_bf16_f32 v137, v138, v139
  v_permlane16_swap_b32 v132, v134
  v_permlane16_swap_b32 v133, v135
  v_cvt_pk_bf16_f32 v138, v152, v153
  v_cvt_pk_bf16_f32 v139, v154, v155
  buffer_store_dwordx4 v[132:135], v17, s[48:51], s33 offen sc1
  v_cvt_pk_bf16_f32 v140, v140, v141
  v_cvt_pk_bf16_f32 v141, v142, v143
  v_permlane16_swap_b32 v136, v138
  v_permlane16_swap_b32 v137, v139
  v_cvt_pk_bf16_f32 v142, v156, v157
  v_cvt_pk_bf16_f32 v143, v158, v159
  buffer_store_dwordx4 v[136:139], v17, s[48:51], s34 offen sc1
  s_nop 1
  v_permlane16_swap_b32 v140, v142
  v_permlane16_swap_b32 v141, v143
  buffer_store_dwordx4 v[140:143], v17, s[48:51], s35 offen sc1
  s_lshr_b32 s29, s27, 1
  s_mul_i32 s32, s29, s70
  s_and_b32 s29, s27, 1
  s_mul_i32 s29, s29, s71
  s_add_u32 s32, s32, s29
  s_add_u32 s32, s32, s36
  s_add_u32 s27, s27, 1
  s_add_u32 s33, s32, s67
  s_add_u32 s34, s32, s66
  s_add_u32 s35, s34, s67
  v_cvt_pk_bf16_f32 v160, v160, v161
  v_cvt_pk_bf16_f32 v161, v162, v163
  v_cvt_pk_bf16_f32 v162, v176, v177
  v_cvt_pk_bf16_f32 v163, v178, v179
  v_cvt_pk_bf16_f32 v164, v164, v165
  v_cvt_pk_bf16_f32 v165, v166, v167
  v_permlane16_swap_b32 v160, v162
  v_permlane16_swap_b32 v161, v163
  v_cvt_pk_bf16_f32 v166, v180, v181
  v_cvt_pk_bf16_f32 v167, v182, v183
  buffer_store_dwordx4 v[160:163], v17, s[48:51], s32 offen sc1
  s_add_u32 s32, s32, s65
  v_cvt_pk_bf16_f32 v168, v168, v169
  v_cvt_pk_bf16_f32 v169, v170, v171
  v_permlane16_swap_b32 v164, v166
  v_permlane16_swap_b32 v165, v167
  v_cvt_pk_bf16_f32 v170, v184, v185
  v_cvt_pk_bf16_f32 v171, v186, v187
  buffer_store_dwordx4 v[164:167], v17, s[48:51], s33 offen sc1
  s_add_u32 s33, s33, s65
  v_cvt_pk_bf16_f32 v172, v172, v173
  v_cvt_pk_bf16_f32 v173, v174, v175
  v_permlane16_swap_b32 v168, v170
  v_permlane16_swap_b32 v169, v171
  v_cvt_pk_bf16_f32 v174, v188, v189
  v_cvt_pk_bf16_f32 v175, v190, v191
  buffer_store_dwordx4 v[168:171], v17, s[48:51], s34 offen sc1
  s_add_u32 s34, s34, s65
  v_cvt_pk_bf16_f32 v192, v192, v193
  v_cvt_pk_bf16_f32 v193, v194, v195
  v_permlane16_swap_b32 v172, v174
  v_permlane16_swap_b32 v173, v175
  v_cvt_pk_bf16_f32 v194, v208, v209
  v_cvt_pk_bf16_f32 v195, v210, v211
  buffer_store_dwordx4 v[172:175], v17, s[48:51], s35 offen sc1
  s_add_u32 s35, s35, s65
  v_cvt_pk_bf16_f32 v196, v196, v197
  v_cvt_pk_bf16_f32 v197, v198, v199
  v_permlane16_swap_b32 v192, v194
  v_permlane16_swap_b32 v193, v195
  v_cvt_pk_bf16_f32 v198, v212, v213
  v_cvt_pk_bf16_f32 v199, v214, v215
  buffer_store_dwordx4 v[192:195], v17, s[48:51], s32 offen sc1
  v_cvt_pk_bf16_f32 v200, v200, v201
  v_cvt_pk_bf16_f32 v201, v202, v203
  v_permlane16_swap_b32 v196, v198
  v_permlane16_swap_b32 v197, v199
  v_cvt_pk_bf16_f32 v202, v216, v217
  v_cvt_pk_bf16_f32 v203, v218, v219
  buffer_store_dwordx4 v[196:199], v17, s[48:51], s33 offen sc1
  v_cvt_pk_bf16_f32 v204, v204, v205
  s_mov_b32 s39, 0
  s_sub_u32 s27, s27, 1
  s_branch P1_U41
K2_G:
  s_cmp_lg_u32 s16, 0
  s_cbranch_scc1 K2_F0
  buffer_load_dword v31, v27, s[8:11], 0 offen sc1
K2_F0:
  v_mfma_f32_16x16x32_bf16 v[224:227], a[64:67], a[0:3], v[112:115]
  s_add_u32 m0, s58, 4096
  v_and_b32 v21, 15, v20
  v_lshlrev_b32 v18, 2, v21
  v_mfma_f32_16x16x32_bf16 v[224:227], a[68:71], a[4:7], v[224:227]
  s_add_u32 s68, s68, 4096
  buffer_load_dwordx4 v24, s[12:15], s68 offen offset:0 sc1 lds
  v_mfma_f32_16x16x32_bf16 v[224:227], a[72:75], a[8:11], v[224:227]
  s_add_u32 s58, s58, 32768
  v_lshrrev_b32 v30, 4, v20
  v_lshlrev_b32 v30, 9, v30
  v_mfma_f32_16x16x32_bf16 v[224:227], a[76:79], a[12:15], v[224:227]
  s_cmp_ge_u32 s58, 163840
  v_lshl_add_u32 v30, v21, 4, v30
  v_and_b32 v250, 63, v0
  v_mfma_f32_16x16x32_bf16 v[232:235], a[64:67], a[16:19], v[120:123]
  v_and_b32 v251, 15, v250
  v_lshrrev_b32 v252, 5, v250
  v_mfma_f32_16x16x32_bf16 v[232:235], a[68:71], a[20:23], v[232:235]
  s_cselect_b32 s58, s61, s58
  v_lshl_add_u32 v251, v252, 4, v251
  v_lshlrev_b32 v240, 4, v251
  v_mfma_f32_16x16x32_bf16 v[232:235], a[72:75], a[24:27], v[232:235]
  buffer_load_dwordx4 v24, s[12:15], s68 offen offset:1024 sc1 lds
  v_and_b32 v253, 27, v250
  v_mfma_f32_16x16x32_bf16 v[232:235], a[76:79], a[28:31], v[232:235]
  s_add_u32 s72, s59, 32768
  v_cmp_eq_u32 vcc, 16, v253
  v_and_b32 v253, 31, v250
  v_mfma_f32_16x16x32_bf16 v[228:231], a[80:83], a[0:3], v[116:119]
  buffer_load_dwordx4 v24, s[12:15], s68 offen offset:2048 sc1 lds
  v_mov_b32 v252, 0x3f803f80
  v_mfma_f32_16x16x32_bf16 v[228:231], a[84:87], a[4:7], v[228:231]
  s_cmp_ge_u32 s72, 163840
  v_lshlrev_b32 v253, 2, v253
  v_cndmask_b32 v252, 0, v252, vcc
  v_mfma_f32_16x16x32_bf16 v[228:231], a[88:91], a[8:11], v[228:231]
  v_accvgpr_write_b32 a176, v252
  v_accvgpr_write_b32 a177, v252
  v_mfma_f32_16x16x32_bf16 v[228:231], a[92:95], a[12:15], v[228:231]
  s_cselect_b32 s72, 0, s72
  v_accvgpr_write_b32 a178, v252
  v_accvgpr_write_b32 a179, v252
  v_mfma_f32_16x16x32_bf16 v[236:239], a[80:83], a[16:19], v[124:127]
  buffer_load_dwordx4 v24, s[12:15], s68 offen offset:3072 sc1 lds
  v_accvgpr_write_b32 a180, v252
  v_mfma_f32_16x16x32_bf16 v[236:239], a[84:87], a[20:23], v[236:239]
  s_waitcnt lgkmcnt(15)
  v_accvgpr_write_b32 a181, v252
  v_accvgpr_write_b32 a182, v252
  v_mfma_f32_16x16x32_bf16 v[236:239], a[88:91], a[24:27], v[236:239]
  v_accvgpr_write_b32 a183, v252
  v_accvgpr_write_b32 a184, v252
  v_mfma_f32_16x16x32_bf16 v[236:239], a[92:95], a[28:31], v[236:239]
  v_accvgpr_write_b32 a185, v252
  v_accvgpr_write_b32 a186, v252
  v_mfma_f32_16x16x32_bf16 v[32:35], a[96:99], v[128:131], 0
  s_sub_u32 s57, s57, 2
  v_accvgpr_write_b32 a187, v252
  v_accvgpr_write_b32 a188, v252
  v_mfma_f32_16x16x32_bf16 v[36:39], a[96:99], v[132:135], 0
  v_accvgpr_write_b32 a189, v252
  v_accvgpr_write_b32 a190, v252
  v_mfma_f32_16x16x32_bf16 v[40:43], a[100:103], v[128:131], 0
  s_lshl_b32 s68, s57, 15
  v_accvgpr_write_b32 a191, v252
  v_accvgpr_write_b32 a192, v252
  v_mfma_f32_16x16x32_bf16 v[44:47], a[100:103], v[132:135], 0
  v_accvgpr_write_b32 a193, v252
  v_accvgpr_write_b32 a194, v252
  v_mfma_f32_16x16x32_bf16 v[48:51], a[104:107], v[128:131], 0
  s_mov_b32 m0, s58
  v_accvgpr_write_b32 a195, v252
  v_accvgpr_write_b32 a196, v252
  v_mfma_f32_16x16x32_bf16 v[52:55], a[104:107], v[132:135], 0
  buffer_load_dwordx4 v24, s[12:15], s68 offen offset:0 sc1 lds
  v_accvgpr_write_b32 a197, v252
  v_mfma_f32_16x16x32_bf16 v[56:59], a[108:111], v[128:131], 0
  s_add_u32 s57, s57, 1
  v_accvgpr_write_b32 a198, v252
  v_accvgpr_write_b32 a199, v252
  v_mfma_f32_16x16x32_bf16 v[60:63], a[108:111], v[132:135], 0
  v_accvgpr_write_b32 a200, v252
  v_accvgpr_write_b32 a201, v252
  v_mfma_f32_16x16x32_bf16 v[64:67], a[112:115], v[128:131], 0
  s_sub_u32 s14, s14, 65536
  v_accvgpr_write_b32 a202, v252
  v_accvgpr_write_b32 a203, v252
  v_mfma_f32_16x16x32_bf16 v[68:71], a[112:115], v[132:135], 0
  buffer_load_dwordx4 v24, s[12:15], s68 offen offset:1024 sc1 lds
  v_accvgpr_write_b32 a204, v252
  v_mfma_f32_16x16x32_bf16 v[72:75], a[116:119], v[128:131], 0
  s_add_u32 s73, s72, 32768
  v_accvgpr_write_b32 a205, v252
  v_accvgpr_write_b32 a206, v252
  v_mfma_f32_16x16x32_bf16 v[76:79], a[116:119], v[132:135], 0
  v_accvgpr_write_b32 a207, v252
  v_add_u32 v243, 294912, v3
  v_mfma_f32_16x16x32_bf16 v[80:83], a[120:123], v[128:131], 0
  s_waitcnt lgkmcnt(15)
  v_lshrrev_b32 v254, 3, v250
  v_and_b32 v255, 7, v250
  v_mfma_f32_16x16x32_bf16 v[84:87], a[120:123], v[132:135], 0
  buffer_load_dwordx4 v24, s[12:15], s68 offen offset:2048 sc1 lds
  v_bfe_u32 v247, v250, 4, 1
  v_mfma_f32_16x16x32_bf16 v[88:91], a[124:127], v[128:131], 0
  s_cmp_ge_u32 s73, 163840
  v_lshlrev_b32 v247, 2, v247
  v_xor_b32 v255, v255, v247
  v_mfma_f32_16x16x32_bf16 v[92:95], a[124:127], v[132:135], 0
  v_lshlrev_b32 v255, 4, v255
  v_lshl_add_u32 v246, v254, 10, v255
  v_mfma_f32_16x16x32_bf16 a[208:211], v[4:7], v[128:131], 0
  s_cselect_b32 s73, 0, s73
  v_add_u32 v247, 7168, v246
  v_add_u32 v248, 14336, v246
  v_mfma_f32_16x16x32_bf16 a[212:215], v[4:7], v[132:135], 0
  buffer_load_dwordx4 v24, s[12:15], s68 offen offset:3072 sc1 lds
  v_add_u32 v249, 21504, v246
  v_lshrrev_b32 v254, 5, v250
  v_mfma_f32_16x16x32_bf16 v[144:147], a[64:67], a[32:35], 0
  s_add_u32 m0, s58, 4096
  v_exp_f32 v224, v224
  v_mfma_f32_16x16x32_bf16 v[144:147], a[68:71], a[36:39], v[144:147]
  s_add_u32 s68, s68, 4096
  buffer_load_dwordx4 v24, s[12:15], s68 offen offset:0 sc1 lds
  v_mfma_f32_16x16x32_bf16 v[144:147], a[72:75], a[40:43], v[144:147]
  s_add_u32 s74, s73, 32768
  v_exp_f32 v225, v225
  v_mfma_f32_16x16x32_bf16 v[144:147], a[76:79], a[44:47], v[144:147]
  s_cmp_ge_u32 s74, 163840
  v_exp_f32 v226, v226
  v_mfma_f32_16x16x32_bf16 v[152:155], a[64:67], a[48:51], 0
  ds_read_b128 a[64:67], v1 offset:16384
  v_cvt_pk_bf16_f32 v128, v224, v225
  v_mfma_f32_16x16x32_bf16 v[152:155], a[68:71], a[52:55], v[152:155]
  s_cselect_b32 s74, 0, s74
  v_exp_f32 v227, v227
  v_mfma_f32_16x16x32_bf16 v[152:155], a[72:75], a[56:59], v[152:155]
  ds_read_b128 a[68:71], v1 offset:17408
  v_cvt_pk_bf16_f32 v129, v226, v227
  v_mfma_f32_16x16x32_bf16 v[152:155], a[76:79], a[60:63], v[152:155]
  s_cmp_eq_u32 s16, 0
  v_exp_f32 v228, v228
  v_mfma_f32_16x16x32_bf16 v[148:151], a[80:83], a[32:35], 0
  ds_read_b128 a[72:75], v1 offset:18432
  v_mfma_f32_16x16x32_bf16 v[148:151], a[84:87], a[36:39], v[148:151]
  s_cselect_b32 s75, s72, s59
  v_exp_f32 v229, v229
  v_mfma_f32_16x16x32_bf16 v[148:151], a[88:91], a[40:43], v[148:151]
  ds_read_b128 a[76:79], v1 offset:19456
  v_cvt_pk_bf16_f32 v130, v228, v229
  v_mfma_f32_16x16x32_bf16 v[148:151], a[92:95], a[44:47], v[148:151]
  s_add_u32 s75, s75, 16384
  v_exp_f32 v230, v230
  v_mfma_f32_16x16x32_bf16 v[156:159], a[80:83], a[48:51], 0
  ds_read_b128 a[80:83], v1 offset:20480
  buffer_load_dwordx4 v24, s[12:15], s68 offen offset:1024 sc1 lds
  v_mfma_f32_16x16x32_bf16 v[156:159], a[84:87], a[52:55], v[156:159]
  s_waitcnt lgkmcnt(15)
  v_exp_f32 v231, v231
  v_mfma_f32_16x16x32_bf16 v[156:159], a[88:91], a[56:59], v[156:159]
  ds_read_b128 a[84:87], v1 offset:21504
  v_cvt_pk_bf16_f32 v131, v230, v231
  v_mfma_f32_16x16x32_bf16 v[156:159], a[92:95], a[60:63], v[156:159]
  ds_read_b128 a[88:91], v1 offset:22528
  v_add_u32 v2, s59, v3
  v_mfma_f32_16x16x32_bf16 v[160:163], a[96:99], v[136:139], 0
  s_cmp_lt_u32 s16, 2
  v_exp_f32 v232, v232
  v_mfma_f32_16x16x32_bf16 v[164:167], a[96:99], v[140:143], 0
  ds_read_b128 a[92:95], v1 offset:23552
  v_mfma_f32_16x16x32_bf16 v[168:171], a[100:103], v[136:139], 0
  s_cselect_b32 s62, s72, s74
  v_exp_f32 v233, v233
  v_mfma_f32_16x16x32_bf16 v[172:175], a[100:103], v[140:143], 0
  ds_read_b128 a[96:99], v2 offset:8192
  v_cvt_pk_bf16_f32 v132, v232, v233
  v_mfma_f32_16x16x32_bf16 v[176:179], a[104:107], v[136:139], 0
  v_exp_f32 v234, v234
  v_mfma_f32_16x16x32_bf16 v[180:183], a[104:107], v[140:143], 0
  ds_read_b128 a[100:103], v2 offset:9216
  v_add_u32 v1, s75, v3
  v_mfma_f32_16x16x32_bf16 v[184:187], a[108:111], v[136:139], 0
  s_add_u32 s58, s58, 32768
  v_exp_f32 v235, v235
  v_mfma_f32_16x16x32_bf16 v[188:191], a[108:111], v[140:143], 0
  ds_read_b128 a[104:107], v2 offset:10240
  v_cvt_pk_bf16_f32 v133, v234, v235
  v_mfma_f32_16x16x32_bf16 v[192:195], a[112:115], v[136:139], 0
  s_cmp_ge_u32 s58, 163840
  v_exp_f32 v236, v236
  v_mfma_f32_16x16x32_bf16 v[196:199], a[112:115], v[140:143], 0
  ds_read_b128 a[108:111], v2 offset:11264
  buffer_load_dwordx4 v24, s[12:15], s68 offen offset:2048 sc1 lds
  v_mfma_f32_16x16x32_bf16 v[200:203], a[116:119], v[136:139], 0
  s_cselect_b32 s58, s61, s58
  v_exp_f32 v237, v237
  v_mfma_f32_16x16x32_bf16 v[204:207], a[116:119], v[140:143], 0
  ds_read_b128 a[112:115], v2 offset:12288
  v_cvt_pk_bf16_f32 v134, v236, v237
  v_mfma_f32_16x16x32_bf16 v[208:211], a[120:123], v[136:139], 0
  s_waitcnt lgkmcnt(5)
  v_exp_f32 v238, v238
  v_mfma_f32_16x16x32_bf16 v[212:215], a[120:123], v[140:143], 0
  ds_read_b128 a[116:119], v2 offset:13312
  v_mfma_f32_16x16x32_bf16 v[216:219], a[124:127], v[136:139], 0
  v_exp_f32 v239, v239
  v_mfma_f32_16x16x32_bf16 v[220:223], a[124:127], v[140:143], 0
  ds_read_b128 a[120:123], v2 offset:14336
  v_cvt_pk_bf16_f32 v135, v238, v239
  v_mfma_f32_16x16x32_bf16 a[216:219], v[4:7], v[136:139], 0
  ds_read_b128 a[124:127], v2 offset:15360
  v_mfma_f32_16x16x32_bf16 a[220:223], v[4:7], v[140:143], 0
  buffer_load_dwordx4 v24, s[12:15], s68 offen offset:3072 sc1 lds
  s_branch K2_D2
K2_V1:
  v_mfma_f32_16x16x32_bf16 v[144:147], a[64:67], a[0:3], v[96:99]
  s_waitcnt vmcnt(4)
  v_exp_f32 v224, v224
  v_mfma_f32_16x16x32_bf16 v[144:147], a[68:71], a[4:7], v[144:147]
  s_barrier
  v_mfma_f32_16x16x32_bf16 v[144:147], a[72:75], a[8:11], v[144:147]
  s_lshl_b32 s68, s57, 15
  v_exp_f32 v225, v225
  v_mfma_f32_16x16x32_bf16 v[144:147], a[76:79], a[12:15], v[144:147]
  s_mov_b32 m0, s58
  v_exp_f32 v226, v226
  v_mfma_f32_16x16x32_bf16 v[152:155], a[64:67], a[16:19], v[104:107]
  ds_read_b128 a[64:67], v1 offset:0
  v_cvt_pk_bf16_f32 v128, v224, v225
  v_mfma_f32_16x16x32_bf16 v[152:155], a[68:71], a[20:23], v[152:155]
  s_add_u32 s22, s22, s23
  v_exp_f32 v227, v227
  v_mfma_f32_16x16x32_bf16 v[152:155], a[72:75], a[24:27], v[152:155]
  ds_read_b128 a[68:71], v1 offset:1024
  v_cvt_pk_bf16_f32 v129, v226, v227
  v_mfma_f32_16x16x32_bf16 v[152:155], a[76:79], a[28:31], v[152:155]
  s_add_u32 s19, s22, 56623104
  v_exp_f32 v228, v228
  v_mfma_f32_16x16x32_bf16 v[148:151], a[80:83], a[0:3], v[100:103]
  ds_read_b128 a[72:75], v1 offset:2048
  buffer_load_dwordx4 v24, s[12:15], s68 offen offset:0 sc1 lds
  v_mfma_f32_16x16x32_bf16 v[148:151], a[84:87], a[4:7], v[148:151]
  s_lshl_b32 s22, s17, 16
  v_exp_f32 v229, v229
  v_mfma_f32_16x16x32_bf16 v[148:151], a[88:91], a[8:11], v[148:151]
  ds_read_b128 a[76:79], v1 offset:3072
  v_cvt_pk_bf16_f32 v130, v228, v229
  v_mfma_f32_16x16x32_bf16 v[148:151], a[92:95], a[12:15], v[148:151]
  s_lshl_b32 s23, s18, 13
  v_exp_f32 v230, v230
  v_mfma_f32_16x16x32_bf16 v[156:159], a[80:83], a[16:19], v[108:111]
  ds_read_b128 a[80:83], v1 offset:4096
  buffer_store_dwordx4 a[128:131], v3, s[8:11], s100 offen offset:0 sc1
  v_mfma_f32_16x16x32_bf16 v[156:159], a[84:87], a[20:23], v[156:159]
  s_waitcnt lgkmcnt(13)
  v_exp_f32 v231, v231
  v_mfma_f32_16x16x32_bf16 v[156:159], a[88:91], a[24:27], v[156:159]
  ds_read_b128 a[84:87], v1 offset:5120
  v_cvt_pk_bf16_f32 v131, v230, v231
  v_mfma_f32_16x16x32_bf16 v[156:159], a[92:95], a[28:31], v[156:159]
  ds_read_b128 a[88:91], v1 offset:6144
  v_add_u32 v2, s59, v3
  v_mfma_f32_16x16x32_bf16 v[160:163], a[96:99], v[136:139], v[160:163]
  s_add_u32 s57, s57, 1
  v_exp_f32 v232, v232
  v_mfma_f32_16x16x32_bf16 v[164:167], a[96:99], v[140:143], v[164:167]
  ds_read_b128 a[92:95], v1 offset:7168
  buffer_load_dwordx4 v24, s[12:15], s68 offen offset:1024 sc1 lds
  v_mfma_f32_16x16x32_bf16 v[168:171], a[100:103], v[136:139], v[168:171]
  s_add_u32 s22, s22, s23
  v_exp_f32 v233, v233
  v_mfma_f32_16x16x32_bf16 v[172:175], a[100:103], v[140:143], v[172:175]
  ds_read_b128 a[96:99], v2 offset:24576
  v_cvt_pk_bf16_f32 v132, v232, v233
  v_mfma_f32_16x16x32_bf16 v[176:179], a[104:107], v[136:139], v[176:179]
  s_add_u32 s22, s22, 50331648
  v_exp_f32 v234, v234
  v_mfma_f32_16x16x32_bf16 v[180:183], a[104:107], v[140:143], v[180:183]
  ds_read_b128 a[100:103], v2 offset:25600
  buffer_store_dwordx4 a[132:135], v3, s[8:11], s100 offen offset:1024 sc1
  v_add_u32 v1, s73, v3
  v_mfma_f32_16x16x32_bf16 v[184:187], a[108:111], v[136:139], v[184:187]
  s_add_u32 s23, s22, 4096
  v_exp_f32 v235, v235
  v_mfma_f32_16x16x32_bf16 v[188:191], a[108:111], v[140:143], v[188:191]
  ds_read_b128 a[104:107], v2 offset:26624
  v_cvt_pk_bf16_f32 v133, v234, v235
  v_mfma_f32_16x16x32_bf16 v[192:195], a[112:115], v[136:139], v[192:195]
  v_exp_f32 v236, v236
  v_mfma_f32_16x16x32_bf16 v[196:199], a[112:115], v[140:143], v[196:199]
  ds_read_b128 a[108:111], v2 offset:27648
  buffer_load_dwordx4 v24, s[12:15], s68 offen offset:2048 sc1 lds
  v_mfma_f32_16x16x32_bf16 v[200:203], a[116:119], v[136:139], v[200:203]
  v_exp_f32 v237, v237
  v_mfma_f32_16x16x32_bf16 v[204:207], a[116:119], v[140:143], v[204:207]
  ds_read_b128 a[112:115], v2 offset:28672
  v_cvt_pk_bf16_f32 v134, v236, v237
  v_mfma_f32_16x16x32_bf16 v[208:211], a[120:123], v[136:139], v[208:211]
  s_waitcnt lgkmcnt(5)
  v_exp_f32 v238, v238
  v_mfma_f32_16x16x32_bf16 v[212:215], a[120:123], v[140:143], v[212:215]
  ds_read_b128 a[116:119], v2 offset:29696
  buffer_store_dwordx4 a[136:139], v3, s[8:11], s100 offen offset:2048 sc1
  v_mfma_f32_16x16x32_bf16 v[216:219], a[124:127], v[136:139], v[216:219]
  v_exp_f32 v239, v239
  v_mfma_f32_16x16x32_bf16 v[220:223], a[124:127], v[140:143], v[220:223]
  ds_read_b128 a[120:123], v2 offset:30720
  v_cvt_pk_bf16_f32 v135, v238, v239
  v_mfma_f32_16x16x32_bf16 a[216:219], v[4:7], v[136:139], a[216:219]
  ds_read_b128 a[124:127], v2 offset:31744
  buffer_store_dwordx4 a[140:143], v3, s[8:11], s100 offen offset:3072 sc1
  v_mfma_f32_16x16x32_bf16 a[220:223], v[4:7], v[140:143], a[220:223]
  buffer_load_dwordx4 v24, s[12:15], s68 offen offset:3072 sc1 lds
  v_mfma_f32_16x16x32_bf16 v[224:227], a[64:67], a[32:35], v[96:99]
  s_add_u32 m0, s58, 4096
  v_exp_f32 v144, v144
  v_mfma_f32_16x16x32_bf16 v[224:227], a[68:71], a[36:39], v[224:227]
  s_add_u32 s68, s68, 4096
  buffer_load_dwordx4 v24, s[12:15], s68 offen offset:0 sc1 lds
  v_mfma_f32_16x16x32_bf16 v[224:227], a[72:75], a[40:43], v[224:227]
  v_exp_f32 v145, v145
  v_mfma_f32_16x16x32_bf16 v[224:227], a[76:79], a[44:47], v[224:227]
  v_exp_f32 v146, v146
  v_mfma_f32_16x16x32_bf16 v[232:235], a[64:67], a[48:51], v[104:107]
  ds_read_b128 a[64:67], v1 offset:16384
  v_cvt_pk_bf16_f32 v136, v144, v145
  v_mfma_f32_16x16x32_bf16 v[232:235], a[68:71], a[52:55], v[232:235]
  v_exp_f32 v147, v147
  v_mfma_f32_16x16x32_bf16 v[232:235], a[72:75], a[56:59], v[232:235]
  ds_read_b128 a[68:71], v1 offset:17408
  v_cvt_pk_bf16_f32 v137, v146, v147
  v_mfma_f32_16x16x32_bf16 v[232:235], a[76:79], a[60:63], v[232:235]
  v_exp_f32 v148, v148
  v_mfma_f32_16x16x32_bf16 v[228:231], a[80:83], a[32:35], v[100:103]
  ds_read_b128 a[72:75], v1 offset:18432
  buffer_load_dwordx4 a[128:131], v3, s[8:11], s22 offen offset:0 sc1
  v_mfma_f32_16x16x32_bf16 v[228:231], a[84:87], a[36:39], v[228:231]
  v_exp_f32 v149, v149
  v_mfma_f32_16x16x32_bf16 v[228:231], a[88:91], a[40:43], v[228:231]
  ds_read_b128 a[76:79], v1 offset:19456
  v_cvt_pk_bf16_f32 v138, v148, v149
  v_mfma_f32_16x16x32_bf16 v[228:231], a[92:95], a[44:47], v[228:231]
  v_exp_f32 v150, v150
  v_mfma_f32_16x16x32_bf16 v[236:239], a[80:83], a[48:51], v[108:111]
  ds_read_b128 a[80:83], v1 offset:20480
  buffer_load_dwordx4 v24, s[12:15], s68 offen offset:1024 sc1 lds
  v_mfma_f32_16x16x32_bf16 v[236:239], a[84:87], a[52:55], v[236:239]
  s_waitcnt lgkmcnt(5)
  v_exp_f32 v151, v151
  v_mfma_f32_16x16x32_bf16 v[236:239], a[88:91], a[56:59], v[236:239]
  ds_read_b128 a[84:87], v1 offset:21504
  v_cvt_pk_bf16_f32 v139, v150, v151
  v_mfma_f32_16x16x32_bf16 v[236:239], a[92:95], a[60:63], v[236:239]
  ds_read_b128 a[88:91], v1 offset:22528
  v_add_u32 v2, s59, v3
  v_mfma_f32_16x16x32_bf16 v[160:163], a[96:99], v[128:131], v[160:163]
  v_exp_f32 v152, v152
  v_mfma_f32_16x16x32_bf16 v[164:167], a[96:99], v[132:135], v[164:167]
  ds_read_b128 a[92:95], v1 offset:23552
  buffer_load_dwordx4 a[132:135], v3, s[8:11], s22 offen offset:1024 sc1
  v_mfma_f32_16x16x32_bf16 v[168:171], a[100:103], v[128:131], v[168:171]
  v_exp_f32 v153, v153
  v_mfma_f32_16x16x32_bf16 v[172:175], a[100:103], v[132:135], v[172:175]
  ds_read_b128 a[96:99], v2 offset:24576
  v_cvt_pk_bf16_f32 v140, v152, v153
  v_mfma_f32_16x16x32_bf16 v[176:179], a[104:107], v[128:131], v[176:179]
  v_exp_f32 v154, v154
  v_mfma_f32_16x16x32_bf16 v[180:183], a[104:107], v[132:135], v[180:183]
  ds_read_b128 a[100:103], v2 offset:25600
  v_add_u32 v1, s73, v3
  v_mfma_f32_16x16x32_bf16 v[184:187], a[108:111], v[128:131], v[184:187]
  s_add_u32 s58, s58, 32768
  v_exp_f32 v155, v155
  v_mfma_f32_16x16x32_bf16 v[188:191], a[108:111], v[132:135], v[188:191]
  ds_read_b128 a[104:107], v2 offset:26624
  v_cvt_pk_bf16_f32 v141, v154, v155
  v_mfma_f32_16x16x32_bf16 v[192:195], a[112:115], v[128:131], v[192:195]
  s_cmp_ge_u32 s58, 163840
  v_exp_f32 v156, v156
  v_mfma_f32_16x16x32_bf16 v[196:199], a[112:115], v[132:135], v[196:199]
  ds_read_b128 a[108:111], v2 offset:27648
  buffer_load_dwordx4 v24, s[12:15], s68 offen offset:2048 sc1 lds
  buffer_load_dwordx4 a[136:139], v3, s[8:11], s22 offen offset:2048 sc1
  v_mfma_f32_16x16x32_bf16 v[200:203], a[116:119], v[128:131], v[200:203]
  s_cselect_b32 s58, s61, s58
  v_exp_f32 v157, v157
  v_mfma_f32_16x16x32_bf16 v[204:207], a[116:119], v[132:135], v[204:207]
  ds_read_b128 a[112:115], v2 offset:28672
  v_cvt_pk_bf16_f32 v142, v156, v157
  v_mfma_f32_16x16x32_bf16 v[208:211], a[120:123], v[128:131], v[208:211]
  s_waitcnt lgkmcnt(5)
  v_exp_f32 v158, v158
  v_mfma_f32_16x16x32_bf16 v[212:215], a[120:123], v[132:135], v[212:215]
  ds_read_b128 a[116:119], v2 offset:29696
  v_mfma_f32_16x16x32_bf16 v[216:219], a[124:127], v[128:131], v[216:219]
  v_exp_f32 v159, v159
  v_mfma_f32_16x16x32_bf16 v[220:223], a[124:127], v[132:135], v[220:223]
  ds_read_b128 a[120:123], v2 offset:30720
  v_cvt_pk_bf16_f32 v143, v158, v159
  v_mfma_f32_16x16x32_bf16 a[216:219], v[4:7], v[128:131], a[216:219]
  ds_read_b128 a[124:127], v2 offset:31744
  buffer_load_dwordx4 a[140:143], v3, s[8:11], s22 offen offset:3072 sc1
  v_mfma_f32_16x16x32_bf16 a[220:223], v[4:7], v[132:135], a[220:223]
  buffer_load_dwordx4 v24, s[12:15], s68 offen offset:3072 sc1 lds
  v_mfma_f32_16x16x32_bf16 v[144:147], a[64:67], a[32:35], 0
  s_mov_b64 s[32:33], s[48:49]
  v_exp_f32 v224, v224
  v_mfma_f32_16x16x32_bf16 v[144:147], a[68:71], a[36:39], v[144:147]
  s_lshl_b32 s26, s16, 14
  s_mul_i32 s27, s17, 589824
  s_add_u32 s27, s27, 57671680
  v_mfma_f32_16x16x32_bf16 v[144:147], a[72:75], a[40:43], v[144:147]
  s_lshl_b32 s24, s16, 16
  v_exp_f32 v225, v225
  v_mfma_f32_16x16x32_bf16 v[144:147], a[76:79], a[44:47], v[144:147]
  s_add_u32 s24, s24, s27
  v_exp_f32 v226, v226
  v_mfma_f32_16x16x32_bf16 v[152:155], a[64:67], a[48:51], 0
  ds_read_b128 a[64:67], v1 offset:0
  v_cvt_pk_bf16_f32 v128, v224, v225
  v_mfma_f32_16x16x32_bf16 v[152:155], a[68:71], a[52:55], v[152:155]
  s_lshl_b32 s39, s18, 19
  v_exp_f32 v227, v227
  v_mfma_f32_16x16x32_bf16 v[152:155], a[72:75], a[56:59], v[152:155]
  ds_read_b128 a[68:71], v1 offset:1024
  v_cvt_pk_bf16_f32 v129, v226, v227
  v_mfma_f32_16x16x32_bf16 v[152:155], a[76:79], a[60:63], v[152:155]
  s_lshl_b32 s25, s16, 17
  v_exp_f32 v228, v228
  v_mfma_f32_16x16x32_bf16 v[148:151], a[80:83], a[32:35], 0
  ds_read_b128 a[72:75], v1 offset:2048
  buffer_load_dwordx4 a[144:147], v3, s[8:11], s23 offen offset:0 sc1
  v_mfma_f32_16x16x32_bf16 v[148:151], a[84:87], a[36:39], v[148:151]
  s_add_u32 s39, s39, s25
  v_exp_f32 v229, v229
  v_mfma_f32_16x16x32_bf16 v[148:151], a[88:91], a[40:43], v[148:151]
  ds_read_b128 a[76:79], v1 offset:3072
  v_cvt_pk_bf16_f32 v130, v228, v229
  v_mfma_f32_16x16x32_bf16 v[148:151], a[92:95], a[44:47], v[148:151]
  s_lshl_b32 s28, s18, 7
  v_exp_f32 v230, v230
  v_mfma_f32_16x16x32_bf16 v[156:159], a[80:83], a[48:51], 0
  ds_read_b128 a[80:83], v1 offset:4096
  buffer_load_dwordx4 a[148:151], v3, s[8:11], s23 offen offset:1024 sc1
  v_mfma_f32_16x16x32_bf16 v[156:159], a[84:87], a[52:55], v[156:159]
  s_waitcnt lgkmcnt(5)
  v_exp_f32 v231, v231
  v_mfma_f32_16x16x32_bf16 v[156:159], a[88:91], a[56:59], v[156:159]
  ds_read_b128 a[84:87], v1 offset:5120
  v_cvt_pk_bf16_f32 v131, v230, v231
  v_mfma_f32_16x16x32_bf16 v[156:159], a[92:95], a[60:63], v[156:159]
  ds_read_b128 a[88:91], v1 offset:6144
  v_add_u32 v2, s72, v3
  v_mfma_f32_16x16x32_bf16 v[32:35], a[96:99], v[136:139], v[32:35]
  s_sub_u32 s28, s28, 32768
  v_exp_f32 v232, v232
  v_mfma_f32_16x16x32_bf16 v[36:39], a[96:99], v[140:143], v[36:39]
  ds_read_b128 a[92:95], v1 offset:7168
  buffer_load_dwordx4 a[152:155], v3, s[8:11], s23 offen offset:2048 sc1
  v_mfma_f32_16x16x32_bf16 v[40:43], a[100:103], v[136:139], v[40:43]
  s_add_u32 s25, s25, s28
  v_exp_f32 v233, v233
  v_mfma_f32_16x16x32_bf16 v[44:47], a[100:103], v[140:143], v[44:47]
  ds_read_b128 a[96:99], v2 offset:8192
  v_cvt_pk_bf16_f32 v132, v232, v233
  v_mfma_f32_16x16x32_bf16 v[48:51], a[104:107], v[136:139], v[48:51]
  s_add_u32 s20, s36, 8192
  v_exp_f32 v234, v234
  v_mfma_f32_16x16x32_bf16 v[52:55], a[104:107], v[140:143], v[52:55]
  ds_read_b128 a[100:103], v2 offset:9216
  buffer_load_dwordx4 a[156:159], v3, s[8:11], s23 offen offset:3072 sc1
  v_add_u32 v1, s74, v3
  v_mfma_f32_16x16x32_bf16 v[56:59], a[108:111], v[136:139], v[56:59]
  s_mov_b32 s21, s20
  v_exp_f32 v235, v235
  v_mfma_f32_16x16x32_bf16 v[60:63], a[108:111], v[140:143], v[60:63]
  ds_read_b128 a[104:107], v2 offset:10240
  v_cvt_pk_bf16_f32 v133, v234, v235
  v_mfma_f32_16x16x32_bf16 v[64:67], a[112:115], v[136:139], v[64:67]
  v_exp_f32 v236, v236
  v_mfma_f32_16x16x32_bf16 v[68:71], a[112:115], v[140:143], v[68:71]
  ds_read_b128 a[108:111], v2 offset:11264
  buffer_load_dwordx4 a[160:163], v3, s[8:11], s36 offen offset:0 sc1
  v_mfma_f32_16x16x32_bf16 v[72:75], a[116:119], v[136:139], v[72:75]
  v_exp_f32 v237, v237
  v_mfma_f32_16x16x32_bf16 v[76:79], a[116:119], v[140:143], v[76:79]
  ds_read_b128 a[112:115], v2 offset:12288
  v_cvt_pk_bf16_f32 v134, v236, v237
  v_mfma_f32_16x16x32_bf16 v[80:83], a[120:123], v[136:139], v[80:83]
  s_waitcnt lgkmcnt(5)
  v_exp_f32 v238, v238
  v_mfma_f32_16x16x32_bf16 v[84:87], a[120:123], v[140:143], v[84:87]
  ds_read_b128 a[116:119], v2 offset:13312
  s_mov_b64 exec, s[30:31]
  buffer_load_dwordx4 a[176:179], v240, s[8:11], s36 offen offset:1024 sc1
  buffer_load_dwordx4 a[180:183], v240, s[8:11], s36 offen offset:1536 sc1
  s_mov_b64 exec, -1
  v_mfma_f32_16x16x32_bf16 v[88:91], a[124:127], v[136:139], v[88:91]
  v_exp_f32 v239, v239
  v_mfma_f32_16x16x32_bf16 v[92:95], a[124:127], v[140:143], v[92:95]
  ds_read_b128 a[120:123], v2 offset:14336
  v_cvt_pk_bf16_f32 v135, v238, v239
  v_mfma_f32_16x16x32_bf16 a[208:211], v[4:7], v[136:139], a[208:211]
  ds_read_b128 a[124:127], v2 offset:15360
  buffer_load_dwordx4 a[164:167], v3, s[8:11], s36 offen offset:2048 sc1
  v_mfma_f32_16x16x32_bf16 a[212:215], v[4:7], v[140:143], a[212:215]
  s_mov_b64 exec, s[30:31]
  buffer_load_dwordx4 a[184:187], v240, s[8:11], s36 offen offset:3072 sc1
  buffer_load_dwordx4 a[188:191], v240, s[8:11], s36 offen offset:3584 sc1
  s_mov_b64 exec, -1
  v_mfma_f32_16x16x32_bf16 v[224:227], a[64:67], a[32:35], 0
  v_exp_f32 v144, v144
  v_mfma_f32_16x16x32_bf16 v[224:227], a[68:71], a[36:39], v[224:227]
  s_barrier
  v_mfma_f32_16x16x32_bf16 v[224:227], a[72:75], a[40:43], v[224:227]
  s_lshl_b32 s68, s57, 15
  v_exp_f32 v145, v145
  v_mfma_f32_16x16x32_bf16 v[224:227], a[76:79], a[44:47], v[224:227]
  s_mov_b32 m0, s58
  v_exp_f32 v146, v146
  v_mfma_f32_16x16x32_bf16 v[232:235], a[64:67], a[48:51], 0
  ds_read_b128 a[64:67], v1 offset:0
  v_cvt_pk_bf16_f32 v136, v144, v145
  v_mfma_f32_16x16x32_bf16 v[232:235], a[68:71], a[52:55], v[232:235]
  v_exp_f32 v147, v147
  v_mfma_f32_16x16x32_bf16 v[232:235], a[72:75], a[56:59], v[232:235]
  ds_read_b128 a[68:71], v1 offset:1024
  v_cvt_pk_bf16_f32 v137, v146, v147
  v_mfma_f32_16x16x32_bf16 v[232:235], a[76:79], a[60:63], v[232:235]
  v_exp_f32 v148, v148
  v_mfma_f32_16x16x32_bf16 v[228:231], a[80:83], a[32:35], 0
  ds_read_b128 a[72:75], v1 offset:2048
  buffer_load_dwordx4 v24, s[12:15], s68 offen offset:0 sc1 lds
  buffer_load_dwordx4 a[168:171], v3, s[8:11], s37 offen offset:0 sc1
  v_mfma_f32_16x16x32_bf16 v[228:231], a[84:87], a[36:39], v[228:231]
  v_exp_f32 v149, v149
  v_mfma_f32_16x16x32_bf16 v[228:231], a[88:91], a[40:43], v[228:231]
  ds_read_b128 a[76:79], v1 offset:3072
  v_cvt_pk_bf16_f32 v138, v148, v149
  v_mfma_f32_16x16x32_bf16 v[228:231], a[92:95], a[44:47], v[228:231]
  v_exp_f32 v150, v150
  v_mfma_f32_16x16x32_bf16 v[236:239], a[80:83], a[48:51], 0
  ds_read_b128 a[80:83], v1 offset:4096
  v_mfma_f32_16x16x32_bf16 v[236:239], a[84:87], a[52:55], v[236:239]
  s_waitcnt lgkmcnt(5)
  v_exp_f32 v151, v151
  v_mfma_f32_16x16x32_bf16 v[236:239], a[88:91], a[56:59], v[236:239]
  ds_read_b128 a[84:87], v1 offset:5120
  v_cvt_pk_bf16_f32 v139, v150, v151
  v_mfma_f32_16x16x32_bf16 v[236:239], a[92:95], a[60:63], v[236:239]
  ds_read_b128 a[88:91], v1 offset:6144
  v_add_u32 v2, s73, v3
  v_mfma_f32_16x16x32_bf16 v[160:163], a[96:99], v[128:131], v[160:163]
  s_add_u32 s57, s57, 1
  v_exp_f32 v152, v152
  v_mfma_f32_16x16x32_bf16 v[164:167], a[96:99], v[132:135], v[164:167]
  ds_read_b128 a[92:95], v1 offset:7168
  buffer_load_dwordx4 v24, s[12:15], s68 offen offset:1024 sc1 lds
  s_mov_b64 exec, s[30:31]
  buffer_load_dwordx4 a[192:195], v240, s[8:11], s37 offen offset:1024 sc1
  buffer_load_dwordx4 a[196:199], v240, s[8:11], s37 offen offset:1536 sc1
  s_mov_b64 exec, -1
  v_mfma_f32_16x16x32_bf16 v[168:171], a[100:103], v[128:131], v[168:171]
  v_exp_f32 v153, v153
  v_mfma_f32_16x16x32_bf16 v[172:175], a[100:103], v[132:135], v[172:175]
  ds_read_b128 a[96:99], v2 offset:24576
  v_cvt_pk_bf16_f32 v140, v152, v153
  v_mfma_f32_16x16x32_bf16 v[176:179], a[104:107], v[128:131], v[176:179]
  v_exp_f32 v154, v154
  v_mfma_f32_16x16x32_bf16 v[180:183], a[104:107], v[132:135], v[180:183]
  ds_read_b128 a[100:103], v2 offset:25600
  v_add_u32 v1, s74, v3
  v_mfma_f32_16x16x32_bf16 v[184:187], a[108:111], v[128:131], v[184:187]
  v_exp_f32 v155, v155
  v_mfma_f32_16x16x32_bf16 v[188:191], a[108:111], v[132:135], v[188:191]
  ds_read_b128 a[104:107], v2 offset:26624
  v_cvt_pk_bf16_f32 v141, v154, v155
  v_mfma_f32_16x16x32_bf16 v[192:195], a[112:115], v[128:131], v[192:195]
  v_exp_f32 v156, v156
  v_mfma_f32_16x16x32_bf16 v[196:199], a[112:115], v[132:135], v[196:199]
  ds_read_b128 a[108:111], v2 offset:27648
  buffer_load_dwordx4 v24, s[12:15], s68 offen offset:2048 sc1 lds
  v_mfma_f32_16x16x32_bf16 v[200:203], a[116:119], v[128:131], v[200:203]
  v_exp_f32 v157, v157
  v_mfma_f32_16x16x32_bf16 v[204:207], a[116:119], v[132:135], v[204:207]
  ds_read_b128 a[112:115], v2 offset:28672
  v_cvt_pk_bf16_f32 v142, v156, v157
  v_mfma_f32_16x16x32_bf16 v[208:211], a[120:123], v[128:131], v[208:211]
  s_waitcnt lgkmcnt(5)
  v_exp_f32 v158, v158
  v_mfma_f32_16x16x32_bf16 v[212:215], a[120:123], v[132:135], v[212:215]
  ds_read_b128 a[116:119], v2 offset:29696
  buffer_load_dwordx4 a[172:175], v3, s[8:11], s37 offen offset:2048 sc1
  v_mfma_f32_16x16x32_bf16 v[216:219], a[124:127], v[128:131], v[216:219]
  v_exp_f32 v159, v159
  v_mfma_f32_16x16x32_bf16 v[220:223], a[124:127], v[132:135], v[220:223]
  ds_read_b128 a[120:123], v2 offset:30720
  v_cvt_pk_bf16_f32 v143, v158, v159
  v_mfma_f32_16x16x32_bf16 a[216:219], v[4:7], v[128:131], a[216:219]
  ds_read_b128 a[124:127], v2 offset:31744
  v_mfma_f32_16x16x32_bf16 a[220:223], v[4:7], v[132:135], a[220:223]
  buffer_load_dwordx4 v24, s[12:15], s68 offen offset:3072 sc1 lds
  v_mfma_f32_16x16x32_bf16 v[144:147], a[64:67], a[32:35], 0
  s_add_u32 m0, s58, 4096
  v_exp_f32 v224, v224
  v_mfma_f32_16x16x32_bf16 v[144:147], a[68:71], a[36:39], v[144:147]
  s_add_u32 s68, s68, 4096
  buffer_load_dwordx4 v24, s[12:15], s68 offen offset:0 sc1 lds
  v_mfma_f32_16x16x32_bf16 v[144:147], a[72:75], a[40:43], v[144:147]
  s_mov_b32 s60, s74
  v_exp_f32 v225, v225
  v_mfma_f32_16x16x32_bf16 v[144:147], a[76:79], a[44:47], v[144:147]
  v_exp_f32 v226, v226
  v_mfma_f32_16x16x32_bf16 v[152:155], a[64:67], a[48:51], 0
  ds_read_b128 a[64:67], v1 offset:16384
  v_cvt_pk_bf16_f32 v128, v224, v225
  v_mfma_f32_16x16x32_bf16 v[152:155], a[68:71], a[52:55], v[152:155]
  v_exp_f32 v227, v227
  v_mfma_f32_16x16x32_bf16 v[152:155], a[72:75], a[56:59], v[152:155]
  ds_read_b128 a[68:71], v1 offset:17408
  v_cvt_pk_bf16_f32 v129, v226, v227
  v_mfma_f32_16x16x32_bf16 v[152:155], a[76:79], a[60:63], v[152:155]
  v_exp_f32 v228, v228
  v_mfma_f32_16x16x32_bf16 v[148:151], a[80:83], a[32:35], 0
  ds_read_b128 a[72:75], v1 offset:18432
  s_mov_b64 exec, s[30:31]
  buffer_load_dwordx4 a[200:203], v240, s[8:11], s37 offen offset:3072 sc1
  buffer_load_dwordx4 a[204:207], v240, s[8:11], s37 offen offset:3584 sc1
  s_mov_b64 exec, -1
  v_mfma_f32_16x16x32_bf16 v[148:151], a[84:87], a[36:39], v[148:151]
  v_exp_f32 v229, v229
  v_mfma_f32_16x16x32_bf16 v[148:151], a[88:91], a[40:43], v[148:151]
  ds_read_b128 a[76:79], v1 offset:19456
  v_cvt_pk_bf16_f32 v130, v228, v229
  v_mfma_f32_16x16x32_bf16 v[148:151], a[92:95], a[44:47], v[148:151]
  v_exp_f32 v230, v230
  v_mfma_f32_16x16x32_bf16 v[156:159], a[80:83], a[48:51], 0
  ds_read_b128 a[80:83], v1 offset:20480
  buffer_load_dwordx4 v24, s[12:15], s68 offen offset:1024 sc1 lds
  v_mfma_f32_16x16x32_bf16 v[156:159], a[84:87], a[52:55], v[156:159]
  s_waitcnt lgkmcnt(5)
  v_exp_f32 v231, v231
  v_mfma_f32_16x16x32_bf16 v[156:159], a[88:91], a[56:59], v[156:159]
  ds_read_b128 a[84:87], v1 offset:21504
  v_cvt_pk_bf16_f32 v131, v230, v231
  v_mfma_f32_16x16x32_bf16 v[156:159], a[92:95], a[60:63], v[156:159]
  ds_read_b128 a[88:91], v1 offset:22528
  s_mov_b32 s59, s74
  v_add_u32 v2, s73, v3
  v_mfma_f32_16x16x32_bf16 v[160:163], a[96:99], v[136:139], v[160:163]
  s_add_u32 s59, s59, 32768
  v_exp_f32 v232, v232
  v_mfma_f32_16x16x32_bf16 v[164:167], a[96:99], v[140:143], v[164:167]
  ds_read_b128 a[92:95], v1 offset:23552
  buffer_load_dword v241, v253, s[8:11], s19 offen offset:0 sc1
  v_mfma_f32_16x16x32_bf16 v[168:171], a[100:103], v[136:139], v[168:171]
  s_cmp_ge_u32 s59, 163840
  v_exp_f32 v233, v233
  v_mfma_f32_16x16x32_bf16 v[172:175], a[100:103], v[140:143], v[172:175]
  ds_read_b128 a[96:99], v2 offset:8192
  v_cvt_pk_bf16_f32 v132, v232, v233
  v_mfma_f32_16x16x32_bf16 v[176:179], a[104:107], v[136:139], v[176:179]
  s_cselect_b32 s59, 0, s59
  v_exp_f32 v234, v234
  v_mfma_f32_16x16x32_bf16 v[180:183], a[104:107], v[140:143], v[180:183]
  ds_read_b128 a[100:103], v2 offset:9216
  v_add_u32 v1, s59, v3
  v_mfma_f32_16x16x32_bf16 v[184:187], a[108:111], v[136:139], v[184:187]
  s_add_u32 s58, s58, 32768
  v_exp_f32 v235, v235
  v_mfma_f32_16x16x32_bf16 v[188:191], a[108:111], v[140:143], v[188:191]
  ds_read_b128 a[104:107], v2 offset:10240
  v_cvt_pk_bf16_f32 v133, v234, v235
  v_mfma_f32_16x16x32_bf16 v[192:195], a[112:115], v[136:139], v[192:195]
  s_cmp_ge_u32 s58, 163840
  v_exp_f32 v236, v236
  v_mfma_f32_16x16x32_bf16 v[196:199], a[112:115], v[140:143], v[196:199]
  ds_read_b128 a[108:111], v2 offset:11264
  buffer_load_dwordx4 v24, s[12:15], s68 offen offset:2048 sc1 lds
  v_mfma_f32_16x16x32_bf16 v[200:203], a[116:119], v[136:139], v[200:203]
  s_cselect_b32 s58, s61, s58
  v_exp_f32 v237, v237
  v_mfma_f32_16x16x32_bf16 v[204:207], a[116:119], v[140:143], v[204:207]
  ds_read_b128 a[112:115], v2 offset:12288
  v_cvt_pk_bf16_f32 v134, v236, v237
  v_mfma_f32_16x16x32_bf16 v[208:211], a[120:123], v[136:139], v[208:211]
  s_waitcnt lgkmcnt(5)
  v_exp_f32 v238, v238
  v_mfma_f32_16x16x32_bf16 v[212:215], a[120:123], v[140:143], v[212:215]
  ds_read_b128 a[116:119], v2 offset:13312
  buffer_load_dword v242, v253, s[8:11], s19 offen offset:128 sc1
  v_mfma_f32_16x16x32_bf16 v[216:219], a[124:127], v[136:139], v[216:219]
  v_exp_f32 v239, v239
  v_mfma_f32_16x16x32_bf16 v[220:223], a[124:127], v[140:143], v[220:223]
  ds_read_b128 a[120:123], v2 offset:14336
  v_cvt_pk_bf16_f32 v135, v238, v239
  v_mfma_f32_16x16x32_bf16 a[216:219], v[4:7], v[136:139], a[216:219]
  ds_read_b128 a[124:127], v2 offset:15360
  v_mfma_f32_16x16x32_bf16 a[220:223], v[4:7], v[140:143], a[220:223]
  buffer_load_dwordx4 v24, s[12:15], s68 offen offset:3072 sc1 lds
  s_branch K2_J
K2_V2:
  v_mfma_f32_16x16x32_bf16 v[144:147], a[64:67], a[0:3], 0
  s_waitcnt vmcnt(4)
  v_exp_f32 v224, v224
  v_mfma_f32_16x16x32_bf16 v[144:147], a[68:71], a[4:7], v[144:147]
  s_barrier
  v_mfma_f32_16x16x32_bf16 v[144:147], a[72:75], a[8:11], v[144:147]
  s_lshl_b32 s68, s57, 15
  v_exp_f32 v225, v225
  v_mfma_f32_16x16x32_bf16 v[144:147], a[76:79], a[12:15], v[144:147]
  s_mov_b32 m0, s58
  v_exp_f32 v226, v226
  v_mfma_f32_16x16x32_bf16 v[152:155], a[64:67], a[16:19], 0
  ds_read_b128 a[64:67], v1 offset:0
  v_cvt_pk_bf16_f32 v128, v224, v225
  v_mfma_f32_16x16x32_bf16 v[152:155], a[68:71], a[20:23], v[152:155]
  s_add_u32 s22, s22, s23
  v_exp_f32 v227, v227
  v_mfma_f32_16x16x32_bf16 v[152:155], a[72:75], a[24:27], v[152:155]
  ds_read_b128 a[68:71], v1 offset:1024
  v_cvt_pk_bf16_f32 v129, v226, v227
  v_mfma_f32_16x16x32_bf16 v[152:155], a[76:79], a[28:31], v[152:155]
  s_add_u32 s19, s22, 56623104
  v_exp_f32 v228, v228
  v_mfma_f32_16x16x32_bf16 v[148:151], a[80:83], a[0:3], 0
  ds_read_b128 a[72:75], v1 offset:2048
  buffer_load_dwordx4 v24, s[12:15], s68 offen offset:0 sc1 lds
  v_mfma_f32_16x16x32_bf16 v[148:151], a[84:87], a[4:7], v[148:151]
  s_lshl_b32 s22, s17, 16
  v_exp_f32 v229, v229
  v_mfma_f32_16x16x32_bf16 v[148:151], a[88:91], a[8:11], v[148:151]
  ds_read_b128 a[76:79], v1 offset:3072
  v_cvt_pk_bf16_f32 v130, v228, v229
  v_mfma_f32_16x16x32_bf16 v[148:151], a[92:95], a[12:15], v[148:151]
  s_lshl_b32 s23, s18, 13
  v_exp_f32 v230, v230
  v_mfma_f32_16x16x32_bf16 v[156:159], a[80:83], a[16:19], 0
  ds_read_b128 a[80:83], v1 offset:4096
  buffer_store_dwordx4 a[128:131], v3, s[8:11], s100 offen offset:0 sc1
  v_mfma_f32_16x16x32_bf16 v[156:159], a[84:87], a[20:23], v[156:159]
  s_waitcnt lgkmcnt(13)
  v_exp_f32 v231, v231
  v_mfma_f32_16x16x32_bf16 v[156:159], a[88:91], a[24:27], v[156:159]
  ds_read_b128 a[84:87], v1 offset:5120
  v_cvt_pk_bf16_f32 v131, v230, v231
  v_mfma_f32_16x16x32_bf16 v[156:159], a[92:95], a[28:31], v[156:159]
  ds_read_b128 a[88:91], v1 offset:6144
  v_add_u32 v2, s59, v3
  v_mfma_f32_16x16x32_bf16 v[160:163], a[96:99], v[136:139], v[160:163]
  s_add_u32 s57, s57, 1
  v_exp_f32 v232, v232
  v_mfma_f32_16x16x32_bf16 v[164:167], a[96:99], v[140:143], v[164:167]
  ds_read_b128 a[92:95], v1 offset:7168
  buffer_load_dwordx4 v24, s[12:15], s68 offen offset:1024 sc1 lds
  v_mfma_f32_16x16x32_bf16 v[168:171], a[100:103], v[136:139], v[168:171]
  s_add_u32 s22, s22, s23
  v_exp_f32 v233, v233
  v_mfma_f32_16x16x32_bf16 v[172:175], a[100:103], v[140:143], v[172:175]
  ds_read_b128 a[96:99], v2 offset:24576
  v_cvt_pk_bf16_f32 v132, v232, v233
  v_mfma_f32_16x16x32_bf16 v[176:179], a[104:107], v[136:139], v[176:179]
  s_add_u32 s22, s22, 50331648
  v_exp_f32 v234, v234
  v_mfma_f32_16x16x32_bf16 v[180:183], a[104:107], v[140:143], v[180:183]
  ds_read_b128 a[100:103], v2 offset:25600
  buffer_store_dwordx4 a[132:135], v3, s[8:11], s100 offen offset:1024 sc1
  v_add_u32 v1, s73, v3
  v_mfma_f32_16x16x32_bf16 v[184:187], a[108:111], v[136:139], v[184:187]
  s_add_u32 s23, s22, 4096
  v_exp_f32 v235, v235
  v_mfma_f32_16x16x32_bf16 v[188:191], a[108:111], v[140:143], v[188:191]
  ds_read_b128 a[104:107], v2 offset:26624
  v_cvt_pk_bf16_f32 v133, v234, v235
  v_mfma_f32_16x16x32_bf16 v[192:195], a[112:115], v[136:139], v[192:195]
  v_exp_f32 v236, v236
  v_mfma_f32_16x16x32_bf16 v[196:199], a[112:115], v[140:143], v[196:199]
  ds_read_b128 a[108:111], v2 offset:27648
  buffer_load_dwordx4 v24, s[12:15], s68 offen offset:2048 sc1 lds
  v_mfma_f32_16x16x32_bf16 v[200:203], a[116:119], v[136:139], v[200:203]
  v_exp_f32 v237, v237
  v_mfma_f32_16x16x32_bf16 v[204:207], a[116:119], v[140:143], v[204:207]
  ds_read_b128 a[112:115], v2 offset:28672
  v_cvt_pk_bf16_f32 v134, v236, v237
  v_mfma_f32_16x16x32_bf16 v[208:211], a[120:123], v[136:139], v[208:211]
  s_waitcnt lgkmcnt(5)
  v_exp_f32 v238, v238
  v_mfma_f32_16x16x32_bf16 v[212:215], a[120:123], v[140:143], v[212:215]
  ds_read_b128 a[116:119], v2 offset:29696
  buffer_store_dwordx4 a[136:139], v3, s[8:11], s100 offen offset:2048 sc1
  v_mfma_f32_16x16x32_bf16 v[216:219], a[124:127], v[136:139], v[216:219]
  v_exp_f32 v239, v239
  v_mfma_f32_16x16x32_bf16 v[220:223], a[124:127], v[140:143], v[220:223]
  ds_read_b128 a[120:123], v2 offset:30720
  v_cvt_pk_bf16_f32 v135, v238, v239
  v_mfma_f32_16x16x32_bf16 a[216:219], v[4:7], v[136:139], a[216:219]
  ds_read_b128 a[124:127], v2 offset:31744
  buffer_store_dwordx4 a[140:143], v3, s[8:11], s100 offen offset:3072 sc1
  v_mfma_f32_16x16x32_bf16 a[220:223], v[4:7], v[140:143], a[220:223]
  buffer_load_dwordx4 v24, s[12:15], s68 offen offset:3072 sc1 lds
  v_mfma_f32_16x16x32_bf16 v[224:227], a[64:67], a[0:3], v[96:99]
  s_add_u32 m0, s58, 4096
  v_exp_f32 v144, v144
  v_mfma_f32_16x16x32_bf16 v[224:227], a[68:71], a[4:7], v[224:227]
  s_add_u32 s68, s68, 4096
  buffer_load_dwordx4 v24, s[12:15], s68 offen offset:0 sc1 lds
  v_mfma_f32_16x16x32_bf16 v[224:227], a[72:75], a[8:11], v[224:227]
  v_exp_f32 v145, v145
  v_mfma_f32_16x16x32_bf16 v[224:227], a[76:79], a[12:15], v[224:227]
  v_exp_f32 v146, v146
  v_mfma_f32_16x16x32_bf16 v[232:235], a[64:67], a[16:19], v[104:107]
  ds_read_b128 a[64:67], v1 offset:16384
  v_cvt_pk_bf16_f32 v136, v144, v145
  v_mfma_f32_16x16x32_bf16 v[232:235], a[68:71], a[20:23], v[232:235]
  v_exp_f32 v147, v147
  v_mfma_f32_16x16x32_bf16 v[232:235], a[72:75], a[24:27], v[232:235]
  ds_read_b128 a[68:71], v1 offset:17408
  v_cvt_pk_bf16_f32 v137, v146, v147
  v_mfma_f32_16x16x32_bf16 v[232:235], a[76:79], a[28:31], v[232:235]
  v_exp_f32 v148, v148
  v_mfma_f32_16x16x32_bf16 v[228:231], a[80:83], a[0:3], v[100:103]
  ds_read_b128 a[72:75], v1 offset:18432
  buffer_load_dwordx4 a[128:131], v3, s[8:11], s22 offen offset:0 sc1
  v_mfma_f32_16x16x32_bf16 v[228:231], a[84:87], a[4:7], v[228:231]
  v_exp_f32 v149, v149
  v_mfma_f32_16x16x32_bf16 v[228:231], a[88:91], a[8:11], v[228:231]
  ds_read_b128 a[76:79], v1 offset:19456
  v_cvt_pk_bf16_f32 v138, v148, v149
  v_mfma_f32_16x16x32_bf16 v[228:231], a[92:95], a[12:15], v[228:231]
  v_exp_f32 v150, v150
  v_mfma_f32_16x16x32_bf16 v[236:239], a[80:83], a[16:19], v[108:111]
  ds_read_b128 a[80:83], v1 offset:20480
  buffer_load_dwordx4 v24, s[12:15], s68 offen offset:1024 sc1 lds
  v_mfma_f32_16x16x32_bf16 v[236:239], a[84:87], a[20:23], v[236:239]
  s_waitcnt lgkmcnt(5)
  v_exp_f32 v151, v151
  v_mfma_f32_16x16x32_bf16 v[236:239], a[88:91], a[24:27], v[236:239]
  ds_read_b128 a[84:87], v1 offset:21504
  v_cvt_pk_bf16_f32 v139, v150, v151
  v_mfma_f32_16x16x32_bf16 v[236:239], a[92:95], a[28:31], v[236:239]
  ds_read_b128 a[88:91], v1 offset:22528
  v_add_u32 v2, s59, v3
  v_mfma_f32_16x16x32_bf16 v[160:163], a[96:99], v[128:131], v[160:163]
  v_exp_f32 v152, v152
  v_mfma_f32_16x16x32_bf16 v[164:167], a[96:99], v[132:135], v[164:167]
  ds_read_b128 a[92:95], v1 offset:23552
  buffer_load_dwordx4 a[132:135], v3, s[8:11], s22 offen offset:1024 sc1
  v_mfma_f32_16x16x32_bf16 v[168:171], a[100:103], v[128:131], v[168:171]
  v_exp_f32 v153, v153
  v_mfma_f32_16x16x32_bf16 v[172:175], a[100:103], v[132:135], v[172:175]
  ds_read_b128 a[96:99], v2 offset:24576
  v_cvt_pk_bf16_f32 v140, v152, v153
  v_mfma_f32_16x16x32_bf16 v[176:179], a[104:107], v[128:131], v[176:179]
  v_exp_f32 v154, v154
  v_mfma_f32_16x16x32_bf16 v[180:183], a[104:107], v[132:135], v[180:183]
  ds_read_b128 a[100:103], v2 offset:25600
  v_add_u32 v1, s73, v3
  v_mfma_f32_16x16x32_bf16 v[184:187], a[108:111], v[128:131], v[184:187]
  s_add_u32 s58, s58, 32768
  v_exp_f32 v155, v155
  v_mfma_f32_16x16x32_bf16 v[188:191], a[108:111], v[132:135], v[188:191]
  ds_read_b128 a[104:107], v2 offset:26624
  v_cvt_pk_bf16_f32 v141, v154, v155
  v_mfma_f32_16x16x32_bf16 v[192:195], a[112:115], v[128:131], v[192:195]
  s_cmp_ge_u32 s58, 163840
  v_exp_f32 v156, v156
  v_mfma_f32_16x16x32_bf16 v[196:199], a[112:115], v[132:135], v[196:199]
  ds_read_b128 a[108:111], v2 offset:27648
  buffer_load_dwordx4 v24, s[12:15], s68 offen offset:2048 sc1 lds
  buffer_load_dwordx4 a[136:139], v3, s[8:11], s22 offen offset:2048 sc1
  v_mfma_f32_16x16x32_bf16 v[200:203], a[116:119], v[128:131], v[200:203]
  s_cselect_b32 s58, s61, s58
  v_exp_f32 v157, v157
  v_mfma_f32_16x16x32_bf16 v[204:207], a[116:119], v[132:135], v[204:207]
  ds_read_b128 a[112:115], v2 offset:28672
  v_cvt_pk_bf16_f32 v142, v156, v157
  v_mfma_f32_16x16x32_bf16 v[208:211], a[120:123], v[128:131], v[208:211]
  s_waitcnt lgkmcnt(5)
  v_exp_f32 v158, v158
  v_mfma_f32_16x16x32_bf16 v[212:215], a[120:123], v[132:135], v[212:215]
  ds_read_b128 a[116:119], v2 offset:29696
  v_mfma_f32_16x16x32_bf16 v[216:219], a[124:127], v[128:131], v[216:219]
  v_exp_f32 v159, v159
  v_mfma_f32_16x16x32_bf16 v[220:223], a[124:127], v[132:135], v[220:223]
  ds_read_b128 a[120:123], v2 offset:30720
  v_cvt_pk_bf16_f32 v143, v158, v159
  v_mfma_f32_16x16x32_bf16 a[216:219], v[4:7], v[128:131], a[216:219]
  ds_read_b128 a[124:127], v2 offset:31744
  buffer_load_dwordx4 a[140:143], v3, s[8:11], s22 offen offset:3072 sc1
  v_mfma_f32_16x16x32_bf16 a[220:223], v[4:7], v[132:135], a[220:223]
  buffer_load_dwordx4 v24, s[12:15], s68 offen offset:3072 sc1 lds
  v_mfma_f32_16x16x32_bf16 v[144:147], a[64:67], a[32:35], v[96:99]
  s_mov_b64 s[32:33], s[48:49]
  v_exp_f32 v224, v224
  v_mfma_f32_16x16x32_bf16 v[144:147], a[68:71], a[36:39], v[144:147]
  s_lshl_b32 s26, s16, 14
  s_mul_i32 s27, s17, 589824
  s_add_u32 s27, s27, 57671680
  v_mfma_f32_16x16x32_bf16 v[144:147], a[72:75], a[40:43], v[144:147]
  s_lshl_b32 s24, s16, 16
  v_exp_f32 v225, v225
  v_mfma_f32_16x16x32_bf16 v[144:147], a[76:79], a[44:47], v[144:147]
  s_add_u32 s24, s24, s27
  v_exp_f32 v226, v226
  v_mfma_f32_16x16x32_bf16 v[152:155], a[64:67], a[48:51], v[104:107]
  ds_read_b128 a[64:67], v1 offset:0
  v_cvt_pk_bf16_f32 v128, v224, v225
  v_mfma_f32_16x16x32_bf16 v[152:155], a[68:71], a[52:55], v[152:155]
  s_lshl_b32 s39, s18, 19
  v_exp_f32 v227, v227
  v_mfma_f32_16x16x32_bf16 v[152:155], a[72:75], a[56:59], v[152:155]
  ds_read_b128 a[68:71], v1 offset:1024
  v_cvt_pk_bf16_f32 v129, v226, v227
  v_mfma_f32_16x16x32_bf16 v[152:155], a[76:79], a[60:63], v[152:155]
  s_lshl_b32 s25, s16, 17
  v_exp_f32 v228, v228
  v_mfma_f32_16x16x32_bf16 v[148:151], a[80:83], a[32:35], v[100:103]
  ds_read_b128 a[72:75], v1 offset:2048
  buffer_load_dwordx4 a[144:147], v3, s[8:11], s23 offen offset:0 sc1
  v_mfma_f32_16x16x32_bf16 v[148:151], a[84:87], a[36:39], v[148:151]
  s_add_u32 s39, s39, s25
  v_exp_f32 v229, v229
  v_mfma_f32_16x16x32_bf16 v[148:151], a[88:91], a[40:43], v[148:151]
  ds_read_b128 a[76:79], v1 offset:3072
  v_cvt_pk_bf16_f32 v130, v228, v229
  v_mfma_f32_16x16x32_bf16 v[148:151], a[92:95], a[44:47], v[148:151]
  s_lshl_b32 s28, s18, 7
  v_exp_f32 v230, v230
  v_mfma_f32_16x16x32_bf16 v[156:159], a[80:83], a[48:51], v[108:111]
  ds_read_b128 a[80:83], v1 offset:4096
  buffer_load_dwordx4 a[148:151], v3, s[8:11], s23 offen offset:1024 sc1
  v_mfma_f32_16x16x32_bf16 v[156:159], a[84:87], a[52:55], v[156:159]
  s_waitcnt lgkmcnt(5)
  v_exp_f32 v231, v231
  v_mfma_f32_16x16x32_bf16 v[156:159], a[88:91], a[56:59], v[156:159]
  ds_read_b128 a[84:87], v1 offset:5120
  v_cvt_pk_bf16_f32 v131, v230, v231
  v_mfma_f32_16x16x32_bf16 v[156:159], a[92:95], a[60:63], v[156:159]
  ds_read_b128 a[88:91], v1 offset:6144
  v_add_u32 v2, s74, v3
  v_mfma_f32_16x16x32_bf16 v[32:35], a[96:99], v[136:139], v[32:35]
  s_sub_u32 s28, s28, 32768
  v_exp_f32 v232, v232
  v_mfma_f32_16x16x32_bf16 v[36:39], a[96:99], v[140:143], v[36:39]
  ds_read_b128 a[92:95], v1 offset:7168
  buffer_load_dwordx4 a[152:155], v3, s[8:11], s23 offen offset:2048 sc1
  v_mfma_f32_16x16x32_bf16 v[40:43], a[100:103], v[136:139], v[40:43]
  s_add_u32 s25, s25, s28
  v_exp_f32 v233, v233
  v_mfma_f32_16x16x32_bf16 v[44:47], a[100:103], v[140:143], v[44:47]
  ds_read_b128 a[96:99], v2 offset:8192
  v_cvt_pk_bf16_f32 v132, v232, v233
  v_mfma_f32_16x16x32_bf16 v[48:51], a[104:107], v[136:139], v[48:51]
  s_add_u32 s20, s36, 8192
  v_exp_f32 v234, v234
  v_mfma_f32_16x16x32_bf16 v[52:55], a[104:107], v[140:143], v[52:55]
  ds_read_b128 a[100:103], v2 offset:9216
  buffer_load_dwordx4 a[156:159], v3, s[8:11], s23 offen offset:3072 sc1
  v_add_u32 v1, s74, v3
  v_mfma_f32_16x16x32_bf16 v[56:59], a[108:111], v[136:139], v[56:59]
  s_mov_b32 s21, s20
  v_exp_f32 v235, v235
  v_mfma_f32_16x16x32_bf16 v[60:63], a[108:111], v[140:143], v[60:63]
  ds_read_b128 a[104:107], v2 offset:10240
  v_cvt_pk_bf16_f32 v133, v234, v235
  v_mfma_f32_16x16x32_bf16 v[64:67], a[112:115], v[136:139], v[64:67]
  v_exp_f32 v236, v236
  v_mfma_f32_16x16x32_bf16 v[68:71], a[112:115], v[140:143], v[68:71]
  ds_read_b128 a[108:111], v2 offset:11264
  buffer_load_dwordx4 a[160:163], v3, s[8:11], s36 offen offset:0 sc1
  v_mfma_f32_16x16x32_bf16 v[72:75], a[116:119], v[136:139], v[72:75]
  v_exp_f32 v237, v237
  v_mfma_f32_16x16x32_bf16 v[76:79], a[116:119], v[140:143], v[76:79]
  ds_read_b128 a[112:115], v2 offset:12288
  v_cvt_pk_bf16_f32 v134, v236, v237
  v_mfma_f32_16x16x32_bf16 v[80:83], a[120:123], v[136:139], v[80:83]
  s_waitcnt lgkmcnt(5)
  v_exp_f32 v238, v238
  v_mfma_f32_16x16x32_bf16 v[84:87], a[120:123], v[140:143], v[84:87]
  ds_read_b128 a[116:119], v2 offset:13312
  s_mov_b64 exec, s[30:31]
  buffer_load_dwordx4 a[176:179], v240, s[8:11], s36 offen offset:1024 sc1
  buffer_load_dwordx4 a[180:183], v240, s[8:11], s36 offen offset:1536 sc1
  s_mov_b64 exec, -1
  v_mfma_f32_16x16x32_bf16 v[88:91], a[124:127], v[136:139], v[88:91]
  v_exp_f32 v239, v239
  v_mfma_f32_16x16x32_bf16 v[92:95], a[124:127], v[140:143], v[92:95]
  ds_read_b128 a[120:123], v2 offset:14336
  v_cvt_pk_bf16_f32 v135, v238, v239
  v_mfma_f32_16x16x32_bf16 a[208:211], v[4:7], v[136:139], a[208:211]
  ds_read_b128 a[124:127], v2 offset:15360
  buffer_load_dwordx4 a[164:167], v3, s[8:11], s36 offen offset:2048 sc1
  v_mfma_f32_16x16x32_bf16 a[212:215], v[4:7], v[140:143], a[212:215]
  s_mov_b64 exec, s[30:31]
  buffer_load_dwordx4 a[184:187], v240, s[8:11], s36 offen offset:3072 sc1
  buffer_load_dwordx4 a[188:191], v240, s[8:11], s36 offen offset:3584 sc1
  s_mov_b64 exec, -1
  v_mfma_f32_16x16x32_bf16 v[224:227], a[64:67], a[32:35], 0
  v_exp_f32 v144, v144
  v_mfma_f32_16x16x32_bf16 v[224:227], a[68:71], a[36:39], v[224:227]
  s_barrier
  v_mfma_f32_16x16x32_bf16 v[224:227], a[72:75], a[40:43], v[224:227]
  s_lshl_b32 s68, s57, 15
  v_exp_f32 v145, v145
  v_mfma_f32_16x16x32_bf16 v[224:227], a[76:79], a[44:47], v[224:227]
  s_mov_b32 m0, s58
  v_exp_f32 v146, v146
  v_mfma_f32_16x16x32_bf16 v[232:235], a[64:67], a[48:51], 0
  ds_read_b128 a[64:67], v1 offset:0
  v_cvt_pk_bf16_f32 v136, v144, v145
  v_mfma_f32_16x16x32_bf16 v[232:235], a[68:71], a[52:55], v[232:235]
  v_exp_f32 v147, v147
  v_mfma_f32_16x16x32_bf16 v[232:235], a[72:75], a[56:59], v[232:235]
  ds_read_b128 a[68:71], v1 offset:1024
  v_cvt_pk_bf16_f32 v137, v146, v147
  v_mfma_f32_16x16x32_bf16 v[232:235], a[76:79], a[60:63], v[232:235]
  v_exp_f32 v148, v148
  v_mfma_f32_16x16x32_bf16 v[228:231], a[80:83], a[32:35], 0
  ds_read_b128 a[72:75], v1 offset:2048
  buffer_load_dwordx4 v24, s[12:15], s68 offen offset:0 sc1 lds
  buffer_load_dwordx4 a[168:171], v3, s[8:11], s37 offen offset:0 sc1
  v_mfma_f32_16x16x32_bf16 v[228:231], a[84:87], a[36:39], v[228:231]
  v_exp_f32 v149, v149
  v_mfma_f32_16x16x32_bf16 v[228:231], a[88:91], a[40:43], v[228:231]
  ds_read_b128 a[76:79], v1 offset:3072
  v_cvt_pk_bf16_f32 v138, v148, v149
  v_mfma_f32_16x16x32_bf16 v[228:231], a[92:95], a[44:47], v[228:231]
  v_exp_f32 v150, v150
  v_mfma_f32_16x16x32_bf16 v[236:239], a[80:83], a[48:51], 0
  ds_read_b128 a[80:83], v1 offset:4096
  v_mfma_f32_16x16x32_bf16 v[236:239], a[84:87], a[52:55], v[236:239]
  s_waitcnt lgkmcnt(5)
  v_exp_f32 v151, v151
  v_mfma_f32_16x16x32_bf16 v[236:239], a[88:91], a[56:59], v[236:239]
  ds_read_b128 a[84:87], v1 offset:5120
  v_cvt_pk_bf16_f32 v139, v150, v151
  v_mfma_f32_16x16x32_bf16 v[236:239], a[92:95], a[60:63], v[236:239]
  ds_read_b128 a[88:91], v1 offset:6144
  v_add_u32 v2, s73, v3
  v_mfma_f32_16x16x32_bf16 v[32:35], a[96:99], v[128:131], v[32:35]
  s_add_u32 s57, s57, 1
  v_exp_f32 v152, v152
  v_mfma_f32_16x16x32_bf16 v[36:39], a[96:99], v[132:135], v[36:39]
  ds_read_b128 a[92:95], v1 offset:7168
  buffer_load_dwordx4 v24, s[12:15], s68 offen offset:1024 sc1 lds
  s_mov_b64 exec, s[30:31]
  buffer_load_dwordx4 a[192:195], v240, s[8:11], s37 offen offset:1024 sc1
  buffer_load_dwordx4 a[196:199], v240, s[8:11], s37 offen offset:1536 sc1
  s_mov_b64 exec, -1
  v_mfma_f32_16x16x32_bf16 v[40:43], a[100:103], v[128:131], v[40:43]
  v_exp_f32 v153, v153
  v_mfma_f32_16x16x32_bf16 v[44:47], a[100:103], v[132:135], v[44:47]
  ds_read_b128 a[96:99], v2 offset:24576
  v_cvt_pk_bf16_f32 v140, v152, v153
  v_mfma_f32_16x16x32_bf16 v[48:51], a[104:107], v[128:131], v[48:51]
  v_exp_f32 v154, v154
  v_mfma_f32_16x16x32_bf16 v[52:55], a[104:107], v[132:135], v[52:55]
  ds_read_b128 a[100:103], v2 offset:25600
  v_add_u32 v1, s74, v3
  v_mfma_f32_16x16x32_bf16 v[56:59], a[108:111], v[128:131], v[56:59]
  v_exp_f32 v155, v155
  v_mfma_f32_16x16x32_bf16 v[60:63], a[108:111], v[132:135], v[60:63]
  ds_read_b128 a[104:107], v2 offset:26624
  v_cvt_pk_bf16_f32 v141, v154, v155
  v_mfma_f32_16x16x32_bf16 v[64:67], a[112:115], v[128:131], v[64:67]
  v_exp_f32 v156, v156
  v_mfma_f32_16x16x32_bf16 v[68:71], a[112:115], v[132:135], v[68:71]
  ds_read_b128 a[108:111], v2 offset:27648
  buffer_load_dwordx4 v24, s[12:15], s68 offen offset:2048 sc1 lds
  v_mfma_f32_16x16x32_bf16 v[72:75], a[116:119], v[128:131], v[72:75]
  v_exp_f32 v157, v157
  v_mfma_f32_16x16x32_bf16 v[76:79], a[116:119], v[132:135], v[76:79]
  ds_read_b128 a[112:115], v2 offset:28672
  v_cvt_pk_bf16_f32 v142, v156, v157
  v_mfma_f32_16x16x32_bf16 v[80:83], a[120:123], v[128:131], v[80:83]
  s_waitcnt lgkmcnt(5)
  v_exp_f32 v158, v158
  v_mfma_f32_16x16x32_bf16 v[84:87], a[120:123], v[132:135], v[84:87]
  ds_read_b128 a[116:119], v2 offset:29696
  buffer_load_dwordx4 a[172:175], v3, s[8:11], s37 offen offset:2048 sc1
  v_mfma_f32_16x16x32_bf16 v[88:91], a[124:127], v[128:131], v[88:91]
  v_exp_f32 v159, v159
  v_mfma_f32_16x16x32_bf16 v[92:95], a[124:127], v[132:135], v[92:95]
  ds_read_b128 a[120:123], v2 offset:30720
  v_cvt_pk_bf16_f32 v143, v158, v159
  v_mfma_f32_16x16x32_bf16 a[208:211], v[4:7], v[128:131], a[208:211]
  ds_read_b128 a[124:127], v2 offset:31744
  v_mfma_f32_16x16x32_bf16 a[212:215], v[4:7], v[132:135], a[212:215]
  buffer_load_dwordx4 v24, s[12:15], s68 offen offset:3072 sc1 lds
  v_mfma_f32_16x16x32_bf16 v[144:147], a[64:67], a[32:35], 0
  s_add_u32 m0, s58, 4096
  v_exp_f32 v224, v224
  v_mfma_f32_16x16x32_bf16 v[144:147], a[68:71], a[36:39], v[144:147]
  s_add_u32 s68, s68, 4096
  buffer_load_dwordx4 v24, s[12:15], s68 offen offset:0 sc1 lds
  v_mfma_f32_16x16x32_bf16 v[144:147], a[72:75], a[40:43], v[144:147]
  s_mov_b32 s60, s74
  v_exp_f32 v225, v225
  v_mfma_f32_16x16x32_bf16 v[144:147], a[76:79], a[44:47], v[144:147]
  v_exp_f32 v226, v226
  v_mfma_f32_16x16x32_bf16 v[152:155], a[64:67], a[48:51], 0
  ds_read_b128 a[64:67], v1 offset:16384
  v_cvt_pk_bf16_f32 v128, v224, v225
  v_mfma_f32_16x16x32_bf16 v[152:155], a[68:71], a[52:55], v[152:155]
  v_exp_f32 v227, v227
  v_mfma_f32_16x16x32_bf16 v[152:155], a[72:75], a[56:59], v[152:155]
  ds_read_b128 a[68:71], v1 offset:17408
  v_cvt_pk_bf16_f32 v129, v226, v227
  v_mfma_f32_16x16x32_bf16 v[152:155], a[76:79], a[60:63], v[152:155]
  v_exp_f32 v228, v228
  v_mfma_f32_16x16x32_bf16 v[148:151], a[80:83], a[32:35], 0
  ds_read_b128 a[72:75], v1 offset:18432
  s_mov_b64 exec, s[30:31]
  buffer_load_dwordx4 a[200:203], v240, s[8:11], s37 offen offset:3072 sc1
  buffer_load_dwordx4 a[204:207], v240, s[8:11], s37 offen offset:3584 sc1
  s_mov_b64 exec, -1
  v_mfma_f32_16x16x32_bf16 v[148:151], a[84:87], a[36:39], v[148:151]
  v_exp_f32 v229, v229
  v_mfma_f32_16x16x32_bf16 v[148:151], a[88:91], a[40:43], v[148:151]
  ds_read_b128 a[76:79], v1 offset:19456
  v_cvt_pk_bf16_f32 v130, v228, v229
  v_mfma_f32_16x16x32_bf16 v[148:151], a[92:95], a[44:47], v[148:151]
  v_exp_f32 v230, v230
  v_mfma_f32_16x16x32_bf16 v[156:159], a[80:83], a[48:51], 0
  ds_read_b128 a[80:83], v1 offset:20480
  buffer_load_dwordx4 v24, s[12:15], s68 offen offset:1024 sc1 lds
  v_mfma_f32_16x16x32_bf16 v[156:159], a[84:87], a[52:55], v[156:159]
  s_waitcnt lgkmcnt(5)
  v_exp_f32 v231, v231
  v_mfma_f32_16x16x32_bf16 v[156:159], a[88:91], a[56:59], v[156:159]
  ds_read_b128 a[84:87], v1 offset:21504
  v_cvt_pk_bf16_f32 v131, v230, v231
  v_mfma_f32_16x16x32_bf16 v[156:159], a[92:95], a[60:63], v[156:159]
  ds_read_b128 a[88:91], v1 offset:22528
  s_mov_b32 s59, s74
  v_add_u32 v2, s73, v3
  v_mfma_f32_16x16x32_bf16 v[160:163], a[96:99], v[136:139], v[160:163]
  s_add_u32 s59, s59, 32768
  v_exp_f32 v232, v232
  v_mfma_f32_16x16x32_bf16 v[164:167], a[96:99], v[140:143], v[164:167]
  ds_read_b128 a[92:95], v1 offset:23552
  buffer_load_dword v241, v253, s[8:11], s19 offen offset:0 sc1
  v_mfma_f32_16x16x32_bf16 v[168:171], a[100:103], v[136:139], v[168:171]
  s_cmp_ge_u32 s59, 163840
  v_exp_f32 v233, v233
  v_mfma_f32_16x16x32_bf16 v[172:175], a[100:103], v[140:143], v[172:175]
  ds_read_b128 a[96:99], v2 offset:8192
  v_cvt_pk_bf16_f32 v132, v232, v233
  v_mfma_f32_16x16x32_bf16 v[176:179], a[104:107], v[136:139], v[176:179]
  s_cselect_b32 s59, 0, s59
  v_exp_f32 v234, v234
  v_mfma_f32_16x16x32_bf16 v[180:183], a[104:107], v[140:143], v[180:183]
  ds_read_b128 a[100:103], v2 offset:9216
  v_add_u32 v1, s59, v3
  v_mfma_f32_16x16x32_bf16 v[184:187], a[108:111], v[136:139], v[184:187]
  s_add_u32 s58, s58, 32768
  v_exp_f32 v235, v235
  v_mfma_f32_16x16x32_bf16 v[188:191], a[108:111], v[140:143], v[188:191]
  ds_read_b128 a[104:107], v2 offset:10240
  v_cvt_pk_bf16_f32 v133, v234, v235
  v_mfma_f32_16x16x32_bf16 v[192:195], a[112:115], v[136:139], v[192:195]
  s_cmp_ge_u32 s58, 163840
  v_exp_f32 v236, v236
  v_mfma_f32_16x16x32_bf16 v[196:199], a[112:115], v[140:143], v[196:199]
  ds_read_b128 a[108:111], v2 offset:11264
  buffer_load_dwordx4 v24, s[12:15], s68 offen offset:2048 sc1 lds
  v_mfma_f32_16x16x32_bf16 v[200:203], a[116:119], v[136:139], v[200:203]
  s_cselect_b32 s58, s61, s58
  v_exp_f32 v237, v237
  v_mfma_f32_16x16x32_bf16 v[204:207], a[116:119], v[140:143], v[204:207]
  ds_read_b128 a[112:115], v2 offset:12288
  v_cvt_pk_bf16_f32 v134, v236, v237
  v_mfma_f32_16x16x32_bf16 v[208:211], a[120:123], v[136:139], v[208:211]
  s_waitcnt lgkmcnt(5)
  v_exp_f32 v238, v238
  v_mfma_f32_16x16x32_bf16 v[212:215], a[120:123], v[140:143], v[212:215]
  ds_read_b128 a[116:119], v2 offset:13312
  buffer_load_dword v242, v253, s[8:11], s19 offen offset:128 sc1
  v_mfma_f32_16x16x32_bf16 v[216:219], a[124:127], v[136:139], v[216:219]
  v_exp_f32 v239, v239
  v_mfma_f32_16x16x32_bf16 v[220:223], a[124:127], v[140:143], v[220:223]
  ds_read_b128 a[120:123], v2 offset:14336
  v_cvt_pk_bf16_f32 v135, v238, v239
  v_mfma_f32_16x16x32_bf16 a[216:219], v[4:7], v[136:139], a[216:219]
  ds_read_b128 a[124:127], v2 offset:15360
  v_mfma_f32_16x16x32_bf16 a[220:223], v[4:7], v[140:143], a[220:223]
  buffer_load_dwordx4 v24, s[12:15], s68 offen offset:3072 sc1 lds
  s_branch K2_J
K2_V3:
  v_mfma_f32_16x16x32_bf16 v[144:147], a[64:67], a[0:3], 0
  s_waitcnt vmcnt(4)
  v_exp_f32 v224, v224
  v_mfma_f32_16x16x32_bf16 v[144:147], a[68:71], a[4:7], v[144:147]
  s_barrier
  v_mfma_f32_16x16x32_bf16 v[144:147], a[72:75], a[8:11], v[144:147]
  s_lshl_b32 s68, s57, 15
  v_exp_f32 v225, v225
  v_mfma_f32_16x16x32_bf16 v[144:147], a[76:79], a[12:15], v[144:147]
  s_mov_b32 m0, s58
  v_exp_f32 v226, v226
  v_mfma_f32_16x16x32_bf16 v[152:155], a[64:67], a[16:19], 0
  ds_read_b128 a[64:67], v1 offset:0
  v_cvt_pk_bf16_f32 v128, v224, v225
  v_mfma_f32_16x16x32_bf16 v[152:155], a[68:71], a[20:23], v[152:155]
  s_add_u32 s22, s22, s23
  v_exp_f32 v227, v227
  v_mfma_f32_16x16x32_bf16 v[152:155], a[72:75], a[24:27], v[152:155]
  ds_read_b128 a[68:71], v1 offset:1024
  v_cvt_pk_bf16_f32 v129, v226, v227
  v_mfma_f32_16x16x32_bf16 v[152:155], a[76:79], a[28:31], v[152:155]
  s_add_u32 s19, s22, 56623104
  v_exp_f32 v228, v228
  v_mfma_f32_16x16x32_bf16 v[148:151], a[80:83], a[0:3], 0
  ds_read_b128 a[72:75], v1 offset:2048
  buffer_load_dwordx4 v24, s[12:15], s68 offen offset:0 sc1 lds
  v_mfma_f32_16x16x32_bf16 v[148:151], a[84:87], a[4:7], v[148:151]
  s_lshl_b32 s22, s17, 16
  v_exp_f32 v229, v229
  v_mfma_f32_16x16x32_bf16 v[148:151], a[88:91], a[8:11], v[148:151]
  ds_read_b128 a[76:79], v1 offset:3072
  v_cvt_pk_bf16_f32 v130, v228, v229
  v_mfma_f32_16x16x32_bf16 v[148:151], a[92:95], a[12:15], v[148:151]
  s_lshl_b32 s23, s18, 13
  v_exp_f32 v230, v230
  v_mfma_f32_16x16x32_bf16 v[156:159], a[80:83], a[16:19], 0
  ds_read_b128 a[80:83], v1 offset:4096
  buffer_store_dwordx4 a[128:131], v3, s[8:11], s100 offen offset:0 sc1
  v_mfma_f32_16x16x32_bf16 v[156:159], a[84:87], a[20:23], v[156:159]
  s_waitcnt lgkmcnt(13)
  v_exp_f32 v231, v231
  v_mfma_f32_16x16x32_bf16 v[156:159], a[88:91], a[24:27], v[156:159]
  ds_read_b128 a[84:87], v1 offset:5120
  v_cvt_pk_bf16_f32 v131, v230, v231
  v_mfma_f32_16x16x32_bf16 v[156:159], a[92:95], a[28:31], v[156:159]
  ds_read_b128 a[88:91], v1 offset:6144
  v_add_u32 v2, s59, v3
  v_mfma_f32_16x16x32_bf16 v[160:163], a[96:99], v[136:139], v[160:163]
  s_add_u32 s57, s57, 1
  v_exp_f32 v232, v232
  v_mfma_f32_16x16x32_bf16 v[164:167], a[96:99], v[140:143], v[164:167]
  ds_read_b128 a[92:95], v1 offset:7168
  buffer_load_dwordx4 v24, s[12:15], s68 offen offset:1024 sc1 lds
  v_mfma_f32_16x16x32_bf16 v[168:171], a[100:103], v[136:139], v[168:171]
  s_add_u32 s22, s22, s23
  v_exp_f32 v233, v233
  v_mfma_f32_16x16x32_bf16 v[172:175], a[100:103], v[140:143], v[172:175]
  ds_read_b128 a[96:99], v2 offset:24576
  v_cvt_pk_bf16_f32 v132, v232, v233
  v_mfma_f32_16x16x32_bf16 v[176:179], a[104:107], v[136:139], v[176:179]
  s_add_u32 s22, s22, 50331648
  v_exp_f32 v234, v234
  v_mfma_f32_16x16x32_bf16 v[180:183], a[104:107], v[140:143], v[180:183]
  ds_read_b128 a[100:103], v2 offset:25600
  buffer_store_dwordx4 a[132:135], v3, s[8:11], s100 offen offset:1024 sc1
  v_add_u32 v1, s74, v3
  v_mfma_f32_16x16x32_bf16 v[184:187], a[108:111], v[136:139], v[184:187]
  s_add_u32 s23, s22, 4096
  v_exp_f32 v235, v235
  v_mfma_f32_16x16x32_bf16 v[188:191], a[108:111], v[140:143], v[188:191]
  ds_read_b128 a[104:107], v2 offset:26624
  v_cvt_pk_bf16_f32 v133, v234, v235
  v_mfma_f32_16x16x32_bf16 v[192:195], a[112:115], v[136:139], v[192:195]
  v_exp_f32 v236, v236
  v_mfma_f32_16x16x32_bf16 v[196:199], a[112:115], v[140:143], v[196:199]
  ds_read_b128 a[108:111], v2 offset:27648
  buffer_load_dwordx4 v24, s[12:15], s68 offen offset:2048 sc1 lds
  v_mfma_f32_16x16x32_bf16 v[200:203], a[116:119], v[136:139], v[200:203]
  v_exp_f32 v237, v237
  v_mfma_f32_16x16x32_bf16 v[204:207], a[116:119], v[140:143], v[204:207]
  ds_read_b128 a[112:115], v2 offset:28672
  v_cvt_pk_bf16_f32 v134, v236, v237
  v_mfma_f32_16x16x32_bf16 v[208:211], a[120:123], v[136:139], v[208:211]
  s_waitcnt lgkmcnt(5)
  v_exp_f32 v238, v238
  v_mfma_f32_16x16x32_bf16 v[212:215], a[120:123], v[140:143], v[212:215]
  ds_read_b128 a[116:119], v2 offset:29696
  buffer_store_dwordx4 a[136:139], v3, s[8:11], s100 offen offset:2048 sc1
  v_mfma_f32_16x16x32_bf16 v[216:219], a[124:127], v[136:139], v[216:219]
  v_exp_f32 v239, v239
  v_mfma_f32_16x16x32_bf16 v[220:223], a[124:127], v[140:143], v[220:223]
  ds_read_b128 a[120:123], v2 offset:30720
  v_cvt_pk_bf16_f32 v135, v238, v239
  v_mfma_f32_16x16x32_bf16 a[216:219], v[4:7], v[136:139], a[216:219]
  ds_read_b128 a[124:127], v2 offset:31744
  buffer_store_dwordx4 a[140:143], v3, s[8:11], s100 offen offset:3072 sc1
  v_mfma_f32_16x16x32_bf16 a[220:223], v[4:7], v[140:143], a[220:223]
  buffer_load_dwordx4 v24, s[12:15], s68 offen offset:3072 sc1 lds
  v_mfma_f32_16x16x32_bf16 v[224:227], a[64:67], a[0:3], 0
  s_add_u32 m0, s58, 4096
  v_exp_f32 v144, v144
  v_mfma_f32_16x16x32_bf16 v[224:227], a[68:71], a[4:7], v[224:227]
  s_add_u32 s68, s68, 4096
  buffer_load_dwordx4 v24, s[12:15], s68 offen offset:0 sc1 lds
  v_mfma_f32_16x16x32_bf16 v[224:227], a[72:75], a[8:11], v[224:227]
  v_exp_f32 v145, v145
  v_mfma_f32_16x16x32_bf16 v[224:227], a[76:79], a[12:15], v[224:227]
  v_exp_f32 v146, v146
  v_mfma_f32_16x16x32_bf16 v[232:235], a[64:67], a[16:19], 0
  ds_read_b128 a[64:67], v1 offset:16384
  v_cvt_pk_bf16_f32 v136, v144, v145
  v_mfma_f32_16x16x32_bf16 v[232:235], a[68:71], a[20:23], v[232:235]
  v_exp_f32 v147, v147
  v_mfma_f32_16x16x32_bf16 v[232:235], a[72:75], a[24:27], v[232:235]
  ds_read_b128 a[68:71], v1 offset:17408
  v_cvt_pk_bf16_f32 v137, v146, v147
  v_mfma_f32_16x16x32_bf16 v[232:235], a[76:79], a[28:31], v[232:235]
  v_exp_f32 v148, v148
  v_mfma_f32_16x16x32_bf16 v[228:231], a[80:83], a[0:3], 0
  ds_read_b128 a[72:75], v1 offset:18432
  buffer_load_dwordx4 a[128:131], v3, s[8:11], s22 offen offset:0 sc1
  v_mfma_f32_16x16x32_bf16 v[228:231], a[84:87], a[4:7], v[228:231]
  v_exp_f32 v149, v149
  v_mfma_f32_16x16x32_bf16 v[228:231], a[88:91], a[8:11], v[228:231]
  ds_read_b128 a[76:79], v1 offset:19456
  v_cvt_pk_bf16_f32 v138, v148, v149
  v_mfma_f32_16x16x32_bf16 v[228:231], a[92:95], a[12:15], v[228:231]
  v_exp_f32 v150, v150
  v_mfma_f32_16x16x32_bf16 v[236:239], a[80:83], a[16:19], 0
  ds_read_b128 a[80:83], v1 offset:20480
  buffer_load_dwordx4 v24, s[12:15], s68 offen offset:1024 sc1 lds
  v_mfma_f32_16x16x32_bf16 v[236:239], a[84:87], a[20:23], v[236:239]
  s_waitcnt lgkmcnt(5)
  v_exp_f32 v151, v151
  v_mfma_f32_16x16x32_bf16 v[236:239], a[88:91], a[24:27], v[236:239]
  ds_read_b128 a[84:87], v1 offset:21504
  v_cvt_pk_bf16_f32 v139, v150, v151
  v_mfma_f32_16x16x32_bf16 v[236:239], a[92:95], a[28:31], v[236:239]
  ds_read_b128 a[88:91], v1 offset:22528
  v_add_u32 v2, s59, v3
  v_mfma_f32_16x16x32_bf16 v[160:163], a[96:99], v[128:131], v[160:163]
  v_exp_f32 v152, v152
  v_mfma_f32_16x16x32_bf16 v[164:167], a[96:99], v[132:135], v[164:167]
  ds_read_b128 a[92:95], v1 offset:23552
  buffer_load_dwordx4 a[132:135], v3, s[8:11], s22 offen offset:1024 sc1
  v_mfma_f32_16x16x32_bf16 v[168:171], a[100:103], v[128:131], v[168:171]
  v_exp_f32 v153, v153
  v_mfma_f32_16x16x32_bf16 v[172:175], a[100:103], v[132:135], v[172:175]
  ds_read_b128 a[96:99], v2 offset:24576
  v_cvt_pk_bf16_f32 v140, v152, v153
  v_mfma_f32_16x16x32_bf16 v[176:179], a[104:107], v[128:131], v[176:179]
  v_exp_f32 v154, v154
  v_mfma_f32_16x16x32_bf16 v[180:183], a[104:107], v[132:135], v[180:183]
  ds_read_b128 a[100:103], v2 offset:25600
  v_add_u32 v1, s73, v3
  v_mfma_f32_16x16x32_bf16 v[184:187], a[108:111], v[128:131], v[184:187]
  s_add_u32 s58, s58, 32768
  v_exp_f32 v155, v155
  v_mfma_f32_16x16x32_bf16 v[188:191], a[108:111], v[132:135], v[188:191]
  ds_read_b128 a[104:107], v2 offset:26624
  v_cvt_pk_bf16_f32 v141, v154, v155
  v_mfma_f32_16x16x32_bf16 v[192:195], a[112:115], v[128:131], v[192:195]
  s_cmp_ge_u32 s58, 163840
  v_exp_f32 v156, v156
  v_mfma_f32_16x16x32_bf16 v[196:199], a[112:115], v[132:135], v[196:199]
  ds_read_b128 a[108:111], v2 offset:27648
  buffer_load_dwordx4 v24, s[12:15], s68 offen offset:2048 sc1 lds
  buffer_load_dwordx4 a[136:139], v3, s[8:11], s22 offen offset:2048 sc1
  v_mfma_f32_16x16x32_bf16 v[200:203], a[116:119], v[128:131], v[200:203]
  s_cselect_b32 s58, s61, s58
  v_exp_f32 v157, v157
  v_mfma_f32_16x16x32_bf16 v[204:207], a[116:119], v[132:135], v[204:207]
  ds_read_b128 a[112:115], v2 offset:28672
  v_cvt_pk_bf16_f32 v142, v156, v157
  v_mfma_f32_16x16x32_bf16 v[208:211], a[120:123], v[128:131], v[208:211]
  s_waitcnt lgkmcnt(5)
  v_exp_f32 v158, v158
  v_mfma_f32_16x16x32_bf16 v[212:215], a[120:123], v[132:135], v[212:215]
  ds_read_b128 a[116:119], v2 offset:29696
  v_mfma_f32_16x16x32_bf16 v[216:219], a[124:127], v[128:131], v[216:219]
  v_exp_f32 v159, v159
  v_mfma_f32_16x16x32_bf16 v[220:223], a[124:127], v[132:135], v[220:223]
  ds_read_b128 a[120:123], v2 offset:30720
  v_cvt_pk_bf16_f32 v143, v158, v159
  v_mfma_f32_16x16x32_bf16 a[216:219], v[4:7], v[128:131], a[216:219]
  ds_read_b128 a[124:127], v2 offset:31744
  buffer_load_dwordx4 a[140:143], v3, s[8:11], s22 offen offset:3072 sc1
  v_mfma_f32_16x16x32_bf16 a[220:223], v[4:7], v[132:135], a[220:223]
  buffer_load_dwordx4 v24, s[12:15], s68 offen offset:3072 sc1 lds
  v_mfma_f32_16x16x32_bf16 v[144:147], a[64:67], a[0:3], v[96:99]
  s_mov_b64 s[32:33], s[48:49]
  v_exp_f32 v224, v224
  v_mfma_f32_16x16x32_bf16 v[144:147], a[68:71], a[4:7], v[144:147]
  s_lshl_b32 s26, s16, 14
  s_mul_i32 s27, s17, 589824
  s_add_u32 s27, s27, 57671680
  v_mfma_f32_16x16x32_bf16 v[144:147], a[72:75], a[8:11], v[144:147]
  s_lshl_b32 s24, s16, 16
  v_exp_f32 v225, v225
  v_mfma_f32_16x16x32_bf16 v[144:147], a[76:79], a[12:15], v[144:147]
  s_add_u32 s24, s24, s27
  v_exp_f32 v226, v226
  v_mfma_f32_16x16x32_bf16 v[152:155], a[64:67], a[16:19], v[104:107]
  ds_read_b128 a[64:67], v1 offset:0
  v_cvt_pk_bf16_f32 v128, v224, v225
  v_mfma_f32_16x16x32_bf16 v[152:155], a[68:71], a[20:23], v[152:155]
  s_lshl_b32 s39, s18, 19
  v_exp_f32 v227, v227
  v_mfma_f32_16x16x32_bf16 v[152:155], a[72:75], a[24:27], v[152:155]
  ds_read_b128 a[68:71], v1 offset:1024
  v_cvt_pk_bf16_f32 v129, v226, v227
  v_mfma_f32_16x16x32_bf16 v[152:155], a[76:79], a[28:31], v[152:155]
  s_lshl_b32 s25, s16, 17
  v_exp_f32 v228, v228
  v_mfma_f32_16x16x32_bf16 v[148:151], a[80:83], a[0:3], v[100:103]
  ds_read_b128 a[72:75], v1 offset:2048
  buffer_load_dwordx4 a[144:147], v3, s[8:11], s23 offen offset:0 sc1
  v_mfma_f32_16x16x32_bf16 v[148:151], a[84:87], a[4:7], v[148:151]
  s_add_u32 s39, s39, s25
  v_exp_f32 v229, v229
  v_mfma_f32_16x16x32_bf16 v[148:151], a[88:91], a[8:11], v[148:151]
  ds_read_b128 a[76:79], v1 offset:3072
  v_cvt_pk_bf16_f32 v130, v228, v229
  v_mfma_f32_16x16x32_bf16 v[148:151], a[92:95], a[12:15], v[148:151]
  s_lshl_b32 s28, s18, 7
  v_exp_f32 v230, v230
  v_mfma_f32_16x16x32_bf16 v[156:159], a[80:83], a[16:19], v[108:111]
  ds_read_b128 a[80:83], v1 offset:4096
  buffer_load_dwordx4 a[148:151], v3, s[8:11], s23 offen offset:1024 sc1
  v_mfma_f32_16x16x32_bf16 v[156:159], a[84:87], a[20:23], v[156:159]
  s_waitcnt lgkmcnt(5)
  v_exp_f32 v231, v231
  v_mfma_f32_16x16x32_bf16 v[156:159], a[88:91], a[24:27], v[156:159]
  ds_read_b128 a[84:87], v1 offset:5120
  v_cvt_pk_bf16_f32 v131, v230, v231
  v_mfma_f32_16x16x32_bf16 v[156:159], a[92:95], a[28:31], v[156:159]
  ds_read_b128 a[88:91], v1 offset:6144
  v_add_u32 v2, s74, v3
  v_mfma_f32_16x16x32_bf16 v[32:35], a[96:99], v[136:139], v[32:35]
  s_sub_u32 s28, s28, 32768
  v_exp_f32 v232, v232
  v_mfma_f32_16x16x32_bf16 v[36:39], a[96:99], v[140:143], v[36:39]
  ds_read_b128 a[92:95], v1 offset:7168
  buffer_load_dwordx4 a[152:155], v3, s[8:11], s23 offen offset:2048 sc1
  v_mfma_f32_16x16x32_bf16 v[40:43], a[100:103], v[136:139], v[40:43]
  s_add_u32 s25, s25, s28
  v_exp_f32 v233, v233
  v_mfma_f32_16x16x32_bf16 v[44:47], a[100:103], v[140:143], v[44:47]
  ds_read_b128 a[96:99], v2 offset:8192
  v_cvt_pk_bf16_f32 v132, v232, v233
  v_mfma_f32_16x16x32_bf16 v[48:51], a[104:107], v[136:139], v[48:51]
  s_add_u32 s20, s36, 8192
  v_exp_f32 v234, v234
  v_mfma_f32_16x16x32_bf16 v[52:55], a[104:107], v[140:143], v[52:55]
  ds_read_b128 a[100:103], v2 offset:9216
  buffer_load_dwordx4 a[156:159], v3, s[8:11], s23 offen offset:3072 sc1
  v_add_u32 v1, s74, v3
  v_mfma_f32_16x16x32_bf16 v[56:59], a[108:111], v[136:139], v[56:59]
  s_mov_b32 s21, s20
  v_exp_f32 v235, v235
  v_mfma_f32_16x16x32_bf16 v[60:63], a[108:111], v[140:143], v[60:63]
  ds_read_b128 a[104:107], v2 offset:10240
  v_cvt_pk_bf16_f32 v133, v234, v235
  v_mfma_f32_16x16x32_bf16 v[64:67], a[112:115], v[136:139], v[64:67]
  v_exp_f32 v236, v236
  v_mfma_f32_16x16x32_bf16 v[68:71], a[112:115], v[140:143], v[68:71]
  ds_read_b128 a[108:111], v2 offset:11264
  buffer_load_dwordx4 a[160:163], v3, s[8:11], s36 offen offset:0 sc1
  v_mfma_f32_16x16x32_bf16 v[72:75], a[116:119], v[136:139], v[72:75]
  v_exp_f32 v237, v237
  v_mfma_f32_16x16x32_bf16 v[76:79], a[116:119], v[140:143], v[76:79]
  ds_read_b128 a[112:115], v2 offset:12288
  v_cvt_pk_bf16_f32 v134, v236, v237
  v_mfma_f32_16x16x32_bf16 v[80:83], a[120:123], v[136:139], v[80:83]
  s_waitcnt lgkmcnt(5)
  v_exp_f32 v238, v238
  v_mfma_f32_16x16x32_bf16 v[84:87], a[120:123], v[140:143], v[84:87]
  ds_read_b128 a[116:119], v2 offset:13312
  s_mov_b64 exec, s[30:31]
  buffer_load_dwordx4 a[176:179], v240, s[8:11], s36 offen offset:1024 sc1
  buffer_load_dwordx4 a[180:183], v240, s[8:11], s36 offen offset:1536 sc1
  s_mov_b64 exec, -1
  v_mfma_f32_16x16x32_bf16 v[88:91], a[124:127], v[136:139], v[88:91]
  v_exp_f32 v239, v239
  v_mfma_f32_16x16x32_bf16 v[92:95], a[124:127], v[140:143], v[92:95]
  ds_read_b128 a[120:123], v2 offset:14336
  v_cvt_pk_bf16_f32 v135, v238, v239
  v_mfma_f32_16x16x32_bf16 a[208:211], v[4:7], v[136:139], a[208:211]
  ds_read_b128 a[124:127], v2 offset:15360
  buffer_load_dwordx4 a[164:167], v3, s[8:11], s36 offen offset:2048 sc1
  v_mfma_f32_16x16x32_bf16 a[212:215], v[4:7], v[140:143], a[212:215]
  s_mov_b64 exec, s[30:31]
  buffer_load_dwordx4 a[184:187], v240, s[8:11], s36 offen offset:3072 sc1
  buffer_load_dwordx4 a[188:191], v240, s[8:11], s36 offen offset:3584 sc1
  s_mov_b64 exec, -1
  v_mfma_f32_16x16x32_bf16 v[224:227], a[64:67], a[32:35], v[96:99]
  v_exp_f32 v144, v144
  v_mfma_f32_16x16x32_bf16 v[224:227], a[68:71], a[36:39], v[224:227]
  s_barrier
  v_mfma_f32_16x16x32_bf16 v[224:227], a[72:75], a[40:43], v[224:227]
  s_lshl_b32 s68, s57, 15
  v_exp_f32 v145, v145
  v_mfma_f32_16x16x32_bf16 v[224:227], a[76:79], a[44:47], v[224:227]
  s_mov_b32 m0, s58
  v_exp_f32 v146, v146
  v_mfma_f32_16x16x32_bf16 v[232:235], a[64:67], a[48:51], v[104:107]
  ds_read_b128 a[64:67], v1 offset:0
  v_cvt_pk_bf16_f32 v136, v144, v145
  v_mfma_f32_16x16x32_bf16 v[232:235], a[68:71], a[52:55], v[232:235]
  v_exp_f32 v147, v147
  v_mfma_f32_16x16x32_bf16 v[232:235], a[72:75], a[56:59], v[232:235]
  ds_read_b128 a[68:71], v1 offset:1024
  v_cvt_pk_bf16_f32 v137, v146, v147
  v_mfma_f32_16x16x32_bf16 v[232:235], a[76:79], a[60:63], v[232:235]
  v_exp_f32 v148, v148
  v_mfma_f32_16x16x32_bf16 v[228:231], a[80:83], a[32:35], v[100:103]
  ds_read_b128 a[72:75], v1 offset:2048
  buffer_load_dwordx4 v24, s[12:15], s68 offen offset:0 sc1 lds
  buffer_load_dwordx4 a[168:171], v3, s[8:11], s37 offen offset:0 sc1
  v_mfma_f32_16x16x32_bf16 v[228:231], a[84:87], a[36:39], v[228:231]
  v_exp_f32 v149, v149
  v_mfma_f32_16x16x32_bf16 v[228:231], a[88:91], a[40:43], v[228:231]
  ds_read_b128 a[76:79], v1 offset:3072
  v_cvt_pk_bf16_f32 v138, v148, v149
  v_mfma_f32_16x16x32_bf16 v[228:231], a[92:95], a[44:47], v[228:231]
  v_exp_f32 v150, v150
  v_mfma_f32_16x16x32_bf16 v[236:239], a[80:83], a[48:51], v[108:111]
  ds_read_b128 a[80:83], v1 offset:4096
  v_mfma_f32_16x16x32_bf16 v[236:239], a[84:87], a[52:55], v[236:239]
  s_waitcnt lgkmcnt(5)
  v_exp_f32 v151, v151
  v_mfma_f32_16x16x32_bf16 v[236:239], a[88:91], a[56:59], v[236:239]
  ds_read_b128 a[84:87], v1 offset:5120
  v_cvt_pk_bf16_f32 v139, v150, v151
  v_mfma_f32_16x16x32_bf16 v[236:239], a[92:95], a[60:63], v[236:239]
  ds_read_b128 a[88:91], v1 offset:6144
  v_add_u32 v2, s74, v3
  v_mfma_f32_16x16x32_bf16 v[32:35], a[96:99], v[128:131], v[32:35]
  s_add_u32 s57, s57, 1
  v_exp_f32 v152, v152
  v_mfma_f32_16x16x32_bf16 v[36:39], a[96:99], v[132:135], v[36:39]
  ds_read_b128 a[92:95], v1 offset:7168
  buffer_load_dwordx4 v24, s[12:15], s68 offen offset:1024 sc1 lds
  s_mov_b64 exec, s[30:31]
  buffer_load_dwordx4 a[192:195], v240, s[8:11], s37 offen offset:1024 sc1
  buffer_load_dwordx4 a[196:199], v240, s[8:11], s37 offen offset:1536 sc1
  s_mov_b64 exec, -1
  v_mfma_f32_16x16x32_bf16 v[40:43], a[100:103], v[128:131], v[40:43]
  v_exp_f32 v153, v153
  v_mfma_f32_16x16x32_bf16 v[44:47], a[100:103], v[132:135], v[44:47]
  ds_read_b128 a[96:99], v2 offset:24576
  v_cvt_pk_bf16_f32 v140, v152, v153
  v_mfma_f32_16x16x32_bf16 v[48:51], a[104:107], v[128:131], v[48:51]
  v_exp_f32 v154, v154
  v_mfma_f32_16x16x32_bf16 v[52:55], a[104:107], v[132:135], v[52:55]
  ds_read_b128 a[100:103], v2 offset:25600
  v_add_u32 v1, s74, v3
  v_mfma_f32_16x16x32_bf16 v[56:59], a[108:111], v[128:131], v[56:59]
  v_exp_f32 v155, v155
  v_mfma_f32_16x16x32_bf16 v[60:63], a[108:111], v[132:135], v[60:63]
  ds_read_b128 a[104:107], v2 offset:26624
  v_cvt_pk_bf16_f32 v141, v154, v155
  v_mfma_f32_16x16x32_bf16 v[64:67], a[112:115], v[128:131], v[64:67]
  v_exp_f32 v156, v156
  v_mfma_f32_16x16x32_bf16 v[68:71], a[112:115], v[132:135], v[68:71]
  ds_read_b128 a[108:111], v2 offset:27648
  buffer_load_dwordx4 v24, s[12:15], s68 offen offset:2048 sc1 lds
  v_mfma_f32_16x16x32_bf16 v[72:75], a[116:119], v[128:131], v[72:75]
  v_exp_f32 v157, v157
  v_mfma_f32_16x16x32_bf16 v[76:79], a[116:119], v[132:135], v[76:79]
  ds_read_b128 a[112:115], v2 offset:28672
  v_cvt_pk_bf16_f32 v142, v156, v157
  v_mfma_f32_16x16x32_bf16 v[80:83], a[120:123], v[128:131], v[80:83]
  s_waitcnt lgkmcnt(5)
  v_exp_f32 v158, v158
  v_mfma_f32_16x16x32_bf16 v[84:87], a[120:123], v[132:135], v[84:87]
  ds_read_b128 a[116:119], v2 offset:29696
  buffer_load_dwordx4 a[172:175], v3, s[8:11], s37 offen offset:2048 sc1
  v_mfma_f32_16x16x32_bf16 v[88:91], a[124:127], v[128:131], v[88:91]
  v_exp_f32 v159, v159
  v_mfma_f32_16x16x32_bf16 v[92:95], a[124:127], v[132:135], v[92:95]
  ds_read_b128 a[120:123], v2 offset:30720
  v_cvt_pk_bf16_f32 v143, v158, v159
  v_mfma_f32_16x16x32_bf16 a[208:211], v[4:7], v[128:131], a[208:211]
  ds_read_b128 a[124:127], v2 offset:31744
  v_mfma_f32_16x16x32_bf16 a[212:215], v[4:7], v[132:135], a[212:215]
  buffer_load_dwordx4 v24, s[12:15], s68 offen offset:3072 sc1 lds
  v_mfma_f32_16x16x32_bf16 v[144:147], a[64:67], a[32:35], 0
  s_add_u32 m0, s58, 4096
  v_exp_f32 v224, v224
  v_mfma_f32_16x16x32_bf16 v[144:147], a[68:71], a[36:39], v[144:147]
  s_add_u32 s68, s68, 4096
  buffer_load_dwordx4 v24, s[12:15], s68 offen offset:0 sc1 lds
  v_mfma_f32_16x16x32_bf16 v[144:147], a[72:75], a[40:43], v[144:147]
  s_mov_b32 s60, s74
  v_exp_f32 v225, v225
  v_mfma_f32_16x16x32_bf16 v[144:147], a[76:79], a[44:47], v[144:147]
  v_exp_f32 v226, v226
  v_mfma_f32_16x16x32_bf16 v[152:155], a[64:67], a[48:51], 0
  ds_read_b128 a[64:67], v1 offset:16384
  v_cvt_pk_bf16_f32 v128, v224, v225
  v_mfma_f32_16x16x32_bf16 v[152:155], a[68:71], a[52:55], v[152:155]
  v_exp_f32 v227, v227
  v_mfma_f32_16x16x32_bf16 v[152:155], a[72:75], a[56:59], v[152:155]
  ds_read_b128 a[68:71], v1 offset:17408
  v_cvt_pk_bf16_f32 v129, v226, v227
  v_mfma_f32_16x16x32_bf16 v[152:155], a[76:79], a[60:63], v[152:155]
  v_exp_f32 v228, v228
  v_mfma_f32_16x16x32_bf16 v[148:151], a[80:83], a[32:35], 0
  ds_read_b128 a[72:75], v1 offset:18432
  s_mov_b64 exec, s[30:31]
  buffer_load_dwordx4 a[200:203], v240, s[8:11], s37 offen offset:3072 sc1
  buffer_load_dwordx4 a[204:207], v240, s[8:11], s37 offen offset:3584 sc1
  s_mov_b64 exec, -1
  v_mfma_f32_16x16x32_bf16 v[148:151], a[84:87], a[36:39], v[148:151]
  v_exp_f32 v229, v229
  v_mfma_f32_16x16x32_bf16 v[148:151], a[88:91], a[40:43], v[148:151]
  ds_read_b128 a[76:79], v1 offset:19456
  v_cvt_pk_bf16_f32 v130, v228, v229
  v_mfma_f32_16x16x32_bf16 v[148:151], a[92:95], a[44:47], v[148:151]
  v_exp_f32 v230, v230
  v_mfma_f32_16x16x32_bf16 v[156:159], a[80:83], a[48:51], 0
  ds_read_b128 a[80:83], v1 offset:20480
  buffer_load_dwordx4 v24, s[12:15], s68 offen offset:1024 sc1 lds
  v_mfma_f32_16x16x32_bf16 v[156:159], a[84:87], a[52:55], v[156:159]
  s_waitcnt lgkmcnt(5)
  v_exp_f32 v231, v231
  v_mfma_f32_16x16x32_bf16 v[156:159], a[88:91], a[56:59], v[156:159]
  ds_read_b128 a[84:87], v1 offset:21504
  v_cvt_pk_bf16_f32 v131, v230, v231
  v_mfma_f32_16x16x32_bf16 v[156:159], a[92:95], a[60:63], v[156:159]
  ds_read_b128 a[88:91], v1 offset:22528
  s_mov_b32 s59, s74
  v_add_u32 v2, s73, v3
  v_mfma_f32_16x16x32_bf16 v[32:35], a[96:99], v[136:139], v[32:35]
  s_add_u32 s59, s59, 32768
  v_exp_f32 v232, v232
  v_mfma_f32_16x16x32_bf16 v[36:39], a[96:99], v[140:143], v[36:39]
  ds_read_b128 a[92:95], v1 offset:23552
  buffer_load_dword v241, v253, s[8:11], s19 offen offset:0 sc1
  v_mfma_f32_16x16x32_bf16 v[40:43], a[100:103], v[136:139], v[40:43]
  s_cmp_ge_u32 s59, 163840
  v_exp_f32 v233, v233
  v_mfma_f32_16x16x32_bf16 v[44:47], a[100:103], v[140:143], v[44:47]
  ds_read_b128 a[96:99], v2 offset:8192
  v_cvt_pk_bf16_f32 v132, v232, v233
  v_mfma_f32_16x16x32_bf16 v[48:51], a[104:107], v[136:139], v[48:51]
  s_cselect_b32 s59, 0, s59
  v_exp_f32 v234, v234
  v_mfma_f32_16x16x32_bf16 v[52:55], a[104:107], v[140:143], v[52:55]
  ds_read_b128 a[100:103], v2 offset:9216
  v_add_u32 v1, s59, v3
  v_mfma_f32_16x16x32_bf16 v[56:59], a[108:111], v[136:139], v[56:59]
  s_add_u32 s58, s58, 32768
  v_exp_f32 v235, v235
  v_mfma_f32_16x16x32_bf16 v[60:63], a[108:111], v[140:143], v[60:63]
  ds_read_b128 a[104:107], v2 offset:10240
  v_cvt_pk_bf16_f32 v133, v234, v235
  v_mfma_f32_16x16x32_bf16 v[64:67], a[112:115], v[136:139], v[64:67]
  s_cmp_ge_u32 s58, 163840
  v_exp_f32 v236, v236
  v_mfma_f32_16x16x32_bf16 v[68:71], a[112:115], v[140:143], v[68:71]
  ds_read_b128 a[108:111], v2 offset:11264
  buffer_load_dwordx4 v24, s[12:15], s68 offen offset:2048 sc1 lds
  v_mfma_f32_16x16x32_bf16 v[72:75], a[116:119], v[136:139], v[72:75]
  s_cselect_b32 s58, s61, s58
  v_exp_f32 v237, v237
  v_mfma_f32_16x16x32_bf16 v[76:79], a[116:119], v[140:143], v[76:79]
  ds_read_b128 a[112:115], v2 offset:12288
  v_cvt_pk_bf16_f32 v134, v236, v237
  v_mfma_f32_16x16x32_bf16 v[80:83], a[120:123], v[136:139], v[80:83]
  s_waitcnt lgkmcnt(5)
  v_exp_f32 v238, v238
  v_mfma_f32_16x16x32_bf16 v[84:87], a[120:123], v[140:143], v[84:87]
  ds_read_b128 a[116:119], v2 offset:13312
  buffer_load_dword v242, v253, s[8:11], s19 offen offset:128 sc1
  v_mfma_f32_16x16x32_bf16 v[88:91], a[124:127], v[136:139], v[88:91]
  v_exp_f32 v239, v239
  v_mfma_f32_16x16x32_bf16 v[92:95], a[124:127], v[140:143], v[92:95]
  ds_read_b128 a[120:123], v2 offset:14336
  v_cvt_pk_bf16_f32 v135, v238, v239
  v_mfma_f32_16x16x32_bf16 a[208:211], v[4:7], v[136:139], a[208:211]
  ds_read_b128 a[124:127], v2 offset:15360
  v_mfma_f32_16x16x32_bf16 a[212:215], v[4:7], v[140:143], a[212:215]
  buffer_load_dwordx4 v24, s[12:15], s68 offen offset:3072 sc1 lds
  s_branch K2_J
K2_SLOW:
  s_waitcnt vmcnt(0)
  s_lshl_b32 s14, s64, 15
  v_mov_b32 v16, 0xf149f2ca
  v_mov_b32 v17, 0xf149f2ca
  s_mov_b32 s56, 0
K2_SML:
  s_lshl_b32 s62, s56, 14
  s_add_u32 s62, s62, 0
  s_add_u32 s63, s62, 4096
  buffer_load_dwordx4 a[64:67], v3, s[12:15], s62 offen offset:0 sc1
  buffer_load_dwordx4 a[68:71], v3, s[12:15], s62 offen offset:1024 sc1
  buffer_load_dwordx4 a[72:75], v3, s[12:15], s62 offen offset:2048 sc1
  buffer_load_dwordx4 a[76:79], v3, s[12:15], s62 offen offset:3072 sc1
  buffer_load_dwordx4 a[80:83], v3, s[12:15], s63 offen offset:0 sc1
  buffer_load_dwordx4 a[84:87], v3, s[12:15], s63 offen offset:1024 sc1
  buffer_load_dwordx4 a[88:91], v3, s[12:15], s63 offen offset:2048 sc1
  buffer_load_dwordx4 a[92:95], v3, s[12:15], s63 offen offset:3072 sc1
  s_sub_u32 s67, s56, s65
  s_cmp_lt_i32 s67, 0
  s_cselect_b32 s62, 0, 0xf149f2ca
  v_mov_b32 v25, s62
  s_cmp_le_i32 s67, 0
  s_cselect_b32 s62, 0, 0xf149f2ca
  v_mov_b32 v28, s62
  s_add_u32 s67, s67, 1
  v_med3_f32 v112, v96, v25, v28
  v_med3_f32 v113, v97, v25, v28
  v_med3_f32 v114, v98, v25, v28
  v_med3_f32 v115, v99, v25, v28
  v_med3_f32 v116, v100, v25, v28
  v_med3_f32 v117, v101, v25, v28
  v_med3_f32 v118, v102, v25, v28
  v_med3_f32 v119, v103, v25, v28
  v_med3_f32 v120, v104, v25, v28
  v_med3_f32 v121, v105, v25, v28
  v_med3_f32 v122, v106, v25, v28
  v_med3_f32 v123, v107, v25, v28
  v_med3_f32 v124, v108, v25, v28
  v_med3_f32 v125, v109, v25, v28
  v_med3_f32 v126, v110, v25, v28
  v_med3_f32 v127, v111, v25, v28
  s_nop 1
  s_waitcnt vmcnt(0)
  v_mfma_f32_16x16x32_bf16 v[224:227], a[64:67], a[0:3], v[112:115]
  v_mfma_f32_16x16x32_bf16 v[224:227], a[68:71], a[4:7], v[224:227]
  v_mfma_f32_16x16x32_bf16 v[224:227], a[72:75], a[8:11], v[224:227]
  v_mfma_f32_16x16x32_bf16 v[224:227], a[76:79], a[12:15], v[224:227]
  v_mfma_f32_16x16x32_bf16 v[232:235], a[64:67], a[16:19], v[120:123]
  v_mfma_f32_16x16x32_bf16 v[232:235], a[68:71], a[20:23], v[232:235]
  v_mfma_f32_16x16x32_bf16 v[232:235], a[72:75], a[24:27], v[232:235]
  v_mfma_f32_16x16x32_bf16 v[232:235], a[76:79], a[28:31], v[232:235]
  v_mfma_f32_16x16x32_bf16 v[228:231], a[80:83], a[0:3], v[116:119]
  v_mfma_f32_16x16x32_bf16 v[228:231], a[84:87], a[4:7], v[228:231]
  v_mfma_f32_16x16x32_bf16 v[228:231], a[88:91], a[8:11], v[228:231]
  v_mfma_f32_16x16x32_bf16 v[228:231], a[92:95], a[12:15], v[228:231]
  v_mfma_f32_16x16x32_bf16 v[236:239], a[80:83], a[16:19], v[124:127]
  v_mfma_f32_16x16x32_bf16 v[236:239], a[84:87], a[20:23], v[236:239]
  v_mfma_f32_16x16x32_bf16 v[236:239], a[88:91], a[24:27], v[236:239]
  v_mfma_f32_16x16x32_bf16 v[236:239], a[92:95], a[28:31], v[236:239]
  s_nop 15
  v_max_f32 v16, v16, v224
  v_max_f32 v16, v16, v225
  v_max_f32 v16, v16, v226
  v_max_f32 v16, v16, v227
  v_max_f32 v16, v16, v228
  v_max_f32 v16, v16, v229
  v_max_f32 v16, v16, v230
  v_max_f32 v16, v16, v231
  v_max_f32 v17, v17, v232
  v_max_f32 v17, v17, v233
  v_max_f32 v17, v17, v234
  v_max_f32 v17, v17, v235
  v_max_f32 v17, v17, v236
  v_max_f32 v17, v17, v237
  v_max_f32 v17, v17, v238
  v_max_f32 v17, v17, v239
  s_add_u32 s56, s56, 1
  s_cmp_le_u32 s56, s65
  s_cbranch_scc1 K2_SML
  v_mov_b32 v18, v16
  s_nop 1
  v_permlane16_swap_b32 v16, v18
  v_max_f32 v16, v16, v18
  v_mov_b32 v18, v16
  s_nop 1
  v_permlane32_swap_b32 v16, v18
  v_max_f32 v16, v16, v18
  v_mov_b32 v18, v17
  s_nop 1
  v_permlane16_swap_b32 v17, v18
  v_max_f32 v17, v17, v18
  v_mov_b32 v18, v17
  s_nop 1
  v_permlane32_swap_b32 v17, v18
  v_max_f32 v17, v17, v18
  v_mov_b32 v32, 0
  v_mov_b32 v33, 0
  v_mov_b32 v34, 0
  v_mov_b32 v35, 0
  v_mov_b32 v36, 0
  v_mov_b32 v37, 0
  v_mov_b32 v38, 0
  v_mov_b32 v39, 0
  v_mov_b32 v40, 0
  v_mov_b32 v41, 0
  v_mov_b32 v42, 0
  v_mov_b32 v43, 0
  v_mov_b32 v44, 0
  v_mov_b32 v45, 0
  v_mov_b32 v46, 0
  v_mov_b32 v47, 0
  v_mov_b32 v48, 0
  v_mov_b32 v49, 0
  v_mov_b32 v50, 0
  v_mov_b32 v51, 0
  v_mov_b32 v52, 0
  v_mov_b32 v53, 0
  v_mov_b32 v54, 0
  v_mov_b32 v55, 0
  v_mov_b32 v56, 0
  v_mov_b32 v57, 0
  v_mov_b32 v58, 0
  v_mov_b32 v59, 0
  v_mov_b32 v60, 0
  v_mov_b32 v61, 0
  v_mov_b32 v62, 0
  v_mov_b32 v63, 0
  v_mov_b32 v64, 0
  v_mov_b32 v65, 0
  v_mov_b32 v66, 0
  v_mov_b32 v67, 0
  v_mov_b32 v68, 0
  v_mov_b32 v69, 0
  v_mov_b32 v70, 0
  v_mov_b32 v71, 0
  v_mov_b32 v72, 0
  v_mov_b32 v73, 0
  v_mov_b32 v74, 0
  v_mov_b32 v75, 0
  v_mov_b32 v76, 0
  v_mov_b32 v77, 0
  v_mov_b32 v78, 0
  v_mov_b32 v79, 0
  v_mov_b32 v80, 0
  v_mov_b32 v81, 0
  v_mov_b32 v82, 0
  v_mov_b32 v83, 0
  v_mov_b32 v84, 0
  v_mov_b32 v85, 0
  v_mov_b32 v86, 0
  v_mov_b32 v87, 0
  v_mov_b32 v88, 0
  v_mov_b32 v89, 0
  v_mov_b32 v90, 0
  v_mov_b32 v91, 0
  v_mov_b32 v92, 0
  v_mov_b32 v93, 0
  v_mov_b32 v94, 0
  v_mov_b32 v95, 0
  v_accvgpr_write_b32 a208, 0
  v_accvgpr_write_b32 a209, 0
  v_accvgpr_write_b32 a210, 0
  v_accvgpr_write_b32 a211, 0
  v_accvgpr_write_b32 a212, 0
  v_accvgpr_write_b32 a213, 0
  v_accvgpr_write_b32 a214, 0
  v_accvgpr_write_b32 a215, 0
  s_mov_b32 s56, 0
K2_SPL:
  s_lshl_b32 s62, s56, 14
  s_add_u32 s62, s62, 0
  s_add_u32 s63, s62, 4096
  buffer_load_dwordx4 a[64:67], v3, s[12:15], s62 offen offset:0 sc1
  buffer_load_dwordx4 a[68:71], v3, s[12:15], s62 offen offset:1024 sc1
  buffer_load_dwordx4 a[72:75], v3, s[12:15], s62 offen offset:2048 sc1
  buffer_load_dwordx4 a[76:79], v3, s[12:15], s62 offen offset:3072 sc1
  buffer_load_dwordx4 a[80:83], v3, s[12:15], s63 offen offset:0 sc1
  buffer_load_dwordx4 a[84:87], v3, s[12:15], s63 offen offset:1024 sc1
  buffer_load_dwordx4 a[88:91], v3, s[12:15], s63 offen offset:2048 sc1
  buffer_load_dwordx4 a[92:95], v3, s[12:15], s63 offen offset:3072 sc1
  s_lshl_b32 s62, s56, 14
  s_add_u32 s62, s62, 8192
  s_add_u32 s63, s62, 4096
  buffer_load_dwordx4 a[96:99], v3, s[12:15], s62 offen offset:0 sc1
  buffer_load_dwordx4 a[100:103], v3, s[12:15], s62 offen offset:1024 sc1
  buffer_load_dwordx4 a[104:107], v3, s[12:15], s62 offen offset:2048 sc1
  buffer_load_dwordx4 a[108:111], v3, s[12:15], s62 offen offset:3072 sc1
  buffer_load_dwordx4 a[112:115], v3, s[12:15], s63 offen offset:0 sc1
  buffer_load_dwordx4 a[116:119], v3, s[12:15], s63 offen offset:1024 sc1
  buffer_load_dwordx4 a[120:123], v3, s[12:15], s63 offen offset:2048 sc1
  buffer_load_dwordx4 a[124:127], v3, s[12:15], s63 offen offset:3072 sc1
  s_sub_u32 s67, s56, s65
  s_cmp_lt_i32 s67, 0
  s_cselect_b32 s62, 0, 0xf149f2ca
  v_mov_b32 v25, s62
  s_cmp_le_i32 s67, 0
  s_cselect_b32 s62, 0, 0xf149f2ca
  v_mov_b32 v28, s62
  s_add_u32 s67, s67, 1
  v_med3_f32 v112, v96, v25, v28
  v_med3_f32 v113, v97, v25, v28
  v_med3_f32 v114, v98, v25, v28
  v_med3_f32 v115, v99, v25, v28
  v_med3_f32 v116, v100, v25, v28
  v_med3_f32 v117, v101, v25, v28
  v_med3_f32 v118, v102, v25, v28
  v_med3_f32 v119, v103, v25, v28
  v_med3_f32 v120, v104, v25, v28
  v_med3_f32 v121, v105, v25, v28
  v_med3_f32 v122, v106, v25, v28
  v_med3_f32 v123, v107, v25, v28
  v_med3_f32 v124, v108, v25, v28
  v_med3_f32 v125, v109, v25, v28
  v_med3_f32 v126, v110, v25, v28
  v_med3_f32 v127, v111, v25, v28
  s_nop 1
  s_waitcnt vmcnt(0)
  v_mfma_f32_16x16x32_bf16 v[224:227], a[64:67], a[0:3], v[112:115]
  v_mfma_f32_16x16x32_bf16 v[224:227], a[68:71], a[4:7], v[224:227]
  v_mfma_f32_16x16x32_bf16 v[224:227], a[72:75], a[8:11], v[224:227]
  v_mfma_f32_16x16x32_bf16 v[224:227], a[76:79], a[12:15], v[224:227]
  v_mfma_f32_16x16x32_bf16 v[232:235], a[64:67], a[16:19], v[120:123]
  v_mfma_f32_16x16x32_bf16 v[232:235], a[68:71], a[20:23], v[232:235]
  v_mfma_f32_16x16x32_bf16 v[232:235], a[72:75], a[24:27], v[232:235]
  v_mfma_f32_16x16x32_bf16 v[232:235], a[76:79], a[28:31], v[232:235]
  v_mfma_f32_16x16x32_bf16 v[228:231], a[80:83], a[0:3], v[116:119]
  v_mfma_f32_16x16x32_bf16 v[228:231], a[84:87], a[4:7], v[228:231]
  v_mfma_f32_16x16x32_bf16 v[228:231], a[88:91], a[8:11], v[228:231]
  v_mfma_f32_16x16x32_bf16 v[228:231], a[92:95], a[12:15], v[228:231]
  v_mfma_f32_16x16x32_bf16 v[236:239], a[80:83], a[16:19], v[124:127]
  v_mfma_f32_16x16x32_bf16 v[236:239], a[84:87], a[20:23], v[236:239]
  v_mfma_f32_16x16x32_bf16 v[236:239], a[88:91], a[24:27], v[236:239]
  v_mfma_f32_16x16x32_bf16 v[236:239], a[92:95], a[28:31], v[236:239]
  s_nop 15
  v_sub_f32 v224, v224, v16
  v_sub_f32 v225, v225, v16
  v_sub_f32 v226, v226, v16
  v_sub_f32 v227, v227, v16
  v_sub_f32 v228, v228, v16
  v_sub_f32 v229, v229, v16
  v_sub_f32 v230, v230, v16
  v_sub_f32 v231, v231, v16
  v_sub_f32 v232, v232, v17
  v_sub_f32 v233, v233, v17
  v_sub_f32 v234, v234, v17
  v_sub_f32 v235, v235, v17
  v_sub_f32 v236, v236, v17
  v_sub_f32 v237, v237, v17
  v_sub_f32 v238, v238, v17
  v_sub_f32 v239, v239, v17
  v_exp_f32 v224, v224
  v_exp_f32 v225, v225
  v_exp_f32 v226, v226
  v_exp_f32 v227, v227
  v_exp_f32 v228, v228
  v_exp_f32 v229, v229
  v_exp_f32 v230, v230
  v_exp_f32 v231, v231
  v_exp_f32 v232, v232
  v_exp_f32 v233, v233
  v_exp_f32 v234, v234
  v_exp_f32 v235, v235
  v_exp_f32 v236, v236
  v_exp_f32 v237, v237
  v_exp_f32 v238, v238
  v_exp_f32 v239, v239
  s_nop 0
  v_cvt_pk_bf16_f32 v128, v224, v225
  v_cvt_pk_bf16_f32 v129, v226, v227
  v_cvt_pk_bf16_f32 v130, v228, v229
  v_cvt_pk_bf16_f32 v131, v230, v231
  v_cvt_pk_bf16_f32 v132, v232, v233
  v_cvt_pk_bf16_f32 v133, v234, v235
  v_cvt_pk_bf16_f32 v134, v236, v237
  v_cvt_pk_bf16_f32 v135, v238, v239
  s_nop 1
  v_mfma_f32_16x16x32_bf16 v[32:35], a[96:99], v[128:131], v[32:35]
  v_mfma_f32_16x16x32_bf16 v[36:39], a[96:99], v[132:135], v[36:39]
  v_mfma_f32_16x16x32_bf16 v[40:43], a[100:103], v[128:131], v[40:43]
  v_mfma_f32_16x16x32_bf16 v[44:47], a[100:103], v[132:135], v[44:47]
  v_mfma_f32_16x16x32_bf16 v[48:51], a[104:107], v[128:131], v[48:51]
  v_mfma_f32_16x16x32_bf16 v[52:55], a[104:107], v[132:135], v[52:55]
  v_mfma_f32_16x16x32_bf16 v[56:59], a[108:111], v[128:131], v[56:59]
  v_mfma_f32_16x16x32_bf16 v[60:63], a[108:111], v[132:135], v[60:63]
  v_mfma_f32_16x16x32_bf16 v[64:67], a[112:115], v[128:131], v[64:67]
  v_mfma_f32_16x16x32_bf16 v[68:71], a[112:115], v[132:135], v[68:71]
  v_mfma_f32_16x16x32_bf16 v[72:75], a[116:119], v[128:131], v[72:75]
  v_mfma_f32_16x16x32_bf16 v[76:79], a[116:119], v[132:135], v[76:79]
  v_mfma_f32_16x16x32_bf16 v[80:83], a[120:123], v[128:131], v[80:83]
  v_mfma_f32_16x16x32_bf16 v[84:87], a[120:123], v[132:135], v[84:87]
  v_mfma_f32_16x16x32_bf16 v[88:91], a[124:127], v[128:131], v[88:91]
  v_mfma_f32_16x16x32_bf16 v[92:95], a[124:127], v[132:135], v[92:95]
  v_mfma_f32_16x16x32_bf16 a[208:211], v[4:7], v[128:131], a[208:211]
  v_mfma_f32_16x16x32_bf16 a[212:215], v[4:7], v[132:135], a[212:215]
  s_add_u32 s56, s56, 1
  s_cmp_le_u32 s56, s65
  s_cbranch_scc1 K2_SPL
  s_nop 15
  v_accvgpr_read_b32 v11, a208
  v_accvgpr_read_b32 v12, a212
  v_rcp_f32 v14, v11
  v_rcp_f32 v15, v12
  s_mul_i32 s76, s65, 294912
  s_lshl_b32 s77, s17, 13
  s_add_u32 s76, s76, s77
  s_add_u32 s76, s76, 57671680
  s_add_u32 s77, s76, 4096
  v_mul_f32 v14, v14, v29
  v_mul_f32 v15, v15, v8
  v_pk_mul_f32 v[32:33], v[32:33], v[14:15] op_sel:[0,0] op_sel_hi:[1,0]
  v_pk_mul_f32 v[34:35], v[34:35], v[14:15] op_sel:[0,0] op_sel_hi:[1,0]
  v_pk_mul_f32 v[40:41], v[40:41], v[14:15] op_sel:[0,0] op_sel_hi:[1,0]
  v_pk_mul_f32 v[42:43], v[42:43], v[14:15] op_sel:[0,0] op_sel_hi:[1,0]
  v_cvt_pk_bf16_f32 v32, v32, v33
  v_cvt_pk_bf16_f32 v33, v34, v35
  v_cvt_pk_bf16_f32 v34, v40, v41
  v_cvt_pk_bf16_f32 v35, v42, v43
  buffer_store_dwordx4 v[32:35], v30, s[8:11], s76 offen offset:0 sc1
  v_pk_mul_f32 v[36:37], v[36:37], v[14:15] op_sel:[0,1] op_sel_hi:[1,1]
  v_pk_mul_f32 v[38:39], v[38:39], v[14:15] op_sel:[0,1] op_sel_hi:[1,1]
  v_pk_mul_f32 v[44:45], v[44:45], v[14:15] op_sel:[0,1] op_sel_hi:[1,1]
  v_pk_mul_f32 v[46:47], v[46:47], v[14:15] op_sel:[0,1] op_sel_hi:[1,1]
  v_cvt_pk_bf16_f32 v36, v36, v37
  v_cvt_pk_bf16_f32 v37, v38, v39
  v_cvt_pk_bf16_f32 v38, v44, v45
  v_cvt_pk_bf16_f32 v39, v46, v47
  buffer_store_dwordx4 v[36:39], v30, s[8:11], s76 offen offset:256 sc1
  v_pk_mul_f32 v[48:49], v[48:49], v[14:15] op_sel:[0,0] op_sel_hi:[1,0]
  v_pk_mul_f32 v[50:51], v[50:51], v[14:15] op_sel:[0,0] op_sel_hi:[1,0]
  v_pk_mul_f32 v[56:57], v[56:57], v[14:15] op_sel:[0,0] op_sel_hi:[1,0]
  v_pk_mul_f32 v[58:59], v[58:59], v[14:15] op_sel:[0,0] op_sel_hi:[1,0]
  v_cvt_pk_bf16_f32 v48, v48, v49
  v_cvt_pk_bf16_f32 v49, v50, v51
  v_cvt_pk_bf16_f32 v50, v56, v57
  v_cvt_pk_bf16_f32 v51, v58, v59
  buffer_store_dwordx4 v[48:51], v30, s[8:11], s76 offen offset:2048 sc1
  v_pk_mul_f32 v[52:53], v[52:53], v[14:15] op_sel:[0,1] op_sel_hi:[1,1]
  v_pk_mul_f32 v[54:55], v[54:55], v[14:15] op_sel:[0,1] op_sel_hi:[1,1]
  v_pk_mul_f32 v[60:61], v[60:61], v[14:15] op_sel:[0,1] op_sel_hi:[1,1]
  v_pk_mul_f32 v[62:63], v[62:63], v[14:15] op_sel:[0,1] op_sel_hi:[1,1]
  v_cvt_pk_bf16_f32 v52, v52, v53
  v_cvt_pk_bf16_f32 v53, v54, v55
  v_cvt_pk_bf16_f32 v54, v60, v61
  v_cvt_pk_bf16_f32 v55, v62, v63
  buffer_store_dwordx4 v[52:55], v30, s[8:11], s76 offen offset:2304 sc1
  v_pk_mul_f32 v[64:65], v[64:65], v[14:15] op_sel:[0,0] op_sel_hi:[1,0]
  v_pk_mul_f32 v[66:67], v[66:67], v[14:15] op_sel:[0,0] op_sel_hi:[1,0]
  v_pk_mul_f32 v[72:73], v[72:73], v[14:15] op_sel:[0,0] op_sel_hi:[1,0]
  v_pk_mul_f32 v[74:75], v[74:75], v[14:15] op_sel:[0,0] op_sel_hi:[1,0]
  v_cvt_pk_bf16_f32 v64, v64, v65
  v_cvt_pk_bf16_f32 v65, v66, v67
  v_cvt_pk_bf16_f32 v66, v72, v73
  v_cvt_pk_bf16_f32 v67, v74, v75
  buffer_store_dwordx4 v[64:67], v30, s[8:11], s77 offen offset:0 sc1
  v_pk_mul_f32 v[68:69], v[68:69], v[14:15] op_sel:[0,1] op_sel_hi:[1,1]
  v_pk_mul_f32 v[70:71], v[70:71], v[14:15] op_sel:[0,1] op_sel_hi:[1,1]
  v_pk_mul_f32 v[76:77], v[76:77], v[14:15] op_sel:[0,1] op_sel_hi:[1,1]
  v_pk_mul_f32 v[78:79], v[78:79], v[14:15] op_sel:[0,1] op_sel_hi:[1,1]
  v_cvt_pk_bf16_f32 v68, v68, v69
  v_cvt_pk_bf16_f32 v69, v70, v71
  v_cvt_pk_bf16_f32 v70, v76, v77
  v_cvt_pk_bf16_f32 v71, v78, v79
  buffer_store_dwordx4 v[68:71], v30, s[8:11], s77 offen offset:256 sc1
  v_pk_mul_f32 v[80:81], v[80:81], v[14:15] op_sel:[0,0] op_sel_hi:[1,0]
  v_pk_mul_f32 v[82:83], v[82:83], v[14:15] op_sel:[0,0] op_sel_hi:[1,0]
  v_pk_mul_f32 v[88:89], v[88:89], v[14:15] op_sel:[0,0] op_sel_hi:[1,0]
  v_pk_mul_f32 v[90:91], v[90:91], v[14:15] op_sel:[0,0] op_sel_hi:[1,0]
  v_cvt_pk_bf16_f32 v80, v80, v81
  v_cvt_pk_bf16_f32 v81, v82, v83
  v_cvt_pk_bf16_f32 v82, v88, v89
  v_cvt_pk_bf16_f32 v83, v90, v91
  buffer_store_dwordx4 v[80:83], v30, s[8:11], s77 offen offset:2048 sc1
  v_pk_mul_f32 v[84:85], v[84:85], v[14:15] op_sel:[0,1] op_sel_hi:[1,1]
  v_pk_mul_f32 v[86:87], v[86:87], v[14:15] op_sel:[0,1] op_sel_hi:[1,1]
  v_pk_mul_f32 v[92:93], v[92:93], v[14:15] op_sel:[0,1] op_sel_hi:[1,1]
  v_pk_mul_f32 v[94:95], v[94:95], v[14:15] op_sel:[0,1] op_sel_hi:[1,1]
  v_cvt_pk_bf16_f32 v84, v84, v85
  v_cvt_pk_bf16_f32 v85, v86, v87
  v_cvt_pk_bf16_f32 v86, v92, v93
  v_cvt_pk_bf16_f32 v87, v94, v95
  buffer_store_dwordx4 v[84:87], v30, s[8:11], s77 offen offset:2304 sc1
  v_mov_b32 v16, 0xf149f2ca
  v_mov_b32 v17, 0xf149f2ca
  s_mov_b32 s56, 0
K2_SMH:
  s_lshl_b32 s62, s56, 14
  s_add_u32 s62, s62, 0
  s_add_u32 s63, s62, 4096
  buffer_load_dwordx4 a[64:67], v3, s[12:15], s62 offen offset:0 sc1
  buffer_load_dwordx4 a[68:71], v3, s[12:15], s62 offen offset:1024 sc1
  buffer_load_dwordx4 a[72:75], v3, s[12:15], s62 offen offset:2048 sc1
  buffer_load_dwordx4 a[76:79], v3, s[12:15], s62 offen offset:3072 sc1
  buffer_load_dwordx4 a[80:83], v3, s[12:15], s63 offen offset:0 sc1
  buffer_load_dwordx4 a[84:87], v3, s[12:15], s63 offen offset:1024 sc1
  buffer_load_dwordx4 a[88:91], v3, s[12:15], s63 offen offset:2048 sc1
  buffer_load_dwordx4 a[92:95], v3, s[12:15], s63 offen offset:3072 sc1
  s_sub_u32 s67, s56, s66
  s_cmp_lt_i32 s67, 0
  s_cselect_b32 s62, 0, 0xf149f2ca
  v_mov_b32 v25, s62
  s_cmp_le_i32 s67, 0
  s_cselect_b32 s62, 0, 0xf149f2ca
  v_mov_b32 v28, s62
  s_add_u32 s67, s67, 1
  v_med3_f32 v112, v96, v25, v28
  v_med3_f32 v113, v97, v25, v28
  v_med3_f32 v114, v98, v25, v28
  v_med3_f32 v115, v99, v25, v28
  v_med3_f32 v116, v100, v25, v28
  v_med3_f32 v117, v101, v25, v28
  v_med3_f32 v118, v102, v25, v28
  v_med3_f32 v119, v103, v25, v28
  v_med3_f32 v120, v104, v25, v28
  v_med3_f32 v121, v105, v25, v28
  v_med3_f32 v122, v106, v25, v28
  v_med3_f32 v123, v107, v25, v28
  v_med3_f32 v124, v108, v25, v28
  v_med3_f32 v125, v109, v25, v28
  v_med3_f32 v126, v110, v25, v28
  v_med3_f32 v127, v111, v25, v28
  s_nop 1
  s_waitcnt vmcnt(0)
  v_mfma_f32_16x16x32_bf16 v[224:227], a[64:67], a[32:35], v[112:115]
  v_mfma_f32_16x16x32_bf16 v[224:227], a[68:71], a[36:39], v[224:227]
  v_mfma_f32_16x16x32_bf16 v[224:227], a[72:75], a[40:43], v[224:227]
  v_mfma_f32_16x16x32_bf16 v[224:227], a[76:79], a[44:47], v[224:227]
  v_mfma_f32_16x16x32_bf16 v[232:235], a[64:67], a[48:51], v[120:123]
  v_mfma_f32_16x16x32_bf16 v[232:235], a[68:71], a[52:55], v[232:235]
  v_mfma_f32_16x16x32_bf16 v[232:235], a[72:75], a[56:59], v[232:235]
  v_mfma_f32_16x16x32_bf16 v[232:235], a[76:79], a[60:63], v[232:235]
  v_mfma_f32_16x16x32_bf16 v[228:231], a[80:83], a[32:35], v[116:119]
  v_mfma_f32_16x16x32_bf16 v[228:231], a[84:87], a[36:39], v[228:231]
  v_mfma_f32_16x16x32_bf16 v[228:231], a[88:91], a[40:43], v[228:231]
  v_mfma_f32_16x16x32_bf16 v[228:231], a[92:95], a[44:47], v[228:231]
  v_mfma_f32_16x16x32_bf16 v[236:239], a[80:83], a[48:51], v[124:127]
  v_mfma_f32_16x16x32_bf16 v[236:239], a[84:87], a[52:55], v[236:239]
  v_mfma_f32_16x16x32_bf16 v[236:239], a[88:91], a[56:59], v[236:239]
  v_mfma_f32_16x16x32_bf16 v[236:239], a[92:95], a[60:63], v[236:239]
  s_nop 15
  v_max_f32 v16, v16, v224
  v_max_f32 v16, v16, v225
  v_max_f32 v16, v16, v226
  v_max_f32 v16, v16, v227
  v_max_f32 v16, v16, v228
  v_max_f32 v16, v16, v229
  v_max_f32 v16, v16, v230
  v_max_f32 v16, v16, v231
  v_max_f32 v17, v17, v232
  v_max_f32 v17, v17, v233
  v_max_f32 v17, v17, v234
  v_max_f32 v17, v17, v235
  v_max_f32 v17, v17, v236
  v_max_f32 v17, v17, v237
  v_max_f32 v17, v17, v238
  v_max_f32 v17, v17, v239
  s_add_u32 s56, s56, 1
  s_cmp_le_u32 s56, s66
  s_cbranch_scc1 K2_SMH
  v_mov_b32 v18, v16
  s_nop 1
  v_permlane16_swap_b32 v16, v18
  v_max_f32 v16, v16, v18
  v_mov_b32 v18, v16
  s_nop 1
  v_permlane32_swap_b32 v16, v18
  v_max_f32 v16, v16, v18
  v_mov_b32 v18, v17
  s_nop 1
  v_permlane16_swap_b32 v17, v18
  v_max_f32 v17, v17, v18
  v_mov_b32 v18, v17
  s_nop 1
  v_permlane32_swap_b32 v17, v18
  v_max_f32 v17, v17, v18
  v_mov_b32 v160, 0
  v_mov_b32 v161, 0
  v_mov_b32 v162, 0
  v_mov_b32 v163, 0
  v_mov_b32 v164, 0
  v_mov_b32 v165, 0
  v_mov_b32 v166, 0
  v_mov_b32 v167, 0
  v_mov_b32 v168, 0
  v_mov_b32 v169, 0
  v_mov_b32 v170, 0
  v_mov_b32 v171, 0
  v_mov_b32 v172, 0
  v_mov_b32 v173, 0
  v_mov_b32 v174, 0
  v_mov_b32 v175, 0
  v_mov_b32 v176, 0
  v_mov_b32 v177, 0
  v_mov_b32 v178, 0
  v_mov_b32 v179, 0
  v_mov_b32 v180, 0
  v_mov_b32 v181, 0
  v_mov_b32 v182, 0
  v_mov_b32 v183, 0
  v_mov_b32 v184, 0
  v_mov_b32 v185, 0
  v_mov_b32 v186, 0
  v_mov_b32 v187, 0
  v_mov_b32 v188, 0
  v_mov_b32 v189, 0
  v_mov_b32 v190, 0
  v_mov_b32 v191, 0
  v_mov_b32 v192, 0
  v_mov_b32 v193, 0
  v_mov_b32 v194, 0
  v_mov_b32 v195, 0
  v_mov_b32 v196, 0
  v_mov_b32 v197, 0
  v_mov_b32 v198, 0
  v_mov_b32 v199, 0
  v_mov_b32 v200, 0
  v_mov_b32 v201, 0
  v_mov_b32 v202, 0
  v_mov_b32 v203, 0
  v_mov_b32 v204, 0
  v_mov_b32 v205, 0
  v_mov_b32 v206, 0
  v_mov_b32 v207, 0
  v_mov_b32 v208, 0
  v_mov_b32 v209, 0
  v_mov_b32 v210, 0
  v_mov_b32 v211, 0
  v_mov_b32 v212, 0
  v_mov_b32 v213, 0
  v_mov_b32 v214, 0
  v_mov_b32 v215, 0
  v_mov_b32 v216, 0
  v_mov_b32 v217, 0
  v_mov_b32 v218, 0
  v_mov_b32 v219, 0
  v_mov_b32 v220, 0
  v_mov_b32 v221, 0
  v_mov_b32 v222, 0
  v_mov_b32 v223, 0
  v_accvgpr_write_b32 a216, 0
  v_accvgpr_write_b32 a217, 0
  v_accvgpr_write_b32 a218, 0
  v_accvgpr_write_b32 a219, 0
  v_accvgpr_write_b32 a220, 0
  v_accvgpr_write_b32 a221, 0
  v_accvgpr_write_b32 a222, 0
  v_accvgpr_write_b32 a223, 0
  s_mov_b32 s56, 0
K2_SPH:
  s_lshl_b32 s62, s56, 14
  s_add_u32 s62, s62, 0
  s_add_u32 s63, s62, 4096
  buffer_load_dwordx4 a[64:67], v3, s[12:15], s62 offen offset:0 sc1
  buffer_load_dwordx4 a[68:71], v3, s[12:15], s62 offen offset:1024 sc1
  buffer_load_dwordx4 a[72:75], v3, s[12:15], s62 offen offset:2048 sc1
  buffer_load_dwordx4 a[76:79], v3, s[12:15], s62 offen offset:3072 sc1
  buffer_load_dwordx4 a[80:83], v3, s[12:15], s63 offen offset:0 sc1
  buffer_load_dwordx4 a[84:87], v3, s[12:15], s63 offen offset:1024 sc1
  buffer_load_dwordx4 a[88:91], v3, s[12:15], s63 offen offset:2048 sc1
  buffer_load_dwordx4 a[92:95], v3, s[12:15], s63 offen offset:3072 sc1
  s_lshl_b32 s62, s56, 14
  s_add_u32 s62, s62, 8192
  s_add_u32 s63, s62, 4096
  buffer_load_dwordx4 a[96:99], v3, s[12:15], s62 offen offset:0 sc1
  buffer_load_dwordx4 a[100:103], v3, s[12:15], s62 offen offset:1024 sc1
  buffer_load_dwordx4 a[104:107], v3, s[12:15], s62 offen offset:2048 sc1
  buffer_load_dwordx4 a[108:111], v3, s[12:15], s62 offen offset:3072 sc1
  buffer_load_dwordx4 a[112:115], v3, s[12:15], s63 offen offset:0 sc1
  buffer_load_dwordx4 a[116:119], v3, s[12:15], s63 offen offset:1024 sc1
  buffer_load_dwordx4 a[120:123], v3, s[12:15], s63 offen offset:2048 sc1
  buffer_load_dwordx4 a[124:127], v3, s[12:15], s63 offen offset:3072 sc1
  s_sub_u32 s67, s56, s66
  s_cmp_lt_i32 s67, 0
  s_cselect_b32 s62, 0, 0xf149f2ca
  v_mov_b32 v25, s62
  s_cmp_le_i32 s67, 0
  s_cselect_b32 s62, 0, 0xf149f2ca
  v_mov_b32 v28, s62
  s_add_u32 s67, s67, 1
  v_med3_f32 v112, v96, v25, v28
  v_med3_f32 v113, v97, v25, v28
  v_med3_f32 v114, v98, v25, v28
  v_med3_f32 v115, v99, v25, v28
  v_med3_f32 v116, v100, v25, v28
  v_med3_f32 v117, v101, v25, v28
  v_med3_f32 v118, v102, v25, v28
  v_med3_f32 v119, v103, v25, v28
  v_med3_f32 v120, v104, v25, v28
  v_med3_f32 v121, v105, v25, v28
  v_med3_f32 v122, v106, v25, v28
  v_med3_f32 v123, v107, v25, v28
  v_med3_f32 v124, v108, v25, v28
  v_med3_f32 v125, v109, v25, v28
  v_med3_f32 v126, v110, v25, v28
  v_med3_f32 v127, v111, v25, v28
  s_nop 1
  s_waitcnt vmcnt(0)
  v_mfma_f32_16x16x32_bf16 v[224:227], a[64:67], a[32:35], v[112:115]
  v_mfma_f32_16x16x32_bf16 v[224:227], a[68:71], a[36:39], v[224:227]
  v_mfma_f32_16x16x32_bf16 v[224:227], a[72:75], a[40:43], v[224:227]
  v_mfma_f32_16x16x32_bf16 v[224:227], a[76:79], a[44:47], v[224:227]
  v_mfma_f32_16x16x32_bf16 v[232:235], a[64:67], a[48:51], v[120:123]
  v_mfma_f32_16x16x32_bf16 v[232:235], a[68:71], a[52:55], v[232:235]
  v_mfma_f32_16x16x32_bf16 v[232:235], a[72:75], a[56:59], v[232:235]
  v_mfma_f32_16x16x32_bf16 v[232:235], a[76:79], a[60:63], v[232:235]
  v_mfma_f32_16x16x32_bf16 v[228:231], a[80:83], a[32:35], v[116:119]
  v_mfma_f32_16x16x32_bf16 v[228:231], a[84:87], a[36:39], v[228:231]
  v_mfma_f32_16x16x32_bf16 v[228:231], a[88:91], a[40:43], v[228:231]
  v_mfma_f32_16x16x32_bf16 v[228:231], a[92:95], a[44:47], v[228:231]
  v_mfma_f32_16x16x32_bf16 v[236:239], a[80:83], a[48:51], v[124:127]
  v_mfma_f32_16x16x32_bf16 v[236:239], a[84:87], a[52:55], v[236:239]
  v_mfma_f32_16x16x32_bf16 v[236:239], a[88:91], a[56:59], v[236:239]
  v_mfma_f32_16x16x32_bf16 v[236:239], a[92:95], a[60:63], v[236:239]
  s_nop 15
  v_sub_f32 v224, v224, v16
  v_sub_f32 v225, v225, v16
  v_sub_f32 v226, v226, v16
  v_sub_f32 v227, v227, v16
  v_sub_f32 v228, v228, v16
  v_sub_f32 v229, v229, v16
  v_sub_f32 v230, v230, v16
  v_sub_f32 v231, v231, v16
  v_sub_f32 v232, v232, v17
  v_sub_f32 v233, v233, v17
  v_sub_f32 v234, v234, v17
  v_sub_f32 v235, v235, v17
  v_sub_f32 v236, v236, v17
  v_sub_f32 v237, v237, v17
  v_sub_f32 v238, v238, v17
  v_sub_f32 v239, v239, v17
  v_exp_f32 v224, v224
  v_exp_f32 v225, v225
  v_exp_f32 v226, v226
  v_exp_f32 v227, v227
  v_exp_f32 v228, v228
  v_exp_f32 v229, v229
  v_exp_f32 v230, v230
  v_exp_f32 v231, v231
  v_exp_f32 v232, v232
  v_exp_f32 v233, v233
  v_exp_f32 v234, v234
  v_exp_f32 v235, v235
  v_exp_f32 v236, v236
  v_exp_f32 v237, v237
  v_exp_f32 v238, v238
  v_exp_f32 v239, v239
  s_nop 0
  v_cvt_pk_bf16_f32 v128, v224, v225
  v_cvt_pk_bf16_f32 v129, v226, v227
  v_cvt_pk_bf16_f32 v130, v228, v229
  v_cvt_pk_bf16_f32 v131, v230, v231
  v_cvt_pk_bf16_f32 v132, v232, v233
  v_cvt_pk_bf16_f32 v133, v234, v235
  v_cvt_pk_bf16_f32 v134, v236, v237
  v_cvt_pk_bf16_f32 v135, v238, v239
  s_nop 1
  v_mfma_f32_16x16x32_bf16 v[160:163], a[96:99], v[128:131], v[160:163]
  v_mfma_f32_16x16x32_bf16 v[164:167], a[96:99], v[132:135], v[164:167]
  v_mfma_f32_16x16x32_bf16 v[168:171], a[100:103], v[128:131], v[168:171]
  v_mfma_f32_16x16x32_bf16 v[172:175], a[100:103], v[132:135], v[172:175]
  v_mfma_f32_16x16x32_bf16 v[176:179], a[104:107], v[128:131], v[176:179]
  v_mfma_f32_16x16x32_bf16 v[180:183], a[104:107], v[132:135], v[180:183]
  v_mfma_f32_16x16x32_bf16 v[184:187], a[108:111], v[128:131], v[184:187]
  v_mfma_f32_16x16x32_bf16 v[188:191], a[108:111], v[132:135], v[188:191]
  v_mfma_f32_16x16x32_bf16 v[192:195], a[112:115], v[128:131], v[192:195]
  v_mfma_f32_16x16x32_bf16 v[196:199], a[112:115], v[132:135], v[196:199]
  v_mfma_f32_16x16x32_bf16 v[200:203], a[116:119], v[128:131], v[200:203]
  v_mfma_f32_16x16x32_bf16 v[204:207], a[116:119], v[132:135], v[204:207]
  v_mfma_f32_16x16x32_bf16 v[208:211], a[120:123], v[128:131], v[208:211]
  v_mfma_f32_16x16x32_bf16 v[212:215], a[120:123], v[132:135], v[212:215]
  v_mfma_f32_16x16x32_bf16 v[216:219], a[124:127], v[128:131], v[216:219]
  v_mfma_f32_16x16x32_bf16 v[220:223], a[124:127], v[132:135], v[220:223]
  v_mfma_f32_16x16x32_bf16 a[216:219], v[4:7], v[128:131], a[216:219]
  v_mfma_f32_16x16x32_bf16 a[220:223], v[4:7], v[132:135], a[220:223]
  s_add_u32 s56, s56, 1
  s_cmp_le_u32 s56, s66
  s_cbranch_scc1 K2_SPH
  s_nop 15
  v_accvgpr_read_b32 v11, a216
  v_accvgpr_read_b32 v12, a220
  v_rcp_f32 v14, v11
  v_rcp_f32 v15, v12
  s_mul_i32 s76, s66, 294912
  s_lshl_b32 s77, s17, 13
  s_add_u32 s76, s76, s77
  s_add_u32 s76, s76, 57671680
  s_add_u32 s77, s76, 4096
  v_mul_f32 v14, v14, v9
  v_mul_f32 v15, v15, v10
  s_branch K2_STORE
P4_SLOW:
  s_lshl_b32 s22, s17, 16
  s_lshl_b32 s23, s18, 13
  s_add_u32 s22, s22, s23
  s_lshl_b32 s23, s16, 11
  s_add_u32 s22, s22, s23
  s_add_u32 s22, s22, 50331648
  s_waitcnt vmcnt(0)
  buffer_load_dwordx4 v[176:179], v3, s[8:11], s22 offen sc1
  v_mov_b32 v251, 0xf149f2ca
  s_lshl_b32 s20, s17, 17
  s_add_u32 s20, s20, 52428800
  s_mov_b32 s21, s20
  s_mov_b32 s19, 64
P4_S00:
  buffer_load_dwordx4 a[160:163], v3, s[8:11], s20 offen sc1
  s_add_u32 s20, s20, 2048
  s_waitcnt vmcnt(0)
  v_mfma_f32_32x32x16_bf16 v[208:223], a[160:163], v[176:179], 0
  s_nop 15
  v_max_f32 v251, v251, v208
  v_max_f32 v251, v251, v209
  v_max_f32 v251, v251, v210
  v_max_f32 v251, v251, v211
  v_max_f32 v251, v251, v212
  v_max_f32 v251, v251, v213
  v_max_f32 v251, v251, v214
  v_max_f32 v251, v251, v215
  v_max_f32 v251, v251, v216
  v_max_f32 v251, v251, v217
  v_max_f32 v251, v251, v218
  v_max_f32 v251, v251, v219
  v_max_f32 v251, v251, v220
  v_max_f32 v251, v251, v221
  v_max_f32 v251, v251, v222
  v_max_f32 v251, v251, v223
  s_sub_u32 s19, s19, 1
  s_cmp_lg_u32 s19, 0
  s_cbranch_scc1 P4_S00
  v_mov_b32 v252, v251
  s_nop 1
  v_permlane32_swap_b32 v251, v252
  v_max_f32 v251, v251, v252
  s_lshl_b32 s20, s17, 17
  s_add_u32 s20, s20, 52428800
  s_mov_b32 s21, s20
  s_mov_b32 s19, 64
  v_mov_b32 v160, 0
  v_mov_b32 v161, 0
  v_mov_b32 v162, 0
  v_mov_b32 v163, 0
  v_mov_b32 v164, 0
  v_mov_b32 v165, 0
  v_mov_b32 v166, 0
  v_mov_b32 v167, 0
  v_mov_b32 v168, 0
  v_mov_b32 v169, 0
  v_mov_b32 v170, 0
  v_mov_b32 v171, 0
  v_mov_b32 v172, 0
  v_mov_b32 v173, 0
  v_mov_b32 v174, 0
  v_mov_b32 v175, 0
P4_S01:
  buffer_load_dwordx4 a[160:163], v3, s[8:11], s20 offen sc1
  s_add_u32 s20, s20, 2048
  s_mov_b64 exec, s[30:31]
  buffer_load_dwordx4 a[176:179], v240, s[8:11], s21 offen offset:1024 sc1
  buffer_load_dwordx4 a[180:183], v240, s[8:11], s21 offen offset:1536 sc1
  s_mov_b64 exec, -1
  s_add_u32 s21, s21, 2048
  s_waitcnt vmcnt(0)
  v_mfma_f32_32x32x16_bf16 v[208:223], a[160:163], v[176:179], 0
  s_nop 15
  v_sub_f32 v208, v208, v251
  v_sub_f32 v209, v209, v251
  v_sub_f32 v210, v210, v251
  v_sub_f32 v211, v211, v251
  v_sub_f32 v212, v212, v251
  v_sub_f32 v213, v213, v251
  v_sub_f32 v214, v214, v251
  v_sub_f32 v215, v215, v251
  v_sub_f32 v216, v216, v251
  v_sub_f32 v217, v217, v251
  v_sub_f32 v218, v218, v251
  v_sub_f32 v219, v219, v251
  v_sub_f32 v220, v220, v251
  v_sub_f32 v221, v221, v251
  v_sub_f32 v222, v222, v251
  v_sub_f32 v223, v223, v251
  v_exp_f32 v208, v208
  v_exp_f32 v209, v209
  v_exp_f32 v210, v210
  v_exp_f32 v211, v211
  v_exp_f32 v212, v212
  v_exp_f32 v213, v213
  v_exp_f32 v214, v214
  v_exp_f32 v215, v215
  v_exp_f32 v216, v216
  v_exp_f32 v217, v217
  v_exp_f32 v218, v218
  v_exp_f32 v219, v219
  v_exp_f32 v220, v220
  v_exp_f32 v221, v221
  v_exp_f32 v222, v222
  v_exp_f32 v223, v223
  s_nop 0
  v_cvt_pk_bf16_f32 v224, v208, v209
  v_cvt_pk_bf16_f32 v225, v210, v211
  v_cvt_pk_bf16_f32 v226, v212, v213
  v_cvt_pk_bf16_f32 v227, v214, v215
  v_cvt_pk_bf16_f32 v228, v216, v217
  v_cvt_pk_bf16_f32 v229, v218, v219
  v_cvt_pk_bf16_f32 v230, v220, v221
  v_cvt_pk_bf16_f32 v231, v222, v223
  s_nop 1
  v_mfma_f32_32x32x16_bf16 v[160:175], a[176:179], v[224:227], v[160:175]
  v_mfma_f32_32x32x16_bf16 v[160:175], a[180:183], v[228:231], v[160:175]
  s_nop 7
  s_sub_u32 s19, s19, 1
  s_cmp_lg_u32 s19, 0
  s_cbranch_scc1 P4_S01
  s_nop 7
  v_mov_b32 v192, v160
  v_mov_b32 v193, v161
  v_mov_b32 v194, v162
  v_mov_b32 v195, v163
  v_mov_b32 v196, v164
  v_mov_b32 v197, v165
  v_mov_b32 v198, v166
  v_mov_b32 v199, v167
  v_rcp_f32 v6, v168
  s_nop 0
  v_mul_f32 v6, v6, v241
  v_permlane32_swap_b32 v192, v196
  v_permlane32_swap_b32 v193, v197
  v_permlane32_swap_b32 v194, v198
  v_permlane32_swap_b32 v195, v199
  v_pk_mul_f32 v[192:193], v[192:193], v[6:7] op_sel_hi:[1,0]
  v_pk_mul_f32 v[194:195], v[194:195], v[6:7] op_sel_hi:[1,0]
  v_pk_mul_f32 v[196:197], v[196:197], v[6:7] op_sel_hi:[1,0]
  v_pk_mul_f32 v[198:199], v[198:199], v[6:7] op_sel_hi:[1,0]
  v_cvt_pk_bf16_f32 v200, v192, v193
  v_cvt_pk_bf16_f32 v201, v194, v195
  v_cvt_pk_bf16_f32 v202, v196, v197
  v_cvt_pk_bf16_f32 v203, v198, v199
  buffer_store_dwordx4 v[200:203], v3, s[8:11], s29 offen sc1
  s_lshl_b32 s22, s17, 16
  s_lshl_b32 s23, s18, 13
  s_add_u32 s22, s22, s23
  s_lshl_b32 s23, s16, 11
  s_add_u32 s22, s22, s23
  s_add_u32 s22, s22, 50332672
  s_waitcnt vmcnt(0)
  buffer_load_dwordx4 v[176:179], v3, s[8:11], s22 offen sc1
  v_mov_b32 v251, 0xf149f2ca
  s_lshl_b32 s20, s17, 17
  s_add_u32 s20, s20, 52428800
  s_mov_b32 s21, s20
  s_mov_b32 s19, 64
P4_S10:
  buffer_load_dwordx4 a[160:163], v3, s[8:11], s20 offen sc1
  s_add_u32 s20, s20, 2048
  s_waitcnt vmcnt(0)
  v_mfma_f32_32x32x16_bf16 v[208:223], a[160:163], v[176:179], 0
  s_nop 15
  v_max_f32 v251, v251, v208
  v_max_f32 v251, v251, v209
  v_max_f32 v251, v251, v210
  v_max_f32 v251, v251, v211
  v_max_f32 v251, v251, v212
  v_max_f32 v251, v251, v213
  v_max_f32 v251, v251, v214
  v_max_f32 v251, v251, v215
  v_max_f32 v251, v251, v216
  v_max_f32 v251, v251, v217
  v_max_f32 v251, v251, v218
  v_max_f32 v251, v251, v219
  v_max_f32 v251, v251, v220
  v_max_f32 v251, v251, v221
  v_max_f32 v251, v251, v222
  v_max_f32 v251, v251, v223
  s_sub_u32 s19, s19, 1
  s_cmp_lg_u32 s19, 0
  s_cbranch_scc1 P4_S10
  v_mov_b32 v252, v251
  s_nop 1
  v_permlane32_swap_b32 v251, v252
  v_max_f32 v251, v251, v252
  s_lshl_b32 s20, s17, 17
  s_add_u32 s20, s20, 52428800
  s_mov_b32 s21, s20
  s_mov_b32 s19, 64
  v_mov_b32 v160, 0
  v_mov_b32 v161, 0
  v_mov_b32 v162, 0
  v_mov_b32 v163, 0
  v_mov_b32 v164, 0
  v_mov_b32 v165, 0
  v_mov_b32 v166, 0
  v_mov_b32 v167, 0
  v_mov_b32 v168, 0
  v_mov_b32 v169, 0
  v_mov_b32 v170, 0
  v_mov_b32 v171, 0
  v_mov_b32 v172, 0
  v_mov_b32 v173, 0
  v_mov_b32 v174, 0
  v_mov_b32 v175, 0
P4_S11:
  buffer_load_dwordx4 a[160:163], v3, s[8:11], s20 offen sc1
  s_add_u32 s20, s20, 2048
  s_mov_b64 exec, s[30:31]
  buffer_load_dwordx4 a[176:179], v240, s[8:11], s21 offen offset:1024 sc1
  buffer_load_dwordx4 a[180:183], v240, s[8:11], s21 offen offset:1536 sc1
  s_mov_b64 exec, -1
  s_add_u32 s21, s21, 2048
  s_waitcnt vmcnt(0)
  v_mfma_f32_32x32x16_bf16 v[208:223], a[160:163], v[176:179], 0
  s_nop 15
  v_sub_f32 v208, v208, v251
  v_sub_f32 v209, v209, v251
  v_sub_f32 v210, v210, v251
  v_sub_f32 v211, v211, v251
  v_sub_f32 v212, v212, v251
  v_sub_f32 v213, v213, v251
  v_sub_f32 v214, v214, v251
  v_sub_f32 v215, v215, v251
  v_sub_f32 v216, v216, v251
  v_sub_f32 v217, v217, v251
  v_sub_f32 v218, v218, v251
  v_sub_f32 v219, v219, v251
  v_sub_f32 v220, v220, v251
  v_sub_f32 v221, v221, v251
  v_sub_f32 v222, v222, v251
  v_sub_f32 v223, v223, v251
  v_exp_f32 v208, v208
  v_exp_f32 v209, v209
  v_exp_f32 v210, v210
  v_exp_f32 v211, v211
  v_exp_f32 v212, v212
  v_exp_f32 v213, v213
  v_exp_f32 v214, v214
  v_exp_f32 v215, v215
  v_exp_f32 v216, v216
  v_exp_f32 v217, v217
  v_exp_f32 v218, v218
  v_exp_f32 v219, v219
  v_exp_f32 v220, v220
  v_exp_f32 v221, v221
  v_exp_f32 v222, v222
  v_exp_f32 v223, v223
  s_nop 0
  v_cvt_pk_bf16_f32 v224, v208, v209
  v_cvt_pk_bf16_f32 v225, v210, v211
  v_cvt_pk_bf16_f32 v226, v212, v213
  v_cvt_pk_bf16_f32 v227, v214, v215
  v_cvt_pk_bf16_f32 v228, v216, v217
  v_cvt_pk_bf16_f32 v229, v218, v219
  v_cvt_pk_bf16_f32 v230, v220, v221
  v_cvt_pk_bf16_f32 v231, v222, v223
  s_nop 1
  v_mfma_f32_32x32x16_bf16 v[160:175], a[176:179], v[224:227], v[160:175]
  v_mfma_f32_32x32x16_bf16 v[160:175], a[180:183], v[228:231], v[160:175]
  s_nop 7
  s_sub_u32 s19, s19, 1
  s_cmp_lg_u32 s19, 0
  s_cbranch_scc1 P4_S11
  s_nop 7
  v_mov_b32 v32, v160
  v_mov_b32 v33, v161
  v_mov_b32 v34, v162
  v_mov_b32 v35, v163
  v_mov_b32 v36, v164
  v_mov_b32 v37, v165
  v_mov_b32 v38, v166
  v_mov_b32 v39, v167
  v_rcp_f32 v10, v168
  s_nop 0
  v_mul_f32 v10, v10, v242
  v_permlane32_swap_b32 v32, v36
  v_permlane32_swap_b32 v33, v37
  v_permlane32_swap_b32 v34, v38
  v_permlane32_swap_b32 v35, v39
  v_pk_mul_f32 v[32:33], v[32:33], v[10:11] op_sel_hi:[1,0]
  v_pk_mul_f32 v[34:35], v[34:35], v[10:11] op_sel_hi:[1,0]
  v_pk_mul_f32 v[36:37], v[36:37], v[10:11] op_sel_hi:[1,0]
  v_pk_mul_f32 v[38:39], v[38:39], v[10:11] op_sel_hi:[1,0]
  v_cvt_pk_bf16_f32 v40, v32, v33
  v_cvt_pk_bf16_f32 v41, v34, v35
  v_cvt_pk_bf16_f32 v42, v36, v37
  v_cvt_pk_bf16_f32 v43, v38, v39
  buffer_store_dwordx4 v[40:43], v243, s[8:11], s29 offen sc1
  s_branch P4_STORE
.p2align 6
.type P1_TAB,@object
P1_TAB:
.long 0x1, 0x0, 0x2000, 0x0, 0x0, 0x0, 0x0, 0x100, 0x200, 0x400, 0x4000, 0x80, 0x3e0293ee, 0x1000000, 0x100000, 0x800
.long 0x1, 0x0, 0x2000, 0x0, 0x5, 0x10000, 0x280, 0x100, 0x200, 0x400, 0x4000, 0x80, 0x3e0293ee, 0x1000000, 0x100000, 0x800
.long 0x1, 0x0, 0x2000, 0x0, 0xa, 0x20000, 0x500, 0x100, 0x200, 0x400, 0x4000, 0x80, 0x3e0293ee, 0x1000000, 0x100000, 0x800
.long 0x1, 0x0, 0x2000, 0x0, 0x3c, 0xc0001, 0x1e00, 0x100, 0x200, 0x400, 0x4000, 0x80, 0x3e0293ee, 0x1000000, 0x100000, 0x800
.long 0x1, 0x0, 0x2000, 0x0, 0xf, 0x30000, 0x780, 0x100, 0x200, 0x400, 0x4000, 0x80, 0x3e0293ee, 0x1000000, 0x100000, 0x800
.long 0x1, 0x0, 0x2000, 0x0, 0x14, 0x40000, 0xa00, 0x100, 0x200, 0x400, 0x4000, 0x80, 0x3e0293ee, 0x1000000, 0x100000, 0x800
.long 0x1, 0x0, 0x2000, 0x0, 0x19, 0x50000, 0xc80, 0x100, 0x200, 0x400, 0x4000, 0x80, 0x3e0293ee, 0x1000000, 0x100000, 0x800
.long 0x0, 0x2, 0xc00, 0x0, 0x0, 0x1a0201, 0x0, 0x10000, 0x200, 0x20000, 0x400, 0x100, 0x3eb8aa3b, 0x3000000, 0x80000, 0x40000
.long 0x1, 0x0, 0x2000, 0x0, 0x1e, 0x60000, 0xf00, 0x100, 0x200, 0x400, 0x4000, 0x80, 0x3e0293ee, 0x1000000, 0x100000, 0x800
.long 0x1, 0x0, 0x2000, 0x0, 0x23, 0x70000, 0x1180, 0x100, 0x200, 0x400, 0x4000, 0x80, 0x3e0293ee, 0x1000000, 0x100000, 0x800
.long 0x1, 0x0, 0x2000, 0x0, 0x28, 0x80000, 0x1400, 0x100, 0x200, 0x400, 0x4000, 0x80, 0x3e0293ee, 0x1000000, 0x100000, 0x800
.long 0x0, 0x2, 0xc00, 0x0, 0x4, 0x1b0301, 0x200, 0x10000, 0x200, 0x20000, 0x400, 0x100, 0x3eb8aa3b, 0x3000000, 0x80000, 0x40000
.long 0x1, 0x0, 0x2000, 0x0, 0x2d, 0x90000, 0x1680, 0x100, 0x200, 0x400, 0x4000, 0x80, 0x3e0293ee, 0x1000000, 0x100000, 0x800
.long 0x1, 0x0, 0x2000, 0x0, 0x32, 0xa0000, 0x1900, 0x100, 0x200, 0x400, 0x4000, 0x80, 0x3e0293ee, 0x1000000, 0x100000, 0x800
.long 0x1, 0x0, 0x2000, 0x0, 0x37, 0xb0000, 0x1b80, 0x100, 0x200, 0x400, 0x4000, 0x80, 0x3e0293ee, 0x1000000, 0x100000, 0x800
.long 0x0, 0x2, 0xc00, 0x0, 0x0, 0x1c0403, 0x400, 0x20000, 0x200, 0x40000, 0x800, 0x100, 0x3f800000, 0x3200000, 0x100000, 0x80000
.long 0x1, 0x1, 0x2000, 0x1, 0x0, 0xd0000, 0x0, 0x200, 0x100, 0x4000, 0x800, 0x400, 0x3f800000, 0x1002000, 0x100000, 0x1000
.long 0x1, 0x1, 0x2000, 0x1, 0x5, 0xe0000, 0x280, 0x200, 0x100, 0x4000, 0x800, 0x400, 0x3f800000, 0x1002000, 0x100000, 0x1000
.long 0x1, 0x1, 0x2000, 0x1, 0xa, 0xf0000, 0x500, 0x200, 0x100, 0x4000, 0x800, 0x400, 0x3f800000, 0x1002000, 0x100000, 0x1000
.long 0x1, 0x1, 0x2000, 0x1, 0x3c, 0x190101, 0x1e00, 0x200, 0x100, 0x4000, 0x800, 0x400, 0x3f800000, 0x1002000, 0x100000, 0x1000
.long 0x1, 0x1, 0x2000, 0x1, 0xf, 0x100000, 0x780, 0x200, 0x100, 0x4000, 0x800, 0x400, 0x3f800000, 0x1002000, 0x100000, 0x1000
.long 0x1, 0x1, 0x2000, 0x1, 0x14, 0x110000, 0xa00, 0x200, 0x100, 0x4000, 0x800, 0x400, 0x3f800000, 0x1002000, 0x100000, 0x1000
.long 0x1, 0x1, 0x2000, 0x1, 0x19, 0x120000, 0xc80, 0x200, 0x100, 0x4000, 0x800, 0x400, 0x3f800000, 0x1002000, 0x100000, 0x1000
.long 0x0, 0x2, 0xc00, 0x0, 0x4, 0x1d0501, 0x600, 0x20000, 0x200, 0x40000, 0x800, 0x100, 0x3f800000, 0x3200000, 0x100000, 0x80000
.long 0x1, 0x1, 0x2000, 0x1, 0x1e, 0x130000, 0xf00, 0x200, 0x100, 0x4000, 0x800, 0x400, 0x3f800000, 0x1002000, 0x100000, 0x1000
.long 0x1, 0x1, 0x2000, 0x1, 0x23, 0x140000, 0x1180, 0x200, 0x100, 0x4000, 0x800, 0x400, 0x3f800000, 0x1002000, 0x100000, 0x1000
.long 0x1, 0x1, 0x2000, 0x1, 0x28, 0x150000, 0x1400, 0x200, 0x100, 0x4000, 0x800, 0x400, 0x3f800000, 0x1002000, 0x100000, 0x1000
.long 0x0, 0x2, 0xc00, 0x1, 0x0, 0x1e0601, 0x800, 0x200, 0x100, 0x800, 0x40000, 0x20000, 0x3f800000, 0x3200400, 0x100000, 0x80000
.long 0x1, 0x1, 0x2000, 0x1, 0x2d, 0x160000, 0x1680, 0x200, 0x100, 0x4000, 0x800, 0x400, 0x3f800000, 0x1002000, 0x100000, 0x1000
.long 0x1, 0x1, 0x2000, 0x1, 0x32, 0x170000, 0x1900, 0x200, 0x100, 0x4000, 0x800, 0x400, 0x3f800000, 0x1002000, 0x100000, 0x1000
.long 0x1, 0x1, 0x2000, 0x1, 0x37, 0x180000, 0x1b80, 0x200, 0x100, 0x4000, 0x800, 0x400, 0x3f800000, 0x1002000, 0x100000, 0x1000
.long 0x0, 0x2, 0xc00, 0x1, 0x4, 0x1f0701, 0xa00, 0x200, 0x100, 0x800, 0x40000, 0x20000, 0x3f800000, 0x3200400, 0x100000, 0x80000
.section .rodata,"a"
.p2align 6
.amdhsa_kernel gated_mix__compressed_kv_cla__mha_block__prompt_kernel
  .amdhsa_next_free_vgpr 512
  .amdhsa_next_free_sgpr 102
  .amdhsa_accum_offset 256
  .amdhsa_group_segment_fixed_size 0
  .amdhsa_kernarg_size 104
  .amdhsa_user_sgpr_count 2
  .amdhsa_user_sgpr_kernarg_segment_ptr 1
  .amdhsa_system_sgpr_workgroup_id_x 1
.end_amdhsa_kernel
```
